```python
import torch

def _softmax(x, axis=-1):
    return torch.softmax(x, dim=axis)
def _gelu(x):
    return torch.nn.functional.gelu(x, approximate="tanh")
def _silu(x):
    return torch.nn.functional.silu(x)
def _sigmoid(x):
    return torch.sigmoid(x)
def _layernorm(x, axis=-1, eps=1e-5):
    m = x.mean(dim=axis, keepdim=True)
    v = x.var(dim=axis, keepdim=True, unbiased=False)
    return (x - m) / torch.sqrt(v + eps)
def _scatter_add(tgt, idx, src, axis=0):
    return tgt.clone().index_add_(axis, idx, src)
def _segment_sum(src, seg, n):
    out = torch.zeros((n,) + src.shape[1:], dtype=src.dtype)
    return out.index_add_(0, seg, src)
def _pad(x, pw):
    flat = tuple(v for pair in reversed(pw) for v in pair)
    return torch.nn.functional.pad(x, flat)

kernel_name = 'sequential_preLN__linear_attn_block__moe_arch_mod__prompt'

def setup_inputs():

    _w = (lambda a: (lambda t: t.to(torch.bfloat16) if t.is_floating_point() else t)(torch.as_tensor(a)))
    def _A_setup():
        B, S, D = 1, 2048, 1024
        return {
            "x": _w((lambda *s: torch.randn(*s, dtype=torch.bfloat16) * 0.05)(B, S, D)),
            "wqkv": _w((lambda *s: torch.randn(*s, dtype=torch.bfloat16) * 0.05)(D, 3 * D)),
            "wo": _w((lambda *s: torch.randn(*s, dtype=torch.bfloat16) * 0.05)(D, D)),
        }
    _A_in = _A_setup()

    def _B_setup():
        B, S, D, F, C = 1, 2048, 1024, 3584, 2
        return {
            "x": _w((lambda *s: torch.randn(*s, dtype=torch.bfloat16) * 0.05)(B, S, D)),
            "w_r": _w((lambda *s: torch.randn(*s, dtype=torch.bfloat16) * 0.05)(D)),
            "w_gate": _w((lambda *s: torch.randn(*s, dtype=torch.bfloat16) * 0.05)(D, F)),
            "w_up": _w((lambda *s: torch.randn(*s, dtype=torch.bfloat16) * 0.05)(D, F)),
            "w_down": _w((lambda *s: torch.randn(*s, dtype=torch.bfloat16) * 0.05)(F, D)),
        }
    _B_in = _B_setup()

    return {
        "A_x": _A_in["x"],
        "A_wqkv": _A_in["wqkv"],
        "A_wo": _A_in["wo"],
        "B_x": _B_in["x"],
        "B_w_r": _B_in["w_r"],
        "B_w_gate": _B_in["w_gate"],
        "B_w_up": _B_in["w_up"],
        "B_w_down": _B_in["w_down"],
    }

def reference(A_x, A_wqkv, A_wo, B_x, B_w_r, B_w_gate, B_w_up, B_w_down):
    def _A_ref(x, wqkv, wo):
        B, S, D = x.shape
        H = 32; Dh = D // H
        qkv = (lambda x, *d: x.permute(*d))((x @ wqkv).reshape(B, S, 3, H, Dh), 2, 0, 3, 1, 4)
        q, k, v = qkv[0], qkv[1], qkv[2]
        phi = lambda t: torch.where(t > 0, t + 1, torch.exp(t)) + 1e-6
        pq, pk = phi(q), phi(k)
        kv = torch.einsum("bhsd,bhse->bhde", pk, v)
        z = torch.einsum("bhsd->bhd", pk)
        num = torch.einsum("bhqd,bhde->bhqe", pq, kv)
        den = torch.einsum("bhqd,bhd->bhq", pq, z)[..., None] + 1e-6
        o = num / den
        return (lambda x, *d: x.permute(*d))(o, 0, 2, 1, 3).reshape(B, S, D) @ wo

    def _B_ref(x, w_r, w_gate, w_up, w_down):
        B, S, D = x.shape
        C = 2
        r = x @ w_r
        idx = torch.argsort(-r, axis=-1)[:, :C]
        idx_e = (lambda x, n, axis: torch.repeat_interleave(x, n, dim=axis))(idx.reshape(B, C, 1), D, axis=2)
        x_sel = (lambda x, i, axis: torch.take_along_dim(x, i, dim=axis))(x, idx_e, axis=1)
        g = _silu(x_sel @ w_gate)
        u = x_sel @ w_up
        y = (g * u) @ w_down
        r_sel = _sigmoid((lambda x, i, axis: torch.take_along_dim(x, i, dim=axis))(r, idx, axis=1))
        y = y * r_sel.reshape(B, C, 1)
        b_off = (torch.arange(B) * S).reshape(B, 1)
        flat_idx = (idx + b_off).reshape(B * C)
        zero = (x * 0.0).reshape(B * S, D)
        upd = _scatter_add(zero, flat_idx, y.reshape(B * C, D), axis=0)
        return x + upd.reshape(B, S, D)

    x = A_x
    h = x + _A_ref(_layernorm(x, axis=-1), A_wqkv, A_wo)
    h2 = h + _B_ref(_layernorm(h, axis=-1), B_w_r, B_w_gate, B_w_up, B_w_down)
    return h2
```

```asm
; @launch grid=(256,1,1) block=(512,1,1) lds=163840
.amdgcn_target "amdgcn-amd-amdhsa--gfx950"
.text
.globl sequential_preLN__linear_attn_block__moe_arch_mod__prompt_kernel
.p2align 8
.type sequential_preLN__linear_attn_block__moe_arch_mod__prompt_kernel,@function
sequential_preLN__linear_attn_block__moe_arch_mod__prompt_kernel:
    s_cmp_ge_u32 s2, 256
    s_cbranch_scc1 L_end
    s_load_dwordx16 s[64:79], s[0:1], 0
    s_load_dwordx4 s[80:83], s[0:1], 64
    s_load_dwordx2 s[84:85], s[0:1], 80
    v_lshrrev_b32 v1, 6, v0
    v_and_b32 v0, 63, v0
    v_readfirstlane_b32 s3, v1
    s_and_b32 s44, s2, 7
    s_lshr_b32 s45, s2, 3
    s_and_b32 s46, s44, 1
    s_lshl_b32 s46, s46, 3
    s_and_b32 s86, s45, 7
    s_add_u32 s46, s46, s86
    s_lshr_b32 s47, s44, 1
    s_lshl_b32 s47, s47, 2
    s_lshr_b32 s86, s45, 3
    s_add_u32 s47, s47, s86
    s_lshl_b32 s51, s44, 1
    s_lshr_b32 s86, s45, 4
    s_add_u32 s51, s51, s86
    s_and_b32 s52, s45, 15
    s_and_b32 s48, s3, 3
    s_and_b32 s49, s3, 1
    s_bfe_u32 s50, s3, 0x10001
    s_mov_b32 s56, 262144
    s_mov_b32 s95, 0x3f803f80
    s_movk_i32 s92, 0x1000
    s_movk_i32 s93, 0x2000
    s_movk_i32 s94, 0x3000
    s_cmp_lt_u32 s3, 4
    s_cbranch_scc1 L_comp
    v_lshrrev_b32 v20, 3, v0
    v_and_b32 v21, 7, v0
    v_lshrrev_b32 v22, 4, v0
    v_xor_b32 v23, v21, v22
    v_xor_b32 v24, 4, v23
    s_lshl_b32 s86, s48, 5
    v_add_u32 v25, s86, v20
    v_lshlrev_b32 v25, 11, v25
    v_lshl_add_u32 v2, v23, 4, v25
    v_lshl_add_u32 v3, v24, 4, v25
    v_add_u32 v3, 15360, v3
    v_lshl_add_u32 v4, v23, 4, v25
    v_add_u32 v4, 30720, v4
    v_lshl_add_u32 v5, v24, 4, v25
    v_add_u32 v5, 46080, v5
    s_lshl_b32 s86, s48, 4
    v_add_u32 v25, s86, v20
    v_mul_u32_u24 v25, 6144, v25
    s_lshl_b32 s86, s47, 7
    v_add_u32 v25, s86, v25
    v_bfe_u32 v26, v0, 4, 1
    v_lshlrev_b32 v26, 1, v26
    v_xor_b32 v26, v26, v21
    v_xor_b32 v27, 4, v26
    v_lshl_add_u32 v6, v26, 4, v25
    v_lshl_add_u32 v7, v27, 4, v25
    v_add_u32 v7, 48128, v7
    v_lshl_add_u32 v8, v26, 4, v25
    v_add_u32 v8, 2048, v8
    v_lshl_add_u32 v9, v27, 4, v25
    v_add_u32 v9, 50176, v9
    v_lshl_add_u32 v10, v26, 4, v25
    v_add_u32 v10, 4096, v10
    v_lshl_add_u32 v11, v27, 4, v25
    v_add_u32 v11, 52224, v11
    s_lshl_b32 s63, s46, 18
    s_lshl_b32 s53, s48, 12
    s_lshl_b32 s62, s48, 11
    s_add_u32 s62, s62, 16384
    s_waitcnt lgkmcnt(0)
    s_mov_b32 s8, s64
    s_and_b32 s9, s65, 0xffff
    s_mov_b32 s10, 4194304
    s_mov_b32 s11, 0x20000
    s_mov_b32 s12, s66
    s_and_b32 s13, s67, 0xffff
    s_mov_b32 s14, 6291456
    s_mov_b32 s15, 0x20000
    s_add_u32 m0, s53, 0
    s_add_u32 s90, s63, 0
    buffer_load_dwordx4 v2, s[8:11], s90 offen offset:0 lds
    buffer_load_dwordx4 v3, s[8:11], s90 offen offset:1024 lds
    buffer_load_dwordx4 v4, s[8:11], s90 offen offset:2048 lds
    buffer_load_dwordx4 v5, s[8:11], s90 offen offset:3072 lds
    s_mov_b32 s91, 0
    s_add_u32 m0, s62, 0
    s_nop 0
    buffer_load_dwordx4 v6, s[12:15], s91 offen offset:0 lds
    buffer_load_dwordx4 v7, s[12:15], s91 offen offset:1024 lds
    s_add_u32 m0, s62, 8192
    s_nop 0
    buffer_load_dwordx4 v8, s[12:15], s91 offen offset:0 lds
    buffer_load_dwordx4 v9, s[12:15], s91 offen offset:1024 lds
    s_add_u32 m0, s62, 16384
    s_nop 0
    buffer_load_dwordx4 v10, s[12:15], s91 offen offset:0 lds
    buffer_load_dwordx4 v11, s[12:15], s91 offen offset:1024 lds
    s_add_u32 m0, s53, 40960
    s_add_u32 s90, s63, 128
    buffer_load_dwordx4 v2, s[8:11], s90 offen offset:0 lds
    buffer_load_dwordx4 v3, s[8:11], s90 offen offset:1024 lds
    buffer_load_dwordx4 v4, s[8:11], s90 offen offset:2048 lds
    buffer_load_dwordx4 v5, s[8:11], s90 offen offset:3072 lds
    s_mov_b32 s91, 393216
    s_add_u32 m0, s62, 40960
    s_nop 0
    buffer_load_dwordx4 v6, s[12:15], s91 offen offset:0 lds
    buffer_load_dwordx4 v7, s[12:15], s91 offen offset:1024 lds
    s_add_u32 m0, s62, 49152
    s_nop 0
    buffer_load_dwordx4 v8, s[12:15], s91 offen offset:0 lds
    buffer_load_dwordx4 v9, s[12:15], s91 offen offset:1024 lds
    s_add_u32 m0, s62, 57344
    s_nop 0
    buffer_load_dwordx4 v10, s[12:15], s91 offen offset:0 lds
    buffer_load_dwordx4 v11, s[12:15], s91 offen offset:1024 lds
    s_mov_b32 s16, s84
    s_and_b32 s17, s85, 0xffff
    s_mov_b32 s18, 268435456
    s_mov_b32 s19, 0x20000
    s_mov_b32 s20, s68
    s_and_b32 s21, s69, 0xffff
    s_mov_b32 s22, 2097152
    s_mov_b32 s23, 0x20000
    s_mov_b32 s24, s80
    s_and_b32 s25, s81, 0xffff
    s_mov_b32 s26, 4194304
    s_mov_b32 s27, 0x20000
    s_mov_b32 s28, s82
    s_and_b32 s29, s83, 0xffff
    s_mov_b32 s30, 256
    s_mov_b32 s31, 0x20000
    s_bitcmp1_b32 s2, 0
    s_cselect_b32 s32, s76, s74
    s_cselect_b32 s33, s77, s75
    s_and_b32 s33, s33, 0xffff
    s_mov_b32 s34, 7340032
    s_mov_b32 s35, 0x20000
    s_mov_b32 s36, s78
    s_and_b32 s37, s79, 0xffff
    s_mov_b32 s38, 7340032
    s_mov_b32 s39, 0x20000
    s_mov_b32 s40, s72
    s_and_b32 s41, s73, 0xffff
    s_mov_b32 s42, 2048
    s_mov_b32 s43, 0x20000
    s_cmp_eq_u32 s48, 3
    s_cbranch_scc1 L_h0_stat_ld
    s_lshl_b32 s86, s46, 6
    v_add_u32 v25, s86, v20
    v_mul_u32_u24 v25, 6144, v25
    s_lshl_b32 s86, s48, 11
    s_lshl_b32 s87, s47, 7
    s_add_u32 s86, s86, s87
    v_lshl_add_u32 v26, v21, 4, s86
    v_add_u32 v25, v25, v26
    s_mov_b32 s90, 0
    buffer_load_dwordx4 v[40:43], v25, s[12:15], s90 offen
    s_mov_b32 s90, 49152
    buffer_load_dwordx4 v[44:47], v25, s[12:15], s90 offen
    s_mov_b32 s90, 98304
    buffer_load_dwordx4 v[48:51], v25, s[12:15], s90 offen
    s_mov_b32 s90, 147456
    buffer_load_dwordx4 v[52:55], v25, s[12:15], s90 offen
    s_mov_b32 s90, 196608
    buffer_load_dwordx4 v[56:59], v25, s[12:15], s90 offen
    s_mov_b32 s90, 245760
    buffer_load_dwordx4 v[60:63], v25, s[12:15], s90 offen
    s_mov_b32 s90, 294912
    buffer_load_dwordx4 v[64:67], v25, s[12:15], s90 offen
    s_mov_b32 s90, 344064
    buffer_load_dwordx4 v[68:71], v25, s[12:15], s90 offen
    s_waitcnt vmcnt(18)
    s_barrier
    s_add_u32 m0, s53, 81920
    s_add_u32 s90, s63, 256
    buffer_load_dwordx4 v2, s[8:11], s90 offen offset:0 lds
    buffer_load_dwordx4 v3, s[8:11], s90 offen offset:1024 lds
    buffer_load_dwordx4 v4, s[8:11], s90 offen offset:2048 lds
    buffer_load_dwordx4 v5, s[8:11], s90 offen offset:3072 lds
    s_mov_b32 s91, 786432
    s_add_u32 m0, s62, 81920
    s_nop 0
    buffer_load_dwordx4 v6, s[12:15], s91 offen offset:0 lds
    buffer_load_dwordx4 v7, s[12:15], s91 offen offset:1024 lds
    s_add_u32 m0, s62, 90112
    s_nop 0
    buffer_load_dwordx4 v8, s[12:15], s91 offen offset:0 lds
    buffer_load_dwordx4 v9, s[12:15], s91 offen offset:1024 lds
    s_add_u32 m0, s62, 98304
    s_nop 0
    buffer_load_dwordx4 v10, s[12:15], s91 offen offset:0 lds
    buffer_load_dwordx4 v11, s[12:15], s91 offen offset:1024 lds
    s_waitcnt vmcnt(18)
    s_branch L_h0_ld_done
L_h0_stat_ld:
    s_lshl_b32 s86, s46, 7
    s_lshl_b32 s87, s47, 3
    s_add_u32 s86, s86, s87
    v_add_u32 v25, s86, v20
    v_lshlrev_b32 v13, 3, v25
    v_lshlrev_b32 v25, 11, v25
    v_lshl_add_u32 v25, v21, 4, v25
    buffer_load_dwordx4 v[40:43], v25, s[8:11], 0 offen offset:0
    buffer_load_dwordx4 v[44:47], v25, s[8:11], 0 offen offset:128
    buffer_load_dwordx4 v[48:51], v25, s[8:11], 0 offen offset:256
    buffer_load_dwordx4 v[52:55], v25, s[8:11], 0 offen offset:384
    buffer_load_dwordx4 v[56:59], v25, s[8:11], 0 offen offset:512
    buffer_load_dwordx4 v[60:63], v25, s[8:11], 0 offen offset:640
    buffer_load_dwordx4 v[64:67], v25, s[8:11], 0 offen offset:768
    buffer_load_dwordx4 v[68:71], v25, s[8:11], 0 offen offset:896
    buffer_load_dwordx4 v[72:75], v25, s[8:11], 0 offen offset:1024
    buffer_load_dwordx4 v[76:79], v25, s[8:11], 0 offen offset:1152
    buffer_load_dwordx4 v[80:83], v25, s[8:11], 0 offen offset:1280
    buffer_load_dwordx4 v[84:87], v25, s[8:11], 0 offen offset:1408
    buffer_load_dwordx4 v[88:91], v25, s[8:11], 0 offen offset:1536
    buffer_load_dwordx4 v[92:95], v25, s[8:11], 0 offen offset:1664
    buffer_load_dwordx4 v[96:99], v25, s[8:11], 0 offen offset:1792
    buffer_load_dwordx4 v[100:103], v25, s[8:11], 0 offen offset:1920
    s_waitcnt vmcnt(26)
    s_barrier
    s_add_u32 m0, s53, 81920
    s_add_u32 s90, s63, 256
    buffer_load_dwordx4 v2, s[8:11], s90 offen offset:0 lds
    buffer_load_dwordx4 v3, s[8:11], s90 offen offset:1024 lds
    buffer_load_dwordx4 v4, s[8:11], s90 offen offset:2048 lds
    buffer_load_dwordx4 v5, s[8:11], s90 offen offset:3072 lds
    s_mov_b32 s91, 786432
    s_add_u32 m0, s62, 81920
    s_nop 0
    buffer_load_dwordx4 v6, s[12:15], s91 offen offset:0 lds
    buffer_load_dwordx4 v7, s[12:15], s91 offen offset:1024 lds
    s_add_u32 m0, s62, 90112
    s_nop 0
    buffer_load_dwordx4 v8, s[12:15], s91 offen offset:0 lds
    buffer_load_dwordx4 v9, s[12:15], s91 offen offset:1024 lds
    s_add_u32 m0, s62, 98304
    s_nop 0
    buffer_load_dwordx4 v10, s[12:15], s91 offen offset:0 lds
    buffer_load_dwordx4 v11, s[12:15], s91 offen offset:1024 lds
    s_waitcnt vmcnt(26)
L_h0_ld_done:
    s_barrier
    v_lshrrev_b32 v22, 4, v0
    v_and_b32 v23, 15, v0
    s_bfe_u32 s86, s2, 0x20001
    s_lshl_b32 s86, s86, 2
    s_add_u32 s86, s86, s48
    s_lshl_b32 s86, s86, 6
    v_lshl_add_u32 v30, v22, 4, s86
    v_mul_u32_u24 v30, 7168, v30
    s_lshl_b32 s86, s45, 8
    s_cmp_ge_u32 s2, 224
    s_cselect_b32 s86, 2147483648, s86
    v_lshl_add_u32 v24, v23, 4, s86
    v_add_u32 v30, v30, v24
    s_mul_i32 s86, s45, 112
    s_mul_i32 s87, s48, 28
    s_add_u32 s86, s86, s87
    v_mul_u32_u24 v31, 7, v22
    v_add_u32 v31, s86, v31
    v_lshlrev_b32 v31, 11, v31
    s_lshl_b32 s86, s44, 8
    v_lshl_add_u32 v24, v23, 4, s86
    v_add_u32 v31, v31, v24
    v_lshlrev_b32 v24, 1, v22
    v_xor_b32 v24, v24, v21
    s_lshl_b32 s86, s48, 3
    v_add_u32 v12, s86, v20
    v_lshlrev_b32 v12, 11, v12
    s_lshl_b32 s86, s52, 7
    v_lshl_add_u32 v24, v24, 4, s86
    v_add_u32 v12, v12, v24
    s_add_u32 m0, s53, 0
    s_add_u32 s90, s63, 384
    buffer_load_dwordx4 v2, s[8:11], s90 offen offset:0 lds
    buffer_load_dwordx4 v3, s[8:11], s90 offen offset:1024 lds
    buffer_load_dwordx4 v4, s[8:11], s90 offen offset:2048 lds
    buffer_load_dwordx4 v5, s[8:11], s90 offen offset:3072 lds
    s_mov_b32 s91, 1179648
    s_add_u32 m0, s62, 0
    s_nop 0
    buffer_load_dwordx4 v6, s[12:15], s91 offen offset:0 lds
    buffer_load_dwordx4 v7, s[12:15], s91 offen offset:1024 lds
    s_add_u32 m0, s62, 8192
    s_nop 0
    buffer_load_dwordx4 v8, s[12:15], s91 offen offset:0 lds
    buffer_load_dwordx4 v9, s[12:15], s91 offen offset:1024 lds
    s_add_u32 m0, s62, 16384
    s_nop 0
    buffer_load_dwordx4 v10, s[12:15], s91 offen offset:0 lds
    buffer_load_dwordx4 v11, s[12:15], s91 offen offset:1024 lds
    s_waitcnt vmcnt(20)
    s_cmp_eq_u32 s48, 3
    s_cbranch_scc1 L_h0_stat_1
    v_and_b32 v24, 1, v0
    v_lshlrev_b32 v24, 4, v24
    v_mov_b32 v25, 0x3f80
    v_lshlrev_b32 v24, v24, v25
    v_bfe_u32 v25, v0, 1, 2
    v_cmp_eq_u32 vcc, 0, v25
    s_nop 1
    v_cndmask_b32 v104, 0, v24, vcc
    v_cmp_eq_u32 vcc, 1, v25
    s_nop 1
    v_cndmask_b32 v105, 0, v24, vcc
    v_cmp_eq_u32 vcc, 2, v25
    s_nop 1
    v_cndmask_b32 v106, 0, v24, vcc
    v_cmp_eq_u32 vcc, 3, v25
    s_nop 1
    v_cndmask_b32 v107, 0, v24, vcc
    s_nop 1
    v_mfma_f32_16x16x32_bf16 v[108:111], v[104:107], v[40:43], 0
    v_mfma_f32_16x16x32_bf16 v[108:111], v[104:107], v[44:47], v[108:111]
    v_mfma_f32_16x16x32_bf16 v[108:111], v[104:107], v[48:51], v[108:111]
    v_mfma_f32_16x16x32_bf16 v[108:111], v[104:107], v[52:55], v[108:111]
    v_mfma_f32_16x16x32_bf16 v[108:111], v[104:107], v[56:59], v[108:111]
    v_mfma_f32_16x16x32_bf16 v[108:111], v[104:107], v[60:63], v[108:111]
    v_mfma_f32_16x16x32_bf16 v[108:111], v[104:107], v[64:67], v[108:111]
    v_mfma_f32_16x16x32_bf16 v[108:111], v[104:107], v[68:71], v[108:111]
    s_branch L_h0_1_done
L_h0_stat_1:
    v_mov_b32 v104, 0
    v_mov_b32 v105, 0
    v_mov_b32 v106, 0
    v_mov_b32 v107, 0
    v_mov_b32 v108, 0
    v_mov_b32 v109, 0
    v_mov_b32 v110, 0
    v_mov_b32 v111, 0
    v_dot2c_f32_bf16 v104, s95, v40
    v_dot2c_f32_bf16 v105, s95, v41
    v_dot2c_f32_bf16 v106, s95, v42
    v_dot2c_f32_bf16 v107, s95, v43
    v_dot2c_f32_bf16 v108, v40, v40
    v_dot2c_f32_bf16 v109, v41, v41
    v_dot2c_f32_bf16 v110, v42, v42
    v_dot2c_f32_bf16 v111, v43, v43
    v_dot2c_f32_bf16 v104, s95, v44
    v_dot2c_f32_bf16 v105, s95, v45
    v_dot2c_f32_bf16 v106, s95, v46
    v_dot2c_f32_bf16 v107, s95, v47
    v_dot2c_f32_bf16 v108, v44, v44
    v_dot2c_f32_bf16 v109, v45, v45
    v_dot2c_f32_bf16 v110, v46, v46
    v_dot2c_f32_bf16 v111, v47, v47
    v_dot2c_f32_bf16 v104, s95, v48
    v_dot2c_f32_bf16 v105, s95, v49
    v_dot2c_f32_bf16 v106, s95, v50
    v_dot2c_f32_bf16 v107, s95, v51
    v_dot2c_f32_bf16 v108, v48, v48
    v_dot2c_f32_bf16 v109, v49, v49
    v_dot2c_f32_bf16 v110, v50, v50
    v_dot2c_f32_bf16 v111, v51, v51
    v_dot2c_f32_bf16 v104, s95, v52
    v_dot2c_f32_bf16 v105, s95, v53
    v_dot2c_f32_bf16 v106, s95, v54
    v_dot2c_f32_bf16 v107, s95, v55
    v_dot2c_f32_bf16 v108, v52, v52
    v_dot2c_f32_bf16 v109, v53, v53
    v_dot2c_f32_bf16 v110, v54, v54
    v_dot2c_f32_bf16 v111, v55, v55
    v_dot2c_f32_bf16 v104, s95, v56
    v_dot2c_f32_bf16 v105, s95, v57
    v_dot2c_f32_bf16 v106, s95, v58
    v_dot2c_f32_bf16 v107, s95, v59
    v_dot2c_f32_bf16 v108, v56, v56
    v_dot2c_f32_bf16 v109, v57, v57
    v_dot2c_f32_bf16 v110, v58, v58
    v_dot2c_f32_bf16 v111, v59, v59
    v_dot2c_f32_bf16 v104, s95, v60
    v_dot2c_f32_bf16 v105, s95, v61
    v_dot2c_f32_bf16 v106, s95, v62
    v_dot2c_f32_bf16 v107, s95, v63
    v_dot2c_f32_bf16 v108, v60, v60
    v_dot2c_f32_bf16 v109, v61, v61
    v_dot2c_f32_bf16 v110, v62, v62
    v_dot2c_f32_bf16 v111, v63, v63
    v_dot2c_f32_bf16 v104, s95, v64
    v_dot2c_f32_bf16 v105, s95, v65
    v_dot2c_f32_bf16 v106, s95, v66
    v_dot2c_f32_bf16 v107, s95, v67
    v_dot2c_f32_bf16 v108, v64, v64
    v_dot2c_f32_bf16 v109, v65, v65
    v_dot2c_f32_bf16 v110, v66, v66
    v_dot2c_f32_bf16 v111, v67, v67
    v_dot2c_f32_bf16 v104, s95, v68
    v_dot2c_f32_bf16 v105, s95, v69
    v_dot2c_f32_bf16 v106, s95, v70
    v_dot2c_f32_bf16 v107, s95, v71
    v_dot2c_f32_bf16 v108, v68, v68
    v_dot2c_f32_bf16 v109, v69, v69
    v_dot2c_f32_bf16 v110, v70, v70
    v_dot2c_f32_bf16 v111, v71, v71
L_h0_1_done:
    s_mov_b32 s90, 0
    buffer_load_dwordx4 v[164:167], v30, s[32:35], s90 offen
    s_mov_b32 s90, 7168
    buffer_load_dwordx4 v[168:171], v30, s[32:35], s90 offen
    s_waitcnt vmcnt(12)
    s_barrier
    s_add_u32 m0, s53, 40960
    s_add_u32 s90, s63, 512
    buffer_load_dwordx4 v2, s[8:11], s90 offen offset:0 lds
    buffer_load_dwordx4 v3, s[8:11], s90 offen offset:1024 lds
    buffer_load_dwordx4 v4, s[8:11], s90 offen offset:2048 lds
    buffer_load_dwordx4 v5, s[8:11], s90 offen offset:3072 lds
    s_mov_b32 s91, 1572864
    s_add_u32 m0, s62, 40960
    s_nop 0
    buffer_load_dwordx4 v6, s[12:15], s91 offen offset:0 lds
    buffer_load_dwordx4 v7, s[12:15], s91 offen offset:1024 lds
    s_add_u32 m0, s62, 49152
    s_nop 0
    buffer_load_dwordx4 v8, s[12:15], s91 offen offset:0 lds
    buffer_load_dwordx4 v9, s[12:15], s91 offen offset:1024 lds
    s_add_u32 m0, s62, 57344
    s_nop 0
    buffer_load_dwordx4 v10, s[12:15], s91 offen offset:0 lds
    buffer_load_dwordx4 v11, s[12:15], s91 offen offset:1024 lds
    s_cmp_eq_u32 s48, 3
    s_cbranch_scc1 L_h0_stat_2
    v_add_f32_dpp v108, v108, v108 row_ror:8 row_mask:0xf bank_mask:0xf
    v_add_f32_dpp v109, v109, v109 row_ror:8 row_mask:0xf bank_mask:0xf
    v_add_f32_dpp v110, v110, v110 row_ror:8 row_mask:0xf bank_mask:0xf
    v_add_f32_dpp v111, v111, v111 row_ror:8 row_mask:0xf bank_mask:0xf
    s_lshl_b32 s86, s47, 4
    s_add_u32 s86, s86, s46
    s_mul_i32 s86, s86, 768
    s_lshl_b32 s87, s48, 8
    s_add_u32 s86, s86, s87
    s_add_u32 s86, s86, 65536
    v_lshl_add_u32 v24, v23, 5, s86
    v_lshl_add_u32 v24, v22, 4, v24
    v_and_b32 v25, 0x28, v0
    v_cmp_eq_u32 vcc, 0, v25
    v_mov_b32 v25, 2147483648
    s_nop 0
    v_cndmask_b32 v24, v25, v24, vcc
    buffer_store_dwordx4 v[108:111], v24, s[16:19], 0 offen sc1
    s_branch L_h0_2_done
L_h0_stat_2:
    v_dot2c_f32_bf16 v104, s95, v72
    v_dot2c_f32_bf16 v105, s95, v73
    v_dot2c_f32_bf16 v106, s95, v74
    v_dot2c_f32_bf16 v107, s95, v75
    v_dot2c_f32_bf16 v108, v72, v72
    v_dot2c_f32_bf16 v109, v73, v73
    v_dot2c_f32_bf16 v110, v74, v74
    v_dot2c_f32_bf16 v111, v75, v75
    v_dot2c_f32_bf16 v104, s95, v76
    v_dot2c_f32_bf16 v105, s95, v77
    v_dot2c_f32_bf16 v106, s95, v78
    v_dot2c_f32_bf16 v107, s95, v79
    v_dot2c_f32_bf16 v108, v76, v76
    v_dot2c_f32_bf16 v109, v77, v77
    v_dot2c_f32_bf16 v110, v78, v78
    v_dot2c_f32_bf16 v111, v79, v79
    v_dot2c_f32_bf16 v104, s95, v80
    v_dot2c_f32_bf16 v105, s95, v81
    v_dot2c_f32_bf16 v106, s95, v82
    v_dot2c_f32_bf16 v107, s95, v83
    v_dot2c_f32_bf16 v108, v80, v80
    v_dot2c_f32_bf16 v109, v81, v81
    v_dot2c_f32_bf16 v110, v82, v82
    v_dot2c_f32_bf16 v111, v83, v83
    v_dot2c_f32_bf16 v104, s95, v84
    v_dot2c_f32_bf16 v105, s95, v85
    v_dot2c_f32_bf16 v106, s95, v86
    v_dot2c_f32_bf16 v107, s95, v87
    v_dot2c_f32_bf16 v108, v84, v84
    v_dot2c_f32_bf16 v109, v85, v85
    v_dot2c_f32_bf16 v110, v86, v86
    v_dot2c_f32_bf16 v111, v87, v87
    v_dot2c_f32_bf16 v104, s95, v88
    v_dot2c_f32_bf16 v105, s95, v89
    v_dot2c_f32_bf16 v106, s95, v90
    v_dot2c_f32_bf16 v107, s95, v91
    v_dot2c_f32_bf16 v108, v88, v88
    v_dot2c_f32_bf16 v109, v89, v89
    v_dot2c_f32_bf16 v110, v90, v90
    v_dot2c_f32_bf16 v111, v91, v91
    v_dot2c_f32_bf16 v104, s95, v92
    v_dot2c_f32_bf16 v105, s95, v93
    v_dot2c_f32_bf16 v106, s95, v94
    v_dot2c_f32_bf16 v107, s95, v95
    v_dot2c_f32_bf16 v108, v92, v92
    v_dot2c_f32_bf16 v109, v93, v93
    v_dot2c_f32_bf16 v110, v94, v94
    v_dot2c_f32_bf16 v111, v95, v95
    v_dot2c_f32_bf16 v104, s95, v96
    v_dot2c_f32_bf16 v105, s95, v97
    v_dot2c_f32_bf16 v106, s95, v98
    v_dot2c_f32_bf16 v107, s95, v99
    v_dot2c_f32_bf16 v108, v96, v96
    v_dot2c_f32_bf16 v109, v97, v97
    v_dot2c_f32_bf16 v110, v98, v98
    v_dot2c_f32_bf16 v111, v99, v99
    v_dot2c_f32_bf16 v104, s95, v100
    v_dot2c_f32_bf16 v105, s95, v101
    v_dot2c_f32_bf16 v106, s95, v102
    v_dot2c_f32_bf16 v107, s95, v103
    v_dot2c_f32_bf16 v108, v100, v100
    v_dot2c_f32_bf16 v109, v101, v101
    v_dot2c_f32_bf16 v110, v102, v102
    v_dot2c_f32_bf16 v111, v103, v103
    v_add_f32 v104, v104, v105
    v_add_f32 v106, v106, v107
    v_add_f32 v108, v108, v109
    v_add_f32 v110, v110, v111
    v_add_f32 v104, v104, v106
    v_add_f32 v108, v108, v110
    s_nop 0
    v_add_f32_dpp v104, v104, v104 quad_perm:[1,0,3,2] row_mask:0xf bank_mask:0xf
    v_add_f32_dpp v108, v108, v108 quad_perm:[1,0,3,2] row_mask:0xf bank_mask:0xf
    s_nop 0
    v_add_f32_dpp v104, v104, v104 quad_perm:[2,3,0,1] row_mask:0xf bank_mask:0xf
    v_add_f32_dpp v108, v108, v108 quad_perm:[2,3,0,1] row_mask:0xf bank_mask:0xf
    s_nop 0
    v_add_f32_dpp v104, v104, v104 row_half_mirror row_mask:0xf bank_mask:0xf
    v_add_f32_dpp v108, v108, v108 row_half_mirror row_mask:0xf bank_mask:0xf
    v_mul_f32 v104, 0x3a800000, v104
    v_mul_f32 v108, 0x3a800000, v108
    v_fma_f32 v108, -v104, v104, v108
    v_max_f32 v108, 0, v108
    v_cvt_pk_bf16_f32 v105, v104, v108
    v_lshlrev_b32 v106, 16, v105
    v_and_b32 v105, 0xffff0000, v105
    v_add_f32 v105, 0x3727c5ac, v105
    v_cvt_pk_bf16_f32 v105, v105, v105
    v_lshlrev_b32 v105, 16, v105
    v_sqrt_f32 v105, v105
    s_nop 0
    v_cvt_pk_bf16_f32 v105, v105, v105
    v_lshlrev_b32 v105, 16, v105
    v_rcp_f32 v107, v105
    v_cmp_eq_u32 vcc, 0, v21
    v_mov_b32 v25, 2147483648
    s_nop 0
    v_cndmask_b32 v24, v25, v13, vcc
    buffer_store_dwordx2 v[106:107], v24, s[16:19], 0 offen sc1
L_h0_2_done:
    s_mov_b32 s90, 14336
    buffer_load_dwordx4 v[172:175], v30, s[32:35], s90 offen
    s_mov_b32 s90, 21504
    buffer_load_dwordx4 v[176:179], v30, s[32:35], s90 offen
    s_waitcnt vmcnt(15)
    s_barrier
    s_add_u32 m0, s53, 81920
    s_add_u32 s90, s63, 640
    buffer_load_dwordx4 v2, s[8:11], s90 offen offset:0 lds
    buffer_load_dwordx4 v3, s[8:11], s90 offen offset:1024 lds
    buffer_load_dwordx4 v4, s[8:11], s90 offen offset:2048 lds
    buffer_load_dwordx4 v5, s[8:11], s90 offen offset:3072 lds
    s_mov_b32 s91, 1966080
    s_add_u32 m0, s62, 81920
    s_nop 0
    buffer_load_dwordx4 v6, s[12:15], s91 offen offset:0 lds
    buffer_load_dwordx4 v7, s[12:15], s91 offen offset:1024 lds
    s_add_u32 m0, s62, 90112
    s_nop 0
    buffer_load_dwordx4 v8, s[12:15], s91 offen offset:0 lds
    buffer_load_dwordx4 v9, s[12:15], s91 offen offset:1024 lds
    s_add_u32 m0, s62, 98304
    s_nop 0
    buffer_load_dwordx4 v10, s[12:15], s91 offen offset:0 lds
    buffer_load_dwordx4 v11, s[12:15], s91 offen offset:1024 lds
    s_mov_b32 s90, 28672
    buffer_load_dwordx4 v[180:183], v30, s[32:35], s90 offen
    s_mov_b32 s90, 35840
    buffer_load_dwordx4 v[184:187], v30, s[32:35], s90 offen
    s_waitcnt vmcnt(15)
    s_barrier
    s_add_u32 m0, s53, 0
    s_add_u32 s90, s63, 768
    buffer_load_dwordx4 v2, s[8:11], s90 offen offset:0 lds
    buffer_load_dwordx4 v3, s[8:11], s90 offen offset:1024 lds
    buffer_load_dwordx4 v4, s[8:11], s90 offen offset:2048 lds
    buffer_load_dwordx4 v5, s[8:11], s90 offen offset:3072 lds
    s_mov_b32 s91, 2359296
    s_add_u32 m0, s62, 0
    s_nop 0
    buffer_load_dwordx4 v6, s[12:15], s91 offen offset:0 lds
    buffer_load_dwordx4 v7, s[12:15], s91 offen offset:1024 lds
    s_add_u32 m0, s62, 8192
    s_nop 0
    buffer_load_dwordx4 v8, s[12:15], s91 offen offset:0 lds
    buffer_load_dwordx4 v9, s[12:15], s91 offen offset:1024 lds
    s_add_u32 m0, s62, 16384
    s_nop 0
    buffer_load_dwordx4 v10, s[12:15], s91 offen offset:0 lds
    buffer_load_dwordx4 v11, s[12:15], s91 offen offset:1024 lds
    s_mov_b32 s90, 43008
    buffer_load_dwordx4 v[188:191], v30, s[32:35], s90 offen
    s_mov_b32 s90, 50176
    buffer_load_dwordx4 v[192:195], v30, s[32:35], s90 offen
    s_waitcnt vmcnt(14)
    s_barrier
    s_add_u32 m0, s53, 40960
    s_add_u32 s90, s63, 896
    buffer_load_dwordx4 v2, s[8:11], s90 offen offset:0 lds
    buffer_load_dwordx4 v3, s[8:11], s90 offen offset:1024 lds
    buffer_load_dwordx4 v4, s[8:11], s90 offen offset:2048 lds
    buffer_load_dwordx4 v5, s[8:11], s90 offen offset:3072 lds
    s_mov_b32 s91, 2752512
    s_add_u32 m0, s62, 40960
    s_nop 0
    buffer_load_dwordx4 v6, s[12:15], s91 offen offset:0 lds
    buffer_load_dwordx4 v7, s[12:15], s91 offen offset:1024 lds
    s_add_u32 m0, s62, 49152
    s_nop 0
    buffer_load_dwordx4 v8, s[12:15], s91 offen offset:0 lds
    buffer_load_dwordx4 v9, s[12:15], s91 offen offset:1024 lds
    s_add_u32 m0, s62, 57344
    s_nop 0
    buffer_load_dwordx4 v10, s[12:15], s91 offen offset:0 lds
    buffer_load_dwordx4 v11, s[12:15], s91 offen offset:1024 lds
    s_and_b32 s86, s2, 3
    s_lshl_b32 s86, s86, 6
    s_cmp_eq_u32 s48, 0
    s_cselect_b32 s86, s86, 2147483648
    v_mov_b32 v25, 2147483648
    v_mov_b32 v24, s86
    v_cmp_eq_u32 vcc, 0, v0
    s_nop 1
    v_cndmask_b32 v24, v25, v24, vcc
    v_mov_b32 v25, 1
    buffer_atomic_add v25, v24, s[28:31], 0 offen sc1
    s_mov_b32 s90, 57344
    buffer_load_dwordx4 v[196:199], v30, s[32:35], s90 offen
    s_mov_b32 s90, 64512
    buffer_load_dwordx4 v[200:203], v30, s[32:35], s90 offen
    s_waitcnt vmcnt(15)
    s_barrier
    s_add_u32 m0, s53, 81920
    s_add_u32 s90, s63, 1024
    buffer_load_dwordx4 v2, s[8:11], s90 offen offset:0 lds
    buffer_load_dwordx4 v3, s[8:11], s90 offen offset:1024 lds
    buffer_load_dwordx4 v4, s[8:11], s90 offen offset:2048 lds
    buffer_load_dwordx4 v5, s[8:11], s90 offen offset:3072 lds
    s_mov_b32 s91, 3145728
    s_add_u32 m0, s62, 81920
    s_nop 0
    buffer_load_dwordx4 v6, s[12:15], s91 offen offset:0 lds
    buffer_load_dwordx4 v7, s[12:15], s91 offen offset:1024 lds
    s_add_u32 m0, s62, 90112
    s_nop 0
    buffer_load_dwordx4 v8, s[12:15], s91 offen offset:0 lds
    buffer_load_dwordx4 v9, s[12:15], s91 offen offset:1024 lds
    s_add_u32 m0, s62, 98304
    s_nop 0
    buffer_load_dwordx4 v10, s[12:15], s91 offen offset:0 lds
    buffer_load_dwordx4 v11, s[12:15], s91 offen offset:1024 lds
    s_mov_b32 s90, 71680
    buffer_load_dwordx4 v[204:207], v30, s[32:35], s90 offen
    s_mov_b32 s90, 78848
    buffer_load_dwordx4 v[208:211], v30, s[32:35], s90 offen
    s_waitcnt vmcnt(15)
    s_barrier
    s_add_u32 m0, s53, 0
    s_add_u32 s90, s63, 1152
    buffer_load_dwordx4 v2, s[8:11], s90 offen offset:0 lds
    buffer_load_dwordx4 v3, s[8:11], s90 offen offset:1024 lds
    buffer_load_dwordx4 v4, s[8:11], s90 offen offset:2048 lds
    buffer_load_dwordx4 v5, s[8:11], s90 offen offset:3072 lds
    s_mov_b32 s91, 3538944
    s_add_u32 m0, s62, 0
    s_nop 0
    buffer_load_dwordx4 v6, s[12:15], s91 offen offset:0 lds
    buffer_load_dwordx4 v7, s[12:15], s91 offen offset:1024 lds
    s_add_u32 m0, s62, 8192
    s_nop 0
    buffer_load_dwordx4 v8, s[12:15], s91 offen offset:0 lds
    buffer_load_dwordx4 v9, s[12:15], s91 offen offset:1024 lds
    s_add_u32 m0, s62, 16384
    s_nop 0
    buffer_load_dwordx4 v10, s[12:15], s91 offen offset:0 lds
    buffer_load_dwordx4 v11, s[12:15], s91 offen offset:1024 lds
    s_mov_b32 s90, 86016
    buffer_load_dwordx4 v[212:215], v30, s[32:35], s90 offen
    s_mov_b32 s90, 93184
    buffer_load_dwordx4 v[216:219], v30, s[32:35], s90 offen
    s_waitcnt vmcnt(14)
    s_barrier
    s_add_u32 m0, s53, 40960
    s_add_u32 s90, s63, 1280
    buffer_load_dwordx4 v2, s[8:11], s90 offen offset:0 lds
    buffer_load_dwordx4 v3, s[8:11], s90 offen offset:1024 lds
    buffer_load_dwordx4 v4, s[8:11], s90 offen offset:2048 lds
    buffer_load_dwordx4 v5, s[8:11], s90 offen offset:3072 lds
    s_mov_b32 s91, 3932160
    s_add_u32 m0, s62, 40960
    s_nop 0
    buffer_load_dwordx4 v6, s[12:15], s91 offen offset:0 lds
    buffer_load_dwordx4 v7, s[12:15], s91 offen offset:1024 lds
    s_add_u32 m0, s62, 49152
    s_nop 0
    buffer_load_dwordx4 v8, s[12:15], s91 offen offset:0 lds
    buffer_load_dwordx4 v9, s[12:15], s91 offen offset:1024 lds
    s_add_u32 m0, s62, 57344
    s_nop 0
    buffer_load_dwordx4 v10, s[12:15], s91 offen offset:0 lds
    buffer_load_dwordx4 v11, s[12:15], s91 offen offset:1024 lds
    s_mov_b32 s90, 100352
    buffer_load_dwordx4 v[220:223], v30, s[32:35], s90 offen
    s_mov_b32 s90, 107520
    buffer_load_dwordx4 v[224:227], v30, s[32:35], s90 offen
    s_waitcnt vmcnt(14)
    s_barrier
    s_add_u32 m0, s53, 81920
    s_add_u32 s90, s63, 1408
    buffer_load_dwordx4 v2, s[8:11], s90 offen offset:0 lds
    buffer_load_dwordx4 v3, s[8:11], s90 offen offset:1024 lds
    buffer_load_dwordx4 v4, s[8:11], s90 offen offset:2048 lds
    buffer_load_dwordx4 v5, s[8:11], s90 offen offset:3072 lds
    s_mov_b32 s91, 4325376
    s_add_u32 m0, s62, 81920
    s_nop 0
    buffer_load_dwordx4 v6, s[12:15], s91 offen offset:0 lds
    buffer_load_dwordx4 v7, s[12:15], s91 offen offset:1024 lds
    s_add_u32 m0, s62, 90112
    s_nop 0
    buffer_load_dwordx4 v8, s[12:15], s91 offen offset:0 lds
    buffer_load_dwordx4 v9, s[12:15], s91 offen offset:1024 lds
    s_add_u32 m0, s62, 98304
    s_nop 0
    buffer_load_dwordx4 v10, s[12:15], s91 offen offset:0 lds
    buffer_load_dwordx4 v11, s[12:15], s91 offen offset:1024 lds
    s_mov_b32 s90, 0
    buffer_load_dwordx4 v[228:231], v31, s[36:39], s90 offen
    s_mov_b32 s90, 2048
    buffer_load_dwordx4 v[232:235], v31, s[36:39], s90 offen
    s_waitcnt vmcnt(14)
    s_barrier
    v_lshlrev_b32 v24, 6, v0
    buffer_load_dword v40, v24, s[28:31], 0 offen sc1
    s_add_u32 m0, s53, 0
    s_add_u32 s90, s63, 1536
    buffer_load_dwordx4 v2, s[8:11], s90 offen offset:0 lds
    buffer_load_dwordx4 v3, s[8:11], s90 offen offset:1024 lds
    buffer_load_dwordx4 v4, s[8:11], s90 offen offset:2048 lds
    buffer_load_dwordx4 v5, s[8:11], s90 offen offset:3072 lds
    s_mov_b32 s91, 4718592
    s_add_u32 m0, s62, 0
    s_nop 0
    buffer_load_dwordx4 v6, s[12:15], s91 offen offset:0 lds
    buffer_load_dwordx4 v7, s[12:15], s91 offen offset:1024 lds
    s_add_u32 m0, s62, 8192
    s_nop 0
    buffer_load_dwordx4 v8, s[12:15], s91 offen offset:0 lds
    buffer_load_dwordx4 v9, s[12:15], s91 offen offset:1024 lds
    s_add_u32 m0, s62, 16384
    s_nop 0
    buffer_load_dwordx4 v10, s[12:15], s91 offen offset:0 lds
    buffer_load_dwordx4 v11, s[12:15], s91 offen offset:1024 lds
    s_mov_b32 s90, 4096
    buffer_load_dwordx4 v[236:239], v31, s[36:39], s90 offen
    s_mov_b32 s90, 6144
    buffer_load_dwordx4 v[240:243], v31, s[36:39], s90 offen
    s_waitcnt vmcnt(15)
    s_barrier
    s_add_u32 m0, s53, 40960
    s_add_u32 s90, s63, 1664
    buffer_load_dwordx4 v2, s[8:11], s90 offen offset:0 lds
    buffer_load_dwordx4 v3, s[8:11], s90 offen offset:1024 lds
    buffer_load_dwordx4 v4, s[8:11], s90 offen offset:2048 lds
    buffer_load_dwordx4 v5, s[8:11], s90 offen offset:3072 lds
    s_mov_b32 s91, 5111808
    s_add_u32 m0, s62, 40960
    s_nop 0
    buffer_load_dwordx4 v6, s[12:15], s91 offen offset:0 lds
    buffer_load_dwordx4 v7, s[12:15], s91 offen offset:1024 lds
    s_add_u32 m0, s62, 49152
    s_nop 0
    buffer_load_dwordx4 v8, s[12:15], s91 offen offset:0 lds
    buffer_load_dwordx4 v9, s[12:15], s91 offen offset:1024 lds
    s_add_u32 m0, s62, 57344
    s_nop 0
    buffer_load_dwordx4 v10, s[12:15], s91 offen offset:0 lds
    buffer_load_dwordx4 v11, s[12:15], s91 offen offset:1024 lds
    s_mov_b32 s90, 8192
    buffer_load_dwordx4 v[244:247], v31, s[36:39], s90 offen
    s_mov_b32 s90, 10240
    buffer_load_dwordx4 v[248:251], v31, s[36:39], s90 offen
    s_waitcnt vmcnt(14)
    v_mov_b32 v25, 64
    v_cmp_gt_u32 vcc, 4, v0
    s_nop 1
    v_cndmask_b32 v25, 0, v25, vcc
    v_cmp_ne_u32 vcc, v40, v25
    s_cbranch_vccz L_h0_poll_ok
    v_lshlrev_b32 v24, 6, v0
L_h0_poll:
    buffer_load_dword v40, v24, s[28:31], 0 offen sc1
    s_waitcnt vmcnt(0)
    v_cmp_ne_u32 vcc, v40, v25
    s_cbranch_vccz L_ok_1
    s_sub_u32 s56, s56, 1
    s_cbranch_scc0 L_h0_poll
    s_mov_b32 s56, 0
L_ok_1:
L_h0_poll_ok:
    s_barrier
    s_cmp_eq_u32 s48, 3
    s_cbranch_scc1 L_h0_g_stat
    s_mul_i32 s86, s47, 12288
    s_lshl_b32 s87, s48, 8
    s_add_u32 s86, s86, s87
    s_add_u32 s86, s86, 65536
    v_lshl_add_u32 v24, v23, 4, s86
    v_mul_u32_u24 v25, 768, v22
    v_add_u32 v24, v24, v25
    s_mov_b32 s90, 0
    buffer_load_dwordx4 v[40:43], v24, s[16:19], s90 offen sc1
    s_mov_b32 s90, 3072
    buffer_load_dwordx4 v[44:47], v24, s[16:19], s90 offen sc1
    s_mov_b32 s90, 6144
    buffer_load_dwordx4 v[48:51], v24, s[16:19], s90 offen sc1
    s_mov_b32 s90, 9216
    buffer_load_dwordx4 v[52:55], v24, s[16:19], s90 offen sc1
    s_branch L_h0_g_done
L_h0_g_stat:
    s_lshl_b32 s86, s46, 10
    v_lshl_add_u32 v24, v0, 4, s86
    buffer_load_dwordx4 v[40:43], v24, s[16:19], 0 offen sc1
    v_mov_b32 v24, 2147483648
    buffer_load_dwordx4 v[44:47], v24, s[16:19], 0 offen sc1
    buffer_load_dwordx4 v[48:51], v24, s[16:19], 0 offen sc1
    buffer_load_dwordx4 v[52:55], v24, s[16:19], 0 offen sc1
L_h0_g_done:
    s_add_u32 m0, s53, 81920
    s_add_u32 s90, s63, 1792
    buffer_load_dwordx4 v2, s[8:11], s90 offen offset:0 lds
    buffer_load_dwordx4 v3, s[8:11], s90 offen offset:1024 lds
    buffer_load_dwordx4 v4, s[8:11], s90 offen offset:2048 lds
    buffer_load_dwordx4 v5, s[8:11], s90 offen offset:3072 lds
    s_mov_b32 s91, 5505024
    s_add_u32 m0, s62, 81920
    s_nop 0
    buffer_load_dwordx4 v6, s[12:15], s91 offen offset:0 lds
    buffer_load_dwordx4 v7, s[12:15], s91 offen offset:1024 lds
    s_add_u32 m0, s62, 90112
    s_nop 0
    buffer_load_dwordx4 v8, s[12:15], s91 offen offset:0 lds
    buffer_load_dwordx4 v9, s[12:15], s91 offen offset:1024 lds
    s_add_u32 m0, s62, 98304
    s_nop 0
    buffer_load_dwordx4 v10, s[12:15], s91 offen offset:0 lds
    buffer_load_dwordx4 v11, s[12:15], s91 offen offset:1024 lds
    s_mov_b32 s90, 12288
    buffer_load_dwordx4 v[252:255], v31, s[36:39], s90 offen
    s_lshl_b32 s89, s48, 10
    s_add_u32 m0, s89, 122880
    s_mov_b32 s90, 1310720
    buffer_load_dwordx4 v12, s[20:23], s90 offen lds
    s_add_u32 m0, s89, 126976
    s_mov_b32 s90, 1376256
    buffer_load_dwordx4 v12, s[20:23], s90 offen lds
    s_add_u32 m0, s89, 131072
    s_mov_b32 s90, 1441792
    buffer_load_dwordx4 v12, s[20:23], s90 offen lds
    s_add_u32 m0, s89, 135168
    s_mov_b32 s90, 1507328
    buffer_load_dwordx4 v12, s[20:23], s90 offen lds
    s_waitcnt vmcnt(21)
    s_barrier
    s_add_u32 m0, s53, 0
    s_add_u32 s90, s63, 1920
    buffer_load_dwordx4 v2, s[8:11], s90 offen offset:0 lds
    buffer_load_dwordx4 v3, s[8:11], s90 offen offset:1024 lds
    buffer_load_dwordx4 v4, s[8:11], s90 offen offset:2048 lds
    buffer_load_dwordx4 v5, s[8:11], s90 offen offset:3072 lds
    s_mov_b32 s91, 5898240
    s_add_u32 m0, s62, 0
    s_nop 0
    buffer_load_dwordx4 v6, s[12:15], s91 offen offset:0 lds
    buffer_load_dwordx4 v7, s[12:15], s91 offen offset:1024 lds
    s_add_u32 m0, s62, 8192
    s_nop 0
    buffer_load_dwordx4 v8, s[12:15], s91 offen offset:0 lds
    buffer_load_dwordx4 v9, s[12:15], s91 offen offset:1024 lds
    s_add_u32 m0, s62, 16384
    s_nop 0
    buffer_load_dwordx4 v10, s[12:15], s91 offen offset:0 lds
    buffer_load_dwordx4 v11, s[12:15], s91 offen offset:1024 lds
    s_lshl_b32 s89, s48, 10
    s_add_u32 m0, s89, 139264
    s_mov_b32 s90, 1572864
    buffer_load_dwordx4 v12, s[20:23], s90 offen lds
    s_add_u32 m0, s89, 143360
    s_mov_b32 s90, 1638400
    buffer_load_dwordx4 v12, s[20:23], s90 offen lds
    s_add_u32 m0, s89, 147456
    s_mov_b32 s90, 1703936
    buffer_load_dwordx4 v12, s[20:23], s90 offen lds
    s_add_u32 m0, s89, 151552
    s_mov_b32 s90, 1769472
    buffer_load_dwordx4 v12, s[20:23], s90 offen lds
    s_waitcnt vmcnt(19)
    s_cmp_eq_u32 s48, 3
    s_cbranch_scc1 L_h0_w_stat
    v_pk_add_f32 v[40:41], v[40:41], v[44:45]
    v_pk_add_f32 v[48:49], v[48:49], v[52:53]
    v_pk_add_f32 v[40:41], v[40:41], v[48:49]
    v_pk_add_f32 v[42:43], v[42:43], v[46:47]
    v_pk_add_f32 v[50:51], v[50:51], v[54:55]
    v_pk_add_f32 v[42:43], v[42:43], v[50:51]
    v_mov_b32 v44, v40
    v_mov_b32 v45, v41
    v_mov_b32 v46, v42
    v_mov_b32 v47, v43
    v_permlane32_swap_b32 v40, v44
    v_permlane32_swap_b32 v41, v45
    v_permlane32_swap_b32 v42, v46
    v_permlane32_swap_b32 v43, v47
    v_add_f32 v40, v40, v44
    v_add_f32 v41, v41, v45
    v_add_f32 v42, v42, v46
    v_add_f32 v43, v43, v47
    v_mov_b32 v44, v40
    v_mov_b32 v45, v41
    v_mov_b32 v46, v42
    v_mov_b32 v47, v43
    v_permlane16_swap_b32 v40, v44
    v_permlane16_swap_b32 v41, v45
    v_permlane16_swap_b32 v42, v46
    v_permlane16_swap_b32 v43, v47
    v_add_f32 v40, v40, v44
    v_add_f32 v41, v41, v45
    v_add_f32 v42, v42, v46
    v_add_f32 v43, v43, v47
    s_lshl_b32 s86, s48, 8
    s_add_u32 s86, s86, 157184
    v_lshl_add_u32 v24, v23, 4, s86
    ds_write_b128 v24, v[40:43]
    s_branch L_h0_w_done
L_h0_w_stat:
    v_sub_f32 v44, 0, v40
    v_sub_f32 v45, 0, v42
    v_mov_b32 v46, v41
    v_mov_b32 v47, v43
    v_mul_f32 v48, 0x3fb8aa3b, v41
    v_mul_f32 v49, 0x3fb8aa3b, v43
    v_lshlrev_b32 v24, 3, v0
    v_add_u32 v24, 155648, v24
    ds_write_b64 v24, v[44:45]
    ds_write_b64 v24, v[46:47] offset:512
    ds_write_b64 v24, v[48:49] offset:1024
L_h0_w_done:
    s_waitcnt lgkmcnt(0)
    s_barrier
    s_add_u32 m0, s89, 40960
    s_mov_b32 s90, 0
    buffer_load_dwordx4 v12, s[20:23], s90 offen lds
    s_add_u32 m0, s89, 45056
    s_mov_b32 s90, 65536
    buffer_load_dwordx4 v12, s[20:23], s90 offen lds
    s_add_u32 m0, s89, 49152
    s_mov_b32 s90, 131072
    buffer_load_dwordx4 v12, s[20:23], s90 offen lds
    s_add_u32 m0, s89, 53248
    s_mov_b32 s90, 196608
    buffer_load_dwordx4 v12, s[20:23], s90 offen lds
    s_add_u32 m0, s89, 57344
    s_mov_b32 s90, 262144
    buffer_load_dwordx4 v12, s[20:23], s90 offen lds
    s_add_u32 m0, s89, 61440
    s_mov_b32 s90, 327680
    buffer_load_dwordx4 v12, s[20:23], s90 offen lds
    s_add_u32 m0, s89, 65536
    s_mov_b32 s90, 393216
    buffer_load_dwordx4 v12, s[20:23], s90 offen lds
    s_add_u32 m0, s89, 69632
    s_mov_b32 s90, 458752
    buffer_load_dwordx4 v12, s[20:23], s90 offen lds
    s_add_u32 m0, s89, 73728
    s_mov_b32 s90, 524288
    buffer_load_dwordx4 v12, s[20:23], s90 offen lds
    s_add_u32 m0, s89, 77824
    s_mov_b32 s90, 589824
    buffer_load_dwordx4 v12, s[20:23], s90 offen lds
    s_waitcnt vmcnt(14)
    s_barrier
    s_add_u32 m0, s89, 81920
    s_mov_b32 s90, 655360
    buffer_load_dwordx4 v12, s[20:23], s90 offen lds
    s_add_u32 m0, s89, 86016
    s_mov_b32 s90, 720896
    buffer_load_dwordx4 v12, s[20:23], s90 offen lds
    s_add_u32 m0, s89, 90112
    s_mov_b32 s90, 786432
    buffer_load_dwordx4 v12, s[20:23], s90 offen lds
    s_add_u32 m0, s89, 94208
    s_mov_b32 s90, 851968
    buffer_load_dwordx4 v12, s[20:23], s90 offen lds
    s_add_u32 m0, s89, 98304
    s_mov_b32 s90, 917504
    buffer_load_dwordx4 v12, s[20:23], s90 offen lds
    s_add_u32 m0, s89, 102400
    s_mov_b32 s90, 983040
    buffer_load_dwordx4 v12, s[20:23], s90 offen lds
    s_add_u32 m0, s89, 106496
    s_mov_b32 s90, 1048576
    buffer_load_dwordx4 v12, s[20:23], s90 offen lds
    s_add_u32 m0, s89, 110592
    s_mov_b32 s90, 1114112
    buffer_load_dwordx4 v12, s[20:23], s90 offen lds
    s_add_u32 m0, s89, 114688
    s_mov_b32 s90, 1179648
    buffer_load_dwordx4 v12, s[20:23], s90 offen lds
    s_add_u32 m0, s89, 118784
    s_mov_b32 s90, 1245184
    buffer_load_dwordx4 v12, s[20:23], s90 offen lds
    s_barrier
    s_add_u32 m0, s89, 0
    s_mov_b32 s90, 1835008
    buffer_load_dwordx4 v12, s[20:23], s90 offen lds
    s_add_u32 m0, s89, 4096
    s_mov_b32 s90, 1900544
    buffer_load_dwordx4 v12, s[20:23], s90 offen lds
    s_add_u32 m0, s89, 8192
    s_mov_b32 s90, 1966080
    buffer_load_dwordx4 v12, s[20:23], s90 offen lds
    s_add_u32 m0, s89, 12288
    s_mov_b32 s90, 2031616
    buffer_load_dwordx4 v12, s[20:23], s90 offen lds
    s_lshl_b32 s86, s47, 2
    s_add_u32 s86, s86, s48
    s_lshl_b32 s86, s86, 14
    s_add_u32 s86, s86, 5242880
    v_lshl_add_u32 v2, v0, 4, s86
    s_lshl_b32 s86, s47, 1
    s_add_u32 s86, s86, s50
    s_lshl_b32 s86, s86, 11
    s_add_u32 s86, s86, 7307264
    v_lshl_add_u32 v3, v23, 7, s86
    v_lshl_add_u32 v3, v22, 4, v3
    v_mov_b32 v112, 0
    v_mov_b32 v113, 0
    v_mov_b32 v114, 0
    v_mov_b32 v115, 0
    v_mov_b32 v116, 0
    v_mov_b32 v117, 0
    v_mov_b32 v118, 0
    v_mov_b32 v119, 0
    s_mov_b32 s88, 0
    s_mov_b32 s86, 0x00003f80
    s_mov_b32 s87, 0x3f800000
    s_barrier
    buffer_load_dwordx4 v[40:43], v2, s[16:19], 0 offen offset:0 sc1
    buffer_load_dwordx4 v[44:47], v2, s[16:19], 0 offen offset:1024 sc1
    buffer_load_dwordx4 v[48:51], v2, s[16:19], 0 offen offset:2048 sc1
    buffer_load_dwordx4 v[52:55], v2, s[16:19], 0 offen offset:3072 sc1
    buffer_load_dwordx4 v[56:59], v2, s[16:19], s92 offen offset:0 sc1
    buffer_load_dwordx4 v[60:63], v2, s[16:19], s92 offen offset:1024 sc1
    buffer_load_dwordx4 v[64:67], v2, s[16:19], s92 offen offset:2048 sc1
    buffer_load_dwordx4 v[68:71], v2, s[16:19], s92 offen offset:3072 sc1
    buffer_load_dwordx4 v[72:75], v2, s[16:19], s93 offen offset:0 sc1
    buffer_load_dwordx4 v[76:79], v2, s[16:19], s93 offen offset:1024 sc1
    buffer_load_dwordx4 v[80:83], v2, s[16:19], s93 offen offset:2048 sc1
    buffer_load_dwordx4 v[84:87], v2, s[16:19], s93 offen offset:3072 sc1
    buffer_load_dwordx4 v[88:91], v2, s[16:19], s94 offen offset:0 sc1
    buffer_load_dwordx4 v[92:95], v2, s[16:19], s94 offen offset:1024 sc1
    buffer_load_dwordx4 v[96:99], v2, s[16:19], s94 offen offset:2048 sc1
    buffer_load_dwordx4 v[100:103], v2, s[16:19], s94 offen offset:3072 sc1
    buffer_load_dwordx4 v[104:107], v3, s[16:19], 0 offen sc1
    buffer_load_dwordx4 v[108:111], v3, s[16:19], 0 offen offset:64 sc1
L_h1_round:
    s_bitcmp1_b32 s88, 0
    s_cbranch_scc1 L_h1_n0
    s_waitcnt vmcnt(17)
    v_cmp_eq_u32 vcc, -1, v43
    s_cbranch_vccnz L_h1_b0
    v_dot2c_f32_bf16 v112, s86, v40
    v_dot2c_f32_bf16 v113, s87, v40
    v_dot2c_f32_bf16 v114, s86, v41
    v_dot2c_f32_bf16 v115, s87, v41
    v_dot2c_f32_bf16 v116, s86, v42
    v_dot2c_f32_bf16 v117, s87, v42
    v_dot2c_f32_bf16 v118, s86, v43
    v_dot2c_f32_bf16 v119, s87, v43
    s_bitset1_b32 s88, 0
    s_branch L_h1_n0
L_h1_b0:
    buffer_load_dwordx4 v[40:43], v2, s[16:19], 0 offen offset:0 sc1
L_h1_n0:
    s_bitcmp1_b32 s88, 1
    s_cbranch_scc1 L_h1_n1
    s_waitcnt vmcnt(16)
    v_cmp_eq_u32 vcc, -1, v47
    s_cbranch_vccnz L_h1_b1
    v_dot2c_f32_bf16 v112, s86, v44
    v_dot2c_f32_bf16 v113, s87, v44
    v_dot2c_f32_bf16 v114, s86, v45
    v_dot2c_f32_bf16 v115, s87, v45
    v_dot2c_f32_bf16 v116, s86, v46
    v_dot2c_f32_bf16 v117, s87, v46
    v_dot2c_f32_bf16 v118, s86, v47
    v_dot2c_f32_bf16 v119, s87, v47
    s_bitset1_b32 s88, 1
    s_branch L_h1_n1
L_h1_b1:
    buffer_load_dwordx4 v[44:47], v2, s[16:19], 0 offen offset:1024 sc1
L_h1_n1:
    s_bitcmp1_b32 s88, 2
    s_cbranch_scc1 L_h1_n2
    s_waitcnt vmcnt(15)
    v_cmp_eq_u32 vcc, -1, v51
    s_cbranch_vccnz L_h1_b2
    v_dot2c_f32_bf16 v112, s86, v48
    v_dot2c_f32_bf16 v113, s87, v48
    v_dot2c_f32_bf16 v114, s86, v49
    v_dot2c_f32_bf16 v115, s87, v49
    v_dot2c_f32_bf16 v116, s86, v50
    v_dot2c_f32_bf16 v117, s87, v50
    v_dot2c_f32_bf16 v118, s86, v51
    v_dot2c_f32_bf16 v119, s87, v51
    s_bitset1_b32 s88, 2
    s_branch L_h1_n2
L_h1_b2:
    buffer_load_dwordx4 v[48:51], v2, s[16:19], 0 offen offset:2048 sc1
L_h1_n2:
    s_bitcmp1_b32 s88, 3
    s_cbranch_scc1 L_h1_n3
    s_waitcnt vmcnt(14)
    v_cmp_eq_u32 vcc, -1, v55
    s_cbranch_vccnz L_h1_b3
    v_dot2c_f32_bf16 v112, s86, v52
    v_dot2c_f32_bf16 v113, s87, v52
    v_dot2c_f32_bf16 v114, s86, v53
    v_dot2c_f32_bf16 v115, s87, v53
    v_dot2c_f32_bf16 v116, s86, v54
    v_dot2c_f32_bf16 v117, s87, v54
    v_dot2c_f32_bf16 v118, s86, v55
    v_dot2c_f32_bf16 v119, s87, v55
    s_bitset1_b32 s88, 3
    s_branch L_h1_n3
L_h1_b3:
    buffer_load_dwordx4 v[52:55], v2, s[16:19], 0 offen offset:3072 sc1
L_h1_n3:
    s_bitcmp1_b32 s88, 4
    s_cbranch_scc1 L_h1_n4
    s_waitcnt vmcnt(13)
    v_cmp_eq_u32 vcc, -1, v59
    s_cbranch_vccnz L_h1_b4
    v_dot2c_f32_bf16 v112, s86, v56
    v_dot2c_f32_bf16 v113, s87, v56
    v_dot2c_f32_bf16 v114, s86, v57
    v_dot2c_f32_bf16 v115, s87, v57
    v_dot2c_f32_bf16 v116, s86, v58
    v_dot2c_f32_bf16 v117, s87, v58
    v_dot2c_f32_bf16 v118, s86, v59
    v_dot2c_f32_bf16 v119, s87, v59
    s_bitset1_b32 s88, 4
    s_branch L_h1_n4
L_h1_b4:
    buffer_load_dwordx4 v[56:59], v2, s[16:19], s92 offen offset:0 sc1
L_h1_n4:
    s_bitcmp1_b32 s88, 5
    s_cbranch_scc1 L_h1_n5
    s_waitcnt vmcnt(12)
    v_cmp_eq_u32 vcc, -1, v63
    s_cbranch_vccnz L_h1_b5
    v_dot2c_f32_bf16 v112, s86, v60
    v_dot2c_f32_bf16 v113, s87, v60
    v_dot2c_f32_bf16 v114, s86, v61
    v_dot2c_f32_bf16 v115, s87, v61
    v_dot2c_f32_bf16 v116, s86, v62
    v_dot2c_f32_bf16 v117, s87, v62
    v_dot2c_f32_bf16 v118, s86, v63
    v_dot2c_f32_bf16 v119, s87, v63
    s_bitset1_b32 s88, 5
    s_branch L_h1_n5
L_h1_b5:
    buffer_load_dwordx4 v[60:63], v2, s[16:19], s92 offen offset:1024 sc1
L_h1_n5:
    s_bitcmp1_b32 s88, 6
    s_cbranch_scc1 L_h1_n6
    s_waitcnt vmcnt(11)
    v_cmp_eq_u32 vcc, -1, v67
    s_cbranch_vccnz L_h1_b6
    v_dot2c_f32_bf16 v112, s86, v64
    v_dot2c_f32_bf16 v113, s87, v64
    v_dot2c_f32_bf16 v114, s86, v65
    v_dot2c_f32_bf16 v115, s87, v65
    v_dot2c_f32_bf16 v116, s86, v66
    v_dot2c_f32_bf16 v117, s87, v66
    v_dot2c_f32_bf16 v118, s86, v67
    v_dot2c_f32_bf16 v119, s87, v67
    s_bitset1_b32 s88, 6
    s_branch L_h1_n6
L_h1_b6:
    buffer_load_dwordx4 v[64:67], v2, s[16:19], s92 offen offset:2048 sc1
L_h1_n6:
    s_bitcmp1_b32 s88, 7
    s_cbranch_scc1 L_h1_n7
    s_waitcnt vmcnt(10)
    v_cmp_eq_u32 vcc, -1, v71
    s_cbranch_vccnz L_h1_b7
    v_dot2c_f32_bf16 v112, s86, v68
    v_dot2c_f32_bf16 v113, s87, v68
    v_dot2c_f32_bf16 v114, s86, v69
    v_dot2c_f32_bf16 v115, s87, v69
    v_dot2c_f32_bf16 v116, s86, v70
    v_dot2c_f32_bf16 v117, s87, v70
    v_dot2c_f32_bf16 v118, s86, v71
    v_dot2c_f32_bf16 v119, s87, v71
    s_bitset1_b32 s88, 7
    s_branch L_h1_n7
L_h1_b7:
    buffer_load_dwordx4 v[68:71], v2, s[16:19], s92 offen offset:3072 sc1
L_h1_n7:
    s_bitcmp1_b32 s88, 8
    s_cbranch_scc1 L_h1_n8
    s_waitcnt vmcnt(9)
    v_cmp_eq_u32 vcc, -1, v75
    s_cbranch_vccnz L_h1_b8
    v_dot2c_f32_bf16 v112, s86, v72
    v_dot2c_f32_bf16 v113, s87, v72
    v_dot2c_f32_bf16 v114, s86, v73
    v_dot2c_f32_bf16 v115, s87, v73
    v_dot2c_f32_bf16 v116, s86, v74
    v_dot2c_f32_bf16 v117, s87, v74
    v_dot2c_f32_bf16 v118, s86, v75
    v_dot2c_f32_bf16 v119, s87, v75
    s_bitset1_b32 s88, 8
    s_branch L_h1_n8
L_h1_b8:
    buffer_load_dwordx4 v[72:75], v2, s[16:19], s93 offen offset:0 sc1
L_h1_n8:
    s_bitcmp1_b32 s88, 9
    s_cbranch_scc1 L_h1_n9
    s_waitcnt vmcnt(8)
    v_cmp_eq_u32 vcc, -1, v79
    s_cbranch_vccnz L_h1_b9
    v_dot2c_f32_bf16 v112, s86, v76
    v_dot2c_f32_bf16 v113, s87, v76
    v_dot2c_f32_bf16 v114, s86, v77
    v_dot2c_f32_bf16 v115, s87, v77
    v_dot2c_f32_bf16 v116, s86, v78
    v_dot2c_f32_bf16 v117, s87, v78
    v_dot2c_f32_bf16 v118, s86, v79
    v_dot2c_f32_bf16 v119, s87, v79
    s_bitset1_b32 s88, 9
    s_branch L_h1_n9
L_h1_b9:
    buffer_load_dwordx4 v[76:79], v2, s[16:19], s93 offen offset:1024 sc1
L_h1_n9:
    s_bitcmp1_b32 s88, 10
    s_cbranch_scc1 L_h1_n10
    s_waitcnt vmcnt(7)
    v_cmp_eq_u32 vcc, -1, v83
    s_cbranch_vccnz L_h1_b10
    v_dot2c_f32_bf16 v112, s86, v80
    v_dot2c_f32_bf16 v113, s87, v80
    v_dot2c_f32_bf16 v114, s86, v81
    v_dot2c_f32_bf16 v115, s87, v81
    v_dot2c_f32_bf16 v116, s86, v82
    v_dot2c_f32_bf16 v117, s87, v82
    v_dot2c_f32_bf16 v118, s86, v83
    v_dot2c_f32_bf16 v119, s87, v83
    s_bitset1_b32 s88, 10
    s_branch L_h1_n10
L_h1_b10:
    buffer_load_dwordx4 v[80:83], v2, s[16:19], s93 offen offset:2048 sc1
L_h1_n10:
    s_bitcmp1_b32 s88, 11
    s_cbranch_scc1 L_h1_n11
    s_waitcnt vmcnt(6)
    v_cmp_eq_u32 vcc, -1, v87
    s_cbranch_vccnz L_h1_b11
    v_dot2c_f32_bf16 v112, s86, v84
    v_dot2c_f32_bf16 v113, s87, v84
    v_dot2c_f32_bf16 v114, s86, v85
    v_dot2c_f32_bf16 v115, s87, v85
    v_dot2c_f32_bf16 v116, s86, v86
    v_dot2c_f32_bf16 v117, s87, v86
    v_dot2c_f32_bf16 v118, s86, v87
    v_dot2c_f32_bf16 v119, s87, v87
    s_bitset1_b32 s88, 11
    s_branch L_h1_n11
L_h1_b11:
    buffer_load_dwordx4 v[84:87], v2, s[16:19], s93 offen offset:3072 sc1
L_h1_n11:
    s_bitcmp1_b32 s88, 12
    s_cbranch_scc1 L_h1_n12
    s_waitcnt vmcnt(5)
    v_cmp_eq_u32 vcc, -1, v91
    s_cbranch_vccnz L_h1_b12
    v_dot2c_f32_bf16 v112, s86, v88
    v_dot2c_f32_bf16 v113, s87, v88
    v_dot2c_f32_bf16 v114, s86, v89
    v_dot2c_f32_bf16 v115, s87, v89
    v_dot2c_f32_bf16 v116, s86, v90
    v_dot2c_f32_bf16 v117, s87, v90
    v_dot2c_f32_bf16 v118, s86, v91
    v_dot2c_f32_bf16 v119, s87, v91
    s_bitset1_b32 s88, 12
    s_branch L_h1_n12
L_h1_b12:
    buffer_load_dwordx4 v[88:91], v2, s[16:19], s94 offen offset:0 sc1
L_h1_n12:
    s_bitcmp1_b32 s88, 13
    s_cbranch_scc1 L_h1_n13
    s_waitcnt vmcnt(4)
    v_cmp_eq_u32 vcc, -1, v95
    s_cbranch_vccnz L_h1_b13
    v_dot2c_f32_bf16 v112, s86, v92
    v_dot2c_f32_bf16 v113, s87, v92
    v_dot2c_f32_bf16 v114, s86, v93
    v_dot2c_f32_bf16 v115, s87, v93
    v_dot2c_f32_bf16 v116, s86, v94
    v_dot2c_f32_bf16 v117, s87, v94
    v_dot2c_f32_bf16 v118, s86, v95
    v_dot2c_f32_bf16 v119, s87, v95
    s_bitset1_b32 s88, 13
    s_branch L_h1_n13
L_h1_b13:
    buffer_load_dwordx4 v[92:95], v2, s[16:19], s94 offen offset:1024 sc1
L_h1_n13:
    s_bitcmp1_b32 s88, 14
    s_cbranch_scc1 L_h1_n14
    s_waitcnt vmcnt(3)
    v_cmp_eq_u32 vcc, -1, v99
    s_cbranch_vccnz L_h1_b14
    v_dot2c_f32_bf16 v112, s86, v96
    v_dot2c_f32_bf16 v113, s87, v96
    v_dot2c_f32_bf16 v114, s86, v97
    v_dot2c_f32_bf16 v115, s87, v97
    v_dot2c_f32_bf16 v116, s86, v98
    v_dot2c_f32_bf16 v117, s87, v98
    v_dot2c_f32_bf16 v118, s86, v99
    v_dot2c_f32_bf16 v119, s87, v99
    s_bitset1_b32 s88, 14
    s_branch L_h1_n14
L_h1_b14:
    buffer_load_dwordx4 v[96:99], v2, s[16:19], s94 offen offset:2048 sc1
L_h1_n14:
    s_bitcmp1_b32 s88, 15
    s_cbranch_scc1 L_h1_n15
    s_waitcnt vmcnt(2)
    v_cmp_eq_u32 vcc, -1, v103
    s_cbranch_vccnz L_h1_b15
    v_dot2c_f32_bf16 v112, s86, v100
    v_dot2c_f32_bf16 v113, s87, v100
    v_dot2c_f32_bf16 v114, s86, v101
    v_dot2c_f32_bf16 v115, s87, v101
    v_dot2c_f32_bf16 v116, s86, v102
    v_dot2c_f32_bf16 v117, s87, v102
    v_dot2c_f32_bf16 v118, s86, v103
    v_dot2c_f32_bf16 v119, s87, v103
    s_bitset1_b32 s88, 15
    s_branch L_h1_n15
L_h1_b15:
    buffer_load_dwordx4 v[100:103], v2, s[16:19], s94 offen offset:3072 sc1
L_h1_n15:
    s_bitcmp1_b32 s88, 16
    s_cbranch_scc1 L_h1_nz
    s_waitcnt vmcnt(0)
    v_max_u32 v4, v104, v108
    v_cmp_eq_u32 vcc, -1, v4
    s_cbranch_vccnz L_h1_bz
    v_add_f32_dpp v104, v104, v104 row_ror:8 row_mask:0xf bank_mask:0xf
    v_add_f32_dpp v105, v105, v105 row_ror:8 row_mask:0xf bank_mask:0xf
    v_add_f32_dpp v106, v106, v106 row_ror:8 row_mask:0xf bank_mask:0xf
    v_add_f32_dpp v107, v107, v107 row_ror:8 row_mask:0xf bank_mask:0xf
    v_add_f32_dpp v108, v108, v108 row_ror:8 row_mask:0xf bank_mask:0xf
    v_add_f32_dpp v109, v109, v109 row_ror:8 row_mask:0xf bank_mask:0xf
    v_add_f32_dpp v110, v110, v110 row_ror:8 row_mask:0xf bank_mask:0xf
    v_add_f32_dpp v111, v111, v111 row_ror:8 row_mask:0xf bank_mask:0xf
    v_add_f32_dpp v104, v104, v104 row_ror:4 row_mask:0xf bank_mask:0xf
    v_add_f32_dpp v105, v105, v105 row_ror:4 row_mask:0xf bank_mask:0xf
    v_add_f32_dpp v106, v106, v106 row_ror:4 row_mask:0xf bank_mask:0xf
    v_add_f32_dpp v107, v107, v107 row_ror:4 row_mask:0xf bank_mask:0xf
    v_add_f32_dpp v108, v108, v108 row_ror:4 row_mask:0xf bank_mask:0xf
    v_add_f32_dpp v109, v109, v109 row_ror:4 row_mask:0xf bank_mask:0xf
    v_add_f32_dpp v110, v110, v110 row_ror:4 row_mask:0xf bank_mask:0xf
    v_add_f32_dpp v111, v111, v111 row_ror:4 row_mask:0xf bank_mask:0xf
    v_add_f32_dpp v104, v104, v104 row_ror:2 row_mask:0xf bank_mask:0xf
    v_add_f32_dpp v105, v105, v105 row_ror:2 row_mask:0xf bank_mask:0xf
    v_add_f32_dpp v106, v106, v106 row_ror:2 row_mask:0xf bank_mask:0xf
    v_add_f32_dpp v107, v107, v107 row_ror:2 row_mask:0xf bank_mask:0xf
    v_add_f32_dpp v108, v108, v108 row_ror:2 row_mask:0xf bank_mask:0xf
    v_add_f32_dpp v109, v109, v109 row_ror:2 row_mask:0xf bank_mask:0xf
    v_add_f32_dpp v110, v110, v110 row_ror:2 row_mask:0xf bank_mask:0xf
    v_add_f32_dpp v111, v111, v111 row_ror:2 row_mask:0xf bank_mask:0xf
    v_add_f32_dpp v104, v104, v104 row_ror:1 row_mask:0xf bank_mask:0xf
    v_add_f32_dpp v105, v105, v105 row_ror:1 row_mask:0xf bank_mask:0xf
    v_add_f32_dpp v106, v106, v106 row_ror:1 row_mask:0xf bank_mask:0xf
    v_add_f32_dpp v107, v107, v107 row_ror:1 row_mask:0xf bank_mask:0xf
    v_add_f32_dpp v108, v108, v108 row_ror:1 row_mask:0xf bank_mask:0xf
    v_add_f32_dpp v109, v109, v109 row_ror:1 row_mask:0xf bank_mask:0xf
    v_add_f32_dpp v110, v110, v110 row_ror:1 row_mask:0xf bank_mask:0xf
    v_add_f32_dpp v111, v111, v111 row_ror:1 row_mask:0xf bank_mask:0xf
    s_bitset1_b32 s88, 16
    s_branch L_h1_nz
L_h1_bz:
    buffer_load_dwordx4 v[104:107], v3, s[16:19], 0 offen sc1
    buffer_load_dwordx4 v[108:111], v3, s[16:19], 0 offen offset:64 sc1
L_h1_nz:
    s_cmp_eq_u32 s88, 0x1ffff
    s_cbranch_scc1 L_h1_done
    s_waitcnt vmcnt(0)
    s_sub_u32 s56, s56, 1
    s_cbranch_scc0 L_h1_round
    s_mov_b32 s56, 0
L_h1_done:
    v_cvt_pk_bf16_f32 v120, v112, v113
    v_cvt_pk_bf16_f32 v121, v114, v115
    v_cvt_pk_bf16_f32 v122, v116, v117
    v_cvt_pk_bf16_f32 v123, v118, v119
    v_cvt_pk_bf16_f32 v124, v104, v105
    v_cvt_pk_bf16_f32 v125, v106, v107
    v_cvt_pk_bf16_f32 v126, v108, v109
    v_cvt_pk_bf16_f32 v127, v110, v111
    s_mul_i32 s86, s50, 3072
    s_add_u32 s86, s86, 28672
    v_lshl_add_u32 v4, v0, 4, s86
    s_lshl_b32 s86, s49, 10
    v_add_u32 v5, s86, v4
    ds_write_b128 v5, v[120:123]
    ds_write_b128 v4, v[124:127] offset:2048
    s_waitcnt vmcnt(0) lgkmcnt(0)
    s_barrier
    s_barrier
    s_branch L_phaseB
L_comp:
    v_and_b32 v20, 15, v0
    v_lshrrev_b32 v21, 4, v0
    v_bfe_u32 v22, v0, 1, 3
    s_lshl_b32 s86, s49, 13
    v_lshl_add_u32 v20, v20, 7, s86
    v_or_b32 v23, 0, v21
    v_xor_b32 v23, v23, v22
    v_lshl_add_u32 v2, v23, 4, v20
    v_or_b32 v23, 4, v21
    v_xor_b32 v23, v23, v22
    v_lshl_add_u32 v3, v23, 4, v20
    v_bfe_u32 v22, v0, 2, 2
    v_lshl_add_u32 v22, v21, 3, v22
    v_lshlrev_b32 v22, 7, v22
    v_bfe_u32 v23, v0, 3, 2
    s_lshl_b32 s86, s50, 1
    v_xor_b32 v23, s86, v23
    v_lshl_add_u32 v22, v23, 5, v22
    v_and_b32 v23, 3, v0
    v_lshl_add_u32 v22, v23, 3, v22
    v_add_u32 v4, 16384, v22
    v_xor_b32 v5, 32, v4
    s_lshl_b32 s53, s2, 2
    s_add_u32 s53, s53, s3
    s_mul_i32 s53, s53, 6400
    s_add_u32 s53, s53, 1048576
    v_lshl_add_u32 v6, v0, 4, s53
    v_cmp_gt_u32 vcc, 16, v0
    v_mov_b32 v7, 2147483648
    s_nop 0
    v_cndmask_b32 v7, v7, v6, vcc
    v_mov_b32 v8, -1
    v_mov_b32 v9, -1
    v_mov_b32 v10, -1
    v_mov_b32 v11, -1
    s_waitcnt lgkmcnt(0)
    s_mov_b32 s16, s84
    s_and_b32 s17, s85, 0xffff
    s_mov_b32 s18, 268435456
    s_mov_b32 s19, 0x20000
    s_mov_b32 s8, s64
    s_and_b32 s9, s65, 0xffff
    s_mov_b32 s10, 4194304
    s_mov_b32 s11, 0x20000
    s_mov_b32 s20, s68
    s_and_b32 s21, s69, 0xffff
    s_mov_b32 s22, 2097152
    s_mov_b32 s23, 0x20000
    s_mov_b32 s24, s80
    s_and_b32 s25, s81, 0xffff
    s_mov_b32 s26, 4194304
    s_mov_b32 s27, 0x20000
    s_mov_b32 s28, s82
    s_and_b32 s29, s83, 0xffff
    s_mov_b32 s30, 256
    s_mov_b32 s31, 0x20000
    s_bitcmp1_b32 s2, 0
    s_cselect_b32 s32, s76, s74
    s_cselect_b32 s33, s77, s75
    s_and_b32 s33, s33, 0xffff
    s_mov_b32 s34, 7340032
    s_mov_b32 s35, 0x20000
    s_mov_b32 s36, s78
    s_and_b32 s37, s79, 0xffff
    s_mov_b32 s38, 7340032
    s_mov_b32 s39, 0x20000
    s_mov_b32 s40, s72
    s_and_b32 s41, s73, 0xffff
    s_mov_b32 s42, 2048
    s_mov_b32 s43, 0x20000
    s_mov_b32 s12, s66
    s_and_b32 s13, s67, 0xffff
    s_mov_b32 s14, 6291456
    s_mov_b32 s15, 0x20000
    v_mov_b32 v128, 0
    v_mov_b32 v129, 0
    v_mov_b32 v130, 0
    v_mov_b32 v131, 0
    v_mov_b32 v132, 0
    v_mov_b32 v133, 0
    v_mov_b32 v134, 0
    v_mov_b32 v135, 0
    v_mov_b32 v136, 0
    v_mov_b32 v137, 0
    v_mov_b32 v138, 0
    v_mov_b32 v139, 0
    v_mov_b32 v140, 0
    v_mov_b32 v141, 0
    v_mov_b32 v142, 0
    v_mov_b32 v143, 0
    v_mov_b32 v144, 0
    v_mov_b32 v145, 0
    v_mov_b32 v146, 0
    v_mov_b32 v147, 0
    v_mov_b32 v148, 0
    v_mov_b32 v149, 0
    v_mov_b32 v150, 0
    v_mov_b32 v151, 0
    v_mov_b32 v152, 0
    v_mov_b32 v153, 0
    v_mov_b32 v154, 0
    v_mov_b32 v155, 0
    v_mov_b32 v156, 0
    v_mov_b32 v157, 0
    v_mov_b32 v158, 0
    v_mov_b32 v159, 0
    v_mov_b32 v160, 0
    v_mov_b32 v161, 0
    v_mov_b32 v162, 0
    v_mov_b32 v163, 0
    v_mov_b32 v164, 0
    v_mov_b32 v165, 0
    v_mov_b32 v166, 0
    v_mov_b32 v167, 0
    v_mov_b32 v168, 0
    v_mov_b32 v169, 0
    v_mov_b32 v170, 0
    v_mov_b32 v171, 0
    v_mov_b32 v172, 0
    v_mov_b32 v173, 0
    v_mov_b32 v174, 0
    v_mov_b32 v175, 0
    v_mov_b32 v176, 0
    v_mov_b32 v177, 0
    v_mov_b32 v178, 0
    v_mov_b32 v179, 0
    v_mov_b32 v180, 0
    v_mov_b32 v181, 0
    v_mov_b32 v182, 0
    v_mov_b32 v183, 0
    v_mov_b32 v184, 0
    v_mov_b32 v185, 0
    v_mov_b32 v186, 0
    v_mov_b32 v187, 0
    v_mov_b32 v188, 0
    v_mov_b32 v189, 0
    v_mov_b32 v190, 0
    v_mov_b32 v191, 0
    v_mov_b32 v192, 0
    v_mov_b32 v193, 0
    v_mov_b32 v194, 0
    v_mov_b32 v195, 0
    v_mov_b32 v196, 0
    v_mov_b32 v197, 0
    v_mov_b32 v198, 0
    v_mov_b32 v199, 0
    v_mov_b32 v200, 0
    v_mov_b32 v201, 0
    v_mov_b32 v202, 0
    v_mov_b32 v203, 0
    v_mov_b32 v204, 0
    v_mov_b32 v205, 0
    v_mov_b32 v206, 0
    v_mov_b32 v207, 0
    v_mov_b32 v208, 0
    v_mov_b32 v209, 0
    v_mov_b32 v210, 0
    v_mov_b32 v211, 0
    v_mov_b32 v212, 0
    v_mov_b32 v213, 0
    v_mov_b32 v214, 0
    v_mov_b32 v215, 0
    v_mov_b32 v216, 0
    v_mov_b32 v217, 0
    v_mov_b32 v218, 0
    v_mov_b32 v219, 0
    v_mov_b32 v220, 0
    v_mov_b32 v221, 0
    v_mov_b32 v222, 0
    v_mov_b32 v223, 0
    buffer_store_dwordx4 v[8:11], v6, s[16:19], 0 offen offset:0 sc1
    buffer_store_dwordx4 v[8:11], v6, s[16:19], 0 offen offset:1024 sc1
    buffer_store_dwordx4 v[8:11], v6, s[16:19], 0 offen offset:2048 sc1
    buffer_store_dwordx4 v[8:11], v6, s[16:19], 0 offen offset:3072 sc1
    buffer_store_dwordx4 v[8:11], v6, s[16:19], s92 offen offset:0 sc1
    buffer_store_dwordx4 v[8:11], v6, s[16:19], s92 offen offset:1024 sc1
    buffer_store_dwordx4 v[8:11], v7, s[16:19], s92 offen offset:2048 sc1
    s_mov_b32 s54, 0x358637bd
    s_mov_b32 s55, 0x358637bd
    s_mov_b32 s62, 0
    s_mov_b32 s63, 0
    s_barrier
    ds_read_b128 v[40:43], v2 offset:0
    ds_read_b128 v[44:47], v2 offset:2048
    ds_read_b128 v[48:51], v2 offset:4096
    ds_read_b128 v[52:55], v2 offset:6144
    ds_read_b64_tr_b16 v[56:57], v4 offset:0
    ds_read_b64_tr_b16 v[58:59], v4 offset:512
    ds_read_b64_tr_b16 v[60:61], v5 offset:0
    ds_read_b64_tr_b16 v[62:63], v5 offset:512
    ds_read_b64_tr_b16 v[64:65], v4 offset:8192
    ds_read_b64_tr_b16 v[66:67], v4 offset:8704
    ds_read_b64_tr_b16 v[68:69], v5 offset:8192
    ds_read_b64_tr_b16 v[70:71], v5 offset:8704
    ds_read_b64_tr_b16 v[72:73], v4 offset:16384
    ds_read_b64_tr_b16 v[74:75], v4 offset:16896
    ds_read_b64_tr_b16 v[76:77], v5 offset:16384
    ds_read_b64_tr_b16 v[78:79], v5 offset:16896
L_cloop:
    s_waitcnt lgkmcnt(0)
    v_mfma_f32_16x16x32_bf16 v[128:131], v[56:59], v[40:43], v[128:131]
    ds_read_b128 v[80:83], v3 offset:0
    v_mfma_f32_16x16x32_bf16 v[132:135], v[56:59], v[44:47], v[132:135]
    ds_read_b128 v[84:87], v3 offset:2048
    v_mfma_f32_16x16x32_bf16 v[136:139], v[56:59], v[48:51], v[136:139]
    ds_read_b128 v[88:91], v3 offset:4096
    v_mfma_f32_16x16x32_bf16 v[140:143], v[56:59], v[52:55], v[140:143]
    ds_read_b128 v[92:95], v3 offset:6144
    v_mfma_f32_16x16x32_bf16 v[144:147], v[60:63], v[40:43], v[144:147]
    ds_read_b64_tr_b16 v[96:97], v4 offset:4096
    v_mfma_f32_16x16x32_bf16 v[148:151], v[60:63], v[44:47], v[148:151]
    ds_read_b64_tr_b16 v[98:99], v4 offset:4608
    v_mfma_f32_16x16x32_bf16 v[152:155], v[60:63], v[48:51], v[152:155]
    ds_read_b64_tr_b16 v[100:101], v5 offset:4096
    v_mfma_f32_16x16x32_bf16 v[156:159], v[60:63], v[52:55], v[156:159]
    ds_read_b64_tr_b16 v[102:103], v5 offset:4608
    v_mfma_f32_16x16x32_bf16 v[160:163], v[40:43], v[64:67], v[160:163]
    ds_read_b64_tr_b16 v[104:105], v4 offset:12288
    v_mfma_f32_16x16x32_bf16 v[164:167], v[44:47], v[64:67], v[164:167]
    ds_read_b64_tr_b16 v[106:107], v4 offset:12800
    v_mfma_f32_16x16x32_bf16 v[168:171], v[48:51], v[64:67], v[168:171]
    ds_read_b64_tr_b16 v[108:109], v5 offset:12288
    v_mfma_f32_16x16x32_bf16 v[172:175], v[52:55], v[64:67], v[172:175]
    ds_read_b64_tr_b16 v[110:111], v5 offset:12800
    v_mfma_f32_16x16x32_bf16 v[176:179], v[40:43], v[68:71], v[176:179]
    ds_read_b64_tr_b16 v[112:113], v4 offset:20480
    v_mfma_f32_16x16x32_bf16 v[180:183], v[44:47], v[68:71], v[180:183]
    ds_read_b64_tr_b16 v[114:115], v4 offset:20992
    v_mfma_f32_16x16x32_bf16 v[184:187], v[48:51], v[68:71], v[184:187]
    ds_read_b64_tr_b16 v[116:117], v5 offset:20480
    v_mfma_f32_16x16x32_bf16 v[188:191], v[52:55], v[68:71], v[188:191]
    ds_read_b64_tr_b16 v[118:119], v5 offset:20992
    v_mfma_f32_16x16x32_bf16 v[192:195], v[40:43], v[72:75], v[192:195]
    s_add_u32 s63, s63, 1
    s_cmp_eq_u32 s63, 3
    s_cselect_b32 s53, 4294844416, 0
    s_cselect_b32 s63, 0, s63
    s_add_u32 s53, s53, 40960
    v_mfma_f32_16x16x32_bf16 v[196:199], v[44:47], v[72:75], v[196:199]
    v_add_u32 v2, s53, v2
    v_mfma_f32_16x16x32_bf16 v[200:203], v[48:51], v[72:75], v[200:203]
    v_add_u32 v4, s53, v4
    v_mfma_f32_16x16x32_bf16 v[204:207], v[52:55], v[72:75], v[204:207]
    v_add_u32 v5, s53, v5
    v_mfma_f32_16x16x32_bf16 v[208:211], v[40:43], v[76:79], v[208:211]
    v_add_u32 v3, s53, v3
    v_mfma_f32_16x16x32_bf16 v[212:215], v[44:47], v[76:79], v[212:215]
    v_mfma_f32_16x16x32_bf16 v[216:219], v[48:51], v[76:79], v[216:219]
    v_mfma_f32_16x16x32_bf16 v[220:223], v[52:55], v[76:79], v[220:223]
    s_waitcnt lgkmcnt(0)
    v_mfma_f32_16x16x32_bf16 v[128:131], v[96:99], v[80:83], v[128:131]
    s_barrier
    ds_read_b128 v[40:43], v2 offset:0
    v_mfma_f32_16x16x32_bf16 v[132:135], v[96:99], v[84:87], v[132:135]
    ds_read_b128 v[44:47], v2 offset:2048
    v_mfma_f32_16x16x32_bf16 v[136:139], v[96:99], v[88:91], v[136:139]
    ds_read_b128 v[48:51], v2 offset:4096
    v_mfma_f32_16x16x32_bf16 v[140:143], v[96:99], v[92:95], v[140:143]
    ds_read_b128 v[52:55], v2 offset:6144
    v_mfma_f32_16x16x32_bf16 v[144:147], v[100:103], v[80:83], v[144:147]
    ds_read_b64_tr_b16 v[56:57], v4 offset:0
    v_mfma_f32_16x16x32_bf16 v[148:151], v[100:103], v[84:87], v[148:151]
    ds_read_b64_tr_b16 v[58:59], v4 offset:512
    v_mfma_f32_16x16x32_bf16 v[152:155], v[100:103], v[88:91], v[152:155]
    ds_read_b64_tr_b16 v[60:61], v5 offset:0
    v_mfma_f32_16x16x32_bf16 v[156:159], v[100:103], v[92:95], v[156:159]
    ds_read_b64_tr_b16 v[62:63], v5 offset:512
    v_mfma_f32_16x16x32_bf16 v[160:163], v[80:83], v[104:107], v[160:163]
    ds_read_b64_tr_b16 v[64:65], v4 offset:8192
    v_mfma_f32_16x16x32_bf16 v[164:167], v[84:87], v[104:107], v[164:167]
    ds_read_b64_tr_b16 v[66:67], v4 offset:8704
    v_mfma_f32_16x16x32_bf16 v[168:171], v[88:91], v[104:107], v[168:171]
    ds_read_b64_tr_b16 v[68:69], v5 offset:8192
    v_mfma_f32_16x16x32_bf16 v[172:175], v[92:95], v[104:107], v[172:175]
    ds_read_b64_tr_b16 v[70:71], v5 offset:8704
    v_mfma_f32_16x16x32_bf16 v[176:179], v[80:83], v[108:111], v[176:179]
    ds_read_b64_tr_b16 v[72:73], v4 offset:16384
    v_mfma_f32_16x16x32_bf16 v[180:183], v[84:87], v[108:111], v[180:183]
    ds_read_b64_tr_b16 v[74:75], v4 offset:16896
    v_mfma_f32_16x16x32_bf16 v[184:187], v[88:91], v[108:111], v[184:187]
    ds_read_b64_tr_b16 v[76:77], v5 offset:16384
    v_mfma_f32_16x16x32_bf16 v[188:191], v[92:95], v[108:111], v[188:191]
    ds_read_b64_tr_b16 v[78:79], v5 offset:16896
    v_mfma_f32_16x16x32_bf16 v[192:195], v[80:83], v[112:115], v[192:195]
    v_mfma_f32_16x16x32_bf16 v[196:199], v[84:87], v[112:115], v[196:199]
    s_cmp_lg_u32 s62, 3
    s_cbranch_scc1 L_cl_nw
    s_waitcnt vmcnt(0)
L_cl_nw:
    v_mfma_f32_16x16x32_bf16 v[200:203], v[88:91], v[112:115], v[200:203]
    v_mfma_f32_16x16x32_bf16 v[204:207], v[92:95], v[112:115], v[204:207]
    v_mfma_f32_16x16x32_bf16 v[208:211], v[80:83], v[116:119], v[208:211]
    s_add_u32 s62, s62, 1
    v_mfma_f32_16x16x32_bf16 v[212:215], v[84:87], v[116:119], v[212:215]
    v_mfma_f32_16x16x32_bf16 v[216:219], v[88:91], v[116:119], v[216:219]
    v_mfma_f32_16x16x32_bf16 v[220:223], v[92:95], v[116:119], v[220:223]
    s_cmp_lt_u32 s62, 15
    s_cbranch_scc1 L_cloop
    s_waitcnt lgkmcnt(0)
    v_mfma_f32_16x16x32_bf16 v[128:131], v[56:59], v[40:43], v[128:131]
    ds_read_b128 v[80:83], v3 offset:0
    v_mfma_f32_16x16x32_bf16 v[132:135], v[56:59], v[44:47], v[132:135]
    ds_read_b128 v[84:87], v3 offset:2048
    v_mfma_f32_16x16x32_bf16 v[136:139], v[56:59], v[48:51], v[136:139]
    ds_read_b128 v[88:91], v3 offset:4096
    v_mfma_f32_16x16x32_bf16 v[140:143], v[56:59], v[52:55], v[140:143]
    ds_read_b128 v[92:95], v3 offset:6144
    v_mfma_f32_16x16x32_bf16 v[144:147], v[60:63], v[40:43], v[144:147]
    ds_read_b64_tr_b16 v[96:97], v4 offset:4096
    v_mfma_f32_16x16x32_bf16 v[148:151], v[60:63], v[44:47], v[148:151]
    ds_read_b64_tr_b16 v[98:99], v4 offset:4608
    v_mfma_f32_16x16x32_bf16 v[152:155], v[60:63], v[48:51], v[152:155]
    ds_read_b64_tr_b16 v[100:101], v5 offset:4096
    v_mfma_f32_16x16x32_bf16 v[156:159], v[60:63], v[52:55], v[156:159]
    ds_read_b64_tr_b16 v[102:103], v5 offset:4608
    v_mfma_f32_16x16x32_bf16 v[160:163], v[40:43], v[64:67], v[160:163]
    ds_read_b64_tr_b16 v[104:105], v4 offset:12288
    v_mfma_f32_16x16x32_bf16 v[164:167], v[44:47], v[64:67], v[164:167]
    ds_read_b64_tr_b16 v[106:107], v4 offset:12800
    v_mfma_f32_16x16x32_bf16 v[168:171], v[48:51], v[64:67], v[168:171]
    ds_read_b64_tr_b16 v[108:109], v5 offset:12288
    v_mfma_f32_16x16x32_bf16 v[172:175], v[52:55], v[64:67], v[172:175]
    ds_read_b64_tr_b16 v[110:111], v5 offset:12800
    v_mfma_f32_16x16x32_bf16 v[176:179], v[40:43], v[68:71], v[176:179]
    ds_read_b64_tr_b16 v[112:113], v4 offset:20480
    v_mfma_f32_16x16x32_bf16 v[180:183], v[44:47], v[68:71], v[180:183]
    ds_read_b64_tr_b16 v[114:115], v4 offset:20992
    v_mfma_f32_16x16x32_bf16 v[184:187], v[48:51], v[68:71], v[184:187]
    ds_read_b64_tr_b16 v[116:117], v5 offset:20480
    v_mfma_f32_16x16x32_bf16 v[188:191], v[52:55], v[68:71], v[188:191]
    ds_read_b64_tr_b16 v[118:119], v5 offset:20992
    v_mfma_f32_16x16x32_bf16 v[192:195], v[40:43], v[72:75], v[192:195]
    v_lshrrev_b32 v21, 4, v0
    v_and_b32 v22, 15, v0
    v_mfma_f32_16x16x32_bf16 v[196:199], v[44:47], v[72:75], v[196:199]
    s_lshl_b32 s86, s49, 8
    s_add_u32 s86, s86, 155648
    v_lshl_add_u32 v6, v21, 4, s86
    v_mfma_f32_16x16x32_bf16 v[200:203], v[48:51], v[72:75], v[200:203]
    v_lshl_add_u32 v7, v22, 2, s86
    v_mfma_f32_16x16x32_bf16 v[204:207], v[52:55], v[72:75], v[204:207]
    s_lshl_b32 s86, s50, 7
    s_add_u32 s86, s86, 157184
    v_lshl_add_u32 v8, v22, 2, s86
    v_mfma_f32_16x16x32_bf16 v[208:211], v[40:43], v[76:79], v[208:211]
    v_lshl_add_u32 v9, v21, 4, s86
    v_mfma_f32_16x16x32_bf16 v[212:215], v[44:47], v[76:79], v[212:215]
    v_mfma_f32_16x16x32_bf16 v[216:219], v[48:51], v[76:79], v[216:219]
    v_mfma_f32_16x16x32_bf16 v[220:223], v[52:55], v[76:79], v[220:223]
    s_waitcnt lgkmcnt(0)
    v_mfma_f32_16x16x32_bf16 v[160:163], v[80:83], v[104:107], v[160:163]
    s_barrier
    ds_read_b128 v[40:43], v6 offset:0
    v_mfma_f32_16x16x32_bf16 v[164:167], v[84:87], v[104:107], v[164:167]
    ds_read_b128 v[44:47], v6 offset:64
    v_mfma_f32_16x16x32_bf16 v[168:171], v[88:91], v[104:107], v[168:171]
    ds_read_b128 v[48:51], v6 offset:128
    v_mfma_f32_16x16x32_bf16 v[172:175], v[92:95], v[104:107], v[172:175]
    ds_read_b128 v[52:55], v6 offset:192
    v_mfma_f32_16x16x32_bf16 v[176:179], v[80:83], v[108:111], v[176:179]
    ds_read_b32 v72, v8 offset:256
    v_mfma_f32_16x16x32_bf16 v[180:183], v[84:87], v[108:111], v[180:183]
    ds_read_b32 v73, v8 offset:320
    v_mfma_f32_16x16x32_bf16 v[184:187], v[88:91], v[108:111], v[184:187]
    ds_read_b32 v74, v8 offset:512
    v_mfma_f32_16x16x32_bf16 v[188:191], v[92:95], v[108:111], v[188:191]
    ds_read_b32 v75, v8 offset:576
    v_mfma_f32_16x16x32_bf16 v[192:195], v[80:83], v[112:115], v[192:195]
    ds_read_b128 v[56:59], v6 offset:512
    v_mfma_f32_16x16x32_bf16 v[196:199], v[84:87], v[112:115], v[196:199]
    ds_read_b128 v[60:63], v6 offset:576
    v_mfma_f32_16x16x32_bf16 v[200:203], v[88:91], v[112:115], v[200:203]
    ds_read_b128 v[64:67], v6 offset:640
    v_mfma_f32_16x16x32_bf16 v[204:207], v[92:95], v[112:115], v[204:207]
    ds_read_b128 v[68:71], v6 offset:704
    v_mfma_f32_16x16x32_bf16 v[208:211], v[80:83], v[116:119], v[208:211]
    ds_read_b128 v[224:227], v6 offset:1024
    v_mfma_f32_16x16x32_bf16 v[212:215], v[84:87], v[116:119], v[212:215]
    ds_read_b128 v[228:231], v6 offset:1088
    v_mfma_f32_16x16x32_bf16 v[216:219], v[88:91], v[116:119], v[216:219]
    ds_read_b128 v[232:235], v6 offset:1152
    v_mfma_f32_16x16x32_bf16 v[220:223], v[92:95], v[116:119], v[220:223]
    ds_read_b128 v[236:239], v6 offset:1216
    v_mfma_f32_16x16x32_bf16 v[128:131], v[96:99], v[80:83], v[128:131]
    ds_read_b128 v[28:31], v9 offset:0
    v_mfma_f32_16x16x32_bf16 v[132:135], v[96:99], v[84:87], v[132:135]
    ds_read_b128 v[32:35], v9 offset:64
    v_mfma_f32_16x16x32_bf16 v[136:139], v[96:99], v[88:91], v[136:139]
    v_mfma_f32_16x16x32_bf16 v[140:143], v[96:99], v[92:95], v[140:143]
    v_mfma_f32_16x16x32_bf16 v[144:147], v[100:103], v[80:83], v[144:147]
    v_mfma_f32_16x16x32_bf16 v[148:151], v[100:103], v[84:87], v[148:151]
    v_mfma_f32_16x16x32_bf16 v[152:155], v[100:103], v[88:91], v[152:155]
    v_mfma_f32_16x16x32_bf16 v[156:159], v[100:103], v[92:95], v[156:159]
    ds_read_b32 v240, v7 offset:0
    ds_read_b32 v244, v7 offset:512
    ds_read_b32 v248, v7 offset:1024
    ds_read_b32 v241, v7 offset:64
    ds_read_b32 v245, v7 offset:576
    ds_read_b32 v249, v7 offset:1088
    ds_read_b32 v242, v7 offset:128
    ds_read_b32 v246, v7 offset:640
    ds_read_b32 v250, v7 offset:1152
    ds_read_b32 v243, v7 offset:192
    ds_read_b32 v247, v7 offset:704
    ds_read_b32 v251, v7 offset:1216
    s_waitcnt lgkmcnt(12)
    v_pk_fma_f32 v[160:161], v[40:41], v[72:73], v[160:161] op_sel_hi:[1,0,1]
    v_pk_mul_f32 v[112:113], v[160:161], v[224:225]
    v_pk_fma_f32 v[160:161], v[160:161], v[56:57], s[54:55]
    v_exp_f32 v112, v112 clamp
    v_exp_f32 v113, v113 clamp
    v_max_f32 v160, s54, v160
    v_max_f32 v161, s54, v161
    v_pk_add_f32 v[160:161], v[160:161], v[112:113]
    v_cvt_pk_bf16_f32 v80, v160, v161
    v_pk_fma_f32 v[162:163], v[42:43], v[72:73], v[162:163] op_sel_hi:[1,0,1]
    v_pk_mul_f32 v[114:115], v[162:163], v[226:227]
    v_pk_fma_f32 v[162:163], v[162:163], v[58:59], s[54:55]
    v_exp_f32 v114, v114 clamp
    v_exp_f32 v115, v115 clamp
    v_max_f32 v162, s54, v162
    v_max_f32 v163, s54, v163
    v_pk_add_f32 v[162:163], v[162:163], v[114:115]
    v_cvt_pk_bf16_f32 v81, v162, v163
    v_pk_fma_f32 v[164:165], v[44:45], v[72:73], v[164:165] op_sel_hi:[1,0,1]
    v_pk_mul_f32 v[116:117], v[164:165], v[228:229]
    v_pk_fma_f32 v[164:165], v[164:165], v[60:61], s[54:55]
    v_exp_f32 v116, v116 clamp
    v_exp_f32 v117, v117 clamp
    v_max_f32 v164, s54, v164
    v_max_f32 v165, s54, v165
    v_pk_add_f32 v[164:165], v[164:165], v[116:117]
    v_cvt_pk_bf16_f32 v82, v164, v165
    v_pk_fma_f32 v[166:167], v[46:47], v[72:73], v[166:167] op_sel_hi:[1,0,1]
    v_pk_mul_f32 v[118:119], v[166:167], v[230:231]
    v_pk_fma_f32 v[166:167], v[166:167], v[62:63], s[54:55]
    v_exp_f32 v118, v118 clamp
    v_exp_f32 v119, v119 clamp
    v_max_f32 v166, s54, v166
    v_max_f32 v167, s54, v167
    v_pk_add_f32 v[166:167], v[166:167], v[118:119]
    v_cvt_pk_bf16_f32 v83, v166, v167
    v_pk_fma_f32 v[168:169], v[48:49], v[72:73], v[168:169] op_sel_hi:[1,0,1]
    v_pk_mul_f32 v[112:113], v[168:169], v[232:233]
    v_pk_fma_f32 v[168:169], v[168:169], v[64:65], s[54:55]
    v_exp_f32 v112, v112 clamp
    v_exp_f32 v113, v113 clamp
    v_max_f32 v168, s54, v168
    v_max_f32 v169, s54, v169
    v_pk_add_f32 v[168:169], v[168:169], v[112:113]
    v_cvt_pk_bf16_f32 v84, v168, v169
    v_pk_fma_f32 v[170:171], v[50:51], v[72:73], v[170:171] op_sel_hi:[1,0,1]
    v_pk_mul_f32 v[114:115], v[170:171], v[234:235]
    v_pk_fma_f32 v[170:171], v[170:171], v[66:67], s[54:55]
    v_exp_f32 v114, v114 clamp
    v_exp_f32 v115, v115 clamp
    v_max_f32 v170, s54, v170
    v_max_f32 v171, s54, v171
    v_pk_add_f32 v[170:171], v[170:171], v[114:115]
    v_cvt_pk_bf16_f32 v85, v170, v171
    v_pk_fma_f32 v[172:173], v[52:53], v[72:73], v[172:173] op_sel_hi:[1,0,1]
    v_pk_mul_f32 v[116:117], v[172:173], v[236:237]
    v_pk_fma_f32 v[172:173], v[172:173], v[68:69], s[54:55]
    v_exp_f32 v116, v116 clamp
    v_exp_f32 v117, v117 clamp
    v_max_f32 v172, s54, v172
    v_max_f32 v173, s54, v173
    v_pk_add_f32 v[172:173], v[172:173], v[116:117]
    v_cvt_pk_bf16_f32 v86, v172, v173
    v_pk_fma_f32 v[174:175], v[54:55], v[72:73], v[174:175] op_sel_hi:[1,0,1]
    v_pk_mul_f32 v[118:119], v[174:175], v[238:239]
    v_pk_fma_f32 v[174:175], v[174:175], v[70:71], s[54:55]
    v_exp_f32 v118, v118 clamp
    v_exp_f32 v119, v119 clamp
    v_max_f32 v174, s54, v174
    v_max_f32 v175, s54, v175
    v_pk_add_f32 v[174:175], v[174:175], v[118:119]
    v_cvt_pk_bf16_f32 v87, v174, v175
    v_pk_fma_f32 v[176:177], v[40:41], v[72:73], v[176:177] op_sel:[0,1,0] op_sel_hi:[1,1,1]
    v_pk_mul_f32 v[112:113], v[176:177], v[224:225]
    v_pk_fma_f32 v[176:177], v[176:177], v[56:57], s[54:55]
    v_exp_f32 v112, v112 clamp
    v_exp_f32 v113, v113 clamp
    v_max_f32 v176, s54, v176
    v_max_f32 v177, s54, v177
    v_pk_add_f32 v[176:177], v[176:177], v[112:113]
    v_cvt_pk_bf16_f32 v88, v176, v177
    v_pk_fma_f32 v[178:179], v[42:43], v[72:73], v[178:179] op_sel:[0,1,0] op_sel_hi:[1,1,1]
    v_pk_mul_f32 v[114:115], v[178:179], v[226:227]
    v_pk_fma_f32 v[178:179], v[178:179], v[58:59], s[54:55]
    v_exp_f32 v114, v114 clamp
    v_exp_f32 v115, v115 clamp
    v_max_f32 v178, s54, v178
    v_max_f32 v179, s54, v179
    v_pk_add_f32 v[178:179], v[178:179], v[114:115]
    v_cvt_pk_bf16_f32 v89, v178, v179
    v_pk_fma_f32 v[180:181], v[44:45], v[72:73], v[180:181] op_sel:[0,1,0] op_sel_hi:[1,1,1]
    v_pk_mul_f32 v[116:117], v[180:181], v[228:229]
    v_pk_fma_f32 v[180:181], v[180:181], v[60:61], s[54:55]
    v_exp_f32 v116, v116 clamp
    v_exp_f32 v117, v117 clamp
    v_max_f32 v180, s54, v180
    v_max_f32 v181, s54, v181
    v_pk_add_f32 v[180:181], v[180:181], v[116:117]
    v_cvt_pk_bf16_f32 v90, v180, v181
    v_pk_fma_f32 v[182:183], v[46:47], v[72:73], v[182:183] op_sel:[0,1,0] op_sel_hi:[1,1,1]
    v_pk_mul_f32 v[118:119], v[182:183], v[230:231]
    v_pk_fma_f32 v[182:183], v[182:183], v[62:63], s[54:55]
    v_exp_f32 v118, v118 clamp
    v_exp_f32 v119, v119 clamp
    v_max_f32 v182, s54, v182
    v_max_f32 v183, s54, v183
    v_pk_add_f32 v[182:183], v[182:183], v[118:119]
    v_cvt_pk_bf16_f32 v91, v182, v183
    v_pk_fma_f32 v[184:185], v[48:49], v[72:73], v[184:185] op_sel:[0,1,0] op_sel_hi:[1,1,1]
    v_pk_mul_f32 v[112:113], v[184:185], v[232:233]
    v_pk_fma_f32 v[184:185], v[184:185], v[64:65], s[54:55]
    v_exp_f32 v112, v112 clamp
    v_exp_f32 v113, v113 clamp
    v_max_f32 v184, s54, v184
    v_max_f32 v185, s54, v185
    v_pk_add_f32 v[184:185], v[184:185], v[112:113]
    v_cvt_pk_bf16_f32 v92, v184, v185
    v_pk_fma_f32 v[186:187], v[50:51], v[72:73], v[186:187] op_sel:[0,1,0] op_sel_hi:[1,1,1]
    v_pk_mul_f32 v[114:115], v[186:187], v[234:235]
    v_pk_fma_f32 v[186:187], v[186:187], v[66:67], s[54:55]
    v_exp_f32 v114, v114 clamp
    v_exp_f32 v115, v115 clamp
    v_max_f32 v186, s54, v186
    v_max_f32 v187, s54, v187
    v_pk_add_f32 v[186:187], v[186:187], v[114:115]
    v_cvt_pk_bf16_f32 v93, v186, v187
    v_pk_fma_f32 v[188:189], v[52:53], v[72:73], v[188:189] op_sel:[0,1,0] op_sel_hi:[1,1,1]
    v_pk_mul_f32 v[116:117], v[188:189], v[236:237]
    v_pk_fma_f32 v[188:189], v[188:189], v[68:69], s[54:55]
    v_exp_f32 v116, v116 clamp
    v_exp_f32 v117, v117 clamp
    v_max_f32 v188, s54, v188
    v_max_f32 v189, s54, v189
    v_pk_add_f32 v[188:189], v[188:189], v[116:117]
    v_cvt_pk_bf16_f32 v94, v188, v189
    v_pk_fma_f32 v[190:191], v[54:55], v[72:73], v[190:191] op_sel:[0,1,0] op_sel_hi:[1,1,1]
    v_pk_mul_f32 v[118:119], v[190:191], v[238:239]
    v_pk_fma_f32 v[190:191], v[190:191], v[70:71], s[54:55]
    v_exp_f32 v118, v118 clamp
    v_exp_f32 v119, v119 clamp
    v_max_f32 v190, s54, v190
    v_max_f32 v191, s54, v191
    v_pk_add_f32 v[190:191], v[190:191], v[118:119]
    v_cvt_pk_bf16_f32 v95, v190, v191
    v_mov_b32 v120, s95
    v_mov_b32 v121, s95
    v_mov_b32 v122, s95
    v_mov_b32 v123, s95
    v_pk_fma_f32 v[192:193], v[40:41], v[74:75], v[192:193] op_sel_hi:[1,0,1]
    v_pk_mul_f32 v[192:193], v[192:193], v[56:57]
    v_cvt_pk_bf16_f32 v96, v192, v193
    v_pk_fma_f32 v[194:195], v[42:43], v[74:75], v[194:195] op_sel_hi:[1,0,1]
    v_pk_mul_f32 v[194:195], v[194:195], v[58:59]
    v_cvt_pk_bf16_f32 v97, v194, v195
    v_pk_fma_f32 v[196:197], v[44:45], v[74:75], v[196:197] op_sel_hi:[1,0,1]
    v_pk_mul_f32 v[196:197], v[196:197], v[60:61]
    v_cvt_pk_bf16_f32 v98, v196, v197
    v_pk_fma_f32 v[198:199], v[46:47], v[74:75], v[198:199] op_sel_hi:[1,0,1]
    v_pk_mul_f32 v[198:199], v[198:199], v[62:63]
    v_cvt_pk_bf16_f32 v99, v198, v199
    v_pk_fma_f32 v[200:201], v[48:49], v[74:75], v[200:201] op_sel_hi:[1,0,1]
    v_pk_mul_f32 v[200:201], v[200:201], v[64:65]
    v_cvt_pk_bf16_f32 v100, v200, v201
    v_pk_fma_f32 v[202:203], v[50:51], v[74:75], v[202:203] op_sel_hi:[1,0,1]
    v_pk_mul_f32 v[202:203], v[202:203], v[66:67]
    v_cvt_pk_bf16_f32 v101, v202, v203
    v_pk_fma_f32 v[204:205], v[52:53], v[74:75], v[204:205] op_sel_hi:[1,0,1]
    v_pk_mul_f32 v[204:205], v[204:205], v[68:69]
    v_cvt_pk_bf16_f32 v102, v204, v205
    v_pk_fma_f32 v[206:207], v[54:55], v[74:75], v[206:207] op_sel_hi:[1,0,1]
    v_pk_mul_f32 v[206:207], v[206:207], v[70:71]
    v_cvt_pk_bf16_f32 v103, v206, v207
    v_pk_fma_f32 v[208:209], v[40:41], v[74:75], v[208:209] op_sel:[0,1,0] op_sel_hi:[1,1,1]
    v_pk_mul_f32 v[208:209], v[208:209], v[56:57]
    v_cvt_pk_bf16_f32 v104, v208, v209
    v_pk_fma_f32 v[210:211], v[42:43], v[74:75], v[210:211] op_sel:[0,1,0] op_sel_hi:[1,1,1]
    v_pk_mul_f32 v[210:211], v[210:211], v[58:59]
    v_cvt_pk_bf16_f32 v105, v210, v211
    v_pk_fma_f32 v[212:213], v[44:45], v[74:75], v[212:213] op_sel:[0,1,0] op_sel_hi:[1,1,1]
    v_pk_mul_f32 v[212:213], v[212:213], v[60:61]
    v_cvt_pk_bf16_f32 v106, v212, v213
    v_pk_fma_f32 v[214:215], v[46:47], v[74:75], v[214:215] op_sel:[0,1,0] op_sel_hi:[1,1,1]
    v_pk_mul_f32 v[214:215], v[214:215], v[62:63]
    v_cvt_pk_bf16_f32 v107, v214, v215
    v_pk_fma_f32 v[216:217], v[48:49], v[74:75], v[216:217] op_sel:[0,1,0] op_sel_hi:[1,1,1]
    v_pk_mul_f32 v[216:217], v[216:217], v[64:65]
    v_cvt_pk_bf16_f32 v108, v216, v217
    v_pk_fma_f32 v[218:219], v[50:51], v[74:75], v[218:219] op_sel:[0,1,0] op_sel_hi:[1,1,1]
    v_pk_mul_f32 v[218:219], v[218:219], v[66:67]
    v_cvt_pk_bf16_f32 v109, v218, v219
    v_pk_fma_f32 v[220:221], v[52:53], v[74:75], v[220:221] op_sel:[0,1,0] op_sel_hi:[1,1,1]
    v_pk_mul_f32 v[220:221], v[220:221], v[68:69]
    v_cvt_pk_bf16_f32 v110, v220, v221
    v_pk_fma_f32 v[222:223], v[54:55], v[74:75], v[222:223] op_sel:[0,1,0] op_sel_hi:[1,1,1]
    v_pk_mul_f32 v[222:223], v[222:223], v[70:71]
    v_cvt_pk_bf16_f32 v111, v222, v223
    s_mul_i32 s86, s3, 3072
    s_add_u32 s86, s86, 16384
    v_lshl_add_u32 v6, v0, 4, s86
    s_xor_b32 s86, s3, 1
    s_mul_i32 s86, s86, 3072
    s_add_u32 s86, s86, 16384
    v_lshl_add_u32 v7, v0, 4, s86
    s_cmp_eq_u32 s49, 1
    s_cbranch_scc1 L_kv1
    v_mfma_f32_16x16x32_bf16 v[172:175], v[80:83], v[104:107], 0
    v_mfma_f32_16x16x32_bf16 v[176:179], v[88:91], v[104:107], 0
    v_mfma_f32_16x16x32_bf16 v[180:183], v[88:91], v[120:123], 0
    v_mfma_f32_16x16x32_bf16 v[160:163], v[80:83], v[96:99], 0
    v_mfma_f32_16x16x32_bf16 v[164:167], v[88:91], v[96:99], 0
    v_mfma_f32_16x16x32_bf16 v[168:171], v[80:83], v[120:123], 0
    v_mfma_f32_16x16x32_bf16 v[172:175], v[84:87], v[108:111], v[172:175]
    v_mfma_f32_16x16x32_bf16 v[176:179], v[92:95], v[108:111], v[176:179]
    v_mfma_f32_16x16x32_bf16 v[180:183], v[92:95], v[120:123], v[180:183]
    v_mfma_f32_16x16x32_bf16 v[160:163], v[84:87], v[100:103], v[160:163]
    v_mfma_f32_16x16x32_bf16 v[164:167], v[92:95], v[100:103], v[164:167]
    v_mfma_f32_16x16x32_bf16 v[168:171], v[84:87], v[120:123], v[168:171]
    s_branch L_kvd
L_kv1:
    v_mfma_f32_16x16x32_bf16 v[172:175], v[80:83], v[96:99], 0
    v_mfma_f32_16x16x32_bf16 v[176:179], v[88:91], v[96:99], 0
    v_mfma_f32_16x16x32_bf16 v[180:183], v[80:83], v[120:123], 0
    v_mfma_f32_16x16x32_bf16 v[160:163], v[80:83], v[104:107], 0
    v_mfma_f32_16x16x32_bf16 v[164:167], v[88:91], v[104:107], 0
    v_mfma_f32_16x16x32_bf16 v[168:171], v[88:91], v[120:123], 0
    v_mfma_f32_16x16x32_bf16 v[172:175], v[84:87], v[100:103], v[172:175]
    v_mfma_f32_16x16x32_bf16 v[176:179], v[92:95], v[100:103], v[176:179]
    v_mfma_f32_16x16x32_bf16 v[180:183], v[84:87], v[120:123], v[180:183]
    v_mfma_f32_16x16x32_bf16 v[160:163], v[84:87], v[108:111], v[160:163]
    v_mfma_f32_16x16x32_bf16 v[164:167], v[92:95], v[108:111], v[164:167]
    v_mfma_f32_16x16x32_bf16 v[168:171], v[92:95], v[120:123], v[168:171]
L_kvd:
    s_lshl_b32 s86, s47, 1
    s_add_u32 s86, s86, s50
    s_lshl_b32 s87, s86, 1
    s_add_u32 s87, s87, s49
    s_lshl_b32 s87, s87, 4
    s_add_u32 s87, s87, s46
    s_lshl_b32 s87, s87, 10
    s_add_u32 s87, s87, 5242880
    v_lshl_add_u32 v8, v0, 4, s87
    s_lshl_b32 s87, s86, 4
    s_add_u32 s87, s87, s46
    s_lshl_b32 s87, s87, 7
    s_lshl_b32 s88, s49, 6
    s_add_u32 s87, s87, s88
    s_add_u32 s87, s87, 7307264
    v_lshl_add_u32 v9, v21, 4, s87
    v_cmp_eq_u32 vcc, 0, v22
    v_mov_b32 v10, 2147483648
    s_nop 0
    v_cndmask_b32 v9, v10, v9, vcc
    ds_write_b128 v6, v[172:175] offset:0
    ds_write_b128 v6, v[176:179] offset:1024
    ds_write_b128 v6, v[180:183] offset:2048
    s_waitcnt lgkmcnt(0)
    s_barrier
    ds_read_b128 v[172:175], v7 offset:0
    ds_read_b128 v[176:179], v7 offset:1024
    ds_read_b128 v[180:183], v7 offset:2048
    s_lshl_b32 s87, s46, 3
    s_lshl_b32 s88, s49, 2
    s_add_u32 s87, s87, s88
    s_lshl_b32 s87, s87, 5
    s_add_u32 s87, s87, s86
    s_lshl_b32 s87, s87, 10
    s_add_u32 s87, s87, 1048576
    v_lshl_add_u32 v10, v0, 4, s87
    s_mul_i32 s87, s50, 3072
    s_add_u32 s87, s87, 28672
    v_lshl_add_u32 v11, v0, 4, s87
    s_waitcnt lgkmcnt(0)
    v_pk_add_f32 v[160:161], v[160:161], v[172:173]
    v_pk_add_f32 v[162:163], v[162:163], v[174:175]
    v_pk_add_f32 v[164:165], v[164:165], v[176:177]
    v_pk_add_f32 v[166:167], v[166:167], v[178:179]
    v_pk_add_f32 v[168:169], v[168:169], v[180:181]
    v_pk_add_f32 v[170:171], v[170:171], v[182:183]
    v_cvt_pk_bf16_f32 v184, v160, v161
    v_cvt_pk_bf16_f32 v185, v162, v163
    v_cvt_pk_bf16_f32 v186, v164, v165
    v_cvt_pk_bf16_f32 v187, v166, v167
    buffer_store_dwordx4 v[184:187], v8, s[16:19], 0 offen sc1
    buffer_store_dwordx4 v[168:171], v9, s[16:19], 0 offen sc1
    v_pk_fma_f32 v[128:129], v[28:29], v[240:241], v[128:129] op_sel_hi:[1,0,1]
    v_pk_mul_f32 v[112:113], v[128:129], v[248:249] op_sel_hi:[1,0]
    v_pk_fma_f32 v[128:129], v[128:129], v[244:245], s[54:55] op_sel_hi:[1,0,1]
    v_exp_f32 v112, v112 clamp
    v_exp_f32 v113, v113 clamp
    v_max_f32 v128, s54, v128
    v_max_f32 v129, s54, v129
    v_pk_add_f32 v[128:129], v[128:129], v[112:113]
    v_cvt_pk_bf16_f32 v80, v128, v129
    v_pk_fma_f32 v[130:131], v[30:31], v[240:241], v[130:131] op_sel_hi:[1,0,1]
    v_pk_mul_f32 v[114:115], v[130:131], v[248:249] op_sel_hi:[1,0]
    v_pk_fma_f32 v[130:131], v[130:131], v[244:245], s[54:55] op_sel_hi:[1,0,1]
    v_exp_f32 v114, v114 clamp
    v_exp_f32 v115, v115 clamp
    v_max_f32 v130, s54, v130
    v_max_f32 v131, s54, v131
    v_pk_add_f32 v[130:131], v[130:131], v[114:115]
    v_cvt_pk_bf16_f32 v81, v130, v131
    v_pk_fma_f32 v[144:145], v[32:33], v[240:241], v[144:145] op_sel_hi:[1,0,1]
    v_pk_mul_f32 v[116:117], v[144:145], v[248:249] op_sel_hi:[1,0]
    v_pk_fma_f32 v[144:145], v[144:145], v[244:245], s[54:55] op_sel_hi:[1,0,1]
    v_exp_f32 v116, v116 clamp
    v_exp_f32 v117, v117 clamp
    v_max_f32 v144, s54, v144
    v_max_f32 v145, s54, v145
    v_pk_add_f32 v[144:145], v[144:145], v[116:117]
    v_cvt_pk_bf16_f32 v82, v144, v145
    v_pk_fma_f32 v[146:147], v[34:35], v[240:241], v[146:147] op_sel_hi:[1,0,1]
    v_pk_mul_f32 v[118:119], v[146:147], v[248:249] op_sel_hi:[1,0]
    v_pk_fma_f32 v[146:147], v[146:147], v[244:245], s[54:55] op_sel_hi:[1,0,1]
    v_exp_f32 v118, v118 clamp
    v_exp_f32 v119, v119 clamp
    v_max_f32 v146, s54, v146
    v_max_f32 v147, s54, v147
    v_pk_add_f32 v[146:147], v[146:147], v[118:119]
    v_cvt_pk_bf16_f32 v83, v146, v147
    v_pk_fma_f32 v[132:133], v[28:29], v[240:241], v[132:133] op_sel:[0,1,0] op_sel_hi:[1,1,1]
    v_pk_mul_f32 v[112:113], v[132:133], v[248:249] op_sel:[0,1] op_sel_hi:[1,1]
    v_pk_fma_f32 v[132:133], v[132:133], v[244:245], s[54:55] op_sel:[0,1,0] op_sel_hi:[1,1,1]
    v_exp_f32 v112, v112 clamp
    v_exp_f32 v113, v113 clamp
    v_max_f32 v132, s54, v132
    v_max_f32 v133, s54, v133
    v_pk_add_f32 v[132:133], v[132:133], v[112:113]
    v_cvt_pk_bf16_f32 v84, v132, v133
    v_pk_fma_f32 v[134:135], v[30:31], v[240:241], v[134:135] op_sel:[0,1,0] op_sel_hi:[1,1,1]
    v_pk_mul_f32 v[114:115], v[134:135], v[248:249] op_sel:[0,1] op_sel_hi:[1,1]
    v_pk_fma_f32 v[134:135], v[134:135], v[244:245], s[54:55] op_sel:[0,1,0] op_sel_hi:[1,1,1]
    v_exp_f32 v114, v114 clamp
    v_exp_f32 v115, v115 clamp
    v_max_f32 v134, s54, v134
    v_max_f32 v135, s54, v135
    v_pk_add_f32 v[134:135], v[134:135], v[114:115]
    v_cvt_pk_bf16_f32 v85, v134, v135
    v_pk_fma_f32 v[148:149], v[32:33], v[240:241], v[148:149] op_sel:[0,1,0] op_sel_hi:[1,1,1]
    v_pk_mul_f32 v[116:117], v[148:149], v[248:249] op_sel:[0,1] op_sel_hi:[1,1]
    v_pk_fma_f32 v[148:149], v[148:149], v[244:245], s[54:55] op_sel:[0,1,0] op_sel_hi:[1,1,1]
    v_exp_f32 v116, v116 clamp
    v_exp_f32 v117, v117 clamp
    v_max_f32 v148, s54, v148
    v_max_f32 v149, s54, v149
    v_pk_add_f32 v[148:149], v[148:149], v[116:117]
    v_cvt_pk_bf16_f32 v86, v148, v149
    v_pk_fma_f32 v[150:151], v[34:35], v[240:241], v[150:151] op_sel:[0,1,0] op_sel_hi:[1,1,1]
    v_pk_mul_f32 v[118:119], v[150:151], v[248:249] op_sel:[0,1] op_sel_hi:[1,1]
    v_pk_fma_f32 v[150:151], v[150:151], v[244:245], s[54:55] op_sel:[0,1,0] op_sel_hi:[1,1,1]
    v_exp_f32 v118, v118 clamp
    v_exp_f32 v119, v119 clamp
    v_max_f32 v150, s54, v150
    v_max_f32 v151, s54, v151
    v_pk_add_f32 v[150:151], v[150:151], v[118:119]
    v_cvt_pk_bf16_f32 v87, v150, v151
    v_pk_fma_f32 v[136:137], v[28:29], v[242:243], v[136:137] op_sel_hi:[1,0,1]
    v_pk_mul_f32 v[112:113], v[136:137], v[250:251] op_sel_hi:[1,0]
    v_pk_fma_f32 v[136:137], v[136:137], v[246:247], s[54:55] op_sel_hi:[1,0,1]
    v_exp_f32 v112, v112 clamp
    v_exp_f32 v113, v113 clamp
    v_max_f32 v136, s54, v136
    v_max_f32 v137, s54, v137
    v_pk_add_f32 v[136:137], v[136:137], v[112:113]
    v_cvt_pk_bf16_f32 v88, v136, v137
    v_pk_fma_f32 v[138:139], v[30:31], v[242:243], v[138:139] op_sel_hi:[1,0,1]
    v_pk_mul_f32 v[114:115], v[138:139], v[250:251] op_sel_hi:[1,0]
    v_pk_fma_f32 v[138:139], v[138:139], v[246:247], s[54:55] op_sel_hi:[1,0,1]
    v_exp_f32 v114, v114 clamp
    v_exp_f32 v115, v115 clamp
    v_max_f32 v138, s54, v138
    v_max_f32 v139, s54, v139
    v_pk_add_f32 v[138:139], v[138:139], v[114:115]
    v_cvt_pk_bf16_f32 v89, v138, v139
    v_pk_fma_f32 v[152:153], v[32:33], v[242:243], v[152:153] op_sel_hi:[1,0,1]
    v_pk_mul_f32 v[116:117], v[152:153], v[250:251] op_sel_hi:[1,0]
    v_pk_fma_f32 v[152:153], v[152:153], v[246:247], s[54:55] op_sel_hi:[1,0,1]
    v_exp_f32 v116, v116 clamp
    v_exp_f32 v117, v117 clamp
    v_max_f32 v152, s54, v152
    v_max_f32 v153, s54, v153
    v_pk_add_f32 v[152:153], v[152:153], v[116:117]
    v_cvt_pk_bf16_f32 v90, v152, v153
    v_pk_fma_f32 v[154:155], v[34:35], v[242:243], v[154:155] op_sel_hi:[1,0,1]
    v_pk_mul_f32 v[118:119], v[154:155], v[250:251] op_sel_hi:[1,0]
    v_pk_fma_f32 v[154:155], v[154:155], v[246:247], s[54:55] op_sel_hi:[1,0,1]
    v_exp_f32 v118, v118 clamp
    v_exp_f32 v119, v119 clamp
    v_max_f32 v154, s54, v154
    v_max_f32 v155, s54, v155
    v_pk_add_f32 v[154:155], v[154:155], v[118:119]
    v_cvt_pk_bf16_f32 v91, v154, v155
    v_pk_fma_f32 v[140:141], v[28:29], v[242:243], v[140:141] op_sel:[0,1,0] op_sel_hi:[1,1,1]
    v_pk_mul_f32 v[112:113], v[140:141], v[250:251] op_sel:[0,1] op_sel_hi:[1,1]
    v_pk_fma_f32 v[140:141], v[140:141], v[246:247], s[54:55] op_sel:[0,1,0] op_sel_hi:[1,1,1]
    v_exp_f32 v112, v112 clamp
    v_exp_f32 v113, v113 clamp
    v_max_f32 v140, s54, v140
    v_max_f32 v141, s54, v141
    v_pk_add_f32 v[140:141], v[140:141], v[112:113]
    v_cvt_pk_bf16_f32 v92, v140, v141
    v_pk_fma_f32 v[142:143], v[30:31], v[242:243], v[142:143] op_sel:[0,1,0] op_sel_hi:[1,1,1]
    v_pk_mul_f32 v[114:115], v[142:143], v[250:251] op_sel:[0,1] op_sel_hi:[1,1]
    v_pk_fma_f32 v[142:143], v[142:143], v[246:247], s[54:55] op_sel:[0,1,0] op_sel_hi:[1,1,1]
    v_exp_f32 v114, v114 clamp
    v_exp_f32 v115, v115 clamp
    v_max_f32 v142, s54, v142
    v_max_f32 v143, s54, v143
    v_pk_add_f32 v[142:143], v[142:143], v[114:115]
    v_cvt_pk_bf16_f32 v93, v142, v143
    v_pk_fma_f32 v[156:157], v[32:33], v[242:243], v[156:157] op_sel:[0,1,0] op_sel_hi:[1,1,1]
    v_pk_mul_f32 v[116:117], v[156:157], v[250:251] op_sel:[0,1] op_sel_hi:[1,1]
    v_pk_fma_f32 v[156:157], v[156:157], v[246:247], s[54:55] op_sel:[0,1,0] op_sel_hi:[1,1,1]
    v_exp_f32 v116, v116 clamp
    v_exp_f32 v117, v117 clamp
    v_max_f32 v156, s54, v156
    v_max_f32 v157, s54, v157
    v_pk_add_f32 v[156:157], v[156:157], v[116:117]
    v_cvt_pk_bf16_f32 v94, v156, v157
    v_pk_fma_f32 v[158:159], v[34:35], v[242:243], v[158:159] op_sel:[0,1,0] op_sel_hi:[1,1,1]
    v_pk_mul_f32 v[118:119], v[158:159], v[250:251] op_sel:[0,1] op_sel_hi:[1,1]
    v_pk_fma_f32 v[158:159], v[158:159], v[246:247], s[54:55] op_sel:[0,1,0] op_sel_hi:[1,1,1]
    v_exp_f32 v118, v118 clamp
    v_exp_f32 v119, v119 clamp
    v_max_f32 v158, s54, v158
    v_max_f32 v159, s54, v159
    v_pk_add_f32 v[158:159], v[158:159], v[118:119]
    v_cvt_pk_bf16_f32 v95, v158, v159
    s_barrier
    ds_read_b128 v[40:43], v11 offset:0
    ds_read_b128 v[44:47], v11 offset:1024
    ds_read_b128 v[48:51], v11 offset:2048
    s_mov_b32 s86, 0x8000
    s_mov_b32 s87, 0x10000
    s_mov_b32 s88, 0x18000
    s_waitcnt lgkmcnt(0)
    s_barrier
    v_mfma_f32_16x16x32_bf16 v[136:139], v[48:51], v[80:83], 0
    v_mfma_f32_16x16x32_bf16 v[128:131], v[40:43], v[80:83], 0
    v_mfma_f32_16x16x32_bf16 v[132:135], v[44:47], v[80:83], 0
    v_mfma_f32_16x16x32_bf16 v[148:151], v[48:51], v[84:87], 0
    v_mfma_f32_16x16x32_bf16 v[140:143], v[40:43], v[84:87], 0
    v_mfma_f32_16x16x32_bf16 v[144:147], v[44:47], v[84:87], 0
    v_mfma_f32_16x16x32_bf16 v[160:163], v[48:51], v[88:91], 0
    v_mfma_f32_16x16x32_bf16 v[152:155], v[40:43], v[88:91], 0
    v_mfma_f32_16x16x32_bf16 v[156:159], v[44:47], v[88:91], 0
    v_mfma_f32_16x16x32_bf16 v[172:175], v[48:51], v[92:95], 0
    v_mfma_f32_16x16x32_bf16 v[164:167], v[40:43], v[92:95], 0
    v_mfma_f32_16x16x32_bf16 v[168:171], v[44:47], v[92:95], 0
    v_add_f32 v136, s54, v136
    v_rcp_f32 v136, v136
    s_nop 0
    v_pk_mul_f32 v[128:129], v[128:129], v[136:137] op_sel_hi:[1,0]
    v_pk_mul_f32 v[130:131], v[130:131], v[136:137] op_sel_hi:[1,0]
    v_pk_mul_f32 v[132:133], v[132:133], v[136:137] op_sel_hi:[1,0]
    v_pk_mul_f32 v[134:135], v[134:135], v[136:137] op_sel_hi:[1,0]
    v_cvt_pk_bf16_f32 v60, v128, v129
    v_cvt_pk_bf16_f32 v61, v130, v131
    v_cvt_pk_bf16_f32 v62, v132, v133
    v_cvt_pk_bf16_f32 v63, v134, v135
    buffer_store_dwordx4 v[60:63], v10, s[16:19], 0 offen sc1
    v_add_f32 v148, s54, v148
    v_rcp_f32 v148, v148
    s_nop 0
    v_pk_mul_f32 v[140:141], v[140:141], v[148:149] op_sel_hi:[1,0]
    v_pk_mul_f32 v[142:143], v[142:143], v[148:149] op_sel_hi:[1,0]
    v_pk_mul_f32 v[144:145], v[144:145], v[148:149] op_sel_hi:[1,0]
    v_pk_mul_f32 v[146:147], v[146:147], v[148:149] op_sel_hi:[1,0]
    v_cvt_pk_bf16_f32 v64, v140, v141
    v_cvt_pk_bf16_f32 v65, v142, v143
    v_cvt_pk_bf16_f32 v66, v144, v145
    v_cvt_pk_bf16_f32 v67, v146, v147
    buffer_store_dwordx4 v[64:67], v10, s[16:19], s86 offen sc1
    v_add_f32 v160, s54, v160
    v_rcp_f32 v160, v160
    s_nop 0
    v_pk_mul_f32 v[152:153], v[152:153], v[160:161] op_sel_hi:[1,0]
    v_pk_mul_f32 v[154:155], v[154:155], v[160:161] op_sel_hi:[1,0]
    v_pk_mul_f32 v[156:157], v[156:157], v[160:161] op_sel_hi:[1,0]
    v_pk_mul_f32 v[158:159], v[158:159], v[160:161] op_sel_hi:[1,0]
    v_cvt_pk_bf16_f32 v68, v152, v153
    v_cvt_pk_bf16_f32 v69, v154, v155
    v_cvt_pk_bf16_f32 v70, v156, v157
    v_cvt_pk_bf16_f32 v71, v158, v159
    buffer_store_dwordx4 v[68:71], v10, s[16:19], s87 offen sc1
    v_add_f32 v172, s54, v172
    v_rcp_f32 v172, v172
    s_nop 0
    v_pk_mul_f32 v[164:165], v[164:165], v[172:173] op_sel_hi:[1,0]
    v_pk_mul_f32 v[166:167], v[166:167], v[172:173] op_sel_hi:[1,0]
    v_pk_mul_f32 v[168:169], v[168:169], v[172:173] op_sel_hi:[1,0]
    v_pk_mul_f32 v[170:171], v[170:171], v[172:173] op_sel_hi:[1,0]
    v_cvt_pk_bf16_f32 v72, v164, v165
    v_cvt_pk_bf16_f32 v73, v166, v167
    v_cvt_pk_bf16_f32 v74, v168, v169
    v_cvt_pk_bf16_f32 v75, v170, v171
    buffer_store_dwordx4 v[72:75], v10, s[16:19], s88 offen sc1
L_phaseB:
    s_lshr_b32 s62, s3, 2
    s_lshl_b32 s53, s51, 3
    s_lshl_b32 s86, s48, 1
    s_add_u32 s53, s53, s86
    s_add_u32 s53, s53, s62
    v_lshrrev_b32 v1, 4, v0
    v_and_b32 v2, 15, v0
    v_lshlrev_b32 v3, 4, v0
    buffer_load_dwordx4 v[112:115], v3, s[40:43], 0 offen
    buffer_load_dwordx4 v[116:119], v3, s[40:43], 0 offen offset:1024
    s_lshl_b32 s86, s52, 7
    v_lshl_add_u32 v4, v1, 3, s86
    buffer_load_dwordx2 v[148:149], v4, s[40:43], 0 offen offset:0
    buffer_load_dwordx2 v[150:151], v4, s[40:43], 0 offen offset:32
    buffer_load_dwordx2 v[152:153], v4, s[40:43], 0 offen offset:64
    buffer_load_dwordx2 v[154:155], v4, s[40:43], 0 offen offset:96
    s_lshl_b32 s87, s53, 4
    v_add_u32 v6, s87, v2
    v_lshlrev_b32 v5, 11, v6
    v_sub_u32 v6, 2047, v6
    v_add_u32 v7, v5, v4
    v_add_u32 v5, s86, v5
    v_lshrrev_b32 v8, 1, v1
    v_and_b32 v9, 1, v1
    v_lshl_add_u32 v8, v9, 1, v8
    v_lshl_add_u32 v5, v8, 4, v5
    s_lshl_b32 s86, s53, 15
    s_lshl_b32 s87, s62, 14
    s_add_u32 s86, s86, s87
    s_add_u32 s86, s86, 1048576
    v_lshl_add_u32 v157, v0, 4, s86
    v_xor_b32 v158, 0x8000, v157
    s_and_b32 s86, s86, 0xffff7fff
    s_add_u32 s86, s86, 1020
    v_lshl_add_u32 v159, v2, 10, s86
    v_lshl_add_u32 v159, v9, 15, v159
    v_bfe_u32 v8, v0, 2, 2
    v_lshl_add_u32 v8, v1, 2, v8
    v_bfe_u32 v9, v8, 1, 2
    v_lshlrev_b32 v8, 7, v8
    v_lshl_add_u32 v8, v9, 5, v8
    v_and_b32 v9, 3, v0
    v_lshl_add_u32 v8, v9, 3, v8
    s_lshl_b32 s86, s62, 16
    s_add_u32 s86, s86, 40960
    v_add_u32 v10, s86, v8
    s_cmp_eq_u32 s62, 0
    s_cselect_b32 s86, 90112, 0
    v_add_u32 v11, s86, v8
    v_cmp_eq_u32 s[4:5], 1, v9
    v_cmp_eq_u32 s[6:7], 2, v9
    v_cmp_eq_u32 s[98:99], 3, v9
    s_lshl_b32 s86, s53, 12
    s_add_u32 s86, s86, 6291456
    v_lshl_add_u32 v160, v0, 4, s86
    s_lshl_b32 s87, s52, 8
    s_add_u32 s86, s86, s87
    v_lshl_add_u32 v161, v2, 4, s86
    v_lshrrev_b32 v8, 2, v2
    v_cmp_eq_u32 vcc, v8, v1
    v_mov_b32 v8, 2147483648
    s_nop 0
    v_cndmask_b32 v161, v8, v161, vcc
    s_lshl_b32 s86, s3, 12
    s_cmp_ge_u32 s3, 6
    s_cselect_b32 s87, 114688, 0
    s_add_u32 s86, s86, s87
    s_add_u32 s86, s86, 16384
    v_lshl_add_u32 v162, v0, 4, s86
    s_xor_b32 s88, s3, 4
    s_lshl_b32 s86, s88, 12
    s_cmp_ge_u32 s88, 6
    s_cselect_b32 s87, 114688, 0
    s_add_u32 s86, s86, s87
    s_add_u32 s86, s86, 16384
    v_lshl_add_u32 v163, v0, 4, s86
    s_waitcnt vmcnt(0)
    v_mov_b32 v8, 0
    v_dot2c_f32_bf16 v8, s95, v112
    v_dot2c_f32_bf16 v8, s95, v113
    v_dot2c_f32_bf16 v8, s95, v114
    v_dot2c_f32_bf16 v8, s95, v115
    v_dot2c_f32_bf16 v8, s95, v116
    v_dot2c_f32_bf16 v8, s95, v117
    v_dot2c_f32_bf16 v8, s95, v118
    v_dot2c_f32_bf16 v8, s95, v119
    v_cmp_eq_u32 vcc, 0, v9
    v_mov_b32 v12, s95
    s_nop 0
    v_cndmask_b32 v12, 0, v12, vcc
    v_cndmask_b32 v148, v12, v148, s[4:5]
    v_cndmask_b32 v149, v12, v149, s[4:5]
    v_cndmask_b32 v150, v12, v150, s[4:5]
    v_cndmask_b32 v151, v12, v151, s[4:5]
    v_cndmask_b32 v152, v12, v152, s[4:5]
    v_cndmask_b32 v153, v12, v153, s[4:5]
    v_cndmask_b32 v154, v12, v154, s[4:5]
    v_cndmask_b32 v155, v12, v155, s[4:5]
    v_add_f32_dpp v8, v8, v8 row_ror:8 row_mask:0xf bank_mask:0xf
    s_nop 1
    v_add_f32_dpp v8, v8, v8 row_ror:4 row_mask:0xf bank_mask:0xf
    s_nop 1
    v_add_f32_dpp v8, v8, v8 row_ror:2 row_mask:0xf bank_mask:0xf
    s_nop 1
    v_add_f32_dpp v8, v8, v8 row_ror:1 row_mask:0xf bank_mask:0xf
    v_mov_b32 v12, v8
    s_nop 1
    v_permlane32_swap_b32 v8, v12
    v_add_f32 v8, v8, v12
    v_mov_b32 v12, v8
    s_nop 1
    v_permlane16_swap_b32 v8, v12
    v_add_f32 v8, v8, v12
    s_nop 0
    v_readfirstlane_b32 s57, v8
L_b_restart:
    buffer_load_dwordx2 v[112:113], v7, s[8:11], 0 offen offset:0
    buffer_load_dwordx2 v[114:115], v7, s[8:11], 0 offen offset:32
    buffer_load_dwordx2 v[116:117], v7, s[8:11], 0 offen offset:64
    buffer_load_dwordx2 v[118:119], v7, s[8:11], 0 offen offset:96
    v_xor_b32 v144, 0, v10
    v_xor_b32 v145, 32, v10
    v_xor_b32 v146, 64, v10
    v_xor_b32 v147, 96, v10
    v_mov_b32 v96, 0
    v_mov_b32 v97, 0
    v_mov_b32 v98, 0
    v_mov_b32 v99, 0
    v_mov_b32 v100, 0
    v_mov_b32 v101, 0
    v_mov_b32 v102, 0
    v_mov_b32 v103, 0
    v_mov_b32 v104, 0
    v_mov_b32 v105, 0
    v_mov_b32 v106, 0
    v_mov_b32 v107, 0
    v_mov_b32 v108, 0
    v_mov_b32 v109, 0
    v_mov_b32 v110, 0
    v_mov_b32 v111, 0
    v_mov_b32 v156, 0
    s_waitcnt vmcnt(0)
    v_lshlrev_b32 v80, 16, v112
    v_and_b32 v81, 0xffff0000, v112
    v_lshlrev_b32 v82, 16, v113
    v_and_b32 v83, 0xffff0000, v113
    v_lshlrev_b32 v84, 16, v114
    v_and_b32 v85, 0xffff0000, v114
    v_lshlrev_b32 v86, 16, v115
    v_and_b32 v87, 0xffff0000, v115
    v_lshlrev_b32 v88, 16, v116
    v_and_b32 v89, 0xffff0000, v116
    v_lshlrev_b32 v90, 16, v117
    v_and_b32 v91, 0xffff0000, v117
    v_lshlrev_b32 v92, 16, v118
    v_and_b32 v93, 0xffff0000, v118
    v_lshlrev_b32 v94, 16, v119
    v_and_b32 v95, 0xffff0000, v119
L_b_poll:
    buffer_load_dword v8, v159, s[16:19], 0 offen sc1
    s_waitcnt vmcnt(0)
    v_cmp_eq_u32 vcc, -1, v8
    s_cbranch_vccz L_ok_2
    s_sub_u32 s56, s56, 1
    s_cbranch_scc0 L_b_poll
    s_mov_b32 s56, 0
L_ok_2:
    buffer_load_dwordx4 v[16:19], v157, s[16:19], 0 offen offset:0 sc1
    buffer_load_dwordx4 v[20:23], v158, s[16:19], 0 offen offset:0 sc1
    buffer_load_dwordx4 v[24:27], v157, s[16:19], 0 offen offset:1024 sc1
    buffer_load_dwordx4 v[28:31], v158, s[16:19], 0 offen offset:1024 sc1
    buffer_load_dwordx4 v[32:35], v157, s[16:19], 0 offen offset:2048 sc1
    buffer_load_dwordx4 v[36:39], v158, s[16:19], 0 offen offset:2048 sc1
    buffer_load_dwordx4 v[40:43], v157, s[16:19], 0 offen offset:3072 sc1
    buffer_load_dwordx4 v[44:47], v158, s[16:19], 0 offen offset:3072 sc1
    buffer_load_dwordx4 v[48:51], v157, s[16:19], s92 offen offset:0 sc1
    buffer_load_dwordx4 v[52:55], v158, s[16:19], s92 offen offset:0 sc1
    buffer_load_dwordx4 v[56:59], v157, s[16:19], s92 offen offset:1024 sc1
    buffer_load_dwordx4 v[60:63], v158, s[16:19], s92 offen offset:1024 sc1
    buffer_load_dwordx4 v[64:67], v157, s[16:19], s92 offen offset:2048 sc1
    buffer_load_dwordx4 v[68:71], v158, s[16:19], s92 offen offset:2048 sc1
    buffer_load_dwordx4 v[72:75], v157, s[16:19], s92 offen offset:3072 sc1
    buffer_load_dwordx4 v[76:79], v158, s[16:19], s92 offen offset:3072 sc1
    ds_read_b64_tr_b16 v[112:113], v144 offset:0
    ds_read_b64_tr_b16 v[114:115], v144 offset:2048
    ds_read_b64_tr_b16 v[116:117], v145 offset:0
    ds_read_b64_tr_b16 v[118:119], v145 offset:2048
    ds_read_b64_tr_b16 v[120:121], v146 offset:0
    ds_read_b64_tr_b16 v[122:123], v146 offset:2048
    ds_read_b64_tr_b16 v[124:125], v147 offset:0
    ds_read_b64_tr_b16 v[126:127], v147 offset:2048
    s_waitcnt vmcnt(14) lgkmcnt(0)
    v_max3_u32 v156, v156, v19, v23
    v_mfma_f32_16x16x32_bf16 v[80:83], v[112:115], v[16:19], v[80:83]
    ds_read_b64_tr_b16 v[128:129], v144 offset:4096
    v_mfma_f32_16x16x32_bf16 v[96:99], v[112:115], v[20:23], v[96:99]
    ds_read_b64_tr_b16 v[130:131], v144 offset:6144
    v_mfma_f32_16x16x32_bf16 v[84:87], v[116:119], v[16:19], v[84:87]
    ds_read_b64_tr_b16 v[132:133], v145 offset:4096
    v_mfma_f32_16x16x32_bf16 v[100:103], v[116:119], v[20:23], v[100:103]
    ds_read_b64_tr_b16 v[134:135], v145 offset:6144
    v_mfma_f32_16x16x32_bf16 v[88:91], v[120:123], v[16:19], v[88:91]
    ds_read_b64_tr_b16 v[136:137], v146 offset:4096
    v_mfma_f32_16x16x32_bf16 v[104:107], v[120:123], v[20:23], v[104:107]
    ds_read_b64_tr_b16 v[138:139], v146 offset:6144
    v_mfma_f32_16x16x32_bf16 v[92:95], v[124:127], v[16:19], v[92:95]
    ds_read_b64_tr_b16 v[140:141], v147 offset:4096
    v_mfma_f32_16x16x32_bf16 v[108:111], v[124:127], v[20:23], v[108:111]
    ds_read_b64_tr_b16 v[142:143], v147 offset:6144
    buffer_load_dwordx4 v[16:19], v157, s[16:19], s93 offen offset:0 sc1
    buffer_load_dwordx4 v[20:23], v158, s[16:19], s93 offen offset:0 sc1
    s_waitcnt vmcnt(14) lgkmcnt(0)
    v_max3_u32 v156, v156, v27, v31
    v_mfma_f32_16x16x32_bf16 v[80:83], v[128:131], v[24:27], v[80:83]
    ds_read_b64_tr_b16 v[112:113], v144 offset:8192
    v_mfma_f32_16x16x32_bf16 v[96:99], v[128:131], v[28:31], v[96:99]
    ds_read_b64_tr_b16 v[114:115], v144 offset:10240
    v_mfma_f32_16x16x32_bf16 v[84:87], v[132:135], v[24:27], v[84:87]
    ds_read_b64_tr_b16 v[116:117], v145 offset:8192
    v_mfma_f32_16x16x32_bf16 v[100:103], v[132:135], v[28:31], v[100:103]
    ds_read_b64_tr_b16 v[118:119], v145 offset:10240
    v_mfma_f32_16x16x32_bf16 v[88:91], v[136:139], v[24:27], v[88:91]
    ds_read_b64_tr_b16 v[120:121], v146 offset:8192
    v_mfma_f32_16x16x32_bf16 v[104:107], v[136:139], v[28:31], v[104:107]
    ds_read_b64_tr_b16 v[122:123], v146 offset:10240
    v_mfma_f32_16x16x32_bf16 v[92:95], v[140:143], v[24:27], v[92:95]
    ds_read_b64_tr_b16 v[124:125], v147 offset:8192
    v_mfma_f32_16x16x32_bf16 v[108:111], v[140:143], v[28:31], v[108:111]
    ds_read_b64_tr_b16 v[126:127], v147 offset:10240
    buffer_load_dwordx4 v[24:27], v157, s[16:19], s93 offen offset:1024 sc1
    buffer_load_dwordx4 v[28:31], v158, s[16:19], s93 offen offset:1024 sc1
    s_waitcnt vmcnt(14) lgkmcnt(0)
    v_max3_u32 v156, v156, v35, v39
    v_mfma_f32_16x16x32_bf16 v[80:83], v[112:115], v[32:35], v[80:83]
    ds_read_b64_tr_b16 v[128:129], v144 offset:12288
    v_mfma_f32_16x16x32_bf16 v[96:99], v[112:115], v[36:39], v[96:99]
    ds_read_b64_tr_b16 v[130:131], v144 offset:14336
    v_mfma_f32_16x16x32_bf16 v[84:87], v[116:119], v[32:35], v[84:87]
    ds_read_b64_tr_b16 v[132:133], v145 offset:12288
    v_mfma_f32_16x16x32_bf16 v[100:103], v[116:119], v[36:39], v[100:103]
    ds_read_b64_tr_b16 v[134:135], v145 offset:14336
    v_mfma_f32_16x16x32_bf16 v[88:91], v[120:123], v[32:35], v[88:91]
    ds_read_b64_tr_b16 v[136:137], v146 offset:12288
    v_mfma_f32_16x16x32_bf16 v[104:107], v[120:123], v[36:39], v[104:107]
    ds_read_b64_tr_b16 v[138:139], v146 offset:14336
    v_mfma_f32_16x16x32_bf16 v[92:95], v[124:127], v[32:35], v[92:95]
    ds_read_b64_tr_b16 v[140:141], v147 offset:12288
    v_mfma_f32_16x16x32_bf16 v[108:111], v[124:127], v[36:39], v[108:111]
    ds_read_b64_tr_b16 v[142:143], v147 offset:14336
    buffer_load_dwordx4 v[32:35], v157, s[16:19], s93 offen offset:2048 sc1
    buffer_load_dwordx4 v[36:39], v158, s[16:19], s93 offen offset:2048 sc1
    s_waitcnt vmcnt(14) lgkmcnt(0)
    v_max3_u32 v156, v156, v43, v47
    v_mfma_f32_16x16x32_bf16 v[80:83], v[128:131], v[40:43], v[80:83]
    ds_read_b64_tr_b16 v[112:113], v144 offset:16384
    v_mfma_f32_16x16x32_bf16 v[96:99], v[128:131], v[44:47], v[96:99]
    ds_read_b64_tr_b16 v[114:115], v144 offset:18432
    v_mfma_f32_16x16x32_bf16 v[84:87], v[132:135], v[40:43], v[84:87]
    ds_read_b64_tr_b16 v[116:117], v145 offset:16384
    v_mfma_f32_16x16x32_bf16 v[100:103], v[132:135], v[44:47], v[100:103]
    ds_read_b64_tr_b16 v[118:119], v145 offset:18432
    v_mfma_f32_16x16x32_bf16 v[88:91], v[136:139], v[40:43], v[88:91]
    ds_read_b64_tr_b16 v[120:121], v146 offset:16384
    v_mfma_f32_16x16x32_bf16 v[104:107], v[136:139], v[44:47], v[104:107]
    ds_read_b64_tr_b16 v[122:123], v146 offset:18432
    v_mfma_f32_16x16x32_bf16 v[92:95], v[140:143], v[40:43], v[92:95]
    ds_read_b64_tr_b16 v[124:125], v147 offset:16384
    v_mfma_f32_16x16x32_bf16 v[108:111], v[140:143], v[44:47], v[108:111]
    ds_read_b64_tr_b16 v[126:127], v147 offset:18432
    buffer_load_dwordx4 v[40:43], v157, s[16:19], s93 offen offset:3072 sc1
    buffer_load_dwordx4 v[44:47], v158, s[16:19], s93 offen offset:3072 sc1
    s_waitcnt vmcnt(14) lgkmcnt(0)
    v_max3_u32 v156, v156, v51, v55
    v_mfma_f32_16x16x32_bf16 v[80:83], v[112:115], v[48:51], v[80:83]
    ds_read_b64_tr_b16 v[128:129], v144 offset:20480
    v_mfma_f32_16x16x32_bf16 v[96:99], v[112:115], v[52:55], v[96:99]
    ds_read_b64_tr_b16 v[130:131], v144 offset:22528
    v_mfma_f32_16x16x32_bf16 v[84:87], v[116:119], v[48:51], v[84:87]
    ds_read_b64_tr_b16 v[132:133], v145 offset:20480
    v_mfma_f32_16x16x32_bf16 v[100:103], v[116:119], v[52:55], v[100:103]
    ds_read_b64_tr_b16 v[134:135], v145 offset:22528
    v_mfma_f32_16x16x32_bf16 v[88:91], v[120:123], v[48:51], v[88:91]
    ds_read_b64_tr_b16 v[136:137], v146 offset:20480
    v_mfma_f32_16x16x32_bf16 v[104:107], v[120:123], v[52:55], v[104:107]
    ds_read_b64_tr_b16 v[138:139], v146 offset:22528
    v_mfma_f32_16x16x32_bf16 v[92:95], v[124:127], v[48:51], v[92:95]
    ds_read_b64_tr_b16 v[140:141], v147 offset:20480
    v_mfma_f32_16x16x32_bf16 v[108:111], v[124:127], v[52:55], v[108:111]
    ds_read_b64_tr_b16 v[142:143], v147 offset:22528
    buffer_load_dwordx4 v[48:51], v157, s[16:19], s94 offen offset:0 sc1
    buffer_load_dwordx4 v[52:55], v158, s[16:19], s94 offen offset:0 sc1
    s_waitcnt vmcnt(14) lgkmcnt(0)
    v_max3_u32 v156, v156, v59, v63
    v_mfma_f32_16x16x32_bf16 v[80:83], v[128:131], v[56:59], v[80:83]
    ds_read_b64_tr_b16 v[112:113], v144 offset:24576
    v_mfma_f32_16x16x32_bf16 v[96:99], v[128:131], v[60:63], v[96:99]
    ds_read_b64_tr_b16 v[114:115], v144 offset:26624
    v_mfma_f32_16x16x32_bf16 v[84:87], v[132:135], v[56:59], v[84:87]
    ds_read_b64_tr_b16 v[116:117], v145 offset:24576
    v_mfma_f32_16x16x32_bf16 v[100:103], v[132:135], v[60:63], v[100:103]
    ds_read_b64_tr_b16 v[118:119], v145 offset:26624
    v_mfma_f32_16x16x32_bf16 v[88:91], v[136:139], v[56:59], v[88:91]
    ds_read_b64_tr_b16 v[120:121], v146 offset:24576
    v_mfma_f32_16x16x32_bf16 v[104:107], v[136:139], v[60:63], v[104:107]
    ds_read_b64_tr_b16 v[122:123], v146 offset:26624
    v_mfma_f32_16x16x32_bf16 v[92:95], v[140:143], v[56:59], v[92:95]
    ds_read_b64_tr_b16 v[124:125], v147 offset:24576
    v_mfma_f32_16x16x32_bf16 v[108:111], v[140:143], v[60:63], v[108:111]
    ds_read_b64_tr_b16 v[126:127], v147 offset:26624
    buffer_load_dwordx4 v[56:59], v157, s[16:19], s94 offen offset:1024 sc1
    buffer_load_dwordx4 v[60:63], v158, s[16:19], s94 offen offset:1024 sc1
    s_waitcnt vmcnt(14) lgkmcnt(0)
    v_max3_u32 v156, v156, v67, v71
    v_mfma_f32_16x16x32_bf16 v[80:83], v[112:115], v[64:67], v[80:83]
    ds_read_b64_tr_b16 v[128:129], v144 offset:28672
    v_mfma_f32_16x16x32_bf16 v[96:99], v[112:115], v[68:71], v[96:99]
    ds_read_b64_tr_b16 v[130:131], v144 offset:30720
    v_mfma_f32_16x16x32_bf16 v[84:87], v[116:119], v[64:67], v[84:87]
    ds_read_b64_tr_b16 v[132:133], v145 offset:28672
    v_mfma_f32_16x16x32_bf16 v[100:103], v[116:119], v[68:71], v[100:103]
    ds_read_b64_tr_b16 v[134:135], v145 offset:30720
    v_mfma_f32_16x16x32_bf16 v[88:91], v[120:123], v[64:67], v[88:91]
    ds_read_b64_tr_b16 v[136:137], v146 offset:28672
    v_mfma_f32_16x16x32_bf16 v[104:107], v[120:123], v[68:71], v[104:107]
    ds_read_b64_tr_b16 v[138:139], v146 offset:30720
    v_mfma_f32_16x16x32_bf16 v[92:95], v[124:127], v[64:67], v[92:95]
    ds_read_b64_tr_b16 v[140:141], v147 offset:28672
    v_mfma_f32_16x16x32_bf16 v[108:111], v[124:127], v[68:71], v[108:111]
    ds_read_b64_tr_b16 v[142:143], v147 offset:30720
    buffer_load_dwordx4 v[64:67], v157, s[16:19], s94 offen offset:2048 sc1
    buffer_load_dwordx4 v[68:71], v158, s[16:19], s94 offen offset:2048 sc1
    s_waitcnt vmcnt(14) lgkmcnt(0)
    v_max3_u32 v156, v156, v75, v79
    v_mfma_f32_16x16x32_bf16 v[80:83], v[128:131], v[72:75], v[80:83]
    ds_read_b64_tr_b16 v[112:113], v144 offset:32768
    v_mfma_f32_16x16x32_bf16 v[96:99], v[128:131], v[76:79], v[96:99]
    ds_read_b64_tr_b16 v[114:115], v144 offset:34816
    v_mfma_f32_16x16x32_bf16 v[84:87], v[132:135], v[72:75], v[84:87]
    ds_read_b64_tr_b16 v[116:117], v145 offset:32768
    v_mfma_f32_16x16x32_bf16 v[100:103], v[132:135], v[76:79], v[100:103]
    ds_read_b64_tr_b16 v[118:119], v145 offset:34816
    v_mfma_f32_16x16x32_bf16 v[88:91], v[136:139], v[72:75], v[88:91]
    ds_read_b64_tr_b16 v[120:121], v146 offset:32768
    v_mfma_f32_16x16x32_bf16 v[104:107], v[136:139], v[76:79], v[104:107]
    ds_read_b64_tr_b16 v[122:123], v146 offset:34816
    v_mfma_f32_16x16x32_bf16 v[92:95], v[140:143], v[72:75], v[92:95]
    ds_read_b64_tr_b16 v[124:125], v147 offset:32768
    v_mfma_f32_16x16x32_bf16 v[108:111], v[140:143], v[76:79], v[108:111]
    ds_read_b64_tr_b16 v[126:127], v147 offset:34816
    buffer_load_dwordx4 v[72:75], v157, s[16:19], s94 offen offset:3072 sc1
    buffer_load_dwordx4 v[76:79], v158, s[16:19], s94 offen offset:3072 sc1
    s_waitcnt vmcnt(14) lgkmcnt(0)
    v_max3_u32 v156, v156, v19, v23
    v_mfma_f32_16x16x32_bf16 v[80:83], v[112:115], v[16:19], v[80:83]
    ds_read_b64_tr_b16 v[128:129], v144 offset:36864
    v_mfma_f32_16x16x32_bf16 v[96:99], v[112:115], v[20:23], v[96:99]
    ds_read_b64_tr_b16 v[130:131], v144 offset:38912
    v_mfma_f32_16x16x32_bf16 v[84:87], v[116:119], v[16:19], v[84:87]
    ds_read_b64_tr_b16 v[132:133], v145 offset:36864
    v_mfma_f32_16x16x32_bf16 v[100:103], v[116:119], v[20:23], v[100:103]
    ds_read_b64_tr_b16 v[134:135], v145 offset:38912
    v_mfma_f32_16x16x32_bf16 v[88:91], v[120:123], v[16:19], v[88:91]
    ds_read_b64_tr_b16 v[136:137], v146 offset:36864
    v_mfma_f32_16x16x32_bf16 v[104:107], v[120:123], v[20:23], v[104:107]
    ds_read_b64_tr_b16 v[138:139], v146 offset:38912
    v_mfma_f32_16x16x32_bf16 v[92:95], v[124:127], v[16:19], v[92:95]
    ds_read_b64_tr_b16 v[140:141], v147 offset:36864
    v_mfma_f32_16x16x32_bf16 v[108:111], v[124:127], v[20:23], v[108:111]
    ds_read_b64_tr_b16 v[142:143], v147 offset:38912
    s_waitcnt vmcnt(12) lgkmcnt(0)
    v_max3_u32 v156, v156, v27, v31
    v_mfma_f32_16x16x32_bf16 v[80:83], v[128:131], v[24:27], v[80:83]
    ds_read_b64_tr_b16 v[112:113], v144 offset:40960
    v_mfma_f32_16x16x32_bf16 v[96:99], v[128:131], v[28:31], v[96:99]
    ds_read_b64_tr_b16 v[114:115], v144 offset:43008
    v_mfma_f32_16x16x32_bf16 v[84:87], v[132:135], v[24:27], v[84:87]
    ds_read_b64_tr_b16 v[116:117], v145 offset:40960
    v_mfma_f32_16x16x32_bf16 v[100:103], v[132:135], v[28:31], v[100:103]
    ds_read_b64_tr_b16 v[118:119], v145 offset:43008
    v_mfma_f32_16x16x32_bf16 v[88:91], v[136:139], v[24:27], v[88:91]
    ds_read_b64_tr_b16 v[120:121], v146 offset:40960
    v_mfma_f32_16x16x32_bf16 v[104:107], v[136:139], v[28:31], v[104:107]
    ds_read_b64_tr_b16 v[122:123], v146 offset:43008
    v_mfma_f32_16x16x32_bf16 v[92:95], v[140:143], v[24:27], v[92:95]
    ds_read_b64_tr_b16 v[124:125], v147 offset:40960
    v_mfma_f32_16x16x32_bf16 v[108:111], v[140:143], v[28:31], v[108:111]
    ds_read_b64_tr_b16 v[126:127], v147 offset:43008
    s_waitcnt vmcnt(10) lgkmcnt(0)
    v_max3_u32 v156, v156, v35, v39
    v_mfma_f32_16x16x32_bf16 v[80:83], v[112:115], v[32:35], v[80:83]
    ds_read_b64_tr_b16 v[128:129], v144 offset:45056
    v_mfma_f32_16x16x32_bf16 v[96:99], v[112:115], v[36:39], v[96:99]
    ds_read_b64_tr_b16 v[130:131], v144 offset:47104
    v_mfma_f32_16x16x32_bf16 v[84:87], v[116:119], v[32:35], v[84:87]
    ds_read_b64_tr_b16 v[132:133], v145 offset:45056
    v_mfma_f32_16x16x32_bf16 v[100:103], v[116:119], v[36:39], v[100:103]
    ds_read_b64_tr_b16 v[134:135], v145 offset:47104
    v_mfma_f32_16x16x32_bf16 v[88:91], v[120:123], v[32:35], v[88:91]
    ds_read_b64_tr_b16 v[136:137], v146 offset:45056
    v_mfma_f32_16x16x32_bf16 v[104:107], v[120:123], v[36:39], v[104:107]
    ds_read_b64_tr_b16 v[138:139], v146 offset:47104
    v_mfma_f32_16x16x32_bf16 v[92:95], v[124:127], v[32:35], v[92:95]
    ds_read_b64_tr_b16 v[140:141], v147 offset:45056
    v_mfma_f32_16x16x32_bf16 v[108:111], v[124:127], v[36:39], v[108:111]
    ds_read_b64_tr_b16 v[142:143], v147 offset:47104
    v_xor_b32 v144, 0, v11
    v_xor_b32 v145, 32, v11
    v_xor_b32 v146, 64, v11
    v_xor_b32 v147, 96, v11
    s_waitcnt vmcnt(8) lgkmcnt(0)
    v_max3_u32 v156, v156, v43, v47
    v_mfma_f32_16x16x32_bf16 v[80:83], v[128:131], v[40:43], v[80:83]
    ds_read_b64_tr_b16 v[112:113], v144 offset:0
    v_mfma_f32_16x16x32_bf16 v[96:99], v[128:131], v[44:47], v[96:99]
    ds_read_b64_tr_b16 v[114:115], v144 offset:2048
    v_mfma_f32_16x16x32_bf16 v[84:87], v[132:135], v[40:43], v[84:87]
    ds_read_b64_tr_b16 v[116:117], v145 offset:0
    v_mfma_f32_16x16x32_bf16 v[100:103], v[132:135], v[44:47], v[100:103]
    ds_read_b64_tr_b16 v[118:119], v145 offset:2048
    v_mfma_f32_16x16x32_bf16 v[88:91], v[136:139], v[40:43], v[88:91]
    ds_read_b64_tr_b16 v[120:121], v146 offset:0
    v_mfma_f32_16x16x32_bf16 v[104:107], v[136:139], v[44:47], v[104:107]
    ds_read_b64_tr_b16 v[122:123], v146 offset:2048
    v_mfma_f32_16x16x32_bf16 v[92:95], v[140:143], v[40:43], v[92:95]
    ds_read_b64_tr_b16 v[124:125], v147 offset:0
    v_mfma_f32_16x16x32_bf16 v[108:111], v[140:143], v[44:47], v[108:111]
    ds_read_b64_tr_b16 v[126:127], v147 offset:2048
    s_waitcnt vmcnt(6) lgkmcnt(0)
    v_max3_u32 v156, v156, v51, v55
    v_mfma_f32_16x16x32_bf16 v[80:83], v[112:115], v[48:51], v[80:83]
    ds_read_b64_tr_b16 v[128:129], v144 offset:4096
    v_mfma_f32_16x16x32_bf16 v[96:99], v[112:115], v[52:55], v[96:99]
    ds_read_b64_tr_b16 v[130:131], v144 offset:6144
    v_mfma_f32_16x16x32_bf16 v[84:87], v[116:119], v[48:51], v[84:87]
    ds_read_b64_tr_b16 v[132:133], v145 offset:4096
    v_mfma_f32_16x16x32_bf16 v[100:103], v[116:119], v[52:55], v[100:103]
    ds_read_b64_tr_b16 v[134:135], v145 offset:6144
    v_mfma_f32_16x16x32_bf16 v[88:91], v[120:123], v[48:51], v[88:91]
    ds_read_b64_tr_b16 v[136:137], v146 offset:4096
    v_mfma_f32_16x16x32_bf16 v[104:107], v[120:123], v[52:55], v[104:107]
    ds_read_b64_tr_b16 v[138:139], v146 offset:6144
    v_mfma_f32_16x16x32_bf16 v[92:95], v[124:127], v[48:51], v[92:95]
    ds_read_b64_tr_b16 v[140:141], v147 offset:4096
    v_mfma_f32_16x16x32_bf16 v[108:111], v[124:127], v[52:55], v[108:111]
    ds_read_b64_tr_b16 v[142:143], v147 offset:6144
    s_waitcnt vmcnt(4) lgkmcnt(0)
    v_max3_u32 v156, v156, v59, v63
    v_mfma_f32_16x16x32_bf16 v[80:83], v[128:131], v[56:59], v[80:83]
    ds_read_b64_tr_b16 v[112:113], v144 offset:8192
    v_mfma_f32_16x16x32_bf16 v[96:99], v[128:131], v[60:63], v[96:99]
    ds_read_b64_tr_b16 v[114:115], v144 offset:10240
    v_mfma_f32_16x16x32_bf16 v[84:87], v[132:135], v[56:59], v[84:87]
    ds_read_b64_tr_b16 v[116:117], v145 offset:8192
    v_mfma_f32_16x16x32_bf16 v[100:103], v[132:135], v[60:63], v[100:103]
    ds_read_b64_tr_b16 v[118:119], v145 offset:10240
    v_mfma_f32_16x16x32_bf16 v[88:91], v[136:139], v[56:59], v[88:91]
    ds_read_b64_tr_b16 v[120:121], v146 offset:8192
    v_mfma_f32_16x16x32_bf16 v[104:107], v[136:139], v[60:63], v[104:107]
    ds_read_b64_tr_b16 v[122:123], v146 offset:10240
    v_mfma_f32_16x16x32_bf16 v[92:95], v[140:143], v[56:59], v[92:95]
    ds_read_b64_tr_b16 v[124:125], v147 offset:8192
    v_mfma_f32_16x16x32_bf16 v[108:111], v[140:143], v[60:63], v[108:111]
    ds_read_b64_tr_b16 v[126:127], v147 offset:10240
    s_waitcnt vmcnt(2) lgkmcnt(0)
    v_max3_u32 v156, v156, v67, v71
    v_mfma_f32_16x16x32_bf16 v[80:83], v[112:115], v[64:67], v[80:83]
    ds_read_b64_tr_b16 v[128:129], v144 offset:12288
    v_mfma_f32_16x16x32_bf16 v[96:99], v[112:115], v[68:71], v[96:99]
    ds_read_b64_tr_b16 v[130:131], v144 offset:14336
    v_mfma_f32_16x16x32_bf16 v[84:87], v[116:119], v[64:67], v[84:87]
    ds_read_b64_tr_b16 v[132:133], v145 offset:12288
    v_mfma_f32_16x16x32_bf16 v[100:103], v[116:119], v[68:71], v[100:103]
    ds_read_b64_tr_b16 v[134:135], v145 offset:14336
    v_mfma_f32_16x16x32_bf16 v[88:91], v[120:123], v[64:67], v[88:91]
    ds_read_b64_tr_b16 v[136:137], v146 offset:12288
    v_mfma_f32_16x16x32_bf16 v[104:107], v[120:123], v[68:71], v[104:107]
    ds_read_b64_tr_b16 v[138:139], v146 offset:14336
    v_mfma_f32_16x16x32_bf16 v[92:95], v[124:127], v[64:67], v[92:95]
    ds_read_b64_tr_b16 v[140:141], v147 offset:12288
    v_mfma_f32_16x16x32_bf16 v[108:111], v[124:127], v[68:71], v[108:111]
    ds_read_b64_tr_b16 v[142:143], v147 offset:14336
    s_waitcnt vmcnt(0) lgkmcnt(0)
    v_max3_u32 v156, v156, v75, v79
    v_cmp_eq_u32 vcc, -1, v156
    s_cbranch_vccz L_ok_3
    s_sub_u32 s56, s56, 1
    s_cbranch_scc0 L_b_restart
    s_mov_b32 s56, 0
L_ok_3:
    v_mfma_f32_16x16x32_bf16 v[80:83], v[128:131], v[72:75], v[80:83]
    v_mfma_f32_16x16x32_bf16 v[96:99], v[128:131], v[76:79], v[96:99]
    v_mfma_f32_16x16x32_bf16 v[84:87], v[132:135], v[72:75], v[84:87]
    v_mfma_f32_16x16x32_bf16 v[100:103], v[132:135], v[76:79], v[100:103]
    v_mfma_f32_16x16x32_bf16 v[88:91], v[136:139], v[72:75], v[88:91]
    v_mfma_f32_16x16x32_bf16 v[104:107], v[136:139], v[76:79], v[104:107]
    v_mfma_f32_16x16x32_bf16 v[92:95], v[140:143], v[72:75], v[92:95]
    v_mfma_f32_16x16x32_bf16 v[108:111], v[140:143], v[76:79], v[108:111]
    s_nop 1
    ds_write_b128 v162, v[96:99] offset:0
    s_nop 0
    ds_write_b128 v162, v[100:103] offset:1024
    s_nop 0
    ds_write_b128 v162, v[104:107] offset:2048
    s_nop 0
    ds_write_b128 v162, v[108:111] offset:3072
    s_waitcnt lgkmcnt(0)
    s_barrier
    ds_read_b128 v[16:19], v163 offset:0
    ds_read_b128 v[20:23], v163 offset:1024
    ds_read_b128 v[24:27], v163 offset:2048
    ds_read_b128 v[28:31], v163 offset:3072
    s_waitcnt lgkmcnt(3)
    v_pk_add_f32 v[80:81], v[80:81], v[16:17]
    v_pk_add_f32 v[82:83], v[82:83], v[18:19]
    v_cvt_pk_bf16_f32 v32, v80, v81
    v_cvt_pk_bf16_f32 v33, v82, v83
    s_waitcnt lgkmcnt(2)
    v_pk_add_f32 v[84:85], v[84:85], v[20:21]
    v_pk_add_f32 v[86:87], v[86:87], v[22:23]
    v_cvt_pk_bf16_f32 v34, v84, v85
    v_cvt_pk_bf16_f32 v35, v86, v87
    s_waitcnt lgkmcnt(1)
    v_pk_add_f32 v[88:89], v[88:89], v[24:25]
    v_pk_add_f32 v[90:91], v[90:91], v[26:27]
    v_cvt_pk_bf16_f32 v36, v88, v89
    v_cvt_pk_bf16_f32 v37, v90, v91
    s_waitcnt lgkmcnt(0)
    v_pk_add_f32 v[92:93], v[92:93], v[28:29]
    v_pk_add_f32 v[94:95], v[94:95], v[30:31]
    v_cvt_pk_bf16_f32 v38, v92, v93
    v_cvt_pk_bf16_f32 v39, v94, v95
    v_mfma_f32_16x16x32_bf16 v[60:63], v[32:35], v[32:35], 0
    v_mfma_f32_16x16x32_bf16 v[56:59], v[148:151], v[32:35], 0
    v_mfma_f32_16x16x32_bf16 v[60:63], v[36:39], v[36:39], v[60:63]
    v_mfma_f32_16x16x32_bf16 v[56:59], v[152:155], v[36:39], v[56:59]
    v_lshlrev_b32 v40, 16, v32
    v_and_b32 v41, 0xffff0000, v32
    v_lshlrev_b32 v42, 16, v33
    v_and_b32 v43, 0xffff0000, v33
    v_lshlrev_b32 v44, 16, v34
    v_and_b32 v45, 0xffff0000, v34
    v_lshlrev_b32 v46, 16, v35
    v_and_b32 v47, 0xffff0000, v35
    v_cndmask_b32 v60, v60, v61, s[4:5]
    v_cndmask_b32 v60, v60, v62, s[6:7]
    v_cndmask_b32 v58, v60, v63, s[98:99]
    buffer_store_dwordx4 v[56:59], v161, s[16:19], 0 offen sc1
    v_lshlrev_b32 v48, 16, v36
    v_and_b32 v49, 0xffff0000, v36
    v_lshlrev_b32 v50, 16, v37
    v_and_b32 v51, 0xffff0000, v37
    v_lshlrev_b32 v52, 16, v38
    v_and_b32 v53, 0xffff0000, v38
    v_lshlrev_b32 v54, 16, v39
    v_and_b32 v55, 0xffff0000, v39
L_h3:
    buffer_load_dwordx4 v[64:67], v160, s[16:19], 0 offen offset:0 sc1
    buffer_load_dwordx4 v[68:71], v160, s[16:19], 0 offen offset:1024 sc1
    buffer_load_dwordx4 v[72:75], v160, s[16:19], 0 offen offset:2048 sc1
    buffer_load_dwordx4 v[76:79], v160, s[16:19], 0 offen offset:3072 sc1
    s_waitcnt vmcnt(0)
    v_max3_u32 v8, v66, v70, v74
    v_max_u32 v8, v8, v78
    v_cmp_eq_u32 vcc, -1, v8
    s_cbranch_vccz L_ok_4
    s_sub_u32 s56, s56, 1
    s_cbranch_scc0 L_h3
    s_mov_b32 s56, 0
L_ok_4:
    v_pk_add_f32 v[64:65], v[64:65], v[68:69]
    v_add_f32 v66, v66, v70
    v_pk_add_f32 v[72:73], v[72:73], v[76:77]
    v_add_f32 v74, v74, v78
    v_pk_add_f32 v[64:65], v[64:65], v[72:73]
    v_add_f32 v66, v66, v74
    v_mov_b32 v68, v64
    v_mov_b32 v69, v65
    v_mov_b32 v70, v66
    v_permlane32_swap_b32 v64, v68
    v_permlane32_swap_b32 v65, v69
    v_permlane32_swap_b32 v66, v70
    v_add_f32 v64, v64, v68
    v_add_f32 v65, v65, v69
    v_add_f32 v66, v66, v70
    v_mov_b32 v68, v64
    v_mov_b32 v69, v65
    v_mov_b32 v70, v66
    v_permlane16_swap_b32 v64, v68
    v_permlane16_swap_b32 v65, v69
    v_permlane16_swap_b32 v66, v70
    v_add_f32 v64, v64, v68
    v_add_f32 v65, v65, v69
    v_add_f32 v66, v66, v70
    v_mul_f32 v64, 0x3a800000, v64
    v_mul_f32 v66, 0x3a800000, v66
    v_fma_f32 v66, -v64, v64, v66
    v_max_f32 v66, 0, v66
    v_cvt_pk_bf16_f32 v69, v64, v66
    v_lshlrev_b32 v68, 16, v69
    v_and_b32 v69, 0xffff0000, v69
    v_add_f32 v69, 0x3727c5ac, v69
    v_cvt_pk_bf16_f32 v69, v69, v69
    v_lshlrev_b32 v69, 16, v69
    v_sqrt_f32 v69, v69
    s_nop 0
    v_cvt_pk_bf16_f32 v69, v69, v69
    v_lshlrev_b32 v69, 16, v69
    v_rcp_f32 v70, v69
    v_fma_f32 v12, -v68, s57, v65
    v_mul_f32 v12, v12, v70
    v_mul_f32 v72, -v68, v70
    v_ashrrev_i32 v8, 31, v12
    v_or_b32 v8, 0x80000000, v8
    v_xor_b32 v8, v8, v12
    v_and_b32 v8, 0xfffff800, v8
    v_or_b32 v13, v8, v6
    s_lshl_b32 s86, s3, 6
    s_add_u32 s86, s86, 65536
    v_lshl_add_u32 v8, v2, 2, s86
    ds_write_b32 v8, v13
    v_pk_fma_f32 v[16:17], v[40:41], v[70:71], v[72:73] op_sel_hi:[1,0,0]
    v_pk_fma_f32 v[18:19], v[42:43], v[70:71], v[72:73] op_sel_hi:[1,0,0]
    v_pk_fma_f32 v[20:21], v[44:45], v[70:71], v[72:73] op_sel_hi:[1,0,0]
    v_pk_fma_f32 v[22:23], v[46:47], v[70:71], v[72:73] op_sel_hi:[1,0,0]
    v_pk_fma_f32 v[24:25], v[48:49], v[70:71], v[72:73] op_sel_hi:[1,0,0]
    v_pk_fma_f32 v[26:27], v[50:51], v[70:71], v[72:73] op_sel_hi:[1,0,0]
    v_pk_fma_f32 v[28:29], v[52:53], v[70:71], v[72:73] op_sel_hi:[1,0,0]
    v_pk_fma_f32 v[30:31], v[54:55], v[70:71], v[72:73] op_sel_hi:[1,0,0]
    v_lshlrev_b32 v8, 3, v0
    v_add_u32 v8, 65536, v8
    s_waitcnt lgkmcnt(0)
    s_barrier
    ds_read_b64 v[64:65], v8
    v_cvt_pk_bf16_f32 v96, v16, v17
    v_cvt_pk_bf16_f32 v97, v18, v19
    v_cvt_pk_bf16_f32 v98, v20, v21
    v_cvt_pk_bf16_f32 v99, v22, v23
    v_cvt_pk_bf16_f32 v100, v24, v25
    v_cvt_pk_bf16_f32 v101, v26, v27
    v_cvt_pk_bf16_f32 v102, v28, v29
    v_cvt_pk_bf16_f32 v103, v30, v31
    s_waitcnt lgkmcnt(0)
    v_max_u32 v66, v64, v65
    v_min_u32 v67, v64, v65
    s_nop 0
    v_mov_b32_dpp v64, v66 row_ror:8 row_mask:0xf bank_mask:0xf
    v_max_u32_dpp v65, v67, v67 row_ror:8 row_mask:0xf bank_mask:0xf
    v_med3_u32 v67, v66, v64, v65
    v_max_u32 v66, v66, v64
    s_nop 1
    v_mov_b32_dpp v64, v66 row_ror:4 row_mask:0xf bank_mask:0xf
    v_max_u32_dpp v65, v67, v67 row_ror:4 row_mask:0xf bank_mask:0xf
    v_med3_u32 v67, v66, v64, v65
    v_max_u32 v66, v66, v64
    s_nop 1
    v_mov_b32_dpp v64, v66 row_ror:2 row_mask:0xf bank_mask:0xf
    v_max_u32_dpp v65, v67, v67 row_ror:2 row_mask:0xf bank_mask:0xf
    v_med3_u32 v67, v66, v64, v65
    v_max_u32 v66, v66, v64
    s_nop 1
    v_mov_b32_dpp v64, v66 row_ror:1 row_mask:0xf bank_mask:0xf
    v_max_u32_dpp v65, v67, v67 row_ror:1 row_mask:0xf bank_mask:0xf
    v_med3_u32 v67, v66, v64, v65
    v_max_u32 v66, v66, v64
    s_nop 0
    v_readlane_b32 s58, v66, 0
    v_readlane_b32 s59, v67, 0
    v_readlane_b32 s86, v66, 16
    v_readlane_b32 s87, v67, 16
    s_nop 0
    s_max_u32 s59, s59, s87
    s_min_u32 s87, s58, s86
    s_max_u32 s58, s58, s86
    s_max_u32 s59, s59, s87
    v_readlane_b32 s86, v66, 32
    v_readlane_b32 s87, v67, 32
    s_nop 0
    s_max_u32 s59, s59, s87
    s_min_u32 s87, s58, s86
    s_max_u32 s58, s58, s86
    s_max_u32 s59, s59, s87
    v_readlane_b32 s86, v66, 48
    v_readlane_b32 s87, v67, 48
    s_nop 0
    s_max_u32 s59, s59, s87
    s_min_u32 s87, s58, s86
    s_max_u32 s58, s58, s86
    s_max_u32 s59, s59, s87
    v_cmp_eq_u32 s[4:5], s58, v13
    v_cmp_eq_u32 s[6:7], s59, v13
    s_nop 0
    s_or_b64 s[96:97], s[4:5], s[6:7]
    s_cbranch_scc0 L_nocand
    s_lshl_b32 s86, s51, 12
    s_lshl_b32 s87, s52, 7
    s_add_u32 s86, s86, s87
    s_add_u32 s86, s86, 7372800
    v_lshl_add_u32 v8, v1, 3, s86
    v_add_u32 v9, 2048, v8
    v_cndmask_b32 v8, v8, v9, s[6:7]
    v_mov_b32 v9, 2147483648
    v_cndmask_b32 v8, v9, v8, s[96:97]
    buffer_store_dwordx2 v[96:97], v8, s[16:19], 0 offen offset:0 sc1
    buffer_store_dwordx2 v[98:99], v8, s[16:19], 0 offen offset:32 sc1
    buffer_store_dwordx2 v[100:101], v8, s[16:19], 0 offen offset:64 sc1
    buffer_store_dwordx2 v[102:103], v8, s[16:19], 0 offen offset:96 sc1
L_nocand:
    s_cmp_lg_u32 s3, 0
    s_cbranch_scc1 L_nokey
    s_lshl_b32 s86, s52, 7
    s_lshl_b32 s87, s51, 3
    s_add_u32 s86, s86, s87
    s_add_u32 s86, s86, 7438336
    v_mov_b32 v8, s86
    v_mov_b32 v9, 2147483648
    v_cmp_eq_u32 vcc, 0, v0
    s_nop 1
    v_cndmask_b32 v8, v9, v8, vcc
    v_mov_b32 v10, s58
    v_mov_b32 v11, s59
    buffer_store_dwordx2 v[10:11], v8, s[16:19], 0 offen sc1
L_nokey:
    s_bfe_u32 s86, s2, 0x20001
    s_lshl_b32 s86, s86, 2
    s_add_u32 s86, s86, s48
    s_lshl_b32 s86, s86, 7
    s_add_u32 s87, s86, 7438336
    v_and_b32 v8, 31, v0
    v_lshl_add_u32 v129, v8, 2, s87
    s_add_u32 s87, s86, 7372800
    v_and_b32 v8, 7, v0
    v_lshl_add_u32 v130, v8, 4, s87
    v_lshrrev_b32 v8, 3, v0
    v_lshl_add_u32 v130, v8, 11, v130
    s_mov_b32 s89, 0x4000
    s_mov_b32 s90, 0x8000
    s_mov_b32 s91, 0xc000
    s_cmp_lg_u64 s[96:97], 0
    s_cselect_b32 s63, 1, s62
    s_cmp_eq_u32 s63, 0
    s_cbranch_scc1 L_h4_skip1
    buffer_load_dword v128, v129, s[16:19], 0 offen sc1
    buffer_load_dwordx4 v[112:115], v130, s[16:19], 0 offen sc1
    buffer_load_dwordx4 v[116:119], v130, s[16:19], s89 offen sc1
    buffer_load_dwordx4 v[120:123], v130, s[16:19], s90 offen sc1
    buffer_load_dwordx4 v[124:127], v130, s[16:19], s91 offen sc1
L_h4_skip1:
    v_lshlrev_b32 v16, 16, v96
    v_and_b32 v17, 0xffff0000, v96
    v_lshlrev_b32 v18, 16, v97
    v_and_b32 v19, 0xffff0000, v97
    v_lshlrev_b32 v20, 16, v98
    v_and_b32 v21, 0xffff0000, v98
    v_lshlrev_b32 v22, 16, v99
    v_and_b32 v23, 0xffff0000, v99
    v_lshlrev_b32 v24, 16, v100
    v_and_b32 v25, 0xffff0000, v100
    v_lshlrev_b32 v26, 16, v101
    v_and_b32 v27, 0xffff0000, v101
    v_lshlrev_b32 v28, 16, v102
    v_and_b32 v29, 0xffff0000, v102
    v_lshlrev_b32 v30, 16, v103
    v_and_b32 v31, 0xffff0000, v103
    v_pk_add_f32 v[16:17], v[16:17], v[40:41]
    v_pk_add_f32 v[18:19], v[18:19], v[42:43]
    v_pk_add_f32 v[20:21], v[20:21], v[44:45]
    v_pk_add_f32 v[22:23], v[22:23], v[46:47]
    v_pk_add_f32 v[24:25], v[24:25], v[48:49]
    v_pk_add_f32 v[26:27], v[26:27], v[50:51]
    v_pk_add_f32 v[28:29], v[28:29], v[52:53]
    v_pk_add_f32 v[30:31], v[30:31], v[54:55]
    v_cvt_pk_bf16_f32 v104, v16, v17
    v_cvt_pk_bf16_f32 v105, v18, v19
    v_cvt_pk_bf16_f32 v106, v20, v21
    v_cvt_pk_bf16_f32 v107, v22, v23
    v_cvt_pk_bf16_f32 v108, v24, v25
    v_cvt_pk_bf16_f32 v109, v26, v27
    v_cvt_pk_bf16_f32 v110, v28, v29
    v_cvt_pk_bf16_f32 v111, v30, v31
    v_permlane16_swap_b32 v104, v106
    v_permlane16_swap_b32 v105, v107
    v_permlane16_swap_b32 v108, v110
    v_permlane16_swap_b32 v109, v111
    v_mov_b32 v9, 2147483648
    v_cndmask_b32 v8, v5, v9, s[96:97]
    buffer_store_dwordx4 v[104:107], v8, s[24:27], 0 offen
    buffer_store_dwordx4 v[108:111], v8, s[24:27], 0 offen offset:64
    s_cmp_eq_u32 s63, 0
    s_cbranch_scc1 L_fin
    s_cmp_eq_u64 s[96:97], 0
    s_cbranch_scc1 L_nostash
    v_lshlrev_b32 v8, 3, v1
    v_add_u32 v8, 98304, v8
    v_add_u32 v9, 512, v8
    v_cndmask_b32 v8, v8, v9, s[6:7]
    v_cvt_pk_bf16_f32 v9, v12, v12
    v_lshlrev_b32 v9, 16, v9
    s_mov_b64 exec, s[96:97]
    ds_write_b64 v8, v[32:33] offset:0
    ds_write_b64 v8, v[96:97] offset:128
    ds_write_b64 v8, v[34:35] offset:32
    ds_write_b64 v8, v[98:99] offset:160
    ds_write_b64 v8, v[36:37] offset:64
    ds_write_b64 v8, v[100:101] offset:192
    ds_write_b64 v8, v[38:39] offset:96
    ds_write_b64 v8, v[102:103] offset:224
    ds_write_b32 v8, v9 offset:256
    s_mov_b64 exec, -1
L_nostash:
    s_branch L_h4_chk
L_h4:
    buffer_load_dword v128, v129, s[16:19], 0 offen sc1
    buffer_load_dwordx4 v[112:115], v130, s[16:19], 0 offen sc1
    buffer_load_dwordx4 v[116:119], v130, s[16:19], s89 offen sc1
    buffer_load_dwordx4 v[120:123], v130, s[16:19], s90 offen sc1
    buffer_load_dwordx4 v[124:127], v130, s[16:19], s91 offen sc1
L_h4_chk:
    s_waitcnt vmcnt(0)
    v_max3_u32 v8, v128, v113, v115
    v_max3_u32 v8, v8, v117, v119
    v_max3_u32 v8, v8, v121, v123
    v_max3_u32 v8, v8, v125, v127
    v_cmp_eq_u32 vcc, -1, v8
    s_cbranch_vccz L_ok_5
    s_sub_u32 s56, s56, 1
    s_cbranch_scc0 L_h4
    s_mov_b32 s56, 0
L_ok_5:
    s_lshl_b32 s88, s48, 12
    s_add_u32 s88, s88, 69632
    s_cmp_eq_u32 s62, 0
    s_cbranch_scc1 L_noseg
    v_lshl_add_u32 v8, v0, 4, s88
    ds_write_b128 v8, v[112:115] offset:0
    ds_write_b128 v8, v[116:119] offset:1024
    ds_write_b128 v8, v[120:123] offset:2048
    ds_write_b128 v8, v[124:127] offset:3072
L_noseg:
    v_mov_b32 v64, v128
    v_mov_b32 v65, 0
    s_nop 0
    v_mov_b32_dpp v66, v64 row_ror:8 row_mask:0xf bank_mask:0xf
    v_max_u32_dpp v67, v65, v65 row_ror:8 row_mask:0xf bank_mask:0xf
    v_med3_u32 v65, v64, v66, v67
    v_max_u32 v64, v64, v66
    s_nop 1
    v_mov_b32_dpp v66, v64 row_ror:4 row_mask:0xf bank_mask:0xf
    v_max_u32_dpp v67, v65, v65 row_ror:4 row_mask:0xf bank_mask:0xf
    v_med3_u32 v65, v64, v66, v67
    v_max_u32 v64, v64, v66
    s_nop 1
    v_mov_b32_dpp v66, v64 row_ror:2 row_mask:0xf bank_mask:0xf
    v_max_u32_dpp v67, v65, v65 row_ror:2 row_mask:0xf bank_mask:0xf
    v_med3_u32 v65, v64, v66, v67
    v_max_u32 v64, v64, v66
    s_nop 1
    v_mov_b32_dpp v66, v64 row_ror:1 row_mask:0xf bank_mask:0xf
    v_max_u32_dpp v67, v65, v65 row_ror:1 row_mask:0xf bank_mask:0xf
    v_med3_u32 v65, v64, v66, v67
    v_max_u32 v64, v64, v66
    s_nop 0
    v_readlane_b32 s60, v64, 0
    v_readlane_b32 s61, v65, 0
    v_readlane_b32 s86, v64, 16
    v_readlane_b32 s87, v65, 16
    s_nop 0
    s_max_u32 s61, s61, s87
    s_min_u32 s87, s60, s86
    s_max_u32 s60, s60, s86
    s_max_u32 s61, s61, s87
    s_cmp_eq_u64 s[96:97], 0
    s_cbranch_scc1 L_nolost
    v_cmp_ne_u32 s[4:5], s60, v13
    v_cmp_ne_u32 s[6:7], s61, v13
    s_nop 0
    s_and_b64 s[4:5], s[4:5], s[6:7]
    s_and_b64 s[4:5], s[4:5], s[96:97]
    v_mov_b32 v9, 2147483648
    v_cndmask_b32 v8, v9, v5, s[4:5]
    buffer_store_dwordx4 v[104:107], v8, s[24:27], 0 offen
    buffer_store_dwordx4 v[108:111], v8, s[24:27], 0 offen offset:64
L_nolost:
    s_cmp_lg_u32 s62, 0
    s_cbranch_scc1 L_moe
    s_barrier
    s_barrier
    s_branch L_final
L_moe:
    v_cmp_eq_u32 vcc, s60, v128
    s_nop 0
    s_ff1_i32_b64 s86, vcc
    v_cmp_eq_u32 vcc, s61, v128
    s_nop 0
    s_ff1_i32_b64 s87, vcc
    s_lshl_b32 s86, s86, 7
    s_lshl_b32 s87, s87, 7
    v_bfe_u32 v8, v0, 3, 1
    v_cmp_eq_u32 vcc, 1, v8
    v_mov_b32 v9, s86
    v_mov_b32 v10, s87
    v_cndmask_b32 v9, v9, v10, vcc
    v_lshl_add_u32 v10, v1, 5, s88
    v_add_u32 v9, v9, v10
    s_waitcnt lgkmcnt(0)
    ds_read_b128 v[64:67], v9
    ds_read_b128 v[68:71], v9 offset:16
    v_and_b32 v10, 1, v0
    v_cmp_eq_u32 vcc, 1, v10
    v_mov_b32 v10, 0x0c0c0100
    v_mov_b32 v11, 0x01000c0c
    v_cndmask_b32 v16, v10, v11, vcc
    v_mov_b32 v10, 0x0c0c0302
    v_mov_b32 v11, 0x03020c0c
    v_cndmask_b32 v17, v10, v11, vcc
    v_bfe_u32 v10, v0, 1, 2
    v_mov_b32 v11, 0x0c0c0c0c
    v_cmp_eq_u32 vcc, 0, v10
    s_nop 1
    v_cndmask_b32 v72, v11, v16, vcc
    v_cndmask_b32 v76, v11, v17, vcc
    v_cmp_eq_u32 vcc, 1, v10
    s_nop 1
    v_cndmask_b32 v73, v11, v16, vcc
    v_cndmask_b32 v77, v11, v17, vcc
    v_cmp_eq_u32 vcc, 2, v10
    s_nop 1
    v_cndmask_b32 v74, v11, v16, vcc
    v_cndmask_b32 v78, v11, v17, vcc
    v_cmp_eq_u32 vcc, 3, v10
    s_nop 1
    v_cndmask_b32 v75, v11, v16, vcc
    v_cndmask_b32 v79, v11, v17, vcc
    s_lshl_b32 s86, s48, 10
    s_add_u32 s86, s86, 90112
    v_lshl_add_u32 v18, v0, 4, s86
    s_and_b32 s86, s2, 1
    s_lshl_b32 s86, s86, 2
    s_bfe_u32 s87, s2, 0x20001
    s_add_u32 s86, s86, s87
    s_mul_i32 s86, s86, 28672
    s_lshl_b32 s87, s45, 9
    s_add_u32 s86, s86, s87
    s_add_u32 s86, s86, 7077888
    s_cmp_ge_u32 s2, 224
    s_cselect_b32 s86, 2147483648, s86
    v_lshl_add_u32 v19, v2, 5, s86
    v_and_b32 v10, 1, v1
    v_lshl_add_u32 v19, v10, 4, v19
    v_lshrrev_b32 v11, 1, v1
    v_mul_u32_u24 v16, 14336, v11
    v_add_u32 v19, v19, v16
    s_waitcnt lgkmcnt(0)
    v_perm_b32 v80, v64, v64, v72
    v_perm_b32 v81, v64, v64, v73
    v_perm_b32 v82, v64, v64, v74
    v_perm_b32 v83, v64, v64, v75
    s_nop 1
    v_mfma_f32_16x16x32_bf16 v[88:91], v[80:83], v[164:167], 0
    v_perm_b32 v84, v64, v64, v76
    v_perm_b32 v85, v64, v64, v77
    v_perm_b32 v86, v64, v64, v78
    v_perm_b32 v87, v64, v64, v79
    s_nop 1
    v_mfma_f32_16x16x32_bf16 v[88:91], v[84:87], v[168:171], v[88:91]
    v_perm_b32 v80, v65, v65, v72
    v_perm_b32 v81, v65, v65, v73
    v_perm_b32 v82, v65, v65, v74
    v_perm_b32 v83, v65, v65, v75
    s_nop 1
    v_mfma_f32_16x16x32_bf16 v[88:91], v[80:83], v[172:175], v[88:91]
    v_perm_b32 v84, v65, v65, v76
    v_perm_b32 v85, v65, v65, v77
    v_perm_b32 v86, v65, v65, v78
    v_perm_b32 v87, v65, v65, v79
    s_nop 1
    v_mfma_f32_16x16x32_bf16 v[88:91], v[84:87], v[176:179], v[88:91]
    v_perm_b32 v80, v66, v66, v72
    v_perm_b32 v81, v66, v66, v73
    v_perm_b32 v82, v66, v66, v74
    v_perm_b32 v83, v66, v66, v75
    s_nop 1
    v_mfma_f32_16x16x32_bf16 v[88:91], v[80:83], v[180:183], v[88:91]
    v_perm_b32 v84, v66, v66, v76
    v_perm_b32 v85, v66, v66, v77
    v_perm_b32 v86, v66, v66, v78
    v_perm_b32 v87, v66, v66, v79
    s_nop 1
    v_mfma_f32_16x16x32_bf16 v[88:91], v[84:87], v[184:187], v[88:91]
    v_perm_b32 v80, v67, v67, v72
    v_perm_b32 v81, v67, v67, v73
    v_perm_b32 v82, v67, v67, v74
    v_perm_b32 v83, v67, v67, v75
    s_nop 1
    v_mfma_f32_16x16x32_bf16 v[88:91], v[80:83], v[188:191], v[88:91]
    v_perm_b32 v84, v67, v67, v76
    v_perm_b32 v85, v67, v67, v77
    v_perm_b32 v86, v67, v67, v78
    v_perm_b32 v87, v67, v67, v79
    s_nop 1
    v_mfma_f32_16x16x32_bf16 v[88:91], v[84:87], v[192:195], v[88:91]
    v_perm_b32 v80, v68, v68, v72
    v_perm_b32 v81, v68, v68, v73
    v_perm_b32 v82, v68, v68, v74
    v_perm_b32 v83, v68, v68, v75
    s_nop 1
    v_mfma_f32_16x16x32_bf16 v[88:91], v[80:83], v[196:199], v[88:91]
    v_perm_b32 v84, v68, v68, v76
    v_perm_b32 v85, v68, v68, v77
    v_perm_b32 v86, v68, v68, v78
    v_perm_b32 v87, v68, v68, v79
    s_nop 1
    v_mfma_f32_16x16x32_bf16 v[88:91], v[84:87], v[200:203], v[88:91]
    v_perm_b32 v80, v69, v69, v72
    v_perm_b32 v81, v69, v69, v73
    v_perm_b32 v82, v69, v69, v74
    v_perm_b32 v83, v69, v69, v75
    s_nop 1
    v_mfma_f32_16x16x32_bf16 v[88:91], v[80:83], v[204:207], v[88:91]
    v_perm_b32 v84, v69, v69, v76
    v_perm_b32 v85, v69, v69, v77
    v_perm_b32 v86, v69, v69, v78
    v_perm_b32 v87, v69, v69, v79
    s_nop 1
    v_mfma_f32_16x16x32_bf16 v[88:91], v[84:87], v[208:211], v[88:91]
    v_perm_b32 v80, v70, v70, v72
    v_perm_b32 v81, v70, v70, v73
    v_perm_b32 v82, v70, v70, v74
    v_perm_b32 v83, v70, v70, v75
    s_nop 1
    v_mfma_f32_16x16x32_bf16 v[88:91], v[80:83], v[212:215], v[88:91]
    v_perm_b32 v84, v70, v70, v76
    v_perm_b32 v85, v70, v70, v77
    v_perm_b32 v86, v70, v70, v78
    v_perm_b32 v87, v70, v70, v79
    s_nop 1
    v_mfma_f32_16x16x32_bf16 v[88:91], v[84:87], v[216:219], v[88:91]
    v_perm_b32 v80, v71, v71, v72
    v_perm_b32 v81, v71, v71, v73
    v_perm_b32 v82, v71, v71, v74
    v_perm_b32 v83, v71, v71, v75
    s_nop 1
    v_mfma_f32_16x16x32_bf16 v[88:91], v[80:83], v[220:223], v[88:91]
    v_perm_b32 v84, v71, v71, v76
    v_perm_b32 v85, v71, v71, v77
    v_perm_b32 v86, v71, v71, v78
    v_perm_b32 v87, v71, v71, v79
    s_nop 1
    v_mfma_f32_16x16x32_bf16 v[88:91], v[84:87], v[224:227], v[88:91]
    s_nop 7
    ds_write_b128 v18, v[88:91] offset:0
    s_waitcnt lgkmcnt(0)
    s_barrier
    s_cmp_lg_u32 s48, 0
    s_cbranch_scc1 L_gu_done
    ds_read_b128 v[20:23], v18 offset:1024
    ds_read_b128 v[24:27], v18 offset:2048
    ds_read_b128 v[28:31], v18 offset:3072
    s_waitcnt lgkmcnt(0)
    v_pk_add_f32 v[88:89], v[88:89], v[20:21]
    v_pk_add_f32 v[24:25], v[24:25], v[28:29]
    v_pk_add_f32 v[88:89], v[88:89], v[24:25]
    v_pk_add_f32 v[90:91], v[90:91], v[22:23]
    v_pk_add_f32 v[26:27], v[26:27], v[30:31]
    v_pk_add_f32 v[90:91], v[90:91], v[26:27]
    buffer_store_dwordx4 v[88:91], v19, s[16:19], 0 offen sc1
L_gu_done:
    s_mul_i32 s86, s45, 112
    s_mul_i32 s87, s48, 28
    s_add_u32 s86, s86, s87
    v_bfe_u32 v16, v0, 3, 2
    v_mul_u32_u24 v16, 7, v16
    v_and_b32 v17, 7, v0
    v_min_u32 v17, 6, v17
    v_add3_u32 v16, v16, v17, s86
    v_lshrrev_b32 v17, 5, v0
    v_mul_u32_u24 v17, 14336, v17
    v_lshl_add_u32 v16, v16, 2, v17
    v_add_u32 v16, 7077888, v16
    s_lshl_b32 s86, s45, 13
    s_lshl_b32 s87, s44, 9
    s_add_u32 s86, s86, s87
    s_add_u32 s86, s86, 6815744
    v_lshl_add_u32 v9, v2, 5, s86
    v_lshl_add_u32 v9, v10, 4, v9
    v_lshl_add_u32 v9, v11, 12, v9
    s_lshl_b32 s86, s48, 7
    s_add_u32 s86, s86, 100352
    v_lshl_add_u32 v10, v0, 1, s86
    v_lshl_add_u32 v11, v8, 6, s86
    v_lshl_add_u32 v11, v1, 4, v11
L_h5:
    s_mov_b32 s90, 0
    buffer_load_dword v24, v16, s[16:19], s90 offen sc1
    s_mov_b32 s90, 28672
    buffer_load_dword v25, v16, s[16:19], s90 offen sc1
    s_mov_b32 s90, 57344
    buffer_load_dword v26, v16, s[16:19], s90 offen sc1
    s_mov_b32 s90, 86016
    buffer_load_dword v27, v16, s[16:19], s90 offen sc1
    s_mov_b32 s90, 114688
    buffer_load_dword v28, v16, s[16:19], s90 offen sc1
    s_mov_b32 s90, 143360
    buffer_load_dword v29, v16, s[16:19], s90 offen sc1
    s_mov_b32 s90, 172032
    buffer_load_dword v30, v16, s[16:19], s90 offen sc1
    s_mov_b32 s90, 200704
    buffer_load_dword v31, v16, s[16:19], s90 offen sc1
    s_waitcnt vmcnt(0)
    v_max3_u32 v17, v24, v25, v26
    v_max3_u32 v17, v17, v27, v28
    v_max3_u32 v17, v17, v29, v30
    v_max_u32 v17, v17, v31
    v_cmp_eq_u32 vcc, -1, v17
    s_cbranch_vccz L_ok_6
    s_sub_u32 s56, s56, 1
    s_cbranch_scc0 L_h5
    s_mov_b32 s56, 0
L_ok_6:
    v_mov_b32 v19, v9
    v_add_f32 v24, v24, v25
    v_add_f32 v26, v26, v27
    v_add_f32 v28, v28, v29
    v_add_f32 v30, v30, v31
    v_add_f32 v24, v24, v26
    v_add_f32 v28, v28, v30
    v_cvt_pk_bf16_f32 v25, v24, v28
    v_lshlrev_b32 v24, 16, v25
    v_and_b32 v28, 0xffff0000, v25
    v_mul_f32 v25, 0xbfb8aa3b, v24
    v_exp_f32 v25, v25
    s_nop 0
    v_add_f32 v25, 1.0, v25
    v_rcp_f32 v25, v25
    s_nop 0
    v_mul_f32 v24, v24, v25
    v_cvt_pk_bf16_f32 v24, v24, v24
    v_lshlrev_b32 v24, 16, v24
    v_mul_f32 v24, v24, v28
    v_cvt_pk_bf16_f32 v24, v24, v24
    ds_write_b16 v10, v24
    s_waitcnt lgkmcnt(0)
    ds_read_b128 v[64:67], v11
    s_waitcnt lgkmcnt(0)
    v_perm_b32 v80, v64, v64, v72
    v_perm_b32 v81, v64, v64, v73
    v_perm_b32 v82, v64, v64, v74
    v_perm_b32 v83, v64, v64, v75
    s_nop 1
    v_mfma_f32_16x16x32_bf16 v[88:91], v[80:83], v[228:231], 0
    v_perm_b32 v84, v64, v64, v76
    v_perm_b32 v85, v64, v64, v77
    v_perm_b32 v86, v64, v64, v78
    v_perm_b32 v87, v64, v64, v79
    s_nop 1
    v_mfma_f32_16x16x32_bf16 v[88:91], v[84:87], v[232:235], v[88:91]
    v_perm_b32 v80, v65, v65, v72
    v_perm_b32 v81, v65, v65, v73
    v_perm_b32 v82, v65, v65, v74
    v_perm_b32 v83, v65, v65, v75
    s_nop 1
    v_mfma_f32_16x16x32_bf16 v[88:91], v[80:83], v[236:239], v[88:91]
    v_perm_b32 v84, v65, v65, v76
    v_perm_b32 v85, v65, v65, v77
    v_perm_b32 v86, v65, v65, v78
    v_perm_b32 v87, v65, v65, v79
    s_nop 1
    v_mfma_f32_16x16x32_bf16 v[88:91], v[84:87], v[240:243], v[88:91]
    v_perm_b32 v80, v66, v66, v72
    v_perm_b32 v81, v66, v66, v73
    v_perm_b32 v82, v66, v66, v74
    v_perm_b32 v83, v66, v66, v75
    s_nop 1
    v_mfma_f32_16x16x32_bf16 v[88:91], v[80:83], v[244:247], v[88:91]
    v_perm_b32 v84, v66, v66, v76
    v_perm_b32 v85, v66, v66, v77
    v_perm_b32 v86, v66, v66, v78
    v_perm_b32 v87, v66, v66, v79
    s_nop 1
    v_mfma_f32_16x16x32_bf16 v[88:91], v[84:87], v[248:251], v[88:91]
    v_perm_b32 v80, v67, v67, v72
    v_perm_b32 v81, v67, v67, v73
    v_perm_b32 v82, v67, v67, v74
    v_perm_b32 v83, v67, v67, v75
    s_nop 1
    v_mfma_f32_16x16x32_bf16 v[88:91], v[80:83], v[252:255], v[88:91]
    s_nop 7
    ds_write_b128 v18, v[88:91] offset:4096
    s_waitcnt lgkmcnt(0)
    s_barrier
    s_cmp_lg_u32 s48, 0
    s_cbranch_scc1 L_dn_done
    ds_read_b128 v[20:23], v18 offset:5120
    ds_read_b128 v[24:27], v18 offset:6144
    ds_read_b128 v[28:31], v18 offset:7168
    s_waitcnt lgkmcnt(0)
    v_pk_add_f32 v[88:89], v[88:89], v[20:21]
    v_pk_add_f32 v[24:25], v[24:25], v[28:29]
    v_pk_add_f32 v[88:89], v[88:89], v[24:25]
    v_pk_add_f32 v[90:91], v[90:91], v[22:23]
    v_pk_add_f32 v[26:27], v[26:27], v[30:31]
    v_pk_add_f32 v[90:91], v[90:91], v[26:27]
    buffer_store_dwordx4 v[88:91], v19, s[16:19], 0 offen sc1
L_dn_done:
L_final:
    s_cmp_eq_u64 s[96:97], 0
    s_cbranch_scc1 L_fin
    s_mov_b32 s63, 0
L_fin_loop:
    v_cmp_eq_u32 vcc, s60, v13
    s_cbranch_vccz L_fin_next
    s_cmp_eq_u32 s60, s58
    s_cselect_b32 s86, 0, 512
    s_add_u32 s86, s86, 98304
    v_lshl_add_u32 v8, v2, 3, s86
    v_mov_b32 v9, s86
    ds_read_b64 v[56:57], v8
    ds_read_b64 v[58:59], v8 offset:128
    ds_read_b32 v60, v9 offset:256
    s_lshl_b32 s86, s63, 12
    s_lshl_b32 s87, s52, 8
    s_add_u32 s86, s86, s87
    s_add_u32 s86, s86, 6815744
    v_lshl_add_u32 v10, v2, 4, s86
    v_lshl_add_u32 v10, v1, 13, v10
    s_and_b32 s86, s60, 0x7ff
    s_sub_u32 s86, 2047, s86
    s_lshl_b32 s86, s86, 11
    s_lshl_b32 s87, s52, 7
    s_add_u32 s86, s86, s87
    v_lshl_add_u32 v11, v2, 3, s86
    v_cmp_eq_u32 vcc, 0, v1
    v_mov_b32 v9, 2147483648
    s_nop 0
    v_cndmask_b32 v11, v9, v11, vcc
    s_waitcnt lgkmcnt(0)
    v_mul_f32 v60, 0xbfb8aa3b, v60
    v_exp_f32 v60, v60
    s_nop 0
    v_add_f32 v60, 1.0, v60
    v_rcp_f32 v60, v60
    s_nop 0
    v_cvt_pk_bf16_f32 v60, v60, v60
    v_lshlrev_b32 v60, 16, v60
    v_lshlrev_b32 v64, 16, v56
    v_and_b32 v65, 0xffff0000, v56
    v_lshlrev_b32 v68, 16, v58
    v_and_b32 v69, 0xffff0000, v58
    v_lshlrev_b32 v66, 16, v57
    v_and_b32 v67, 0xffff0000, v57
    v_lshlrev_b32 v70, 16, v59
    v_and_b32 v71, 0xffff0000, v59
L_h6:
    s_mov_b32 s90, 0
    buffer_load_dwordx4 v[112:115], v10, s[16:19], s90 offen sc1
    s_mov_b32 s90, 32768
    buffer_load_dwordx4 v[116:119], v10, s[16:19], s90 offen sc1
    s_mov_b32 s90, 65536
    buffer_load_dwordx4 v[120:123], v10, s[16:19], s90 offen sc1
    s_mov_b32 s90, 98304
    buffer_load_dwordx4 v[124:127], v10, s[16:19], s90 offen sc1
    s_mov_b32 s90, 131072
    buffer_load_dwordx4 v[128:131], v10, s[16:19], s90 offen sc1
    s_mov_b32 s90, 163840
    buffer_load_dwordx4 v[132:135], v10, s[16:19], s90 offen sc1
    s_mov_b32 s90, 196608
    buffer_load_dwordx4 v[136:139], v10, s[16:19], s90 offen sc1
    s_mov_b32 s90, 229376
    buffer_load_dwordx4 v[140:143], v10, s[16:19], s90 offen sc1
    s_waitcnt vmcnt(0)
    v_max3_u32 v8, v115, v119, v123
    v_max3_u32 v8, v8, v127, v131
    v_max3_u32 v8, v8, v135, v139
    v_max_u32 v8, v8, v143
    v_cmp_eq_u32 vcc, -1, v8
    s_cbranch_vccz L_ok_7
    s_sub_u32 s56, s56, 1
    s_cbranch_scc0 L_h6
    s_mov_b32 s56, 0
L_ok_7:
    v_pk_add_f32 v[112:113], v[112:113], v[128:129]
    v_pk_add_f32 v[114:115], v[114:115], v[130:131]
    v_pk_add_f32 v[116:117], v[116:117], v[132:133]
    v_pk_add_f32 v[118:119], v[118:119], v[134:135]
    v_pk_add_f32 v[120:121], v[120:121], v[136:137]
    v_pk_add_f32 v[122:123], v[122:123], v[138:139]
    v_pk_add_f32 v[124:125], v[124:125], v[140:141]
    v_pk_add_f32 v[126:127], v[126:127], v[142:143]
    v_pk_add_f32 v[112:113], v[112:113], v[120:121]
    v_pk_add_f32 v[114:115], v[114:115], v[122:123]
    v_pk_add_f32 v[116:117], v[116:117], v[124:125]
    v_pk_add_f32 v[118:119], v[118:119], v[126:127]
    v_pk_add_f32 v[112:113], v[112:113], v[116:117]
    v_pk_add_f32 v[114:115], v[114:115], v[118:119]
    v_mov_b32 v116, v112
    v_mov_b32 v117, v113
    v_mov_b32 v118, v114
    v_mov_b32 v119, v115
    v_permlane32_swap_b32 v112, v116
    v_permlane32_swap_b32 v113, v117
    v_permlane32_swap_b32 v114, v118
    v_permlane32_swap_b32 v115, v119
    v_add_f32 v112, v112, v116
    v_add_f32 v113, v113, v117
    v_add_f32 v114, v114, v118
    v_add_f32 v115, v115, v119
    v_mov_b32 v116, v112
    v_mov_b32 v117, v113
    v_mov_b32 v118, v114
    v_mov_b32 v119, v115
    v_permlane16_swap_b32 v112, v116
    v_permlane16_swap_b32 v113, v117
    v_permlane16_swap_b32 v114, v118
    v_permlane16_swap_b32 v115, v119
    v_add_f32 v112, v112, v116
    v_add_f32 v113, v113, v117
    v_add_f32 v114, v114, v118
    v_add_f32 v115, v115, v119
    v_cvt_pk_bf16_f32 v116, v112, v113
    v_cvt_pk_bf16_f32 v117, v114, v115
    v_lshlrev_b32 v112, 16, v116
    v_and_b32 v113, 0xffff0000, v116
    v_lshlrev_b32 v114, 16, v117
    v_and_b32 v115, 0xffff0000, v117
    v_pk_mul_f32 v[112:113], v[112:113], v[60:61] op_sel_hi:[1,0]
    v_pk_mul_f32 v[114:115], v[114:115], v[60:61] op_sel_hi:[1,0]
    v_cvt_pk_bf16_f32 v116, v112, v113
    v_cvt_pk_bf16_f32 v117, v114, v115
    v_lshlrev_b32 v112, 16, v116
    v_and_b32 v113, 0xffff0000, v116
    v_lshlrev_b32 v114, 16, v117
    v_and_b32 v115, 0xffff0000, v117
    v_pk_add_f32 v[112:113], v[112:113], v[68:69]
    v_pk_add_f32 v[114:115], v[114:115], v[70:71]
    v_cvt_pk_bf16_f32 v116, v112, v113
    v_cvt_pk_bf16_f32 v117, v114, v115
    v_lshlrev_b32 v112, 16, v116
    v_and_b32 v113, 0xffff0000, v116
    v_lshlrev_b32 v114, 16, v117
    v_and_b32 v115, 0xffff0000, v117
    v_pk_add_f32 v[112:113], v[112:113], v[64:65]
    v_pk_add_f32 v[114:115], v[114:115], v[66:67]
    v_cvt_pk_bf16_f32 v116, v112, v113
    v_cvt_pk_bf16_f32 v117, v114, v115
    buffer_store_dwordx2 v[116:117], v11, s[24:27], 0 offen
L_fin_next:
    s_mov_b32 s60, s61
    s_add_u32 s63, s63, 1
    s_cmp_lt_u32 s63, 2
    s_cbranch_scc1 L_fin_loop
L_fin:
L_end:
    s_endpgm
.section .rodata,"a"
.p2align 6
.amdhsa_kernel sequential_preLN__linear_attn_block__moe_arch_mod__prompt_kernel
  .amdhsa_next_free_vgpr 256
  .amdhsa_next_free_sgpr 102
  .amdhsa_accum_offset 256
  .amdhsa_group_segment_fixed_size 0
  .amdhsa_kernarg_size 88
  .amdhsa_user_sgpr_count 2
  .amdhsa_user_sgpr_kernarg_segment_ptr 1
  .amdhsa_system_sgpr_workgroup_id_x 1
.end_amdhsa_kernel
```

```asm
; @launch grid=(256,1,1) block=(512,1,1) lds=163840
.amdgcn_target "amdgcn-amd-amdhsa--gfx950"
.text
.globl sequential_preLN__linear_attn_block__moe_arch_mod__prompt_kernel
.p2align 8
.type sequential_preLN__linear_attn_block__moe_arch_mod__prompt_kernel,@function
sequential_preLN__linear_attn_block__moe_arch_mod__prompt_kernel:
    s_cmp_ge_u32 s2, 256
    s_cbranch_scc1 L_end
    s_load_dwordx16 s[64:79], s[0:1], 0
    s_load_dwordx4 s[80:83], s[0:1], 64
    s_load_dwordx2 s[84:85], s[0:1], 80
    v_lshrrev_b32 v1, 6, v0
    v_and_b32 v0, 63, v0
    v_readfirstlane_b32 s3, v1
    s_and_b32 s44, s2, 7
    s_lshr_b32 s45, s2, 3
    s_and_b32 s46, s44, 1
    s_lshl_b32 s46, s46, 3
    s_and_b32 s86, s45, 7
    s_add_u32 s46, s46, s86
    s_lshr_b32 s47, s44, 1
    s_lshl_b32 s47, s47, 2
    s_lshr_b32 s86, s45, 3
    s_add_u32 s47, s47, s86
    s_lshl_b32 s51, s44, 1
    s_lshr_b32 s86, s45, 4
    s_add_u32 s51, s51, s86
    s_and_b32 s52, s45, 15
    s_and_b32 s48, s3, 3
    s_and_b32 s49, s3, 1
    s_bfe_u32 s50, s3, 0x10001
    s_mov_b32 s56, 65536
    s_mov_b32 s95, 0x3f803f80
    s_movk_i32 s92, 0x1000
    s_movk_i32 s93, 0x2000
    s_movk_i32 s94, 0x3000
    s_cmp_lt_u32 s3, 4
    s_cbranch_scc1 L_comp
    v_lshrrev_b32 v20, 3, v0
    v_and_b32 v21, 7, v0
    v_lshrrev_b32 v22, 4, v0
    v_xor_b32 v23, v21, v22
    v_xor_b32 v24, 4, v23
    s_lshl_b32 s86, s48, 5
    v_add_u32 v25, s86, v20
    v_lshlrev_b32 v25, 11, v25
    v_lshl_add_u32 v2, v23, 4, v25
    v_lshl_add_u32 v3, v24, 4, v25
    v_add_u32 v3, 15360, v3
    v_lshl_add_u32 v4, v23, 4, v25
    v_add_u32 v4, 30720, v4
    v_lshl_add_u32 v5, v24, 4, v25
    v_add_u32 v5, 46080, v5
    s_lshl_b32 s86, s48, 4
    v_add_u32 v25, s86, v20
    v_mul_u32_u24 v25, 6144, v25
    s_lshl_b32 s86, s47, 7
    v_add_u32 v25, s86, v25
    v_bfe_u32 v26, v0, 4, 1
    v_lshlrev_b32 v26, 1, v26
    v_xor_b32 v26, v26, v21
    v_xor_b32 v27, 4, v26
    v_lshl_add_u32 v6, v26, 4, v25
    v_lshl_add_u32 v7, v27, 4, v25
    v_add_u32 v7, 48128, v7
    v_lshl_add_u32 v8, v26, 4, v25
    v_add_u32 v8, 2048, v8
    v_lshl_add_u32 v9, v27, 4, v25
    v_add_u32 v9, 50176, v9
    v_lshl_add_u32 v10, v26, 4, v25
    v_add_u32 v10, 4096, v10
    v_lshl_add_u32 v11, v27, 4, v25
    v_add_u32 v11, 52224, v11
    s_lshl_b32 s63, s46, 18
    s_lshl_b32 s53, s48, 12
    s_lshl_b32 s62, s48, 11
    s_add_u32 s62, s62, 16384
    s_waitcnt lgkmcnt(0)
    s_mov_b32 s8, s64
    s_and_b32 s9, s65, 0xffff
    s_mov_b32 s10, 4194304
    s_mov_b32 s11, 0x20000
    s_mov_b32 s12, s66
    s_and_b32 s13, s67, 0xffff
    s_mov_b32 s14, 6291456
    s_mov_b32 s15, 0x20000
    s_load_dword s61, s[84:85], 524288
    s_add_u32 m0, s53, 0
    s_add_u32 s90, s63, 0
    buffer_load_dwordx4 v2, s[8:11], s90 offen offset:0 lds
    buffer_load_dwordx4 v3, s[8:11], s90 offen offset:1024 lds
    buffer_load_dwordx4 v4, s[8:11], s90 offen offset:2048 lds
    buffer_load_dwordx4 v5, s[8:11], s90 offen offset:3072 lds
    s_mov_b32 s91, 0
    s_add_u32 m0, s62, 0
    s_nop 0
    buffer_load_dwordx4 v6, s[12:15], s91 offen offset:0 lds
    buffer_load_dwordx4 v7, s[12:15], s91 offen offset:1024 lds
    s_add_u32 m0, s62, 8192
    s_nop 0
    buffer_load_dwordx4 v8, s[12:15], s91 offen offset:0 lds
    buffer_load_dwordx4 v9, s[12:15], s91 offen offset:1024 lds
    s_add_u32 m0, s62, 16384
    s_nop 0
    buffer_load_dwordx4 v10, s[12:15], s91 offen offset:0 lds
    buffer_load_dwordx4 v11, s[12:15], s91 offen offset:1024 lds
    s_add_u32 m0, s53, 40960
    s_add_u32 s90, s63, 128
    buffer_load_dwordx4 v2, s[8:11], s90 offen offset:0 lds
    buffer_load_dwordx4 v3, s[8:11], s90 offen offset:1024 lds
    buffer_load_dwordx4 v4, s[8:11], s90 offen offset:2048 lds
    buffer_load_dwordx4 v5, s[8:11], s90 offen offset:3072 lds
    s_mov_b32 s91, 393216
    s_add_u32 m0, s62, 40960
    s_nop 0
    buffer_load_dwordx4 v6, s[12:15], s91 offen offset:0 lds
    buffer_load_dwordx4 v7, s[12:15], s91 offen offset:1024 lds
    s_add_u32 m0, s62, 49152
    s_nop 0
    buffer_load_dwordx4 v8, s[12:15], s91 offen offset:0 lds
    buffer_load_dwordx4 v9, s[12:15], s91 offen offset:1024 lds
    s_add_u32 m0, s62, 57344
    s_nop 0
    buffer_load_dwordx4 v10, s[12:15], s91 offen offset:0 lds
    buffer_load_dwordx4 v11, s[12:15], s91 offen offset:1024 lds
    s_add_u32 m0, s53, 81920
    s_add_u32 s90, s63, 256
    buffer_load_dwordx4 v2, s[8:11], s90 offen offset:0 lds
    buffer_load_dwordx4 v3, s[8:11], s90 offen offset:1024 lds
    buffer_load_dwordx4 v4, s[8:11], s90 offen offset:2048 lds
    buffer_load_dwordx4 v5, s[8:11], s90 offen offset:3072 lds
    s_mov_b32 s91, 786432
    s_add_u32 m0, s62, 81920
    s_nop 0
    buffer_load_dwordx4 v6, s[12:15], s91 offen offset:0 lds
    buffer_load_dwordx4 v7, s[12:15], s91 offen offset:1024 lds
    s_add_u32 m0, s62, 90112
    s_nop 0
    buffer_load_dwordx4 v8, s[12:15], s91 offen offset:0 lds
    buffer_load_dwordx4 v9, s[12:15], s91 offen offset:1024 lds
    s_add_u32 m0, s62, 98304
    s_nop 0
    buffer_load_dwordx4 v10, s[12:15], s91 offen offset:0 lds
    buffer_load_dwordx4 v11, s[12:15], s91 offen offset:1024 lds
    s_mov_b32 s16, s84
    s_and_b32 s17, s85, 0xffff
    s_mov_b32 s18, 268435456
    s_mov_b32 s19, 0x20000
    s_mov_b32 s20, s68
    s_and_b32 s21, s69, 0xffff
    s_mov_b32 s22, 2097152
    s_mov_b32 s23, 0x20000
    s_mov_b32 s24, s80
    s_and_b32 s25, s81, 0xffff
    s_mov_b32 s26, 4194304
    s_mov_b32 s27, 0x20000
    s_mov_b32 s28, s82
    s_and_b32 s29, s83, 0xffff
    s_mov_b32 s30, 256
    s_mov_b32 s31, 0x20000
    s_bitcmp1_b32 s2, 0
    s_cselect_b32 s32, s76, s74
    s_cselect_b32 s33, s77, s75
    s_and_b32 s33, s33, 0xffff
    s_mov_b32 s34, 7340032
    s_mov_b32 s35, 0x20000
    s_mov_b32 s36, s78
    s_and_b32 s37, s79, 0xffff
    s_mov_b32 s38, 7340032
    s_mov_b32 s39, 0x20000
    s_mov_b32 s40, s72
    s_and_b32 s41, s73, 0xffff
    s_mov_b32 s42, 2048
    s_mov_b32 s43, 0x20000
    v_lshrrev_b32 v22, 4, v0
    v_and_b32 v23, 15, v0
    s_lshl_b32 s86, s46, 6
    v_add_u32 v28, s86, v20
    v_mul_u32_u24 v28, 6144, v28
    s_lshl_b32 s86, s48, 11
    s_lshl_b32 s87, s47, 7
    s_add_u32 s86, s86, s87
    s_cmp_eq_u32 s48, 3
    s_cselect_b32 s86, 2147483648, s86
    v_lshl_add_u32 v26, v21, 4, s86
    v_add_u32 v28, v28, v26
    s_lshl_b32 s86, s46, 7
    s_lshl_b32 s87, s47, 3
    s_add_u32 s86, s86, s87
    s_lshl_b32 s87, s48, 1
    s_add_u32 s86, s86, s87
    v_lshrrev_b32 v25, 5, v0
    v_add_u32 v25, s86, v25
    v_lshlrev_b32 v13, 3, v25
    v_and_b32 v26, 31, v0
    v_cmp_eq_u32 vcc, 0, v26
    v_mov_b32 v24, 2147483648
    s_nop 0
    v_cndmask_b32 v13, v24, v13, vcc
    v_lshlrev_b32 v25, 11, v25
    v_lshl_add_u32 v29, v26, 4, v25
    s_bfe_u32 s86, s2, 0x20001
    s_lshl_b32 s86, s86, 2
    s_add_u32 s86, s86, s48
    s_lshl_b32 s86, s86, 6
    v_lshl_add_u32 v30, v22, 4, s86
    v_mul_u32_u24 v30, 7168, v30
    s_lshl_b32 s86, s45, 8
    s_cmp_ge_u32 s2, 224
    s_cselect_b32 s86, 2147483648, s86
    v_lshl_add_u32 v24, v23, 4, s86
    v_add_u32 v30, v30, v24
    s_mul_i32 s86, s45, 112
    s_mul_i32 s87, s48, 28
    s_add_u32 s86, s86, s87
    v_mul_u32_u24 v31, 7, v22
    v_add_u32 v31, s86, v31
    v_lshlrev_b32 v31, 11, v31
    s_lshl_b32 s86, s44, 8
    v_lshl_add_u32 v24, v23, 4, s86
    v_add_u32 v31, v31, v24
    v_lshlrev_b32 v24, 1, v22
    v_xor_b32 v24, v24, v21
    s_lshl_b32 s86, s48, 3
    v_add_u32 v12, s86, v20
    v_lshlrev_b32 v12, 11, v12
    s_lshl_b32 s86, s52, 7
    v_lshl_add_u32 v24, v24, 4, s86
    v_add_u32 v12, v12, v24
    s_lshl_b32 s89, s48, 10
    v_and_b32 v24, 1, v0
    v_lshlrev_b32 v24, 4, v24
    v_mov_b32 v25, 0x3f80
    v_lshlrev_b32 v24, v24, v25
    v_bfe_u32 v25, v0, 1, 2
    v_cmp_eq_u32 vcc, 0, v25
    s_nop 1
    v_cndmask_b32 v104, 0, v24, vcc
    v_cmp_eq_u32 vcc, 1, v25
    s_nop 1
    v_cndmask_b32 v105, 0, v24, vcc
    v_cmp_eq_u32 vcc, 2, v25
    s_nop 1
    v_cndmask_b32 v106, 0, v24, vcc
    v_cmp_eq_u32 vcc, 3, v25
    s_nop 1
    v_cndmask_b32 v107, 0, v24, vcc
    s_waitcnt lgkmcnt(0)
    s_add_u32 s61, s61, 0x9e3779b9
    s_waitcnt vmcnt(20)
    s_barrier
    s_add_u32 m0, s53, 122880
    s_add_u32 s90, s63, 384
    buffer_load_dwordx4 v2, s[8:11], s90 offen offset:0 lds
    buffer_load_dwordx4 v3, s[8:11], s90 offen offset:1024 lds
    buffer_load_dwordx4 v4, s[8:11], s90 offen offset:2048 lds
    buffer_load_dwordx4 v5, s[8:11], s90 offen offset:3072 lds
    s_mov_b32 s91, 1179648
    s_add_u32 m0, s62, 122880
    s_nop 0
    buffer_load_dwordx4 v6, s[12:15], s91 offen offset:0 lds
    buffer_load_dwordx4 v7, s[12:15], s91 offen offset:1024 lds
    s_add_u32 m0, s62, 131072
    s_nop 0
    buffer_load_dwordx4 v8, s[12:15], s91 offen offset:0 lds
    buffer_load_dwordx4 v9, s[12:15], s91 offen offset:1024 lds
    s_add_u32 m0, s62, 139264
    s_nop 0
    buffer_load_dwordx4 v10, s[12:15], s91 offen offset:0 lds
    buffer_load_dwordx4 v11, s[12:15], s91 offen offset:1024 lds
    buffer_load_dwordx4 v[72:75], v29, s[8:11], 0 offen offset:0
    buffer_load_dwordx4 v[76:79], v29, s[8:11], 0 offen offset:512
    buffer_load_dwordx4 v[80:83], v29, s[8:11], 0 offen offset:1024
    buffer_load_dwordx4 v[84:87], v29, s[8:11], 0 offen offset:1536
    s_mov_b32 s90, 0
    buffer_load_dwordx4 v[40:43], v28, s[12:15], s90 offen
    s_mov_b32 s90, 49152
    buffer_load_dwordx4 v[44:47], v28, s[12:15], s90 offen
    s_mov_b32 s90, 98304
    buffer_load_dwordx4 v[48:51], v28, s[12:15], s90 offen
    s_mov_b32 s90, 147456
    buffer_load_dwordx4 v[52:55], v28, s[12:15], s90 offen
    s_mov_b32 s90, 196608
    buffer_load_dwordx4 v[56:59], v28, s[12:15], s90 offen
    s_mov_b32 s90, 245760
    buffer_load_dwordx4 v[60:63], v28, s[12:15], s90 offen
    s_mov_b32 s90, 294912
    buffer_load_dwordx4 v[64:67], v28, s[12:15], s90 offen
    s_mov_b32 s90, 344064
    buffer_load_dwordx4 v[68:71], v28, s[12:15], s90 offen
    s_waitcnt vmcnt(32)
    s_barrier
    s_add_u32 m0, s53, 0
    s_add_u32 s90, s63, 512
    buffer_load_dwordx4 v2, s[8:11], s90 offen offset:0 lds
    buffer_load_dwordx4 v3, s[8:11], s90 offen offset:1024 lds
    buffer_load_dwordx4 v4, s[8:11], s90 offen offset:2048 lds
    buffer_load_dwordx4 v5, s[8:11], s90 offen offset:3072 lds
    s_mov_b32 s91, 1572864
    s_add_u32 m0, s62, 0
    s_nop 0
    buffer_load_dwordx4 v6, s[12:15], s91 offen offset:0 lds
    buffer_load_dwordx4 v7, s[12:15], s91 offen offset:1024 lds
    s_add_u32 m0, s62, 8192
    s_nop 0
    buffer_load_dwordx4 v8, s[12:15], s91 offen offset:0 lds
    buffer_load_dwordx4 v9, s[12:15], s91 offen offset:1024 lds
    s_add_u32 m0, s62, 16384
    s_nop 0
    buffer_load_dwordx4 v10, s[12:15], s91 offen offset:0 lds
    buffer_load_dwordx4 v11, s[12:15], s91 offen offset:1024 lds
    s_waitcnt vmcnt(32)
    s_barrier
    s_add_u32 m0, s53, 40960
    s_add_u32 s90, s63, 640
    buffer_load_dwordx4 v2, s[8:11], s90 offen offset:0 lds
    buffer_load_dwordx4 v3, s[8:11], s90 offen offset:1024 lds
    buffer_load_dwordx4 v4, s[8:11], s90 offen offset:2048 lds
    buffer_load_dwordx4 v5, s[8:11], s90 offen offset:3072 lds
    s_mov_b32 s91, 1966080
    s_add_u32 m0, s62, 40960
    s_nop 0
    buffer_load_dwordx4 v6, s[12:15], s91 offen offset:0 lds
    buffer_load_dwordx4 v7, s[12:15], s91 offen offset:1024 lds
    s_add_u32 m0, s62, 49152
    s_nop 0
    buffer_load_dwordx4 v8, s[12:15], s91 offen offset:0 lds
    buffer_load_dwordx4 v9, s[12:15], s91 offen offset:1024 lds
    s_add_u32 m0, s62, 57344
    s_nop 0
    buffer_load_dwordx4 v10, s[12:15], s91 offen offset:0 lds
    buffer_load_dwordx4 v11, s[12:15], s91 offen offset:1024 lds
    s_waitcnt vmcnt(32)
    s_barrier
    s_add_u32 m0, s53, 81920
    s_add_u32 s90, s63, 768
    buffer_load_dwordx4 v2, s[8:11], s90 offen offset:0 lds
    buffer_load_dwordx4 v3, s[8:11], s90 offen offset:1024 lds
    buffer_load_dwordx4 v4, s[8:11], s90 offen offset:2048 lds
    buffer_load_dwordx4 v5, s[8:11], s90 offen offset:3072 lds
    s_mov_b32 s91, 2359296
    s_add_u32 m0, s62, 81920
    s_nop 0
    buffer_load_dwordx4 v6, s[12:15], s91 offen offset:0 lds
    buffer_load_dwordx4 v7, s[12:15], s91 offen offset:1024 lds
    s_add_u32 m0, s62, 90112
    s_nop 0
    buffer_load_dwordx4 v8, s[12:15], s91 offen offset:0 lds
    buffer_load_dwordx4 v9, s[12:15], s91 offen offset:1024 lds
    s_add_u32 m0, s62, 98304
    s_nop 0
    buffer_load_dwordx4 v10, s[12:15], s91 offen offset:0 lds
    buffer_load_dwordx4 v11, s[12:15], s91 offen offset:1024 lds
    s_waitcnt vmcnt(30)
    v_mfma_f32_16x16x32_bf16 v[108:111], v[104:107], v[40:43], 0
    v_mfma_f32_16x16x32_bf16 v[108:111], v[104:107], v[44:47], v[108:111]
    v_mfma_f32_16x16x32_bf16 v[108:111], v[104:107], v[48:51], v[108:111]
    v_mfma_f32_16x16x32_bf16 v[108:111], v[104:107], v[52:55], v[108:111]
    v_mfma_f32_16x16x32_bf16 v[108:111], v[104:107], v[56:59], v[108:111]
    v_mfma_f32_16x16x32_bf16 v[108:111], v[104:107], v[60:63], v[108:111]
    v_mfma_f32_16x16x32_bf16 v[108:111], v[104:107], v[64:67], v[108:111]
    v_mfma_f32_16x16x32_bf16 v[108:111], v[104:107], v[68:71], v[108:111]
    v_mov_b32 v88, 0
    v_mov_b32 v89, 0
    v_mov_b32 v90, 0
    v_mov_b32 v96, 0
    v_mov_b32 v92, 0
    v_mov_b32 v93, 0
    v_mov_b32 v94, 0
    v_mov_b32 v95, 0
    v_dot2c_f32_bf16 v88, s95, v72
    v_dot2c_f32_bf16 v89, s95, v73
    v_dot2c_f32_bf16 v90, s95, v74
    v_dot2c_f32_bf16 v96, s95, v75
    v_dot2c_f32_bf16 v92, v72, v72
    v_dot2c_f32_bf16 v93, v73, v73
    v_dot2c_f32_bf16 v94, v74, v74
    v_dot2c_f32_bf16 v95, v75, v75
    v_dot2c_f32_bf16 v88, s95, v76
    v_dot2c_f32_bf16 v89, s95, v77
    v_dot2c_f32_bf16 v90, s95, v78
    v_dot2c_f32_bf16 v96, s95, v79
    v_dot2c_f32_bf16 v92, v76, v76
    v_dot2c_f32_bf16 v93, v77, v77
    v_dot2c_f32_bf16 v94, v78, v78
    v_dot2c_f32_bf16 v95, v79, v79
    v_dot2c_f32_bf16 v88, s95, v80
    v_dot2c_f32_bf16 v89, s95, v81
    v_dot2c_f32_bf16 v90, s95, v82
    v_dot2c_f32_bf16 v96, s95, v83
    v_dot2c_f32_bf16 v92, v80, v80
    v_dot2c_f32_bf16 v93, v81, v81
    v_dot2c_f32_bf16 v94, v82, v82
    v_dot2c_f32_bf16 v95, v83, v83
    v_dot2c_f32_bf16 v88, s95, v84
    v_dot2c_f32_bf16 v89, s95, v85
    v_dot2c_f32_bf16 v90, s95, v86
    v_dot2c_f32_bf16 v96, s95, v87
    v_dot2c_f32_bf16 v92, v84, v84
    v_dot2c_f32_bf16 v93, v85, v85
    v_dot2c_f32_bf16 v94, v86, v86
    v_dot2c_f32_bf16 v95, v87, v87
    v_add_f32_dpp v108, v108, v108 row_ror:8 row_mask:0xf bank_mask:0xf
    v_add_f32_dpp v109, v109, v109 row_ror:8 row_mask:0xf bank_mask:0xf
    v_add_f32_dpp v110, v110, v110 row_ror:8 row_mask:0xf bank_mask:0xf
    v_add_f32_dpp v111, v111, v111 row_ror:8 row_mask:0xf bank_mask:0xf
    s_lshl_b32 s86, s47, 4
    s_add_u32 s86, s86, s46
    s_mul_i32 s86, s86, 768
    s_lshl_b32 s87, s48, 8
    s_add_u32 s86, s86, s87
    s_add_u32 s86, s86, 65536
    s_cmp_eq_u32 s48, 3
    s_cselect_b32 s86, 2147483648, s86
    v_lshl_add_u32 v34, v23, 5, s86
    v_lshl_add_u32 v34, v22, 4, v34
    v_and_b32 v25, 0x28, v0
    v_cmp_eq_u32 vcc, 0, v25
    v_mov_b32 v25, 2147483648
    s_nop 0
    v_cndmask_b32 v34, v25, v34, vcc
    v_mov_b32 v91, s61
    s_mov_b32 s86, 117835008
    v_perm_b32 v108, v108, v91, s86
    s_mov_b32 s86, 117835009
    v_perm_b32 v109, v109, v91, s86
    s_mov_b32 s86, 117835010
    v_perm_b32 v110, v110, v91, s86
    s_mov_b32 s86, 117835011
    v_perm_b32 v111, v111, v91, s86
    v_add_f32 v88, v88, v90
    v_pk_add_f32 v[92:93], v[92:93], v[94:95]
    v_add_f32 v88, v88, v89
    v_add_f32 v92, v92, v93
    v_add_f32 v88, v88, v96
    s_nop 1
    v_add_f32_dpp v88, v88, v88 row_ror:8 row_mask:0xf bank_mask:0xf
    v_add_f32_dpp v92, v92, v92 row_ror:8 row_mask:0xf bank_mask:0xf
    s_nop 0
    v_add_f32_dpp v88, v88, v88 row_ror:4 row_mask:0xf bank_mask:0xf
    v_add_f32_dpp v92, v92, v92 row_ror:4 row_mask:0xf bank_mask:0xf
    s_nop 0
    v_add_f32_dpp v88, v88, v88 row_ror:2 row_mask:0xf bank_mask:0xf
    v_add_f32_dpp v92, v92, v92 row_ror:2 row_mask:0xf bank_mask:0xf
    s_nop 0
    v_add_f32_dpp v88, v88, v88 row_ror:1 row_mask:0xf bank_mask:0xf
    v_add_f32_dpp v92, v92, v92 row_ror:1 row_mask:0xf bank_mask:0xf
    v_mov_b32 v89, v88
    v_mov_b32 v93, v92
    s_nop 0
    v_permlane16_swap_b32 v88, v89
    v_permlane16_swap_b32 v92, v93
    v_add_f32 v88, v88, v89
    v_add_f32 v92, v92, v93
    v_mul_f32 v88, 0x3a800000, v88
    v_mul_f32 v92, 0x3a800000, v92
    v_fma_f32 v92, -v88, v88, v92
    v_max_f32 v92, 0, v92
    v_cvt_pk_bf16_f32 v89, v88, v92
    v_lshlrev_b32 v90, 16, v89
    v_and_b32 v89, 0xffff0000, v89
    v_add_f32 v89, 0x3727c5ac, v89
    v_cvt_pk_bf16_f32 v89, v89, v89
    v_lshlrev_b32 v89, 16, v89
    v_sqrt_f32 v89, v89
    s_nop 0
    v_cvt_pk_bf16_f32 v89, v89, v89
    v_lshlrev_b32 v89, 16, v89
    v_lshrrev_b32 v90, 16, v90
    v_or_b32 v90, v90, v89
    s_waitcnt vmcnt(20)
    s_barrier
    s_add_u32 m0, s53, 122880
    s_add_u32 s90, s63, 896
    buffer_load_dwordx4 v2, s[8:11], s90 offen offset:0 lds
    buffer_load_dwordx4 v3, s[8:11], s90 offen offset:1024 lds
    buffer_load_dwordx4 v4, s[8:11], s90 offen offset:2048 lds
    buffer_load_dwordx4 v5, s[8:11], s90 offen offset:3072 lds
    s_mov_b32 s91, 2752512
    s_add_u32 m0, s62, 122880
    s_nop 0
    buffer_load_dwordx4 v6, s[12:15], s91 offen offset:0 lds
    buffer_load_dwordx4 v7, s[12:15], s91 offen offset:1024 lds
    s_add_u32 m0, s62, 131072
    s_nop 0
    buffer_load_dwordx4 v8, s[12:15], s91 offen offset:0 lds
    buffer_load_dwordx4 v9, s[12:15], s91 offen offset:1024 lds
    s_add_u32 m0, s62, 139264
    s_nop 0
    buffer_load_dwordx4 v10, s[12:15], s91 offen offset:0 lds
    buffer_load_dwordx4 v11, s[12:15], s91 offen offset:1024 lds
    s_waitcnt vmcnt(20)
    s_barrier
    s_add_u32 m0, s53, 0
    s_add_u32 s90, s63, 1024
    buffer_load_dwordx4 v2, s[8:11], s90 offen offset:0 lds
    buffer_load_dwordx4 v3, s[8:11], s90 offen offset:1024 lds
    buffer_load_dwordx4 v4, s[8:11], s90 offen offset:2048 lds
    buffer_load_dwordx4 v5, s[8:11], s90 offen offset:3072 lds
    s_mov_b32 s91, 3145728
    s_add_u32 m0, s62, 0
    s_nop 0
    buffer_load_dwordx4 v6, s[12:15], s91 offen offset:0 lds
    buffer_load_dwordx4 v7, s[12:15], s91 offen offset:1024 lds
    s_add_u32 m0, s62, 8192
    s_nop 0
    buffer_load_dwordx4 v8, s[12:15], s91 offen offset:0 lds
    buffer_load_dwordx4 v9, s[12:15], s91 offen offset:1024 lds
    s_add_u32 m0, s62, 16384
    s_nop 0
    buffer_load_dwordx4 v10, s[12:15], s91 offen offset:0 lds
    buffer_load_dwordx4 v11, s[12:15], s91 offen offset:1024 lds
    s_waitcnt vmcnt(20)
    s_barrier
    s_add_u32 m0, s53, 40960
    s_add_u32 s90, s63, 1152
    buffer_load_dwordx4 v2, s[8:11], s90 offen offset:0 lds
    buffer_load_dwordx4 v3, s[8:11], s90 offen offset:1024 lds
    buffer_load_dwordx4 v4, s[8:11], s90 offen offset:2048 lds
    buffer_load_dwordx4 v5, s[8:11], s90 offen offset:3072 lds
    s_mov_b32 s91, 3538944
    s_add_u32 m0, s62, 40960
    s_nop 0
    buffer_load_dwordx4 v6, s[12:15], s91 offen offset:0 lds
    buffer_load_dwordx4 v7, s[12:15], s91 offen offset:1024 lds
    s_add_u32 m0, s62, 49152
    s_nop 0
    buffer_load_dwordx4 v8, s[12:15], s91 offen offset:0 lds
    buffer_load_dwordx4 v9, s[12:15], s91 offen offset:1024 lds
    s_add_u32 m0, s62, 57344
    s_nop 0
    buffer_load_dwordx4 v10, s[12:15], s91 offen offset:0 lds
    buffer_load_dwordx4 v11, s[12:15], s91 offen offset:1024 lds
    buffer_store_dwordx4 v[108:111], v34, s[16:19], 0 offen sc1
    buffer_store_dwordx2 v[90:91], v13, s[16:19], 0 offen sc1
    s_waitcnt vmcnt(22)
    s_barrier
    s_add_u32 m0, s53, 81920
    s_add_u32 s90, s63, 1280
    buffer_load_dwordx4 v2, s[8:11], s90 offen offset:0 lds
    buffer_load_dwordx4 v3, s[8:11], s90 offen offset:1024 lds
    buffer_load_dwordx4 v4, s[8:11], s90 offen offset:2048 lds
    buffer_load_dwordx4 v5, s[8:11], s90 offen offset:3072 lds
    s_mov_b32 s91, 3932160
    s_add_u32 m0, s62, 81920
    s_nop 0
    buffer_load_dwordx4 v6, s[12:15], s91 offen offset:0 lds
    buffer_load_dwordx4 v7, s[12:15], s91 offen offset:1024 lds
    s_add_u32 m0, s62, 90112
    s_nop 0
    buffer_load_dwordx4 v8, s[12:15], s91 offen offset:0 lds
    buffer_load_dwordx4 v9, s[12:15], s91 offen offset:1024 lds
    s_add_u32 m0, s62, 98304
    s_nop 0
    buffer_load_dwordx4 v10, s[12:15], s91 offen offset:0 lds
    buffer_load_dwordx4 v11, s[12:15], s91 offen offset:1024 lds
    s_waitcnt vmcnt(22)
    s_barrier
    s_add_u32 m0, s53, 122880
    s_add_u32 s90, s63, 1408
    buffer_load_dwordx4 v2, s[8:11], s90 offen offset:0 lds
    buffer_load_dwordx4 v3, s[8:11], s90 offen offset:1024 lds
    buffer_load_dwordx4 v4, s[8:11], s90 offen offset:2048 lds
    buffer_load_dwordx4 v5, s[8:11], s90 offen offset:3072 lds
    s_mov_b32 s91, 4325376
    s_add_u32 m0, s62, 122880
    s_nop 0
    buffer_load_dwordx4 v6, s[12:15], s91 offen offset:0 lds
    buffer_load_dwordx4 v7, s[12:15], s91 offen offset:1024 lds
    s_add_u32 m0, s62, 131072
    s_nop 0
    buffer_load_dwordx4 v8, s[12:15], s91 offen offset:0 lds
    buffer_load_dwordx4 v9, s[12:15], s91 offen offset:1024 lds
    s_add_u32 m0, s62, 139264
    s_nop 0
    buffer_load_dwordx4 v10, s[12:15], s91 offen offset:0 lds
    buffer_load_dwordx4 v11, s[12:15], s91 offen offset:1024 lds
    s_waitcnt vmcnt(22)
    s_barrier
    s_add_u32 m0, s53, 0
    s_add_u32 s90, s63, 1536
    buffer_load_dwordx4 v2, s[8:11], s90 offen offset:0 lds
    buffer_load_dwordx4 v3, s[8:11], s90 offen offset:1024 lds
    buffer_load_dwordx4 v4, s[8:11], s90 offen offset:2048 lds
    buffer_load_dwordx4 v5, s[8:11], s90 offen offset:3072 lds
    s_mov_b32 s91, 4718592
    s_add_u32 m0, s62, 0
    s_nop 0
    buffer_load_dwordx4 v6, s[12:15], s91 offen offset:0 lds
    buffer_load_dwordx4 v7, s[12:15], s91 offen offset:1024 lds
    s_add_u32 m0, s62, 8192
    s_nop 0
    buffer_load_dwordx4 v8, s[12:15], s91 offen offset:0 lds
    buffer_load_dwordx4 v9, s[12:15], s91 offen offset:1024 lds
    s_add_u32 m0, s62, 16384
    s_nop 0
    buffer_load_dwordx4 v10, s[12:15], s91 offen offset:0 lds
    buffer_load_dwordx4 v11, s[12:15], s91 offen offset:1024 lds
    s_waitcnt vmcnt(20)
    s_barrier
    s_add_u32 m0, s53, 40960
    s_add_u32 s90, s63, 1664
    buffer_load_dwordx4 v2, s[8:11], s90 offen offset:0 lds
    buffer_load_dwordx4 v3, s[8:11], s90 offen offset:1024 lds
    buffer_load_dwordx4 v4, s[8:11], s90 offen offset:2048 lds
    buffer_load_dwordx4 v5, s[8:11], s90 offen offset:3072 lds
    s_mov_b32 s91, 5111808
    s_add_u32 m0, s62, 40960
    s_nop 0
    buffer_load_dwordx4 v6, s[12:15], s91 offen offset:0 lds
    buffer_load_dwordx4 v7, s[12:15], s91 offen offset:1024 lds
    s_add_u32 m0, s62, 49152
    s_nop 0
    buffer_load_dwordx4 v8, s[12:15], s91 offen offset:0 lds
    buffer_load_dwordx4 v9, s[12:15], s91 offen offset:1024 lds
    s_add_u32 m0, s62, 57344
    s_nop 0
    buffer_load_dwordx4 v10, s[12:15], s91 offen offset:0 lds
    buffer_load_dwordx4 v11, s[12:15], s91 offen offset:1024 lds
    s_waitcnt vmcnt(20)
    s_barrier
    s_add_u32 m0, s53, 81920
    s_add_u32 s90, s63, 1792
    buffer_load_dwordx4 v2, s[8:11], s90 offen offset:0 lds
    buffer_load_dwordx4 v3, s[8:11], s90 offen offset:1024 lds
    buffer_load_dwordx4 v4, s[8:11], s90 offen offset:2048 lds
    buffer_load_dwordx4 v5, s[8:11], s90 offen offset:3072 lds
    s_mov_b32 s91, 5505024
    s_add_u32 m0, s62, 81920
    s_nop 0
    buffer_load_dwordx4 v6, s[12:15], s91 offen offset:0 lds
    buffer_load_dwordx4 v7, s[12:15], s91 offen offset:1024 lds
    s_add_u32 m0, s62, 90112
    s_nop 0
    buffer_load_dwordx4 v8, s[12:15], s91 offen offset:0 lds
    buffer_load_dwordx4 v9, s[12:15], s91 offen offset:1024 lds
    s_add_u32 m0, s62, 98304
    s_nop 0
    buffer_load_dwordx4 v10, s[12:15], s91 offen offset:0 lds
    buffer_load_dwordx4 v11, s[12:15], s91 offen offset:1024 lds
    s_waitcnt vmcnt(20)
    s_barrier
    s_add_u32 m0, s53, 122880
    s_add_u32 s90, s63, 1920
    buffer_load_dwordx4 v2, s[8:11], s90 offen offset:0 lds
    buffer_load_dwordx4 v3, s[8:11], s90 offen offset:1024 lds
    buffer_load_dwordx4 v4, s[8:11], s90 offen offset:2048 lds
    buffer_load_dwordx4 v5, s[8:11], s90 offen offset:3072 lds
    s_mov_b32 s91, 5898240
    s_add_u32 m0, s62, 122880
    s_nop 0
    buffer_load_dwordx4 v6, s[12:15], s91 offen offset:0 lds
    buffer_load_dwordx4 v7, s[12:15], s91 offen offset:1024 lds
    s_add_u32 m0, s62, 131072
    s_nop 0
    buffer_load_dwordx4 v8, s[12:15], s91 offen offset:0 lds
    buffer_load_dwordx4 v9, s[12:15], s91 offen offset:1024 lds
    s_add_u32 m0, s62, 139264
    s_nop 0
    buffer_load_dwordx4 v10, s[12:15], s91 offen offset:0 lds
    buffer_load_dwordx4 v11, s[12:15], s91 offen offset:1024 lds
    s_waitcnt vmcnt(20)
    s_barrier
    s_mul_i32 s86, s47, 12288
    s_lshl_b32 s87, s48, 8
    s_cmp_eq_u32 s48, 3
    s_cselect_b32 s87, 0, s87
    s_add_u32 s86, s86, s87
    s_add_u32 s86, s86, 65536
    v_lshl_add_u32 v32, v23, 4, s86
    v_mul_u32_u24 v25, 768, v22
    v_add_u32 v32, v32, v25
    s_lshl_b32 s86, s46, 10
    s_lshl_b32 s87, s48, 8
    s_add_u32 s86, s86, s87
    v_lshl_add_u32 v33, v23, 4, s86
    s_mov_b32 s90, 0
    buffer_load_dwordx4 v[40:43], v32, s[16:19], s90 offen sc1
    s_mov_b32 s90, 3072
    buffer_load_dwordx4 v[44:47], v32, s[16:19], s90 offen sc1
    s_mov_b32 s90, 6144
    buffer_load_dwordx4 v[48:51], v32, s[16:19], s90 offen sc1
    s_mov_b32 s90, 9216
    buffer_load_dwordx4 v[52:55], v32, s[16:19], s90 offen sc1
    buffer_load_dwordx4 v[56:59], v33, s[16:19], 0 offen sc1
    s_add_u32 m0, s89, 8192
    s_mov_b32 s90, 0
    buffer_load_dwordx4 v12, s[20:23], s90 offen lds
    s_add_u32 m0, s89, 12288
    s_mov_b32 s90, 65536
    buffer_load_dwordx4 v12, s[20:23], s90 offen lds
    s_add_u32 m0, s89, 16384
    s_mov_b32 s90, 131072
    buffer_load_dwordx4 v12, s[20:23], s90 offen lds
    s_add_u32 m0, s89, 20480
    s_mov_b32 s90, 196608
    buffer_load_dwordx4 v12, s[20:23], s90 offen lds
    s_add_u32 m0, s89, 24576
    s_mov_b32 s90, 262144
    buffer_load_dwordx4 v12, s[20:23], s90 offen lds
    s_add_u32 m0, s89, 28672
    s_mov_b32 s90, 327680
    buffer_load_dwordx4 v12, s[20:23], s90 offen lds
    s_add_u32 m0, s89, 32768
    s_mov_b32 s90, 393216
    buffer_load_dwordx4 v12, s[20:23], s90 offen lds
    s_add_u32 m0, s89, 36864
    s_mov_b32 s90, 458752
    buffer_load_dwordx4 v12, s[20:23], s90 offen lds
    s_waitcnt vmcnt(23)
    s_barrier
    s_add_u32 m0, s89, 40960
    s_mov_b32 s90, 524288
    buffer_load_dwordx4 v12, s[20:23], s90 offen lds
    s_add_u32 m0, s89, 45056
    s_mov_b32 s90, 589824
    buffer_load_dwordx4 v12, s[20:23], s90 offen lds
    s_add_u32 m0, s89, 49152
    s_mov_b32 s90, 655360
    buffer_load_dwordx4 v12, s[20:23], s90 offen lds
    s_add_u32 m0, s89, 53248
    s_mov_b32 s90, 720896
    buffer_load_dwordx4 v12, s[20:23], s90 offen lds
    s_add_u32 m0, s89, 57344
    s_mov_b32 s90, 786432
    buffer_load_dwordx4 v12, s[20:23], s90 offen lds
    s_add_u32 m0, s89, 61440
    s_mov_b32 s90, 851968
    buffer_load_dwordx4 v12, s[20:23], s90 offen lds
    s_add_u32 m0, s89, 65536
    s_mov_b32 s90, 917504
    buffer_load_dwordx4 v12, s[20:23], s90 offen lds
    s_add_u32 m0, s89, 69632
    s_mov_b32 s90, 983040
    buffer_load_dwordx4 v12, s[20:23], s90 offen lds
    s_add_u32 m0, s89, 73728
    s_mov_b32 s90, 1048576
    buffer_load_dwordx4 v12, s[20:23], s90 offen lds
    s_add_u32 m0, s89, 77824
    s_mov_b32 s90, 1114112
    buffer_load_dwordx4 v12, s[20:23], s90 offen lds
    s_waitcnt vmcnt(23)
    s_barrier
    s_waitcnt vmcnt(18)
    s_mov_b32 s86, 0x0c0c0400
    s_mov_b32 s87, 0x05040100
L_h0_chk:
    v_perm_b32 v60, v41, v40, s86
    v_perm_b32 v64, v43, v42, s86
    v_perm_b32 v60, v64, v60, s87
    v_perm_b32 v61, v45, v44, s86
    v_perm_b32 v65, v47, v46, s86
    v_perm_b32 v61, v65, v61, s87
    v_perm_b32 v62, v49, v48, s86
    v_perm_b32 v66, v51, v50, s86
    v_perm_b32 v62, v66, v62, s87
    v_perm_b32 v63, v53, v52, s86
    v_perm_b32 v67, v55, v54, s86
    v_perm_b32 v63, v67, v63, s87
    v_cmp_ne_u32 vcc, s61, v57
    v_cmp_ne_u32 s[4:5], s61, v59
    s_nop 0
    s_or_b64 vcc, vcc, s[4:5]
    v_cmp_ne_u32 s[4:5], s61, v60
    s_nop 0
    s_or_b64 vcc, vcc, s[4:5]
    v_cmp_ne_u32 s[4:5], s61, v61
    s_nop 0
    s_or_b64 vcc, vcc, s[4:5]
    v_cmp_ne_u32 s[4:5], s61, v62
    s_nop 0
    s_or_b64 vcc, vcc, s[4:5]
    v_cmp_ne_u32 s[4:5], s61, v63
    s_nop 0
    s_or_b64 vcc, vcc, s[4:5]
    s_cbranch_vccz L_h0_ok
    s_mov_b32 s90, 0
    buffer_load_dwordx4 v[40:43], v32, s[16:19], s90 offen sc1
    s_mov_b32 s90, 3072
    buffer_load_dwordx4 v[44:47], v32, s[16:19], s90 offen sc1
    s_mov_b32 s90, 6144
    buffer_load_dwordx4 v[48:51], v32, s[16:19], s90 offen sc1
    s_mov_b32 s90, 9216
    buffer_load_dwordx4 v[52:55], v32, s[16:19], s90 offen sc1
    buffer_load_dwordx4 v[56:59], v33, s[16:19], 0 offen sc1
    s_waitcnt vmcnt(0)
    s_sub_u32 s56, s56, 1
    s_cbranch_scc0 L_h0_chk
    s_mov_b32 s56, 0
L_h0_ok:
    v_pk_add_f32 v[40:41], v[40:41], v[44:45]
    v_pk_add_f32 v[48:49], v[48:49], v[52:53]
    v_pk_add_f32 v[40:41], v[40:41], v[48:49]
    v_pk_add_f32 v[42:43], v[42:43], v[46:47]
    v_pk_add_f32 v[50:51], v[50:51], v[54:55]
    v_pk_add_f32 v[42:43], v[42:43], v[50:51]
    v_mov_b32 v44, v40
    v_mov_b32 v45, v41
    v_mov_b32 v46, v42
    v_mov_b32 v47, v43
    v_permlane32_swap_b32 v40, v44
    v_permlane32_swap_b32 v41, v45
    v_permlane32_swap_b32 v42, v46
    v_permlane32_swap_b32 v43, v47
    v_add_f32 v40, v40, v44
    v_add_f32 v41, v41, v45
    v_add_f32 v42, v42, v46
    v_add_f32 v43, v43, v47
    v_mov_b32 v44, v40
    v_mov_b32 v45, v41
    v_mov_b32 v46, v42
    v_mov_b32 v47, v43
    v_permlane16_swap_b32 v40, v44
    v_permlane16_swap_b32 v41, v45
    v_permlane16_swap_b32 v42, v46
    v_permlane16_swap_b32 v43, v47
    v_add_f32 v40, v40, v44
    v_add_f32 v41, v41, v45
    v_add_f32 v42, v42, v46
    v_add_f32 v43, v43, v47
    s_lshl_b32 s86, s48, 8
    s_add_u32 s86, s86, 1536
    v_lshl_add_u32 v24, v23, 4, s86
    ds_write_b128 v24, v[40:43]
    v_and_b32 v46, 0xffff0000, v56
    v_and_b32 v47, 0xffff0000, v58
    v_rcp_f32 v46, v46
    v_rcp_f32 v47, v47
    v_lshlrev_b32 v44, 16, v56
    v_lshlrev_b32 v45, 16, v58
    v_sub_f32 v44, 0, v44
    v_sub_f32 v45, 0, v45
    v_mul_f32 v48, 0x3fb8aa3b, v46
    v_mul_f32 v49, 0x3fb8aa3b, v47
    s_lshl_b32 s86, s48, 7
    s_add_u32 s86, s86, 0
    v_lshl_add_u32 v24, v23, 3, s86
    ds_write_b64 v24, v[44:45]
    ds_write_b64 v24, v[46:47] offset:512
    ds_write_b64 v24, v[48:49] offset:1024
    s_waitcnt lgkmcnt(0)
    s_lshl_b32 s89, s48, 10
    s_add_u32 m0, s89, 81920
    s_mov_b32 s90, 1179648
    buffer_load_dwordx4 v12, s[20:23], s90 offen lds
    s_add_u32 m0, s89, 86016
    s_mov_b32 s90, 1245184
    buffer_load_dwordx4 v12, s[20:23], s90 offen lds
    s_add_u32 m0, s89, 90112
    s_mov_b32 s90, 1310720
    buffer_load_dwordx4 v12, s[20:23], s90 offen lds
    s_add_u32 m0, s89, 94208
    s_mov_b32 s90, 1376256
    buffer_load_dwordx4 v12, s[20:23], s90 offen lds
    s_add_u32 m0, s89, 98304
    s_mov_b32 s90, 1441792
    buffer_load_dwordx4 v12, s[20:23], s90 offen lds
    s_add_u32 m0, s89, 102400
    s_mov_b32 s90, 1507328
    buffer_load_dwordx4 v12, s[20:23], s90 offen lds
    s_add_u32 m0, s89, 106496
    s_mov_b32 s90, 1572864
    buffer_load_dwordx4 v12, s[20:23], s90 offen lds
    s_add_u32 m0, s89, 110592
    s_mov_b32 s90, 1638400
    buffer_load_dwordx4 v12, s[20:23], s90 offen lds
    s_add_u32 m0, s89, 114688
    s_mov_b32 s90, 1703936
    buffer_load_dwordx4 v12, s[20:23], s90 offen lds
    s_add_u32 m0, s89, 118784
    s_mov_b32 s90, 1769472
    buffer_load_dwordx4 v12, s[20:23], s90 offen lds
    s_barrier
    s_add_u32 m0, s89, 122880
    s_mov_b32 s90, 1835008
    buffer_load_dwordx4 v12, s[20:23], s90 offen lds
    s_add_u32 m0, s89, 126976
    s_mov_b32 s90, 1900544
    buffer_load_dwordx4 v12, s[20:23], s90 offen lds
    s_add_u32 m0, s89, 131072
    s_mov_b32 s90, 1966080
    buffer_load_dwordx4 v12, s[20:23], s90 offen lds
    s_add_u32 m0, s89, 135168
    s_mov_b32 s90, 2031616
    buffer_load_dwordx4 v12, s[20:23], s90 offen lds
    s_lshl_b32 s86, s47, 2
    s_add_u32 s86, s86, s48
    s_lshl_b32 s86, s86, 14
    s_add_u32 s86, s86, 5242880
    v_lshl_add_u32 v2, v0, 4, s86
    s_lshl_b32 s86, s47, 1
    s_add_u32 s86, s86, s50
    s_lshl_b32 s86, s86, 11
    s_add_u32 s86, s86, 7307264
    v_lshl_add_u32 v3, v23, 7, s86
    v_lshl_add_u32 v3, v22, 4, v3
    v_mov_b32 v112, 0
    v_mov_b32 v113, 0
    v_mov_b32 v114, 0
    v_mov_b32 v115, 0
    v_mov_b32 v116, 0
    v_mov_b32 v117, 0
    v_mov_b32 v118, 0
    v_mov_b32 v119, 0
    s_mov_b32 s88, 0
    s_mov_b32 s86, 0x00003f80
    s_mov_b32 s87, 0x3f800000
    s_barrier
    buffer_load_dwordx4 v[40:43], v2, s[16:19], 0 offen offset:0 sc1
    buffer_load_dwordx4 v[44:47], v2, s[16:19], 0 offen offset:1024 sc1
    buffer_load_dwordx4 v[48:51], v2, s[16:19], 0 offen offset:2048 sc1
    buffer_load_dwordx4 v[52:55], v2, s[16:19], 0 offen offset:3072 sc1
    buffer_load_dwordx4 v[56:59], v2, s[16:19], s92 offen offset:0 sc1
    buffer_load_dwordx4 v[60:63], v2, s[16:19], s92 offen offset:1024 sc1
    buffer_load_dwordx4 v[64:67], v2, s[16:19], s92 offen offset:2048 sc1
    buffer_load_dwordx4 v[68:71], v2, s[16:19], s92 offen offset:3072 sc1
    buffer_load_dwordx4 v[72:75], v2, s[16:19], s93 offen offset:0 sc1
    buffer_load_dwordx4 v[76:79], v2, s[16:19], s93 offen offset:1024 sc1
    buffer_load_dwordx4 v[80:83], v2, s[16:19], s93 offen offset:2048 sc1
    buffer_load_dwordx4 v[84:87], v2, s[16:19], s93 offen offset:3072 sc1
    buffer_load_dwordx4 v[88:91], v2, s[16:19], s94 offen offset:0 sc1
    buffer_load_dwordx4 v[92:95], v2, s[16:19], s94 offen offset:1024 sc1
    buffer_load_dwordx4 v[96:99], v2, s[16:19], s94 offen offset:2048 sc1
    buffer_load_dwordx4 v[100:103], v2, s[16:19], s94 offen offset:3072 sc1
    buffer_load_dwordx4 v[104:107], v3, s[16:19], 0 offen sc1
    buffer_load_dwordx4 v[108:111], v3, s[16:19], 0 offen offset:64 sc1
L_h1_round:
    s_bitcmp1_b32 s88, 0
    s_cbranch_scc1 L_h1_n0
    s_waitcnt vmcnt(17)
    v_cmp_eq_u32 vcc, -1, v43
    s_cbranch_vccnz L_h1_b0
    v_dot2c_f32_bf16 v112, s86, v40
    v_dot2c_f32_bf16 v113, s87, v40
    v_dot2c_f32_bf16 v114, s86, v41
    v_dot2c_f32_bf16 v115, s87, v41
    v_dot2c_f32_bf16 v116, s86, v42
    v_dot2c_f32_bf16 v117, s87, v42
    v_dot2c_f32_bf16 v118, s86, v43
    v_dot2c_f32_bf16 v119, s87, v43
    s_bitset1_b32 s88, 0
    s_branch L_h1_n0
L_h1_b0:
    buffer_load_dwordx4 v[40:43], v2, s[16:19], 0 offen offset:0 sc1
L_h1_n0:
    s_bitcmp1_b32 s88, 1
    s_cbranch_scc1 L_h1_n1
    s_waitcnt vmcnt(16)
    v_cmp_eq_u32 vcc, -1, v47
    s_cbranch_vccnz L_h1_b1
    v_dot2c_f32_bf16 v112, s86, v44
    v_dot2c_f32_bf16 v113, s87, v44
    v_dot2c_f32_bf16 v114, s86, v45
    v_dot2c_f32_bf16 v115, s87, v45
    v_dot2c_f32_bf16 v116, s86, v46
    v_dot2c_f32_bf16 v117, s87, v46
    v_dot2c_f32_bf16 v118, s86, v47
    v_dot2c_f32_bf16 v119, s87, v47
    s_bitset1_b32 s88, 1
    s_branch L_h1_n1
L_h1_b1:
    buffer_load_dwordx4 v[44:47], v2, s[16:19], 0 offen offset:1024 sc1
L_h1_n1:
    s_bitcmp1_b32 s88, 2
    s_cbranch_scc1 L_h1_n2
    s_waitcnt vmcnt(15)
    v_cmp_eq_u32 vcc, -1, v51
    s_cbranch_vccnz L_h1_b2
    v_dot2c_f32_bf16 v112, s86, v48
    v_dot2c_f32_bf16 v113, s87, v48
    v_dot2c_f32_bf16 v114, s86, v49
    v_dot2c_f32_bf16 v115, s87, v49
    v_dot2c_f32_bf16 v116, s86, v50
    v_dot2c_f32_bf16 v117, s87, v50
    v_dot2c_f32_bf16 v118, s86, v51
    v_dot2c_f32_bf16 v119, s87, v51
    s_bitset1_b32 s88, 2
    s_branch L_h1_n2
L_h1_b2:
    buffer_load_dwordx4 v[48:51], v2, s[16:19], 0 offen offset:2048 sc1
L_h1_n2:
    s_bitcmp1_b32 s88, 3
    s_cbranch_scc1 L_h1_n3
    s_waitcnt vmcnt(14)
    v_cmp_eq_u32 vcc, -1, v55
    s_cbranch_vccnz L_h1_b3
    v_dot2c_f32_bf16 v112, s86, v52
    v_dot2c_f32_bf16 v113, s87, v52
    v_dot2c_f32_bf16 v114, s86, v53
    v_dot2c_f32_bf16 v115, s87, v53
    v_dot2c_f32_bf16 v116, s86, v54
    v_dot2c_f32_bf16 v117, s87, v54
    v_dot2c_f32_bf16 v118, s86, v55
    v_dot2c_f32_bf16 v119, s87, v55
    s_bitset1_b32 s88, 3
    s_branch L_h1_n3
L_h1_b3:
    buffer_load_dwordx4 v[52:55], v2, s[16:19], 0 offen offset:3072 sc1
L_h1_n3:
    s_bitcmp1_b32 s88, 4
    s_cbranch_scc1 L_h1_n4
    s_waitcnt vmcnt(13)
    v_cmp_eq_u32 vcc, -1, v59
    s_cbranch_vccnz L_h1_b4
    v_dot2c_f32_bf16 v112, s86, v56
    v_dot2c_f32_bf16 v113, s87, v56
    v_dot2c_f32_bf16 v114, s86, v57
    v_dot2c_f32_bf16 v115, s87, v57
    v_dot2c_f32_bf16 v116, s86, v58
    v_dot2c_f32_bf16 v117, s87, v58
    v_dot2c_f32_bf16 v118, s86, v59
    v_dot2c_f32_bf16 v119, s87, v59
    s_bitset1_b32 s88, 4
    s_branch L_h1_n4
L_h1_b4:
    buffer_load_dwordx4 v[56:59], v2, s[16:19], s92 offen offset:0 sc1
L_h1_n4:
    s_bitcmp1_b32 s88, 5
    s_cbranch_scc1 L_h1_n5
    s_waitcnt vmcnt(12)
    v_cmp_eq_u32 vcc, -1, v63
    s_cbranch_vccnz L_h1_b5
    v_dot2c_f32_bf16 v112, s86, v60
    v_dot2c_f32_bf16 v113, s87, v60
    v_dot2c_f32_bf16 v114, s86, v61
    v_dot2c_f32_bf16 v115, s87, v61
    v_dot2c_f32_bf16 v116, s86, v62
    v_dot2c_f32_bf16 v117, s87, v62
    v_dot2c_f32_bf16 v118, s86, v63
    v_dot2c_f32_bf16 v119, s87, v63
    s_bitset1_b32 s88, 5
    s_branch L_h1_n5
L_h1_b5:
    buffer_load_dwordx4 v[60:63], v2, s[16:19], s92 offen offset:1024 sc1
L_h1_n5:
    s_bitcmp1_b32 s88, 6
    s_cbranch_scc1 L_h1_n6
    s_waitcnt vmcnt(11)
    v_cmp_eq_u32 vcc, -1, v67
    s_cbranch_vccnz L_h1_b6
    v_dot2c_f32_bf16 v112, s86, v64
    v_dot2c_f32_bf16 v113, s87, v64
    v_dot2c_f32_bf16 v114, s86, v65
    v_dot2c_f32_bf16 v115, s87, v65
    v_dot2c_f32_bf16 v116, s86, v66
    v_dot2c_f32_bf16 v117, s87, v66
    v_dot2c_f32_bf16 v118, s86, v67
    v_dot2c_f32_bf16 v119, s87, v67
    s_bitset1_b32 s88, 6
    s_branch L_h1_n6
L_h1_b6:
    buffer_load_dwordx4 v[64:67], v2, s[16:19], s92 offen offset:2048 sc1
L_h1_n6:
    s_bitcmp1_b32 s88, 7
    s_cbranch_scc1 L_h1_n7
    s_waitcnt vmcnt(10)
    v_cmp_eq_u32 vcc, -1, v71
    s_cbranch_vccnz L_h1_b7
    v_dot2c_f32_bf16 v112, s86, v68
    v_dot2c_f32_bf16 v113, s87, v68
    v_dot2c_f32_bf16 v114, s86, v69
    v_dot2c_f32_bf16 v115, s87, v69
    v_dot2c_f32_bf16 v116, s86, v70
    v_dot2c_f32_bf16 v117, s87, v70
    v_dot2c_f32_bf16 v118, s86, v71
    v_dot2c_f32_bf16 v119, s87, v71
    s_bitset1_b32 s88, 7
    s_branch L_h1_n7
L_h1_b7:
    buffer_load_dwordx4 v[68:71], v2, s[16:19], s92 offen offset:3072 sc1
L_h1_n7:
    s_bitcmp1_b32 s88, 8
    s_cbranch_scc1 L_h1_n8
    s_waitcnt vmcnt(9)
    v_cmp_eq_u32 vcc, -1, v75
    s_cbranch_vccnz L_h1_b8
    v_dot2c_f32_bf16 v112, s86, v72
    v_dot2c_f32_bf16 v113, s87, v72
    v_dot2c_f32_bf16 v114, s86, v73
    v_dot2c_f32_bf16 v115, s87, v73
    v_dot2c_f32_bf16 v116, s86, v74
    v_dot2c_f32_bf16 v117, s87, v74
    v_dot2c_f32_bf16 v118, s86, v75
    v_dot2c_f32_bf16 v119, s87, v75
    s_bitset1_b32 s88, 8
    s_branch L_h1_n8
L_h1_b8:
    buffer_load_dwordx4 v[72:75], v2, s[16:19], s93 offen offset:0 sc1
L_h1_n8:
    s_bitcmp1_b32 s88, 9
    s_cbranch_scc1 L_h1_n9
    s_waitcnt vmcnt(8)
    v_cmp_eq_u32 vcc, -1, v79
    s_cbranch_vccnz L_h1_b9
    v_dot2c_f32_bf16 v112, s86, v76
    v_dot2c_f32_bf16 v113, s87, v76
    v_dot2c_f32_bf16 v114, s86, v77
    v_dot2c_f32_bf16 v115, s87, v77
    v_dot2c_f32_bf16 v116, s86, v78
    v_dot2c_f32_bf16 v117, s87, v78
    v_dot2c_f32_bf16 v118, s86, v79
    v_dot2c_f32_bf16 v119, s87, v79
    s_bitset1_b32 s88, 9
    s_branch L_h1_n9
L_h1_b9:
    buffer_load_dwordx4 v[76:79], v2, s[16:19], s93 offen offset:1024 sc1
L_h1_n9:
    s_bitcmp1_b32 s88, 10
    s_cbranch_scc1 L_h1_n10
    s_waitcnt vmcnt(7)
    v_cmp_eq_u32 vcc, -1, v83
    s_cbranch_vccnz L_h1_b10
    v_dot2c_f32_bf16 v112, s86, v80
    v_dot2c_f32_bf16 v113, s87, v80
    v_dot2c_f32_bf16 v114, s86, v81
    v_dot2c_f32_bf16 v115, s87, v81
    v_dot2c_f32_bf16 v116, s86, v82
    v_dot2c_f32_bf16 v117, s87, v82
    v_dot2c_f32_bf16 v118, s86, v83
    v_dot2c_f32_bf16 v119, s87, v83
    s_bitset1_b32 s88, 10
    s_branch L_h1_n10
L_h1_b10:
    buffer_load_dwordx4 v[80:83], v2, s[16:19], s93 offen offset:2048 sc1
L_h1_n10:
    s_bitcmp1_b32 s88, 11
    s_cbranch_scc1 L_h1_n11
    s_waitcnt vmcnt(6)
    v_cmp_eq_u32 vcc, -1, v87
    s_cbranch_vccnz L_h1_b11
    v_dot2c_f32_bf16 v112, s86, v84
    v_dot2c_f32_bf16 v113, s87, v84
    v_dot2c_f32_bf16 v114, s86, v85
    v_dot2c_f32_bf16 v115, s87, v85
    v_dot2c_f32_bf16 v116, s86, v86
    v_dot2c_f32_bf16 v117, s87, v86
    v_dot2c_f32_bf16 v118, s86, v87
    v_dot2c_f32_bf16 v119, s87, v87
    s_bitset1_b32 s88, 11
    s_branch L_h1_n11
L_h1_b11:
    buffer_load_dwordx4 v[84:87], v2, s[16:19], s93 offen offset:3072 sc1
L_h1_n11:
    s_bitcmp1_b32 s88, 12
    s_cbranch_scc1 L_h1_n12
    s_waitcnt vmcnt(5)
    v_cmp_eq_u32 vcc, -1, v91
    s_cbranch_vccnz L_h1_b12
    v_dot2c_f32_bf16 v112, s86, v88
    v_dot2c_f32_bf16 v113, s87, v88
    v_dot2c_f32_bf16 v114, s86, v89
    v_dot2c_f32_bf16 v115, s87, v89
    v_dot2c_f32_bf16 v116, s86, v90
    v_dot2c_f32_bf16 v117, s87, v90
    v_dot2c_f32_bf16 v118, s86, v91
    v_dot2c_f32_bf16 v119, s87, v91
    s_bitset1_b32 s88, 12
    s_branch L_h1_n12
L_h1_b12:
    buffer_load_dwordx4 v[88:91], v2, s[16:19], s94 offen offset:0 sc1
L_h1_n12:
    s_bitcmp1_b32 s88, 13
    s_cbranch_scc1 L_h1_n13
    s_waitcnt vmcnt(4)
    v_cmp_eq_u32 vcc, -1, v95
    s_cbranch_vccnz L_h1_b13
    v_dot2c_f32_bf16 v112, s86, v92
    v_dot2c_f32_bf16 v113, s87, v92
    v_dot2c_f32_bf16 v114, s86, v93
    v_dot2c_f32_bf16 v115, s87, v93
    v_dot2c_f32_bf16 v116, s86, v94
    v_dot2c_f32_bf16 v117, s87, v94
    v_dot2c_f32_bf16 v118, s86, v95
    v_dot2c_f32_bf16 v119, s87, v95
    s_bitset1_b32 s88, 13
    s_branch L_h1_n13
L_h1_b13:
    buffer_load_dwordx4 v[92:95], v2, s[16:19], s94 offen offset:1024 sc1
L_h1_n13:
    s_bitcmp1_b32 s88, 14
    s_cbranch_scc1 L_h1_n14
    s_waitcnt vmcnt(3)
    v_cmp_eq_u32 vcc, -1, v99
    s_cbranch_vccnz L_h1_b14
    v_dot2c_f32_bf16 v112, s86, v96
    v_dot2c_f32_bf16 v113, s87, v96
    v_dot2c_f32_bf16 v114, s86, v97
    v_dot2c_f32_bf16 v115, s87, v97
    v_dot2c_f32_bf16 v116, s86, v98
    v_dot2c_f32_bf16 v117, s87, v98
    v_dot2c_f32_bf16 v118, s86, v99
    v_dot2c_f32_bf16 v119, s87, v99
    s_bitset1_b32 s88, 14
    s_branch L_h1_n14
L_h1_b14:
    buffer_load_dwordx4 v[96:99], v2, s[16:19], s94 offen offset:2048 sc1
L_h1_n14:
    s_bitcmp1_b32 s88, 15
    s_cbranch_scc1 L_h1_n15
    s_waitcnt vmcnt(2)
    v_cmp_eq_u32 vcc, -1, v103
    s_cbranch_vccnz L_h1_b15
    v_dot2c_f32_bf16 v112, s86, v100
    v_dot2c_f32_bf16 v113, s87, v100
    v_dot2c_f32_bf16 v114, s86, v101
    v_dot2c_f32_bf16 v115, s87, v101
    v_dot2c_f32_bf16 v116, s86, v102
    v_dot2c_f32_bf16 v117, s87, v102
    v_dot2c_f32_bf16 v118, s86, v103
    v_dot2c_f32_bf16 v119, s87, v103
    s_bitset1_b32 s88, 15
    s_branch L_h1_n15
L_h1_b15:
    buffer_load_dwordx4 v[100:103], v2, s[16:19], s94 offen offset:3072 sc1
L_h1_n15:
    s_bitcmp1_b32 s88, 16
    s_cbranch_scc1 L_h1_nz
    s_waitcnt vmcnt(0)
    v_max_u32 v4, v104, v108
    v_cmp_eq_u32 vcc, -1, v4
    s_cbranch_vccnz L_h1_bz
    v_add_f32_dpp v104, v104, v104 row_ror:8 row_mask:0xf bank_mask:0xf
    v_add_f32_dpp v105, v105, v105 row_ror:8 row_mask:0xf bank_mask:0xf
    v_add_f32_dpp v106, v106, v106 row_ror:8 row_mask:0xf bank_mask:0xf
    v_add_f32_dpp v107, v107, v107 row_ror:8 row_mask:0xf bank_mask:0xf
    v_add_f32_dpp v108, v108, v108 row_ror:8 row_mask:0xf bank_mask:0xf
    v_add_f32_dpp v109, v109, v109 row_ror:8 row_mask:0xf bank_mask:0xf
    v_add_f32_dpp v110, v110, v110 row_ror:8 row_mask:0xf bank_mask:0xf
    v_add_f32_dpp v111, v111, v111 row_ror:8 row_mask:0xf bank_mask:0xf
    v_add_f32_dpp v104, v104, v104 row_ror:4 row_mask:0xf bank_mask:0xf
    v_add_f32_dpp v105, v105, v105 row_ror:4 row_mask:0xf bank_mask:0xf
    v_add_f32_dpp v106, v106, v106 row_ror:4 row_mask:0xf bank_mask:0xf
    v_add_f32_dpp v107, v107, v107 row_ror:4 row_mask:0xf bank_mask:0xf
    v_add_f32_dpp v108, v108, v108 row_ror:4 row_mask:0xf bank_mask:0xf
    v_add_f32_dpp v109, v109, v109 row_ror:4 row_mask:0xf bank_mask:0xf
    v_add_f32_dpp v110, v110, v110 row_ror:4 row_mask:0xf bank_mask:0xf
    v_add_f32_dpp v111, v111, v111 row_ror:4 row_mask:0xf bank_mask:0xf
    v_add_f32_dpp v104, v104, v104 row_ror:2 row_mask:0xf bank_mask:0xf
    v_add_f32_dpp v105, v105, v105 row_ror:2 row_mask:0xf bank_mask:0xf
    v_add_f32_dpp v106, v106, v106 row_ror:2 row_mask:0xf bank_mask:0xf
    v_add_f32_dpp v107, v107, v107 row_ror:2 row_mask:0xf bank_mask:0xf
    v_add_f32_dpp v108, v108, v108 row_ror:2 row_mask:0xf bank_mask:0xf
    v_add_f32_dpp v109, v109, v109 row_ror:2 row_mask:0xf bank_mask:0xf
    v_add_f32_dpp v110, v110, v110 row_ror:2 row_mask:0xf bank_mask:0xf
    v_add_f32_dpp v111, v111, v111 row_ror:2 row_mask:0xf bank_mask:0xf
    v_add_f32_dpp v104, v104, v104 row_ror:1 row_mask:0xf bank_mask:0xf
    v_add_f32_dpp v105, v105, v105 row_ror:1 row_mask:0xf bank_mask:0xf
    v_add_f32_dpp v106, v106, v106 row_ror:1 row_mask:0xf bank_mask:0xf
    v_add_f32_dpp v107, v107, v107 row_ror:1 row_mask:0xf bank_mask:0xf
    v_add_f32_dpp v108, v108, v108 row_ror:1 row_mask:0xf bank_mask:0xf
    v_add_f32_dpp v109, v109, v109 row_ror:1 row_mask:0xf bank_mask:0xf
    v_add_f32_dpp v110, v110, v110 row_ror:1 row_mask:0xf bank_mask:0xf
    v_add_f32_dpp v111, v111, v111 row_ror:1 row_mask:0xf bank_mask:0xf
    s_bitset1_b32 s88, 16
    s_branch L_h1_nz
L_h1_bz:
    buffer_load_dwordx4 v[104:107], v3, s[16:19], 0 offen sc1
    buffer_load_dwordx4 v[108:111], v3, s[16:19], 0 offen offset:64 sc1
L_h1_nz:
    s_cmp_eq_u32 s88, 0x1ffff
    s_cbranch_scc1 L_h1_done
    s_waitcnt vmcnt(0)
    s_sub_u32 s56, s56, 1
    s_cbranch_scc0 L_h1_round
    s_mov_b32 s56, 0
L_h1_done:
    s_or_b32 s86, s2, s48
    s_cmp_eq_u32 s86, 0
    s_cselect_b32 s86, 0, 2147483648
    s_add_u32 s86, s86, 524288
    v_mov_b32 v6, s86
    v_mov_b32 v7, s61
    buffer_store_dword v7, v6, s[16:19], 0 offen sc1
    v_cvt_pk_bf16_f32 v120, v112, v113
    v_cvt_pk_bf16_f32 v121, v114, v115
    v_cvt_pk_bf16_f32 v122, v116, v117
    v_cvt_pk_bf16_f32 v123, v118, v119
    v_cvt_pk_bf16_f32 v124, v104, v105
    v_cvt_pk_bf16_f32 v125, v106, v107
    v_cvt_pk_bf16_f32 v126, v108, v109
    v_cvt_pk_bf16_f32 v127, v110, v111
    s_mul_i32 s86, s50, 3072
    s_add_u32 s86, s86, 151552
    v_lshl_add_u32 v4, v0, 4, s86
    s_lshl_b32 s86, s49, 10
    v_add_u32 v5, s86, v4
    ds_write_b128 v5, v[120:123]
    ds_write_b128 v4, v[124:127] offset:2048
    s_waitcnt vmcnt(0) lgkmcnt(0)
    s_barrier
    s_barrier
    v_mov_b32 v11, v30
    v_mov_b32 v14, v31
    s_branch L_phaseB
L_comp:
    v_and_b32 v20, 15, v0
    v_lshrrev_b32 v21, 4, v0
    v_bfe_u32 v22, v0, 1, 3
    s_lshl_b32 s86, s49, 13
    v_lshl_add_u32 v20, v20, 7, s86
    v_or_b32 v23, 0, v21
    v_xor_b32 v23, v23, v22
    v_lshl_add_u32 v2, v23, 4, v20
    v_or_b32 v23, 4, v21
    v_xor_b32 v23, v23, v22
    v_lshl_add_u32 v3, v23, 4, v20
    v_bfe_u32 v22, v0, 2, 2
    v_lshl_add_u32 v22, v21, 3, v22
    v_lshlrev_b32 v22, 7, v22
    v_bfe_u32 v23, v0, 3, 2
    s_lshl_b32 s86, s50, 1
    v_xor_b32 v23, s86, v23
    v_lshl_add_u32 v22, v23, 5, v22
    v_and_b32 v23, 3, v0
    v_lshl_add_u32 v22, v23, 3, v22
    v_add_u32 v4, 16384, v22
    v_xor_b32 v5, 32, v4
    s_lshl_b32 s53, s2, 2
    s_add_u32 s53, s53, s3
    s_mul_i32 s53, s53, 6400
    s_add_u32 s53, s53, 1048576
    v_lshl_add_u32 v6, v0, 4, s53
    v_mov_b32 v8, -1
    v_mov_b32 v9, -1
    v_mov_b32 v10, -1
    v_mov_b32 v11, -1
    s_waitcnt lgkmcnt(0)
    s_mov_b32 s16, s84
    s_and_b32 s17, s85, 0xffff
    s_mov_b32 s18, 268435456
    s_mov_b32 s19, 0x20000
    s_mov_b32 s8, s64
    s_and_b32 s9, s65, 0xffff
    s_mov_b32 s10, 4194304
    s_mov_b32 s11, 0x20000
    s_mov_b32 s20, s68
    s_and_b32 s21, s69, 0xffff
    s_mov_b32 s22, 2097152
    s_mov_b32 s23, 0x20000
    s_mov_b32 s24, s80
    s_and_b32 s25, s81, 0xffff
    s_mov_b32 s26, 4194304
    s_mov_b32 s27, 0x20000
    s_mov_b32 s28, s82
    s_and_b32 s29, s83, 0xffff
    s_mov_b32 s30, 256
    s_mov_b32 s31, 0x20000
    s_bitcmp1_b32 s2, 0
    s_cselect_b32 s32, s76, s74
    s_cselect_b32 s33, s77, s75
    s_and_b32 s33, s33, 0xffff
    s_mov_b32 s34, 7340032
    s_mov_b32 s35, 0x20000
    s_mov_b32 s36, s78
    s_and_b32 s37, s79, 0xffff
    s_mov_b32 s38, 7340032
    s_mov_b32 s39, 0x20000
    s_mov_b32 s40, s72
    s_and_b32 s41, s73, 0xffff
    s_mov_b32 s42, 2048
    s_mov_b32 s43, 0x20000
    s_mov_b32 s12, s84
    s_and_b32 s13, s85, 0xffff
    s_mov_b32 s14, 0
    s_mov_b32 s15, 0x20000
    s_add_u32 s14, s53, 6400
    v_mov_b32 v128, 0
    v_mov_b32 v129, 0
    v_mov_b32 v130, 0
    v_mov_b32 v131, 0
    v_mov_b32 v132, 0
    v_mov_b32 v133, 0
    v_mov_b32 v134, 0
    v_mov_b32 v135, 0
    v_mov_b32 v136, 0
    v_mov_b32 v137, 0
    v_mov_b32 v138, 0
    v_mov_b32 v139, 0
    v_mov_b32 v140, 0
    v_mov_b32 v141, 0
    v_mov_b32 v142, 0
    v_mov_b32 v143, 0
    v_mov_b32 v144, 0
    v_mov_b32 v145, 0
    v_mov_b32 v146, 0
    v_mov_b32 v147, 0
    v_mov_b32 v148, 0
    v_mov_b32 v149, 0
    v_mov_b32 v150, 0
    v_mov_b32 v151, 0
    v_mov_b32 v152, 0
    v_mov_b32 v153, 0
    v_mov_b32 v154, 0
    v_mov_b32 v155, 0
    v_mov_b32 v156, 0
    v_mov_b32 v157, 0
    v_mov_b32 v158, 0
    v_mov_b32 v159, 0
    v_mov_b32 v160, 0
    v_mov_b32 v161, 0
    v_mov_b32 v162, 0
    v_mov_b32 v163, 0
    v_mov_b32 v164, 0
    v_mov_b32 v165, 0
    v_mov_b32 v166, 0
    v_mov_b32 v167, 0
    v_mov_b32 v168, 0
    v_mov_b32 v169, 0
    v_mov_b32 v170, 0
    v_mov_b32 v171, 0
    v_mov_b32 v172, 0
    v_mov_b32 v173, 0
    v_mov_b32 v174, 0
    v_mov_b32 v175, 0
    v_mov_b32 v176, 0
    v_mov_b32 v177, 0
    v_mov_b32 v178, 0
    v_mov_b32 v179, 0
    v_mov_b32 v180, 0
    v_mov_b32 v181, 0
    v_mov_b32 v182, 0
    v_mov_b32 v183, 0
    v_mov_b32 v184, 0
    v_mov_b32 v185, 0
    v_mov_b32 v186, 0
    v_mov_b32 v187, 0
    v_mov_b32 v188, 0
    v_mov_b32 v189, 0
    v_mov_b32 v190, 0
    v_mov_b32 v191, 0
    v_mov_b32 v192, 0
    v_mov_b32 v193, 0
    v_mov_b32 v194, 0
    v_mov_b32 v195, 0
    v_mov_b32 v196, 0
    v_mov_b32 v197, 0
    v_mov_b32 v198, 0
    v_mov_b32 v199, 0
    v_mov_b32 v200, 0
    v_mov_b32 v201, 0
    v_mov_b32 v202, 0
    v_mov_b32 v203, 0
    v_mov_b32 v204, 0
    v_mov_b32 v205, 0
    v_mov_b32 v206, 0
    v_mov_b32 v207, 0
    v_mov_b32 v208, 0
    v_mov_b32 v209, 0
    v_mov_b32 v210, 0
    v_mov_b32 v211, 0
    v_mov_b32 v212, 0
    v_mov_b32 v213, 0
    v_mov_b32 v214, 0
    v_mov_b32 v215, 0
    v_mov_b32 v216, 0
    v_mov_b32 v217, 0
    v_mov_b32 v218, 0
    v_mov_b32 v219, 0
    v_mov_b32 v220, 0
    v_mov_b32 v221, 0
    v_mov_b32 v222, 0
    v_mov_b32 v223, 0
    s_mov_b32 s54, 0x358637bd
    s_mov_b32 s55, 0x358637bd
    s_mov_b32 s62, 0
    s_mov_b32 s63, 0
    s_barrier
    ds_read_b128 v[40:43], v2 offset:0
    ds_read_b128 v[44:47], v2 offset:2048
    ds_read_b128 v[48:51], v2 offset:4096
    ds_read_b128 v[52:55], v2 offset:6144
    ds_read_b64_tr_b16 v[56:57], v4 offset:0
    ds_read_b64_tr_b16 v[58:59], v4 offset:512
    ds_read_b64_tr_b16 v[60:61], v5 offset:0
    ds_read_b64_tr_b16 v[62:63], v5 offset:512
    ds_read_b64_tr_b16 v[64:65], v4 offset:8192
    ds_read_b64_tr_b16 v[66:67], v4 offset:8704
    ds_read_b64_tr_b16 v[68:69], v5 offset:8192
    ds_read_b64_tr_b16 v[70:71], v5 offset:8704
    ds_read_b64_tr_b16 v[72:73], v4 offset:16384
    ds_read_b64_tr_b16 v[74:75], v4 offset:16896
    ds_read_b64_tr_b16 v[76:77], v5 offset:16384
    ds_read_b64_tr_b16 v[78:79], v5 offset:16896
L_cloop:
    s_waitcnt lgkmcnt(0)
    v_mfma_f32_16x16x32_bf16 v[128:131], v[56:59], v[40:43], v[128:131]
    ds_read_b128 v[80:83], v3 offset:0
    v_mfma_f32_16x16x32_bf16 v[132:135], v[56:59], v[44:47], v[132:135]
    ds_read_b128 v[84:87], v3 offset:2048
    v_mfma_f32_16x16x32_bf16 v[136:139], v[56:59], v[48:51], v[136:139]
    ds_read_b128 v[88:91], v3 offset:4096
    v_mfma_f32_16x16x32_bf16 v[140:143], v[56:59], v[52:55], v[140:143]
    ds_read_b128 v[92:95], v3 offset:6144
    v_mfma_f32_16x16x32_bf16 v[144:147], v[60:63], v[40:43], v[144:147]
    ds_read_b64_tr_b16 v[96:97], v4 offset:4096
    v_mfma_f32_16x16x32_bf16 v[148:151], v[60:63], v[44:47], v[148:151]
    ds_read_b64_tr_b16 v[98:99], v4 offset:4608
    v_mfma_f32_16x16x32_bf16 v[152:155], v[60:63], v[48:51], v[152:155]
    ds_read_b64_tr_b16 v[100:101], v5 offset:4096
    v_mfma_f32_16x16x32_bf16 v[156:159], v[60:63], v[52:55], v[156:159]
    ds_read_b64_tr_b16 v[102:103], v5 offset:4608
    v_mfma_f32_16x16x32_bf16 v[160:163], v[40:43], v[64:67], v[160:163]
    ds_read_b64_tr_b16 v[104:105], v4 offset:12288
    v_mfma_f32_16x16x32_bf16 v[164:167], v[44:47], v[64:67], v[164:167]
    ds_read_b64_tr_b16 v[106:107], v4 offset:12800
    v_mfma_f32_16x16x32_bf16 v[168:171], v[48:51], v[64:67], v[168:171]
    ds_read_b64_tr_b16 v[108:109], v5 offset:12288
    v_mfma_f32_16x16x32_bf16 v[172:175], v[52:55], v[64:67], v[172:175]
    ds_read_b64_tr_b16 v[110:111], v5 offset:12800
    v_mfma_f32_16x16x32_bf16 v[176:179], v[40:43], v[68:71], v[176:179]
    ds_read_b64_tr_b16 v[112:113], v4 offset:20480
    v_mfma_f32_16x16x32_bf16 v[180:183], v[44:47], v[68:71], v[180:183]
    ds_read_b64_tr_b16 v[114:115], v4 offset:20992
    v_mfma_f32_16x16x32_bf16 v[184:187], v[48:51], v[68:71], v[184:187]
    ds_read_b64_tr_b16 v[116:117], v5 offset:20480
    v_mfma_f32_16x16x32_bf16 v[188:191], v[52:55], v[68:71], v[188:191]
    ds_read_b64_tr_b16 v[118:119], v5 offset:20992
    v_mfma_f32_16x16x32_bf16 v[192:195], v[40:43], v[72:75], v[192:195]
    s_add_u32 s63, s63, 1
    s_cmp_eq_u32 s63, 4
    s_cselect_b32 s53, 4294803456, 0
    s_cselect_b32 s63, 0, s63
    s_add_u32 s53, s53, 40960
    v_mfma_f32_16x16x32_bf16 v[196:199], v[44:47], v[72:75], v[196:199]
    v_add_u32 v2, s53, v2
    v_mfma_f32_16x16x32_bf16 v[200:203], v[48:51], v[72:75], v[200:203]
    v_add_u32 v4, s53, v4
    v_mfma_f32_16x16x32_bf16 v[204:207], v[52:55], v[72:75], v[204:207]
    v_add_u32 v5, s53, v5
    v_mfma_f32_16x16x32_bf16 v[208:211], v[40:43], v[76:79], v[208:211]
    v_add_u32 v3, s53, v3
    v_mfma_f32_16x16x32_bf16 v[212:215], v[44:47], v[76:79], v[212:215]
    s_cmp_ge_u32 s62, 4
    s_cbranch_scc1 L_cl_none
    buffer_store_dwordx4 v[8:11], v6, s[12:15], 0 offen offset:0 sc1
    buffer_store_dwordx4 v[8:11], v6, s[12:15], 0 offen offset:1024 sc1
    v_add_u32 v6, 2048, v6
L_cl_none:
    v_mfma_f32_16x16x32_bf16 v[216:219], v[48:51], v[76:79], v[216:219]
    v_mfma_f32_16x16x32_bf16 v[220:223], v[52:55], v[76:79], v[220:223]
    s_waitcnt lgkmcnt(0)
    v_mfma_f32_16x16x32_bf16 v[128:131], v[96:99], v[80:83], v[128:131]
    s_barrier
    ds_read_b128 v[40:43], v2 offset:0
    v_mfma_f32_16x16x32_bf16 v[132:135], v[96:99], v[84:87], v[132:135]
    ds_read_b128 v[44:47], v2 offset:2048
    v_mfma_f32_16x16x32_bf16 v[136:139], v[96:99], v[88:91], v[136:139]
    ds_read_b128 v[48:51], v2 offset:4096
    v_mfma_f32_16x16x32_bf16 v[140:143], v[96:99], v[92:95], v[140:143]
    ds_read_b128 v[52:55], v2 offset:6144
    v_mfma_f32_16x16x32_bf16 v[144:147], v[100:103], v[80:83], v[144:147]
    ds_read_b64_tr_b16 v[56:57], v4 offset:0
    v_mfma_f32_16x16x32_bf16 v[148:151], v[100:103], v[84:87], v[148:151]
    ds_read_b64_tr_b16 v[58:59], v4 offset:512
    v_mfma_f32_16x16x32_bf16 v[152:155], v[100:103], v[88:91], v[152:155]
    ds_read_b64_tr_b16 v[60:61], v5 offset:0
    v_mfma_f32_16x16x32_bf16 v[156:159], v[100:103], v[92:95], v[156:159]
    ds_read_b64_tr_b16 v[62:63], v5 offset:512
    v_mfma_f32_16x16x32_bf16 v[160:163], v[80:83], v[104:107], v[160:163]
    ds_read_b64_tr_b16 v[64:65], v4 offset:8192
    v_mfma_f32_16x16x32_bf16 v[164:167], v[84:87], v[104:107], v[164:167]
    ds_read_b64_tr_b16 v[66:67], v4 offset:8704
    v_mfma_f32_16x16x32_bf16 v[168:171], v[88:91], v[104:107], v[168:171]
    ds_read_b64_tr_b16 v[68:69], v5 offset:8192
    v_mfma_f32_16x16x32_bf16 v[172:175], v[92:95], v[104:107], v[172:175]
    ds_read_b64_tr_b16 v[70:71], v5 offset:8704
    v_mfma_f32_16x16x32_bf16 v[176:179], v[80:83], v[108:111], v[176:179]
    ds_read_b64_tr_b16 v[72:73], v4 offset:16384
    v_mfma_f32_16x16x32_bf16 v[180:183], v[84:87], v[108:111], v[180:183]
    ds_read_b64_tr_b16 v[74:75], v4 offset:16896
    v_mfma_f32_16x16x32_bf16 v[184:187], v[88:91], v[108:111], v[184:187]
    ds_read_b64_tr_b16 v[76:77], v5 offset:16384
    v_mfma_f32_16x16x32_bf16 v[188:191], v[92:95], v[108:111], v[188:191]
    ds_read_b64_tr_b16 v[78:79], v5 offset:16896
    v_mfma_f32_16x16x32_bf16 v[192:195], v[80:83], v[112:115], v[192:195]
    v_mfma_f32_16x16x32_bf16 v[196:199], v[84:87], v[112:115], v[196:199]
    s_cmp_lg_u32 s62, 5
    s_cbranch_scc1 L_cl_nw
    s_waitcnt vmcnt(0)
L_cl_nw:
    v_mfma_f32_16x16x32_bf16 v[200:203], v[88:91], v[112:115], v[200:203]
    v_mfma_f32_16x16x32_bf16 v[204:207], v[92:95], v[112:115], v[204:207]
    v_mfma_f32_16x16x32_bf16 v[208:211], v[80:83], v[116:119], v[208:211]
    s_add_u32 s62, s62, 1
    v_mfma_f32_16x16x32_bf16 v[212:215], v[84:87], v[116:119], v[212:215]
    v_mfma_f32_16x16x32_bf16 v[216:219], v[88:91], v[116:119], v[216:219]
    v_mfma_f32_16x16x32_bf16 v[220:223], v[92:95], v[116:119], v[220:223]
    s_cmp_lt_u32 s62, 15
    s_cbranch_scc1 L_cloop
    s_waitcnt lgkmcnt(0)
    v_mfma_f32_16x16x32_bf16 v[128:131], v[56:59], v[40:43], v[128:131]
    ds_read_b128 v[80:83], v3 offset:0
    v_mfma_f32_16x16x32_bf16 v[132:135], v[56:59], v[44:47], v[132:135]
    ds_read_b128 v[84:87], v3 offset:2048
    v_mfma_f32_16x16x32_bf16 v[136:139], v[56:59], v[48:51], v[136:139]
    ds_read_b128 v[88:91], v3 offset:4096
    v_mfma_f32_16x16x32_bf16 v[140:143], v[56:59], v[52:55], v[140:143]
    ds_read_b128 v[92:95], v3 offset:6144
    v_mfma_f32_16x16x32_bf16 v[144:147], v[60:63], v[40:43], v[144:147]
    ds_read_b64_tr_b16 v[96:97], v4 offset:4096
    v_mfma_f32_16x16x32_bf16 v[148:151], v[60:63], v[44:47], v[148:151]
    ds_read_b64_tr_b16 v[98:99], v4 offset:4608
    v_mfma_f32_16x16x32_bf16 v[152:155], v[60:63], v[48:51], v[152:155]
    ds_read_b64_tr_b16 v[100:101], v5 offset:4096
    v_mfma_f32_16x16x32_bf16 v[156:159], v[60:63], v[52:55], v[156:159]
    ds_read_b64_tr_b16 v[102:103], v5 offset:4608
    v_mfma_f32_16x16x32_bf16 v[160:163], v[40:43], v[64:67], v[160:163]
    ds_read_b64_tr_b16 v[104:105], v4 offset:12288
    v_mfma_f32_16x16x32_bf16 v[164:167], v[44:47], v[64:67], v[164:167]
    ds_read_b64_tr_b16 v[106:107], v4 offset:12800
    v_mfma_f32_16x16x32_bf16 v[168:171], v[48:51], v[64:67], v[168:171]
    ds_read_b64_tr_b16 v[108:109], v5 offset:12288
    v_mfma_f32_16x16x32_bf16 v[172:175], v[52:55], v[64:67], v[172:175]
    ds_read_b64_tr_b16 v[110:111], v5 offset:12800
    v_mfma_f32_16x16x32_bf16 v[176:179], v[40:43], v[68:71], v[176:179]
    ds_read_b64_tr_b16 v[112:113], v4 offset:20480
    v_mfma_f32_16x16x32_bf16 v[180:183], v[44:47], v[68:71], v[180:183]
    ds_read_b64_tr_b16 v[114:115], v4 offset:20992
    v_mfma_f32_16x16x32_bf16 v[184:187], v[48:51], v[68:71], v[184:187]
    ds_read_b64_tr_b16 v[116:117], v5 offset:20480
    v_mfma_f32_16x16x32_bf16 v[188:191], v[52:55], v[68:71], v[188:191]
    ds_read_b64_tr_b16 v[118:119], v5 offset:20992
    v_mfma_f32_16x16x32_bf16 v[192:195], v[40:43], v[72:75], v[192:195]
    v_lshrrev_b32 v21, 4, v0
    v_and_b32 v22, 15, v0
    v_mfma_f32_16x16x32_bf16 v[196:199], v[44:47], v[72:75], v[196:199]
    s_lshl_b32 s86, s49, 8
    s_add_u32 s86, s86, 0
    v_lshl_add_u32 v6, v21, 4, s86
    v_mfma_f32_16x16x32_bf16 v[200:203], v[48:51], v[72:75], v[200:203]
    v_lshl_add_u32 v7, v22, 2, s86
    v_mfma_f32_16x16x32_bf16 v[204:207], v[52:55], v[72:75], v[204:207]
    s_lshl_b32 s86, s50, 7
    s_add_u32 s86, s86, 1536
    v_lshl_add_u32 v8, v22, 2, s86
    v_mfma_f32_16x16x32_bf16 v[208:211], v[40:43], v[76:79], v[208:211]
    v_lshl_add_u32 v9, v21, 4, s86
    v_mfma_f32_16x16x32_bf16 v[212:215], v[44:47], v[76:79], v[212:215]
    v_mfma_f32_16x16x32_bf16 v[216:219], v[48:51], v[76:79], v[216:219]
    v_mfma_f32_16x16x32_bf16 v[220:223], v[52:55], v[76:79], v[220:223]
    s_waitcnt lgkmcnt(0)
    v_mfma_f32_16x16x32_bf16 v[160:163], v[80:83], v[104:107], v[160:163]
    s_barrier
    ds_read_b128 v[40:43], v6 offset:0
    v_mfma_f32_16x16x32_bf16 v[164:167], v[84:87], v[104:107], v[164:167]
    ds_read_b128 v[44:47], v6 offset:64
    v_mfma_f32_16x16x32_bf16 v[168:171], v[88:91], v[104:107], v[168:171]
    ds_read_b128 v[48:51], v6 offset:128
    v_mfma_f32_16x16x32_bf16 v[172:175], v[92:95], v[104:107], v[172:175]
    ds_read_b128 v[52:55], v6 offset:192
    v_mfma_f32_16x16x32_bf16 v[176:179], v[80:83], v[108:111], v[176:179]
    ds_read_b32 v72, v8 offset:256
    v_mfma_f32_16x16x32_bf16 v[180:183], v[84:87], v[108:111], v[180:183]
    ds_read_b32 v73, v8 offset:320
    v_mfma_f32_16x16x32_bf16 v[184:187], v[88:91], v[108:111], v[184:187]
    ds_read_b32 v74, v8 offset:512
    v_mfma_f32_16x16x32_bf16 v[188:191], v[92:95], v[108:111], v[188:191]
    ds_read_b32 v75, v8 offset:576
    v_mfma_f32_16x16x32_bf16 v[192:195], v[80:83], v[112:115], v[192:195]
    ds_read_b128 v[56:59], v6 offset:512
    v_mfma_f32_16x16x32_bf16 v[196:199], v[84:87], v[112:115], v[196:199]
    ds_read_b128 v[60:63], v6 offset:576
    v_mfma_f32_16x16x32_bf16 v[200:203], v[88:91], v[112:115], v[200:203]
    ds_read_b128 v[64:67], v6 offset:640
    v_mfma_f32_16x16x32_bf16 v[204:207], v[92:95], v[112:115], v[204:207]
    ds_read_b128 v[68:71], v6 offset:704
    v_mfma_f32_16x16x32_bf16 v[208:211], v[80:83], v[116:119], v[208:211]
    ds_read_b128 v[224:227], v6 offset:1024
    v_mfma_f32_16x16x32_bf16 v[212:215], v[84:87], v[116:119], v[212:215]
    ds_read_b128 v[228:231], v6 offset:1088
    v_mfma_f32_16x16x32_bf16 v[216:219], v[88:91], v[116:119], v[216:219]
    ds_read_b128 v[232:235], v6 offset:1152
    v_mfma_f32_16x16x32_bf16 v[220:223], v[92:95], v[116:119], v[220:223]
    ds_read_b128 v[236:239], v6 offset:1216
    v_mfma_f32_16x16x32_bf16 v[128:131], v[96:99], v[80:83], v[128:131]
    ds_read_b128 v[28:31], v9 offset:0
    v_mfma_f32_16x16x32_bf16 v[132:135], v[96:99], v[84:87], v[132:135]
    ds_read_b128 v[32:35], v9 offset:64
    v_mfma_f32_16x16x32_bf16 v[136:139], v[96:99], v[88:91], v[136:139]
    v_mfma_f32_16x16x32_bf16 v[140:143], v[96:99], v[92:95], v[140:143]
    v_mfma_f32_16x16x32_bf16 v[144:147], v[100:103], v[80:83], v[144:147]
    v_mfma_f32_16x16x32_bf16 v[148:151], v[100:103], v[84:87], v[148:151]
    v_mfma_f32_16x16x32_bf16 v[152:155], v[100:103], v[88:91], v[152:155]
    v_mfma_f32_16x16x32_bf16 v[156:159], v[100:103], v[92:95], v[156:159]
    ds_read_b32 v240, v7 offset:0
    ds_read_b32 v244, v7 offset:512
    ds_read_b32 v248, v7 offset:1024
    ds_read_b32 v241, v7 offset:64
    ds_read_b32 v245, v7 offset:576
    ds_read_b32 v249, v7 offset:1088
    ds_read_b32 v242, v7 offset:128
    ds_read_b32 v246, v7 offset:640
    ds_read_b32 v250, v7 offset:1152
    ds_read_b32 v243, v7 offset:192
    ds_read_b32 v247, v7 offset:704
    ds_read_b32 v251, v7 offset:1216
    s_waitcnt lgkmcnt(12)
    v_pk_fma_f32 v[160:161], v[40:41], v[72:73], v[160:161] op_sel_hi:[1,0,1]
    v_pk_mul_f32 v[112:113], v[160:161], v[224:225]
    v_pk_fma_f32 v[160:161], v[160:161], v[56:57], s[54:55]
    v_exp_f32 v112, v112 clamp
    v_exp_f32 v113, v113 clamp
    v_max_f32 v160, s54, v160
    v_max_f32 v161, s54, v161
    v_pk_add_f32 v[160:161], v[160:161], v[112:113]
    v_cvt_pk_bf16_f32 v80, v160, v161
    v_pk_fma_f32 v[162:163], v[42:43], v[72:73], v[162:163] op_sel_hi:[1,0,1]
    v_pk_mul_f32 v[114:115], v[162:163], v[226:227]
    v_pk_fma_f32 v[162:163], v[162:163], v[58:59], s[54:55]
    v_exp_f32 v114, v114 clamp
    v_exp_f32 v115, v115 clamp
    v_max_f32 v162, s54, v162
    v_max_f32 v163, s54, v163
    v_pk_add_f32 v[162:163], v[162:163], v[114:115]
    v_cvt_pk_bf16_f32 v81, v162, v163
    v_pk_fma_f32 v[164:165], v[44:45], v[72:73], v[164:165] op_sel_hi:[1,0,1]
    v_pk_mul_f32 v[116:117], v[164:165], v[228:229]
    v_pk_fma_f32 v[164:165], v[164:165], v[60:61], s[54:55]
    v_exp_f32 v116, v116 clamp
    v_exp_f32 v117, v117 clamp
    v_max_f32 v164, s54, v164
    v_max_f32 v165, s54, v165
    v_pk_add_f32 v[164:165], v[164:165], v[116:117]
    v_cvt_pk_bf16_f32 v82, v164, v165
    v_pk_fma_f32 v[166:167], v[46:47], v[72:73], v[166:167] op_sel_hi:[1,0,1]
    v_pk_mul_f32 v[118:119], v[166:167], v[230:231]
    v_pk_fma_f32 v[166:167], v[166:167], v[62:63], s[54:55]
    v_exp_f32 v118, v118 clamp
    v_exp_f32 v119, v119 clamp
    v_max_f32 v166, s54, v166
    v_max_f32 v167, s54, v167
    v_pk_add_f32 v[166:167], v[166:167], v[118:119]
    v_cvt_pk_bf16_f32 v83, v166, v167
    v_pk_fma_f32 v[168:169], v[48:49], v[72:73], v[168:169] op_sel_hi:[1,0,1]
    v_pk_mul_f32 v[112:113], v[168:169], v[232:233]
    v_pk_fma_f32 v[168:169], v[168:169], v[64:65], s[54:55]
    v_exp_f32 v112, v112 clamp
    v_exp_f32 v113, v113 clamp
    v_max_f32 v168, s54, v168
    v_max_f32 v169, s54, v169
    v_pk_add_f32 v[168:169], v[168:169], v[112:113]
    v_cvt_pk_bf16_f32 v84, v168, v169
    v_pk_fma_f32 v[170:171], v[50:51], v[72:73], v[170:171] op_sel_hi:[1,0,1]
    v_pk_mul_f32 v[114:115], v[170:171], v[234:235]
    v_pk_fma_f32 v[170:171], v[170:171], v[66:67], s[54:55]
    v_exp_f32 v114, v114 clamp
    v_exp_f32 v115, v115 clamp
    v_max_f32 v170, s54, v170
    v_max_f32 v171, s54, v171
    v_pk_add_f32 v[170:171], v[170:171], v[114:115]
    v_cvt_pk_bf16_f32 v85, v170, v171
    v_pk_fma_f32 v[172:173], v[52:53], v[72:73], v[172:173] op_sel_hi:[1,0,1]
    v_pk_mul_f32 v[116:117], v[172:173], v[236:237]
    v_pk_fma_f32 v[172:173], v[172:173], v[68:69], s[54:55]
    v_exp_f32 v116, v116 clamp
    v_exp_f32 v117, v117 clamp
    v_max_f32 v172, s54, v172
    v_max_f32 v173, s54, v173
    v_pk_add_f32 v[172:173], v[172:173], v[116:117]
    v_cvt_pk_bf16_f32 v86, v172, v173
    v_pk_fma_f32 v[174:175], v[54:55], v[72:73], v[174:175] op_sel_hi:[1,0,1]
    v_pk_mul_f32 v[118:119], v[174:175], v[238:239]
    v_pk_fma_f32 v[174:175], v[174:175], v[70:71], s[54:55]
    v_exp_f32 v118, v118 clamp
    v_exp_f32 v119, v119 clamp
    v_max_f32 v174, s54, v174
    v_max_f32 v175, s54, v175
    v_pk_add_f32 v[174:175], v[174:175], v[118:119]
    v_cvt_pk_bf16_f32 v87, v174, v175
    v_pk_fma_f32 v[176:177], v[40:41], v[72:73], v[176:177] op_sel:[0,1,0] op_sel_hi:[1,1,1]
    v_pk_mul_f32 v[112:113], v[176:177], v[224:225]
    v_pk_fma_f32 v[176:177], v[176:177], v[56:57], s[54:55]
    v_exp_f32 v112, v112 clamp
    v_exp_f32 v113, v113 clamp
    v_max_f32 v176, s54, v176
    v_max_f32 v177, s54, v177
    v_pk_add_f32 v[176:177], v[176:177], v[112:113]
    v_cvt_pk_bf16_f32 v88, v176, v177
    v_pk_fma_f32 v[178:179], v[42:43], v[72:73], v[178:179] op_sel:[0,1,0] op_sel_hi:[1,1,1]
    v_pk_mul_f32 v[114:115], v[178:179], v[226:227]
    v_pk_fma_f32 v[178:179], v[178:179], v[58:59], s[54:55]
    v_exp_f32 v114, v114 clamp
    v_exp_f32 v115, v115 clamp
    v_max_f32 v178, s54, v178
    v_max_f32 v179, s54, v179
    v_pk_add_f32 v[178:179], v[178:179], v[114:115]
    v_cvt_pk_bf16_f32 v89, v178, v179
    v_pk_fma_f32 v[180:181], v[44:45], v[72:73], v[180:181] op_sel:[0,1,0] op_sel_hi:[1,1,1]
    v_pk_mul_f32 v[116:117], v[180:181], v[228:229]
    v_pk_fma_f32 v[180:181], v[180:181], v[60:61], s[54:55]
    v_exp_f32 v116, v116 clamp
    v_exp_f32 v117, v117 clamp
    v_max_f32 v180, s54, v180
    v_max_f32 v181, s54, v181
    v_pk_add_f32 v[180:181], v[180:181], v[116:117]
    v_cvt_pk_bf16_f32 v90, v180, v181
    v_pk_fma_f32 v[182:183], v[46:47], v[72:73], v[182:183] op_sel:[0,1,0] op_sel_hi:[1,1,1]
    v_pk_mul_f32 v[118:119], v[182:183], v[230:231]
    v_pk_fma_f32 v[182:183], v[182:183], v[62:63], s[54:55]
    v_exp_f32 v118, v118 clamp
    v_exp_f32 v119, v119 clamp
    v_max_f32 v182, s54, v182
    v_max_f32 v183, s54, v183
    v_pk_add_f32 v[182:183], v[182:183], v[118:119]
    v_cvt_pk_bf16_f32 v91, v182, v183
    v_pk_fma_f32 v[184:185], v[48:49], v[72:73], v[184:185] op_sel:[0,1,0] op_sel_hi:[1,1,1]
    v_pk_mul_f32 v[112:113], v[184:185], v[232:233]
    v_pk_fma_f32 v[184:185], v[184:185], v[64:65], s[54:55]
    v_exp_f32 v112, v112 clamp
    v_exp_f32 v113, v113 clamp
    v_max_f32 v184, s54, v184
    v_max_f32 v185, s54, v185
    v_pk_add_f32 v[184:185], v[184:185], v[112:113]
    v_cvt_pk_bf16_f32 v92, v184, v185
    v_pk_fma_f32 v[186:187], v[50:51], v[72:73], v[186:187] op_sel:[0,1,0] op_sel_hi:[1,1,1]
    v_pk_mul_f32 v[114:115], v[186:187], v[234:235]
    v_pk_fma_f32 v[186:187], v[186:187], v[66:67], s[54:55]
    v_exp_f32 v114, v114 clamp
    v_exp_f32 v115, v115 clamp
    v_max_f32 v186, s54, v186
    v_max_f32 v187, s54, v187
    v_pk_add_f32 v[186:187], v[186:187], v[114:115]
    v_cvt_pk_bf16_f32 v93, v186, v187
    v_pk_fma_f32 v[188:189], v[52:53], v[72:73], v[188:189] op_sel:[0,1,0] op_sel_hi:[1,1,1]
    v_pk_mul_f32 v[116:117], v[188:189], v[236:237]
    v_pk_fma_f32 v[188:189], v[188:189], v[68:69], s[54:55]
    v_exp_f32 v116, v116 clamp
    v_exp_f32 v117, v117 clamp
    v_max_f32 v188, s54, v188
    v_max_f32 v189, s54, v189
    v_pk_add_f32 v[188:189], v[188:189], v[116:117]
    v_cvt_pk_bf16_f32 v94, v188, v189
    v_pk_fma_f32 v[190:191], v[54:55], v[72:73], v[190:191] op_sel:[0,1,0] op_sel_hi:[1,1,1]
    v_pk_mul_f32 v[118:119], v[190:191], v[238:239]
    v_pk_fma_f32 v[190:191], v[190:191], v[70:71], s[54:55]
    v_exp_f32 v118, v118 clamp
    v_exp_f32 v119, v119 clamp
    v_max_f32 v190, s54, v190
    v_max_f32 v191, s54, v191
    v_pk_add_f32 v[190:191], v[190:191], v[118:119]
    v_cvt_pk_bf16_f32 v95, v190, v191
    v_mov_b32 v120, s95
    v_mov_b32 v121, s95
    v_mov_b32 v122, s95
    v_mov_b32 v123, s95
    v_pk_fma_f32 v[192:193], v[40:41], v[74:75], v[192:193] op_sel_hi:[1,0,1]
    v_pk_mul_f32 v[192:193], v[192:193], v[56:57]
    v_cvt_pk_bf16_f32 v96, v192, v193
    v_pk_fma_f32 v[194:195], v[42:43], v[74:75], v[194:195] op_sel_hi:[1,0,1]
    v_pk_mul_f32 v[194:195], v[194:195], v[58:59]
    v_cvt_pk_bf16_f32 v97, v194, v195
    v_pk_fma_f32 v[196:197], v[44:45], v[74:75], v[196:197] op_sel_hi:[1,0,1]
    v_pk_mul_f32 v[196:197], v[196:197], v[60:61]
    v_cvt_pk_bf16_f32 v98, v196, v197
    v_pk_fma_f32 v[198:199], v[46:47], v[74:75], v[198:199] op_sel_hi:[1,0,1]
    v_pk_mul_f32 v[198:199], v[198:199], v[62:63]
    v_cvt_pk_bf16_f32 v99, v198, v199
    v_pk_fma_f32 v[200:201], v[48:49], v[74:75], v[200:201] op_sel_hi:[1,0,1]
    v_pk_mul_f32 v[200:201], v[200:201], v[64:65]
    v_cvt_pk_bf16_f32 v100, v200, v201
    v_pk_fma_f32 v[202:203], v[50:51], v[74:75], v[202:203] op_sel_hi:[1,0,1]
    v_pk_mul_f32 v[202:203], v[202:203], v[66:67]
    v_cvt_pk_bf16_f32 v101, v202, v203
    v_pk_fma_f32 v[204:205], v[52:53], v[74:75], v[204:205] op_sel_hi:[1,0,1]
    v_pk_mul_f32 v[204:205], v[204:205], v[68:69]
    v_cvt_pk_bf16_f32 v102, v204, v205
    v_pk_fma_f32 v[206:207], v[54:55], v[74:75], v[206:207] op_sel_hi:[1,0,1]
    v_pk_mul_f32 v[206:207], v[206:207], v[70:71]
    v_cvt_pk_bf16_f32 v103, v206, v207
    v_pk_fma_f32 v[208:209], v[40:41], v[74:75], v[208:209] op_sel:[0,1,0] op_sel_hi:[1,1,1]
    v_pk_mul_f32 v[208:209], v[208:209], v[56:57]
    v_cvt_pk_bf16_f32 v104, v208, v209
    v_pk_fma_f32 v[210:211], v[42:43], v[74:75], v[210:211] op_sel:[0,1,0] op_sel_hi:[1,1,1]
    v_pk_mul_f32 v[210:211], v[210:211], v[58:59]
    v_cvt_pk_bf16_f32 v105, v210, v211
    v_pk_fma_f32 v[212:213], v[44:45], v[74:75], v[212:213] op_sel:[0,1,0] op_sel_hi:[1,1,1]
    v_pk_mul_f32 v[212:213], v[212:213], v[60:61]
    v_cvt_pk_bf16_f32 v106, v212, v213
    v_pk_fma_f32 v[214:215], v[46:47], v[74:75], v[214:215] op_sel:[0,1,0] op_sel_hi:[1,1,1]
    v_pk_mul_f32 v[214:215], v[214:215], v[62:63]
    v_cvt_pk_bf16_f32 v107, v214, v215
    v_pk_fma_f32 v[216:217], v[48:49], v[74:75], v[216:217] op_sel:[0,1,0] op_sel_hi:[1,1,1]
    v_pk_mul_f32 v[216:217], v[216:217], v[64:65]
    v_cvt_pk_bf16_f32 v108, v216, v217
    v_pk_fma_f32 v[218:219], v[50:51], v[74:75], v[218:219] op_sel:[0,1,0] op_sel_hi:[1,1,1]
    v_pk_mul_f32 v[218:219], v[218:219], v[66:67]
    v_cvt_pk_bf16_f32 v109, v218, v219
    v_pk_fma_f32 v[220:221], v[52:53], v[74:75], v[220:221] op_sel:[0,1,0] op_sel_hi:[1,1,1]
    v_pk_mul_f32 v[220:221], v[220:221], v[68:69]
    v_cvt_pk_bf16_f32 v110, v220, v221
    v_pk_fma_f32 v[222:223], v[54:55], v[74:75], v[222:223] op_sel:[0,1,0] op_sel_hi:[1,1,1]
    v_pk_mul_f32 v[222:223], v[222:223], v[70:71]
    v_cvt_pk_bf16_f32 v111, v222, v223
    s_mul_i32 s86, s3, 3072
    s_add_u32 s86, s86, 139264
    v_lshl_add_u32 v6, v0, 4, s86
    s_xor_b32 s86, s3, 1
    s_mul_i32 s86, s86, 3072
    s_add_u32 s86, s86, 139264
    v_lshl_add_u32 v7, v0, 4, s86
    s_cmp_eq_u32 s49, 1
    s_cbranch_scc1 L_kv1
    v_mfma_f32_16x16x32_bf16 v[172:175], v[80:83], v[104:107], 0
    v_mfma_f32_16x16x32_bf16 v[176:179], v[88:91], v[104:107], 0
    v_mfma_f32_16x16x32_bf16 v[180:183], v[88:91], v[120:123], 0
    v_mfma_f32_16x16x32_bf16 v[160:163], v[80:83], v[96:99], 0
    v_mfma_f32_16x16x32_bf16 v[164:167], v[88:91], v[96:99], 0
    v_mfma_f32_16x16x32_bf16 v[168:171], v[80:83], v[120:123], 0
    v_mfma_f32_16x16x32_bf16 v[172:175], v[84:87], v[108:111], v[172:175]
    v_mfma_f32_16x16x32_bf16 v[176:179], v[92:95], v[108:111], v[176:179]
    v_mfma_f32_16x16x32_bf16 v[180:183], v[92:95], v[120:123], v[180:183]
    v_mfma_f32_16x16x32_bf16 v[160:163], v[84:87], v[100:103], v[160:163]
    v_mfma_f32_16x16x32_bf16 v[164:167], v[92:95], v[100:103], v[164:167]
    v_mfma_f32_16x16x32_bf16 v[168:171], v[84:87], v[120:123], v[168:171]
    s_branch L_kvd
L_kv1:
    v_mfma_f32_16x16x32_bf16 v[172:175], v[80:83], v[96:99], 0
    v_mfma_f32_16x16x32_bf16 v[176:179], v[88:91], v[96:99], 0
    v_mfma_f32_16x16x32_bf16 v[180:183], v[80:83], v[120:123], 0
    v_mfma_f32_16x16x32_bf16 v[160:163], v[80:83], v[104:107], 0
    v_mfma_f32_16x16x32_bf16 v[164:167], v[88:91], v[104:107], 0
    v_mfma_f32_16x16x32_bf16 v[168:171], v[88:91], v[120:123], 0
    v_mfma_f32_16x16x32_bf16 v[172:175], v[84:87], v[100:103], v[172:175]
    v_mfma_f32_16x16x32_bf16 v[176:179], v[92:95], v[100:103], v[176:179]
    v_mfma_f32_16x16x32_bf16 v[180:183], v[84:87], v[120:123], v[180:183]
    v_mfma_f32_16x16x32_bf16 v[160:163], v[84:87], v[108:111], v[160:163]
    v_mfma_f32_16x16x32_bf16 v[164:167], v[92:95], v[108:111], v[164:167]
    v_mfma_f32_16x16x32_bf16 v[168:171], v[92:95], v[120:123], v[168:171]
L_kvd:
    s_lshl_b32 s86, s47, 1
    s_add_u32 s86, s86, s50
    s_lshl_b32 s87, s86, 1
    s_add_u32 s87, s87, s49
    s_lshl_b32 s87, s87, 4
    s_add_u32 s87, s87, s46
    s_lshl_b32 s87, s87, 10
    s_add_u32 s87, s87, 5242880
    v_lshl_add_u32 v8, v0, 4, s87
    s_lshl_b32 s87, s86, 4
    s_add_u32 s87, s87, s46
    s_lshl_b32 s87, s87, 7
    s_lshl_b32 s88, s49, 6
    s_add_u32 s87, s87, s88
    s_add_u32 s87, s87, 7307264
    v_lshl_add_u32 v9, v21, 4, s87
    v_cmp_eq_u32 vcc, 0, v22
    v_mov_b32 v10, 2147483648
    s_nop 0
    v_cndmask_b32 v9, v10, v9, vcc
    ds_write_b128 v6, v[172:175] offset:0
    ds_write_b128 v6, v[176:179] offset:1024
    ds_write_b128 v6, v[180:183] offset:2048
    s_waitcnt lgkmcnt(0)
    s_barrier
    ds_read_b128 v[172:175], v7 offset:0
    ds_read_b128 v[176:179], v7 offset:1024
    ds_read_b128 v[180:183], v7 offset:2048
    s_lshl_b32 s87, s46, 3
    s_lshl_b32 s88, s49, 2
    s_add_u32 s87, s87, s88
    s_lshl_b32 s87, s87, 5
    s_add_u32 s87, s87, s86
    s_lshl_b32 s87, s87, 10
    s_add_u32 s87, s87, 1048576
    v_lshl_add_u32 v10, v0, 4, s87
    s_mul_i32 s87, s50, 3072
    s_add_u32 s87, s87, 151552
    v_lshl_add_u32 v11, v0, 4, s87
    s_waitcnt lgkmcnt(0)
    v_pk_add_f32 v[160:161], v[160:161], v[172:173]
    v_pk_add_f32 v[162:163], v[162:163], v[174:175]
    v_pk_add_f32 v[164:165], v[164:165], v[176:177]
    v_pk_add_f32 v[166:167], v[166:167], v[178:179]
    v_pk_add_f32 v[168:169], v[168:169], v[180:181]
    v_pk_add_f32 v[170:171], v[170:171], v[182:183]
    v_cvt_pk_bf16_f32 v184, v160, v161
    v_cvt_pk_bf16_f32 v185, v162, v163
    v_cvt_pk_bf16_f32 v186, v164, v165
    v_cvt_pk_bf16_f32 v187, v166, v167
    buffer_store_dwordx4 v[184:187], v8, s[16:19], 0 offen sc1
    buffer_store_dwordx4 v[168:171], v9, s[16:19], 0 offen sc1
    v_pk_fma_f32 v[128:129], v[28:29], v[240:241], v[128:129] op_sel_hi:[1,0,1]
    v_pk_mul_f32 v[112:113], v[128:129], v[248:249] op_sel_hi:[1,0]
    v_pk_fma_f32 v[128:129], v[128:129], v[244:245], s[54:55] op_sel_hi:[1,0,1]
    v_exp_f32 v112, v112 clamp
    v_exp_f32 v113, v113 clamp
    v_max_f32 v128, s54, v128
    v_max_f32 v129, s54, v129
    v_pk_add_f32 v[128:129], v[128:129], v[112:113]
    v_cvt_pk_bf16_f32 v80, v128, v129
    v_pk_fma_f32 v[130:131], v[30:31], v[240:241], v[130:131] op_sel_hi:[1,0,1]
    v_pk_mul_f32 v[114:115], v[130:131], v[248:249] op_sel_hi:[1,0]
    v_pk_fma_f32 v[130:131], v[130:131], v[244:245], s[54:55] op_sel_hi:[1,0,1]
    v_exp_f32 v114, v114 clamp
    v_exp_f32 v115, v115 clamp
    v_max_f32 v130, s54, v130
    v_max_f32 v131, s54, v131
    v_pk_add_f32 v[130:131], v[130:131], v[114:115]
    v_cvt_pk_bf16_f32 v81, v130, v131
    v_pk_fma_f32 v[144:145], v[32:33], v[240:241], v[144:145] op_sel_hi:[1,0,1]
    v_pk_mul_f32 v[116:117], v[144:145], v[248:249] op_sel_hi:[1,0]
    v_pk_fma_f32 v[144:145], v[144:145], v[244:245], s[54:55] op_sel_hi:[1,0,1]
    v_exp_f32 v116, v116 clamp
    v_exp_f32 v117, v117 clamp
    v_max_f32 v144, s54, v144
    v_max_f32 v145, s54, v145
    v_pk_add_f32 v[144:145], v[144:145], v[116:117]
    v_cvt_pk_bf16_f32 v82, v144, v145
    v_pk_fma_f32 v[146:147], v[34:35], v[240:241], v[146:147] op_sel_hi:[1,0,1]
    v_pk_mul_f32 v[118:119], v[146:147], v[248:249] op_sel_hi:[1,0]
    v_pk_fma_f32 v[146:147], v[146:147], v[244:245], s[54:55] op_sel_hi:[1,0,1]
    v_exp_f32 v118, v118 clamp
    v_exp_f32 v119, v119 clamp
    v_max_f32 v146, s54, v146
    v_max_f32 v147, s54, v147
    v_pk_add_f32 v[146:147], v[146:147], v[118:119]
    v_cvt_pk_bf16_f32 v83, v146, v147
    v_pk_fma_f32 v[132:133], v[28:29], v[240:241], v[132:133] op_sel:[0,1,0] op_sel_hi:[1,1,1]
    v_pk_mul_f32 v[112:113], v[132:133], v[248:249] op_sel:[0,1] op_sel_hi:[1,1]
    v_pk_fma_f32 v[132:133], v[132:133], v[244:245], s[54:55] op_sel:[0,1,0] op_sel_hi:[1,1,1]
    v_exp_f32 v112, v112 clamp
    v_exp_f32 v113, v113 clamp
    v_max_f32 v132, s54, v132
    v_max_f32 v133, s54, v133
    v_pk_add_f32 v[132:133], v[132:133], v[112:113]
    v_cvt_pk_bf16_f32 v84, v132, v133
    v_pk_fma_f32 v[134:135], v[30:31], v[240:241], v[134:135] op_sel:[0,1,0] op_sel_hi:[1,1,1]
    v_pk_mul_f32 v[114:115], v[134:135], v[248:249] op_sel:[0,1] op_sel_hi:[1,1]
    v_pk_fma_f32 v[134:135], v[134:135], v[244:245], s[54:55] op_sel:[0,1,0] op_sel_hi:[1,1,1]
    v_exp_f32 v114, v114 clamp
    v_exp_f32 v115, v115 clamp
    v_max_f32 v134, s54, v134
    v_max_f32 v135, s54, v135
    v_pk_add_f32 v[134:135], v[134:135], v[114:115]
    v_cvt_pk_bf16_f32 v85, v134, v135
    v_pk_fma_f32 v[148:149], v[32:33], v[240:241], v[148:149] op_sel:[0,1,0] op_sel_hi:[1,1,1]
    v_pk_mul_f32 v[116:117], v[148:149], v[248:249] op_sel:[0,1] op_sel_hi:[1,1]
    v_pk_fma_f32 v[148:149], v[148:149], v[244:245], s[54:55] op_sel:[0,1,0] op_sel_hi:[1,1,1]
    v_exp_f32 v116, v116 clamp
    v_exp_f32 v117, v117 clamp
    v_max_f32 v148, s54, v148
    v_max_f32 v149, s54, v149
    v_pk_add_f32 v[148:149], v[148:149], v[116:117]
    v_cvt_pk_bf16_f32 v86, v148, v149
    v_pk_fma_f32 v[150:151], v[34:35], v[240:241], v[150:151] op_sel:[0,1,0] op_sel_hi:[1,1,1]
    v_pk_mul_f32 v[118:119], v[150:151], v[248:249] op_sel:[0,1] op_sel_hi:[1,1]
    v_pk_fma_f32 v[150:151], v[150:151], v[244:245], s[54:55] op_sel:[0,1,0] op_sel_hi:[1,1,1]
    v_exp_f32 v118, v118 clamp
    v_exp_f32 v119, v119 clamp
    v_max_f32 v150, s54, v150
    v_max_f32 v151, s54, v151
    v_pk_add_f32 v[150:151], v[150:151], v[118:119]
    v_cvt_pk_bf16_f32 v87, v150, v151
    v_pk_fma_f32 v[136:137], v[28:29], v[242:243], v[136:137] op_sel_hi:[1,0,1]
    v_pk_mul_f32 v[112:113], v[136:137], v[250:251] op_sel_hi:[1,0]
    v_pk_fma_f32 v[136:137], v[136:137], v[246:247], s[54:55] op_sel_hi:[1,0,1]
    v_exp_f32 v112, v112 clamp
    v_exp_f32 v113, v113 clamp
    v_max_f32 v136, s54, v136
    v_max_f32 v137, s54, v137
    v_pk_add_f32 v[136:137], v[136:137], v[112:113]
    v_cvt_pk_bf16_f32 v88, v136, v137
    v_pk_fma_f32 v[138:139], v[30:31], v[242:243], v[138:139] op_sel_hi:[1,0,1]
    v_pk_mul_f32 v[114:115], v[138:139], v[250:251] op_sel_hi:[1,0]
    v_pk_fma_f32 v[138:139], v[138:139], v[246:247], s[54:55] op_sel_hi:[1,0,1]
    v_exp_f32 v114, v114 clamp
    v_exp_f32 v115, v115 clamp
    v_max_f32 v138, s54, v138
    v_max_f32 v139, s54, v139
    v_pk_add_f32 v[138:139], v[138:139], v[114:115]
    v_cvt_pk_bf16_f32 v89, v138, v139
    v_pk_fma_f32 v[152:153], v[32:33], v[242:243], v[152:153] op_sel_hi:[1,0,1]
    v_pk_mul_f32 v[116:117], v[152:153], v[250:251] op_sel_hi:[1,0]
    v_pk_fma_f32 v[152:153], v[152:153], v[246:247], s[54:55] op_sel_hi:[1,0,1]
    v_exp_f32 v116, v116 clamp
    v_exp_f32 v117, v117 clamp
    v_max_f32 v152, s54, v152
    v_max_f32 v153, s54, v153
    v_pk_add_f32 v[152:153], v[152:153], v[116:117]
    v_cvt_pk_bf16_f32 v90, v152, v153
    v_pk_fma_f32 v[154:155], v[34:35], v[242:243], v[154:155] op_sel_hi:[1,0,1]
    v_pk_mul_f32 v[118:119], v[154:155], v[250:251] op_sel_hi:[1,0]
    v_pk_fma_f32 v[154:155], v[154:155], v[246:247], s[54:55] op_sel_hi:[1,0,1]
    v_exp_f32 v118, v118 clamp
    v_exp_f32 v119, v119 clamp
    v_max_f32 v154, s54, v154
    v_max_f32 v155, s54, v155
    v_pk_add_f32 v[154:155], v[154:155], v[118:119]
    v_cvt_pk_bf16_f32 v91, v154, v155
    v_pk_fma_f32 v[140:141], v[28:29], v[242:243], v[140:141] op_sel:[0,1,0] op_sel_hi:[1,1,1]
    v_pk_mul_f32 v[112:113], v[140:141], v[250:251] op_sel:[0,1] op_sel_hi:[1,1]
    v_pk_fma_f32 v[140:141], v[140:141], v[246:247], s[54:55] op_sel:[0,1,0] op_sel_hi:[1,1,1]
    v_exp_f32 v112, v112 clamp
    v_exp_f32 v113, v113 clamp
    v_max_f32 v140, s54, v140
    v_max_f32 v141, s54, v141
    v_pk_add_f32 v[140:141], v[140:141], v[112:113]
    v_cvt_pk_bf16_f32 v92, v140, v141
    v_pk_fma_f32 v[142:143], v[30:31], v[242:243], v[142:143] op_sel:[0,1,0] op_sel_hi:[1,1,1]
    v_pk_mul_f32 v[114:115], v[142:143], v[250:251] op_sel:[0,1] op_sel_hi:[1,1]
    v_pk_fma_f32 v[142:143], v[142:143], v[246:247], s[54:55] op_sel:[0,1,0] op_sel_hi:[1,1,1]
    v_exp_f32 v114, v114 clamp
    v_exp_f32 v115, v115 clamp
    v_max_f32 v142, s54, v142
    v_max_f32 v143, s54, v143
    v_pk_add_f32 v[142:143], v[142:143], v[114:115]
    v_cvt_pk_bf16_f32 v93, v142, v143
    v_pk_fma_f32 v[156:157], v[32:33], v[242:243], v[156:157] op_sel:[0,1,0] op_sel_hi:[1,1,1]
    v_pk_mul_f32 v[116:117], v[156:157], v[250:251] op_sel:[0,1] op_sel_hi:[1,1]
    v_pk_fma_f32 v[156:157], v[156:157], v[246:247], s[54:55] op_sel:[0,1,0] op_sel_hi:[1,1,1]
    v_exp_f32 v116, v116 clamp
    v_exp_f32 v117, v117 clamp
    v_max_f32 v156, s54, v156
    v_max_f32 v157, s54, v157
    v_pk_add_f32 v[156:157], v[156:157], v[116:117]
    v_cvt_pk_bf16_f32 v94, v156, v157
    v_pk_fma_f32 v[158:159], v[34:35], v[242:243], v[158:159] op_sel:[0,1,0] op_sel_hi:[1,1,1]
    v_pk_mul_f32 v[118:119], v[158:159], v[250:251] op_sel:[0,1] op_sel_hi:[1,1]
    v_pk_fma_f32 v[158:159], v[158:159], v[246:247], s[54:55] op_sel:[0,1,0] op_sel_hi:[1,1,1]
    v_exp_f32 v118, v118 clamp
    v_exp_f32 v119, v119 clamp
    v_max_f32 v158, s54, v158
    v_max_f32 v159, s54, v159
    v_pk_add_f32 v[158:159], v[158:159], v[118:119]
    v_cvt_pk_bf16_f32 v95, v158, v159
    s_barrier
    ds_read_b128 v[40:43], v11 offset:0
    ds_read_b128 v[44:47], v11 offset:1024
    ds_read_b128 v[48:51], v11 offset:2048
    s_mov_b32 s86, 0x8000
    s_mov_b32 s87, 0x10000
    s_mov_b32 s88, 0x18000
    s_waitcnt lgkmcnt(0)
    s_barrier
    v_mfma_f32_16x16x32_bf16 v[136:139], v[48:51], v[80:83], 0
    v_mfma_f32_16x16x32_bf16 v[128:131], v[40:43], v[80:83], 0
    v_mfma_f32_16x16x32_bf16 v[132:135], v[44:47], v[80:83], 0
    v_mfma_f32_16x16x32_bf16 v[148:151], v[48:51], v[84:87], 0
    v_mfma_f32_16x16x32_bf16 v[140:143], v[40:43], v[84:87], 0
    v_mfma_f32_16x16x32_bf16 v[144:147], v[44:47], v[84:87], 0
    v_mfma_f32_16x16x32_bf16 v[160:163], v[48:51], v[88:91], 0
    v_mfma_f32_16x16x32_bf16 v[152:155], v[40:43], v[88:91], 0
    v_mfma_f32_16x16x32_bf16 v[156:159], v[44:47], v[88:91], 0
    v_mfma_f32_16x16x32_bf16 v[172:175], v[48:51], v[92:95], 0
    v_mfma_f32_16x16x32_bf16 v[164:167], v[40:43], v[92:95], 0
    v_mfma_f32_16x16x32_bf16 v[168:171], v[44:47], v[92:95], 0
    v_add_f32 v136, s54, v136
    v_rcp_f32 v136, v136
    s_nop 0
    v_pk_mul_f32 v[128:129], v[128:129], v[136:137] op_sel_hi:[1,0]
    v_pk_mul_f32 v[130:131], v[130:131], v[136:137] op_sel_hi:[1,0]
    v_pk_mul_f32 v[132:133], v[132:133], v[136:137] op_sel_hi:[1,0]
    v_pk_mul_f32 v[134:135], v[134:135], v[136:137] op_sel_hi:[1,0]
    v_cvt_pk_bf16_f32 v60, v128, v129
    v_cvt_pk_bf16_f32 v61, v130, v131
    v_cvt_pk_bf16_f32 v62, v132, v133
    v_cvt_pk_bf16_f32 v63, v134, v135
    buffer_store_dwordx4 v[60:63], v10, s[16:19], 0 offen sc1
    v_add_f32 v148, s54, v148
    v_rcp_f32 v148, v148
    s_nop 0
    v_pk_mul_f32 v[140:141], v[140:141], v[148:149] op_sel_hi:[1,0]
    v_pk_mul_f32 v[142:143], v[142:143], v[148:149] op_sel_hi:[1,0]
    v_pk_mul_f32 v[144:145], v[144:145], v[148:149] op_sel_hi:[1,0]
    v_pk_mul_f32 v[146:147], v[146:147], v[148:149] op_sel_hi:[1,0]
    v_cvt_pk_bf16_f32 v64, v140, v141
    v_cvt_pk_bf16_f32 v65, v142, v143
    v_cvt_pk_bf16_f32 v66, v144, v145
    v_cvt_pk_bf16_f32 v67, v146, v147
    buffer_store_dwordx4 v[64:67], v10, s[16:19], s86 offen sc1
    v_add_f32 v160, s54, v160
    v_rcp_f32 v160, v160
    s_nop 0
    v_pk_mul_f32 v[152:153], v[152:153], v[160:161] op_sel_hi:[1,0]
    v_pk_mul_f32 v[154:155], v[154:155], v[160:161] op_sel_hi:[1,0]
    v_pk_mul_f32 v[156:157], v[156:157], v[160:161] op_sel_hi:[1,0]
    v_pk_mul_f32 v[158:159], v[158:159], v[160:161] op_sel_hi:[1,0]
    v_cvt_pk_bf16_f32 v68, v152, v153
    v_cvt_pk_bf16_f32 v69, v154, v155
    v_cvt_pk_bf16_f32 v70, v156, v157
    v_cvt_pk_bf16_f32 v71, v158, v159
    buffer_store_dwordx4 v[68:71], v10, s[16:19], s87 offen sc1
    v_add_f32 v172, s54, v172
    v_rcp_f32 v172, v172
    s_nop 0
    v_pk_mul_f32 v[164:165], v[164:165], v[172:173] op_sel_hi:[1,0]
    v_pk_mul_f32 v[166:167], v[166:167], v[172:173] op_sel_hi:[1,0]
    v_pk_mul_f32 v[168:169], v[168:169], v[172:173] op_sel_hi:[1,0]
    v_pk_mul_f32 v[170:171], v[170:171], v[172:173] op_sel_hi:[1,0]
    v_cvt_pk_bf16_f32 v72, v164, v165
    v_cvt_pk_bf16_f32 v73, v166, v167
    v_cvt_pk_bf16_f32 v74, v168, v169
    v_cvt_pk_bf16_f32 v75, v170, v171
    buffer_store_dwordx4 v[72:75], v10, s[16:19], s88 offen sc1
    v_mov_b32 v14, 2147483648
    v_mov_b32 v11, 2147483648
L_phaseB:
    s_lshr_b32 s62, s3, 2
    s_lshl_b32 s53, s51, 3
    s_lshl_b32 s86, s48, 1
    s_add_u32 s53, s53, s86
    s_add_u32 s53, s53, s62
    v_lshrrev_b32 v1, 4, v0
    v_and_b32 v2, 15, v0
    v_lshlrev_b32 v3, 4, v0
    buffer_load_dwordx4 v[112:115], v3, s[40:43], 0 offen
    buffer_load_dwordx4 v[116:119], v3, s[40:43], 0 offen offset:1024
    s_lshl_b32 s86, s52, 7
    v_lshl_add_u32 v4, v1, 3, s86
    buffer_load_dwordx2 v[148:149], v4, s[40:43], 0 offen offset:0
    buffer_load_dwordx2 v[150:151], v4, s[40:43], 0 offen offset:32
    buffer_load_dwordx2 v[152:153], v4, s[40:43], 0 offen offset:64
    buffer_load_dwordx2 v[154:155], v4, s[40:43], 0 offen offset:96
    s_lshl_b32 s87, s53, 4
    v_add_u32 v6, s87, v2
    v_lshlrev_b32 v5, 11, v6
    v_sub_u32 v6, 2047, v6
    v_add_u32 v7, v5, v4
    v_add_u32 v5, s86, v5
    v_lshrrev_b32 v8, 1, v1
    v_and_b32 v9, 1, v1
    v_lshl_add_u32 v8, v9, 1, v8
    v_lshl_add_u32 v5, v8, 4, v5
    s_lshl_b32 s86, s53, 15
    s_lshl_b32 s87, s62, 14
    s_add_u32 s86, s86, s87
    s_add_u32 s86, s86, 1048576
    v_lshl_add_u32 v157, v0, 4, s86
    v_xor_b32 v158, 0x8000, v157
    s_and_b32 s86, s86, 0xffff7fff
    s_add_u32 s86, s86, 1020
    v_lshl_add_u32 v159, v2, 10, s86
    v_lshl_add_u32 v159, v9, 15, v159
    v_bfe_u32 v8, v0, 2, 2
    v_lshl_add_u32 v8, v1, 2, v8
    v_bfe_u32 v9, v8, 1, 2
    v_lshlrev_b32 v8, 7, v8
    v_lshl_add_u32 v8, v9, 5, v8
    v_and_b32 v9, 3, v0
    v_lshl_add_u32 v8, v9, 3, v8
    s_lshl_b32 s86, s62, 16
    s_add_u32 s86, s86, 8192
    v_add_u32 v10, s86, v8
    v_cmp_eq_u32 s[4:5], 1, v9
    v_cmp_eq_u32 s[6:7], 2, v9
    v_cmp_eq_u32 s[98:99], 3, v9
    s_lshl_b32 s86, s53, 12
    s_add_u32 s86, s86, 6291456
    v_lshl_add_u32 v160, v0, 4, s86
    s_lshl_b32 s87, s52, 8
    s_add_u32 s86, s86, s87
    v_lshl_add_u32 v161, v2, 4, s86
    v_lshrrev_b32 v8, 2, v2
    v_cmp_eq_u32 vcc, v8, v1
    v_mov_b32 v8, 2147483648
    s_nop 0
    v_cndmask_b32 v161, v8, v161, vcc
    s_lshl_b32 s86, s3, 12
    s_cmp_ge_u32 s3, 6
    s_cselect_b32 s87, 4294803456, 0
    s_add_u32 s86, s86, s87
    s_add_u32 s86, s86, 139264
    v_lshl_add_u32 v162, v0, 4, s86
    s_xor_b32 s88, s3, 4
    s_lshl_b32 s86, s88, 12
    s_cmp_ge_u32 s88, 6
    s_cselect_b32 s87, 4294803456, 0
    s_add_u32 s86, s86, s87
    s_add_u32 s86, s86, 139264
    v_lshl_add_u32 v163, v0, 4, s86
    s_waitcnt vmcnt(0)
    v_mov_b32 v8, 0
    v_dot2c_f32_bf16 v8, s95, v112
    v_dot2c_f32_bf16 v8, s95, v113
    v_dot2c_f32_bf16 v8, s95, v114
    v_dot2c_f32_bf16 v8, s95, v115
    v_dot2c_f32_bf16 v8, s95, v116
    v_dot2c_f32_bf16 v8, s95, v117
    v_dot2c_f32_bf16 v8, s95, v118
    v_dot2c_f32_bf16 v8, s95, v119
    v_cmp_eq_u32 vcc, 0, v9
    v_mov_b32 v12, s95
    s_nop 0
    v_cndmask_b32 v12, 0, v12, vcc
    v_cndmask_b32 v148, v12, v148, s[4:5]
    v_cndmask_b32 v149, v12, v149, s[4:5]
    v_cndmask_b32 v150, v12, v150, s[4:5]
    v_cndmask_b32 v151, v12, v151, s[4:5]
    v_cndmask_b32 v152, v12, v152, s[4:5]
    v_cndmask_b32 v153, v12, v153, s[4:5]
    v_cndmask_b32 v154, v12, v154, s[4:5]
    v_cndmask_b32 v155, v12, v155, s[4:5]
    v_add_f32_dpp v8, v8, v8 row_ror:8 row_mask:0xf bank_mask:0xf
    s_nop 1
    v_add_f32_dpp v8, v8, v8 row_ror:4 row_mask:0xf bank_mask:0xf
    s_nop 1
    v_add_f32_dpp v8, v8, v8 row_ror:2 row_mask:0xf bank_mask:0xf
    s_nop 1
    v_add_f32_dpp v8, v8, v8 row_ror:1 row_mask:0xf bank_mask:0xf
    v_mov_b32 v12, v8
    s_nop 1
    v_permlane32_swap_b32 v8, v12
    v_add_f32 v8, v8, v12
    v_mov_b32 v12, v8
    s_nop 1
    v_permlane16_swap_b32 v8, v12
    v_add_f32 v8, v8, v12
    s_nop 0
    v_readfirstlane_b32 s57, v8
L_b_restart:
    buffer_load_dwordx2 v[112:113], v7, s[8:11], 0 offen offset:0
    buffer_load_dwordx2 v[114:115], v7, s[8:11], 0 offen offset:32
    buffer_load_dwordx2 v[116:117], v7, s[8:11], 0 offen offset:64
    buffer_load_dwordx2 v[118:119], v7, s[8:11], 0 offen offset:96
    v_xor_b32 v144, 0, v10
    v_xor_b32 v145, 32, v10
    v_xor_b32 v146, 64, v10
    v_xor_b32 v147, 96, v10
    v_mov_b32 v96, 0
    v_mov_b32 v97, 0
    v_mov_b32 v98, 0
    v_mov_b32 v99, 0
    v_mov_b32 v100, 0
    v_mov_b32 v101, 0
    v_mov_b32 v102, 0
    v_mov_b32 v103, 0
    v_mov_b32 v104, 0
    v_mov_b32 v105, 0
    v_mov_b32 v106, 0
    v_mov_b32 v107, 0
    v_mov_b32 v108, 0
    v_mov_b32 v109, 0
    v_mov_b32 v110, 0
    v_mov_b32 v111, 0
    v_mov_b32 v156, 0
    s_waitcnt vmcnt(0)
    v_lshlrev_b32 v80, 16, v112
    v_and_b32 v81, 0xffff0000, v112
    v_lshlrev_b32 v82, 16, v113
    v_and_b32 v83, 0xffff0000, v113
    v_lshlrev_b32 v84, 16, v114
    v_and_b32 v85, 0xffff0000, v114
    v_lshlrev_b32 v86, 16, v115
    v_and_b32 v87, 0xffff0000, v115
    v_lshlrev_b32 v88, 16, v116
    v_and_b32 v89, 0xffff0000, v116
    v_lshlrev_b32 v90, 16, v117
    v_and_b32 v91, 0xffff0000, v117
    v_lshlrev_b32 v92, 16, v118
    v_and_b32 v93, 0xffff0000, v118
    v_lshlrev_b32 v94, 16, v119
    v_and_b32 v95, 0xffff0000, v119
L_b_poll:
    buffer_load_dword v8, v159, s[16:19], 0 offen sc1
    s_waitcnt vmcnt(0)
    v_cmp_eq_u32 vcc, -1, v8
    s_cbranch_vccz L_ok_1
    s_sub_u32 s56, s56, 1
    s_cbranch_scc0 L_b_poll
    s_mov_b32 s56, 0
L_ok_1:
    buffer_load_dwordx4 v[16:19], v157, s[16:19], 0 offen offset:0 sc1
    buffer_load_dwordx4 v[20:23], v158, s[16:19], 0 offen offset:0 sc1
    buffer_load_dwordx4 v[24:27], v157, s[16:19], 0 offen offset:1024 sc1
    buffer_load_dwordx4 v[28:31], v158, s[16:19], 0 offen offset:1024 sc1
    buffer_load_dwordx4 v[32:35], v157, s[16:19], 0 offen offset:2048 sc1
    buffer_load_dwordx4 v[36:39], v158, s[16:19], 0 offen offset:2048 sc1
    buffer_load_dwordx4 v[40:43], v157, s[16:19], 0 offen offset:3072 sc1
    buffer_load_dwordx4 v[44:47], v158, s[16:19], 0 offen offset:3072 sc1
    buffer_load_dwordx4 v[48:51], v157, s[16:19], s92 offen offset:0 sc1
    buffer_load_dwordx4 v[52:55], v158, s[16:19], s92 offen offset:0 sc1
    buffer_load_dwordx4 v[56:59], v157, s[16:19], s92 offen offset:1024 sc1
    buffer_load_dwordx4 v[60:63], v158, s[16:19], s92 offen offset:1024 sc1
    buffer_load_dwordx4 v[64:67], v157, s[16:19], s92 offen offset:2048 sc1
    buffer_load_dwordx4 v[68:71], v158, s[16:19], s92 offen offset:2048 sc1
    buffer_load_dwordx4 v[72:75], v157, s[16:19], s92 offen offset:3072 sc1
    buffer_load_dwordx4 v[76:79], v158, s[16:19], s92 offen offset:3072 sc1
    ds_read_b64_tr_b16 v[112:113], v144 offset:0
    ds_read_b64_tr_b16 v[114:115], v144 offset:2048
    ds_read_b64_tr_b16 v[116:117], v145 offset:0
    ds_read_b64_tr_b16 v[118:119], v145 offset:2048
    ds_read_b64_tr_b16 v[120:121], v146 offset:0
    ds_read_b64_tr_b16 v[122:123], v146 offset:2048
    ds_read_b64_tr_b16 v[124:125], v147 offset:0
    ds_read_b64_tr_b16 v[126:127], v147 offset:2048
    s_waitcnt vmcnt(14) lgkmcnt(0)
    v_max3_u32 v156, v156, v19, v23
    v_mfma_f32_16x16x32_bf16 v[80:83], v[112:115], v[16:19], v[80:83]
    ds_read_b64_tr_b16 v[128:129], v144 offset:4096
    v_mfma_f32_16x16x32_bf16 v[96:99], v[112:115], v[20:23], v[96:99]
    ds_read_b64_tr_b16 v[130:131], v144 offset:6144
    v_mfma_f32_16x16x32_bf16 v[84:87], v[116:119], v[16:19], v[84:87]
    ds_read_b64_tr_b16 v[132:133], v145 offset:4096
    v_mfma_f32_16x16x32_bf16 v[100:103], v[116:119], v[20:23], v[100:103]
    ds_read_b64_tr_b16 v[134:135], v145 offset:6144
    v_mfma_f32_16x16x32_bf16 v[88:91], v[120:123], v[16:19], v[88:91]
    ds_read_b64_tr_b16 v[136:137], v146 offset:4096
    v_mfma_f32_16x16x32_bf16 v[104:107], v[120:123], v[20:23], v[104:107]
    ds_read_b64_tr_b16 v[138:139], v146 offset:6144
    v_mfma_f32_16x16x32_bf16 v[92:95], v[124:127], v[16:19], v[92:95]
    ds_read_b64_tr_b16 v[140:141], v147 offset:4096
    v_mfma_f32_16x16x32_bf16 v[108:111], v[124:127], v[20:23], v[108:111]
    ds_read_b64_tr_b16 v[142:143], v147 offset:6144
    buffer_load_dwordx4 v[16:19], v157, s[16:19], s93 offen offset:0 sc1
    buffer_load_dwordx4 v[20:23], v158, s[16:19], s93 offen offset:0 sc1
    s_waitcnt vmcnt(14) lgkmcnt(0)
    v_max3_u32 v156, v156, v27, v31
    v_mfma_f32_16x16x32_bf16 v[80:83], v[128:131], v[24:27], v[80:83]
    ds_read_b64_tr_b16 v[112:113], v144 offset:8192
    v_mfma_f32_16x16x32_bf16 v[96:99], v[128:131], v[28:31], v[96:99]
    ds_read_b64_tr_b16 v[114:115], v144 offset:10240
    v_mfma_f32_16x16x32_bf16 v[84:87], v[132:135], v[24:27], v[84:87]
    ds_read_b64_tr_b16 v[116:117], v145 offset:8192
    v_mfma_f32_16x16x32_bf16 v[100:103], v[132:135], v[28:31], v[100:103]
    ds_read_b64_tr_b16 v[118:119], v145 offset:10240
    v_mfma_f32_16x16x32_bf16 v[88:91], v[136:139], v[24:27], v[88:91]
    ds_read_b64_tr_b16 v[120:121], v146 offset:8192
    v_mfma_f32_16x16x32_bf16 v[104:107], v[136:139], v[28:31], v[104:107]
    ds_read_b64_tr_b16 v[122:123], v146 offset:10240
    v_mfma_f32_16x16x32_bf16 v[92:95], v[140:143], v[24:27], v[92:95]
    ds_read_b64_tr_b16 v[124:125], v147 offset:8192
    v_mfma_f32_16x16x32_bf16 v[108:111], v[140:143], v[28:31], v[108:111]
    ds_read_b64_tr_b16 v[126:127], v147 offset:10240
    buffer_load_dwordx4 v[24:27], v157, s[16:19], s93 offen offset:1024 sc1
    buffer_load_dwordx4 v[28:31], v158, s[16:19], s93 offen offset:1024 sc1
    s_waitcnt vmcnt(14) lgkmcnt(0)
    v_max3_u32 v156, v156, v35, v39
    v_mfma_f32_16x16x32_bf16 v[80:83], v[112:115], v[32:35], v[80:83]
    ds_read_b64_tr_b16 v[128:129], v144 offset:12288
    v_mfma_f32_16x16x32_bf16 v[96:99], v[112:115], v[36:39], v[96:99]
    ds_read_b64_tr_b16 v[130:131], v144 offset:14336
    v_mfma_f32_16x16x32_bf16 v[84:87], v[116:119], v[32:35], v[84:87]
    ds_read_b64_tr_b16 v[132:133], v145 offset:12288
    v_mfma_f32_16x16x32_bf16 v[100:103], v[116:119], v[36:39], v[100:103]
    ds_read_b64_tr_b16 v[134:135], v145 offset:14336
    v_mfma_f32_16x16x32_bf16 v[88:91], v[120:123], v[32:35], v[88:91]
    ds_read_b64_tr_b16 v[136:137], v146 offset:12288
    v_mfma_f32_16x16x32_bf16 v[104:107], v[120:123], v[36:39], v[104:107]
    ds_read_b64_tr_b16 v[138:139], v146 offset:14336
    v_mfma_f32_16x16x32_bf16 v[92:95], v[124:127], v[32:35], v[92:95]
    ds_read_b64_tr_b16 v[140:141], v147 offset:12288
    v_mfma_f32_16x16x32_bf16 v[108:111], v[124:127], v[36:39], v[108:111]
    ds_read_b64_tr_b16 v[142:143], v147 offset:14336
    buffer_load_dwordx4 v[32:35], v157, s[16:19], s93 offen offset:2048 sc1
    buffer_load_dwordx4 v[36:39], v158, s[16:19], s93 offen offset:2048 sc1
    s_waitcnt vmcnt(14) lgkmcnt(0)
    v_max3_u32 v156, v156, v43, v47
    v_mfma_f32_16x16x32_bf16 v[80:83], v[128:131], v[40:43], v[80:83]
    ds_read_b64_tr_b16 v[112:113], v144 offset:16384
    v_mfma_f32_16x16x32_bf16 v[96:99], v[128:131], v[44:47], v[96:99]
    ds_read_b64_tr_b16 v[114:115], v144 offset:18432
    v_mfma_f32_16x16x32_bf16 v[84:87], v[132:135], v[40:43], v[84:87]
    ds_read_b64_tr_b16 v[116:117], v145 offset:16384
    v_mfma_f32_16x16x32_bf16 v[100:103], v[132:135], v[44:47], v[100:103]
    ds_read_b64_tr_b16 v[118:119], v145 offset:18432
    v_mfma_f32_16x16x32_bf16 v[88:91], v[136:139], v[40:43], v[88:91]
    ds_read_b64_tr_b16 v[120:121], v146 offset:16384
    v_mfma_f32_16x16x32_bf16 v[104:107], v[136:139], v[44:47], v[104:107]
    ds_read_b64_tr_b16 v[122:123], v146 offset:18432
    v_mfma_f32_16x16x32_bf16 v[92:95], v[140:143], v[40:43], v[92:95]
    ds_read_b64_tr_b16 v[124:125], v147 offset:16384
    v_mfma_f32_16x16x32_bf16 v[108:111], v[140:143], v[44:47], v[108:111]
    ds_read_b64_tr_b16 v[126:127], v147 offset:18432
    buffer_load_dwordx4 v[40:43], v157, s[16:19], s93 offen offset:3072 sc1
    buffer_load_dwordx4 v[44:47], v158, s[16:19], s93 offen offset:3072 sc1
    s_waitcnt vmcnt(14) lgkmcnt(0)
    v_max3_u32 v156, v156, v51, v55
    v_mfma_f32_16x16x32_bf16 v[80:83], v[112:115], v[48:51], v[80:83]
    ds_read_b64_tr_b16 v[128:129], v144 offset:20480
    v_mfma_f32_16x16x32_bf16 v[96:99], v[112:115], v[52:55], v[96:99]
    ds_read_b64_tr_b16 v[130:131], v144 offset:22528
    v_mfma_f32_16x16x32_bf16 v[84:87], v[116:119], v[48:51], v[84:87]
    ds_read_b64_tr_b16 v[132:133], v145 offset:20480
    v_mfma_f32_16x16x32_bf16 v[100:103], v[116:119], v[52:55], v[100:103]
    ds_read_b64_tr_b16 v[134:135], v145 offset:22528
    v_mfma_f32_16x16x32_bf16 v[88:91], v[120:123], v[48:51], v[88:91]
    ds_read_b64_tr_b16 v[136:137], v146 offset:20480
    v_mfma_f32_16x16x32_bf16 v[104:107], v[120:123], v[52:55], v[104:107]
    ds_read_b64_tr_b16 v[138:139], v146 offset:22528
    v_mfma_f32_16x16x32_bf16 v[92:95], v[124:127], v[48:51], v[92:95]
    ds_read_b64_tr_b16 v[140:141], v147 offset:20480
    v_mfma_f32_16x16x32_bf16 v[108:111], v[124:127], v[52:55], v[108:111]
    ds_read_b64_tr_b16 v[142:143], v147 offset:22528
    buffer_load_dwordx4 v[48:51], v157, s[16:19], s94 offen offset:0 sc1
    buffer_load_dwordx4 v[52:55], v158, s[16:19], s94 offen offset:0 sc1
    s_waitcnt vmcnt(14) lgkmcnt(0)
    v_max3_u32 v156, v156, v59, v63
    v_mfma_f32_16x16x32_bf16 v[80:83], v[128:131], v[56:59], v[80:83]
    ds_read_b64_tr_b16 v[112:113], v144 offset:24576
    v_mfma_f32_16x16x32_bf16 v[96:99], v[128:131], v[60:63], v[96:99]
    ds_read_b64_tr_b16 v[114:115], v144 offset:26624
    v_mfma_f32_16x16x32_bf16 v[84:87], v[132:135], v[56:59], v[84:87]
    ds_read_b64_tr_b16 v[116:117], v145 offset:24576
    v_mfma_f32_16x16x32_bf16 v[100:103], v[132:135], v[60:63], v[100:103]
    ds_read_b64_tr_b16 v[118:119], v145 offset:26624
    v_mfma_f32_16x16x32_bf16 v[88:91], v[136:139], v[56:59], v[88:91]
    ds_read_b64_tr_b16 v[120:121], v146 offset:24576
    v_mfma_f32_16x16x32_bf16 v[104:107], v[136:139], v[60:63], v[104:107]
    ds_read_b64_tr_b16 v[122:123], v146 offset:26624
    v_mfma_f32_16x16x32_bf16 v[92:95], v[140:143], v[56:59], v[92:95]
    ds_read_b64_tr_b16 v[124:125], v147 offset:24576
    v_mfma_f32_16x16x32_bf16 v[108:111], v[140:143], v[60:63], v[108:111]
    ds_read_b64_tr_b16 v[126:127], v147 offset:26624
    buffer_load_dwordx4 v[56:59], v157, s[16:19], s94 offen offset:1024 sc1
    buffer_load_dwordx4 v[60:63], v158, s[16:19], s94 offen offset:1024 sc1
    s_waitcnt vmcnt(14) lgkmcnt(0)
    v_max3_u32 v156, v156, v67, v71
    v_mfma_f32_16x16x32_bf16 v[80:83], v[112:115], v[64:67], v[80:83]
    ds_read_b64_tr_b16 v[128:129], v144 offset:28672
    v_mfma_f32_16x16x32_bf16 v[96:99], v[112:115], v[68:71], v[96:99]
    ds_read_b64_tr_b16 v[130:131], v144 offset:30720
    v_mfma_f32_16x16x32_bf16 v[84:87], v[116:119], v[64:67], v[84:87]
    ds_read_b64_tr_b16 v[132:133], v145 offset:28672
    v_mfma_f32_16x16x32_bf16 v[100:103], v[116:119], v[68:71], v[100:103]
    ds_read_b64_tr_b16 v[134:135], v145 offset:30720
    v_mfma_f32_16x16x32_bf16 v[88:91], v[120:123], v[64:67], v[88:91]
    ds_read_b64_tr_b16 v[136:137], v146 offset:28672
    v_mfma_f32_16x16x32_bf16 v[104:107], v[120:123], v[68:71], v[104:107]
    ds_read_b64_tr_b16 v[138:139], v146 offset:30720
    v_mfma_f32_16x16x32_bf16 v[92:95], v[124:127], v[64:67], v[92:95]
    ds_read_b64_tr_b16 v[140:141], v147 offset:28672
    v_mfma_f32_16x16x32_bf16 v[108:111], v[124:127], v[68:71], v[108:111]
    ds_read_b64_tr_b16 v[142:143], v147 offset:30720
    buffer_load_dwordx4 v[64:67], v157, s[16:19], s94 offen offset:2048 sc1
    buffer_load_dwordx4 v[68:71], v158, s[16:19], s94 offen offset:2048 sc1
    s_waitcnt vmcnt(14) lgkmcnt(0)
    v_max3_u32 v156, v156, v75, v79
    v_mfma_f32_16x16x32_bf16 v[80:83], v[128:131], v[72:75], v[80:83]
    ds_read_b64_tr_b16 v[112:113], v144 offset:32768
    v_mfma_f32_16x16x32_bf16 v[96:99], v[128:131], v[76:79], v[96:99]
    ds_read_b64_tr_b16 v[114:115], v144 offset:34816
    v_mfma_f32_16x16x32_bf16 v[84:87], v[132:135], v[72:75], v[84:87]
    ds_read_b64_tr_b16 v[116:117], v145 offset:32768
    v_mfma_f32_16x16x32_bf16 v[100:103], v[132:135], v[76:79], v[100:103]
    ds_read_b64_tr_b16 v[118:119], v145 offset:34816
    v_mfma_f32_16x16x32_bf16 v[88:91], v[136:139], v[72:75], v[88:91]
    ds_read_b64_tr_b16 v[120:121], v146 offset:32768
    v_mfma_f32_16x16x32_bf16 v[104:107], v[136:139], v[76:79], v[104:107]
    ds_read_b64_tr_b16 v[122:123], v146 offset:34816
    v_mfma_f32_16x16x32_bf16 v[92:95], v[140:143], v[72:75], v[92:95]
    ds_read_b64_tr_b16 v[124:125], v147 offset:32768
    v_mfma_f32_16x16x32_bf16 v[108:111], v[140:143], v[76:79], v[108:111]
    ds_read_b64_tr_b16 v[126:127], v147 offset:34816
    buffer_load_dwordx4 v[72:75], v157, s[16:19], s94 offen offset:3072 sc1
    buffer_load_dwordx4 v[76:79], v158, s[16:19], s94 offen offset:3072 sc1
    s_waitcnt vmcnt(14) lgkmcnt(0)
    v_max3_u32 v156, v156, v19, v23
    v_mfma_f32_16x16x32_bf16 v[80:83], v[112:115], v[16:19], v[80:83]
    ds_read_b64_tr_b16 v[128:129], v144 offset:36864
    v_mfma_f32_16x16x32_bf16 v[96:99], v[112:115], v[20:23], v[96:99]
    ds_read_b64_tr_b16 v[130:131], v144 offset:38912
    s_mov_b32 s90, 0
    buffer_load_dwordx4 v[164:167], v11, s[32:35], s90 offen
    v_mfma_f32_16x16x32_bf16 v[84:87], v[116:119], v[16:19], v[84:87]
    ds_read_b64_tr_b16 v[132:133], v145 offset:36864
    v_mfma_f32_16x16x32_bf16 v[100:103], v[116:119], v[20:23], v[100:103]
    ds_read_b64_tr_b16 v[134:135], v145 offset:38912
    v_mfma_f32_16x16x32_bf16 v[88:91], v[120:123], v[16:19], v[88:91]
    ds_read_b64_tr_b16 v[136:137], v146 offset:36864
    v_mfma_f32_16x16x32_bf16 v[104:107], v[120:123], v[20:23], v[104:107]
    ds_read_b64_tr_b16 v[138:139], v146 offset:38912
    s_mov_b32 s90, 7168
    buffer_load_dwordx4 v[168:171], v11, s[32:35], s90 offen
    v_mfma_f32_16x16x32_bf16 v[92:95], v[124:127], v[16:19], v[92:95]
    ds_read_b64_tr_b16 v[140:141], v147 offset:36864
    v_mfma_f32_16x16x32_bf16 v[108:111], v[124:127], v[20:23], v[108:111]
    ds_read_b64_tr_b16 v[142:143], v147 offset:38912
    s_waitcnt vmcnt(14) lgkmcnt(0)
    v_max3_u32 v156, v156, v27, v31
    v_mfma_f32_16x16x32_bf16 v[80:83], v[128:131], v[24:27], v[80:83]
    ds_read_b64_tr_b16 v[112:113], v144 offset:40960
    v_mfma_f32_16x16x32_bf16 v[96:99], v[128:131], v[28:31], v[96:99]
    ds_read_b64_tr_b16 v[114:115], v144 offset:43008
    s_mov_b32 s90, 14336
    buffer_load_dwordx4 v[172:175], v11, s[32:35], s90 offen
    v_mfma_f32_16x16x32_bf16 v[84:87], v[132:135], v[24:27], v[84:87]
    ds_read_b64_tr_b16 v[116:117], v145 offset:40960
    v_mfma_f32_16x16x32_bf16 v[100:103], v[132:135], v[28:31], v[100:103]
    ds_read_b64_tr_b16 v[118:119], v145 offset:43008
    v_mfma_f32_16x16x32_bf16 v[88:91], v[136:139], v[24:27], v[88:91]
    ds_read_b64_tr_b16 v[120:121], v146 offset:40960
    v_mfma_f32_16x16x32_bf16 v[104:107], v[136:139], v[28:31], v[104:107]
    ds_read_b64_tr_b16 v[122:123], v146 offset:43008
    s_mov_b32 s90, 21504
    buffer_load_dwordx4 v[176:179], v11, s[32:35], s90 offen
    v_mfma_f32_16x16x32_bf16 v[92:95], v[140:143], v[24:27], v[92:95]
    ds_read_b64_tr_b16 v[124:125], v147 offset:40960
    v_mfma_f32_16x16x32_bf16 v[108:111], v[140:143], v[28:31], v[108:111]
    ds_read_b64_tr_b16 v[126:127], v147 offset:43008
    s_waitcnt vmcnt(14) lgkmcnt(0)
    v_max3_u32 v156, v156, v35, v39
    v_mfma_f32_16x16x32_bf16 v[80:83], v[112:115], v[32:35], v[80:83]
    ds_read_b64_tr_b16 v[128:129], v144 offset:45056
    v_mfma_f32_16x16x32_bf16 v[96:99], v[112:115], v[36:39], v[96:99]
    ds_read_b64_tr_b16 v[130:131], v144 offset:47104
    s_mov_b32 s90, 28672
    buffer_load_dwordx4 v[180:183], v11, s[32:35], s90 offen
    v_mfma_f32_16x16x32_bf16 v[84:87], v[116:119], v[32:35], v[84:87]
    ds_read_b64_tr_b16 v[132:133], v145 offset:45056
    v_mfma_f32_16x16x32_bf16 v[100:103], v[116:119], v[36:39], v[100:103]
    ds_read_b64_tr_b16 v[134:135], v145 offset:47104
    v_mfma_f32_16x16x32_bf16 v[88:91], v[120:123], v[32:35], v[88:91]
    ds_read_b64_tr_b16 v[136:137], v146 offset:45056
    v_mfma_f32_16x16x32_bf16 v[104:107], v[120:123], v[36:39], v[104:107]
    ds_read_b64_tr_b16 v[138:139], v146 offset:47104
    s_mov_b32 s90, 35840
    buffer_load_dwordx4 v[184:187], v11, s[32:35], s90 offen
    v_mfma_f32_16x16x32_bf16 v[92:95], v[124:127], v[32:35], v[92:95]
    ds_read_b64_tr_b16 v[140:141], v147 offset:45056
    v_mfma_f32_16x16x32_bf16 v[108:111], v[124:127], v[36:39], v[108:111]
    ds_read_b64_tr_b16 v[142:143], v147 offset:47104
    s_waitcnt vmcnt(14) lgkmcnt(0)
    v_max3_u32 v156, v156, v43, v47
    v_mfma_f32_16x16x32_bf16 v[80:83], v[128:131], v[40:43], v[80:83]
    ds_read_b64_tr_b16 v[112:113], v144 offset:49152
    v_mfma_f32_16x16x32_bf16 v[96:99], v[128:131], v[44:47], v[96:99]
    ds_read_b64_tr_b16 v[114:115], v144 offset:51200
    s_mov_b32 s90, 43008
    buffer_load_dwordx4 v[188:191], v11, s[32:35], s90 offen
    v_mfma_f32_16x16x32_bf16 v[84:87], v[132:135], v[40:43], v[84:87]
    ds_read_b64_tr_b16 v[116:117], v145 offset:49152
    v_mfma_f32_16x16x32_bf16 v[100:103], v[132:135], v[44:47], v[100:103]
    ds_read_b64_tr_b16 v[118:119], v145 offset:51200
    v_mfma_f32_16x16x32_bf16 v[88:91], v[136:139], v[40:43], v[88:91]
    ds_read_b64_tr_b16 v[120:121], v146 offset:49152
    v_mfma_f32_16x16x32_bf16 v[104:107], v[136:139], v[44:47], v[104:107]
    ds_read_b64_tr_b16 v[122:123], v146 offset:51200
    s_mov_b32 s90, 50176
    buffer_load_dwordx4 v[192:195], v11, s[32:35], s90 offen
    v_mfma_f32_16x16x32_bf16 v[92:95], v[140:143], v[40:43], v[92:95]
    ds_read_b64_tr_b16 v[124:125], v147 offset:49152
    v_mfma_f32_16x16x32_bf16 v[108:111], v[140:143], v[44:47], v[108:111]
    ds_read_b64_tr_b16 v[126:127], v147 offset:51200
    s_waitcnt vmcnt(14) lgkmcnt(0)
    v_max3_u32 v156, v156, v51, v55
    v_mfma_f32_16x16x32_bf16 v[80:83], v[112:115], v[48:51], v[80:83]
    ds_read_b64_tr_b16 v[128:129], v144 offset:53248
    v_mfma_f32_16x16x32_bf16 v[96:99], v[112:115], v[52:55], v[96:99]
    ds_read_b64_tr_b16 v[130:131], v144 offset:55296
    s_mov_b32 s90, 57344
    buffer_load_dwordx4 v[196:199], v11, s[32:35], s90 offen
    v_mfma_f32_16x16x32_bf16 v[84:87], v[116:119], v[48:51], v[84:87]
    ds_read_b64_tr_b16 v[132:133], v145 offset:53248
    v_mfma_f32_16x16x32_bf16 v[100:103], v[116:119], v[52:55], v[100:103]
    ds_read_b64_tr_b16 v[134:135], v145 offset:55296
    v_mfma_f32_16x16x32_bf16 v[88:91], v[120:123], v[48:51], v[88:91]
    ds_read_b64_tr_b16 v[136:137], v146 offset:53248
    v_mfma_f32_16x16x32_bf16 v[104:107], v[120:123], v[52:55], v[104:107]
    ds_read_b64_tr_b16 v[138:139], v146 offset:55296
    s_mov_b32 s90, 64512
    buffer_load_dwordx4 v[200:203], v11, s[32:35], s90 offen
    v_mfma_f32_16x16x32_bf16 v[92:95], v[124:127], v[48:51], v[92:95]
    ds_read_b64_tr_b16 v[140:141], v147 offset:53248
    v_mfma_f32_16x16x32_bf16 v[108:111], v[124:127], v[52:55], v[108:111]
    ds_read_b64_tr_b16 v[142:143], v147 offset:55296
    s_waitcnt vmcnt(14) lgkmcnt(0)
    v_max3_u32 v156, v156, v59, v63
    v_mfma_f32_16x16x32_bf16 v[80:83], v[128:131], v[56:59], v[80:83]
    ds_read_b64_tr_b16 v[112:113], v144 offset:57344
    v_mfma_f32_16x16x32_bf16 v[96:99], v[128:131], v[60:63], v[96:99]
    ds_read_b64_tr_b16 v[114:115], v144 offset:59392
    s_mov_b32 s90, 71680
    buffer_load_dwordx4 v[204:207], v11, s[32:35], s90 offen
    v_mfma_f32_16x16x32_bf16 v[84:87], v[132:135], v[56:59], v[84:87]
    ds_read_b64_tr_b16 v[116:117], v145 offset:57344
    v_mfma_f32_16x16x32_bf16 v[100:103], v[132:135], v[60:63], v[100:103]
    ds_read_b64_tr_b16 v[118:119], v145 offset:59392
    v_mfma_f32_16x16x32_bf16 v[88:91], v[136:139], v[56:59], v[88:91]
    ds_read_b64_tr_b16 v[120:121], v146 offset:57344
    v_mfma_f32_16x16x32_bf16 v[104:107], v[136:139], v[60:63], v[104:107]
    ds_read_b64_tr_b16 v[122:123], v146 offset:59392
    s_mov_b32 s90, 78848
    buffer_load_dwordx4 v[208:211], v11, s[32:35], s90 offen
    v_mfma_f32_16x16x32_bf16 v[92:95], v[140:143], v[56:59], v[92:95]
    ds_read_b64_tr_b16 v[124:125], v147 offset:57344
    v_mfma_f32_16x16x32_bf16 v[108:111], v[140:143], v[60:63], v[108:111]
    ds_read_b64_tr_b16 v[126:127], v147 offset:59392
    s_waitcnt vmcnt(14) lgkmcnt(0)
    v_max3_u32 v156, v156, v67, v71
    v_mfma_f32_16x16x32_bf16 v[80:83], v[112:115], v[64:67], v[80:83]
    ds_read_b64_tr_b16 v[128:129], v144 offset:61440
    v_mfma_f32_16x16x32_bf16 v[96:99], v[112:115], v[68:71], v[96:99]
    ds_read_b64_tr_b16 v[130:131], v144 offset:63488
    s_mov_b32 s90, 86016
    buffer_load_dwordx4 v[212:215], v11, s[32:35], s90 offen
    v_mfma_f32_16x16x32_bf16 v[84:87], v[116:119], v[64:67], v[84:87]
    ds_read_b64_tr_b16 v[132:133], v145 offset:61440
    v_mfma_f32_16x16x32_bf16 v[100:103], v[116:119], v[68:71], v[100:103]
    ds_read_b64_tr_b16 v[134:135], v145 offset:63488
    v_mfma_f32_16x16x32_bf16 v[88:91], v[120:123], v[64:67], v[88:91]
    ds_read_b64_tr_b16 v[136:137], v146 offset:61440
    v_mfma_f32_16x16x32_bf16 v[104:107], v[120:123], v[68:71], v[104:107]
    ds_read_b64_tr_b16 v[138:139], v146 offset:63488
    s_mov_b32 s90, 93184
    buffer_load_dwordx4 v[216:219], v11, s[32:35], s90 offen
    v_mfma_f32_16x16x32_bf16 v[92:95], v[124:127], v[64:67], v[92:95]
    ds_read_b64_tr_b16 v[140:141], v147 offset:61440
    v_mfma_f32_16x16x32_bf16 v[108:111], v[124:127], v[68:71], v[108:111]
    ds_read_b64_tr_b16 v[142:143], v147 offset:63488
    s_waitcnt vmcnt(14) lgkmcnt(0)
    v_max3_u32 v156, v156, v75, v79
    v_cmp_eq_u32 vcc, -1, v156
    s_cbranch_vccz L_ok_2
    s_sub_u32 s56, s56, 1
    s_cbranch_scc0 L_b_restart
    s_mov_b32 s56, 0
L_ok_2:
    v_mfma_f32_16x16x32_bf16 v[80:83], v[128:131], v[72:75], v[80:83]
    v_mfma_f32_16x16x32_bf16 v[96:99], v[128:131], v[76:79], v[96:99]
    s_mov_b32 s90, 100352
    buffer_load_dwordx4 v[220:223], v11, s[32:35], s90 offen
    v_mfma_f32_16x16x32_bf16 v[84:87], v[132:135], v[72:75], v[84:87]
    v_mfma_f32_16x16x32_bf16 v[100:103], v[132:135], v[76:79], v[100:103]
    v_mfma_f32_16x16x32_bf16 v[88:91], v[136:139], v[72:75], v[88:91]
    v_mfma_f32_16x16x32_bf16 v[104:107], v[136:139], v[76:79], v[104:107]
    s_mov_b32 s90, 107520
    buffer_load_dwordx4 v[224:227], v11, s[32:35], s90 offen
    v_mfma_f32_16x16x32_bf16 v[92:95], v[140:143], v[72:75], v[92:95]
    v_mfma_f32_16x16x32_bf16 v[108:111], v[140:143], v[76:79], v[108:111]
    ds_write_b128 v162, v[96:99] offset:0
    s_nop 0
    ds_write_b128 v162, v[100:103] offset:1024
    s_nop 0
    ds_write_b128 v162, v[104:107] offset:2048
    s_nop 2
    ds_write_b128 v162, v[108:111] offset:3072
    s_waitcnt lgkmcnt(0)
    s_barrier
    ds_read_b128 v[16:19], v163 offset:0
    ds_read_b128 v[20:23], v163 offset:1024
    ds_read_b128 v[24:27], v163 offset:2048
    ds_read_b128 v[28:31], v163 offset:3072
    s_waitcnt lgkmcnt(3)
    v_pk_add_f32 v[80:81], v[80:81], v[16:17]
    v_pk_add_f32 v[82:83], v[82:83], v[18:19]
    v_cvt_pk_bf16_f32 v32, v80, v81
    v_cvt_pk_bf16_f32 v33, v82, v83
    s_waitcnt lgkmcnt(2)
    v_pk_add_f32 v[84:85], v[84:85], v[20:21]
    v_pk_add_f32 v[86:87], v[86:87], v[22:23]
    v_cvt_pk_bf16_f32 v34, v84, v85
    v_cvt_pk_bf16_f32 v35, v86, v87
    s_waitcnt lgkmcnt(1)
    v_pk_add_f32 v[88:89], v[88:89], v[24:25]
    v_pk_add_f32 v[90:91], v[90:91], v[26:27]
    v_cvt_pk_bf16_f32 v36, v88, v89
    v_cvt_pk_bf16_f32 v37, v90, v91
    s_waitcnt lgkmcnt(0)
    v_pk_add_f32 v[92:93], v[92:93], v[28:29]
    v_pk_add_f32 v[94:95], v[94:95], v[30:31]
    v_cvt_pk_bf16_f32 v38, v92, v93
    v_cvt_pk_bf16_f32 v39, v94, v95
    v_mfma_f32_16x16x32_bf16 v[60:63], v[32:35], v[32:35], 0
    v_mfma_f32_16x16x32_bf16 v[56:59], v[148:151], v[32:35], 0
    v_mfma_f32_16x16x32_bf16 v[60:63], v[36:39], v[36:39], v[60:63]
    v_mfma_f32_16x16x32_bf16 v[56:59], v[152:155], v[36:39], v[56:59]
    v_lshlrev_b32 v40, 16, v32
    v_and_b32 v41, 0xffff0000, v32
    v_lshlrev_b32 v42, 16, v33
    v_and_b32 v43, 0xffff0000, v33
    v_lshlrev_b32 v44, 16, v34
    v_and_b32 v45, 0xffff0000, v34
    v_lshlrev_b32 v46, 16, v35
    v_and_b32 v47, 0xffff0000, v35
    v_cndmask_b32 v60, v60, v61, s[4:5]
    v_cndmask_b32 v60, v60, v62, s[6:7]
    v_cndmask_b32 v58, v60, v63, s[98:99]
    buffer_store_dwordx4 v[56:59], v161, s[16:19], 0 offen sc1
    v_lshlrev_b32 v48, 16, v36
    v_and_b32 v49, 0xffff0000, v36
    v_lshlrev_b32 v50, 16, v37
    v_and_b32 v51, 0xffff0000, v37
    v_lshlrev_b32 v52, 16, v38
    v_and_b32 v53, 0xffff0000, v38
    v_lshlrev_b32 v54, 16, v39
    v_and_b32 v55, 0xffff0000, v39
L_h3:
    buffer_load_dwordx4 v[64:67], v160, s[16:19], 0 offen offset:0 sc1
    buffer_load_dwordx4 v[68:71], v160, s[16:19], 0 offen offset:1024 sc1
    buffer_load_dwordx4 v[72:75], v160, s[16:19], 0 offen offset:2048 sc1
    buffer_load_dwordx4 v[76:79], v160, s[16:19], 0 offen offset:3072 sc1
    s_waitcnt vmcnt(0)
    v_max3_u32 v8, v66, v70, v74
    v_max_u32 v8, v8, v78
    v_cmp_eq_u32 vcc, -1, v8
    s_cbranch_vccz L_ok_3
    s_sub_u32 s56, s56, 1
    s_cbranch_scc0 L_h3
    s_mov_b32 s56, 0
L_ok_3:
    v_pk_add_f32 v[64:65], v[64:65], v[68:69]
    v_add_f32 v66, v66, v70
    v_pk_add_f32 v[72:73], v[72:73], v[76:77]
    v_add_f32 v74, v74, v78
    v_pk_add_f32 v[64:65], v[64:65], v[72:73]
    v_add_f32 v66, v66, v74
    v_mov_b32 v68, v64
    v_mov_b32 v69, v65
    v_mov_b32 v70, v66
    v_permlane32_swap_b32 v64, v68
    v_permlane32_swap_b32 v65, v69
    v_permlane32_swap_b32 v66, v70
    v_add_f32 v64, v64, v68
    v_add_f32 v65, v65, v69
    v_add_f32 v66, v66, v70
    v_mov_b32 v68, v64
    v_mov_b32 v69, v65
    v_mov_b32 v70, v66
    v_permlane16_swap_b32 v64, v68
    v_permlane16_swap_b32 v65, v69
    v_permlane16_swap_b32 v66, v70
    v_add_f32 v64, v64, v68
    v_add_f32 v65, v65, v69
    v_add_f32 v66, v66, v70
    v_mul_f32 v64, 0x3a800000, v64
    v_mul_f32 v66, 0x3a800000, v66
    v_fma_f32 v66, -v64, v64, v66
    v_max_f32 v66, 0, v66
    v_cvt_pk_bf16_f32 v69, v64, v66
    v_lshlrev_b32 v68, 16, v69
    v_and_b32 v69, 0xffff0000, v69
    v_add_f32 v69, 0x3727c5ac, v69
    v_cvt_pk_bf16_f32 v69, v69, v69
    v_lshlrev_b32 v69, 16, v69
    v_sqrt_f32 v69, v69
    s_nop 0
    v_cvt_pk_bf16_f32 v69, v69, v69
    v_lshlrev_b32 v69, 16, v69
    v_rcp_f32 v70, v69
    v_fma_f32 v12, -v68, s57, v65
    v_mul_f32 v12, v12, v70
    v_mul_f32 v72, -v68, v70
    v_ashrrev_i32 v8, 31, v12
    v_or_b32 v8, 0x80000000, v8
    v_xor_b32 v8, v8, v12
    v_and_b32 v8, 0xfffff800, v8
    v_or_b32 v13, v8, v6
    s_lshl_b32 s86, s3, 6
    s_add_u32 s86, s86, 65536
    v_lshl_add_u32 v8, v2, 2, s86
    ds_write_b32 v8, v13
    v_pk_fma_f32 v[16:17], v[40:41], v[70:71], v[72:73] op_sel_hi:[1,0,0]
    v_pk_fma_f32 v[18:19], v[42:43], v[70:71], v[72:73] op_sel_hi:[1,0,0]
    v_pk_fma_f32 v[20:21], v[44:45], v[70:71], v[72:73] op_sel_hi:[1,0,0]
    v_pk_fma_f32 v[22:23], v[46:47], v[70:71], v[72:73] op_sel_hi:[1,0,0]
    v_pk_fma_f32 v[24:25], v[48:49], v[70:71], v[72:73] op_sel_hi:[1,0,0]
    v_pk_fma_f32 v[26:27], v[50:51], v[70:71], v[72:73] op_sel_hi:[1,0,0]
    v_pk_fma_f32 v[28:29], v[52:53], v[70:71], v[72:73] op_sel_hi:[1,0,0]
    v_pk_fma_f32 v[30:31], v[54:55], v[70:71], v[72:73] op_sel_hi:[1,0,0]
    v_lshlrev_b32 v8, 3, v0
    v_add_u32 v8, 65536, v8
    s_waitcnt lgkmcnt(0)
    s_barrier
    ds_read_b64 v[64:65], v8
    v_cvt_pk_bf16_f32 v96, v16, v17
    v_cvt_pk_bf16_f32 v97, v18, v19
    v_cvt_pk_bf16_f32 v98, v20, v21
    v_cvt_pk_bf16_f32 v99, v22, v23
    v_cvt_pk_bf16_f32 v100, v24, v25
    v_cvt_pk_bf16_f32 v101, v26, v27
    v_cvt_pk_bf16_f32 v102, v28, v29
    v_cvt_pk_bf16_f32 v103, v30, v31
    s_waitcnt lgkmcnt(0)
    v_max_u32 v66, v64, v65
    v_min_u32 v67, v64, v65
    s_nop 0
    v_mov_b32_dpp v64, v66 row_ror:8 row_mask:0xf bank_mask:0xf
    v_max_u32_dpp v65, v67, v67 row_ror:8 row_mask:0xf bank_mask:0xf
    v_med3_u32 v67, v66, v64, v65
    v_max_u32 v66, v66, v64
    s_nop 1
    v_mov_b32_dpp v64, v66 row_ror:4 row_mask:0xf bank_mask:0xf
    v_max_u32_dpp v65, v67, v67 row_ror:4 row_mask:0xf bank_mask:0xf
    v_med3_u32 v67, v66, v64, v65
    v_max_u32 v66, v66, v64
    s_nop 1
    v_mov_b32_dpp v64, v66 row_ror:2 row_mask:0xf bank_mask:0xf
    v_max_u32_dpp v65, v67, v67 row_ror:2 row_mask:0xf bank_mask:0xf
    v_med3_u32 v67, v66, v64, v65
    v_max_u32 v66, v66, v64
    s_nop 1
    v_mov_b32_dpp v64, v66 row_ror:1 row_mask:0xf bank_mask:0xf
    v_max_u32_dpp v65, v67, v67 row_ror:1 row_mask:0xf bank_mask:0xf
    v_med3_u32 v67, v66, v64, v65
    v_max_u32 v66, v66, v64
    s_nop 0
    v_readlane_b32 s58, v66, 0
    v_readlane_b32 s59, v67, 0
    v_readlane_b32 s86, v66, 16
    v_readlane_b32 s87, v67, 16
    s_nop 0
    s_max_u32 s59, s59, s87
    s_min_u32 s87, s58, s86
    s_max_u32 s58, s58, s86
    s_max_u32 s59, s59, s87
    v_readlane_b32 s86, v66, 32
    v_readlane_b32 s87, v67, 32
    s_nop 0
    s_max_u32 s59, s59, s87
    s_min_u32 s87, s58, s86
    s_max_u32 s58, s58, s86
    s_max_u32 s59, s59, s87
    v_readlane_b32 s86, v66, 48
    v_readlane_b32 s87, v67, 48
    s_nop 0
    s_max_u32 s59, s59, s87
    s_min_u32 s87, s58, s86
    s_max_u32 s58, s58, s86
    s_max_u32 s59, s59, s87
    v_cmp_eq_u32 s[4:5], s58, v13
    v_cmp_eq_u32 s[6:7], s59, v13
    s_nop 0
    s_or_b64 s[96:97], s[4:5], s[6:7]
    s_cbranch_scc0 L_nocand
    s_lshl_b32 s86, s51, 12
    s_lshl_b32 s87, s52, 7
    s_add_u32 s86, s86, s87
    s_add_u32 s86, s86, 7372800
    v_lshl_add_u32 v8, v1, 3, s86
    v_add_u32 v9, 2048, v8
    v_cndmask_b32 v8, v8, v9, s[6:7]
    v_mov_b32 v9, 2147483648
    v_cndmask_b32 v8, v9, v8, s[96:97]
    buffer_store_dwordx2 v[96:97], v8, s[16:19], 0 offen offset:0 sc1
    buffer_store_dwordx2 v[98:99], v8, s[16:19], 0 offen offset:32 sc1
    buffer_store_dwordx2 v[100:101], v8, s[16:19], 0 offen offset:64 sc1
    buffer_store_dwordx2 v[102:103], v8, s[16:19], 0 offen offset:96 sc1
L_nocand:
    s_cmp_lg_u32 s3, 0
    s_cbranch_scc1 L_nokey
    s_lshl_b32 s86, s52, 7
    s_lshl_b32 s87, s51, 3
    s_add_u32 s86, s86, s87
    s_add_u32 s86, s86, 7438336
    v_mov_b32 v8, s86
    v_mov_b32 v9, 2147483648
    v_cmp_eq_u32 vcc, 0, v0
    s_nop 1
    v_cndmask_b32 v8, v9, v8, vcc
    v_mov_b32 v10, s58
    v_mov_b32 v11, s59
    buffer_store_dwordx2 v[10:11], v8, s[16:19], 0 offen sc1
L_nokey:
    s_bfe_u32 s86, s2, 0x20001
    s_lshl_b32 s86, s86, 2
    s_add_u32 s86, s86, s48
    s_lshl_b32 s86, s86, 7
    s_add_u32 s87, s86, 7438336
    v_and_b32 v8, 31, v0
    v_lshl_add_u32 v129, v8, 2, s87
    s_add_u32 s87, s86, 7372800
    v_and_b32 v8, 7, v0
    v_lshl_add_u32 v130, v8, 4, s87
    v_lshrrev_b32 v8, 3, v0
    v_lshl_add_u32 v130, v8, 11, v130
    s_mov_b32 s89, 0x4000
    s_mov_b32 s90, 0x8000
    s_mov_b32 s91, 0xc000
    s_cmp_lg_u64 s[96:97], 0
    s_cselect_b32 s63, 1, s62
    s_cmp_eq_u32 s63, 0
    s_cbranch_scc1 L_h4_skip1
    buffer_load_dword v128, v129, s[16:19], 0 offen sc1
    buffer_load_dwordx4 v[112:115], v130, s[16:19], 0 offen sc1
    buffer_load_dwordx4 v[116:119], v130, s[16:19], s89 offen sc1
    buffer_load_dwordx4 v[120:123], v130, s[16:19], s90 offen sc1
    buffer_load_dwordx4 v[124:127], v130, s[16:19], s91 offen sc1
L_h4_skip1:
    v_lshlrev_b32 v16, 16, v96
    v_and_b32 v17, 0xffff0000, v96
    v_lshlrev_b32 v18, 16, v97
    v_and_b32 v19, 0xffff0000, v97
    v_lshlrev_b32 v20, 16, v98
    v_and_b32 v21, 0xffff0000, v98
    v_lshlrev_b32 v22, 16, v99
    v_and_b32 v23, 0xffff0000, v99
    v_lshlrev_b32 v24, 16, v100
    v_and_b32 v25, 0xffff0000, v100
    v_lshlrev_b32 v26, 16, v101
    v_and_b32 v27, 0xffff0000, v101
    v_lshlrev_b32 v28, 16, v102
    v_and_b32 v29, 0xffff0000, v102
    v_lshlrev_b32 v30, 16, v103
    v_and_b32 v31, 0xffff0000, v103
    v_pk_add_f32 v[16:17], v[16:17], v[40:41]
    v_pk_add_f32 v[18:19], v[18:19], v[42:43]
    v_pk_add_f32 v[20:21], v[20:21], v[44:45]
    v_pk_add_f32 v[22:23], v[22:23], v[46:47]
    v_pk_add_f32 v[24:25], v[24:25], v[48:49]
    v_pk_add_f32 v[26:27], v[26:27], v[50:51]
    v_pk_add_f32 v[28:29], v[28:29], v[52:53]
    v_pk_add_f32 v[30:31], v[30:31], v[54:55]
    v_cvt_pk_bf16_f32 v104, v16, v17
    v_cvt_pk_bf16_f32 v105, v18, v19
    v_cvt_pk_bf16_f32 v106, v20, v21
    v_cvt_pk_bf16_f32 v107, v22, v23
    v_cvt_pk_bf16_f32 v108, v24, v25
    v_cvt_pk_bf16_f32 v109, v26, v27
    v_cvt_pk_bf16_f32 v110, v28, v29
    v_cvt_pk_bf16_f32 v111, v30, v31
    v_permlane16_swap_b32 v104, v106
    v_permlane16_swap_b32 v105, v107
    v_permlane16_swap_b32 v108, v110
    v_permlane16_swap_b32 v109, v111
    v_mov_b32 v9, 2147483648
    v_cndmask_b32 v8, v5, v9, s[96:97]
    buffer_store_dwordx4 v[104:107], v8, s[24:27], 0 offen
    buffer_store_dwordx4 v[108:111], v8, s[24:27], 0 offen offset:64
    s_cmp_eq_u32 s63, 0
    s_cbranch_scc1 L_fin
    s_cmp_eq_u64 s[96:97], 0
    s_cbranch_scc1 L_nostash
    v_lshlrev_b32 v8, 3, v1
    v_add_u32 v8, 98304, v8
    v_add_u32 v9, 512, v8
    v_cndmask_b32 v8, v8, v9, s[6:7]
    v_cvt_pk_bf16_f32 v9, v12, v12
    v_lshlrev_b32 v9, 16, v9
    s_mov_b64 exec, s[96:97]
    ds_write_b64 v8, v[32:33] offset:0
    ds_write_b64 v8, v[96:97] offset:128
    ds_write_b64 v8, v[34:35] offset:32
    ds_write_b64 v8, v[98:99] offset:160
    ds_write_b64 v8, v[36:37] offset:64
    ds_write_b64 v8, v[100:101] offset:192
    ds_write_b64 v8, v[38:39] offset:96
    ds_write_b64 v8, v[102:103] offset:224
    ds_write_b32 v8, v9 offset:256
    s_mov_b64 exec, -1
L_nostash:
    s_branch L_h4_chk
L_h4:
    buffer_load_dword v128, v129, s[16:19], 0 offen sc1
    buffer_load_dwordx4 v[112:115], v130, s[16:19], 0 offen sc1
    buffer_load_dwordx4 v[116:119], v130, s[16:19], s89 offen sc1
    buffer_load_dwordx4 v[120:123], v130, s[16:19], s90 offen sc1
    buffer_load_dwordx4 v[124:127], v130, s[16:19], s91 offen sc1
L_h4_chk:
    s_waitcnt vmcnt(0)
    v_max3_u32 v8, v128, v113, v115
    v_max3_u32 v8, v8, v117, v119
    v_max3_u32 v8, v8, v121, v123
    v_max3_u32 v8, v8, v125, v127
    v_cmp_eq_u32 vcc, -1, v8
    s_cbranch_vccz L_ok_4
    s_sub_u32 s56, s56, 1
    s_cbranch_scc0 L_h4
    s_mov_b32 s56, 0
L_ok_4:
    s_lshl_b32 s88, s48, 12
    s_add_u32 s88, s88, 69632
    s_cmp_eq_u32 s62, 0
    s_cbranch_scc1 L_noseg
    v_lshl_add_u32 v8, v0, 4, s88
    ds_write_b128 v8, v[112:115] offset:0
    ds_write_b128 v8, v[116:119] offset:1024
    ds_write_b128 v8, v[120:123] offset:2048
    ds_write_b128 v8, v[124:127] offset:3072
L_noseg:
    v_mov_b32 v64, v128
    v_mov_b32 v65, 0
    s_nop 0
    v_mov_b32_dpp v66, v64 row_ror:8 row_mask:0xf bank_mask:0xf
    v_max_u32_dpp v67, v65, v65 row_ror:8 row_mask:0xf bank_mask:0xf
    v_med3_u32 v65, v64, v66, v67
    v_max_u32 v64, v64, v66
    s_nop 1
    v_mov_b32_dpp v66, v64 row_ror:4 row_mask:0xf bank_mask:0xf
    v_max_u32_dpp v67, v65, v65 row_ror:4 row_mask:0xf bank_mask:0xf
    v_med3_u32 v65, v64, v66, v67
    v_max_u32 v64, v64, v66
    s_nop 1
    v_mov_b32_dpp v66, v64 row_ror:2 row_mask:0xf bank_mask:0xf
    v_max_u32_dpp v67, v65, v65 row_ror:2 row_mask:0xf bank_mask:0xf
    v_med3_u32 v65, v64, v66, v67
    v_max_u32 v64, v64, v66
    s_nop 1
    v_mov_b32_dpp v66, v64 row_ror:1 row_mask:0xf bank_mask:0xf
    v_max_u32_dpp v67, v65, v65 row_ror:1 row_mask:0xf bank_mask:0xf
    v_med3_u32 v65, v64, v66, v67
    v_max_u32 v64, v64, v66
    s_nop 0
    v_readlane_b32 s60, v64, 0
    v_readlane_b32 s61, v65, 0
    v_readlane_b32 s86, v64, 16
    v_readlane_b32 s87, v65, 16
    s_nop 0
    s_max_u32 s61, s61, s87
    s_min_u32 s87, s60, s86
    s_max_u32 s60, s60, s86
    s_max_u32 s61, s61, s87
    s_cmp_eq_u64 s[96:97], 0
    s_cbranch_scc1 L_nolost
    v_cmp_ne_u32 s[4:5], s60, v13
    v_cmp_ne_u32 s[6:7], s61, v13
    s_nop 0
    s_and_b64 s[4:5], s[4:5], s[6:7]
    s_and_b64 s[4:5], s[4:5], s[96:97]
    v_mov_b32 v9, 2147483648
    v_cndmask_b32 v8, v9, v5, s[4:5]
    buffer_store_dwordx4 v[104:107], v8, s[24:27], 0 offen
    buffer_store_dwordx4 v[108:111], v8, s[24:27], 0 offen offset:64
L_nolost:
    s_cmp_lg_u32 s62, 0
    s_cbranch_scc1 L_moe
    s_barrier
    s_barrier
    s_branch L_final
L_moe:
    s_mov_b32 s90, 0
    buffer_load_dwordx4 v[228:231], v14, s[36:39], s90 offen
    s_mov_b32 s90, 2048
    buffer_load_dwordx4 v[232:235], v14, s[36:39], s90 offen
    s_mov_b32 s90, 4096
    buffer_load_dwordx4 v[236:239], v14, s[36:39], s90 offen
    s_mov_b32 s90, 6144
    buffer_load_dwordx4 v[240:243], v14, s[36:39], s90 offen
    s_mov_b32 s90, 8192
    buffer_load_dwordx4 v[244:247], v14, s[36:39], s90 offen
    s_mov_b32 s90, 10240
    buffer_load_dwordx4 v[248:251], v14, s[36:39], s90 offen
    s_mov_b32 s90, 12288
    buffer_load_dwordx4 v[252:255], v14, s[36:39], s90 offen
    v_cmp_eq_u32 vcc, s60, v128
    s_nop 0
    s_ff1_i32_b64 s86, vcc
    v_cmp_eq_u32 vcc, s61, v128
    s_nop 0
    s_ff1_i32_b64 s87, vcc
    s_lshl_b32 s86, s86, 7
    s_lshl_b32 s87, s87, 7
    v_bfe_u32 v8, v0, 3, 1
    v_cmp_eq_u32 vcc, 1, v8
    v_mov_b32 v9, s86
    v_mov_b32 v10, s87
    v_cndmask_b32 v9, v9, v10, vcc
    v_lshl_add_u32 v10, v1, 5, s88
    v_add_u32 v9, v9, v10
    s_waitcnt lgkmcnt(0)
    ds_read_b128 v[64:67], v9
    ds_read_b128 v[68:71], v9 offset:16
    v_and_b32 v10, 1, v0
    v_cmp_eq_u32 vcc, 1, v10
    v_mov_b32 v10, 0x0c0c0100
    v_mov_b32 v11, 0x01000c0c
    v_cndmask_b32 v16, v10, v11, vcc
    v_mov_b32 v10, 0x0c0c0302
    v_mov_b32 v11, 0x03020c0c
    v_cndmask_b32 v17, v10, v11, vcc
    v_bfe_u32 v10, v0, 1, 2
    v_mov_b32 v11, 0x0c0c0c0c
    v_cmp_eq_u32 vcc, 0, v10
    s_nop 1
    v_cndmask_b32 v72, v11, v16, vcc
    v_cndmask_b32 v76, v11, v17, vcc
    v_cmp_eq_u32 vcc, 1, v10
    s_nop 1
    v_cndmask_b32 v73, v11, v16, vcc
    v_cndmask_b32 v77, v11, v17, vcc
    v_cmp_eq_u32 vcc, 2, v10
    s_nop 1
    v_cndmask_b32 v74, v11, v16, vcc
    v_cndmask_b32 v78, v11, v17, vcc
    v_cmp_eq_u32 vcc, 3, v10
    s_nop 1
    v_cndmask_b32 v75, v11, v16, vcc
    v_cndmask_b32 v79, v11, v17, vcc
    s_lshl_b32 s86, s48, 10
    s_add_u32 s86, s86, 90112
    v_lshl_add_u32 v18, v0, 4, s86
    s_and_b32 s86, s2, 1
    s_lshl_b32 s86, s86, 2
    s_bfe_u32 s87, s2, 0x20001
    s_add_u32 s86, s86, s87
    s_mul_i32 s86, s86, 28672
    s_lshl_b32 s87, s45, 9
    s_add_u32 s86, s86, s87
    s_add_u32 s86, s86, 7077888
    s_cmp_ge_u32 s2, 224
    s_cselect_b32 s86, 2147483648, s86
    v_lshl_add_u32 v19, v2, 5, s86
    v_and_b32 v10, 1, v1
    v_lshl_add_u32 v19, v10, 4, v19
    v_lshrrev_b32 v11, 1, v1
    v_mul_u32_u24 v16, 14336, v11
    v_add_u32 v19, v19, v16
    s_waitcnt lgkmcnt(0)
    v_perm_b32 v80, v64, v64, v72
    v_perm_b32 v81, v64, v64, v73
    v_perm_b32 v82, v64, v64, v74
    v_perm_b32 v83, v64, v64, v75
    s_nop 1
    v_mfma_f32_16x16x32_bf16 v[88:91], v[80:83], v[164:167], 0
    v_perm_b32 v84, v64, v64, v76
    v_perm_b32 v85, v64, v64, v77
    v_perm_b32 v86, v64, v64, v78
    v_perm_b32 v87, v64, v64, v79
    s_nop 1
    v_mfma_f32_16x16x32_bf16 v[88:91], v[84:87], v[168:171], v[88:91]
    v_perm_b32 v80, v65, v65, v72
    v_perm_b32 v81, v65, v65, v73
    v_perm_b32 v82, v65, v65, v74
    v_perm_b32 v83, v65, v65, v75
    s_nop 1
    v_mfma_f32_16x16x32_bf16 v[88:91], v[80:83], v[172:175], v[88:91]
    v_perm_b32 v84, v65, v65, v76
    v_perm_b32 v85, v65, v65, v77
    v_perm_b32 v86, v65, v65, v78
    v_perm_b32 v87, v65, v65, v79
    s_nop 1
    v_mfma_f32_16x16x32_bf16 v[88:91], v[84:87], v[176:179], v[88:91]
    v_perm_b32 v80, v66, v66, v72
    v_perm_b32 v81, v66, v66, v73
    v_perm_b32 v82, v66, v66, v74
    v_perm_b32 v83, v66, v66, v75
    s_nop 1
    v_mfma_f32_16x16x32_bf16 v[88:91], v[80:83], v[180:183], v[88:91]
    v_perm_b32 v84, v66, v66, v76
    v_perm_b32 v85, v66, v66, v77
    v_perm_b32 v86, v66, v66, v78
    v_perm_b32 v87, v66, v66, v79
    s_nop 1
    v_mfma_f32_16x16x32_bf16 v[88:91], v[84:87], v[184:187], v[88:91]
    v_perm_b32 v80, v67, v67, v72
    v_perm_b32 v81, v67, v67, v73
    v_perm_b32 v82, v67, v67, v74
    v_perm_b32 v83, v67, v67, v75
    s_nop 1
    v_mfma_f32_16x16x32_bf16 v[88:91], v[80:83], v[188:191], v[88:91]
    v_perm_b32 v84, v67, v67, v76
    v_perm_b32 v85, v67, v67, v77
    v_perm_b32 v86, v67, v67, v78
    v_perm_b32 v87, v67, v67, v79
    s_nop 1
    v_mfma_f32_16x16x32_bf16 v[88:91], v[84:87], v[192:195], v[88:91]
    v_perm_b32 v80, v68, v68, v72
    v_perm_b32 v81, v68, v68, v73
    v_perm_b32 v82, v68, v68, v74
    v_perm_b32 v83, v68, v68, v75
    s_nop 1
    v_mfma_f32_16x16x32_bf16 v[88:91], v[80:83], v[196:199], v[88:91]
    v_perm_b32 v84, v68, v68, v76
    v_perm_b32 v85, v68, v68, v77
    v_perm_b32 v86, v68, v68, v78
    v_perm_b32 v87, v68, v68, v79
    s_nop 1
    v_mfma_f32_16x16x32_bf16 v[88:91], v[84:87], v[200:203], v[88:91]
    v_perm_b32 v80, v69, v69, v72
    v_perm_b32 v81, v69, v69, v73
    v_perm_b32 v82, v69, v69, v74
    v_perm_b32 v83, v69, v69, v75
    s_nop 1
    v_mfma_f32_16x16x32_bf16 v[88:91], v[80:83], v[204:207], v[88:91]
    v_perm_b32 v84, v69, v69, v76
    v_perm_b32 v85, v69, v69, v77
    v_perm_b32 v86, v69, v69, v78
    v_perm_b32 v87, v69, v69, v79
    s_nop 1
    v_mfma_f32_16x16x32_bf16 v[88:91], v[84:87], v[208:211], v[88:91]
    v_perm_b32 v80, v70, v70, v72
    v_perm_b32 v81, v70, v70, v73
    v_perm_b32 v82, v70, v70, v74
    v_perm_b32 v83, v70, v70, v75
    s_nop 1
    v_mfma_f32_16x16x32_bf16 v[88:91], v[80:83], v[212:215], v[88:91]
    v_perm_b32 v84, v70, v70, v76
    v_perm_b32 v85, v70, v70, v77
    v_perm_b32 v86, v70, v70, v78
    v_perm_b32 v87, v70, v70, v79
    s_nop 1
    v_mfma_f32_16x16x32_bf16 v[88:91], v[84:87], v[216:219], v[88:91]
    v_perm_b32 v80, v71, v71, v72
    v_perm_b32 v81, v71, v71, v73
    v_perm_b32 v82, v71, v71, v74
    v_perm_b32 v83, v71, v71, v75
    s_nop 1
    v_mfma_f32_16x16x32_bf16 v[88:91], v[80:83], v[220:223], v[88:91]
    v_perm_b32 v84, v71, v71, v76
    v_perm_b32 v85, v71, v71, v77
    v_perm_b32 v86, v71, v71, v78
    v_perm_b32 v87, v71, v71, v79
    s_nop 1
    v_mfma_f32_16x16x32_bf16 v[88:91], v[84:87], v[224:227], v[88:91]
    s_nop 7
    ds_write_b128 v18, v[88:91] offset:0
    s_waitcnt lgkmcnt(0)
    s_barrier
    s_cmp_lg_u32 s48, 0
    s_cbranch_scc1 L_gu_done
    ds_read_b128 v[20:23], v18 offset:1024
    ds_read_b128 v[24:27], v18 offset:2048
    ds_read_b128 v[28:31], v18 offset:3072
    s_waitcnt lgkmcnt(0)
    v_pk_add_f32 v[88:89], v[88:89], v[20:21]
    v_pk_add_f32 v[24:25], v[24:25], v[28:29]
    v_pk_add_f32 v[88:89], v[88:89], v[24:25]
    v_pk_add_f32 v[90:91], v[90:91], v[22:23]
    v_pk_add_f32 v[26:27], v[26:27], v[30:31]
    v_pk_add_f32 v[90:91], v[90:91], v[26:27]
    buffer_store_dwordx4 v[88:91], v19, s[16:19], 0 offen sc1
L_gu_done:
    s_mul_i32 s86, s45, 112
    s_mul_i32 s87, s48, 28
    s_add_u32 s86, s86, s87
    v_bfe_u32 v16, v0, 3, 2
    v_mul_u32_u24 v16, 7, v16
    v_and_b32 v17, 7, v0
    v_min_u32 v17, 6, v17
    v_add3_u32 v16, v16, v17, s86
    v_lshrrev_b32 v17, 5, v0
    v_mul_u32_u24 v17, 14336, v17
    v_lshl_add_u32 v16, v16, 2, v17
    v_add_u32 v16, 7077888, v16
    s_lshl_b32 s86, s45, 13
    s_lshl_b32 s87, s44, 9
    s_add_u32 s86, s86, s87
    s_add_u32 s86, s86, 6815744
    v_lshl_add_u32 v9, v2, 5, s86
    v_lshl_add_u32 v9, v10, 4, v9
    v_lshl_add_u32 v9, v11, 12, v9
    s_lshl_b32 s86, s48, 7
    s_add_u32 s86, s86, 100352
    v_lshl_add_u32 v10, v0, 1, s86
    v_lshl_add_u32 v11, v8, 6, s86
    v_lshl_add_u32 v11, v1, 4, v11
L_h5:
    s_mov_b32 s90, 0
    buffer_load_dword v24, v16, s[16:19], s90 offen sc1
    s_mov_b32 s90, 28672
    buffer_load_dword v25, v16, s[16:19], s90 offen sc1
    s_mov_b32 s90, 57344
    buffer_load_dword v26, v16, s[16:19], s90 offen sc1
    s_mov_b32 s90, 86016
    buffer_load_dword v27, v16, s[16:19], s90 offen sc1
    s_mov_b32 s90, 114688
    buffer_load_dword v28, v16, s[16:19], s90 offen sc1
    s_mov_b32 s90, 143360
    buffer_load_dword v29, v16, s[16:19], s90 offen sc1
    s_mov_b32 s90, 172032
    buffer_load_dword v30, v16, s[16:19], s90 offen sc1
    s_mov_b32 s90, 200704
    buffer_load_dword v31, v16, s[16:19], s90 offen sc1
    s_waitcnt vmcnt(0)
    v_max3_u32 v17, v24, v25, v26
    v_max3_u32 v17, v17, v27, v28
    v_max3_u32 v17, v17, v29, v30
    v_max_u32 v17, v17, v31
    v_cmp_eq_u32 vcc, -1, v17
    s_cbranch_vccz L_ok_5
    s_sub_u32 s56, s56, 1
    s_cbranch_scc0 L_h5
    s_mov_b32 s56, 0
L_ok_5:
    v_mov_b32 v19, v9
    v_add_f32 v24, v24, v25
    v_add_f32 v26, v26, v27
    v_add_f32 v28, v28, v29
    v_add_f32 v30, v30, v31
    v_add_f32 v24, v24, v26
    v_add_f32 v28, v28, v30
    v_cvt_pk_bf16_f32 v25, v24, v28
    v_lshlrev_b32 v24, 16, v25
    v_and_b32 v28, 0xffff0000, v25
    v_mul_f32 v25, 0xbfb8aa3b, v24
    v_exp_f32 v25, v25
    s_nop 0
    v_add_f32 v25, 1.0, v25
    v_rcp_f32 v25, v25
    s_nop 0
    v_mul_f32 v24, v24, v25
    v_cvt_pk_bf16_f32 v24, v24, v24
    v_lshlrev_b32 v24, 16, v24
    v_mul_f32 v24, v24, v28
    v_cvt_pk_bf16_f32 v24, v24, v24
    ds_write_b16 v10, v24
    s_waitcnt lgkmcnt(0)
    ds_read_b128 v[64:67], v11
    s_waitcnt lgkmcnt(0)
    v_perm_b32 v80, v64, v64, v72
    v_perm_b32 v81, v64, v64, v73
    v_perm_b32 v82, v64, v64, v74
    v_perm_b32 v83, v64, v64, v75
    s_nop 1
    v_mfma_f32_16x16x32_bf16 v[88:91], v[80:83], v[228:231], 0
    v_perm_b32 v84, v64, v64, v76
    v_perm_b32 v85, v64, v64, v77
    v_perm_b32 v86, v64, v64, v78
    v_perm_b32 v87, v64, v64, v79
    s_nop 1
    v_mfma_f32_16x16x32_bf16 v[88:91], v[84:87], v[232:235], v[88:91]
    v_perm_b32 v80, v65, v65, v72
    v_perm_b32 v81, v65, v65, v73
    v_perm_b32 v82, v65, v65, v74
    v_perm_b32 v83, v65, v65, v75
    s_nop 1
    v_mfma_f32_16x16x32_bf16 v[88:91], v[80:83], v[236:239], v[88:91]
    v_perm_b32 v84, v65, v65, v76
    v_perm_b32 v85, v65, v65, v77
    v_perm_b32 v86, v65, v65, v78
    v_perm_b32 v87, v65, v65, v79
    s_nop 1
    v_mfma_f32_16x16x32_bf16 v[88:91], v[84:87], v[240:243], v[88:91]
    v_perm_b32 v80, v66, v66, v72
    v_perm_b32 v81, v66, v66, v73
    v_perm_b32 v82, v66, v66, v74
    v_perm_b32 v83, v66, v66, v75
    s_nop 1
    v_mfma_f32_16x16x32_bf16 v[88:91], v[80:83], v[244:247], v[88:91]
    v_perm_b32 v84, v66, v66, v76
    v_perm_b32 v85, v66, v66, v77
    v_perm_b32 v86, v66, v66, v78
    v_perm_b32 v87, v66, v66, v79
    s_nop 1
    v_mfma_f32_16x16x32_bf16 v[88:91], v[84:87], v[248:251], v[88:91]
    v_perm_b32 v80, v67, v67, v72
    v_perm_b32 v81, v67, v67, v73
    v_perm_b32 v82, v67, v67, v74
    v_perm_b32 v83, v67, v67, v75
    s_nop 1
    v_mfma_f32_16x16x32_bf16 v[88:91], v[80:83], v[252:255], v[88:91]
    s_nop 7
    ds_write_b128 v18, v[88:91] offset:4096
    s_waitcnt lgkmcnt(0)
    s_barrier
    s_cmp_lg_u32 s48, 0
    s_cbranch_scc1 L_dn_done
    ds_read_b128 v[20:23], v18 offset:5120
    ds_read_b128 v[24:27], v18 offset:6144
    ds_read_b128 v[28:31], v18 offset:7168
    s_waitcnt lgkmcnt(0)
    v_pk_add_f32 v[88:89], v[88:89], v[20:21]
    v_pk_add_f32 v[24:25], v[24:25], v[28:29]
    v_pk_add_f32 v[88:89], v[88:89], v[24:25]
    v_pk_add_f32 v[90:91], v[90:91], v[22:23]
    v_pk_add_f32 v[26:27], v[26:27], v[30:31]
    v_pk_add_f32 v[90:91], v[90:91], v[26:27]
    buffer_store_dwordx4 v[88:91], v19, s[16:19], 0 offen sc1
L_dn_done:
L_final:
    s_cmp_eq_u64 s[96:97], 0
    s_cbranch_scc1 L_fin
    s_mov_b32 s63, 0
L_fin_loop:
    v_cmp_eq_u32 vcc, s60, v13
    s_cbranch_vccz L_fin_next
    s_cmp_eq_u32 s60, s58
    s_cselect_b32 s86, 0, 512
    s_add_u32 s86, s86, 98304
    v_lshl_add_u32 v8, v2, 3, s86
    v_mov_b32 v9, s86
    ds_read_b64 v[56:57], v8
    ds_read_b64 v[58:59], v8 offset:128
    ds_read_b32 v60, v9 offset:256
    s_lshl_b32 s86, s63, 12
    s_lshl_b32 s87, s52, 8
    s_add_u32 s86, s86, s87
    s_add_u32 s86, s86, 6815744
    v_lshl_add_u32 v10, v2, 4, s86
    v_lshl_add_u32 v10, v1, 13, v10
    s_and_b32 s86, s60, 0x7ff
    s_sub_u32 s86, 2047, s86
    s_lshl_b32 s86, s86, 11
    s_lshl_b32 s87, s52, 7
    s_add_u32 s86, s86, s87
    v_lshl_add_u32 v11, v2, 3, s86
    v_cmp_eq_u32 vcc, 0, v1
    v_mov_b32 v9, 2147483648
    s_nop 0
    v_cndmask_b32 v11, v9, v11, vcc
    s_waitcnt lgkmcnt(0)
    v_mul_f32 v60, 0xbfb8aa3b, v60
    v_exp_f32 v60, v60
    s_nop 0
    v_add_f32 v60, 1.0, v60
    v_rcp_f32 v60, v60
    s_nop 0
    v_cvt_pk_bf16_f32 v60, v60, v60
    v_lshlrev_b32 v60, 16, v60
    v_lshlrev_b32 v64, 16, v56
    v_and_b32 v65, 0xffff0000, v56
    v_lshlrev_b32 v68, 16, v58
    v_and_b32 v69, 0xffff0000, v58
    v_lshlrev_b32 v66, 16, v57
    v_and_b32 v67, 0xffff0000, v57
    v_lshlrev_b32 v70, 16, v59
    v_and_b32 v71, 0xffff0000, v59
L_h6:
    s_mov_b32 s90, 0
    buffer_load_dwordx4 v[112:115], v10, s[16:19], s90 offen sc1
    s_mov_b32 s90, 32768
    buffer_load_dwordx4 v[116:119], v10, s[16:19], s90 offen sc1
    s_mov_b32 s90, 65536
    buffer_load_dwordx4 v[120:123], v10, s[16:19], s90 offen sc1
    s_mov_b32 s90, 98304
    buffer_load_dwordx4 v[124:127], v10, s[16:19], s90 offen sc1
    s_mov_b32 s90, 131072
    buffer_load_dwordx4 v[128:131], v10, s[16:19], s90 offen sc1
    s_mov_b32 s90, 163840
    buffer_load_dwordx4 v[132:135], v10, s[16:19], s90 offen sc1
    s_mov_b32 s90, 196608
    buffer_load_dwordx4 v[136:139], v10, s[16:19], s90 offen sc1
    s_mov_b32 s90, 229376
    buffer_load_dwordx4 v[140:143], v10, s[16:19], s90 offen sc1
    s_waitcnt vmcnt(0)
    v_max3_u32 v8, v115, v119, v123
    v_max3_u32 v8, v8, v127, v131
    v_max3_u32 v8, v8, v135, v139
    v_max_u32 v8, v8, v143
    v_cmp_eq_u32 vcc, -1, v8
    s_cbranch_vccz L_ok_6
    s_sub_u32 s56, s56, 1
    s_cbranch_scc0 L_h6
    s_mov_b32 s56, 0
L_ok_6:
    v_pk_add_f32 v[112:113], v[112:113], v[128:129]
    v_pk_add_f32 v[114:115], v[114:115], v[130:131]
    v_pk_add_f32 v[116:117], v[116:117], v[132:133]
    v_pk_add_f32 v[118:119], v[118:119], v[134:135]
    v_pk_add_f32 v[120:121], v[120:121], v[136:137]
    v_pk_add_f32 v[122:123], v[122:123], v[138:139]
    v_pk_add_f32 v[124:125], v[124:125], v[140:141]
    v_pk_add_f32 v[126:127], v[126:127], v[142:143]
    v_pk_add_f32 v[112:113], v[112:113], v[120:121]
    v_pk_add_f32 v[114:115], v[114:115], v[122:123]
    v_pk_add_f32 v[116:117], v[116:117], v[124:125]
    v_pk_add_f32 v[118:119], v[118:119], v[126:127]
    v_pk_add_f32 v[112:113], v[112:113], v[116:117]
    v_pk_add_f32 v[114:115], v[114:115], v[118:119]
    v_mov_b32 v116, v112
    v_mov_b32 v117, v113
    v_mov_b32 v118, v114
    v_mov_b32 v119, v115
    v_permlane32_swap_b32 v112, v116
    v_permlane32_swap_b32 v113, v117
    v_permlane32_swap_b32 v114, v118
    v_permlane32_swap_b32 v115, v119
    v_add_f32 v112, v112, v116
    v_add_f32 v113, v113, v117
    v_add_f32 v114, v114, v118
    v_add_f32 v115, v115, v119
    v_mov_b32 v116, v112
    v_mov_b32 v117, v113
    v_mov_b32 v118, v114
    v_mov_b32 v119, v115
    v_permlane16_swap_b32 v112, v116
    v_permlane16_swap_b32 v113, v117
    v_permlane16_swap_b32 v114, v118
    v_permlane16_swap_b32 v115, v119
    v_add_f32 v112, v112, v116
    v_add_f32 v113, v113, v117
    v_add_f32 v114, v114, v118
    v_add_f32 v115, v115, v119
    v_cvt_pk_bf16_f32 v116, v112, v113
    v_cvt_pk_bf16_f32 v117, v114, v115
    v_lshlrev_b32 v112, 16, v116
    v_and_b32 v113, 0xffff0000, v116
    v_lshlrev_b32 v114, 16, v117
    v_and_b32 v115, 0xffff0000, v117
    v_pk_mul_f32 v[112:113], v[112:113], v[60:61] op_sel_hi:[1,0]
    v_pk_mul_f32 v[114:115], v[114:115], v[60:61] op_sel_hi:[1,0]
    v_cvt_pk_bf16_f32 v116, v112, v113
    v_cvt_pk_bf16_f32 v117, v114, v115
    v_lshlrev_b32 v112, 16, v116
    v_and_b32 v113, 0xffff0000, v116
    v_lshlrev_b32 v114, 16, v117
    v_and_b32 v115, 0xffff0000, v117
    v_pk_add_f32 v[112:113], v[112:113], v[68:69]
    v_pk_add_f32 v[114:115], v[114:115], v[70:71]
    v_cvt_pk_bf16_f32 v116, v112, v113
    v_cvt_pk_bf16_f32 v117, v114, v115
    v_lshlrev_b32 v112, 16, v116
    v_and_b32 v113, 0xffff0000, v116
    v_lshlrev_b32 v114, 16, v117
    v_and_b32 v115, 0xffff0000, v117
    v_pk_add_f32 v[112:113], v[112:113], v[64:65]
    v_pk_add_f32 v[114:115], v[114:115], v[66:67]
    v_cvt_pk_bf16_f32 v116, v112, v113
    v_cvt_pk_bf16_f32 v117, v114, v115
    buffer_store_dwordx2 v[116:117], v11, s[24:27], 0 offen
L_fin_next:
    s_mov_b32 s60, s61
    s_add_u32 s63, s63, 1
    s_cmp_lt_u32 s63, 2
    s_cbranch_scc1 L_fin_loop
L_fin:
L_end:
    s_endpgm
.section .rodata,"a"
.p2align 6
.amdhsa_kernel sequential_preLN__linear_attn_block__moe_arch_mod__prompt_kernel
  .amdhsa_next_free_vgpr 256
  .amdhsa_next_free_sgpr 102
  .amdhsa_accum_offset 256
  .amdhsa_group_segment_fixed_size 0
  .amdhsa_kernarg_size 88
  .amdhsa_user_sgpr_count 2
  .amdhsa_user_sgpr_kernarg_segment_ptr 1
  .amdhsa_system_sgpr_workgroup_id_x 1
.end_amdhsa_kernel
```

```asm
; @launch grid=(256,1,1) block=(512,1,1) lds=163840
.amdgcn_target "amdgcn-amd-amdhsa--gfx950"
.text
.globl sequential_preLN__linear_attn_block__moe_arch_mod__prompt_kernel
.p2align 8
.type sequential_preLN__linear_attn_block__moe_arch_mod__prompt_kernel,@function
sequential_preLN__linear_attn_block__moe_arch_mod__prompt_kernel:
    s_cmp_ge_u32 s2, 256
    s_cbranch_scc1 L_end
    s_load_dwordx16 s[64:79], s[0:1], 0
    s_load_dwordx4 s[80:83], s[0:1], 64
    s_load_dwordx2 s[84:85], s[0:1], 80
    v_lshrrev_b32 v1, 6, v0
    v_and_b32 v0, 63, v0
    v_readfirstlane_b32 s3, v1
    s_and_b32 s44, s2, 7
    s_lshr_b32 s45, s2, 3
    s_and_b32 s46, s44, 1
    s_lshl_b32 s46, s46, 3
    s_and_b32 s86, s45, 7
    s_add_u32 s46, s46, s86
    s_lshr_b32 s47, s44, 1
    s_lshl_b32 s47, s47, 2
    s_lshr_b32 s86, s45, 3
    s_add_u32 s47, s47, s86
    s_mov_b32 s51, s47
    s_mov_b32 s52, s46
    s_and_b32 s48, s3, 3
    s_and_b32 s49, s3, 1
    s_bfe_u32 s50, s3, 0x10001
    s_mov_b32 s56, 65536
    s_mov_b32 s95, 0x3f803f80
    s_movk_i32 s92, 0x1000
    s_movk_i32 s93, 0x2000
    s_movk_i32 s94, 0x3000
    s_cmp_lt_u32 s3, 4
    s_cbranch_scc1 L_comp
    v_lshrrev_b32 v20, 3, v0
    v_and_b32 v21, 7, v0
    v_lshrrev_b32 v22, 4, v0
    v_xor_b32 v23, v21, v22
    v_xor_b32 v24, 4, v23
    s_lshl_b32 s86, s48, 5
    v_add_u32 v25, s86, v20
    v_lshlrev_b32 v25, 11, v25
    v_lshl_add_u32 v2, v23, 4, v25
    v_lshl_add_u32 v3, v24, 4, v25
    v_add_u32 v3, 15360, v3
    v_lshl_add_u32 v4, v23, 4, v25
    v_add_u32 v4, 30720, v4
    v_lshl_add_u32 v5, v24, 4, v25
    v_add_u32 v5, 46080, v5
    s_lshl_b32 s86, s48, 4
    v_add_u32 v25, s86, v20
    v_mul_u32_u24 v25, 6144, v25
    s_lshl_b32 s86, s47, 7
    v_add_u32 v25, s86, v25
    v_bfe_u32 v26, v0, 4, 1
    v_lshlrev_b32 v26, 1, v26
    v_xor_b32 v26, v26, v21
    v_xor_b32 v27, 4, v26
    v_lshl_add_u32 v6, v26, 4, v25
    v_lshl_add_u32 v7, v27, 4, v25
    v_add_u32 v7, 48128, v7
    v_lshl_add_u32 v8, v26, 4, v25
    v_add_u32 v8, 2048, v8
    v_lshl_add_u32 v9, v27, 4, v25
    v_add_u32 v9, 50176, v9
    v_lshl_add_u32 v10, v26, 4, v25
    v_add_u32 v10, 4096, v10
    v_lshl_add_u32 v11, v27, 4, v25
    v_add_u32 v11, 52224, v11
    s_lshl_b32 s63, s46, 18
    s_lshl_b32 s53, s48, 12
    s_lshl_b32 s62, s48, 11
    s_add_u32 s62, s62, 16384
    s_lshl_b32 s86, s45, 2
    s_add_u32 s86, s86, s48
    s_mul_i32 s87, s86, 12288
    s_and_b32 s88, s47, 12
    s_lshl_b32 s88, s88, 7
    s_add_u32 s87, s87, s88
    s_add_u32 s87, s87, 384
    s_bitcmp1_b32 s47, 2
    s_cselect_b32 s87, 2147483648, s87
    v_lshl_add_u32 v37, v0, 11, s87
    v_mov_b32 v24, 2147483648
    v_cmp_gt_u32 vcc, 6, v0
    s_nop 1
    v_cndmask_b32 v37, v24, v37, vcc
    s_lshl_b32 s86, s86, 14
    s_and_b32 s88, s46, 8
    s_lshl_b32 s88, s88, 7
    s_add_u32 s86, s86, s88
    s_add_u32 s86, s86, 384
    v_lshl_add_u32 v38, v0, 11, s86
    v_cmp_gt_u32 vcc, 8, v0
    s_nop 1
    v_cndmask_b32 v38, v24, v38, vcc
    s_waitcnt lgkmcnt(0)
    s_mov_b32 s8, s64
    s_and_b32 s9, s65, 0xffff
    s_mov_b32 s10, 4194304
    s_mov_b32 s11, 0x20000
    s_mov_b32 s12, s66
    s_and_b32 s13, s67, 0xffff
    s_mov_b32 s14, 6291456
    s_mov_b32 s15, 0x20000
    s_and_b32 s86, s47, 12
    s_and_b32 s87, s46, 8
    s_add_u32 s64, s86, s87
    s_and_b32 s64, s64, 15
    s_load_dword s61, s[84:85], 524288
    s_mov_b32 s67, s64
    s_lshr_b32 s90, s67, 2
    s_mul_i32 s90, s90, 1572864
    buffer_load_dword v39, v37, s[12:15], s90 offen
    s_add_u32 m0, s53, 0
    s_lshl_b32 s90, s64, 7
    s_add_u32 s90, s90, s63
    buffer_load_dwordx4 v2, s[8:11], s90 offen offset:0 lds
    buffer_load_dwordx4 v3, s[8:11], s90 offen offset:1024 lds
    buffer_load_dwordx4 v4, s[8:11], s90 offen offset:2048 lds
    buffer_load_dwordx4 v5, s[8:11], s90 offen offset:3072 lds
    s_mul_i32 s91, s64, 393216
    s_add_u32 s64, s64, 1
    s_and_b32 s64, s64, 15
    s_add_u32 m0, s62, 0
    s_nop 0
    buffer_load_dwordx4 v6, s[12:15], s91 offen offset:0 lds
    buffer_load_dwordx4 v7, s[12:15], s91 offen offset:1024 lds
    s_add_u32 m0, s62, 8192
    s_nop 0
    buffer_load_dwordx4 v8, s[12:15], s91 offen offset:0 lds
    buffer_load_dwordx4 v9, s[12:15], s91 offen offset:1024 lds
    s_add_u32 m0, s62, 16384
    s_nop 0
    buffer_load_dwordx4 v10, s[12:15], s91 offen offset:0 lds
    buffer_load_dwordx4 v11, s[12:15], s91 offen offset:1024 lds
    s_mov_b32 s16, s84
    s_and_b32 s17, s85, 0xffff
    s_mov_b32 s18, 268435456
    s_mov_b32 s19, 0x20000
    s_mov_b32 s20, s68
    s_and_b32 s21, s69, 0xffff
    s_mov_b32 s22, 2097152
    s_mov_b32 s23, 0x20000
    s_mov_b32 s24, s80
    s_and_b32 s25, s81, 0xffff
    s_mov_b32 s26, 4194304
    s_mov_b32 s27, 0x20000
    s_mov_b32 s28, s82
    s_and_b32 s29, s83, 0xffff
    s_mov_b32 s30, 256
    s_mov_b32 s31, 0x20000
    s_bitcmp1_b32 s2, 0
    s_cselect_b32 s32, s76, s74
    s_cselect_b32 s33, s77, s75
    s_and_b32 s33, s33, 0xffff
    s_mov_b32 s34, 7340032
    s_mov_b32 s35, 0x20000
    s_mov_b32 s36, s78
    s_and_b32 s37, s79, 0xffff
    s_mov_b32 s38, 7340032
    s_mov_b32 s39, 0x20000
    s_mov_b32 s40, s72
    s_and_b32 s41, s73, 0xffff
    s_mov_b32 s42, 2048
    s_mov_b32 s43, 0x20000
    v_lshrrev_b32 v22, 4, v0
    v_and_b32 v23, 15, v0
    s_add_u32 m0, s53, 40960
    s_lshl_b32 s90, s64, 7
    s_add_u32 s90, s90, s63
    buffer_load_dwordx4 v2, s[8:11], s90 offen offset:0 lds
    buffer_load_dwordx4 v3, s[8:11], s90 offen offset:1024 lds
    buffer_load_dwordx4 v4, s[8:11], s90 offen offset:2048 lds
    buffer_load_dwordx4 v5, s[8:11], s90 offen offset:3072 lds
    s_mul_i32 s91, s64, 393216
    s_add_u32 s64, s64, 1
    s_and_b32 s64, s64, 15
    s_add_u32 m0, s62, 40960
    s_nop 0
    buffer_load_dwordx4 v6, s[12:15], s91 offen offset:0 lds
    buffer_load_dwordx4 v7, s[12:15], s91 offen offset:1024 lds
    s_add_u32 m0, s62, 49152
    s_nop 0
    buffer_load_dwordx4 v8, s[12:15], s91 offen offset:0 lds
    buffer_load_dwordx4 v9, s[12:15], s91 offen offset:1024 lds
    s_add_u32 m0, s62, 57344
    s_nop 0
    buffer_load_dwordx4 v10, s[12:15], s91 offen offset:0 lds
    buffer_load_dwordx4 v11, s[12:15], s91 offen offset:1024 lds
    s_and_b32 s65, s45, 7
    s_lshr_b32 s66, s45, 3
    s_mul_i32 s86, s65, 11
    s_lshr_b32 s86, s86, 5
    s_mul_i32 s86, s86, 3
    s_sub_u32 s86, s65, s86
    s_mul_i32 s86, s86, 40960
    s_lshl_b32 s87, s48, 13
    s_cmp_eq_u32 s48, 3
    s_cselect_b32 s87, 0, s87
    s_add_u32 s86, s86, s87
    s_add_u32 s86, s86, 16384
    v_lshl_add_u32 v25, v20, 7, s86
    v_lshl_add_u32 v28, v26, 4, v25
    v_lshl_add_u32 v29, v27, 4, v25
    s_cmp_eq_u32 s66, 3
    s_cselect_b32 s86, 0, s66
    s_mul_i32 s86, s86, 40960
    s_add_u32 s86, s86, s53
    v_lshl_add_u32 v16, v0, 6, s86
    v_bfe_u32 v25, v0, 2, 2
    v_lshl_add_u32 v16, v25, 4, v16
    v_xor_b32 v17, 16, v16
    v_xor_b32 v18, 32, v16
    v_xor_b32 v19, 48, v16
    s_lshl_b32 s86, s46, 14
    s_lshl_b32 s87, s48, 8
    s_add_u32 s86, s86, s87
    s_add_u32 s86, s86, 262144
    v_lshl_add_u32 v33, v23, 4, s86
    v_lshl_add_u32 v33, v22, 10, v33
    s_lshl_b32 s87, s47, 10
    s_add_u32 s86, s86, s87
    v_lshl_add_u32 v13, v0, 2, s86
    v_and_b32 v25, 3, v0
    v_cmp_eq_u32 vcc, 0, v25
    v_mov_b32 v24, 2147483648
    s_nop 0
    v_cndmask_b32 v13, v24, v13, vcc
    s_mul_i32 s86, s47, 12288
    s_add_u32 s86, s86, 65536
    s_lshl_b32 s87, s48, 8
    s_cmp_eq_u32 s48, 3
    s_cselect_b32 s87, 0, s87
    s_cselect_b32 s88, 2147483648, 0
    s_add_u32 s86, s86, s87
    v_lshl_add_u32 v32, v23, 4, s86
    v_mul_u32_u24 v25, 768, v22
    v_add_u32 v32, v32, v25
    s_mul_i32 s87, s46, 768
    s_add_u32 s86, s86, s87
    s_add_u32 s86, s86, s88
    v_lshl_add_u32 v34, v23, 5, s86
    v_lshl_add_u32 v34, v22, 4, v34
    v_and_b32 v25, 0x28, v0
    v_cmp_eq_u32 vcc, 0, v25
    s_nop 1
    v_cndmask_b32 v34, v24, v34, vcc
    s_bfe_u32 s86, s2, 0x20001
    s_lshl_b32 s86, s86, 2
    s_add_u32 s86, s86, s48
    s_lshl_b32 s86, s86, 6
    v_lshl_add_u32 v30, v22, 4, s86
    v_mul_u32_u24 v30, 7168, v30
    s_lshl_b32 s86, s45, 8
    s_cmp_ge_u32 s2, 224
    s_cselect_b32 s86, 2147483648, s86
    v_lshl_add_u32 v24, v23, 4, s86
    v_add_u32 v30, v30, v24
    s_mul_i32 s86, s45, 112
    s_mul_i32 s87, s48, 28
    s_add_u32 s86, s86, s87
    v_mul_u32_u24 v31, 7, v22
    v_add_u32 v31, s86, v31
    v_lshlrev_b32 v31, 11, v31
    s_lshl_b32 s86, s44, 8
    v_lshl_add_u32 v24, v23, 4, s86
    v_add_u32 v31, v31, v24
    v_lshlrev_b32 v24, 1, v22
    v_xor_b32 v24, v24, v21
    s_lshl_b32 s86, s48, 3
    v_add_u32 v12, s86, v20
    v_lshlrev_b32 v12, 11, v12
    s_lshl_b32 s86, s52, 7
    v_lshl_add_u32 v24, v24, 4, s86
    v_add_u32 v12, v12, v24
    s_lshl_b32 s89, s48, 10
    v_and_b32 v24, 1, v0
    v_lshlrev_b32 v24, 4, v24
    v_mov_b32 v25, 0x3f80
    v_lshlrev_b32 v24, v24, v25
    v_bfe_u32 v25, v0, 1, 2
    v_cmp_eq_u32 vcc, 0, v25
    s_nop 1
    v_cndmask_b32 v104, 0, v24, vcc
    v_cmp_eq_u32 vcc, 1, v25
    s_nop 1
    v_cndmask_b32 v105, 0, v24, vcc
    v_cmp_eq_u32 vcc, 2, v25
    s_nop 1
    v_cndmask_b32 v106, 0, v24, vcc
    v_cmp_eq_u32 vcc, 3, v25
    s_nop 1
    v_cndmask_b32 v107, 0, v24, vcc
    s_waitcnt lgkmcnt(0)
    s_add_u32 s61, s61, 0x9e3779b9
    v_mov_b32 v35, s61
    v_mov_b32 v36, 135168
    v_lshl_add_u32 v24, v21, 2, v36
    v_mov_b32 v25, 0
    ds_write_b32 v24, v25
    s_waitcnt lgkmcnt(0)
    s_waitcnt vmcnt(10)
    s_barrier
    s_add_u32 m0, s53, 81920
    s_lshl_b32 s90, s64, 7
    s_add_u32 s90, s90, s63
    buffer_load_dwordx4 v2, s[8:11], s90 offen offset:0 lds
    buffer_load_dwordx4 v3, s[8:11], s90 offen offset:1024 lds
    buffer_load_dwordx4 v4, s[8:11], s90 offen offset:2048 lds
    buffer_load_dwordx4 v5, s[8:11], s90 offen offset:3072 lds
    s_mul_i32 s91, s64, 393216
    s_add_u32 s64, s64, 1
    s_and_b32 s64, s64, 15
    s_add_u32 m0, s62, 81920
    s_nop 0
    buffer_load_dwordx4 v6, s[12:15], s91 offen offset:0 lds
    buffer_load_dwordx4 v7, s[12:15], s91 offen offset:1024 lds
    s_add_u32 m0, s62, 90112
    s_nop 0
    buffer_load_dwordx4 v8, s[12:15], s91 offen offset:0 lds
    buffer_load_dwordx4 v9, s[12:15], s91 offen offset:1024 lds
    s_add_u32 m0, s62, 98304
    s_nop 0
    buffer_load_dwordx4 v10, s[12:15], s91 offen offset:0 lds
    buffer_load_dwordx4 v11, s[12:15], s91 offen offset:1024 lds
    s_lshr_b32 s90, s67, 2
    s_add_u32 s90, s90, 1
    s_and_b32 s90, s90, 3
    s_mul_i32 s90, s90, 1572864
    buffer_load_dword v39, v37, s[12:15], s90 offen
    s_cmp_lg_u32 s65, 0
    s_cbranch_scc1 L_h0c0
    ds_read_b128 v[40:43], v28 offset:0
    ds_read_b128 v[44:47], v29 offset:1024
    ds_read_b128 v[48:51], v28 offset:2048
    ds_read_b128 v[52:55], v29 offset:3072
    ds_read_b128 v[56:59], v28 offset:4096
    ds_read_b128 v[60:63], v29 offset:5120
    ds_read_b128 v[64:67], v28 offset:6144
    ds_read_b128 v[68:71], v29 offset:7168
L_h0c0:
    s_cmp_lg_u32 s66, 0
    s_cbranch_scc1 L_h0r0
    ds_read_b128 v[72:75], v16
    ds_read_b128 v[76:79], v17
    ds_read_b128 v[80:83], v18
    ds_read_b128 v[84:87], v19
L_h0r0:
    s_waitcnt lgkmcnt(0)
    s_waitcnt vmcnt(11)
    s_barrier
    s_add_u32 m0, s53, 0
    s_lshl_b32 s90, s64, 7
    s_add_u32 s90, s90, s63
    buffer_load_dwordx4 v2, s[8:11], s90 offen offset:0 lds
    buffer_load_dwordx4 v3, s[8:11], s90 offen offset:1024 lds
    buffer_load_dwordx4 v4, s[8:11], s90 offen offset:2048 lds
    buffer_load_dwordx4 v5, s[8:11], s90 offen offset:3072 lds
    s_mul_i32 s91, s64, 393216
    s_add_u32 s64, s64, 1
    s_and_b32 s64, s64, 15
    s_add_u32 m0, s62, 0
    s_nop 0
    buffer_load_dwordx4 v6, s[12:15], s91 offen offset:0 lds
    buffer_load_dwordx4 v7, s[12:15], s91 offen offset:1024 lds
    s_add_u32 m0, s62, 8192
    s_nop 0
    buffer_load_dwordx4 v8, s[12:15], s91 offen offset:0 lds
    buffer_load_dwordx4 v9, s[12:15], s91 offen offset:1024 lds
    s_add_u32 m0, s62, 16384
    s_nop 0
    buffer_load_dwordx4 v10, s[12:15], s91 offen offset:0 lds
    buffer_load_dwordx4 v11, s[12:15], s91 offen offset:1024 lds
    s_cmp_lg_u32 s65, 1
    s_cbranch_scc1 L_h0c1
    ds_read_b128 v[40:43], v28 offset:0
    ds_read_b128 v[44:47], v29 offset:1024
    ds_read_b128 v[48:51], v28 offset:2048
    ds_read_b128 v[52:55], v29 offset:3072
    ds_read_b128 v[56:59], v28 offset:4096
    ds_read_b128 v[60:63], v29 offset:5120
    ds_read_b128 v[64:67], v28 offset:6144
    ds_read_b128 v[68:71], v29 offset:7168
L_h0c1:
    s_cmp_lg_u32 s66, 1
    s_cbranch_scc1 L_h0r1
    ds_read_b128 v[72:75], v16
    ds_read_b128 v[76:79], v17
    ds_read_b128 v[80:83], v18
    ds_read_b128 v[84:87], v19
L_h0r1:
    s_waitcnt lgkmcnt(0)
    s_waitcnt vmcnt(11)
    s_barrier
    s_add_u32 m0, s53, 40960
    s_lshl_b32 s90, s64, 7
    s_add_u32 s90, s90, s63
    buffer_load_dwordx4 v2, s[8:11], s90 offen offset:0 lds
    buffer_load_dwordx4 v3, s[8:11], s90 offen offset:1024 lds
    buffer_load_dwordx4 v4, s[8:11], s90 offen offset:2048 lds
    buffer_load_dwordx4 v5, s[8:11], s90 offen offset:3072 lds
    s_mul_i32 s91, s64, 393216
    s_add_u32 s64, s64, 1
    s_and_b32 s64, s64, 15
    s_add_u32 m0, s62, 40960
    s_nop 0
    buffer_load_dwordx4 v6, s[12:15], s91 offen offset:0 lds
    buffer_load_dwordx4 v7, s[12:15], s91 offen offset:1024 lds
    s_add_u32 m0, s62, 49152
    s_nop 0
    buffer_load_dwordx4 v8, s[12:15], s91 offen offset:0 lds
    buffer_load_dwordx4 v9, s[12:15], s91 offen offset:1024 lds
    s_add_u32 m0, s62, 57344
    s_nop 0
    buffer_load_dwordx4 v10, s[12:15], s91 offen offset:0 lds
    buffer_load_dwordx4 v11, s[12:15], s91 offen offset:1024 lds
    s_cmp_lg_u32 s65, 2
    s_cbranch_scc1 L_h0c2
    ds_read_b128 v[40:43], v28 offset:0
    ds_read_b128 v[44:47], v29 offset:1024
    ds_read_b128 v[48:51], v28 offset:2048
    ds_read_b128 v[52:55], v29 offset:3072
    ds_read_b128 v[56:59], v28 offset:4096
    ds_read_b128 v[60:63], v29 offset:5120
    ds_read_b128 v[64:67], v28 offset:6144
    ds_read_b128 v[68:71], v29 offset:7168
L_h0c2:
    s_cmp_lg_u32 s66, 2
    s_cbranch_scc1 L_h0r2
    ds_read_b128 v[72:75], v16
    ds_read_b128 v[76:79], v17
    ds_read_b128 v[80:83], v18
    ds_read_b128 v[84:87], v19
L_h0r2:
    s_waitcnt lgkmcnt(0)
    s_waitcnt vmcnt(10)
    s_barrier
    s_add_u32 m0, s53, 81920
    s_lshl_b32 s90, s64, 7
    s_add_u32 s90, s90, s63
    buffer_load_dwordx4 v2, s[8:11], s90 offen offset:0 lds
    buffer_load_dwordx4 v3, s[8:11], s90 offen offset:1024 lds
    buffer_load_dwordx4 v4, s[8:11], s90 offen offset:2048 lds
    buffer_load_dwordx4 v5, s[8:11], s90 offen offset:3072 lds
    s_mul_i32 s91, s64, 393216
    s_add_u32 s64, s64, 1
    s_and_b32 s64, s64, 15
    s_add_u32 m0, s62, 81920
    s_nop 0
    buffer_load_dwordx4 v6, s[12:15], s91 offen offset:0 lds
    buffer_load_dwordx4 v7, s[12:15], s91 offen offset:1024 lds
    s_add_u32 m0, s62, 90112
    s_nop 0
    buffer_load_dwordx4 v8, s[12:15], s91 offen offset:0 lds
    buffer_load_dwordx4 v9, s[12:15], s91 offen offset:1024 lds
    s_add_u32 m0, s62, 98304
    s_nop 0
    buffer_load_dwordx4 v10, s[12:15], s91 offen offset:0 lds
    buffer_load_dwordx4 v11, s[12:15], s91 offen offset:1024 lds
    s_lshr_b32 s90, s67, 2
    s_add_u32 s90, s90, 2
    s_and_b32 s90, s90, 3
    s_mul_i32 s90, s90, 1572864
    buffer_load_dword v39, v37, s[12:15], s90 offen
    s_cmp_lg_u32 s65, 3
    s_cbranch_scc1 L_h0c3
    ds_read_b128 v[40:43], v28 offset:0
    ds_read_b128 v[44:47], v29 offset:1024
    ds_read_b128 v[48:51], v28 offset:2048
    ds_read_b128 v[52:55], v29 offset:3072
    ds_read_b128 v[56:59], v28 offset:4096
    ds_read_b128 v[60:63], v29 offset:5120
    ds_read_b128 v[64:67], v28 offset:6144
    ds_read_b128 v[68:71], v29 offset:7168
L_h0c3:
    s_cmp_lg_u32 s66, 3
    s_cbranch_scc1 L_h0r3
    ds_read_b128 v[72:75], v16
    ds_read_b128 v[76:79], v17
    ds_read_b128 v[80:83], v18
    ds_read_b128 v[84:87], v19
L_h0r3:
    s_waitcnt lgkmcnt(0)
    s_waitcnt vmcnt(11)
    s_barrier
    s_add_u32 m0, s53, 0
    s_lshl_b32 s90, s64, 7
    s_add_u32 s90, s90, s63
    buffer_load_dwordx4 v2, s[8:11], s90 offen offset:0 lds
    buffer_load_dwordx4 v3, s[8:11], s90 offen offset:1024 lds
    buffer_load_dwordx4 v4, s[8:11], s90 offen offset:2048 lds
    buffer_load_dwordx4 v5, s[8:11], s90 offen offset:3072 lds
    s_mul_i32 s91, s64, 393216
    s_add_u32 s64, s64, 1
    s_and_b32 s64, s64, 15
    s_add_u32 m0, s62, 0
    s_nop 0
    buffer_load_dwordx4 v6, s[12:15], s91 offen offset:0 lds
    buffer_load_dwordx4 v7, s[12:15], s91 offen offset:1024 lds
    s_add_u32 m0, s62, 8192
    s_nop 0
    buffer_load_dwordx4 v8, s[12:15], s91 offen offset:0 lds
    buffer_load_dwordx4 v9, s[12:15], s91 offen offset:1024 lds
    s_add_u32 m0, s62, 16384
    s_nop 0
    buffer_load_dwordx4 v10, s[12:15], s91 offen offset:0 lds
    buffer_load_dwordx4 v11, s[12:15], s91 offen offset:1024 lds
    s_cmp_lg_u32 s65, 4
    s_cbranch_scc1 L_h0c4
    ds_read_b128 v[40:43], v28 offset:0
    ds_read_b128 v[44:47], v29 offset:1024
    ds_read_b128 v[48:51], v28 offset:2048
    ds_read_b128 v[52:55], v29 offset:3072
    ds_read_b128 v[56:59], v28 offset:4096
    ds_read_b128 v[60:63], v29 offset:5120
    ds_read_b128 v[64:67], v28 offset:6144
    ds_read_b128 v[68:71], v29 offset:7168
L_h0c4:
    s_waitcnt lgkmcnt(0)
    v_mov_b32 v88, 0
    v_mov_b32 v89, 0
    v_mov_b32 v90, 0
    v_mov_b32 v91, 0
    v_mov_b32 v92, 0
    v_mov_b32 v93, 0
    v_mov_b32 v94, 0
    v_mov_b32 v95, 0
    v_dot2c_f32_bf16 v88, s95, v72
    v_dot2c_f32_bf16 v89, s95, v73
    v_dot2c_f32_bf16 v90, s95, v74
    v_dot2c_f32_bf16 v91, s95, v75
    v_dot2c_f32_bf16 v92, v72, v72
    v_dot2c_f32_bf16 v93, v73, v73
    v_dot2c_f32_bf16 v94, v74, v74
    v_dot2c_f32_bf16 v95, v75, v75
    v_dot2c_f32_bf16 v88, s95, v76
    v_dot2c_f32_bf16 v89, s95, v77
    v_dot2c_f32_bf16 v90, s95, v78
    v_dot2c_f32_bf16 v91, s95, v79
    v_dot2c_f32_bf16 v92, v76, v76
    v_dot2c_f32_bf16 v93, v77, v77
    v_dot2c_f32_bf16 v94, v78, v78
    v_dot2c_f32_bf16 v95, v79, v79
    v_dot2c_f32_bf16 v88, s95, v80
    v_dot2c_f32_bf16 v89, s95, v81
    v_dot2c_f32_bf16 v90, s95, v82
    v_dot2c_f32_bf16 v91, s95, v83
    v_dot2c_f32_bf16 v92, v80, v80
    v_dot2c_f32_bf16 v93, v81, v81
    v_dot2c_f32_bf16 v94, v82, v82
    v_dot2c_f32_bf16 v95, v83, v83
    v_dot2c_f32_bf16 v88, s95, v84
    v_dot2c_f32_bf16 v89, s95, v85
    v_dot2c_f32_bf16 v90, s95, v86
    v_dot2c_f32_bf16 v91, s95, v87
    v_dot2c_f32_bf16 v92, v84, v84
    v_dot2c_f32_bf16 v93, v85, v85
    v_dot2c_f32_bf16 v94, v86, v86
    v_dot2c_f32_bf16 v95, v87, v87
    s_waitcnt vmcnt(11)
    s_barrier
    s_add_u32 m0, s53, 40960
    s_lshl_b32 s90, s64, 7
    s_add_u32 s90, s90, s63
    buffer_load_dwordx4 v2, s[8:11], s90 offen offset:0 lds
    buffer_load_dwordx4 v3, s[8:11], s90 offen offset:1024 lds
    buffer_load_dwordx4 v4, s[8:11], s90 offen offset:2048 lds
    buffer_load_dwordx4 v5, s[8:11], s90 offen offset:3072 lds
    s_mul_i32 s91, s64, 393216
    s_add_u32 s64, s64, 1
    s_and_b32 s64, s64, 15
    s_add_u32 m0, s62, 40960
    s_nop 0
    buffer_load_dwordx4 v6, s[12:15], s91 offen offset:0 lds
    buffer_load_dwordx4 v7, s[12:15], s91 offen offset:1024 lds
    s_add_u32 m0, s62, 49152
    s_nop 0
    buffer_load_dwordx4 v8, s[12:15], s91 offen offset:0 lds
    buffer_load_dwordx4 v9, s[12:15], s91 offen offset:1024 lds
    s_add_u32 m0, s62, 57344
    s_nop 0
    buffer_load_dwordx4 v10, s[12:15], s91 offen offset:0 lds
    buffer_load_dwordx4 v11, s[12:15], s91 offen offset:1024 lds
    buffer_load_dword v39, v38, s[20:23], 0 offen
    s_cmp_lg_u32 s65, 5
    s_cbranch_scc1 L_h0c5
    ds_read_b128 v[40:43], v28 offset:0
    ds_read_b128 v[44:47], v29 offset:1024
    ds_read_b128 v[48:51], v28 offset:2048
    ds_read_b128 v[52:55], v29 offset:3072
    ds_read_b128 v[56:59], v28 offset:4096
    ds_read_b128 v[60:63], v29 offset:5120
    ds_read_b128 v[64:67], v28 offset:6144
    ds_read_b128 v[68:71], v29 offset:7168
L_h0c5:
    s_waitcnt lgkmcnt(0)
    v_pk_add_f32 v[88:89], v[88:89], v[90:91]
    v_pk_add_f32 v[92:93], v[92:93], v[94:95]
    v_add_f32 v88, v88, v89
    v_add_f32 v89, v92, v93
    s_nop 0
    v_add_f32_dpp v88, v88, v88 quad_perm:[1,0,3,2] row_mask:0xf bank_mask:0xf
    v_add_f32_dpp v89, v89, v89 quad_perm:[1,0,3,2] row_mask:0xf bank_mask:0xf
    s_nop 0
    v_mov_b32_dpp v90, v88 quad_perm:[2,2,2,2] row_mask:0xf bank_mask:0xf
    v_mov_b32_dpp v91, v89 quad_perm:[2,2,2,2] row_mask:0xf bank_mask:0xf
    s_mov_b32 s86, 117835008
    v_perm_b32 v88, v88, v35, s86
    s_mov_b32 s86, 117835009
    v_perm_b32 v89, v89, v35, s86
    s_mov_b32 s86, 117835010
    v_perm_b32 v90, v90, v35, s86
    s_mov_b32 s86, 117835011
    v_perm_b32 v91, v91, v35, s86
    s_waitcnt vmcnt(11)
    s_barrier
    s_add_u32 m0, s53, 81920
    s_lshl_b32 s90, s64, 7
    s_add_u32 s90, s90, s63
    buffer_load_dwordx4 v2, s[8:11], s90 offen offset:0 lds
    buffer_load_dwordx4 v3, s[8:11], s90 offen offset:1024 lds
    buffer_load_dwordx4 v4, s[8:11], s90 offen offset:2048 lds
    buffer_load_dwordx4 v5, s[8:11], s90 offen offset:3072 lds
    s_mul_i32 s91, s64, 393216
    s_add_u32 s64, s64, 1
    s_and_b32 s64, s64, 15
    s_add_u32 m0, s62, 81920
    s_nop 0
    buffer_load_dwordx4 v6, s[12:15], s91 offen offset:0 lds
    buffer_load_dwordx4 v7, s[12:15], s91 offen offset:1024 lds
    s_add_u32 m0, s62, 90112
    s_nop 0
    buffer_load_dwordx4 v8, s[12:15], s91 offen offset:0 lds
    buffer_load_dwordx4 v9, s[12:15], s91 offen offset:1024 lds
    s_add_u32 m0, s62, 98304
    s_nop 0
    buffer_load_dwordx4 v10, s[12:15], s91 offen offset:0 lds
    buffer_load_dwordx4 v11, s[12:15], s91 offen offset:1024 lds
    s_lshr_b32 s90, s67, 2
    s_add_u32 s90, s90, 3
    s_and_b32 s90, s90, 3
    s_mul_i32 s90, s90, 1572864
    buffer_load_dword v39, v37, s[12:15], s90 offen
    s_cmp_lg_u32 s65, 6
    s_cbranch_scc1 L_h0c6
    ds_read_b128 v[40:43], v28 offset:0
    ds_read_b128 v[44:47], v29 offset:1024
    ds_read_b128 v[48:51], v28 offset:2048
    ds_read_b128 v[52:55], v29 offset:3072
    ds_read_b128 v[56:59], v28 offset:4096
    ds_read_b128 v[60:63], v29 offset:5120
    ds_read_b128 v[64:67], v28 offset:6144
    ds_read_b128 v[68:71], v29 offset:7168
L_h0c6:
    s_waitcnt lgkmcnt(0)
    s_waitcnt vmcnt(12)
    s_barrier
    s_add_u32 m0, s53, 0
    s_lshl_b32 s90, s64, 7
    s_add_u32 s90, s90, s63
    buffer_load_dwordx4 v2, s[8:11], s90 offen offset:0 lds
    buffer_load_dwordx4 v3, s[8:11], s90 offen offset:1024 lds
    buffer_load_dwordx4 v4, s[8:11], s90 offen offset:2048 lds
    buffer_load_dwordx4 v5, s[8:11], s90 offen offset:3072 lds
    s_mul_i32 s91, s64, 393216
    s_add_u32 s64, s64, 1
    s_and_b32 s64, s64, 15
    s_add_u32 m0, s62, 0
    s_nop 0
    buffer_load_dwordx4 v6, s[12:15], s91 offen offset:0 lds
    buffer_load_dwordx4 v7, s[12:15], s91 offen offset:1024 lds
    s_add_u32 m0, s62, 8192
    s_nop 0
    buffer_load_dwordx4 v8, s[12:15], s91 offen offset:0 lds
    buffer_load_dwordx4 v9, s[12:15], s91 offen offset:1024 lds
    s_add_u32 m0, s62, 16384
    s_nop 0
    buffer_load_dwordx4 v10, s[12:15], s91 offen offset:0 lds
    buffer_load_dwordx4 v11, s[12:15], s91 offen offset:1024 lds
    s_cmp_lg_u32 s65, 7
    s_cbranch_scc1 L_h0c7
    ds_read_b128 v[40:43], v28 offset:0
    ds_read_b128 v[44:47], v29 offset:1024
    ds_read_b128 v[48:51], v28 offset:2048
    ds_read_b128 v[52:55], v29 offset:3072
    ds_read_b128 v[56:59], v28 offset:4096
    ds_read_b128 v[60:63], v29 offset:5120
    ds_read_b128 v[64:67], v28 offset:6144
    ds_read_b128 v[68:71], v29 offset:7168
L_h0c7:
    s_waitcnt lgkmcnt(0)
    s_waitcnt vmcnt(11)
    s_barrier
    s_add_u32 m0, s53, 40960
    s_lshl_b32 s90, s64, 7
    s_add_u32 s90, s90, s63
    buffer_load_dwordx4 v2, s[8:11], s90 offen offset:0 lds
    buffer_load_dwordx4 v3, s[8:11], s90 offen offset:1024 lds
    buffer_load_dwordx4 v4, s[8:11], s90 offen offset:2048 lds
    buffer_load_dwordx4 v5, s[8:11], s90 offen offset:3072 lds
    s_mul_i32 s91, s64, 393216
    s_add_u32 s64, s64, 1
    s_and_b32 s64, s64, 15
    s_add_u32 m0, s62, 40960
    s_nop 0
    buffer_load_dwordx4 v6, s[12:15], s91 offen offset:0 lds
    buffer_load_dwordx4 v7, s[12:15], s91 offen offset:1024 lds
    s_add_u32 m0, s62, 49152
    s_nop 0
    buffer_load_dwordx4 v8, s[12:15], s91 offen offset:0 lds
    buffer_load_dwordx4 v9, s[12:15], s91 offen offset:1024 lds
    s_add_u32 m0, s62, 57344
    s_nop 0
    buffer_load_dwordx4 v10, s[12:15], s91 offen offset:0 lds
    buffer_load_dwordx4 v11, s[12:15], s91 offen offset:1024 lds
    v_mfma_f32_16x16x32_bf16 v[108:111], v[104:107], v[40:43], 0
    v_mfma_f32_16x16x32_bf16 v[108:111], v[104:107], v[44:47], v[108:111]
    v_mfma_f32_16x16x32_bf16 v[108:111], v[104:107], v[48:51], v[108:111]
    v_mfma_f32_16x16x32_bf16 v[108:111], v[104:107], v[52:55], v[108:111]
    v_mfma_f32_16x16x32_bf16 v[108:111], v[104:107], v[56:59], v[108:111]
    v_mfma_f32_16x16x32_bf16 v[108:111], v[104:107], v[60:63], v[108:111]
    v_mfma_f32_16x16x32_bf16 v[108:111], v[104:107], v[64:67], v[108:111]
    v_mfma_f32_16x16x32_bf16 v[108:111], v[104:107], v[68:71], v[108:111]
    s_nop 7
    v_add_f32_dpp v108, v108, v108 row_ror:8 row_mask:0xf bank_mask:0xf
    v_add_f32_dpp v109, v109, v109 row_ror:8 row_mask:0xf bank_mask:0xf
    v_add_f32_dpp v110, v110, v110 row_ror:8 row_mask:0xf bank_mask:0xf
    v_add_f32_dpp v111, v111, v111 row_ror:8 row_mask:0xf bank_mask:0xf
    s_mov_b32 s86, 117835008
    v_perm_b32 v108, v108, v35, s86
    s_mov_b32 s86, 117835009
    v_perm_b32 v109, v109, v35, s86
    s_mov_b32 s86, 117835010
    v_perm_b32 v110, v110, v35, s86
    s_mov_b32 s86, 117835011
    v_perm_b32 v111, v111, v35, s86
    s_waitcnt vmcnt(10)
    s_barrier
    s_add_u32 m0, s53, 81920
    s_lshl_b32 s90, s64, 7
    s_add_u32 s90, s90, s63
    buffer_load_dwordx4 v2, s[8:11], s90 offen offset:0 lds
    buffer_load_dwordx4 v3, s[8:11], s90 offen offset:1024 lds
    buffer_load_dwordx4 v4, s[8:11], s90 offen offset:2048 lds
    buffer_load_dwordx4 v5, s[8:11], s90 offen offset:3072 lds
    s_mul_i32 s91, s64, 393216
    s_add_u32 s64, s64, 1
    s_and_b32 s64, s64, 15
    s_add_u32 m0, s62, 81920
    s_nop 0
    buffer_load_dwordx4 v6, s[12:15], s91 offen offset:0 lds
    buffer_load_dwordx4 v7, s[12:15], s91 offen offset:1024 lds
    s_add_u32 m0, s62, 90112
    s_nop 0
    buffer_load_dwordx4 v8, s[12:15], s91 offen offset:0 lds
    buffer_load_dwordx4 v9, s[12:15], s91 offen offset:1024 lds
    s_add_u32 m0, s62, 98304
    s_nop 0
    buffer_load_dwordx4 v10, s[12:15], s91 offen offset:0 lds
    buffer_load_dwordx4 v11, s[12:15], s91 offen offset:1024 lds
    buffer_store_dwordx4 v[108:111], v34, s[16:19], 0 offen sc1
    buffer_store_dwordx4 v[88:91], v13, s[16:19], 0 offen sc1
    s_waitcnt vmcnt(12)
    s_barrier
    s_add_u32 m0, s53, 0
    s_lshl_b32 s90, s64, 7
    s_add_u32 s90, s90, s63
    buffer_load_dwordx4 v2, s[8:11], s90 offen offset:0 lds
    buffer_load_dwordx4 v3, s[8:11], s90 offen offset:1024 lds
    buffer_load_dwordx4 v4, s[8:11], s90 offen offset:2048 lds
    buffer_load_dwordx4 v5, s[8:11], s90 offen offset:3072 lds
    s_mul_i32 s91, s64, 393216
    s_add_u32 s64, s64, 1
    s_and_b32 s64, s64, 15
    s_add_u32 m0, s62, 0
    s_nop 0
    buffer_load_dwordx4 v6, s[12:15], s91 offen offset:0 lds
    buffer_load_dwordx4 v7, s[12:15], s91 offen offset:1024 lds
    s_add_u32 m0, s62, 8192
    s_nop 0
    buffer_load_dwordx4 v8, s[12:15], s91 offen offset:0 lds
    buffer_load_dwordx4 v9, s[12:15], s91 offen offset:1024 lds
    s_add_u32 m0, s62, 16384
    s_nop 0
    buffer_load_dwordx4 v10, s[12:15], s91 offen offset:0 lds
    buffer_load_dwordx4 v11, s[12:15], s91 offen offset:1024 lds
    s_add_u32 m0, s89, 122880
    s_mov_b32 s90, 1966080
    buffer_load_dwordx4 v12, s[20:23], s90 offen lds
    s_add_u32 m0, s89, 126976
    s_mov_b32 s90, 2031616
    buffer_load_dwordx4 v12, s[20:23], s90 offen lds
    s_waitcnt vmcnt(14)
    s_barrier
    s_add_u32 m0, s53, 40960
    s_lshl_b32 s90, s64, 7
    s_add_u32 s90, s90, s63
    buffer_load_dwordx4 v2, s[8:11], s90 offen offset:0 lds
    buffer_load_dwordx4 v3, s[8:11], s90 offen offset:1024 lds
    buffer_load_dwordx4 v4, s[8:11], s90 offen offset:2048 lds
    buffer_load_dwordx4 v5, s[8:11], s90 offen offset:3072 lds
    s_mul_i32 s91, s64, 393216
    s_add_u32 s64, s64, 1
    s_and_b32 s64, s64, 15
    s_add_u32 m0, s62, 40960
    s_nop 0
    buffer_load_dwordx4 v6, s[12:15], s91 offen offset:0 lds
    buffer_load_dwordx4 v7, s[12:15], s91 offen offset:1024 lds
    s_add_u32 m0, s62, 49152
    s_nop 0
    buffer_load_dwordx4 v8, s[12:15], s91 offen offset:0 lds
    buffer_load_dwordx4 v9, s[12:15], s91 offen offset:1024 lds
    s_add_u32 m0, s62, 57344
    s_nop 0
    buffer_load_dwordx4 v10, s[12:15], s91 offen offset:0 lds
    buffer_load_dwordx4 v11, s[12:15], s91 offen offset:1024 lds
    s_waitcnt vmcnt(12)
    s_barrier
    s_add_u32 m0, s53, 81920
    s_lshl_b32 s90, s64, 7
    s_add_u32 s90, s90, s63
    buffer_load_dwordx4 v2, s[8:11], s90 offen offset:0 lds
    buffer_load_dwordx4 v3, s[8:11], s90 offen offset:1024 lds
    buffer_load_dwordx4 v4, s[8:11], s90 offen offset:2048 lds
    buffer_load_dwordx4 v5, s[8:11], s90 offen offset:3072 lds
    s_mul_i32 s91, s64, 393216
    s_add_u32 s64, s64, 1
    s_and_b32 s64, s64, 15
    s_add_u32 m0, s62, 81920
    s_nop 0
    buffer_load_dwordx4 v6, s[12:15], s91 offen offset:0 lds
    buffer_load_dwordx4 v7, s[12:15], s91 offen offset:1024 lds
    s_add_u32 m0, s62, 90112
    s_nop 0
    buffer_load_dwordx4 v8, s[12:15], s91 offen offset:0 lds
    buffer_load_dwordx4 v9, s[12:15], s91 offen offset:1024 lds
    s_add_u32 m0, s62, 98304
    s_nop 0
    buffer_load_dwordx4 v10, s[12:15], s91 offen offset:0 lds
    buffer_load_dwordx4 v11, s[12:15], s91 offen offset:1024 lds
    s_mov_b32 s90, 0
    buffer_load_dwordx4 v[40:43], v32, s[16:19], s90 offen sc1
    s_mov_b32 s90, 3072
    buffer_load_dwordx4 v[44:47], v32, s[16:19], s90 offen sc1
    s_mov_b32 s90, 6144
    buffer_load_dwordx4 v[48:51], v32, s[16:19], s90 offen sc1
    s_mov_b32 s90, 9216
    buffer_load_dwordx4 v[52:55], v32, s[16:19], s90 offen sc1
    buffer_load_dwordx4 v[56:59], v33, s[16:19], 0 offen sc1
    buffer_load_dwordx4 v[60:63], v33, s[16:19], s92 offen sc1
    buffer_load_dwordx4 v[64:67], v33, s[16:19], s93 offen sc1
    buffer_load_dwordx4 v[68:71], v33, s[16:19], s94 offen sc1
    s_waitcnt vmcnt(18)
    s_barrier
    s_add_u32 m0, s53, 0
    s_lshl_b32 s90, s64, 7
    s_add_u32 s90, s90, s63
    buffer_load_dwordx4 v2, s[8:11], s90 offen offset:0 lds
    buffer_load_dwordx4 v3, s[8:11], s90 offen offset:1024 lds
    buffer_load_dwordx4 v4, s[8:11], s90 offen offset:2048 lds
    buffer_load_dwordx4 v5, s[8:11], s90 offen offset:3072 lds
    s_mul_i32 s91, s64, 393216
    s_add_u32 s64, s64, 1
    s_and_b32 s64, s64, 15
    s_add_u32 m0, s62, 0
    s_nop 0
    buffer_load_dwordx4 v6, s[12:15], s91 offen offset:0 lds
    buffer_load_dwordx4 v7, s[12:15], s91 offen offset:1024 lds
    s_add_u32 m0, s62, 8192
    s_nop 0
    buffer_load_dwordx4 v8, s[12:15], s91 offen offset:0 lds
    buffer_load_dwordx4 v9, s[12:15], s91 offen offset:1024 lds
    s_add_u32 m0, s62, 16384
    s_nop 0
    buffer_load_dwordx4 v10, s[12:15], s91 offen offset:0 lds
    buffer_load_dwordx4 v11, s[12:15], s91 offen offset:1024 lds
    s_waitcnt vmcnt(10)
    s_mov_b32 s86, 0x0c0c0400
    s_mov_b32 s87, 0x05040100
L_h0_chk:
    v_perm_b32 v72, v41, v40, s86
    v_perm_b32 v80, v43, v42, s86
    v_perm_b32 v72, v80, v72, s87
    v_perm_b32 v73, v45, v44, s86
    v_perm_b32 v81, v47, v46, s86
    v_perm_b32 v73, v81, v73, s87
    v_perm_b32 v74, v49, v48, s86
    v_perm_b32 v82, v51, v50, s86
    v_perm_b32 v74, v82, v74, s87
    v_perm_b32 v75, v53, v52, s86
    v_perm_b32 v83, v55, v54, s86
    v_perm_b32 v75, v83, v75, s87
    v_perm_b32 v76, v57, v56, s86
    v_perm_b32 v84, v59, v58, s86
    v_perm_b32 v76, v84, v76, s87
    v_perm_b32 v77, v61, v60, s86
    v_perm_b32 v85, v63, v62, s86
    v_perm_b32 v77, v85, v77, s87
    v_perm_b32 v78, v65, v64, s86
    v_perm_b32 v86, v67, v66, s86
    v_perm_b32 v78, v86, v78, s87
    v_perm_b32 v79, v69, v68, s86
    v_perm_b32 v87, v71, v70, s86
    v_perm_b32 v79, v87, v79, s87
    v_max3_u32 v80, v72, v73, v74
    v_min3_u32 v81, v72, v73, v74
    v_max3_u32 v80, v80, v75, v76
    v_min3_u32 v81, v81, v75, v76
    v_max3_u32 v80, v80, v77, v78
    v_min3_u32 v81, v81, v77, v78
    v_max_u32 v80, v80, v79
    v_min_u32 v81, v81, v79
    v_cmp_ne_u32 vcc, s61, v80
    v_cmp_ne_u32 s[4:5], s61, v81
    s_nop 0
    s_or_b64 vcc, vcc, s[4:5]
    s_cbranch_vccz L_h0_ok
    s_mov_b32 s90, 0
    buffer_load_dwordx4 v[40:43], v32, s[16:19], s90 offen sc1
    s_mov_b32 s90, 3072
    buffer_load_dwordx4 v[44:47], v32, s[16:19], s90 offen sc1
    s_mov_b32 s90, 6144
    buffer_load_dwordx4 v[48:51], v32, s[16:19], s90 offen sc1
    s_mov_b32 s90, 9216
    buffer_load_dwordx4 v[52:55], v32, s[16:19], s90 offen sc1
    buffer_load_dwordx4 v[56:59], v33, s[16:19], 0 offen sc1
    buffer_load_dwordx4 v[60:63], v33, s[16:19], s92 offen sc1
    buffer_load_dwordx4 v[64:67], v33, s[16:19], s93 offen sc1
    buffer_load_dwordx4 v[68:71], v33, s[16:19], s94 offen sc1
    s_waitcnt vmcnt(0)
    s_sub_u32 s56, s56, 1
    s_cbranch_scc0 L_h0_chk
    s_mov_b32 s56, 0
L_h0_ok:
    v_pk_add_f32 v[40:41], v[40:41], v[44:45]
    v_pk_add_f32 v[48:49], v[48:49], v[52:53]
    v_pk_add_f32 v[40:41], v[40:41], v[48:49]
    v_pk_add_f32 v[42:43], v[42:43], v[46:47]
    v_pk_add_f32 v[50:51], v[50:51], v[54:55]
    v_pk_add_f32 v[42:43], v[42:43], v[50:51]
    v_pk_add_f32 v[56:57], v[56:57], v[60:61]
    v_pk_add_f32 v[64:65], v[64:65], v[68:69]
    v_pk_add_f32 v[56:57], v[56:57], v[64:65]
    v_pk_add_f32 v[58:59], v[58:59], v[62:63]
    v_pk_add_f32 v[66:67], v[66:67], v[70:71]
    v_pk_add_f32 v[58:59], v[58:59], v[66:67]
    v_mov_b32 v44, v40
    v_mov_b32 v45, v41
    v_mov_b32 v46, v42
    v_mov_b32 v47, v43
    v_permlane32_swap_b32 v40, v44
    v_permlane32_swap_b32 v41, v45
    v_permlane32_swap_b32 v42, v46
    v_permlane32_swap_b32 v43, v47
    v_add_f32 v40, v40, v44
    v_add_f32 v41, v41, v45
    v_add_f32 v42, v42, v46
    v_add_f32 v43, v43, v47
    v_mov_b32 v44, v40
    v_mov_b32 v45, v41
    v_mov_b32 v46, v42
    v_mov_b32 v47, v43
    v_permlane16_swap_b32 v40, v44
    v_permlane16_swap_b32 v41, v45
    v_permlane16_swap_b32 v42, v46
    v_permlane16_swap_b32 v43, v47
    v_add_f32 v40, v40, v44
    v_add_f32 v41, v41, v45
    v_add_f32 v42, v42, v46
    v_add_f32 v43, v43, v47
    s_lshl_b32 s86, s48, 8
    s_add_u32 s86, s86, 132608
    v_lshl_add_u32 v24, v23, 4, s86
    ds_write_b128 v24, v[40:43]
    s_waitcnt vmcnt(18)
    s_barrier
    v_mov_b32 v44, v56
    v_mov_b32 v45, v57
    v_mov_b32 v46, v58
    v_mov_b32 v47, v59
    v_permlane32_swap_b32 v56, v44
    v_permlane32_swap_b32 v57, v45
    v_permlane32_swap_b32 v58, v46
    v_permlane32_swap_b32 v59, v47
    v_add_f32 v56, v56, v44
    v_add_f32 v57, v57, v45
    v_add_f32 v58, v58, v46
    v_add_f32 v59, v59, v47
    v_mov_b32 v44, v56
    v_mov_b32 v45, v57
    v_mov_b32 v46, v58
    v_mov_b32 v47, v59
    v_permlane16_swap_b32 v56, v44
    v_permlane16_swap_b32 v57, v45
    v_permlane16_swap_b32 v58, v46
    v_permlane16_swap_b32 v59, v47
    v_add_f32 v56, v56, v44
    v_add_f32 v57, v57, v45
    v_add_f32 v58, v58, v46
    v_add_f32 v59, v59, v47
    v_mul_f32 v56, 0x3a800000, v56
    v_mul_f32 v57, 0x3a800000, v57
    v_fma_f32 v57, -v56, v56, v57
    v_max_f32 v57, 0, v57
    v_cvt_pk_bf16_f32 v48, v56, v57
    v_lshlrev_b32 v44, 16, v48
    v_and_b32 v48, 0xffff0000, v48
    v_add_f32 v48, 0x3727c5ac, v48
    v_cvt_pk_bf16_f32 v48, v48, v48
    v_lshlrev_b32 v48, 16, v48
    v_sqrt_f32 v48, v48
    s_nop 0
    v_cvt_pk_bf16_f32 v48, v48, v48
    v_lshlrev_b32 v48, 16, v48
    v_rcp_f32 v46, v48
    v_mul_f32 v58, 0x3a800000, v58
    v_mul_f32 v59, 0x3a800000, v59
    v_fma_f32 v59, -v58, v58, v59
    v_max_f32 v59, 0, v59
    v_cvt_pk_bf16_f32 v49, v58, v59
    v_lshlrev_b32 v45, 16, v49
    v_and_b32 v49, 0xffff0000, v49
    v_add_f32 v49, 0x3727c5ac, v49
    v_cvt_pk_bf16_f32 v49, v49, v49
    v_lshlrev_b32 v49, 16, v49
    v_sqrt_f32 v49, v49
    s_nop 0
    v_cvt_pk_bf16_f32 v49, v49, v49
    v_lshlrev_b32 v49, 16, v49
    v_rcp_f32 v47, v49
    v_sub_f32 v44, 0, v44
    v_sub_f32 v45, 0, v45
    v_mul_f32 v48, 0x3fb8aa3b, v46
    v_mul_f32 v49, 0x3fb8aa3b, v47
    s_lshl_b32 s86, s48, 7
    s_add_u32 s86, s86, 131072
    v_lshl_add_u32 v24, v23, 3, s86
    ds_write_b64 v24, v[44:45]
    ds_write_b64 v24, v[46:47] offset:512
    ds_write_b64 v24, v[48:49] offset:1024
    s_add_u32 m0, s89, 40960
    s_mov_b32 s90, 655360
    buffer_load_dwordx4 v12, s[20:23], s90 offen lds
    s_add_u32 m0, s89, 45056
    s_mov_b32 s90, 720896
    buffer_load_dwordx4 v12, s[20:23], s90 offen lds
    s_add_u32 m0, s89, 49152
    s_mov_b32 s90, 786432
    buffer_load_dwordx4 v12, s[20:23], s90 offen lds
    s_add_u32 m0, s89, 53248
    s_mov_b32 s90, 851968
    buffer_load_dwordx4 v12, s[20:23], s90 offen lds
    s_add_u32 m0, s89, 57344
    s_mov_b32 s90, 917504
    buffer_load_dwordx4 v12, s[20:23], s90 offen lds
    s_add_u32 m0, s89, 61440
    s_mov_b32 s90, 983040
    buffer_load_dwordx4 v12, s[20:23], s90 offen lds
    s_add_u32 m0, s89, 65536
    s_mov_b32 s90, 1048576
    buffer_load_dwordx4 v12, s[20:23], s90 offen lds
    s_add_u32 m0, s89, 69632
    s_mov_b32 s90, 1114112
    buffer_load_dwordx4 v12, s[20:23], s90 offen lds
    s_add_u32 m0, s89, 73728
    s_mov_b32 s90, 1179648
    buffer_load_dwordx4 v12, s[20:23], s90 offen lds
    s_add_u32 m0, s89, 77824
    s_mov_b32 s90, 1245184
    buffer_load_dwordx4 v12, s[20:23], s90 offen lds
    s_waitcnt lgkmcnt(0)
    s_waitcnt vmcnt(10)
    s_barrier
    s_add_u32 m0, s89, 81920
    s_mov_b32 s90, 1310720
    buffer_load_dwordx4 v12, s[20:23], s90 offen lds
    s_add_u32 m0, s89, 86016
    s_mov_b32 s90, 1376256
    buffer_load_dwordx4 v12, s[20:23], s90 offen lds
    s_add_u32 m0, s89, 90112
    s_mov_b32 s90, 1441792
    buffer_load_dwordx4 v12, s[20:23], s90 offen lds
    s_add_u32 m0, s89, 94208
    s_mov_b32 s90, 1507328
    buffer_load_dwordx4 v12, s[20:23], s90 offen lds
    s_add_u32 m0, s89, 98304
    s_mov_b32 s90, 1572864
    buffer_load_dwordx4 v12, s[20:23], s90 offen lds
    s_add_u32 m0, s89, 102400
    s_mov_b32 s90, 1638400
    buffer_load_dwordx4 v12, s[20:23], s90 offen lds
    s_add_u32 m0, s89, 106496
    s_mov_b32 s90, 1703936
    buffer_load_dwordx4 v12, s[20:23], s90 offen lds
    s_add_u32 m0, s89, 110592
    s_mov_b32 s90, 1769472
    buffer_load_dwordx4 v12, s[20:23], s90 offen lds
    s_add_u32 m0, s89, 114688
    s_mov_b32 s90, 1835008
    buffer_load_dwordx4 v12, s[20:23], s90 offen lds
    s_add_u32 m0, s89, 118784
    s_mov_b32 s90, 1900544
    buffer_load_dwordx4 v12, s[20:23], s90 offen lds
L_f15:
    ds_read_b128 v[24:27], v36
    s_waitcnt lgkmcnt(0)
    v_min3_u32 v24, v24, v25, v26
    v_min_u32 v24, v24, v27
    v_cmp_eq_u32 vcc, 0, v24
    s_cbranch_vccz L_ok_1
    s_sub_u32 s56, s56, 1
    s_cbranch_scc0 L_f15
    s_mov_b32 s56, 0
L_ok_1:
    s_add_u32 m0, s89, 0
    s_mov_b32 s90, 0
    buffer_load_dwordx4 v12, s[20:23], s90 offen lds
    s_add_u32 m0, s89, 4096
    s_mov_b32 s90, 65536
    buffer_load_dwordx4 v12, s[20:23], s90 offen lds
    s_add_u32 m0, s89, 8192
    s_mov_b32 s90, 131072
    buffer_load_dwordx4 v12, s[20:23], s90 offen lds
    s_add_u32 m0, s89, 12288
    s_mov_b32 s90, 196608
    buffer_load_dwordx4 v12, s[20:23], s90 offen lds
    s_add_u32 m0, s89, 16384
    s_mov_b32 s90, 262144
    buffer_load_dwordx4 v12, s[20:23], s90 offen lds
    s_add_u32 m0, s89, 20480
    s_mov_b32 s90, 327680
    buffer_load_dwordx4 v12, s[20:23], s90 offen lds
    s_add_u32 m0, s89, 24576
    s_mov_b32 s90, 393216
    buffer_load_dwordx4 v12, s[20:23], s90 offen lds
    s_add_u32 m0, s89, 28672
    s_mov_b32 s90, 458752
    buffer_load_dwordx4 v12, s[20:23], s90 offen lds
    s_add_u32 m0, s89, 32768
    s_mov_b32 s90, 524288
    buffer_load_dwordx4 v12, s[20:23], s90 offen lds
    s_add_u32 m0, s89, 36864
    s_mov_b32 s90, 589824
    buffer_load_dwordx4 v12, s[20:23], s90 offen lds
    s_mov_b32 s90, 0
    buffer_load_dwordx4 v[164:167], v30, s[32:35], s90 offen
    s_mov_b32 s90, 7168
    buffer_load_dwordx4 v[168:171], v30, s[32:35], s90 offen
    s_mov_b32 s90, 14336
    buffer_load_dwordx4 v[172:175], v30, s[32:35], s90 offen
    s_mov_b32 s90, 21504
    buffer_load_dwordx4 v[176:179], v30, s[32:35], s90 offen
    s_mov_b32 s90, 28672
    buffer_load_dwordx4 v[180:183], v30, s[32:35], s90 offen
    s_mov_b32 s90, 35840
    buffer_load_dwordx4 v[184:187], v30, s[32:35], s90 offen
    s_mov_b32 s90, 43008
    buffer_load_dwordx4 v[188:191], v30, s[32:35], s90 offen
    s_mov_b32 s90, 50176
    buffer_load_dwordx4 v[192:195], v30, s[32:35], s90 offen
    s_lshl_b32 s86, s47, 2
    s_add_u32 s86, s86, s48
    s_lshl_b32 s86, s86, 14
    s_add_u32 s86, s86, 5242880
    v_lshl_add_u32 v2, v0, 4, s86
    s_lshl_b32 s86, s47, 1
    s_add_u32 s86, s86, s50
    s_lshl_b32 s86, s86, 11
    s_add_u32 s86, s86, 7307264
    v_lshl_add_u32 v3, v23, 7, s86
    v_lshl_add_u32 v3, v22, 4, v3
    v_mov_b32 v112, 0
    v_mov_b32 v113, 0
    v_mov_b32 v114, 0
    v_mov_b32 v115, 0
    v_mov_b32 v116, 0
    v_mov_b32 v117, 0
    v_mov_b32 v118, 0
    v_mov_b32 v119, 0
    s_lshr_b32 s62, s3, 2
    s_lshl_b32 s53, s51, 3
    s_lshl_b32 s86, s48, 1
    s_add_u32 s53, s53, s86
    s_add_u32 s53, s53, s62
    v_lshrrev_b32 v36, 4, v0
    v_and_b32 v37, 15, v0
    v_lshlrev_b32 v38, 4, v0
    buffer_load_dwordx4 v[136:139], v38, s[40:43], 0 offen
    buffer_load_dwordx4 v[140:143], v38, s[40:43], 0 offen offset:1024
    s_lshl_b32 s86, s52, 7
    v_lshl_add_u32 v39, v36, 3, s86
    buffer_load_dwordx2 v[148:149], v39, s[40:43], 0 offen offset:0
    buffer_load_dwordx2 v[150:151], v39, s[40:43], 0 offen offset:32
    buffer_load_dwordx2 v[152:153], v39, s[40:43], 0 offen offset:64
    buffer_load_dwordx2 v[154:155], v39, s[40:43], 0 offen offset:96
    s_lshl_b32 s87, s53, 15
    v_lshl_add_u32 v38, v37, 11, s87
    v_add_u32 v38, v38, v39
    buffer_load_dwordx2 v[128:129], v38, s[8:11], 0 offen offset:0
    buffer_load_dwordx2 v[130:131], v38, s[8:11], 0 offen offset:32
    buffer_load_dwordx2 v[132:133], v38, s[8:11], 0 offen offset:64
    buffer_load_dwordx2 v[134:135], v38, s[8:11], 0 offen offset:96
    s_lshl_b32 s86, s62, 14
    s_add_u32 s86, s86, s87
    s_add_u32 s86, s86, 1048576
    v_lshl_add_u32 v157, v0, 4, s86
    v_xor_b32 v158, 0x8000, v157
    s_and_b32 s86, s86, 0xffff7fff
    s_add_u32 s86, s86, 1020
    v_lshl_add_u32 v159, v37, 10, s86
    v_and_b32 v39, 1, v36
    v_lshl_add_u32 v159, v39, 15, v159
    v_bfe_u32 v38, v0, 2, 2
    v_lshl_add_u32 v38, v36, 2, v38
    v_bfe_u32 v39, v38, 1, 2
    v_lshlrev_b32 v38, 7, v38
    v_lshl_add_u32 v38, v39, 5, v38
    v_and_b32 v39, 3, v0
    v_lshl_add_u32 v38, v39, 3, v38
    s_lshl_b32 s86, s62, 16
    s_add_u32 s86, s86, 0
    v_add_u32 v144, s86, v38
    v_xor_b32 v145, 32, v144
    v_xor_b32 v146, 64, v144
    v_xor_b32 v147, 96, v144
    v_cmp_eq_u32 s[4:5], 1, v39
    v_cmp_eq_u32 s[6:7], 2, v39
    v_cmp_eq_u32 s[98:99], 3, v39
    s_lshl_b32 s86, s53, 12
    s_add_u32 s86, s86, 6291456
    v_lshl_add_u32 v160, v0, 4, s86
    s_lshl_b32 s87, s52, 8
    s_add_u32 s86, s86, s87
    v_lshl_add_u32 v161, v37, 4, s86
    v_lshrrev_b32 v38, 2, v37
    v_cmp_eq_u32 vcc, v38, v36
    v_mov_b32 v38, 2147483648
    s_nop 0
    v_cndmask_b32 v161, v38, v161, vcc
    s_lshl_b32 s86, s3, 12
    s_add_u32 s86, s86, 131072
    v_lshl_add_u32 v162, v0, 4, s86
    v_xor_b32 v163, 0x4000, v162
    v_cmp_eq_u32 vcc, 0, v39
    v_mov_b32 v39, s95
    s_nop 0
    v_cndmask_b32 v39, 0, v39, vcc
    v_mov_b32 v38, 0
    s_waitcnt vmcnt(4)
    v_dot2c_f32_bf16 v38, s95, v136
    v_dot2c_f32_bf16 v38, s95, v137
    v_dot2c_f32_bf16 v38, s95, v138
    v_dot2c_f32_bf16 v38, s95, v139
    v_dot2c_f32_bf16 v38, s95, v140
    v_dot2c_f32_bf16 v38, s95, v141
    v_dot2c_f32_bf16 v38, s95, v142
    v_dot2c_f32_bf16 v38, s95, v143
    v_cndmask_b32 v148, v39, v148, s[4:5]
    v_cndmask_b32 v149, v39, v149, s[4:5]
    v_cndmask_b32 v150, v39, v150, s[4:5]
    v_cndmask_b32 v151, v39, v151, s[4:5]
    v_cndmask_b32 v152, v39, v152, s[4:5]
    v_cndmask_b32 v153, v39, v153, s[4:5]
    v_cndmask_b32 v154, v39, v154, s[4:5]
    v_cndmask_b32 v155, v39, v155, s[4:5]
    v_add_f32_dpp v38, v38, v38 row_ror:8 row_mask:0xf bank_mask:0xf
    s_nop 1
    v_add_f32_dpp v38, v38, v38 row_ror:4 row_mask:0xf bank_mask:0xf
    s_nop 1
    v_add_f32_dpp v38, v38, v38 row_ror:2 row_mask:0xf bank_mask:0xf
    s_nop 1
    v_add_f32_dpp v38, v38, v38 row_ror:1 row_mask:0xf bank_mask:0xf
    v_mov_b32 v39, v38
    s_nop 1
    v_permlane32_swap_b32 v38, v39
    v_add_f32 v38, v38, v39
    v_mov_b32 v39, v38
    s_nop 1
    v_permlane16_swap_b32 v38, v39
    v_add_f32 v38, v38, v39
    s_nop 0
    v_readfirstlane_b32 s57, v38
    s_mov_b32 s88, 0
    s_mov_b32 s86, 0x00003f80
    s_mov_b32 s87, 0x3f800000
    buffer_load_dwordx4 v[40:43], v2, s[16:19], 0 offen offset:0 sc1
    buffer_load_dwordx4 v[44:47], v2, s[16:19], 0 offen offset:1024 sc1
    buffer_load_dwordx4 v[48:51], v2, s[16:19], 0 offen offset:2048 sc1
    buffer_load_dwordx4 v[52:55], v2, s[16:19], 0 offen offset:3072 sc1
    buffer_load_dwordx4 v[56:59], v2, s[16:19], s92 offen offset:0 sc1
    buffer_load_dwordx4 v[60:63], v2, s[16:19], s92 offen offset:1024 sc1
    buffer_load_dwordx4 v[64:67], v2, s[16:19], s92 offen offset:2048 sc1
    buffer_load_dwordx4 v[68:71], v2, s[16:19], s92 offen offset:3072 sc1
    buffer_load_dwordx4 v[72:75], v2, s[16:19], s93 offen offset:0 sc1
    buffer_load_dwordx4 v[76:79], v2, s[16:19], s93 offen offset:1024 sc1
    buffer_load_dwordx4 v[80:83], v2, s[16:19], s93 offen offset:2048 sc1
    buffer_load_dwordx4 v[84:87], v2, s[16:19], s93 offen offset:3072 sc1
    buffer_load_dwordx4 v[88:91], v2, s[16:19], s94 offen offset:0 sc1
    buffer_load_dwordx4 v[92:95], v2, s[16:19], s94 offen offset:1024 sc1
    buffer_load_dwordx4 v[96:99], v2, s[16:19], s94 offen offset:2048 sc1
    buffer_load_dwordx4 v[100:103], v2, s[16:19], s94 offen offset:3072 sc1
    buffer_load_dwordx4 v[104:107], v3, s[16:19], 0 offen sc1
    buffer_load_dwordx4 v[108:111], v3, s[16:19], 0 offen offset:64 sc1
L_h1_round:
    s_bitcmp1_b32 s88, 0
    s_cbranch_scc1 L_h1_n0
    s_waitcnt vmcnt(17)
    v_cmp_eq_u32 vcc, -1, v43
    s_cbranch_vccnz L_h1_b0
    v_dot2c_f32_bf16 v112, s86, v40
    v_dot2c_f32_bf16 v113, s87, v40
    v_dot2c_f32_bf16 v114, s86, v41
    v_dot2c_f32_bf16 v115, s87, v41
    v_dot2c_f32_bf16 v116, s86, v42
    v_dot2c_f32_bf16 v117, s87, v42
    v_dot2c_f32_bf16 v118, s86, v43
    v_dot2c_f32_bf16 v119, s87, v43
    s_bitset1_b32 s88, 0
    s_branch L_h1_n0
L_h1_b0:
    buffer_load_dwordx4 v[40:43], v2, s[16:19], 0 offen offset:0 sc1
L_h1_n0:
    s_bitcmp1_b32 s88, 1
    s_cbranch_scc1 L_h1_n1
    s_waitcnt vmcnt(16)
    v_cmp_eq_u32 vcc, -1, v47
    s_cbranch_vccnz L_h1_b1
    v_dot2c_f32_bf16 v112, s86, v44
    v_dot2c_f32_bf16 v113, s87, v44
    v_dot2c_f32_bf16 v114, s86, v45
    v_dot2c_f32_bf16 v115, s87, v45
    v_dot2c_f32_bf16 v116, s86, v46
    v_dot2c_f32_bf16 v117, s87, v46
    v_dot2c_f32_bf16 v118, s86, v47
    v_dot2c_f32_bf16 v119, s87, v47
    s_bitset1_b32 s88, 1
    s_branch L_h1_n1
L_h1_b1:
    buffer_load_dwordx4 v[44:47], v2, s[16:19], 0 offen offset:1024 sc1
L_h1_n1:
    s_bitcmp1_b32 s88, 2
    s_cbranch_scc1 L_h1_n2
    s_waitcnt vmcnt(15)
    v_cmp_eq_u32 vcc, -1, v51
    s_cbranch_vccnz L_h1_b2
    v_dot2c_f32_bf16 v112, s86, v48
    v_dot2c_f32_bf16 v113, s87, v48
    v_dot2c_f32_bf16 v114, s86, v49
    v_dot2c_f32_bf16 v115, s87, v49
    v_dot2c_f32_bf16 v116, s86, v50
    v_dot2c_f32_bf16 v117, s87, v50
    v_dot2c_f32_bf16 v118, s86, v51
    v_dot2c_f32_bf16 v119, s87, v51
    s_bitset1_b32 s88, 2
    s_branch L_h1_n2
L_h1_b2:
    buffer_load_dwordx4 v[48:51], v2, s[16:19], 0 offen offset:2048 sc1
L_h1_n2:
    s_bitcmp1_b32 s88, 3
    s_cbranch_scc1 L_h1_n3
    s_waitcnt vmcnt(14)
    v_cmp_eq_u32 vcc, -1, v55
    s_cbranch_vccnz L_h1_b3
    v_dot2c_f32_bf16 v112, s86, v52
    v_dot2c_f32_bf16 v113, s87, v52
    v_dot2c_f32_bf16 v114, s86, v53
    v_dot2c_f32_bf16 v115, s87, v53
    v_dot2c_f32_bf16 v116, s86, v54
    v_dot2c_f32_bf16 v117, s87, v54
    v_dot2c_f32_bf16 v118, s86, v55
    v_dot2c_f32_bf16 v119, s87, v55
    s_bitset1_b32 s88, 3
    s_branch L_h1_n3
L_h1_b3:
    buffer_load_dwordx4 v[52:55], v2, s[16:19], 0 offen offset:3072 sc1
L_h1_n3:
    s_bitcmp1_b32 s88, 4
    s_cbranch_scc1 L_h1_n4
    s_waitcnt vmcnt(13)
    v_cmp_eq_u32 vcc, -1, v59
    s_cbranch_vccnz L_h1_b4
    v_dot2c_f32_bf16 v112, s86, v56
    v_dot2c_f32_bf16 v113, s87, v56
    v_dot2c_f32_bf16 v114, s86, v57
    v_dot2c_f32_bf16 v115, s87, v57
    v_dot2c_f32_bf16 v116, s86, v58
    v_dot2c_f32_bf16 v117, s87, v58
    v_dot2c_f32_bf16 v118, s86, v59
    v_dot2c_f32_bf16 v119, s87, v59
    s_bitset1_b32 s88, 4
    s_branch L_h1_n4
L_h1_b4:
    buffer_load_dwordx4 v[56:59], v2, s[16:19], s92 offen offset:0 sc1
L_h1_n4:
    s_bitcmp1_b32 s88, 5
    s_cbranch_scc1 L_h1_n5
    s_waitcnt vmcnt(12)
    v_cmp_eq_u32 vcc, -1, v63
    s_cbranch_vccnz L_h1_b5
    v_dot2c_f32_bf16 v112, s86, v60
    v_dot2c_f32_bf16 v113, s87, v60
    v_dot2c_f32_bf16 v114, s86, v61
    v_dot2c_f32_bf16 v115, s87, v61
    v_dot2c_f32_bf16 v116, s86, v62
    v_dot2c_f32_bf16 v117, s87, v62
    v_dot2c_f32_bf16 v118, s86, v63
    v_dot2c_f32_bf16 v119, s87, v63
    s_bitset1_b32 s88, 5
    s_branch L_h1_n5
L_h1_b5:
    buffer_load_dwordx4 v[60:63], v2, s[16:19], s92 offen offset:1024 sc1
L_h1_n5:
    s_bitcmp1_b32 s88, 6
    s_cbranch_scc1 L_h1_n6
    s_waitcnt vmcnt(11)
    v_cmp_eq_u32 vcc, -1, v67
    s_cbranch_vccnz L_h1_b6
    v_dot2c_f32_bf16 v112, s86, v64
    v_dot2c_f32_bf16 v113, s87, v64
    v_dot2c_f32_bf16 v114, s86, v65
    v_dot2c_f32_bf16 v115, s87, v65
    v_dot2c_f32_bf16 v116, s86, v66
    v_dot2c_f32_bf16 v117, s87, v66
    v_dot2c_f32_bf16 v118, s86, v67
    v_dot2c_f32_bf16 v119, s87, v67
    s_bitset1_b32 s88, 6
    s_branch L_h1_n6
L_h1_b6:
    buffer_load_dwordx4 v[64:67], v2, s[16:19], s92 offen offset:2048 sc1
L_h1_n6:
    s_bitcmp1_b32 s88, 7
    s_cbranch_scc1 L_h1_n7
    s_waitcnt vmcnt(10)
    v_cmp_eq_u32 vcc, -1, v71
    s_cbranch_vccnz L_h1_b7
    v_dot2c_f32_bf16 v112, s86, v68
    v_dot2c_f32_bf16 v113, s87, v68
    v_dot2c_f32_bf16 v114, s86, v69
    v_dot2c_f32_bf16 v115, s87, v69
    v_dot2c_f32_bf16 v116, s86, v70
    v_dot2c_f32_bf16 v117, s87, v70
    v_dot2c_f32_bf16 v118, s86, v71
    v_dot2c_f32_bf16 v119, s87, v71
    s_bitset1_b32 s88, 7
    s_branch L_h1_n7
L_h1_b7:
    buffer_load_dwordx4 v[68:71], v2, s[16:19], s92 offen offset:3072 sc1
L_h1_n7:
    s_bitcmp1_b32 s88, 8
    s_cbranch_scc1 L_h1_n8
    s_waitcnt vmcnt(9)
    v_cmp_eq_u32 vcc, -1, v75
    s_cbranch_vccnz L_h1_b8
    v_dot2c_f32_bf16 v112, s86, v72
    v_dot2c_f32_bf16 v113, s87, v72
    v_dot2c_f32_bf16 v114, s86, v73
    v_dot2c_f32_bf16 v115, s87, v73
    v_dot2c_f32_bf16 v116, s86, v74
    v_dot2c_f32_bf16 v117, s87, v74
    v_dot2c_f32_bf16 v118, s86, v75
    v_dot2c_f32_bf16 v119, s87, v75
    s_bitset1_b32 s88, 8
    s_branch L_h1_n8
L_h1_b8:
    buffer_load_dwordx4 v[72:75], v2, s[16:19], s93 offen offset:0 sc1
L_h1_n8:
    s_bitcmp1_b32 s88, 9
    s_cbranch_scc1 L_h1_n9
    s_waitcnt vmcnt(8)
    v_cmp_eq_u32 vcc, -1, v79
    s_cbranch_vccnz L_h1_b9
    v_dot2c_f32_bf16 v112, s86, v76
    v_dot2c_f32_bf16 v113, s87, v76
    v_dot2c_f32_bf16 v114, s86, v77
    v_dot2c_f32_bf16 v115, s87, v77
    v_dot2c_f32_bf16 v116, s86, v78
    v_dot2c_f32_bf16 v117, s87, v78
    v_dot2c_f32_bf16 v118, s86, v79
    v_dot2c_f32_bf16 v119, s87, v79
    s_bitset1_b32 s88, 9
    s_branch L_h1_n9
L_h1_b9:
    buffer_load_dwordx4 v[76:79], v2, s[16:19], s93 offen offset:1024 sc1
L_h1_n9:
    s_bitcmp1_b32 s88, 10
    s_cbranch_scc1 L_h1_n10
    s_waitcnt vmcnt(7)
    v_cmp_eq_u32 vcc, -1, v83
    s_cbranch_vccnz L_h1_b10
    v_dot2c_f32_bf16 v112, s86, v80
    v_dot2c_f32_bf16 v113, s87, v80
    v_dot2c_f32_bf16 v114, s86, v81
    v_dot2c_f32_bf16 v115, s87, v81
    v_dot2c_f32_bf16 v116, s86, v82
    v_dot2c_f32_bf16 v117, s87, v82
    v_dot2c_f32_bf16 v118, s86, v83
    v_dot2c_f32_bf16 v119, s87, v83
    s_bitset1_b32 s88, 10
    s_branch L_h1_n10
L_h1_b10:
    buffer_load_dwordx4 v[80:83], v2, s[16:19], s93 offen offset:2048 sc1
L_h1_n10:
    s_bitcmp1_b32 s88, 11
    s_cbranch_scc1 L_h1_n11
    s_waitcnt vmcnt(6)
    v_cmp_eq_u32 vcc, -1, v87
    s_cbranch_vccnz L_h1_b11
    v_dot2c_f32_bf16 v112, s86, v84
    v_dot2c_f32_bf16 v113, s87, v84
    v_dot2c_f32_bf16 v114, s86, v85
    v_dot2c_f32_bf16 v115, s87, v85
    v_dot2c_f32_bf16 v116, s86, v86
    v_dot2c_f32_bf16 v117, s87, v86
    v_dot2c_f32_bf16 v118, s86, v87
    v_dot2c_f32_bf16 v119, s87, v87
    s_bitset1_b32 s88, 11
    s_branch L_h1_n11
L_h1_b11:
    buffer_load_dwordx4 v[84:87], v2, s[16:19], s93 offen offset:3072 sc1
L_h1_n11:
    s_bitcmp1_b32 s88, 12
    s_cbranch_scc1 L_h1_n12
    s_waitcnt vmcnt(5)
    v_cmp_eq_u32 vcc, -1, v91
    s_cbranch_vccnz L_h1_b12
    v_dot2c_f32_bf16 v112, s86, v88
    v_dot2c_f32_bf16 v113, s87, v88
    v_dot2c_f32_bf16 v114, s86, v89
    v_dot2c_f32_bf16 v115, s87, v89
    v_dot2c_f32_bf16 v116, s86, v90
    v_dot2c_f32_bf16 v117, s87, v90
    v_dot2c_f32_bf16 v118, s86, v91
    v_dot2c_f32_bf16 v119, s87, v91
    s_bitset1_b32 s88, 12
    s_branch L_h1_n12
L_h1_b12:
    buffer_load_dwordx4 v[88:91], v2, s[16:19], s94 offen offset:0 sc1
L_h1_n12:
    s_bitcmp1_b32 s88, 13
    s_cbranch_scc1 L_h1_n13
    s_waitcnt vmcnt(4)
    v_cmp_eq_u32 vcc, -1, v95
    s_cbranch_vccnz L_h1_b13
    v_dot2c_f32_bf16 v112, s86, v92
    v_dot2c_f32_bf16 v113, s87, v92
    v_dot2c_f32_bf16 v114, s86, v93
    v_dot2c_f32_bf16 v115, s87, v93
    v_dot2c_f32_bf16 v116, s86, v94
    v_dot2c_f32_bf16 v117, s87, v94
    v_dot2c_f32_bf16 v118, s86, v95
    v_dot2c_f32_bf16 v119, s87, v95
    s_bitset1_b32 s88, 13
    s_branch L_h1_n13
L_h1_b13:
    buffer_load_dwordx4 v[92:95], v2, s[16:19], s94 offen offset:1024 sc1
L_h1_n13:
    s_bitcmp1_b32 s88, 14
    s_cbranch_scc1 L_h1_n14
    s_waitcnt vmcnt(3)
    v_cmp_eq_u32 vcc, -1, v99
    s_cbranch_vccnz L_h1_b14
    v_dot2c_f32_bf16 v112, s86, v96
    v_dot2c_f32_bf16 v113, s87, v96
    v_dot2c_f32_bf16 v114, s86, v97
    v_dot2c_f32_bf16 v115, s87, v97
    v_dot2c_f32_bf16 v116, s86, v98
    v_dot2c_f32_bf16 v117, s87, v98
    v_dot2c_f32_bf16 v118, s86, v99
    v_dot2c_f32_bf16 v119, s87, v99
    s_bitset1_b32 s88, 14
    s_branch L_h1_n14
L_h1_b14:
    buffer_load_dwordx4 v[96:99], v2, s[16:19], s94 offen offset:2048 sc1
L_h1_n14:
    s_bitcmp1_b32 s88, 15
    s_cbranch_scc1 L_h1_n15
    s_waitcnt vmcnt(2)
    v_cmp_eq_u32 vcc, -1, v103
    s_cbranch_vccnz L_h1_b15
    v_dot2c_f32_bf16 v112, s86, v100
    v_dot2c_f32_bf16 v113, s87, v100
    v_dot2c_f32_bf16 v114, s86, v101
    v_dot2c_f32_bf16 v115, s87, v101
    v_dot2c_f32_bf16 v116, s86, v102
    v_dot2c_f32_bf16 v117, s87, v102
    v_dot2c_f32_bf16 v118, s86, v103
    v_dot2c_f32_bf16 v119, s87, v103
    s_bitset1_b32 s88, 15
    s_branch L_h1_n15
L_h1_b15:
    buffer_load_dwordx4 v[100:103], v2, s[16:19], s94 offen offset:3072 sc1
L_h1_n15:
    s_bitcmp1_b32 s88, 16
    s_cbranch_scc1 L_h1_nz
    s_waitcnt vmcnt(0)
    v_max_u32 v4, v104, v108
    v_cmp_eq_u32 vcc, -1, v4
    s_cbranch_vccnz L_h1_bz
    v_add_f32_dpp v104, v104, v104 row_ror:8 row_mask:0xf bank_mask:0xf
    v_add_f32_dpp v105, v105, v105 row_ror:8 row_mask:0xf bank_mask:0xf
    v_add_f32_dpp v106, v106, v106 row_ror:8 row_mask:0xf bank_mask:0xf
    v_add_f32_dpp v107, v107, v107 row_ror:8 row_mask:0xf bank_mask:0xf
    v_add_f32_dpp v108, v108, v108 row_ror:8 row_mask:0xf bank_mask:0xf
    v_add_f32_dpp v109, v109, v109 row_ror:8 row_mask:0xf bank_mask:0xf
    v_add_f32_dpp v110, v110, v110 row_ror:8 row_mask:0xf bank_mask:0xf
    v_add_f32_dpp v111, v111, v111 row_ror:8 row_mask:0xf bank_mask:0xf
    v_add_f32_dpp v104, v104, v104 row_ror:4 row_mask:0xf bank_mask:0xf
    v_add_f32_dpp v105, v105, v105 row_ror:4 row_mask:0xf bank_mask:0xf
    v_add_f32_dpp v106, v106, v106 row_ror:4 row_mask:0xf bank_mask:0xf
    v_add_f32_dpp v107, v107, v107 row_ror:4 row_mask:0xf bank_mask:0xf
    v_add_f32_dpp v108, v108, v108 row_ror:4 row_mask:0xf bank_mask:0xf
    v_add_f32_dpp v109, v109, v109 row_ror:4 row_mask:0xf bank_mask:0xf
    v_add_f32_dpp v110, v110, v110 row_ror:4 row_mask:0xf bank_mask:0xf
    v_add_f32_dpp v111, v111, v111 row_ror:4 row_mask:0xf bank_mask:0xf
    v_add_f32_dpp v104, v104, v104 row_ror:2 row_mask:0xf bank_mask:0xf
    v_add_f32_dpp v105, v105, v105 row_ror:2 row_mask:0xf bank_mask:0xf
    v_add_f32_dpp v106, v106, v106 row_ror:2 row_mask:0xf bank_mask:0xf
    v_add_f32_dpp v107, v107, v107 row_ror:2 row_mask:0xf bank_mask:0xf
    v_add_f32_dpp v108, v108, v108 row_ror:2 row_mask:0xf bank_mask:0xf
    v_add_f32_dpp v109, v109, v109 row_ror:2 row_mask:0xf bank_mask:0xf
    v_add_f32_dpp v110, v110, v110 row_ror:2 row_mask:0xf bank_mask:0xf
    v_add_f32_dpp v111, v111, v111 row_ror:2 row_mask:0xf bank_mask:0xf
    v_add_f32_dpp v104, v104, v104 row_ror:1 row_mask:0xf bank_mask:0xf
    v_add_f32_dpp v105, v105, v105 row_ror:1 row_mask:0xf bank_mask:0xf
    v_add_f32_dpp v106, v106, v106 row_ror:1 row_mask:0xf bank_mask:0xf
    v_add_f32_dpp v107, v107, v107 row_ror:1 row_mask:0xf bank_mask:0xf
    v_add_f32_dpp v108, v108, v108 row_ror:1 row_mask:0xf bank_mask:0xf
    v_add_f32_dpp v109, v109, v109 row_ror:1 row_mask:0xf bank_mask:0xf
    v_add_f32_dpp v110, v110, v110 row_ror:1 row_mask:0xf bank_mask:0xf
    v_add_f32_dpp v111, v111, v111 row_ror:1 row_mask:0xf bank_mask:0xf
    s_bitset1_b32 s88, 16
    s_branch L_h1_nz
L_h1_bz:
    buffer_load_dwordx4 v[104:107], v3, s[16:19], 0 offen sc1
    buffer_load_dwordx4 v[108:111], v3, s[16:19], 0 offen offset:64 sc1
L_h1_nz:
    s_cmp_eq_u32 s88, 0x1ffff
    s_cbranch_scc1 L_h1_done
    s_waitcnt vmcnt(0)
    s_sub_u32 s56, s56, 1
    s_cbranch_scc0 L_h1_round
    s_mov_b32 s56, 0
L_h1_done:
    s_or_b32 s86, s2, s48
    s_cmp_eq_u32 s86, 0
    s_cselect_b32 s86, 0, 2147483648
    s_add_u32 s86, s86, 524288
    v_mov_b32 v6, s86
    v_mov_b32 v7, s61
    buffer_store_dword v7, v6, s[16:19], 0 offen sc1
    v_cvt_pk_bf16_f32 v120, v112, v113
    v_cvt_pk_bf16_f32 v121, v114, v115
    v_cvt_pk_bf16_f32 v122, v116, v117
    v_cvt_pk_bf16_f32 v123, v118, v119
    v_cvt_pk_bf16_f32 v124, v104, v105
    v_cvt_pk_bf16_f32 v125, v106, v107
    v_cvt_pk_bf16_f32 v126, v108, v109
    v_cvt_pk_bf16_f32 v127, v110, v111
    s_mul_i32 s86, s50, 3072
    s_add_u32 s86, s86, 151552
    v_lshl_add_u32 v4, v0, 4, s86
    s_lshl_b32 s86, s49, 10
    v_add_u32 v5, s86, v4
    ds_write_b128 v5, v[120:123]
    ds_write_b128 v4, v[124:127] offset:2048
    s_waitcnt vmcnt(0) lgkmcnt(0)
    s_barrier
    s_barrier
    v_mov_b32 v11, v30
    v_mov_b32 v14, v31
    s_branch L_phaseB
L_comp:
    v_and_b32 v20, 15, v0
    v_lshrrev_b32 v21, 4, v0
    v_bfe_u32 v22, v0, 1, 3
    s_lshl_b32 s86, s49, 13
    v_lshl_add_u32 v20, v20, 7, s86
    v_or_b32 v23, 0, v21
    v_xor_b32 v23, v23, v22
    v_lshl_add_u32 v2, v23, 4, v20
    v_or_b32 v23, 4, v21
    v_xor_b32 v23, v23, v22
    v_lshl_add_u32 v3, v23, 4, v20
    v_bfe_u32 v22, v0, 2, 2
    v_lshl_add_u32 v22, v21, 3, v22
    v_lshlrev_b32 v22, 7, v22
    v_bfe_u32 v23, v0, 3, 2
    s_lshl_b32 s86, s50, 1
    v_xor_b32 v23, s86, v23
    v_lshl_add_u32 v22, v23, 5, v22
    v_and_b32 v23, 3, v0
    v_lshl_add_u32 v22, v23, 3, v22
    v_add_u32 v4, 16384, v22
    v_xor_b32 v5, 32, v4
    s_lshl_b32 s53, s2, 2
    s_add_u32 s53, s53, s3
    s_mul_i32 s53, s53, 6400
    s_add_u32 s53, s53, 1048576
    v_lshl_add_u32 v6, v0, 4, s53
    v_mov_b32 v8, -1
    v_mov_b32 v9, -1
    v_mov_b32 v10, -1
    v_mov_b32 v11, -1
    s_waitcnt lgkmcnt(0)
    s_mov_b32 s16, s84
    s_and_b32 s17, s85, 0xffff
    s_mov_b32 s18, 268435456
    s_mov_b32 s19, 0x20000
    s_mov_b32 s8, s64
    s_and_b32 s9, s65, 0xffff
    s_mov_b32 s10, 4194304
    s_mov_b32 s11, 0x20000
    s_mov_b32 s20, s68
    s_and_b32 s21, s69, 0xffff
    s_mov_b32 s22, 2097152
    s_mov_b32 s23, 0x20000
    s_mov_b32 s24, s80
    s_and_b32 s25, s81, 0xffff
    s_mov_b32 s26, 4194304
    s_mov_b32 s27, 0x20000
    s_mov_b32 s28, s82
    s_and_b32 s29, s83, 0xffff
    s_mov_b32 s30, 256
    s_mov_b32 s31, 0x20000
    s_bitcmp1_b32 s2, 0
    s_cselect_b32 s32, s76, s74
    s_cselect_b32 s33, s77, s75
    s_and_b32 s33, s33, 0xffff
    s_mov_b32 s34, 7340032
    s_mov_b32 s35, 0x20000
    s_mov_b32 s36, s78
    s_and_b32 s37, s79, 0xffff
    s_mov_b32 s38, 7340032
    s_mov_b32 s39, 0x20000
    s_mov_b32 s40, s72
    s_and_b32 s41, s73, 0xffff
    s_mov_b32 s42, 2048
    s_mov_b32 s43, 0x20000
    s_mov_b32 s12, s84
    s_and_b32 s13, s85, 0xffff
    s_mov_b32 s14, 0
    s_mov_b32 s15, 0x20000
    s_add_u32 s14, s53, 6400
    v_mov_b32 v128, 0
    v_mov_b32 v129, 0
    v_mov_b32 v130, 0
    v_mov_b32 v131, 0
    v_mov_b32 v132, 0
    v_mov_b32 v133, 0
    v_mov_b32 v134, 0
    v_mov_b32 v135, 0
    v_mov_b32 v136, 0
    v_mov_b32 v137, 0
    v_mov_b32 v138, 0
    v_mov_b32 v139, 0
    v_mov_b32 v140, 0
    v_mov_b32 v141, 0
    v_mov_b32 v142, 0
    v_mov_b32 v143, 0
    v_mov_b32 v144, 0
    v_mov_b32 v145, 0
    v_mov_b32 v146, 0
    v_mov_b32 v147, 0
    v_mov_b32 v148, 0
    v_mov_b32 v149, 0
    v_mov_b32 v150, 0
    v_mov_b32 v151, 0
    v_mov_b32 v152, 0
    v_mov_b32 v153, 0
    v_mov_b32 v154, 0
    v_mov_b32 v155, 0
    v_mov_b32 v156, 0
    v_mov_b32 v157, 0
    v_mov_b32 v158, 0
    v_mov_b32 v159, 0
    v_mov_b32 v160, 0
    v_mov_b32 v161, 0
    v_mov_b32 v162, 0
    v_mov_b32 v163, 0
    v_mov_b32 v164, 0
    v_mov_b32 v165, 0
    v_mov_b32 v166, 0
    v_mov_b32 v167, 0
    v_mov_b32 v168, 0
    v_mov_b32 v169, 0
    v_mov_b32 v170, 0
    v_mov_b32 v171, 0
    v_mov_b32 v172, 0
    v_mov_b32 v173, 0
    v_mov_b32 v174, 0
    v_mov_b32 v175, 0
    v_mov_b32 v176, 0
    v_mov_b32 v177, 0
    v_mov_b32 v178, 0
    v_mov_b32 v179, 0
    v_mov_b32 v180, 0
    v_mov_b32 v181, 0
    v_mov_b32 v182, 0
    v_mov_b32 v183, 0
    v_mov_b32 v184, 0
    v_mov_b32 v185, 0
    v_mov_b32 v186, 0
    v_mov_b32 v187, 0
    v_mov_b32 v188, 0
    v_mov_b32 v189, 0
    v_mov_b32 v190, 0
    v_mov_b32 v191, 0
    v_mov_b32 v192, 0
    v_mov_b32 v193, 0
    v_mov_b32 v194, 0
    v_mov_b32 v195, 0
    v_mov_b32 v196, 0
    v_mov_b32 v197, 0
    v_mov_b32 v198, 0
    v_mov_b32 v199, 0
    v_mov_b32 v200, 0
    v_mov_b32 v201, 0
    v_mov_b32 v202, 0
    v_mov_b32 v203, 0
    v_mov_b32 v204, 0
    v_mov_b32 v205, 0
    v_mov_b32 v206, 0
    v_mov_b32 v207, 0
    v_mov_b32 v208, 0
    v_mov_b32 v209, 0
    v_mov_b32 v210, 0
    v_mov_b32 v211, 0
    v_mov_b32 v212, 0
    v_mov_b32 v213, 0
    v_mov_b32 v214, 0
    v_mov_b32 v215, 0
    v_mov_b32 v216, 0
    v_mov_b32 v217, 0
    v_mov_b32 v218, 0
    v_mov_b32 v219, 0
    v_mov_b32 v220, 0
    v_mov_b32 v221, 0
    v_mov_b32 v222, 0
    v_mov_b32 v223, 0
    s_mov_b32 s54, 0x358637bd
    s_mov_b32 s55, 0x358637bd
    s_mov_b32 s62, 0
    s_mov_b32 s63, 0
    s_barrier
    ds_read_b128 v[40:43], v2 offset:0
    ds_read_b128 v[44:47], v2 offset:2048
    ds_read_b128 v[48:51], v2 offset:4096
    ds_read_b128 v[52:55], v2 offset:6144
    ds_read_b64_tr_b16 v[56:57], v4 offset:0
    ds_read_b64_tr_b16 v[58:59], v4 offset:512
    ds_read_b64_tr_b16 v[60:61], v5 offset:0
    ds_read_b64_tr_b16 v[62:63], v5 offset:512
    ds_read_b64_tr_b16 v[64:65], v4 offset:8192
    ds_read_b64_tr_b16 v[66:67], v4 offset:8704
    ds_read_b64_tr_b16 v[68:69], v5 offset:8192
    ds_read_b64_tr_b16 v[70:71], v5 offset:8704
    ds_read_b64_tr_b16 v[72:73], v4 offset:16384
    ds_read_b64_tr_b16 v[74:75], v4 offset:16896
    ds_read_b64_tr_b16 v[76:77], v5 offset:16384
    ds_read_b64_tr_b16 v[78:79], v5 offset:16896
L_cloop:
    s_waitcnt lgkmcnt(0)
    v_mfma_f32_16x16x32_bf16 v[128:131], v[56:59], v[40:43], v[128:131]
    ds_read_b128 v[80:83], v3 offset:0
    v_mfma_f32_16x16x32_bf16 v[132:135], v[56:59], v[44:47], v[132:135]
    ds_read_b128 v[84:87], v3 offset:2048
    v_mfma_f32_16x16x32_bf16 v[136:139], v[56:59], v[48:51], v[136:139]
    ds_read_b128 v[88:91], v3 offset:4096
    v_mfma_f32_16x16x32_bf16 v[140:143], v[56:59], v[52:55], v[140:143]
    ds_read_b128 v[92:95], v3 offset:6144
    v_mfma_f32_16x16x32_bf16 v[144:147], v[60:63], v[40:43], v[144:147]
    ds_read_b64_tr_b16 v[96:97], v4 offset:4096
    v_mfma_f32_16x16x32_bf16 v[148:151], v[60:63], v[44:47], v[148:151]
    ds_read_b64_tr_b16 v[98:99], v4 offset:4608
    v_mfma_f32_16x16x32_bf16 v[152:155], v[60:63], v[48:51], v[152:155]
    ds_read_b64_tr_b16 v[100:101], v5 offset:4096
    v_mfma_f32_16x16x32_bf16 v[156:159], v[60:63], v[52:55], v[156:159]
    ds_read_b64_tr_b16 v[102:103], v5 offset:4608
    v_mfma_f32_16x16x32_bf16 v[160:163], v[40:43], v[64:67], v[160:163]
    ds_read_b64_tr_b16 v[104:105], v4 offset:12288
    v_mfma_f32_16x16x32_bf16 v[164:167], v[44:47], v[64:67], v[164:167]
    ds_read_b64_tr_b16 v[106:107], v4 offset:12800
    v_mfma_f32_16x16x32_bf16 v[168:171], v[48:51], v[64:67], v[168:171]
    ds_read_b64_tr_b16 v[108:109], v5 offset:12288
    v_mfma_f32_16x16x32_bf16 v[172:175], v[52:55], v[64:67], v[172:175]
    ds_read_b64_tr_b16 v[110:111], v5 offset:12800
    v_mfma_f32_16x16x32_bf16 v[176:179], v[40:43], v[68:71], v[176:179]
    ds_read_b64_tr_b16 v[112:113], v4 offset:20480
    v_mfma_f32_16x16x32_bf16 v[180:183], v[44:47], v[68:71], v[180:183]
    ds_read_b64_tr_b16 v[114:115], v4 offset:20992
    v_mfma_f32_16x16x32_bf16 v[184:187], v[48:51], v[68:71], v[184:187]
    ds_read_b64_tr_b16 v[116:117], v5 offset:20480
    v_mfma_f32_16x16x32_bf16 v[188:191], v[52:55], v[68:71], v[188:191]
    ds_read_b64_tr_b16 v[118:119], v5 offset:20992
    v_mfma_f32_16x16x32_bf16 v[192:195], v[40:43], v[72:75], v[192:195]
    s_add_u32 s63, s63, 1
    s_cmp_eq_u32 s63, 3
    s_cselect_b32 s53, 4294844416, 0
    s_cselect_b32 s63, 0, s63
    s_add_u32 s53, s53, 40960
    v_mfma_f32_16x16x32_bf16 v[196:199], v[44:47], v[72:75], v[196:199]
    v_add_u32 v2, s53, v2
    v_mfma_f32_16x16x32_bf16 v[200:203], v[48:51], v[72:75], v[200:203]
    v_add_u32 v4, s53, v4
    v_mfma_f32_16x16x32_bf16 v[204:207], v[52:55], v[72:75], v[204:207]
    v_add_u32 v5, s53, v5
    v_mfma_f32_16x16x32_bf16 v[208:211], v[40:43], v[76:79], v[208:211]
    v_add_u32 v3, s53, v3
    v_mfma_f32_16x16x32_bf16 v[212:215], v[44:47], v[76:79], v[212:215]
    s_cmp_ge_u32 s62, 7
    s_cbranch_scc1 L_cl_none
    buffer_store_dwordx4 v[8:11], v6, s[12:15], 0 offen offset:0 sc1
    v_add_u32 v6, 1024, v6
L_cl_none:
    v_mfma_f32_16x16x32_bf16 v[216:219], v[48:51], v[76:79], v[216:219]
    v_mfma_f32_16x16x32_bf16 v[220:223], v[52:55], v[76:79], v[220:223]
    s_waitcnt lgkmcnt(0)
    v_mfma_f32_16x16x32_bf16 v[128:131], v[96:99], v[80:83], v[128:131]
    s_barrier
    ds_read_b128 v[40:43], v2 offset:0
    v_mfma_f32_16x16x32_bf16 v[132:135], v[96:99], v[84:87], v[132:135]
    ds_read_b128 v[44:47], v2 offset:2048
    v_mfma_f32_16x16x32_bf16 v[136:139], v[96:99], v[88:91], v[136:139]
    ds_read_b128 v[48:51], v2 offset:4096
    v_mfma_f32_16x16x32_bf16 v[140:143], v[96:99], v[92:95], v[140:143]
    ds_read_b128 v[52:55], v2 offset:6144
    v_mfma_f32_16x16x32_bf16 v[144:147], v[100:103], v[80:83], v[144:147]
    ds_read_b64_tr_b16 v[56:57], v4 offset:0
    v_mfma_f32_16x16x32_bf16 v[148:151], v[100:103], v[84:87], v[148:151]
    ds_read_b64_tr_b16 v[58:59], v4 offset:512
    v_mfma_f32_16x16x32_bf16 v[152:155], v[100:103], v[88:91], v[152:155]
    ds_read_b64_tr_b16 v[60:61], v5 offset:0
    v_mfma_f32_16x16x32_bf16 v[156:159], v[100:103], v[92:95], v[156:159]
    ds_read_b64_tr_b16 v[62:63], v5 offset:512
    v_mfma_f32_16x16x32_bf16 v[160:163], v[80:83], v[104:107], v[160:163]
    ds_read_b64_tr_b16 v[64:65], v4 offset:8192
    v_mfma_f32_16x16x32_bf16 v[164:167], v[84:87], v[104:107], v[164:167]
    ds_read_b64_tr_b16 v[66:67], v4 offset:8704
    v_mfma_f32_16x16x32_bf16 v[168:171], v[88:91], v[104:107], v[168:171]
    ds_read_b64_tr_b16 v[68:69], v5 offset:8192
    v_mfma_f32_16x16x32_bf16 v[172:175], v[92:95], v[104:107], v[172:175]
    ds_read_b64_tr_b16 v[70:71], v5 offset:8704
    v_mfma_f32_16x16x32_bf16 v[176:179], v[80:83], v[108:111], v[176:179]
    ds_read_b64_tr_b16 v[72:73], v4 offset:16384
    v_mfma_f32_16x16x32_bf16 v[180:183], v[84:87], v[108:111], v[180:183]
    ds_read_b64_tr_b16 v[74:75], v4 offset:16896
    v_mfma_f32_16x16x32_bf16 v[184:187], v[88:91], v[108:111], v[184:187]
    ds_read_b64_tr_b16 v[76:77], v5 offset:16384
    v_mfma_f32_16x16x32_bf16 v[188:191], v[92:95], v[108:111], v[188:191]
    ds_read_b64_tr_b16 v[78:79], v5 offset:16896
    v_mfma_f32_16x16x32_bf16 v[192:195], v[80:83], v[112:115], v[192:195]
    v_mfma_f32_16x16x32_bf16 v[196:199], v[84:87], v[112:115], v[196:199]
    s_cmp_lg_u32 s62, 8
    s_cbranch_scc1 L_cl_nw
    s_waitcnt vmcnt(0)
L_cl_nw:
    v_mfma_f32_16x16x32_bf16 v[200:203], v[88:91], v[112:115], v[200:203]
    v_mfma_f32_16x16x32_bf16 v[204:207], v[92:95], v[112:115], v[204:207]
    v_mfma_f32_16x16x32_bf16 v[208:211], v[80:83], v[116:119], v[208:211]
    s_add_u32 s62, s62, 1
    v_mfma_f32_16x16x32_bf16 v[212:215], v[84:87], v[116:119], v[212:215]
    v_mfma_f32_16x16x32_bf16 v[216:219], v[88:91], v[116:119], v[216:219]
    v_mfma_f32_16x16x32_bf16 v[220:223], v[92:95], v[116:119], v[220:223]
    s_cmp_lt_u32 s62, 15
    s_cbranch_scc1 L_cloop
    s_waitcnt lgkmcnt(0)
    v_mfma_f32_16x16x32_bf16 v[128:131], v[56:59], v[40:43], v[128:131]
    ds_read_b128 v[80:83], v3 offset:0
    v_mfma_f32_16x16x32_bf16 v[132:135], v[56:59], v[44:47], v[132:135]
    ds_read_b128 v[84:87], v3 offset:2048
    v_mfma_f32_16x16x32_bf16 v[136:139], v[56:59], v[48:51], v[136:139]
    ds_read_b128 v[88:91], v3 offset:4096
    v_mfma_f32_16x16x32_bf16 v[140:143], v[56:59], v[52:55], v[140:143]
    ds_read_b128 v[92:95], v3 offset:6144
    v_mfma_f32_16x16x32_bf16 v[144:147], v[60:63], v[40:43], v[144:147]
    ds_read_b64_tr_b16 v[96:97], v4 offset:4096
    v_mfma_f32_16x16x32_bf16 v[148:151], v[60:63], v[44:47], v[148:151]
    ds_read_b64_tr_b16 v[98:99], v4 offset:4608
    v_mfma_f32_16x16x32_bf16 v[152:155], v[60:63], v[48:51], v[152:155]
    ds_read_b64_tr_b16 v[100:101], v5 offset:4096
    v_mfma_f32_16x16x32_bf16 v[156:159], v[60:63], v[52:55], v[156:159]
    ds_read_b64_tr_b16 v[102:103], v5 offset:4608
    v_mfma_f32_16x16x32_bf16 v[160:163], v[40:43], v[64:67], v[160:163]
    ds_read_b64_tr_b16 v[104:105], v4 offset:12288
    v_mfma_f32_16x16x32_bf16 v[164:167], v[44:47], v[64:67], v[164:167]
    ds_read_b64_tr_b16 v[106:107], v4 offset:12800
    v_mfma_f32_16x16x32_bf16 v[168:171], v[48:51], v[64:67], v[168:171]
    ds_read_b64_tr_b16 v[108:109], v5 offset:12288
    v_mfma_f32_16x16x32_bf16 v[172:175], v[52:55], v[64:67], v[172:175]
    ds_read_b64_tr_b16 v[110:111], v5 offset:12800
    v_mfma_f32_16x16x32_bf16 v[176:179], v[40:43], v[68:71], v[176:179]
    ds_read_b64_tr_b16 v[112:113], v4 offset:20480
    v_mfma_f32_16x16x32_bf16 v[180:183], v[44:47], v[68:71], v[180:183]
    ds_read_b64_tr_b16 v[114:115], v4 offset:20992
    v_mfma_f32_16x16x32_bf16 v[184:187], v[48:51], v[68:71], v[184:187]
    ds_read_b64_tr_b16 v[116:117], v5 offset:20480
    v_mfma_f32_16x16x32_bf16 v[188:191], v[52:55], v[68:71], v[188:191]
    ds_read_b64_tr_b16 v[118:119], v5 offset:20992
    v_mfma_f32_16x16x32_bf16 v[192:195], v[40:43], v[72:75], v[192:195]
    v_lshrrev_b32 v21, 4, v0
    v_and_b32 v22, 15, v0
    v_mfma_f32_16x16x32_bf16 v[196:199], v[44:47], v[72:75], v[196:199]
    s_lshl_b32 s86, s49, 8
    s_add_u32 s86, s86, 131072
    v_lshl_add_u32 v6, v21, 4, s86
    v_mfma_f32_16x16x32_bf16 v[200:203], v[48:51], v[72:75], v[200:203]
    v_lshl_add_u32 v7, v22, 2, s86
    v_mfma_f32_16x16x32_bf16 v[204:207], v[52:55], v[72:75], v[204:207]
    s_lshl_b32 s86, s50, 7
    s_add_u32 s86, s86, 132608
    v_lshl_add_u32 v8, v22, 2, s86
    v_mfma_f32_16x16x32_bf16 v[208:211], v[40:43], v[76:79], v[208:211]
    v_lshl_add_u32 v9, v21, 4, s86
    v_mfma_f32_16x16x32_bf16 v[212:215], v[44:47], v[76:79], v[212:215]
    s_lshl_b32 s86, s3, 2
    s_add_u32 s86, s86, 135168
    v_mov_b32 v12, s86
    v_mfma_f32_16x16x32_bf16 v[216:219], v[48:51], v[76:79], v[216:219]
    v_xor_b32 v13, 4, v12
    v_mfma_f32_16x16x32_bf16 v[220:223], v[52:55], v[76:79], v[220:223]
    s_waitcnt lgkmcnt(0)
    v_mfma_f32_16x16x32_bf16 v[160:163], v[80:83], v[104:107], v[160:163]
    ds_write_b32 v12, v12
    ds_read_b128 v[40:43], v6 offset:0
    v_mfma_f32_16x16x32_bf16 v[164:167], v[84:87], v[104:107], v[164:167]
    ds_read_b128 v[44:47], v6 offset:64
    v_mfma_f32_16x16x32_bf16 v[168:171], v[88:91], v[104:107], v[168:171]
    ds_read_b128 v[48:51], v6 offset:128
    v_mfma_f32_16x16x32_bf16 v[172:175], v[92:95], v[104:107], v[172:175]
    ds_read_b128 v[52:55], v6 offset:192
    v_mfma_f32_16x16x32_bf16 v[176:179], v[80:83], v[108:111], v[176:179]
    ds_read_b32 v72, v8 offset:256
    v_mfma_f32_16x16x32_bf16 v[180:183], v[84:87], v[108:111], v[180:183]
    ds_read_b32 v73, v8 offset:320
    v_mfma_f32_16x16x32_bf16 v[184:187], v[88:91], v[108:111], v[184:187]
    ds_read_b32 v74, v8 offset:512
    v_mfma_f32_16x16x32_bf16 v[188:191], v[92:95], v[108:111], v[188:191]
    ds_read_b32 v75, v8 offset:576
    v_mfma_f32_16x16x32_bf16 v[192:195], v[80:83], v[112:115], v[192:195]
    ds_read_b128 v[56:59], v6 offset:512
    v_mfma_f32_16x16x32_bf16 v[196:199], v[84:87], v[112:115], v[196:199]
    ds_read_b128 v[60:63], v6 offset:576
    v_mfma_f32_16x16x32_bf16 v[200:203], v[88:91], v[112:115], v[200:203]
    ds_read_b128 v[64:67], v6 offset:640
    v_mfma_f32_16x16x32_bf16 v[204:207], v[92:95], v[112:115], v[204:207]
    ds_read_b128 v[68:71], v6 offset:704
    v_mfma_f32_16x16x32_bf16 v[208:211], v[80:83], v[116:119], v[208:211]
    ds_read_b128 v[224:227], v6 offset:1024
    v_mfma_f32_16x16x32_bf16 v[212:215], v[84:87], v[116:119], v[212:215]
    ds_read_b128 v[228:231], v6 offset:1088
    v_mfma_f32_16x16x32_bf16 v[216:219], v[88:91], v[116:119], v[216:219]
    ds_read_b128 v[232:235], v6 offset:1152
    v_mfma_f32_16x16x32_bf16 v[220:223], v[92:95], v[116:119], v[220:223]
    ds_read_b128 v[236:239], v6 offset:1216
    v_mfma_f32_16x16x32_bf16 v[128:131], v[96:99], v[80:83], v[128:131]
    ds_read_b128 v[28:31], v9 offset:0
    v_mfma_f32_16x16x32_bf16 v[132:135], v[96:99], v[84:87], v[132:135]
    ds_read_b128 v[32:35], v9 offset:64
    v_mfma_f32_16x16x32_bf16 v[136:139], v[96:99], v[88:91], v[136:139]
    v_mfma_f32_16x16x32_bf16 v[140:143], v[96:99], v[92:95], v[140:143]
    v_mfma_f32_16x16x32_bf16 v[144:147], v[100:103], v[80:83], v[144:147]
    v_mfma_f32_16x16x32_bf16 v[148:151], v[100:103], v[84:87], v[148:151]
    v_mfma_f32_16x16x32_bf16 v[152:155], v[100:103], v[88:91], v[152:155]
    v_mfma_f32_16x16x32_bf16 v[156:159], v[100:103], v[92:95], v[156:159]
    ds_read_b32 v240, v7 offset:0
    ds_read_b32 v244, v7 offset:512
    ds_read_b32 v248, v7 offset:1024
    ds_read_b32 v241, v7 offset:64
    ds_read_b32 v245, v7 offset:576
    ds_read_b32 v249, v7 offset:1088
    ds_read_b32 v242, v7 offset:128
    ds_read_b32 v246, v7 offset:640
    ds_read_b32 v250, v7 offset:1152
    ds_read_b32 v243, v7 offset:192
    ds_read_b32 v247, v7 offset:704
    ds_read_b32 v251, v7 offset:1216
    s_waitcnt lgkmcnt(12)
    v_pk_fma_f32 v[160:161], v[40:41], v[72:73], v[160:161] op_sel_hi:[1,0,1]
    v_pk_mul_f32 v[112:113], v[160:161], v[224:225]
    v_pk_fma_f32 v[160:161], v[160:161], v[56:57], s[54:55]
    v_exp_f32 v112, v112 clamp
    v_exp_f32 v113, v113 clamp
    v_max_f32 v160, s54, v160
    v_max_f32 v161, s54, v161
    v_pk_add_f32 v[160:161], v[160:161], v[112:113]
    v_cvt_pk_bf16_f32 v80, v160, v161
    v_pk_fma_f32 v[162:163], v[42:43], v[72:73], v[162:163] op_sel_hi:[1,0,1]
    v_pk_mul_f32 v[114:115], v[162:163], v[226:227]
    v_pk_fma_f32 v[162:163], v[162:163], v[58:59], s[54:55]
    v_exp_f32 v114, v114 clamp
    v_exp_f32 v115, v115 clamp
    v_max_f32 v162, s54, v162
    v_max_f32 v163, s54, v163
    v_pk_add_f32 v[162:163], v[162:163], v[114:115]
    v_cvt_pk_bf16_f32 v81, v162, v163
    v_pk_fma_f32 v[164:165], v[44:45], v[72:73], v[164:165] op_sel_hi:[1,0,1]
    v_pk_mul_f32 v[116:117], v[164:165], v[228:229]
    v_pk_fma_f32 v[164:165], v[164:165], v[60:61], s[54:55]
    v_exp_f32 v116, v116 clamp
    v_exp_f32 v117, v117 clamp
    v_max_f32 v164, s54, v164
    v_max_f32 v165, s54, v165
    v_pk_add_f32 v[164:165], v[164:165], v[116:117]
    v_cvt_pk_bf16_f32 v82, v164, v165
    v_pk_fma_f32 v[166:167], v[46:47], v[72:73], v[166:167] op_sel_hi:[1,0,1]
    v_pk_mul_f32 v[118:119], v[166:167], v[230:231]
    v_pk_fma_f32 v[166:167], v[166:167], v[62:63], s[54:55]
    v_exp_f32 v118, v118 clamp
    v_exp_f32 v119, v119 clamp
    v_max_f32 v166, s54, v166
    v_max_f32 v167, s54, v167
    v_pk_add_f32 v[166:167], v[166:167], v[118:119]
    v_cvt_pk_bf16_f32 v83, v166, v167
    v_pk_fma_f32 v[168:169], v[48:49], v[72:73], v[168:169] op_sel_hi:[1,0,1]
    v_pk_mul_f32 v[112:113], v[168:169], v[232:233]
    v_pk_fma_f32 v[168:169], v[168:169], v[64:65], s[54:55]
    v_exp_f32 v112, v112 clamp
    v_exp_f32 v113, v113 clamp
    v_max_f32 v168, s54, v168
    v_max_f32 v169, s54, v169
    v_pk_add_f32 v[168:169], v[168:169], v[112:113]
    v_cvt_pk_bf16_f32 v84, v168, v169
    v_pk_fma_f32 v[170:171], v[50:51], v[72:73], v[170:171] op_sel_hi:[1,0,1]
    v_pk_mul_f32 v[114:115], v[170:171], v[234:235]
    v_pk_fma_f32 v[170:171], v[170:171], v[66:67], s[54:55]
    v_exp_f32 v114, v114 clamp
    v_exp_f32 v115, v115 clamp
    v_max_f32 v170, s54, v170
    v_max_f32 v171, s54, v171
    v_pk_add_f32 v[170:171], v[170:171], v[114:115]
    v_cvt_pk_bf16_f32 v85, v170, v171
    v_pk_fma_f32 v[172:173], v[52:53], v[72:73], v[172:173] op_sel_hi:[1,0,1]
    v_pk_mul_f32 v[116:117], v[172:173], v[236:237]
    v_pk_fma_f32 v[172:173], v[172:173], v[68:69], s[54:55]
    v_exp_f32 v116, v116 clamp
    v_exp_f32 v117, v117 clamp
    v_max_f32 v172, s54, v172
    v_max_f32 v173, s54, v173
    v_pk_add_f32 v[172:173], v[172:173], v[116:117]
    v_cvt_pk_bf16_f32 v86, v172, v173
    v_pk_fma_f32 v[174:175], v[54:55], v[72:73], v[174:175] op_sel_hi:[1,0,1]
    v_pk_mul_f32 v[118:119], v[174:175], v[238:239]
    v_pk_fma_f32 v[174:175], v[174:175], v[70:71], s[54:55]
    v_exp_f32 v118, v118 clamp
    v_exp_f32 v119, v119 clamp
    v_max_f32 v174, s54, v174
    v_max_f32 v175, s54, v175
    v_pk_add_f32 v[174:175], v[174:175], v[118:119]
    v_cvt_pk_bf16_f32 v87, v174, v175
    v_pk_fma_f32 v[176:177], v[40:41], v[72:73], v[176:177] op_sel:[0,1,0] op_sel_hi:[1,1,1]
    v_pk_mul_f32 v[112:113], v[176:177], v[224:225]
    v_pk_fma_f32 v[176:177], v[176:177], v[56:57], s[54:55]
    v_exp_f32 v112, v112 clamp
    v_exp_f32 v113, v113 clamp
    v_max_f32 v176, s54, v176
    v_max_f32 v177, s54, v177
    v_pk_add_f32 v[176:177], v[176:177], v[112:113]
    v_cvt_pk_bf16_f32 v88, v176, v177
    v_pk_fma_f32 v[178:179], v[42:43], v[72:73], v[178:179] op_sel:[0,1,0] op_sel_hi:[1,1,1]
    v_pk_mul_f32 v[114:115], v[178:179], v[226:227]
    v_pk_fma_f32 v[178:179], v[178:179], v[58:59], s[54:55]
    v_exp_f32 v114, v114 clamp
    v_exp_f32 v115, v115 clamp
    v_max_f32 v178, s54, v178
    v_max_f32 v179, s54, v179
    v_pk_add_f32 v[178:179], v[178:179], v[114:115]
    v_cvt_pk_bf16_f32 v89, v178, v179
    v_pk_fma_f32 v[180:181], v[44:45], v[72:73], v[180:181] op_sel:[0,1,0] op_sel_hi:[1,1,1]
    v_pk_mul_f32 v[116:117], v[180:181], v[228:229]
    v_pk_fma_f32 v[180:181], v[180:181], v[60:61], s[54:55]
    v_exp_f32 v116, v116 clamp
    v_exp_f32 v117, v117 clamp
    v_max_f32 v180, s54, v180
    v_max_f32 v181, s54, v181
    v_pk_add_f32 v[180:181], v[180:181], v[116:117]
    v_cvt_pk_bf16_f32 v90, v180, v181
    v_pk_fma_f32 v[182:183], v[46:47], v[72:73], v[182:183] op_sel:[0,1,0] op_sel_hi:[1,1,1]
    v_pk_mul_f32 v[118:119], v[182:183], v[230:231]
    v_pk_fma_f32 v[182:183], v[182:183], v[62:63], s[54:55]
    v_exp_f32 v118, v118 clamp
    v_exp_f32 v119, v119 clamp
    v_max_f32 v182, s54, v182
    v_max_f32 v183, s54, v183
    v_pk_add_f32 v[182:183], v[182:183], v[118:119]
    v_cvt_pk_bf16_f32 v91, v182, v183
    v_pk_fma_f32 v[184:185], v[48:49], v[72:73], v[184:185] op_sel:[0,1,0] op_sel_hi:[1,1,1]
    v_pk_mul_f32 v[112:113], v[184:185], v[232:233]
    v_pk_fma_f32 v[184:185], v[184:185], v[64:65], s[54:55]
    v_exp_f32 v112, v112 clamp
    v_exp_f32 v113, v113 clamp
    v_max_f32 v184, s54, v184
    v_max_f32 v185, s54, v185
    v_pk_add_f32 v[184:185], v[184:185], v[112:113]
    v_cvt_pk_bf16_f32 v92, v184, v185
    v_pk_fma_f32 v[186:187], v[50:51], v[72:73], v[186:187] op_sel:[0,1,0] op_sel_hi:[1,1,1]
    v_pk_mul_f32 v[114:115], v[186:187], v[234:235]
    v_pk_fma_f32 v[186:187], v[186:187], v[66:67], s[54:55]
    v_exp_f32 v114, v114 clamp
    v_exp_f32 v115, v115 clamp
    v_max_f32 v186, s54, v186
    v_max_f32 v187, s54, v187
    v_pk_add_f32 v[186:187], v[186:187], v[114:115]
    v_cvt_pk_bf16_f32 v93, v186, v187
    v_pk_fma_f32 v[188:189], v[52:53], v[72:73], v[188:189] op_sel:[0,1,0] op_sel_hi:[1,1,1]
    v_pk_mul_f32 v[116:117], v[188:189], v[236:237]
    v_pk_fma_f32 v[188:189], v[188:189], v[68:69], s[54:55]
    v_exp_f32 v116, v116 clamp
    v_exp_f32 v117, v117 clamp
    v_max_f32 v188, s54, v188
    v_max_f32 v189, s54, v189
    v_pk_add_f32 v[188:189], v[188:189], v[116:117]
    v_cvt_pk_bf16_f32 v94, v188, v189
    v_pk_fma_f32 v[190:191], v[54:55], v[72:73], v[190:191] op_sel:[0,1,0] op_sel_hi:[1,1,1]
    v_pk_mul_f32 v[118:119], v[190:191], v[238:239]
    v_pk_fma_f32 v[190:191], v[190:191], v[70:71], s[54:55]
    v_exp_f32 v118, v118 clamp
    v_exp_f32 v119, v119 clamp
    v_max_f32 v190, s54, v190
    v_max_f32 v191, s54, v191
    v_pk_add_f32 v[190:191], v[190:191], v[118:119]
    v_cvt_pk_bf16_f32 v95, v190, v191
    v_mov_b32 v120, s95
    v_mov_b32 v121, s95
    v_mov_b32 v122, s95
    v_mov_b32 v123, s95
    v_pk_fma_f32 v[192:193], v[40:41], v[74:75], v[192:193] op_sel_hi:[1,0,1]
    v_pk_mul_f32 v[192:193], v[192:193], v[56:57]
    v_cvt_pk_bf16_f32 v96, v192, v193
    v_pk_fma_f32 v[194:195], v[42:43], v[74:75], v[194:195] op_sel_hi:[1,0,1]
    v_pk_mul_f32 v[194:195], v[194:195], v[58:59]
    v_cvt_pk_bf16_f32 v97, v194, v195
    v_pk_fma_f32 v[196:197], v[44:45], v[74:75], v[196:197] op_sel_hi:[1,0,1]
    v_pk_mul_f32 v[196:197], v[196:197], v[60:61]
    v_cvt_pk_bf16_f32 v98, v196, v197
    v_pk_fma_f32 v[198:199], v[46:47], v[74:75], v[198:199] op_sel_hi:[1,0,1]
    v_pk_mul_f32 v[198:199], v[198:199], v[62:63]
    v_cvt_pk_bf16_f32 v99, v198, v199
    v_pk_fma_f32 v[200:201], v[48:49], v[74:75], v[200:201] op_sel_hi:[1,0,1]
    v_pk_mul_f32 v[200:201], v[200:201], v[64:65]
    v_cvt_pk_bf16_f32 v100, v200, v201
    v_pk_fma_f32 v[202:203], v[50:51], v[74:75], v[202:203] op_sel_hi:[1,0,1]
    v_pk_mul_f32 v[202:203], v[202:203], v[66:67]
    v_cvt_pk_bf16_f32 v101, v202, v203
    v_pk_fma_f32 v[204:205], v[52:53], v[74:75], v[204:205] op_sel_hi:[1,0,1]
    v_pk_mul_f32 v[204:205], v[204:205], v[68:69]
    v_cvt_pk_bf16_f32 v102, v204, v205
    v_pk_fma_f32 v[206:207], v[54:55], v[74:75], v[206:207] op_sel_hi:[1,0,1]
    v_pk_mul_f32 v[206:207], v[206:207], v[70:71]
    v_cvt_pk_bf16_f32 v103, v206, v207
    v_pk_fma_f32 v[208:209], v[40:41], v[74:75], v[208:209] op_sel:[0,1,0] op_sel_hi:[1,1,1]
    v_pk_mul_f32 v[208:209], v[208:209], v[56:57]
    v_cvt_pk_bf16_f32 v104, v208, v209
    v_pk_fma_f32 v[210:211], v[42:43], v[74:75], v[210:211] op_sel:[0,1,0] op_sel_hi:[1,1,1]
    v_pk_mul_f32 v[210:211], v[210:211], v[58:59]
    v_cvt_pk_bf16_f32 v105, v210, v211
    v_pk_fma_f32 v[212:213], v[44:45], v[74:75], v[212:213] op_sel:[0,1,0] op_sel_hi:[1,1,1]
    v_pk_mul_f32 v[212:213], v[212:213], v[60:61]
    v_cvt_pk_bf16_f32 v106, v212, v213
    v_pk_fma_f32 v[214:215], v[46:47], v[74:75], v[214:215] op_sel:[0,1,0] op_sel_hi:[1,1,1]
    v_pk_mul_f32 v[214:215], v[214:215], v[62:63]
    v_cvt_pk_bf16_f32 v107, v214, v215
    v_pk_fma_f32 v[216:217], v[48:49], v[74:75], v[216:217] op_sel:[0,1,0] op_sel_hi:[1,1,1]
    v_pk_mul_f32 v[216:217], v[216:217], v[64:65]
    v_cvt_pk_bf16_f32 v108, v216, v217
    v_pk_fma_f32 v[218:219], v[50:51], v[74:75], v[218:219] op_sel:[0,1,0] op_sel_hi:[1,1,1]
    v_pk_mul_f32 v[218:219], v[218:219], v[66:67]
    v_cvt_pk_bf16_f32 v109, v218, v219
    v_pk_fma_f32 v[220:221], v[52:53], v[74:75], v[220:221] op_sel:[0,1,0] op_sel_hi:[1,1,1]
    v_pk_mul_f32 v[220:221], v[220:221], v[68:69]
    v_cvt_pk_bf16_f32 v110, v220, v221
    v_pk_fma_f32 v[222:223], v[54:55], v[74:75], v[222:223] op_sel:[0,1,0] op_sel_hi:[1,1,1]
    v_pk_mul_f32 v[222:223], v[222:223], v[70:71]
    v_cvt_pk_bf16_f32 v111, v222, v223
    s_mul_i32 s86, s3, 3072
    s_add_u32 s86, s86, 139264
    v_lshl_add_u32 v6, v0, 4, s86
    s_xor_b32 s86, s3, 1
    s_mul_i32 s86, s86, 3072
    s_add_u32 s86, s86, 139264
    v_lshl_add_u32 v7, v0, 4, s86
    s_cmp_eq_u32 s49, 1
    s_cbranch_scc1 L_kv1
    v_mfma_f32_16x16x32_bf16 v[172:175], v[80:83], v[104:107], 0
    v_mfma_f32_16x16x32_bf16 v[176:179], v[88:91], v[104:107], 0
    v_mfma_f32_16x16x32_bf16 v[180:183], v[88:91], v[120:123], 0
    v_mfma_f32_16x16x32_bf16 v[160:163], v[80:83], v[96:99], 0
    v_mfma_f32_16x16x32_bf16 v[164:167], v[88:91], v[96:99], 0
    v_mfma_f32_16x16x32_bf16 v[168:171], v[80:83], v[120:123], 0
    v_mfma_f32_16x16x32_bf16 v[172:175], v[84:87], v[108:111], v[172:175]
    v_mfma_f32_16x16x32_bf16 v[176:179], v[92:95], v[108:111], v[176:179]
    v_mfma_f32_16x16x32_bf16 v[180:183], v[92:95], v[120:123], v[180:183]
    v_mfma_f32_16x16x32_bf16 v[160:163], v[84:87], v[100:103], v[160:163]
    v_mfma_f32_16x16x32_bf16 v[164:167], v[92:95], v[100:103], v[164:167]
    v_mfma_f32_16x16x32_bf16 v[168:171], v[84:87], v[120:123], v[168:171]
    s_branch L_kvd
L_kv1:
    v_mfma_f32_16x16x32_bf16 v[172:175], v[80:83], v[96:99], 0
    v_mfma_f32_16x16x32_bf16 v[176:179], v[88:91], v[96:99], 0
    v_mfma_f32_16x16x32_bf16 v[180:183], v[80:83], v[120:123], 0
    v_mfma_f32_16x16x32_bf16 v[160:163], v[80:83], v[104:107], 0
    v_mfma_f32_16x16x32_bf16 v[164:167], v[88:91], v[104:107], 0
    v_mfma_f32_16x16x32_bf16 v[168:171], v[88:91], v[120:123], 0
    v_mfma_f32_16x16x32_bf16 v[172:175], v[84:87], v[100:103], v[172:175]
    v_mfma_f32_16x16x32_bf16 v[176:179], v[92:95], v[100:103], v[176:179]
    v_mfma_f32_16x16x32_bf16 v[180:183], v[84:87], v[120:123], v[180:183]
    v_mfma_f32_16x16x32_bf16 v[160:163], v[84:87], v[108:111], v[160:163]
    v_mfma_f32_16x16x32_bf16 v[164:167], v[92:95], v[108:111], v[164:167]
    v_mfma_f32_16x16x32_bf16 v[168:171], v[92:95], v[120:123], v[168:171]
L_kvd:
    s_lshl_b32 s86, s47, 1
    s_add_u32 s86, s86, s50
    s_lshl_b32 s87, s86, 1
    s_add_u32 s87, s87, s49
    s_lshl_b32 s87, s87, 4
    s_add_u32 s87, s87, s46
    s_lshl_b32 s87, s87, 10
    s_add_u32 s87, s87, 5242880
    v_lshl_add_u32 v8, v0, 4, s87
    s_lshl_b32 s87, s86, 4
    s_add_u32 s87, s87, s46
    s_lshl_b32 s87, s87, 7
    s_lshl_b32 s88, s49, 6
    s_add_u32 s87, s87, s88
    s_add_u32 s87, s87, 7307264
    v_lshl_add_u32 v9, v21, 4, s87
    v_cmp_eq_u32 vcc, 0, v22
    v_mov_b32 v10, 2147483648
    s_nop 0
    v_cndmask_b32 v9, v10, v9, vcc
    ds_write_b128 v6, v[172:175] offset:0
    ds_write_b128 v6, v[176:179] offset:1024
    ds_write_b128 v6, v[180:183] offset:2048
    ds_write_b32 v12, v12 offset:16
    s_lshl_b32 s87, s46, 3
    s_lshl_b32 s88, s49, 2
    s_add_u32 s87, s87, s88
    s_lshl_b32 s87, s87, 5
    s_add_u32 s87, s87, s86
    s_lshl_b32 s87, s87, 10
    s_add_u32 s87, s87, 1048576
    v_lshl_add_u32 v10, v0, 4, s87
    s_mul_i32 s87, s50, 3072
    s_add_u32 s87, s87, 151552
    v_lshl_add_u32 v11, v0, 4, s87
L_xkv:
    ds_read_b32 v14, v13 offset:16
    ds_read_b128 v[172:175], v7 offset:0
    ds_read_b128 v[176:179], v7 offset:1024
    ds_read_b128 v[180:183], v7 offset:2048
    s_waitcnt lgkmcnt(0)
    v_cmp_eq_u32 vcc, 0, v14
    s_cbranch_vccz L_ok_2
    s_sub_u32 s56, s56, 1
    s_cbranch_scc0 L_xkv
    s_mov_b32 s56, 0
L_ok_2:
    v_pk_add_f32 v[160:161], v[160:161], v[172:173]
    v_pk_add_f32 v[162:163], v[162:163], v[174:175]
    v_pk_add_f32 v[164:165], v[164:165], v[176:177]
    v_pk_add_f32 v[166:167], v[166:167], v[178:179]
    v_pk_add_f32 v[168:169], v[168:169], v[180:181]
    v_pk_add_f32 v[170:171], v[170:171], v[182:183]
    v_cvt_pk_bf16_f32 v184, v160, v161
    v_cvt_pk_bf16_f32 v185, v162, v163
    v_cvt_pk_bf16_f32 v186, v164, v165
    v_cvt_pk_bf16_f32 v187, v166, v167
    buffer_store_dwordx4 v[184:187], v8, s[16:19], 0 offen sc1
    buffer_store_dwordx4 v[168:171], v9, s[16:19], 0 offen sc1
    v_pk_fma_f32 v[128:129], v[28:29], v[240:241], v[128:129] op_sel_hi:[1,0,1]
    v_pk_mul_f32 v[112:113], v[128:129], v[248:249] op_sel_hi:[1,0]
    v_pk_fma_f32 v[128:129], v[128:129], v[244:245], s[54:55] op_sel_hi:[1,0,1]
    v_exp_f32 v112, v112 clamp
    v_exp_f32 v113, v113 clamp
    v_max_f32 v128, s54, v128
    v_max_f32 v129, s54, v129
    v_pk_add_f32 v[128:129], v[128:129], v[112:113]
    v_cvt_pk_bf16_f32 v192, v128, v129
    v_pk_fma_f32 v[130:131], v[30:31], v[240:241], v[130:131] op_sel_hi:[1,0,1]
    v_pk_mul_f32 v[114:115], v[130:131], v[248:249] op_sel_hi:[1,0]
    v_pk_fma_f32 v[130:131], v[130:131], v[244:245], s[54:55] op_sel_hi:[1,0,1]
    v_exp_f32 v114, v114 clamp
    v_exp_f32 v115, v115 clamp
    v_max_f32 v130, s54, v130
    v_max_f32 v131, s54, v131
    v_pk_add_f32 v[130:131], v[130:131], v[114:115]
    v_cvt_pk_bf16_f32 v193, v130, v131
    v_pk_fma_f32 v[144:145], v[32:33], v[240:241], v[144:145] op_sel_hi:[1,0,1]
    v_pk_mul_f32 v[116:117], v[144:145], v[248:249] op_sel_hi:[1,0]
    v_pk_fma_f32 v[144:145], v[144:145], v[244:245], s[54:55] op_sel_hi:[1,0,1]
    v_exp_f32 v116, v116 clamp
    v_exp_f32 v117, v117 clamp
    v_max_f32 v144, s54, v144
    v_max_f32 v145, s54, v145
    v_pk_add_f32 v[144:145], v[144:145], v[116:117]
    v_cvt_pk_bf16_f32 v194, v144, v145
    v_pk_fma_f32 v[146:147], v[34:35], v[240:241], v[146:147] op_sel_hi:[1,0,1]
    v_pk_mul_f32 v[118:119], v[146:147], v[248:249] op_sel_hi:[1,0]
    v_pk_fma_f32 v[146:147], v[146:147], v[244:245], s[54:55] op_sel_hi:[1,0,1]
    v_exp_f32 v118, v118 clamp
    v_exp_f32 v119, v119 clamp
    v_max_f32 v146, s54, v146
    v_max_f32 v147, s54, v147
    v_pk_add_f32 v[146:147], v[146:147], v[118:119]
    v_cvt_pk_bf16_f32 v195, v146, v147
    v_pk_fma_f32 v[132:133], v[28:29], v[240:241], v[132:133] op_sel:[0,1,0] op_sel_hi:[1,1,1]
    v_pk_mul_f32 v[112:113], v[132:133], v[248:249] op_sel:[0,1] op_sel_hi:[1,1]
    v_pk_fma_f32 v[132:133], v[132:133], v[244:245], s[54:55] op_sel:[0,1,0] op_sel_hi:[1,1,1]
    v_exp_f32 v112, v112 clamp
    v_exp_f32 v113, v113 clamp
    v_max_f32 v132, s54, v132
    v_max_f32 v133, s54, v133
    v_pk_add_f32 v[132:133], v[132:133], v[112:113]
    v_cvt_pk_bf16_f32 v196, v132, v133
    v_pk_fma_f32 v[134:135], v[30:31], v[240:241], v[134:135] op_sel:[0,1,0] op_sel_hi:[1,1,1]
    v_pk_mul_f32 v[114:115], v[134:135], v[248:249] op_sel:[0,1] op_sel_hi:[1,1]
    v_pk_fma_f32 v[134:135], v[134:135], v[244:245], s[54:55] op_sel:[0,1,0] op_sel_hi:[1,1,1]
    v_exp_f32 v114, v114 clamp
    v_exp_f32 v115, v115 clamp
    v_max_f32 v134, s54, v134
    v_max_f32 v135, s54, v135
    v_pk_add_f32 v[134:135], v[134:135], v[114:115]
    v_cvt_pk_bf16_f32 v197, v134, v135
    v_pk_fma_f32 v[148:149], v[32:33], v[240:241], v[148:149] op_sel:[0,1,0] op_sel_hi:[1,1,1]
    v_pk_mul_f32 v[116:117], v[148:149], v[248:249] op_sel:[0,1] op_sel_hi:[1,1]
    v_pk_fma_f32 v[148:149], v[148:149], v[244:245], s[54:55] op_sel:[0,1,0] op_sel_hi:[1,1,1]
    v_exp_f32 v116, v116 clamp
    v_exp_f32 v117, v117 clamp
    v_max_f32 v148, s54, v148
    v_max_f32 v149, s54, v149
    v_pk_add_f32 v[148:149], v[148:149], v[116:117]
    v_cvt_pk_bf16_f32 v198, v148, v149
    v_pk_fma_f32 v[150:151], v[34:35], v[240:241], v[150:151] op_sel:[0,1,0] op_sel_hi:[1,1,1]
    v_pk_mul_f32 v[118:119], v[150:151], v[248:249] op_sel:[0,1] op_sel_hi:[1,1]
    v_pk_fma_f32 v[150:151], v[150:151], v[244:245], s[54:55] op_sel:[0,1,0] op_sel_hi:[1,1,1]
    v_exp_f32 v118, v118 clamp
    v_exp_f32 v119, v119 clamp
    v_max_f32 v150, s54, v150
    v_max_f32 v151, s54, v151
    v_pk_add_f32 v[150:151], v[150:151], v[118:119]
    v_cvt_pk_bf16_f32 v199, v150, v151
    v_pk_fma_f32 v[136:137], v[28:29], v[242:243], v[136:137] op_sel_hi:[1,0,1]
    v_pk_mul_f32 v[112:113], v[136:137], v[250:251] op_sel_hi:[1,0]
    v_pk_fma_f32 v[136:137], v[136:137], v[246:247], s[54:55] op_sel_hi:[1,0,1]
    v_exp_f32 v112, v112 clamp
    v_exp_f32 v113, v113 clamp
    v_max_f32 v136, s54, v136
    v_max_f32 v137, s54, v137
    v_pk_add_f32 v[136:137], v[136:137], v[112:113]
    v_cvt_pk_bf16_f32 v200, v136, v137
    v_pk_fma_f32 v[138:139], v[30:31], v[242:243], v[138:139] op_sel_hi:[1,0,1]
    v_pk_mul_f32 v[114:115], v[138:139], v[250:251] op_sel_hi:[1,0]
    v_pk_fma_f32 v[138:139], v[138:139], v[246:247], s[54:55] op_sel_hi:[1,0,1]
    v_exp_f32 v114, v114 clamp
    v_exp_f32 v115, v115 clamp
    v_max_f32 v138, s54, v138
    v_max_f32 v139, s54, v139
    v_pk_add_f32 v[138:139], v[138:139], v[114:115]
    v_cvt_pk_bf16_f32 v201, v138, v139
    v_pk_fma_f32 v[152:153], v[32:33], v[242:243], v[152:153] op_sel_hi:[1,0,1]
    v_pk_mul_f32 v[116:117], v[152:153], v[250:251] op_sel_hi:[1,0]
    v_pk_fma_f32 v[152:153], v[152:153], v[246:247], s[54:55] op_sel_hi:[1,0,1]
    v_exp_f32 v116, v116 clamp
    v_exp_f32 v117, v117 clamp
    v_max_f32 v152, s54, v152
    v_max_f32 v153, s54, v153
    v_pk_add_f32 v[152:153], v[152:153], v[116:117]
    v_cvt_pk_bf16_f32 v202, v152, v153
    v_pk_fma_f32 v[154:155], v[34:35], v[242:243], v[154:155] op_sel_hi:[1,0,1]
    v_pk_mul_f32 v[118:119], v[154:155], v[250:251] op_sel_hi:[1,0]
    v_pk_fma_f32 v[154:155], v[154:155], v[246:247], s[54:55] op_sel_hi:[1,0,1]
    v_exp_f32 v118, v118 clamp
    v_exp_f32 v119, v119 clamp
    v_max_f32 v154, s54, v154
    v_max_f32 v155, s54, v155
    v_pk_add_f32 v[154:155], v[154:155], v[118:119]
    v_cvt_pk_bf16_f32 v203, v154, v155
    v_pk_fma_f32 v[140:141], v[28:29], v[242:243], v[140:141] op_sel:[0,1,0] op_sel_hi:[1,1,1]
    v_pk_mul_f32 v[112:113], v[140:141], v[250:251] op_sel:[0,1] op_sel_hi:[1,1]
    v_pk_fma_f32 v[140:141], v[140:141], v[246:247], s[54:55] op_sel:[0,1,0] op_sel_hi:[1,1,1]
    v_exp_f32 v112, v112 clamp
    v_exp_f32 v113, v113 clamp
    v_max_f32 v140, s54, v140
    v_max_f32 v141, s54, v141
    v_pk_add_f32 v[140:141], v[140:141], v[112:113]
    v_cvt_pk_bf16_f32 v204, v140, v141
    v_pk_fma_f32 v[142:143], v[30:31], v[242:243], v[142:143] op_sel:[0,1,0] op_sel_hi:[1,1,1]
    v_pk_mul_f32 v[114:115], v[142:143], v[250:251] op_sel:[0,1] op_sel_hi:[1,1]
    v_pk_fma_f32 v[142:143], v[142:143], v[246:247], s[54:55] op_sel:[0,1,0] op_sel_hi:[1,1,1]
    v_exp_f32 v114, v114 clamp
    v_exp_f32 v115, v115 clamp
    v_max_f32 v142, s54, v142
    v_max_f32 v143, s54, v143
    v_pk_add_f32 v[142:143], v[142:143], v[114:115]
    v_cvt_pk_bf16_f32 v205, v142, v143
    v_pk_fma_f32 v[156:157], v[32:33], v[242:243], v[156:157] op_sel:[0,1,0] op_sel_hi:[1,1,1]
    v_pk_mul_f32 v[116:117], v[156:157], v[250:251] op_sel:[0,1] op_sel_hi:[1,1]
    v_pk_fma_f32 v[156:157], v[156:157], v[246:247], s[54:55] op_sel:[0,1,0] op_sel_hi:[1,1,1]
    v_exp_f32 v116, v116 clamp
    v_exp_f32 v117, v117 clamp
    v_max_f32 v156, s54, v156
    v_max_f32 v157, s54, v157
    v_pk_add_f32 v[156:157], v[156:157], v[116:117]
    v_cvt_pk_bf16_f32 v206, v156, v157
    v_pk_fma_f32 v[158:159], v[34:35], v[242:243], v[158:159] op_sel:[0,1,0] op_sel_hi:[1,1,1]
    v_pk_mul_f32 v[118:119], v[158:159], v[250:251] op_sel:[0,1] op_sel_hi:[1,1]
    v_pk_fma_f32 v[158:159], v[158:159], v[246:247], s[54:55] op_sel:[0,1,0] op_sel_hi:[1,1,1]
    v_exp_f32 v118, v118 clamp
    v_exp_f32 v119, v119 clamp
    v_max_f32 v158, s54, v158
    v_max_f32 v159, s54, v159
    v_pk_add_f32 v[158:159], v[158:159], v[118:119]
    v_cvt_pk_bf16_f32 v207, v158, v159
    s_lshr_b32 s62, s3, 2
    s_lshl_b32 s53, s51, 3
    s_lshl_b32 s86, s48, 1
    s_add_u32 s53, s53, s86
    s_add_u32 s53, s53, s62
    v_lshrrev_b32 v36, 4, v0
    v_and_b32 v37, 15, v0
    v_lshlrev_b32 v38, 4, v0
    buffer_load_dwordx4 v[136:139], v38, s[40:43], 0 offen
    buffer_load_dwordx4 v[140:143], v38, s[40:43], 0 offen offset:1024
    s_lshl_b32 s86, s52, 7
    v_lshl_add_u32 v39, v36, 3, s86
    buffer_load_dwordx2 v[148:149], v39, s[40:43], 0 offen offset:0
    buffer_load_dwordx2 v[150:151], v39, s[40:43], 0 offen offset:32
    buffer_load_dwordx2 v[152:153], v39, s[40:43], 0 offen offset:64
    buffer_load_dwordx2 v[154:155], v39, s[40:43], 0 offen offset:96
    s_lshl_b32 s87, s53, 15
    v_lshl_add_u32 v38, v37, 11, s87
    v_add_u32 v38, v38, v39
    buffer_load_dwordx2 v[128:129], v38, s[8:11], 0 offen offset:0
    buffer_load_dwordx2 v[130:131], v38, s[8:11], 0 offen offset:32
    buffer_load_dwordx2 v[132:133], v38, s[8:11], 0 offen offset:64
    buffer_load_dwordx2 v[134:135], v38, s[8:11], 0 offen offset:96
    s_lshl_b32 s86, s62, 14
    s_add_u32 s86, s86, s87
    s_add_u32 s86, s86, 1048576
    v_lshl_add_u32 v157, v0, 4, s86
    v_xor_b32 v158, 0x8000, v157
    s_and_b32 s86, s86, 0xffff7fff
    s_add_u32 s86, s86, 1020
    v_lshl_add_u32 v159, v37, 10, s86
    v_and_b32 v39, 1, v36
    v_lshl_add_u32 v159, v39, 15, v159
    v_bfe_u32 v38, v0, 2, 2
    v_lshl_add_u32 v38, v36, 2, v38
    v_bfe_u32 v39, v38, 1, 2
    v_lshlrev_b32 v38, 7, v38
    v_lshl_add_u32 v38, v39, 5, v38
    v_and_b32 v39, 3, v0
    v_lshl_add_u32 v38, v39, 3, v38
    s_lshl_b32 s86, s62, 16
    s_add_u32 s86, s86, 0
    v_add_u32 v144, s86, v38
    v_xor_b32 v145, 32, v144
    v_xor_b32 v146, 64, v144
    v_xor_b32 v147, 96, v144
    v_cmp_eq_u32 s[4:5], 1, v39
    v_cmp_eq_u32 s[6:7], 2, v39
    v_cmp_eq_u32 s[98:99], 3, v39
    s_lshl_b32 s86, s53, 12
    s_add_u32 s86, s86, 6291456
    v_lshl_add_u32 v160, v0, 4, s86
    s_lshl_b32 s87, s52, 8
    s_add_u32 s86, s86, s87
    v_lshl_add_u32 v161, v37, 4, s86
    v_lshrrev_b32 v38, 2, v37
    v_cmp_eq_u32 vcc, v38, v36
    v_mov_b32 v38, 2147483648
    s_nop 0
    v_cndmask_b32 v161, v38, v161, vcc
    s_lshl_b32 s86, s3, 12
    s_add_u32 s86, s86, 131072
    v_lshl_add_u32 v162, v0, 4, s86
    v_xor_b32 v163, 0x4000, v162
    v_cmp_eq_u32 vcc, 0, v39
    v_mov_b32 v39, s95
    s_nop 0
    v_cndmask_b32 v39, 0, v39, vcc
    v_mov_b32 v38, 0
    s_waitcnt vmcnt(4)
    v_dot2c_f32_bf16 v38, s95, v136
    v_dot2c_f32_bf16 v38, s95, v137
    v_dot2c_f32_bf16 v38, s95, v138
    v_dot2c_f32_bf16 v38, s95, v139
    v_dot2c_f32_bf16 v38, s95, v140
    v_dot2c_f32_bf16 v38, s95, v141
    v_dot2c_f32_bf16 v38, s95, v142
    v_dot2c_f32_bf16 v38, s95, v143
    v_cndmask_b32 v148, v39, v148, s[4:5]
    v_cndmask_b32 v149, v39, v149, s[4:5]
    v_cndmask_b32 v150, v39, v150, s[4:5]
    v_cndmask_b32 v151, v39, v151, s[4:5]
    v_cndmask_b32 v152, v39, v152, s[4:5]
    v_cndmask_b32 v153, v39, v153, s[4:5]
    v_cndmask_b32 v154, v39, v154, s[4:5]
    v_cndmask_b32 v155, v39, v155, s[4:5]
    v_add_f32_dpp v38, v38, v38 row_ror:8 row_mask:0xf bank_mask:0xf
    s_nop 1
    v_add_f32_dpp v38, v38, v38 row_ror:4 row_mask:0xf bank_mask:0xf
    s_nop 1
    v_add_f32_dpp v38, v38, v38 row_ror:2 row_mask:0xf bank_mask:0xf
    s_nop 1
    v_add_f32_dpp v38, v38, v38 row_ror:1 row_mask:0xf bank_mask:0xf
    v_mov_b32 v39, v38
    s_nop 1
    v_permlane32_swap_b32 v38, v39
    v_add_f32 v38, v38, v39
    v_mov_b32 v39, v38
    s_nop 1
    v_permlane16_swap_b32 v38, v39
    v_add_f32 v38, v38, v39
    s_nop 0
    v_readfirstlane_b32 s57, v38
    s_barrier
    ds_read_b128 v[40:43], v11 offset:0
    ds_read_b128 v[44:47], v11 offset:1024
    ds_read_b128 v[48:51], v11 offset:2048
    s_mov_b32 s86, 0x8000
    s_mov_b32 s87, 0x10000
    s_mov_b32 s88, 0x18000
    s_waitcnt lgkmcnt(0)
    s_barrier
    v_mfma_f32_16x16x32_bf16 v[216:219], v[48:51], v[192:195], 0
    v_mfma_f32_16x16x32_bf16 v[208:211], v[40:43], v[192:195], 0
    v_mfma_f32_16x16x32_bf16 v[212:215], v[44:47], v[192:195], 0
    v_mfma_f32_16x16x32_bf16 v[228:231], v[48:51], v[196:199], 0
    v_mfma_f32_16x16x32_bf16 v[220:223], v[40:43], v[196:199], 0
    v_mfma_f32_16x16x32_bf16 v[224:227], v[44:47], v[196:199], 0
    v_mfma_f32_16x16x32_bf16 v[240:243], v[48:51], v[200:203], 0
    v_mfma_f32_16x16x32_bf16 v[232:235], v[40:43], v[200:203], 0
    v_mfma_f32_16x16x32_bf16 v[236:239], v[44:47], v[200:203], 0
    v_mfma_f32_16x16x32_bf16 v[252:255], v[48:51], v[204:207], 0
    v_mfma_f32_16x16x32_bf16 v[244:247], v[40:43], v[204:207], 0
    v_mfma_f32_16x16x32_bf16 v[248:251], v[44:47], v[204:207], 0
    v_add_f32 v216, s54, v216
    v_rcp_f32 v216, v216
    s_nop 0
    v_pk_mul_f32 v[208:209], v[208:209], v[216:217] op_sel_hi:[1,0]
    v_pk_mul_f32 v[210:211], v[210:211], v[216:217] op_sel_hi:[1,0]
    v_pk_mul_f32 v[212:213], v[212:213], v[216:217] op_sel_hi:[1,0]
    v_pk_mul_f32 v[214:215], v[214:215], v[216:217] op_sel_hi:[1,0]
    v_cvt_pk_bf16_f32 v60, v208, v209
    v_cvt_pk_bf16_f32 v61, v210, v211
    v_cvt_pk_bf16_f32 v62, v212, v213
    v_cvt_pk_bf16_f32 v63, v214, v215
    buffer_store_dwordx4 v[60:63], v10, s[16:19], 0 offen sc1
    v_add_f32 v228, s54, v228
    v_rcp_f32 v228, v228
    s_nop 0
    v_pk_mul_f32 v[220:221], v[220:221], v[228:229] op_sel_hi:[1,0]
    v_pk_mul_f32 v[222:223], v[222:223], v[228:229] op_sel_hi:[1,0]
    v_pk_mul_f32 v[224:225], v[224:225], v[228:229] op_sel_hi:[1,0]
    v_pk_mul_f32 v[226:227], v[226:227], v[228:229] op_sel_hi:[1,0]
    v_cvt_pk_bf16_f32 v64, v220, v221
    v_cvt_pk_bf16_f32 v65, v222, v223
    v_cvt_pk_bf16_f32 v66, v224, v225
    v_cvt_pk_bf16_f32 v67, v226, v227
    buffer_store_dwordx4 v[64:67], v10, s[16:19], s86 offen sc1
    v_add_f32 v240, s54, v240
    v_rcp_f32 v240, v240
    s_nop 0
    v_pk_mul_f32 v[232:233], v[232:233], v[240:241] op_sel_hi:[1,0]
    v_pk_mul_f32 v[234:235], v[234:235], v[240:241] op_sel_hi:[1,0]
    v_pk_mul_f32 v[236:237], v[236:237], v[240:241] op_sel_hi:[1,0]
    v_pk_mul_f32 v[238:239], v[238:239], v[240:241] op_sel_hi:[1,0]
    v_cvt_pk_bf16_f32 v68, v232, v233
    v_cvt_pk_bf16_f32 v69, v234, v235
    v_cvt_pk_bf16_f32 v70, v236, v237
    v_cvt_pk_bf16_f32 v71, v238, v239
    buffer_store_dwordx4 v[68:71], v10, s[16:19], s87 offen sc1
    v_add_f32 v252, s54, v252
    v_rcp_f32 v252, v252
    s_nop 0
    v_pk_mul_f32 v[244:245], v[244:245], v[252:253] op_sel_hi:[1,0]
    v_pk_mul_f32 v[246:247], v[246:247], v[252:253] op_sel_hi:[1,0]
    v_pk_mul_f32 v[248:249], v[248:249], v[252:253] op_sel_hi:[1,0]
    v_pk_mul_f32 v[250:251], v[250:251], v[252:253] op_sel_hi:[1,0]
    v_cvt_pk_bf16_f32 v72, v244, v245
    v_cvt_pk_bf16_f32 v73, v246, v247
    v_cvt_pk_bf16_f32 v74, v248, v249
    v_cvt_pk_bf16_f32 v75, v250, v251
    buffer_store_dwordx4 v[72:75], v10, s[16:19], s88 offen sc1
    v_mov_b32 v14, 2147483648
    v_mov_b32 v11, 2147483648
L_phaseB:
    buffer_load_dword v8, v159, s[16:19], 0 offen sc1
    v_lshrrev_b32 v1, 4, v0
    v_and_b32 v2, 15, v0
    s_lshl_b32 s87, s53, 4
    v_add_u32 v6, s87, v2
    s_lshl_b32 s86, s52, 7
    v_lshl_add_u32 v5, v6, 11, s86
    v_sub_u32 v6, 2047, v6
    v_lshl_add_u32 v7, v1, 3, v5
    v_lshrrev_b32 v9, 1, v1
    v_lshl_add_u32 v5, v9, 4, v5
    v_and_b32 v9, 1, v1
    v_lshl_add_u32 v5, v9, 5, v5
L_b_init:
    v_lshlrev_b32 v80, 16, v128
    v_and_b32 v81, 0xffff0000, v128
    v_lshlrev_b32 v82, 16, v129
    v_and_b32 v83, 0xffff0000, v129
    v_lshlrev_b32 v84, 16, v130
    v_and_b32 v85, 0xffff0000, v130
    v_lshlrev_b32 v86, 16, v131
    v_and_b32 v87, 0xffff0000, v131
    v_lshlrev_b32 v88, 16, v132
    v_and_b32 v89, 0xffff0000, v132
    v_lshlrev_b32 v90, 16, v133
    v_and_b32 v91, 0xffff0000, v133
    v_lshlrev_b32 v92, 16, v134
    v_and_b32 v93, 0xffff0000, v134
    v_lshlrev_b32 v94, 16, v135
    v_and_b32 v95, 0xffff0000, v135
    v_mov_b32 v96, 0
    v_mov_b32 v97, 0
    v_mov_b32 v98, 0
    v_mov_b32 v99, 0
    v_mov_b32 v100, 0
    v_mov_b32 v101, 0
    v_mov_b32 v102, 0
    v_mov_b32 v103, 0
    v_mov_b32 v104, 0
    v_mov_b32 v105, 0
    v_mov_b32 v106, 0
    v_mov_b32 v107, 0
    v_mov_b32 v108, 0
    v_mov_b32 v109, 0
    v_mov_b32 v110, 0
    v_mov_b32 v111, 0
    v_mov_b32 v156, 0
    s_branch L_b_chk
L_b_restart:
    buffer_load_dwordx2 v[128:129], v7, s[8:11], 0 offen offset:0
    buffer_load_dwordx2 v[130:131], v7, s[8:11], 0 offen offset:32
    buffer_load_dwordx2 v[132:133], v7, s[8:11], 0 offen offset:64
    buffer_load_dwordx2 v[134:135], v7, s[8:11], 0 offen offset:96
    v_mov_b32 v8, -1
    s_waitcnt vmcnt(0)
    s_branch L_b_init
L_b_poll:
    buffer_load_dword v8, v159, s[16:19], 0 offen sc1
L_b_chk:
    s_waitcnt vmcnt(0)
    v_cmp_eq_u32 vcc, -1, v8
    s_cbranch_vccz L_ok_3
    s_sub_u32 s56, s56, 1
    s_cbranch_scc0 L_b_poll
    s_mov_b32 s56, 0
L_ok_3:
    buffer_load_dwordx4 v[16:19], v157, s[16:19], 0 offen offset:0 sc1
    buffer_load_dwordx4 v[20:23], v158, s[16:19], 0 offen offset:0 sc1
    buffer_load_dwordx4 v[24:27], v157, s[16:19], 0 offen offset:1024 sc1
    buffer_load_dwordx4 v[28:31], v158, s[16:19], 0 offen offset:1024 sc1
    buffer_load_dwordx4 v[32:35], v157, s[16:19], 0 offen offset:2048 sc1
    buffer_load_dwordx4 v[36:39], v158, s[16:19], 0 offen offset:2048 sc1
    buffer_load_dwordx4 v[40:43], v157, s[16:19], 0 offen offset:3072 sc1
    buffer_load_dwordx4 v[44:47], v158, s[16:19], 0 offen offset:3072 sc1
    buffer_load_dwordx4 v[48:51], v157, s[16:19], s92 offen offset:0 sc1
    buffer_load_dwordx4 v[52:55], v158, s[16:19], s92 offen offset:0 sc1
    buffer_load_dwordx4 v[56:59], v157, s[16:19], s92 offen offset:1024 sc1
    buffer_load_dwordx4 v[60:63], v158, s[16:19], s92 offen offset:1024 sc1
    buffer_load_dwordx4 v[64:67], v157, s[16:19], s92 offen offset:2048 sc1
    buffer_load_dwordx4 v[68:71], v158, s[16:19], s92 offen offset:2048 sc1
    buffer_load_dwordx4 v[72:75], v157, s[16:19], s92 offen offset:3072 sc1
    buffer_load_dwordx4 v[76:79], v158, s[16:19], s92 offen offset:3072 sc1
    ds_read_b64_tr_b16 v[112:113], v144 offset:0
    ds_read_b64_tr_b16 v[114:115], v144 offset:2048
    ds_read_b64_tr_b16 v[116:117], v145 offset:0
    ds_read_b64_tr_b16 v[118:119], v145 offset:2048
    ds_read_b64_tr_b16 v[120:121], v146 offset:0
    ds_read_b64_tr_b16 v[122:123], v146 offset:2048
    ds_read_b64_tr_b16 v[124:125], v147 offset:0
    ds_read_b64_tr_b16 v[126:127], v147 offset:2048
    s_waitcnt vmcnt(14) lgkmcnt(0)
    v_max3_u32 v156, v156, v19, v23
    v_mfma_f32_16x16x32_bf16 v[80:83], v[112:115], v[16:19], v[80:83]
    ds_read_b64_tr_b16 v[128:129], v144 offset:4096
    v_mfma_f32_16x16x32_bf16 v[96:99], v[112:115], v[20:23], v[96:99]
    ds_read_b64_tr_b16 v[130:131], v144 offset:6144
    v_mfma_f32_16x16x32_bf16 v[84:87], v[116:119], v[16:19], v[84:87]
    ds_read_b64_tr_b16 v[132:133], v145 offset:4096
    v_mfma_f32_16x16x32_bf16 v[100:103], v[116:119], v[20:23], v[100:103]
    ds_read_b64_tr_b16 v[134:135], v145 offset:6144
    v_mfma_f32_16x16x32_bf16 v[88:91], v[120:123], v[16:19], v[88:91]
    ds_read_b64_tr_b16 v[136:137], v146 offset:4096
    v_mfma_f32_16x16x32_bf16 v[104:107], v[120:123], v[20:23], v[104:107]
    ds_read_b64_tr_b16 v[138:139], v146 offset:6144
    v_mfma_f32_16x16x32_bf16 v[92:95], v[124:127], v[16:19], v[92:95]
    ds_read_b64_tr_b16 v[140:141], v147 offset:4096
    v_mfma_f32_16x16x32_bf16 v[108:111], v[124:127], v[20:23], v[108:111]
    ds_read_b64_tr_b16 v[142:143], v147 offset:6144
    buffer_load_dwordx4 v[16:19], v157, s[16:19], s93 offen offset:0 sc1
    buffer_load_dwordx4 v[20:23], v158, s[16:19], s93 offen offset:0 sc1
    s_waitcnt vmcnt(14) lgkmcnt(0)
    v_max3_u32 v156, v156, v27, v31
    v_mfma_f32_16x16x32_bf16 v[80:83], v[128:131], v[24:27], v[80:83]
    ds_read_b64_tr_b16 v[112:113], v144 offset:8192
    v_mfma_f32_16x16x32_bf16 v[96:99], v[128:131], v[28:31], v[96:99]
    ds_read_b64_tr_b16 v[114:115], v144 offset:10240
    v_mfma_f32_16x16x32_bf16 v[84:87], v[132:135], v[24:27], v[84:87]
    ds_read_b64_tr_b16 v[116:117], v145 offset:8192
    v_mfma_f32_16x16x32_bf16 v[100:103], v[132:135], v[28:31], v[100:103]
    ds_read_b64_tr_b16 v[118:119], v145 offset:10240
    v_mfma_f32_16x16x32_bf16 v[88:91], v[136:139], v[24:27], v[88:91]
    ds_read_b64_tr_b16 v[120:121], v146 offset:8192
    v_mfma_f32_16x16x32_bf16 v[104:107], v[136:139], v[28:31], v[104:107]
    ds_read_b64_tr_b16 v[122:123], v146 offset:10240
    v_mfma_f32_16x16x32_bf16 v[92:95], v[140:143], v[24:27], v[92:95]
    ds_read_b64_tr_b16 v[124:125], v147 offset:8192
    v_mfma_f32_16x16x32_bf16 v[108:111], v[140:143], v[28:31], v[108:111]
    ds_read_b64_tr_b16 v[126:127], v147 offset:10240
    buffer_load_dwordx4 v[24:27], v157, s[16:19], s93 offen offset:1024 sc1
    buffer_load_dwordx4 v[28:31], v158, s[16:19], s93 offen offset:1024 sc1
    s_waitcnt vmcnt(14) lgkmcnt(0)
    v_max3_u32 v156, v156, v35, v39
    v_mfma_f32_16x16x32_bf16 v[80:83], v[112:115], v[32:35], v[80:83]
    ds_read_b64_tr_b16 v[128:129], v144 offset:12288
    v_mfma_f32_16x16x32_bf16 v[96:99], v[112:115], v[36:39], v[96:99]
    ds_read_b64_tr_b16 v[130:131], v144 offset:14336
    v_mfma_f32_16x16x32_bf16 v[84:87], v[116:119], v[32:35], v[84:87]
    ds_read_b64_tr_b16 v[132:133], v145 offset:12288
    v_mfma_f32_16x16x32_bf16 v[100:103], v[116:119], v[36:39], v[100:103]
    ds_read_b64_tr_b16 v[134:135], v145 offset:14336
    v_mfma_f32_16x16x32_bf16 v[88:91], v[120:123], v[32:35], v[88:91]
    ds_read_b64_tr_b16 v[136:137], v146 offset:12288
    v_mfma_f32_16x16x32_bf16 v[104:107], v[120:123], v[36:39], v[104:107]
    ds_read_b64_tr_b16 v[138:139], v146 offset:14336
    v_mfma_f32_16x16x32_bf16 v[92:95], v[124:127], v[32:35], v[92:95]
    ds_read_b64_tr_b16 v[140:141], v147 offset:12288
    v_mfma_f32_16x16x32_bf16 v[108:111], v[124:127], v[36:39], v[108:111]
    ds_read_b64_tr_b16 v[142:143], v147 offset:14336
    buffer_load_dwordx4 v[32:35], v157, s[16:19], s93 offen offset:2048 sc1
    buffer_load_dwordx4 v[36:39], v158, s[16:19], s93 offen offset:2048 sc1
    s_waitcnt vmcnt(14) lgkmcnt(0)
    v_max3_u32 v156, v156, v43, v47
    v_mfma_f32_16x16x32_bf16 v[80:83], v[128:131], v[40:43], v[80:83]
    ds_read_b64_tr_b16 v[112:113], v144 offset:16384
    v_mfma_f32_16x16x32_bf16 v[96:99], v[128:131], v[44:47], v[96:99]
    ds_read_b64_tr_b16 v[114:115], v144 offset:18432
    v_mfma_f32_16x16x32_bf16 v[84:87], v[132:135], v[40:43], v[84:87]
    ds_read_b64_tr_b16 v[116:117], v145 offset:16384
    v_mfma_f32_16x16x32_bf16 v[100:103], v[132:135], v[44:47], v[100:103]
    ds_read_b64_tr_b16 v[118:119], v145 offset:18432
    v_mfma_f32_16x16x32_bf16 v[88:91], v[136:139], v[40:43], v[88:91]
    ds_read_b64_tr_b16 v[120:121], v146 offset:16384
    v_mfma_f32_16x16x32_bf16 v[104:107], v[136:139], v[44:47], v[104:107]
    ds_read_b64_tr_b16 v[122:123], v146 offset:18432
    v_mfma_f32_16x16x32_bf16 v[92:95], v[140:143], v[40:43], v[92:95]
    ds_read_b64_tr_b16 v[124:125], v147 offset:16384
    v_mfma_f32_16x16x32_bf16 v[108:111], v[140:143], v[44:47], v[108:111]
    ds_read_b64_tr_b16 v[126:127], v147 offset:18432
    buffer_load_dwordx4 v[40:43], v157, s[16:19], s93 offen offset:3072 sc1
    buffer_load_dwordx4 v[44:47], v158, s[16:19], s93 offen offset:3072 sc1
    s_waitcnt vmcnt(14) lgkmcnt(0)
    v_max3_u32 v156, v156, v51, v55
    v_mfma_f32_16x16x32_bf16 v[80:83], v[112:115], v[48:51], v[80:83]
    ds_read_b64_tr_b16 v[128:129], v144 offset:20480
    v_mfma_f32_16x16x32_bf16 v[96:99], v[112:115], v[52:55], v[96:99]
    ds_read_b64_tr_b16 v[130:131], v144 offset:22528
    v_mfma_f32_16x16x32_bf16 v[84:87], v[116:119], v[48:51], v[84:87]
    ds_read_b64_tr_b16 v[132:133], v145 offset:20480
    v_mfma_f32_16x16x32_bf16 v[100:103], v[116:119], v[52:55], v[100:103]
    ds_read_b64_tr_b16 v[134:135], v145 offset:22528
    v_mfma_f32_16x16x32_bf16 v[88:91], v[120:123], v[48:51], v[88:91]
    ds_read_b64_tr_b16 v[136:137], v146 offset:20480
    v_mfma_f32_16x16x32_bf16 v[104:107], v[120:123], v[52:55], v[104:107]
    ds_read_b64_tr_b16 v[138:139], v146 offset:22528
    v_mfma_f32_16x16x32_bf16 v[92:95], v[124:127], v[48:51], v[92:95]
    ds_read_b64_tr_b16 v[140:141], v147 offset:20480
    v_mfma_f32_16x16x32_bf16 v[108:111], v[124:127], v[52:55], v[108:111]
    ds_read_b64_tr_b16 v[142:143], v147 offset:22528
    buffer_load_dwordx4 v[48:51], v157, s[16:19], s94 offen offset:0 sc1
    buffer_load_dwordx4 v[52:55], v158, s[16:19], s94 offen offset:0 sc1
    s_waitcnt vmcnt(14) lgkmcnt(0)
    v_max3_u32 v156, v156, v59, v63
    v_mfma_f32_16x16x32_bf16 v[80:83], v[128:131], v[56:59], v[80:83]
    ds_read_b64_tr_b16 v[112:113], v144 offset:24576
    v_mfma_f32_16x16x32_bf16 v[96:99], v[128:131], v[60:63], v[96:99]
    ds_read_b64_tr_b16 v[114:115], v144 offset:26624
    v_mfma_f32_16x16x32_bf16 v[84:87], v[132:135], v[56:59], v[84:87]
    ds_read_b64_tr_b16 v[116:117], v145 offset:24576
    v_mfma_f32_16x16x32_bf16 v[100:103], v[132:135], v[60:63], v[100:103]
    ds_read_b64_tr_b16 v[118:119], v145 offset:26624
    v_mfma_f32_16x16x32_bf16 v[88:91], v[136:139], v[56:59], v[88:91]
    ds_read_b64_tr_b16 v[120:121], v146 offset:24576
    v_mfma_f32_16x16x32_bf16 v[104:107], v[136:139], v[60:63], v[104:107]
    ds_read_b64_tr_b16 v[122:123], v146 offset:26624
    v_mfma_f32_16x16x32_bf16 v[92:95], v[140:143], v[56:59], v[92:95]
    ds_read_b64_tr_b16 v[124:125], v147 offset:24576
    v_mfma_f32_16x16x32_bf16 v[108:111], v[140:143], v[60:63], v[108:111]
    ds_read_b64_tr_b16 v[126:127], v147 offset:26624
    buffer_load_dwordx4 v[56:59], v157, s[16:19], s94 offen offset:1024 sc1
    buffer_load_dwordx4 v[60:63], v158, s[16:19], s94 offen offset:1024 sc1
    s_waitcnt vmcnt(14) lgkmcnt(0)
    v_max3_u32 v156, v156, v67, v71
    v_mfma_f32_16x16x32_bf16 v[80:83], v[112:115], v[64:67], v[80:83]
    ds_read_b64_tr_b16 v[128:129], v144 offset:28672
    v_mfma_f32_16x16x32_bf16 v[96:99], v[112:115], v[68:71], v[96:99]
    ds_read_b64_tr_b16 v[130:131], v144 offset:30720
    v_mfma_f32_16x16x32_bf16 v[84:87], v[116:119], v[64:67], v[84:87]
    ds_read_b64_tr_b16 v[132:133], v145 offset:28672
    v_mfma_f32_16x16x32_bf16 v[100:103], v[116:119], v[68:71], v[100:103]
    ds_read_b64_tr_b16 v[134:135], v145 offset:30720
    v_mfma_f32_16x16x32_bf16 v[88:91], v[120:123], v[64:67], v[88:91]
    ds_read_b64_tr_b16 v[136:137], v146 offset:28672
    v_mfma_f32_16x16x32_bf16 v[104:107], v[120:123], v[68:71], v[104:107]
    ds_read_b64_tr_b16 v[138:139], v146 offset:30720
    v_mfma_f32_16x16x32_bf16 v[92:95], v[124:127], v[64:67], v[92:95]
    ds_read_b64_tr_b16 v[140:141], v147 offset:28672
    v_mfma_f32_16x16x32_bf16 v[108:111], v[124:127], v[68:71], v[108:111]
    ds_read_b64_tr_b16 v[142:143], v147 offset:30720
    buffer_load_dwordx4 v[64:67], v157, s[16:19], s94 offen offset:2048 sc1
    buffer_load_dwordx4 v[68:71], v158, s[16:19], s94 offen offset:2048 sc1
    s_waitcnt vmcnt(14) lgkmcnt(0)
    v_max3_u32 v156, v156, v75, v79
    v_mfma_f32_16x16x32_bf16 v[80:83], v[128:131], v[72:75], v[80:83]
    ds_read_b64_tr_b16 v[112:113], v144 offset:32768
    v_mfma_f32_16x16x32_bf16 v[96:99], v[128:131], v[76:79], v[96:99]
    ds_read_b64_tr_b16 v[114:115], v144 offset:34816
    v_mfma_f32_16x16x32_bf16 v[84:87], v[132:135], v[72:75], v[84:87]
    ds_read_b64_tr_b16 v[116:117], v145 offset:32768
    v_mfma_f32_16x16x32_bf16 v[100:103], v[132:135], v[76:79], v[100:103]
    ds_read_b64_tr_b16 v[118:119], v145 offset:34816
    v_mfma_f32_16x16x32_bf16 v[88:91], v[136:139], v[72:75], v[88:91]
    ds_read_b64_tr_b16 v[120:121], v146 offset:32768
    v_mfma_f32_16x16x32_bf16 v[104:107], v[136:139], v[76:79], v[104:107]
    ds_read_b64_tr_b16 v[122:123], v146 offset:34816
    v_mfma_f32_16x16x32_bf16 v[92:95], v[140:143], v[72:75], v[92:95]
    ds_read_b64_tr_b16 v[124:125], v147 offset:32768
    v_mfma_f32_16x16x32_bf16 v[108:111], v[140:143], v[76:79], v[108:111]
    ds_read_b64_tr_b16 v[126:127], v147 offset:34816
    buffer_load_dwordx4 v[72:75], v157, s[16:19], s94 offen offset:3072 sc1
    buffer_load_dwordx4 v[76:79], v158, s[16:19], s94 offen offset:3072 sc1
    s_waitcnt vmcnt(14) lgkmcnt(0)
    v_max3_u32 v156, v156, v19, v23
    v_mfma_f32_16x16x32_bf16 v[80:83], v[112:115], v[16:19], v[80:83]
    ds_read_b64_tr_b16 v[128:129], v144 offset:36864
    v_mfma_f32_16x16x32_bf16 v[96:99], v[112:115], v[20:23], v[96:99]
    ds_read_b64_tr_b16 v[130:131], v144 offset:38912
    s_mov_b32 s90, 57344
    buffer_load_dwordx4 v[196:199], v11, s[32:35], s90 offen
    v_mfma_f32_16x16x32_bf16 v[84:87], v[116:119], v[16:19], v[84:87]
    ds_read_b64_tr_b16 v[132:133], v145 offset:36864
    v_mfma_f32_16x16x32_bf16 v[100:103], v[116:119], v[20:23], v[100:103]
    ds_read_b64_tr_b16 v[134:135], v145 offset:38912
    v_mfma_f32_16x16x32_bf16 v[88:91], v[120:123], v[16:19], v[88:91]
    ds_read_b64_tr_b16 v[136:137], v146 offset:36864
    v_mfma_f32_16x16x32_bf16 v[104:107], v[120:123], v[20:23], v[104:107]
    ds_read_b64_tr_b16 v[138:139], v146 offset:38912
    v_mfma_f32_16x16x32_bf16 v[92:95], v[124:127], v[16:19], v[92:95]
    ds_read_b64_tr_b16 v[140:141], v147 offset:36864
    v_mfma_f32_16x16x32_bf16 v[108:111], v[124:127], v[20:23], v[108:111]
    ds_read_b64_tr_b16 v[142:143], v147 offset:38912
    s_waitcnt vmcnt(13) lgkmcnt(0)
    v_max3_u32 v156, v156, v27, v31
    v_mfma_f32_16x16x32_bf16 v[80:83], v[128:131], v[24:27], v[80:83]
    ds_read_b64_tr_b16 v[112:113], v144 offset:40960
    v_mfma_f32_16x16x32_bf16 v[96:99], v[128:131], v[28:31], v[96:99]
    ds_read_b64_tr_b16 v[114:115], v144 offset:43008
    s_mov_b32 s90, 64512
    buffer_load_dwordx4 v[200:203], v11, s[32:35], s90 offen
    v_mfma_f32_16x16x32_bf16 v[84:87], v[132:135], v[24:27], v[84:87]
    ds_read_b64_tr_b16 v[116:117], v145 offset:40960
    v_mfma_f32_16x16x32_bf16 v[100:103], v[132:135], v[28:31], v[100:103]
    ds_read_b64_tr_b16 v[118:119], v145 offset:43008
    v_mfma_f32_16x16x32_bf16 v[88:91], v[136:139], v[24:27], v[88:91]
    ds_read_b64_tr_b16 v[120:121], v146 offset:40960
    v_mfma_f32_16x16x32_bf16 v[104:107], v[136:139], v[28:31], v[104:107]
    ds_read_b64_tr_b16 v[122:123], v146 offset:43008
    v_mfma_f32_16x16x32_bf16 v[92:95], v[140:143], v[24:27], v[92:95]
    ds_read_b64_tr_b16 v[124:125], v147 offset:40960
    v_mfma_f32_16x16x32_bf16 v[108:111], v[140:143], v[28:31], v[108:111]
    ds_read_b64_tr_b16 v[126:127], v147 offset:43008
    s_waitcnt vmcnt(12) lgkmcnt(0)
    v_max3_u32 v156, v156, v35, v39
    v_mfma_f32_16x16x32_bf16 v[80:83], v[112:115], v[32:35], v[80:83]
    ds_read_b64_tr_b16 v[128:129], v144 offset:45056
    v_mfma_f32_16x16x32_bf16 v[96:99], v[112:115], v[36:39], v[96:99]
    ds_read_b64_tr_b16 v[130:131], v144 offset:47104
    s_mov_b32 s90, 71680
    buffer_load_dwordx4 v[204:207], v11, s[32:35], s90 offen
    v_mfma_f32_16x16x32_bf16 v[84:87], v[116:119], v[32:35], v[84:87]
    ds_read_b64_tr_b16 v[132:133], v145 offset:45056
    v_mfma_f32_16x16x32_bf16 v[100:103], v[116:119], v[36:39], v[100:103]
    ds_read_b64_tr_b16 v[134:135], v145 offset:47104
    v_mfma_f32_16x16x32_bf16 v[88:91], v[120:123], v[32:35], v[88:91]
    ds_read_b64_tr_b16 v[136:137], v146 offset:45056
    v_mfma_f32_16x16x32_bf16 v[104:107], v[120:123], v[36:39], v[104:107]
    ds_read_b64_tr_b16 v[138:139], v146 offset:47104
    v_mfma_f32_16x16x32_bf16 v[92:95], v[124:127], v[32:35], v[92:95]
    ds_read_b64_tr_b16 v[140:141], v147 offset:45056
    v_mfma_f32_16x16x32_bf16 v[108:111], v[124:127], v[36:39], v[108:111]
    ds_read_b64_tr_b16 v[142:143], v147 offset:47104
    s_waitcnt vmcnt(11) lgkmcnt(0)
    v_max3_u32 v156, v156, v43, v47
    v_mfma_f32_16x16x32_bf16 v[80:83], v[128:131], v[40:43], v[80:83]
    ds_read_b64_tr_b16 v[112:113], v144 offset:49152
    v_mfma_f32_16x16x32_bf16 v[96:99], v[128:131], v[44:47], v[96:99]
    ds_read_b64_tr_b16 v[114:115], v144 offset:51200
    s_mov_b32 s90, 78848
    buffer_load_dwordx4 v[208:211], v11, s[32:35], s90 offen
    v_mfma_f32_16x16x32_bf16 v[84:87], v[132:135], v[40:43], v[84:87]
    ds_read_b64_tr_b16 v[116:117], v145 offset:49152
    v_mfma_f32_16x16x32_bf16 v[100:103], v[132:135], v[44:47], v[100:103]
    ds_read_b64_tr_b16 v[118:119], v145 offset:51200
    v_mfma_f32_16x16x32_bf16 v[88:91], v[136:139], v[40:43], v[88:91]
    ds_read_b64_tr_b16 v[120:121], v146 offset:49152
    v_mfma_f32_16x16x32_bf16 v[104:107], v[136:139], v[44:47], v[104:107]
    ds_read_b64_tr_b16 v[122:123], v146 offset:51200
    v_mfma_f32_16x16x32_bf16 v[92:95], v[140:143], v[40:43], v[92:95]
    ds_read_b64_tr_b16 v[124:125], v147 offset:49152
    v_mfma_f32_16x16x32_bf16 v[108:111], v[140:143], v[44:47], v[108:111]
    ds_read_b64_tr_b16 v[126:127], v147 offset:51200
    s_waitcnt vmcnt(10) lgkmcnt(0)
    v_max3_u32 v156, v156, v51, v55
    v_mfma_f32_16x16x32_bf16 v[80:83], v[112:115], v[48:51], v[80:83]
    ds_read_b64_tr_b16 v[128:129], v144 offset:53248
    v_mfma_f32_16x16x32_bf16 v[96:99], v[112:115], v[52:55], v[96:99]
    ds_read_b64_tr_b16 v[130:131], v144 offset:55296
    s_mov_b32 s90, 86016
    buffer_load_dwordx4 v[212:215], v11, s[32:35], s90 offen
    v_mfma_f32_16x16x32_bf16 v[84:87], v[116:119], v[48:51], v[84:87]
    ds_read_b64_tr_b16 v[132:133], v145 offset:53248
    v_mfma_f32_16x16x32_bf16 v[100:103], v[116:119], v[52:55], v[100:103]
    ds_read_b64_tr_b16 v[134:135], v145 offset:55296
    v_mfma_f32_16x16x32_bf16 v[88:91], v[120:123], v[48:51], v[88:91]
    ds_read_b64_tr_b16 v[136:137], v146 offset:53248
    v_mfma_f32_16x16x32_bf16 v[104:107], v[120:123], v[52:55], v[104:107]
    ds_read_b64_tr_b16 v[138:139], v146 offset:55296
    v_mfma_f32_16x16x32_bf16 v[92:95], v[124:127], v[48:51], v[92:95]
    ds_read_b64_tr_b16 v[140:141], v147 offset:53248
    v_mfma_f32_16x16x32_bf16 v[108:111], v[124:127], v[52:55], v[108:111]
    ds_read_b64_tr_b16 v[142:143], v147 offset:55296
    s_waitcnt vmcnt(9) lgkmcnt(0)
    v_max3_u32 v156, v156, v59, v63
    v_mfma_f32_16x16x32_bf16 v[80:83], v[128:131], v[56:59], v[80:83]
    ds_read_b64_tr_b16 v[112:113], v144 offset:57344
    v_mfma_f32_16x16x32_bf16 v[96:99], v[128:131], v[60:63], v[96:99]
    ds_read_b64_tr_b16 v[114:115], v144 offset:59392
    s_mov_b32 s90, 93184
    buffer_load_dwordx4 v[216:219], v11, s[32:35], s90 offen
    v_mfma_f32_16x16x32_bf16 v[84:87], v[132:135], v[56:59], v[84:87]
    ds_read_b64_tr_b16 v[116:117], v145 offset:57344
    v_mfma_f32_16x16x32_bf16 v[100:103], v[132:135], v[60:63], v[100:103]
    ds_read_b64_tr_b16 v[118:119], v145 offset:59392
    v_mfma_f32_16x16x32_bf16 v[88:91], v[136:139], v[56:59], v[88:91]
    ds_read_b64_tr_b16 v[120:121], v146 offset:57344
    v_mfma_f32_16x16x32_bf16 v[104:107], v[136:139], v[60:63], v[104:107]
    ds_read_b64_tr_b16 v[122:123], v146 offset:59392
    v_mfma_f32_16x16x32_bf16 v[92:95], v[140:143], v[56:59], v[92:95]
    ds_read_b64_tr_b16 v[124:125], v147 offset:57344
    v_mfma_f32_16x16x32_bf16 v[108:111], v[140:143], v[60:63], v[108:111]
    ds_read_b64_tr_b16 v[126:127], v147 offset:59392
    s_waitcnt vmcnt(8) lgkmcnt(0)
    v_max3_u32 v156, v156, v67, v71
    v_mfma_f32_16x16x32_bf16 v[80:83], v[112:115], v[64:67], v[80:83]
    ds_read_b64_tr_b16 v[128:129], v144 offset:61440
    v_mfma_f32_16x16x32_bf16 v[96:99], v[112:115], v[68:71], v[96:99]
    ds_read_b64_tr_b16 v[130:131], v144 offset:63488
    s_mov_b32 s90, 100352
    buffer_load_dwordx4 v[220:223], v11, s[32:35], s90 offen
    v_mfma_f32_16x16x32_bf16 v[84:87], v[116:119], v[64:67], v[84:87]
    ds_read_b64_tr_b16 v[132:133], v145 offset:61440
    v_mfma_f32_16x16x32_bf16 v[100:103], v[116:119], v[68:71], v[100:103]
    ds_read_b64_tr_b16 v[134:135], v145 offset:63488
    v_mfma_f32_16x16x32_bf16 v[88:91], v[120:123], v[64:67], v[88:91]
    ds_read_b64_tr_b16 v[136:137], v146 offset:61440
    v_mfma_f32_16x16x32_bf16 v[104:107], v[120:123], v[68:71], v[104:107]
    ds_read_b64_tr_b16 v[138:139], v146 offset:63488
    v_mfma_f32_16x16x32_bf16 v[92:95], v[124:127], v[64:67], v[92:95]
    ds_read_b64_tr_b16 v[140:141], v147 offset:61440
    v_mfma_f32_16x16x32_bf16 v[108:111], v[124:127], v[68:71], v[108:111]
    ds_read_b64_tr_b16 v[142:143], v147 offset:63488
    s_waitcnt vmcnt(7) lgkmcnt(0)
    v_max3_u32 v156, v156, v75, v79
    v_cmp_eq_u32 vcc, -1, v156
    s_cbranch_vccz L_ok_4
    s_sub_u32 s56, s56, 1
    s_cbranch_scc0 L_b_restart
    s_mov_b32 s56, 0
L_ok_4:
    v_mfma_f32_16x16x32_bf16 v[80:83], v[128:131], v[72:75], v[80:83]
    v_mfma_f32_16x16x32_bf16 v[96:99], v[128:131], v[76:79], v[96:99]
    s_mov_b32 s90, 107520
    buffer_load_dwordx4 v[224:227], v11, s[32:35], s90 offen
    v_mfma_f32_16x16x32_bf16 v[84:87], v[132:135], v[72:75], v[84:87]
    v_mfma_f32_16x16x32_bf16 v[100:103], v[132:135], v[76:79], v[100:103]
    v_mfma_f32_16x16x32_bf16 v[88:91], v[136:139], v[72:75], v[88:91]
    v_mfma_f32_16x16x32_bf16 v[104:107], v[136:139], v[76:79], v[104:107]
    v_mfma_f32_16x16x32_bf16 v[92:95], v[140:143], v[72:75], v[92:95]
    v_mfma_f32_16x16x32_bf16 v[108:111], v[140:143], v[76:79], v[108:111]
    ds_write_b128 v162, v[96:99] offset:0
    s_nop 2
    ds_write_b128 v162, v[100:103] offset:1024
    s_nop 0
    ds_write_b128 v162, v[104:107] offset:2048
    s_nop 0
    ds_write_b128 v162, v[108:111] offset:3072
    s_waitcnt lgkmcnt(0)
    s_barrier
    ds_read_b128 v[16:19], v163 offset:0
    ds_read_b128 v[20:23], v163 offset:1024
    ds_read_b128 v[24:27], v163 offset:2048
    ds_read_b128 v[28:31], v163 offset:3072
    s_waitcnt lgkmcnt(3)
    v_pk_add_f32 v[80:81], v[80:81], v[16:17]
    v_pk_add_f32 v[82:83], v[82:83], v[18:19]
    v_cvt_pk_bf16_f32 v32, v80, v81
    v_cvt_pk_bf16_f32 v33, v82, v83
    s_waitcnt lgkmcnt(2)
    v_pk_add_f32 v[84:85], v[84:85], v[20:21]
    v_pk_add_f32 v[86:87], v[86:87], v[22:23]
    v_cvt_pk_bf16_f32 v34, v84, v85
    v_cvt_pk_bf16_f32 v35, v86, v87
    s_waitcnt lgkmcnt(1)
    v_pk_add_f32 v[88:89], v[88:89], v[24:25]
    v_pk_add_f32 v[90:91], v[90:91], v[26:27]
    v_cvt_pk_bf16_f32 v36, v88, v89
    v_cvt_pk_bf16_f32 v37, v90, v91
    s_waitcnt lgkmcnt(0)
    v_pk_add_f32 v[92:93], v[92:93], v[28:29]
    v_pk_add_f32 v[94:95], v[94:95], v[30:31]
    v_cvt_pk_bf16_f32 v38, v92, v93
    v_cvt_pk_bf16_f32 v39, v94, v95
    v_mfma_f32_16x16x32_bf16 v[60:63], v[32:35], v[32:35], 0
    v_mfma_f32_16x16x32_bf16 v[56:59], v[148:151], v[32:35], 0
    v_mfma_f32_16x16x32_bf16 v[60:63], v[36:39], v[36:39], v[60:63]
    v_mfma_f32_16x16x32_bf16 v[56:59], v[152:155], v[36:39], v[56:59]
    v_lshlrev_b32 v40, 16, v32
    v_and_b32 v41, 0xffff0000, v32
    v_lshlrev_b32 v42, 16, v33
    v_and_b32 v43, 0xffff0000, v33
    v_lshlrev_b32 v44, 16, v34
    v_and_b32 v45, 0xffff0000, v34
    v_lshlrev_b32 v46, 16, v35
    v_and_b32 v47, 0xffff0000, v35
    v_cndmask_b32 v60, v60, v61, s[4:5]
    v_cndmask_b32 v60, v60, v62, s[6:7]
    v_cndmask_b32 v58, v60, v63, s[98:99]
    buffer_store_dwordx4 v[56:59], v161, s[16:19], 0 offen sc1
    v_lshlrev_b32 v48, 16, v36
    v_and_b32 v49, 0xffff0000, v36
    v_lshlrev_b32 v50, 16, v37
    v_and_b32 v51, 0xffff0000, v37
    v_lshlrev_b32 v52, 16, v38
    v_and_b32 v53, 0xffff0000, v38
    v_lshlrev_b32 v54, 16, v39
    v_and_b32 v55, 0xffff0000, v39
L_h3:
    buffer_load_dwordx4 v[64:67], v160, s[16:19], 0 offen offset:0 sc1
    buffer_load_dwordx4 v[68:71], v160, s[16:19], 0 offen offset:1024 sc1
    buffer_load_dwordx4 v[72:75], v160, s[16:19], 0 offen offset:2048 sc1
    buffer_load_dwordx4 v[76:79], v160, s[16:19], 0 offen offset:3072 sc1
    s_waitcnt vmcnt(0)
    v_max3_u32 v8, v66, v70, v74
    v_max_u32 v8, v8, v78
    v_cmp_eq_u32 vcc, -1, v8
    s_cbranch_vccz L_ok_5
    s_sub_u32 s56, s56, 1
    s_cbranch_scc0 L_h3
    s_mov_b32 s56, 0
L_ok_5:
    v_pk_add_f32 v[64:65], v[64:65], v[68:69]
    v_add_f32 v66, v66, v70
    v_pk_add_f32 v[72:73], v[72:73], v[76:77]
    v_add_f32 v74, v74, v78
    v_pk_add_f32 v[64:65], v[64:65], v[72:73]
    v_add_f32 v66, v66, v74
    v_mov_b32 v68, v64
    v_mov_b32 v69, v65
    v_mov_b32 v70, v66
    v_permlane32_swap_b32 v64, v68
    v_permlane32_swap_b32 v65, v69
    v_permlane32_swap_b32 v66, v70
    v_add_f32 v64, v64, v68
    v_add_f32 v65, v65, v69
    v_add_f32 v66, v66, v70
    v_mov_b32 v68, v64
    v_mov_b32 v69, v65
    v_mov_b32 v70, v66
    v_permlane16_swap_b32 v64, v68
    v_permlane16_swap_b32 v65, v69
    v_permlane16_swap_b32 v66, v70
    v_add_f32 v64, v64, v68
    v_add_f32 v65, v65, v69
    v_add_f32 v66, v66, v70
    v_mul_f32 v64, 0x3a800000, v64
    v_mul_f32 v66, 0x3a800000, v66
    v_fma_f32 v66, -v64, v64, v66
    v_max_f32 v66, 0, v66
    v_cvt_pk_bf16_f32 v69, v64, v66
    v_lshlrev_b32 v68, 16, v69
    v_and_b32 v69, 0xffff0000, v69
    v_add_f32 v69, 0x3727c5ac, v69
    v_cvt_pk_bf16_f32 v69, v69, v69
    v_lshlrev_b32 v69, 16, v69
    v_sqrt_f32 v69, v69
    s_nop 0
    v_cvt_pk_bf16_f32 v69, v69, v69
    v_lshlrev_b32 v69, 16, v69
    v_rcp_f32 v70, v69
    v_fma_f32 v12, -v68, s57, v65
    v_mul_f32 v12, v12, v70
    v_mul_f32 v72, -v68, v70
    v_ashrrev_i32 v8, 31, v12
    v_or_b32 v8, 0x80000000, v8
    v_xor_b32 v8, v8, v12
    v_and_b32 v8, 0xfffff800, v8
    v_or_b32 v13, v8, v6
    s_lshl_b32 s86, s3, 6
    s_add_u32 s86, s86, 65536
    v_lshl_add_u32 v8, v2, 2, s86
    ds_write_b32 v8, v13
    v_pk_fma_f32 v[16:17], v[40:41], v[70:71], v[72:73] op_sel_hi:[1,0,0]
    v_pk_fma_f32 v[18:19], v[42:43], v[70:71], v[72:73] op_sel_hi:[1,0,0]
    v_pk_fma_f32 v[20:21], v[44:45], v[70:71], v[72:73] op_sel_hi:[1,0,0]
    v_pk_fma_f32 v[22:23], v[46:47], v[70:71], v[72:73] op_sel_hi:[1,0,0]
    v_pk_fma_f32 v[24:25], v[48:49], v[70:71], v[72:73] op_sel_hi:[1,0,0]
    v_pk_fma_f32 v[26:27], v[50:51], v[70:71], v[72:73] op_sel_hi:[1,0,0]
    v_pk_fma_f32 v[28:29], v[52:53], v[70:71], v[72:73] op_sel_hi:[1,0,0]
    v_pk_fma_f32 v[30:31], v[54:55], v[70:71], v[72:73] op_sel_hi:[1,0,0]
    v_lshlrev_b32 v8, 3, v0
    v_add_u32 v8, 65536, v8
    s_waitcnt lgkmcnt(0)
    s_barrier
    ds_read_b64 v[64:65], v8
    v_cvt_pk_bf16_f32 v96, v16, v17
    v_cvt_pk_bf16_f32 v97, v18, v19
    v_cvt_pk_bf16_f32 v98, v20, v21
    v_cvt_pk_bf16_f32 v99, v22, v23
    v_cvt_pk_bf16_f32 v100, v24, v25
    v_cvt_pk_bf16_f32 v101, v26, v27
    v_cvt_pk_bf16_f32 v102, v28, v29
    v_cvt_pk_bf16_f32 v103, v30, v31
    s_waitcnt lgkmcnt(0)
    v_max_u32 v66, v64, v65
    v_min_u32 v67, v64, v65
    s_nop 0
    v_mov_b32_dpp v64, v66 row_ror:8 row_mask:0xf bank_mask:0xf
    v_max_u32_dpp v65, v67, v67 row_ror:8 row_mask:0xf bank_mask:0xf
    v_med3_u32 v67, v66, v64, v65
    v_max_u32 v66, v66, v64
    s_nop 1
    v_mov_b32_dpp v64, v66 row_ror:4 row_mask:0xf bank_mask:0xf
    v_max_u32_dpp v65, v67, v67 row_ror:4 row_mask:0xf bank_mask:0xf
    v_med3_u32 v67, v66, v64, v65
    v_max_u32 v66, v66, v64
    s_nop 1
    v_mov_b32_dpp v64, v66 row_ror:2 row_mask:0xf bank_mask:0xf
    v_max_u32_dpp v65, v67, v67 row_ror:2 row_mask:0xf bank_mask:0xf
    v_med3_u32 v67, v66, v64, v65
    v_max_u32 v66, v66, v64
    s_nop 1
    v_mov_b32_dpp v64, v66 row_ror:1 row_mask:0xf bank_mask:0xf
    v_max_u32_dpp v65, v67, v67 row_ror:1 row_mask:0xf bank_mask:0xf
    v_med3_u32 v67, v66, v64, v65
    v_max_u32 v66, v66, v64
    s_nop 0
    v_readlane_b32 s58, v66, 0
    v_readlane_b32 s59, v67, 0
    v_readlane_b32 s86, v66, 16
    v_readlane_b32 s87, v67, 16
    s_nop 0
    s_max_u32 s59, s59, s87
    s_min_u32 s87, s58, s86
    s_max_u32 s58, s58, s86
    s_max_u32 s59, s59, s87
    v_readlane_b32 s86, v66, 32
    v_readlane_b32 s87, v67, 32
    s_nop 0
    s_max_u32 s59, s59, s87
    s_min_u32 s87, s58, s86
    s_max_u32 s58, s58, s86
    s_max_u32 s59, s59, s87
    v_readlane_b32 s86, v66, 48
    v_readlane_b32 s87, v67, 48
    s_nop 0
    s_max_u32 s59, s59, s87
    s_min_u32 s87, s58, s86
    s_max_u32 s58, s58, s86
    s_max_u32 s59, s59, s87
    v_cmp_eq_u32 s[4:5], s58, v13
    v_cmp_eq_u32 s[6:7], s59, v13
    s_nop 0
    s_or_b64 s[96:97], s[4:5], s[6:7]
    s_cbranch_scc0 L_nocand
    s_lshl_b32 s86, s51, 12
    s_lshl_b32 s87, s52, 7
    s_add_u32 s86, s86, s87
    s_add_u32 s86, s86, 7372800
    v_lshl_add_u32 v8, v1, 3, s86
    v_add_u32 v9, 2048, v8
    v_cndmask_b32 v8, v8, v9, s[6:7]
    v_mov_b32 v9, 2147483648
    v_cndmask_b32 v8, v9, v8, s[96:97]
    buffer_store_dwordx2 v[96:97], v8, s[16:19], 0 offen offset:0 sc1
    buffer_store_dwordx2 v[98:99], v8, s[16:19], 0 offen offset:32 sc1
    buffer_store_dwordx2 v[100:101], v8, s[16:19], 0 offen offset:64 sc1
    buffer_store_dwordx2 v[102:103], v8, s[16:19], 0 offen offset:96 sc1
L_nocand:
    s_cmp_lg_u32 s3, 0
    s_cbranch_scc1 L_nokey
    s_lshl_b32 s86, s52, 7
    s_lshl_b32 s87, s51, 3
    s_add_u32 s86, s86, s87
    s_add_u32 s86, s86, 7438336
    v_mov_b32 v8, s86
    v_mov_b32 v9, 2147483648
    v_cmp_eq_u32 vcc, 0, v0
    s_nop 1
    v_cndmask_b32 v8, v9, v8, vcc
    v_mov_b32 v10, s58
    v_mov_b32 v11, s59
    buffer_store_dwordx2 v[10:11], v8, s[16:19], 0 offen sc1
L_nokey:
    s_bfe_u32 s86, s2, 0x20001
    s_lshl_b32 s86, s86, 2
    s_add_u32 s86, s86, s48
    s_lshl_b32 s86, s86, 7
    s_add_u32 s87, s86, 7438336
    v_and_b32 v8, 31, v0
    v_lshl_add_u32 v129, v8, 2, s87
    s_add_u32 s87, s86, 7372800
    v_and_b32 v8, 7, v0
    v_lshl_add_u32 v130, v8, 4, s87
    v_lshrrev_b32 v8, 3, v0
    v_lshl_add_u32 v130, v8, 11, v130
    s_mov_b32 s89, 0x4000
    s_mov_b32 s90, 0x8000
    s_mov_b32 s91, 0xc000
    s_cmp_lg_u64 s[96:97], 0
    s_cselect_b32 s63, 1, s62
    s_cmp_eq_u32 s63, 0
    s_cbranch_scc1 L_h4_skip1
    buffer_load_dword v128, v129, s[16:19], 0 offen sc1
    buffer_load_dwordx4 v[112:115], v130, s[16:19], 0 offen sc1
    buffer_load_dwordx4 v[116:119], v130, s[16:19], s89 offen sc1
    buffer_load_dwordx4 v[120:123], v130, s[16:19], s90 offen sc1
    buffer_load_dwordx4 v[124:127], v130, s[16:19], s91 offen sc1
L_h4_skip1:
    v_lshlrev_b32 v16, 16, v96
    v_and_b32 v17, 0xffff0000, v96
    v_lshlrev_b32 v18, 16, v97
    v_and_b32 v19, 0xffff0000, v97
    v_lshlrev_b32 v20, 16, v98
    v_and_b32 v21, 0xffff0000, v98
    v_lshlrev_b32 v22, 16, v99
    v_and_b32 v23, 0xffff0000, v99
    v_lshlrev_b32 v24, 16, v100
    v_and_b32 v25, 0xffff0000, v100
    v_lshlrev_b32 v26, 16, v101
    v_and_b32 v27, 0xffff0000, v101
    v_lshlrev_b32 v28, 16, v102
    v_and_b32 v29, 0xffff0000, v102
    v_lshlrev_b32 v30, 16, v103
    v_and_b32 v31, 0xffff0000, v103
    v_pk_add_f32 v[16:17], v[16:17], v[40:41]
    v_pk_add_f32 v[18:19], v[18:19], v[42:43]
    v_pk_add_f32 v[20:21], v[20:21], v[44:45]
    v_pk_add_f32 v[22:23], v[22:23], v[46:47]
    v_pk_add_f32 v[24:25], v[24:25], v[48:49]
    v_pk_add_f32 v[26:27], v[26:27], v[50:51]
    v_pk_add_f32 v[28:29], v[28:29], v[52:53]
    v_pk_add_f32 v[30:31], v[30:31], v[54:55]
    v_cvt_pk_bf16_f32 v104, v16, v17
    v_cvt_pk_bf16_f32 v105, v18, v19
    v_cvt_pk_bf16_f32 v106, v20, v21
    v_cvt_pk_bf16_f32 v107, v22, v23
    v_cvt_pk_bf16_f32 v108, v24, v25
    v_cvt_pk_bf16_f32 v109, v26, v27
    v_cvt_pk_bf16_f32 v110, v28, v29
    v_cvt_pk_bf16_f32 v111, v30, v31
    v_permlane16_swap_b32 v104, v106
    v_permlane16_swap_b32 v105, v107
    v_permlane16_swap_b32 v108, v110
    v_permlane16_swap_b32 v109, v111
    v_mov_b32 v9, 2147483648
    v_cndmask_b32 v8, v5, v9, s[96:97]
    buffer_store_dwordx4 v[104:107], v8, s[24:27], 0 offen
    buffer_store_dwordx4 v[108:111], v8, s[24:27], 0 offen offset:64
    s_cmp_eq_u32 s63, 0
    s_cbranch_scc1 L_fin
    s_cmp_eq_u64 s[96:97], 0
    s_cbranch_scc1 L_nostash
    v_lshlrev_b32 v8, 3, v1
    v_add_u32 v8, 98304, v8
    v_add_u32 v9, 512, v8
    v_cndmask_b32 v8, v8, v9, s[6:7]
    v_cvt_pk_bf16_f32 v9, v12, v12
    v_lshlrev_b32 v9, 16, v9
    s_mov_b64 exec, s[96:97]
    ds_write_b64 v8, v[32:33] offset:0
    ds_write_b64 v8, v[96:97] offset:128
    ds_write_b64 v8, v[34:35] offset:32
    ds_write_b64 v8, v[98:99] offset:160
    ds_write_b64 v8, v[36:37] offset:64
    ds_write_b64 v8, v[100:101] offset:192
    ds_write_b64 v8, v[38:39] offset:96
    ds_write_b64 v8, v[102:103] offset:224
    ds_write_b32 v8, v9 offset:256
    s_mov_b64 exec, -1
L_nostash:
    s_branch L_h4_chk
L_h4:
    buffer_load_dword v128, v129, s[16:19], 0 offen sc1
    buffer_load_dwordx4 v[112:115], v130, s[16:19], 0 offen sc1
    buffer_load_dwordx4 v[116:119], v130, s[16:19], s89 offen sc1
    buffer_load_dwordx4 v[120:123], v130, s[16:19], s90 offen sc1
    buffer_load_dwordx4 v[124:127], v130, s[16:19], s91 offen sc1
L_h4_chk:
    s_waitcnt vmcnt(0)
    v_max3_u32 v8, v128, v113, v115
    v_max3_u32 v8, v8, v117, v119
    v_max3_u32 v8, v8, v121, v123
    v_max3_u32 v8, v8, v125, v127
    v_cmp_eq_u32 vcc, -1, v8
    s_cbranch_vccz L_ok_6
    s_sub_u32 s56, s56, 1
    s_cbranch_scc0 L_h4
    s_mov_b32 s56, 0
L_ok_6:
    s_lshl_b32 s88, s48, 12
    s_add_u32 s88, s88, 69632
    s_cmp_eq_u32 s62, 0
    s_cbranch_scc1 L_noseg
    v_lshl_add_u32 v8, v0, 4, s88
    ds_write_b128 v8, v[112:115] offset:0
    ds_write_b128 v8, v[116:119] offset:1024
    ds_write_b128 v8, v[120:123] offset:2048
    ds_write_b128 v8, v[124:127] offset:3072
L_noseg:
    v_mov_b32 v64, v128
    v_mov_b32 v65, 0
    s_nop 0
    v_mov_b32_dpp v66, v64 row_ror:8 row_mask:0xf bank_mask:0xf
    v_max_u32_dpp v67, v65, v65 row_ror:8 row_mask:0xf bank_mask:0xf
    v_med3_u32 v65, v64, v66, v67
    v_max_u32 v64, v64, v66
    s_nop 1
    v_mov_b32_dpp v66, v64 row_ror:4 row_mask:0xf bank_mask:0xf
    v_max_u32_dpp v67, v65, v65 row_ror:4 row_mask:0xf bank_mask:0xf
    v_med3_u32 v65, v64, v66, v67
    v_max_u32 v64, v64, v66
    s_nop 1
    v_mov_b32_dpp v66, v64 row_ror:2 row_mask:0xf bank_mask:0xf
    v_max_u32_dpp v67, v65, v65 row_ror:2 row_mask:0xf bank_mask:0xf
    v_med3_u32 v65, v64, v66, v67
    v_max_u32 v64, v64, v66
    s_nop 1
    v_mov_b32_dpp v66, v64 row_ror:1 row_mask:0xf bank_mask:0xf
    v_max_u32_dpp v67, v65, v65 row_ror:1 row_mask:0xf bank_mask:0xf
    v_med3_u32 v65, v64, v66, v67
    v_max_u32 v64, v64, v66
    s_nop 0
    v_readlane_b32 s60, v64, 0
    v_readlane_b32 s61, v65, 0
    v_readlane_b32 s86, v64, 16
    v_readlane_b32 s87, v65, 16
    s_nop 0
    s_max_u32 s61, s61, s87
    s_min_u32 s87, s60, s86
    s_max_u32 s60, s60, s86
    s_max_u32 s61, s61, s87
    s_cmp_eq_u64 s[96:97], 0
    s_cbranch_scc1 L_nolost
    v_cmp_ne_u32 s[4:5], s60, v13
    v_cmp_ne_u32 s[6:7], s61, v13
    s_nop 0
    s_and_b64 s[4:5], s[4:5], s[6:7]
    s_and_b64 s[4:5], s[4:5], s[96:97]
    v_mov_b32 v9, 2147483648
    v_cndmask_b32 v8, v9, v5, s[4:5]
    buffer_store_dwordx4 v[104:107], v8, s[24:27], 0 offen
    buffer_store_dwordx4 v[108:111], v8, s[24:27], 0 offen offset:64
L_nolost:
    s_cmp_lg_u32 s62, 0
    s_cbranch_scc1 L_moe
    s_barrier
    s_barrier
    s_branch L_final
L_moe:
    s_mov_b32 s90, 0
    buffer_load_dwordx4 v[228:231], v14, s[36:39], s90 offen
    s_mov_b32 s90, 2048
    buffer_load_dwordx4 v[232:235], v14, s[36:39], s90 offen
    s_mov_b32 s90, 4096
    buffer_load_dwordx4 v[236:239], v14, s[36:39], s90 offen
    s_mov_b32 s90, 6144
    buffer_load_dwordx4 v[240:243], v14, s[36:39], s90 offen
    s_mov_b32 s90, 8192
    buffer_load_dwordx4 v[244:247], v14, s[36:39], s90 offen
    s_mov_b32 s90, 10240
    buffer_load_dwordx4 v[248:251], v14, s[36:39], s90 offen
    s_mov_b32 s90, 12288
    buffer_load_dwordx4 v[252:255], v14, s[36:39], s90 offen
    v_cmp_eq_u32 vcc, s60, v128
    s_nop 0
    s_ff1_i32_b64 s86, vcc
    v_cmp_eq_u32 vcc, s61, v128
    s_nop 0
    s_ff1_i32_b64 s87, vcc
    s_lshl_b32 s86, s86, 7
    s_lshl_b32 s87, s87, 7
    v_bfe_u32 v8, v0, 3, 1
    v_cmp_eq_u32 vcc, 1, v8
    v_mov_b32 v9, s86
    v_mov_b32 v10, s87
    v_cndmask_b32 v9, v9, v10, vcc
    v_lshl_add_u32 v10, v1, 5, s88
    v_add_u32 v9, v9, v10
    s_waitcnt lgkmcnt(0)
    ds_read_b128 v[64:67], v9
    ds_read_b128 v[68:71], v9 offset:16
    v_and_b32 v10, 1, v0
    v_cmp_eq_u32 vcc, 1, v10
    v_mov_b32 v10, 0x0c0c0100
    v_mov_b32 v11, 0x01000c0c
    v_cndmask_b32 v16, v10, v11, vcc
    v_mov_b32 v10, 0x0c0c0302
    v_mov_b32 v11, 0x03020c0c
    v_cndmask_b32 v17, v10, v11, vcc
    v_bfe_u32 v10, v0, 1, 2
    v_mov_b32 v11, 0x0c0c0c0c
    v_cmp_eq_u32 vcc, 0, v10
    s_nop 1
    v_cndmask_b32 v72, v11, v16, vcc
    v_cndmask_b32 v76, v11, v17, vcc
    v_cmp_eq_u32 vcc, 1, v10
    s_nop 1
    v_cndmask_b32 v73, v11, v16, vcc
    v_cndmask_b32 v77, v11, v17, vcc
    v_cmp_eq_u32 vcc, 2, v10
    s_nop 1
    v_cndmask_b32 v74, v11, v16, vcc
    v_cndmask_b32 v78, v11, v17, vcc
    v_cmp_eq_u32 vcc, 3, v10
    s_nop 1
    v_cndmask_b32 v75, v11, v16, vcc
    v_cndmask_b32 v79, v11, v17, vcc
    s_lshl_b32 s86, s48, 10
    s_add_u32 s86, s86, 90112
    v_lshl_add_u32 v18, v0, 4, s86
    s_and_b32 s86, s2, 1
    s_lshl_b32 s86, s86, 2
    s_bfe_u32 s87, s2, 0x20001
    s_add_u32 s86, s86, s87
    s_mul_i32 s86, s86, 28672
    s_lshl_b32 s87, s45, 9
    s_add_u32 s86, s86, s87
    s_add_u32 s86, s86, 7077888
    s_cmp_ge_u32 s2, 224
    s_cselect_b32 s86, 2147483648, s86
    v_lshl_add_u32 v19, v2, 5, s86
    v_and_b32 v10, 1, v1
    v_lshl_add_u32 v19, v10, 4, v19
    v_lshrrev_b32 v11, 1, v1
    v_mul_u32_u24 v16, 14336, v11
    v_add_u32 v19, v19, v16
    s_waitcnt lgkmcnt(0)
    v_perm_b32 v80, v64, v64, v72
    v_perm_b32 v81, v64, v64, v73
    v_perm_b32 v82, v64, v64, v74
    v_perm_b32 v83, v64, v64, v75
    s_nop 1
    v_mfma_f32_16x16x32_bf16 v[88:91], v[80:83], v[164:167], 0
    v_perm_b32 v84, v64, v64, v76
    v_perm_b32 v85, v64, v64, v77
    v_perm_b32 v86, v64, v64, v78
    v_perm_b32 v87, v64, v64, v79
    s_nop 1
    v_mfma_f32_16x16x32_bf16 v[88:91], v[84:87], v[168:171], v[88:91]
    v_perm_b32 v80, v65, v65, v72
    v_perm_b32 v81, v65, v65, v73
    v_perm_b32 v82, v65, v65, v74
    v_perm_b32 v83, v65, v65, v75
    s_nop 1
    v_mfma_f32_16x16x32_bf16 v[88:91], v[80:83], v[172:175], v[88:91]
    v_perm_b32 v84, v65, v65, v76
    v_perm_b32 v85, v65, v65, v77
    v_perm_b32 v86, v65, v65, v78
    v_perm_b32 v87, v65, v65, v79
    s_nop 1
    v_mfma_f32_16x16x32_bf16 v[88:91], v[84:87], v[176:179], v[88:91]
    v_perm_b32 v80, v66, v66, v72
    v_perm_b32 v81, v66, v66, v73
    v_perm_b32 v82, v66, v66, v74
    v_perm_b32 v83, v66, v66, v75
    s_nop 1
    v_mfma_f32_16x16x32_bf16 v[88:91], v[80:83], v[180:183], v[88:91]
    v_perm_b32 v84, v66, v66, v76
    v_perm_b32 v85, v66, v66, v77
    v_perm_b32 v86, v66, v66, v78
    v_perm_b32 v87, v66, v66, v79
    s_nop 1
    v_mfma_f32_16x16x32_bf16 v[88:91], v[84:87], v[184:187], v[88:91]
    v_perm_b32 v80, v67, v67, v72
    v_perm_b32 v81, v67, v67, v73
    v_perm_b32 v82, v67, v67, v74
    v_perm_b32 v83, v67, v67, v75
    s_nop 1
    v_mfma_f32_16x16x32_bf16 v[88:91], v[80:83], v[188:191], v[88:91]
    v_perm_b32 v84, v67, v67, v76
    v_perm_b32 v85, v67, v67, v77
    v_perm_b32 v86, v67, v67, v78
    v_perm_b32 v87, v67, v67, v79
    s_nop 1
    v_mfma_f32_16x16x32_bf16 v[88:91], v[84:87], v[192:195], v[88:91]
    v_perm_b32 v80, v68, v68, v72
    v_perm_b32 v81, v68, v68, v73
    v_perm_b32 v82, v68, v68, v74
    v_perm_b32 v83, v68, v68, v75
    s_nop 1
    v_mfma_f32_16x16x32_bf16 v[88:91], v[80:83], v[196:199], v[88:91]
    v_perm_b32 v84, v68, v68, v76
    v_perm_b32 v85, v68, v68, v77
    v_perm_b32 v86, v68, v68, v78
    v_perm_b32 v87, v68, v68, v79
    s_nop 1
    v_mfma_f32_16x16x32_bf16 v[88:91], v[84:87], v[200:203], v[88:91]
    v_perm_b32 v80, v69, v69, v72
    v_perm_b32 v81, v69, v69, v73
    v_perm_b32 v82, v69, v69, v74
    v_perm_b32 v83, v69, v69, v75
    s_nop 1
    v_mfma_f32_16x16x32_bf16 v[88:91], v[80:83], v[204:207], v[88:91]
    v_perm_b32 v84, v69, v69, v76
    v_perm_b32 v85, v69, v69, v77
    v_perm_b32 v86, v69, v69, v78
    v_perm_b32 v87, v69, v69, v79
    s_nop 1
    v_mfma_f32_16x16x32_bf16 v[88:91], v[84:87], v[208:211], v[88:91]
    v_perm_b32 v80, v70, v70, v72
    v_perm_b32 v81, v70, v70, v73
    v_perm_b32 v82, v70, v70, v74
    v_perm_b32 v83, v70, v70, v75
    s_nop 1
    v_mfma_f32_16x16x32_bf16 v[88:91], v[80:83], v[212:215], v[88:91]
    v_perm_b32 v84, v70, v70, v76
    v_perm_b32 v85, v70, v70, v77
    v_perm_b32 v86, v70, v70, v78
    v_perm_b32 v87, v70, v70, v79
    s_nop 1
    v_mfma_f32_16x16x32_bf16 v[88:91], v[84:87], v[216:219], v[88:91]
    v_perm_b32 v80, v71, v71, v72
    v_perm_b32 v81, v71, v71, v73
    v_perm_b32 v82, v71, v71, v74
    v_perm_b32 v83, v71, v71, v75
    s_nop 1
    v_mfma_f32_16x16x32_bf16 v[88:91], v[80:83], v[220:223], v[88:91]
    v_perm_b32 v84, v71, v71, v76
    v_perm_b32 v85, v71, v71, v77
    v_perm_b32 v86, v71, v71, v78
    v_perm_b32 v87, v71, v71, v79
    s_nop 1
    v_mfma_f32_16x16x32_bf16 v[88:91], v[84:87], v[224:227], v[88:91]
    s_nop 7
    ds_write_b128 v18, v[88:91] offset:0
    s_waitcnt lgkmcnt(0)
    s_barrier
    s_cmp_lg_u32 s48, 0
    s_cbranch_scc1 L_gu_done
    ds_read_b128 v[20:23], v18 offset:1024
    ds_read_b128 v[24:27], v18 offset:2048
    ds_read_b128 v[28:31], v18 offset:3072
    s_waitcnt lgkmcnt(0)
    v_pk_add_f32 v[88:89], v[88:89], v[20:21]
    v_pk_add_f32 v[24:25], v[24:25], v[28:29]
    v_pk_add_f32 v[88:89], v[88:89], v[24:25]
    v_pk_add_f32 v[90:91], v[90:91], v[22:23]
    v_pk_add_f32 v[26:27], v[26:27], v[30:31]
    v_pk_add_f32 v[90:91], v[90:91], v[26:27]
    buffer_store_dwordx4 v[88:91], v19, s[16:19], 0 offen sc1
L_gu_done:
    s_mul_i32 s86, s45, 112
    s_mul_i32 s87, s48, 28
    s_add_u32 s86, s86, s87
    v_bfe_u32 v16, v0, 3, 2
    v_mul_u32_u24 v16, 7, v16
    v_and_b32 v17, 7, v0
    v_min_u32 v17, 6, v17
    v_add3_u32 v16, v16, v17, s86
    v_lshrrev_b32 v17, 5, v0
    v_mul_u32_u24 v17, 14336, v17
    v_lshl_add_u32 v16, v16, 2, v17
    v_add_u32 v16, 7077888, v16
    s_lshl_b32 s86, s45, 13
    s_lshl_b32 s87, s44, 9
    s_add_u32 s86, s86, s87
    s_add_u32 s86, s86, 6815744
    v_lshl_add_u32 v9, v2, 5, s86
    v_lshl_add_u32 v9, v10, 4, v9
    v_lshl_add_u32 v9, v11, 12, v9
    s_lshl_b32 s86, s48, 7
    s_add_u32 s86, s86, 100352
    v_lshl_add_u32 v10, v0, 1, s86
    v_lshl_add_u32 v11, v8, 6, s86
    v_lshl_add_u32 v11, v1, 4, v11
L_h5:
    s_mov_b32 s90, 0
    buffer_load_dword v24, v16, s[16:19], s90 offen sc1
    s_mov_b32 s90, 28672
    buffer_load_dword v25, v16, s[16:19], s90 offen sc1
    s_mov_b32 s90, 57344
    buffer_load_dword v26, v16, s[16:19], s90 offen sc1
    s_mov_b32 s90, 86016
    buffer_load_dword v27, v16, s[16:19], s90 offen sc1
    s_mov_b32 s90, 114688
    buffer_load_dword v28, v16, s[16:19], s90 offen sc1
    s_mov_b32 s90, 143360
    buffer_load_dword v29, v16, s[16:19], s90 offen sc1
    s_mov_b32 s90, 172032
    buffer_load_dword v30, v16, s[16:19], s90 offen sc1
    s_mov_b32 s90, 200704
    buffer_load_dword v31, v16, s[16:19], s90 offen sc1
    s_waitcnt vmcnt(0)
    v_max3_u32 v17, v24, v25, v26
    v_max3_u32 v17, v17, v27, v28
    v_max3_u32 v17, v17, v29, v30
    v_max_u32 v17, v17, v31
    v_cmp_eq_u32 vcc, -1, v17
    s_cbranch_vccz L_ok_7
    s_sub_u32 s56, s56, 1
    s_cbranch_scc0 L_h5
    s_mov_b32 s56, 0
L_ok_7:
    v_mov_b32 v19, v9
    v_add_f32 v24, v24, v25
    v_add_f32 v26, v26, v27
    v_add_f32 v28, v28, v29
    v_add_f32 v30, v30, v31
    v_add_f32 v24, v24, v26
    v_add_f32 v28, v28, v30
    v_cvt_pk_bf16_f32 v25, v24, v28
    v_lshlrev_b32 v24, 16, v25
    v_and_b32 v28, 0xffff0000, v25
    v_mul_f32 v25, 0xbfb8aa3b, v24
    v_exp_f32 v25, v25
    s_nop 0
    v_add_f32 v25, 1.0, v25
    v_rcp_f32 v25, v25
    s_nop 0
    v_mul_f32 v24, v24, v25
    v_cvt_pk_bf16_f32 v24, v24, v24
    v_lshlrev_b32 v24, 16, v24
    v_mul_f32 v24, v24, v28
    v_cvt_pk_bf16_f32 v24, v24, v24
    ds_write_b16 v10, v24
    s_waitcnt lgkmcnt(0)
    ds_read_b128 v[64:67], v11
    s_waitcnt lgkmcnt(0)
    v_perm_b32 v80, v64, v64, v72
    v_perm_b32 v81, v64, v64, v73
    v_perm_b32 v82, v64, v64, v74
    v_perm_b32 v83, v64, v64, v75
    s_nop 1
    v_mfma_f32_16x16x32_bf16 v[88:91], v[80:83], v[228:231], 0
    v_perm_b32 v84, v64, v64, v76
    v_perm_b32 v85, v64, v64, v77
    v_perm_b32 v86, v64, v64, v78
    v_perm_b32 v87, v64, v64, v79
    s_nop 1
    v_mfma_f32_16x16x32_bf16 v[88:91], v[84:87], v[232:235], v[88:91]
    v_perm_b32 v80, v65, v65, v72
    v_perm_b32 v81, v65, v65, v73
    v_perm_b32 v82, v65, v65, v74
    v_perm_b32 v83, v65, v65, v75
    s_nop 1
    v_mfma_f32_16x16x32_bf16 v[88:91], v[80:83], v[236:239], v[88:91]
    v_perm_b32 v84, v65, v65, v76
    v_perm_b32 v85, v65, v65, v77
    v_perm_b32 v86, v65, v65, v78
    v_perm_b32 v87, v65, v65, v79
    s_nop 1
    v_mfma_f32_16x16x32_bf16 v[88:91], v[84:87], v[240:243], v[88:91]
    v_perm_b32 v80, v66, v66, v72
    v_perm_b32 v81, v66, v66, v73
    v_perm_b32 v82, v66, v66, v74
    v_perm_b32 v83, v66, v66, v75
    s_nop 1
    v_mfma_f32_16x16x32_bf16 v[88:91], v[80:83], v[244:247], v[88:91]
    v_perm_b32 v84, v66, v66, v76
    v_perm_b32 v85, v66, v66, v77
    v_perm_b32 v86, v66, v66, v78
    v_perm_b32 v87, v66, v66, v79
    s_nop 1
    v_mfma_f32_16x16x32_bf16 v[88:91], v[84:87], v[248:251], v[88:91]
    v_perm_b32 v80, v67, v67, v72
    v_perm_b32 v81, v67, v67, v73
    v_perm_b32 v82, v67, v67, v74
    v_perm_b32 v83, v67, v67, v75
    s_nop 1
    v_mfma_f32_16x16x32_bf16 v[88:91], v[80:83], v[252:255], v[88:91]
    s_nop 7
    ds_write_b128 v18, v[88:91] offset:4096
    s_waitcnt lgkmcnt(0)
    s_barrier
    s_cmp_lg_u32 s48, 0
    s_cbranch_scc1 L_dn_done
    ds_read_b128 v[20:23], v18 offset:5120
    ds_read_b128 v[24:27], v18 offset:6144
    ds_read_b128 v[28:31], v18 offset:7168
    s_waitcnt lgkmcnt(0)
    v_pk_add_f32 v[88:89], v[88:89], v[20:21]
    v_pk_add_f32 v[24:25], v[24:25], v[28:29]
    v_pk_add_f32 v[88:89], v[88:89], v[24:25]
    v_pk_add_f32 v[90:91], v[90:91], v[22:23]
    v_pk_add_f32 v[26:27], v[26:27], v[30:31]
    v_pk_add_f32 v[90:91], v[90:91], v[26:27]
    buffer_store_dwordx4 v[88:91], v19, s[16:19], 0 offen sc1
L_dn_done:
L_final:
    s_cmp_eq_u64 s[96:97], 0
    s_cbranch_scc1 L_fin
    s_mov_b32 s63, 0
L_fin_loop:
    v_cmp_eq_u32 vcc, s60, v13
    s_cbranch_vccz L_fin_next
    s_cmp_eq_u32 s60, s58
    s_cselect_b32 s86, 0, 512
    s_add_u32 s86, s86, 98304
    v_lshl_add_u32 v8, v2, 3, s86
    v_mov_b32 v9, s86
    ds_read_b64 v[56:57], v8
    ds_read_b64 v[58:59], v8 offset:128
    ds_read_b32 v60, v9 offset:256
    s_lshl_b32 s86, s63, 12
    s_lshl_b32 s87, s52, 8
    s_add_u32 s86, s86, s87
    s_add_u32 s86, s86, 6815744
    v_lshl_add_u32 v10, v2, 4, s86
    v_lshl_add_u32 v10, v1, 13, v10
    s_and_b32 s86, s60, 0x7ff
    s_sub_u32 s86, 2047, s86
    s_lshl_b32 s86, s86, 11
    s_lshl_b32 s87, s52, 7
    s_add_u32 s86, s86, s87
    v_lshl_add_u32 v11, v2, 3, s86
    v_cmp_eq_u32 vcc, 0, v1
    v_mov_b32 v9, 2147483648
    s_nop 0
    v_cndmask_b32 v11, v9, v11, vcc
    s_waitcnt lgkmcnt(0)
    v_mul_f32 v60, 0xbfb8aa3b, v60
    v_exp_f32 v60, v60
    s_nop 0
    v_add_f32 v60, 1.0, v60
    v_rcp_f32 v60, v60
    s_nop 0
    v_cvt_pk_bf16_f32 v60, v60, v60
    v_lshlrev_b32 v60, 16, v60
    v_lshlrev_b32 v64, 16, v56
    v_and_b32 v65, 0xffff0000, v56
    v_lshlrev_b32 v68, 16, v58
    v_and_b32 v69, 0xffff0000, v58
    v_lshlrev_b32 v66, 16, v57
    v_and_b32 v67, 0xffff0000, v57
    v_lshlrev_b32 v70, 16, v59
    v_and_b32 v71, 0xffff0000, v59
L_h6:
    s_mov_b32 s90, 0
    buffer_load_dwordx4 v[112:115], v10, s[16:19], s90 offen sc1
    s_mov_b32 s90, 32768
    buffer_load_dwordx4 v[116:119], v10, s[16:19], s90 offen sc1
    s_mov_b32 s90, 65536
    buffer_load_dwordx4 v[120:123], v10, s[16:19], s90 offen sc1
    s_mov_b32 s90, 98304
    buffer_load_dwordx4 v[124:127], v10, s[16:19], s90 offen sc1
    s_mov_b32 s90, 131072
    buffer_load_dwordx4 v[128:131], v10, s[16:19], s90 offen sc1
    s_mov_b32 s90, 163840
    buffer_load_dwordx4 v[132:135], v10, s[16:19], s90 offen sc1
    s_mov_b32 s90, 196608
    buffer_load_dwordx4 v[136:139], v10, s[16:19], s90 offen sc1
    s_mov_b32 s90, 229376
    buffer_load_dwordx4 v[140:143], v10, s[16:19], s90 offen sc1
    s_waitcnt vmcnt(0)
    v_max3_u32 v8, v115, v119, v123
    v_max3_u32 v8, v8, v127, v131
    v_max3_u32 v8, v8, v135, v139
    v_max_u32 v8, v8, v143
    v_cmp_eq_u32 vcc, -1, v8
    s_cbranch_vccz L_ok_8
    s_sub_u32 s56, s56, 1
    s_cbranch_scc0 L_h6
    s_mov_b32 s56, 0
L_ok_8:
    v_pk_add_f32 v[112:113], v[112:113], v[128:129]
    v_pk_add_f32 v[114:115], v[114:115], v[130:131]
    v_pk_add_f32 v[116:117], v[116:117], v[132:133]
    v_pk_add_f32 v[118:119], v[118:119], v[134:135]
    v_pk_add_f32 v[120:121], v[120:121], v[136:137]
    v_pk_add_f32 v[122:123], v[122:123], v[138:139]
    v_pk_add_f32 v[124:125], v[124:125], v[140:141]
    v_pk_add_f32 v[126:127], v[126:127], v[142:143]
    v_pk_add_f32 v[112:113], v[112:113], v[120:121]
    v_pk_add_f32 v[114:115], v[114:115], v[122:123]
    v_pk_add_f32 v[116:117], v[116:117], v[124:125]
    v_pk_add_f32 v[118:119], v[118:119], v[126:127]
    v_pk_add_f32 v[112:113], v[112:113], v[116:117]
    v_pk_add_f32 v[114:115], v[114:115], v[118:119]
    v_mov_b32 v116, v112
    v_mov_b32 v117, v113
    v_mov_b32 v118, v114
    v_mov_b32 v119, v115
    v_permlane32_swap_b32 v112, v116
    v_permlane32_swap_b32 v113, v117
    v_permlane32_swap_b32 v114, v118
    v_permlane32_swap_b32 v115, v119
    v_add_f32 v112, v112, v116
    v_add_f32 v113, v113, v117
    v_add_f32 v114, v114, v118
    v_add_f32 v115, v115, v119
    v_mov_b32 v116, v112
    v_mov_b32 v117, v113
    v_mov_b32 v118, v114
    v_mov_b32 v119, v115
    v_permlane16_swap_b32 v112, v116
    v_permlane16_swap_b32 v113, v117
    v_permlane16_swap_b32 v114, v118
    v_permlane16_swap_b32 v115, v119
    v_add_f32 v112, v112, v116
    v_add_f32 v113, v113, v117
    v_add_f32 v114, v114, v118
    v_add_f32 v115, v115, v119
    v_cvt_pk_bf16_f32 v116, v112, v113
    v_cvt_pk_bf16_f32 v117, v114, v115
    v_lshlrev_b32 v112, 16, v116
    v_and_b32 v113, 0xffff0000, v116
    v_lshlrev_b32 v114, 16, v117
    v_and_b32 v115, 0xffff0000, v117
    v_pk_mul_f32 v[112:113], v[112:113], v[60:61] op_sel_hi:[1,0]
    v_pk_mul_f32 v[114:115], v[114:115], v[60:61] op_sel_hi:[1,0]
    v_cvt_pk_bf16_f32 v116, v112, v113
    v_cvt_pk_bf16_f32 v117, v114, v115
    v_lshlrev_b32 v112, 16, v116
    v_and_b32 v113, 0xffff0000, v116
    v_lshlrev_b32 v114, 16, v117
    v_and_b32 v115, 0xffff0000, v117
    v_pk_add_f32 v[112:113], v[112:113], v[68:69]
    v_pk_add_f32 v[114:115], v[114:115], v[70:71]
    v_cvt_pk_bf16_f32 v116, v112, v113
    v_cvt_pk_bf16_f32 v117, v114, v115
    v_lshlrev_b32 v112, 16, v116
    v_and_b32 v113, 0xffff0000, v116
    v_lshlrev_b32 v114, 16, v117
    v_and_b32 v115, 0xffff0000, v117
    v_pk_add_f32 v[112:113], v[112:113], v[64:65]
    v_pk_add_f32 v[114:115], v[114:115], v[66:67]
    v_cvt_pk_bf16_f32 v116, v112, v113
    v_cvt_pk_bf16_f32 v117, v114, v115
    buffer_store_dwordx2 v[116:117], v11, s[24:27], 0 offen
L_fin_next:
    s_mov_b32 s60, s61
    s_add_u32 s63, s63, 1
    s_cmp_lt_u32 s63, 2
    s_cbranch_scc1 L_fin_loop
L_fin:
L_end:
    s_endpgm
.section .rodata,"a"
.p2align 6
.amdhsa_kernel sequential_preLN__linear_attn_block__moe_arch_mod__prompt_kernel
  .amdhsa_next_free_vgpr 256
  .amdhsa_next_free_sgpr 102
  .amdhsa_accum_offset 256
  .amdhsa_group_segment_fixed_size 0
  .amdhsa_kernarg_size 88
  .amdhsa_user_sgpr_count 2
  .amdhsa_user_sgpr_kernarg_segment_ptr 1
  .amdhsa_system_sgpr_workgroup_id_x 1
.end_amdhsa_kernel
```

```asm
; @launch grid=(256,1,1) block=(512,1,1) lds=163840
.amdgcn_target "amdgcn-amd-amdhsa--gfx950"
.text
.globl sequential_preLN__linear_attn_block__moe_arch_mod__prompt_kernel
.p2align 8
.type sequential_preLN__linear_attn_block__moe_arch_mod__prompt_kernel,@function
sequential_preLN__linear_attn_block__moe_arch_mod__prompt_kernel:
    s_cmp_ge_u32 s2, 256
    s_cbranch_scc1 L_end
    s_load_dwordx16 s[64:79], s[0:1], 0
    s_load_dwordx4 s[80:83], s[0:1], 64
    s_load_dwordx2 s[84:85], s[0:1], 80
    v_lshrrev_b32 v1, 6, v0
    v_and_b32 v0, 63, v0
    v_readfirstlane_b32 s3, v1
    s_and_b32 s44, s2, 7
    s_lshr_b32 s45, s2, 3
    s_and_b32 s46, s44, 1
    s_lshl_b32 s46, s46, 3
    s_and_b32 s86, s45, 7
    s_add_u32 s46, s46, s86
    s_lshr_b32 s47, s44, 1
    s_lshl_b32 s47, s47, 2
    s_lshr_b32 s86, s45, 3
    s_add_u32 s47, s47, s86
    s_mov_b32 s51, s47
    s_mov_b32 s52, s46
    s_and_b32 s48, s3, 3
    s_and_b32 s49, s3, 1
    s_bfe_u32 s50, s3, 0x10001
    s_mov_b32 s56, 65536
    s_mov_b32 s95, 0x3f803f80
    s_movk_i32 s92, 0x1000
    s_movk_i32 s93, 0x2000
    s_movk_i32 s94, 0x3000
    s_cmp_lt_u32 s3, 4
    s_cbranch_scc1 L_comp
    v_lshrrev_b32 v20, 3, v0
    v_and_b32 v21, 7, v0
    v_lshrrev_b32 v22, 4, v0
    v_xor_b32 v23, v21, v22
    v_xor_b32 v24, 4, v23
    s_lshl_b32 s86, s48, 5
    v_add_u32 v25, s86, v20
    v_lshlrev_b32 v25, 11, v25
    v_lshl_add_u32 v2, v23, 4, v25
    v_lshl_add_u32 v3, v24, 4, v25
    v_add_u32 v3, 15360, v3
    v_lshl_add_u32 v4, v23, 4, v25
    v_add_u32 v4, 30720, v4
    v_lshl_add_u32 v5, v24, 4, v25
    v_add_u32 v5, 46080, v5
    s_lshl_b32 s86, s48, 4
    v_add_u32 v25, s86, v20
    v_mul_u32_u24 v25, 6144, v25
    s_lshl_b32 s86, s47, 7
    v_add_u32 v25, s86, v25
    v_bfe_u32 v26, v0, 4, 1
    v_lshlrev_b32 v26, 1, v26
    v_xor_b32 v26, v26, v21
    v_xor_b32 v27, 4, v26
    v_lshl_add_u32 v6, v26, 4, v25
    v_lshl_add_u32 v7, v27, 4, v25
    v_add_u32 v7, 48128, v7
    v_lshl_add_u32 v8, v26, 4, v25
    v_add_u32 v8, 2048, v8
    v_lshl_add_u32 v9, v27, 4, v25
    v_add_u32 v9, 50176, v9
    v_lshl_add_u32 v10, v26, 4, v25
    v_add_u32 v10, 4096, v10
    v_lshl_add_u32 v11, v27, 4, v25
    v_add_u32 v11, 52224, v11
    s_lshl_b32 s63, s46, 18
    s_lshl_b32 s53, s48, 12
    s_lshl_b32 s62, s48, 11
    s_add_u32 s62, s62, 16384
    s_setprio 1
    s_lshl_b32 s86, s45, 2
    s_add_u32 s86, s86, s48
    s_mul_i32 s87, s86, 12288
    s_and_b32 s88, s47, 12
    s_lshl_b32 s88, s88, 7
    s_add_u32 s87, s87, s88
    s_add_u32 s87, s87, 384
    s_bitcmp1_b32 s47, 2
    s_cselect_b32 s87, 2147483648, s87
    v_lshl_add_u32 v37, v0, 11, s87
    v_mov_b32 v24, 2147483648
    v_cmp_gt_u32 vcc, 6, v0
    s_nop 1
    v_cndmask_b32 v37, v24, v37, vcc
    s_lshl_b32 s86, s86, 14
    s_and_b32 s88, s46, 8
    s_lshl_b32 s88, s88, 7
    s_add_u32 s86, s86, s88
    s_add_u32 s86, s86, 384
    v_lshl_add_u32 v38, v0, 11, s86
    v_cmp_gt_u32 vcc, 8, v0
    s_nop 1
    v_cndmask_b32 v38, v24, v38, vcc
    s_waitcnt lgkmcnt(0)
    s_mov_b32 s8, s64
    s_and_b32 s9, s65, 0xffff
    s_mov_b32 s10, 4194304
    s_mov_b32 s11, 0x20000
    s_mov_b32 s12, s66
    s_and_b32 s13, s67, 0xffff
    s_mov_b32 s14, 6291456
    s_mov_b32 s15, 0x20000
    s_and_b32 s86, s47, 12
    s_and_b32 s87, s46, 8
    s_add_u32 s64, s86, s87
    s_and_b32 s64, s64, 15
    s_load_dword s61, s[84:85], 524288
    s_mov_b32 s67, s64
    s_lshr_b32 s90, s67, 2
    s_mul_i32 s90, s90, 1572864
    buffer_load_dword v39, v37, s[12:15], s90 offen
    s_add_u32 m0, s53, 0
    s_lshl_b32 s90, s64, 7
    s_add_u32 s90, s90, s63
    buffer_load_dwordx4 v2, s[8:11], s90 offen offset:0 lds
    buffer_load_dwordx4 v3, s[8:11], s90 offen offset:1024 lds
    buffer_load_dwordx4 v4, s[8:11], s90 offen offset:2048 lds
    buffer_load_dwordx4 v5, s[8:11], s90 offen offset:3072 lds
    s_mul_i32 s91, s64, 393216
    s_add_u32 s64, s64, 1
    s_and_b32 s64, s64, 15
    s_add_u32 m0, s62, 0
    s_nop 0
    buffer_load_dwordx4 v6, s[12:15], s91 offen offset:0 lds
    buffer_load_dwordx4 v7, s[12:15], s91 offen offset:1024 lds
    s_add_u32 m0, s62, 8192
    s_nop 0
    buffer_load_dwordx4 v8, s[12:15], s91 offen offset:0 lds
    buffer_load_dwordx4 v9, s[12:15], s91 offen offset:1024 lds
    s_add_u32 m0, s62, 16384
    s_nop 0
    buffer_load_dwordx4 v10, s[12:15], s91 offen offset:0 lds
    buffer_load_dwordx4 v11, s[12:15], s91 offen offset:1024 lds
    s_mov_b32 s16, s84
    s_and_b32 s17, s85, 0xffff
    s_mov_b32 s18, 268435456
    s_mov_b32 s19, 0x20000
    s_mov_b32 s20, s68
    s_and_b32 s21, s69, 0xffff
    s_mov_b32 s22, 2097152
    s_mov_b32 s23, 0x20000
    s_mov_b32 s24, s80
    s_and_b32 s25, s81, 0xffff
    s_mov_b32 s26, 4194304
    s_mov_b32 s27, 0x20000
    s_mov_b32 s28, s82
    s_and_b32 s29, s83, 0xffff
    s_mov_b32 s30, 256
    s_mov_b32 s31, 0x20000
    s_bitcmp1_b32 s2, 0
    s_cselect_b32 s32, s76, s74
    s_cselect_b32 s33, s77, s75
    s_and_b32 s33, s33, 0xffff
    s_mov_b32 s34, 7340032
    s_mov_b32 s35, 0x20000
    s_mov_b32 s36, s78
    s_and_b32 s37, s79, 0xffff
    s_mov_b32 s38, 7340032
    s_mov_b32 s39, 0x20000
    s_mov_b32 s40, s72
    s_and_b32 s41, s73, 0xffff
    s_mov_b32 s42, 2048
    s_mov_b32 s43, 0x20000
    v_lshrrev_b32 v22, 4, v0
    v_and_b32 v23, 15, v0
    s_add_u32 m0, s53, 40960
    s_lshl_b32 s90, s64, 7
    s_add_u32 s90, s90, s63
    buffer_load_dwordx4 v2, s[8:11], s90 offen offset:0 lds
    buffer_load_dwordx4 v3, s[8:11], s90 offen offset:1024 lds
    buffer_load_dwordx4 v4, s[8:11], s90 offen offset:2048 lds
    buffer_load_dwordx4 v5, s[8:11], s90 offen offset:3072 lds
    s_mul_i32 s91, s64, 393216
    s_add_u32 s64, s64, 1
    s_and_b32 s64, s64, 15
    s_add_u32 m0, s62, 40960
    s_nop 0
    buffer_load_dwordx4 v6, s[12:15], s91 offen offset:0 lds
    buffer_load_dwordx4 v7, s[12:15], s91 offen offset:1024 lds
    s_add_u32 m0, s62, 49152
    s_nop 0
    buffer_load_dwordx4 v8, s[12:15], s91 offen offset:0 lds
    buffer_load_dwordx4 v9, s[12:15], s91 offen offset:1024 lds
    s_add_u32 m0, s62, 57344
    s_nop 0
    buffer_load_dwordx4 v10, s[12:15], s91 offen offset:0 lds
    buffer_load_dwordx4 v11, s[12:15], s91 offen offset:1024 lds
    s_and_b32 s65, s45, 7
    s_lshr_b32 s66, s45, 3
    s_mul_i32 s86, s65, 11
    s_lshr_b32 s86, s86, 5
    s_mul_i32 s86, s86, 3
    s_sub_u32 s86, s65, s86
    s_mul_i32 s86, s86, 40960
    s_lshl_b32 s87, s48, 13
    s_cmp_eq_u32 s48, 3
    s_cselect_b32 s87, 0, s87
    s_add_u32 s86, s86, s87
    s_add_u32 s86, s86, 16384
    v_lshl_add_u32 v25, v20, 7, s86
    v_lshl_add_u32 v28, v26, 4, v25
    v_lshl_add_u32 v29, v27, 4, v25
    s_cmp_eq_u32 s66, 3
    s_cselect_b32 s86, 0, s66
    s_mul_i32 s86, s86, 40960
    s_add_u32 s86, s86, s53
    v_lshl_add_u32 v16, v0, 6, s86
    v_bfe_u32 v25, v0, 2, 2
    v_lshl_add_u32 v16, v25, 4, v16
    v_xor_b32 v17, 16, v16
    v_xor_b32 v18, 32, v16
    v_xor_b32 v19, 48, v16
    s_lshl_b32 s86, s46, 14
    s_lshl_b32 s87, s48, 8
    s_add_u32 s86, s86, s87
    s_add_u32 s86, s86, 262144
    v_lshl_add_u32 v33, v23, 4, s86
    v_lshl_add_u32 v33, v22, 10, v33
    s_lshl_b32 s87, s47, 10
    s_add_u32 s86, s86, s87
    v_lshl_add_u32 v13, v0, 2, s86
    v_and_b32 v25, 3, v0
    v_cmp_eq_u32 vcc, 0, v25
    v_mov_b32 v24, 2147483648
    s_nop 0
    v_cndmask_b32 v13, v24, v13, vcc
    s_mul_i32 s86, s47, 12288
    s_add_u32 s86, s86, 65536
    s_lshl_b32 s87, s48, 8
    s_cmp_eq_u32 s48, 3
    s_cselect_b32 s87, 0, s87
    s_cselect_b32 s88, 2147483648, 0
    s_add_u32 s86, s86, s87
    v_lshl_add_u32 v32, v23, 4, s86
    v_mul_u32_u24 v25, 768, v22
    v_add_u32 v32, v32, v25
    s_mul_i32 s87, s46, 768
    s_add_u32 s86, s86, s87
    s_add_u32 s86, s86, s88
    v_lshl_add_u32 v34, v23, 5, s86
    v_lshl_add_u32 v34, v22, 4, v34
    v_and_b32 v25, 0x28, v0
    v_cmp_eq_u32 vcc, 0, v25
    s_nop 1
    v_cndmask_b32 v34, v24, v34, vcc
    s_bfe_u32 s86, s2, 0x20001
    s_lshl_b32 s86, s86, 2
    s_add_u32 s86, s86, s48
    s_lshl_b32 s86, s86, 6
    v_lshl_add_u32 v30, v22, 4, s86
    v_mul_u32_u24 v30, 7168, v30
    s_lshl_b32 s86, s45, 8
    s_cmp_ge_u32 s2, 224
    s_cselect_b32 s86, 2147483648, s86
    v_lshl_add_u32 v24, v23, 4, s86
    v_add_u32 v30, v30, v24
    s_mul_i32 s86, s45, 112
    s_mul_i32 s87, s48, 28
    s_add_u32 s86, s86, s87
    v_mul_u32_u24 v31, 7, v22
    v_add_u32 v31, s86, v31
    v_lshlrev_b32 v31, 11, v31
    s_lshl_b32 s86, s44, 8
    v_lshl_add_u32 v24, v23, 4, s86
    v_add_u32 v31, v31, v24
    v_lshlrev_b32 v24, 1, v22
    v_xor_b32 v24, v24, v21
    s_lshl_b32 s86, s48, 3
    v_add_u32 v12, s86, v20
    v_lshlrev_b32 v12, 11, v12
    s_lshl_b32 s86, s52, 7
    v_lshl_add_u32 v24, v24, 4, s86
    v_add_u32 v12, v12, v24
    s_lshl_b32 s89, s48, 10
    v_and_b32 v24, 1, v0
    v_lshlrev_b32 v24, 4, v24
    v_mov_b32 v25, 0x3f80
    v_lshlrev_b32 v24, v24, v25
    v_bfe_u32 v25, v0, 1, 2
    v_cmp_eq_u32 vcc, 0, v25
    s_nop 1
    v_cndmask_b32 v104, 0, v24, vcc
    v_cmp_eq_u32 vcc, 1, v25
    s_nop 1
    v_cndmask_b32 v105, 0, v24, vcc
    v_cmp_eq_u32 vcc, 2, v25
    s_nop 1
    v_cndmask_b32 v106, 0, v24, vcc
    v_cmp_eq_u32 vcc, 3, v25
    s_nop 1
    v_cndmask_b32 v107, 0, v24, vcc
    s_waitcnt lgkmcnt(0)
    s_add_u32 s68, s61, 0x9e3779b9
    v_mov_b32 v35, s68
    s_lshl_b32 s86, s46, 2
    s_add_u32 s86, s86, s48
    s_lshl_b32 s86, s86, 7
    s_add_u32 s86, s86, 655360
    s_lshl_b32 s87, s47, 2
    s_add_u32 s87, s87, s48
    s_lshl_b32 s87, s87, 7
    s_add_u32 s87, s87, 663552
    s_cmp_eq_u32 s48, 3
    s_cselect_b32 s87, 2147483648, s87
    s_cselect_b32 s76, 0xffff, -1
    s_mov_b32 s77, 0
    v_mov_b32 v24, s86
    v_mov_b32 v25, s87
    v_cmp_gt_u32 vcc, 16, v0
    s_nop 1
    v_cndmask_b32 v117, v25, v24, vcc
    v_lshl_add_u32 v117, v23, 2, v117
    v_mov_b32 v116, 2147483648
    v_cmp_gt_u32 vcc, 32, v0
    s_nop 1
    v_cndmask_b32 v117, v116, v117, vcc
    s_lshl2_add_u32 s86, s47, s86
    s_lshl2_add_u32 s87, s46, s87
    v_writelane_b32 v116, s86, 0
    v_writelane_b32 v116, s87, 1
    v_mov_b32 v24, 135168
    v_lshl_add_u32 v24, v21, 2, v24
    v_mov_b32 v25, 0
    ds_write_b32 v24, v25
    s_waitcnt lgkmcnt(0)
    s_waitcnt vmcnt(10)
    s_barrier
    s_add_u32 m0, s53, 81920
    s_lshl_b32 s90, s64, 7
    s_add_u32 s90, s90, s63
    buffer_load_dwordx4 v2, s[8:11], s90 offen offset:0 lds
    buffer_load_dwordx4 v3, s[8:11], s90 offen offset:1024 lds
    buffer_load_dwordx4 v4, s[8:11], s90 offen offset:2048 lds
    buffer_load_dwordx4 v5, s[8:11], s90 offen offset:3072 lds
    s_mul_i32 s91, s64, 393216
    s_add_u32 s64, s64, 1
    s_and_b32 s64, s64, 15
    s_add_u32 m0, s62, 81920
    s_nop 0
    buffer_load_dwordx4 v6, s[12:15], s91 offen offset:0 lds
    buffer_load_dwordx4 v7, s[12:15], s91 offen offset:1024 lds
    s_add_u32 m0, s62, 90112
    s_nop 0
    buffer_load_dwordx4 v8, s[12:15], s91 offen offset:0 lds
    buffer_load_dwordx4 v9, s[12:15], s91 offen offset:1024 lds
    s_add_u32 m0, s62, 98304
    s_nop 0
    buffer_load_dwordx4 v10, s[12:15], s91 offen offset:0 lds
    buffer_load_dwordx4 v11, s[12:15], s91 offen offset:1024 lds
    s_lshr_b32 s90, s67, 2
    s_add_u32 s90, s90, 1
    s_and_b32 s90, s90, 3
    s_mul_i32 s90, s90, 1572864
    buffer_load_dword v39, v37, s[12:15], s90 offen
    s_cmp_lg_u32 s65, 0
    s_cbranch_scc1 L_h0c0
    ds_read_b128 v[40:43], v28 offset:0
    ds_read_b128 v[44:47], v29 offset:1024
    ds_read_b128 v[48:51], v28 offset:2048
    ds_read_b128 v[52:55], v29 offset:3072
    ds_read_b128 v[56:59], v28 offset:4096
    ds_read_b128 v[60:63], v29 offset:5120
    ds_read_b128 v[64:67], v28 offset:6144
    ds_read_b128 v[68:71], v29 offset:7168
L_h0c0:
    s_cmp_lg_u32 s66, 0
    s_cbranch_scc1 L_h0r0
    ds_read_b128 v[72:75], v16
    ds_read_b128 v[76:79], v17
    ds_read_b128 v[80:83], v18
    ds_read_b128 v[84:87], v19
L_h0r0:
    s_waitcnt lgkmcnt(0)
    s_waitcnt vmcnt(11)
    s_barrier
    s_add_u32 m0, s53, 0
    s_lshl_b32 s90, s64, 7
    s_add_u32 s90, s90, s63
    buffer_load_dwordx4 v2, s[8:11], s90 offen offset:0 lds
    buffer_load_dwordx4 v3, s[8:11], s90 offen offset:1024 lds
    buffer_load_dwordx4 v4, s[8:11], s90 offen offset:2048 lds
    buffer_load_dwordx4 v5, s[8:11], s90 offen offset:3072 lds
    s_mul_i32 s91, s64, 393216
    s_add_u32 s64, s64, 1
    s_and_b32 s64, s64, 15
    s_add_u32 m0, s62, 0
    s_nop 0
    buffer_load_dwordx4 v6, s[12:15], s91 offen offset:0 lds
    buffer_load_dwordx4 v7, s[12:15], s91 offen offset:1024 lds
    s_add_u32 m0, s62, 8192
    s_nop 0
    buffer_load_dwordx4 v8, s[12:15], s91 offen offset:0 lds
    buffer_load_dwordx4 v9, s[12:15], s91 offen offset:1024 lds
    s_add_u32 m0, s62, 16384
    s_nop 0
    buffer_load_dwordx4 v10, s[12:15], s91 offen offset:0 lds
    buffer_load_dwordx4 v11, s[12:15], s91 offen offset:1024 lds
    s_cmp_lg_u32 s65, 1
    s_cbranch_scc1 L_h0c1
    ds_read_b128 v[40:43], v28 offset:0
    ds_read_b128 v[44:47], v29 offset:1024
    ds_read_b128 v[48:51], v28 offset:2048
    ds_read_b128 v[52:55], v29 offset:3072
    ds_read_b128 v[56:59], v28 offset:4096
    ds_read_b128 v[60:63], v29 offset:5120
    ds_read_b128 v[64:67], v28 offset:6144
    ds_read_b128 v[68:71], v29 offset:7168
L_h0c1:
    s_cmp_lg_u32 s66, 1
    s_cbranch_scc1 L_h0r1
    ds_read_b128 v[72:75], v16
    ds_read_b128 v[76:79], v17
    ds_read_b128 v[80:83], v18
    ds_read_b128 v[84:87], v19
L_h0r1:
    s_waitcnt lgkmcnt(0)
    s_waitcnt vmcnt(11)
    s_barrier
    s_add_u32 m0, s53, 40960
    s_lshl_b32 s90, s64, 7
    s_add_u32 s90, s90, s63
    buffer_load_dwordx4 v2, s[8:11], s90 offen offset:0 lds
    buffer_load_dwordx4 v3, s[8:11], s90 offen offset:1024 lds
    buffer_load_dwordx4 v4, s[8:11], s90 offen offset:2048 lds
    buffer_load_dwordx4 v5, s[8:11], s90 offen offset:3072 lds
    s_mul_i32 s91, s64, 393216
    s_add_u32 s64, s64, 1
    s_and_b32 s64, s64, 15
    s_add_u32 m0, s62, 40960
    s_nop 0
    buffer_load_dwordx4 v6, s[12:15], s91 offen offset:0 lds
    buffer_load_dwordx4 v7, s[12:15], s91 offen offset:1024 lds
    s_add_u32 m0, s62, 49152
    s_nop 0
    buffer_load_dwordx4 v8, s[12:15], s91 offen offset:0 lds
    buffer_load_dwordx4 v9, s[12:15], s91 offen offset:1024 lds
    s_add_u32 m0, s62, 57344
    s_nop 0
    buffer_load_dwordx4 v10, s[12:15], s91 offen offset:0 lds
    buffer_load_dwordx4 v11, s[12:15], s91 offen offset:1024 lds
    s_cmp_lg_u32 s65, 2
    s_cbranch_scc1 L_h0c2
    ds_read_b128 v[40:43], v28 offset:0
    ds_read_b128 v[44:47], v29 offset:1024
    ds_read_b128 v[48:51], v28 offset:2048
    ds_read_b128 v[52:55], v29 offset:3072
    ds_read_b128 v[56:59], v28 offset:4096
    ds_read_b128 v[60:63], v29 offset:5120
    ds_read_b128 v[64:67], v28 offset:6144
    ds_read_b128 v[68:71], v29 offset:7168
L_h0c2:
    s_cmp_lg_u32 s66, 2
    s_cbranch_scc1 L_h0r2
    ds_read_b128 v[72:75], v16
    ds_read_b128 v[76:79], v17
    ds_read_b128 v[80:83], v18
    ds_read_b128 v[84:87], v19
L_h0r2:
    s_waitcnt lgkmcnt(0)
    s_waitcnt vmcnt(10)
    s_barrier
    s_add_u32 m0, s53, 81920
    s_lshl_b32 s90, s64, 7
    s_add_u32 s90, s90, s63
    buffer_load_dwordx4 v2, s[8:11], s90 offen offset:0 lds
    buffer_load_dwordx4 v3, s[8:11], s90 offen offset:1024 lds
    buffer_load_dwordx4 v4, s[8:11], s90 offen offset:2048 lds
    buffer_load_dwordx4 v5, s[8:11], s90 offen offset:3072 lds
    s_mul_i32 s91, s64, 393216
    s_add_u32 s64, s64, 1
    s_and_b32 s64, s64, 15
    s_add_u32 m0, s62, 81920
    s_nop 0
    buffer_load_dwordx4 v6, s[12:15], s91 offen offset:0 lds
    buffer_load_dwordx4 v7, s[12:15], s91 offen offset:1024 lds
    s_add_u32 m0, s62, 90112
    s_nop 0
    buffer_load_dwordx4 v8, s[12:15], s91 offen offset:0 lds
    buffer_load_dwordx4 v9, s[12:15], s91 offen offset:1024 lds
    s_add_u32 m0, s62, 98304
    s_nop 0
    buffer_load_dwordx4 v10, s[12:15], s91 offen offset:0 lds
    buffer_load_dwordx4 v11, s[12:15], s91 offen offset:1024 lds
    s_lshr_b32 s90, s67, 2
    s_add_u32 s90, s90, 2
    s_and_b32 s90, s90, 3
    s_mul_i32 s90, s90, 1572864
    buffer_load_dword v39, v37, s[12:15], s90 offen
    s_cmp_lg_u32 s65, 3
    s_cbranch_scc1 L_h0c3
    ds_read_b128 v[40:43], v28 offset:0
    ds_read_b128 v[44:47], v29 offset:1024
    ds_read_b128 v[48:51], v28 offset:2048
    ds_read_b128 v[52:55], v29 offset:3072
    ds_read_b128 v[56:59], v28 offset:4096
    ds_read_b128 v[60:63], v29 offset:5120
    ds_read_b128 v[64:67], v28 offset:6144
    ds_read_b128 v[68:71], v29 offset:7168
L_h0c3:
    s_cmp_lg_u32 s66, 3
    s_cbranch_scc1 L_h0r3
    ds_read_b128 v[72:75], v16
    ds_read_b128 v[76:79], v17
    ds_read_b128 v[80:83], v18
    ds_read_b128 v[84:87], v19
L_h0r3:
    s_waitcnt lgkmcnt(0)
    s_waitcnt vmcnt(11)
    s_barrier
    s_add_u32 m0, s53, 0
    s_lshl_b32 s90, s64, 7
    s_add_u32 s90, s90, s63
    buffer_load_dwordx4 v2, s[8:11], s90 offen offset:0 lds
    buffer_load_dwordx4 v3, s[8:11], s90 offen offset:1024 lds
    buffer_load_dwordx4 v4, s[8:11], s90 offen offset:2048 lds
    buffer_load_dwordx4 v5, s[8:11], s90 offen offset:3072 lds
    s_mul_i32 s91, s64, 393216
    s_add_u32 s64, s64, 1
    s_and_b32 s64, s64, 15
    s_add_u32 m0, s62, 0
    s_nop 0
    buffer_load_dwordx4 v6, s[12:15], s91 offen offset:0 lds
    buffer_load_dwordx4 v7, s[12:15], s91 offen offset:1024 lds
    s_add_u32 m0, s62, 8192
    s_nop 0
    buffer_load_dwordx4 v8, s[12:15], s91 offen offset:0 lds
    buffer_load_dwordx4 v9, s[12:15], s91 offen offset:1024 lds
    s_add_u32 m0, s62, 16384
    s_nop 0
    buffer_load_dwordx4 v10, s[12:15], s91 offen offset:0 lds
    buffer_load_dwordx4 v11, s[12:15], s91 offen offset:1024 lds
    s_cmp_lg_u32 s65, 4
    s_cbranch_scc1 L_h0c4
    ds_read_b128 v[40:43], v28 offset:0
    ds_read_b128 v[44:47], v29 offset:1024
    ds_read_b128 v[48:51], v28 offset:2048
    ds_read_b128 v[52:55], v29 offset:3072
    ds_read_b128 v[56:59], v28 offset:4096
    ds_read_b128 v[60:63], v29 offset:5120
    ds_read_b128 v[64:67], v28 offset:6144
    ds_read_b128 v[68:71], v29 offset:7168
L_h0c4:
    s_waitcnt lgkmcnt(0)
    v_mov_b32 v88, 0
    v_mov_b32 v89, 0
    v_mov_b32 v90, 0
    v_mov_b32 v91, 0
    v_mov_b32 v92, 0
    v_mov_b32 v93, 0
    v_mov_b32 v94, 0
    v_mov_b32 v95, 0
    v_dot2c_f32_bf16 v88, s95, v72
    v_dot2c_f32_bf16 v89, s95, v73
    v_dot2c_f32_bf16 v90, s95, v74
    v_dot2c_f32_bf16 v91, s95, v75
    v_dot2c_f32_bf16 v92, v72, v72
    v_dot2c_f32_bf16 v93, v73, v73
    v_dot2c_f32_bf16 v94, v74, v74
    v_dot2c_f32_bf16 v95, v75, v75
    v_dot2c_f32_bf16 v88, s95, v76
    v_dot2c_f32_bf16 v89, s95, v77
    v_dot2c_f32_bf16 v90, s95, v78
    v_dot2c_f32_bf16 v91, s95, v79
    v_dot2c_f32_bf16 v92, v76, v76
    v_dot2c_f32_bf16 v93, v77, v77
    v_dot2c_f32_bf16 v94, v78, v78
    v_dot2c_f32_bf16 v95, v79, v79
    v_dot2c_f32_bf16 v88, s95, v80
    v_dot2c_f32_bf16 v89, s95, v81
    v_dot2c_f32_bf16 v90, s95, v82
    v_dot2c_f32_bf16 v91, s95, v83
    v_dot2c_f32_bf16 v92, v80, v80
    v_dot2c_f32_bf16 v93, v81, v81
    v_dot2c_f32_bf16 v94, v82, v82
    v_dot2c_f32_bf16 v95, v83, v83
    v_dot2c_f32_bf16 v88, s95, v84
    v_dot2c_f32_bf16 v89, s95, v85
    v_dot2c_f32_bf16 v90, s95, v86
    v_dot2c_f32_bf16 v91, s95, v87
    v_dot2c_f32_bf16 v92, v84, v84
    v_dot2c_f32_bf16 v93, v85, v85
    v_dot2c_f32_bf16 v94, v86, v86
    v_dot2c_f32_bf16 v95, v87, v87
    s_waitcnt vmcnt(11)
    s_barrier
    s_add_u32 m0, s53, 40960
    s_lshl_b32 s90, s64, 7
    s_add_u32 s90, s90, s63
    buffer_load_dwordx4 v2, s[8:11], s90 offen offset:0 lds
    buffer_load_dwordx4 v3, s[8:11], s90 offen offset:1024 lds
    buffer_load_dwordx4 v4, s[8:11], s90 offen offset:2048 lds
    buffer_load_dwordx4 v5, s[8:11], s90 offen offset:3072 lds
    s_mul_i32 s91, s64, 393216
    s_add_u32 s64, s64, 1
    s_and_b32 s64, s64, 15
    s_add_u32 m0, s62, 40960
    s_nop 0
    buffer_load_dwordx4 v6, s[12:15], s91 offen offset:0 lds
    buffer_load_dwordx4 v7, s[12:15], s91 offen offset:1024 lds
    s_add_u32 m0, s62, 49152
    s_nop 0
    buffer_load_dwordx4 v8, s[12:15], s91 offen offset:0 lds
    buffer_load_dwordx4 v9, s[12:15], s91 offen offset:1024 lds
    s_add_u32 m0, s62, 57344
    s_nop 0
    buffer_load_dwordx4 v10, s[12:15], s91 offen offset:0 lds
    buffer_load_dwordx4 v11, s[12:15], s91 offen offset:1024 lds
    buffer_load_dword v39, v38, s[20:23], 0 offen
    s_cmp_lg_u32 s65, 5
    s_cbranch_scc1 L_h0c5
    ds_read_b128 v[40:43], v28 offset:0
    ds_read_b128 v[44:47], v29 offset:1024
    ds_read_b128 v[48:51], v28 offset:2048
    ds_read_b128 v[52:55], v29 offset:3072
    ds_read_b128 v[56:59], v28 offset:4096
    ds_read_b128 v[60:63], v29 offset:5120
    ds_read_b128 v[64:67], v28 offset:6144
    ds_read_b128 v[68:71], v29 offset:7168
L_h0c5:
    s_waitcnt lgkmcnt(0)
    v_pk_add_f32 v[88:89], v[88:89], v[90:91]
    v_pk_add_f32 v[92:93], v[92:93], v[94:95]
    v_add_f32 v88, v88, v89
    v_add_f32 v89, v92, v93
    s_nop 0
    v_add_f32_dpp v88, v88, v88 quad_perm:[1,0,3,2] row_mask:0xf bank_mask:0xf
    v_add_f32_dpp v89, v89, v89 quad_perm:[1,0,3,2] row_mask:0xf bank_mask:0xf
    s_nop 0
    v_mov_b32_dpp v90, v88 quad_perm:[2,2,2,2] row_mask:0xf bank_mask:0xf
    v_mov_b32_dpp v91, v89 quad_perm:[2,2,2,2] row_mask:0xf bank_mask:0xf
    buffer_store_dwordx4 v[88:91], v13, s[16:19], 0 offen sc1
    s_lshl_b32 s86, s48, 7
    s_add_u32 s86, s86, 131072
    v_lshl_add_u32 v16, v23, 3, s86
    v_lshrrev_b32 v17, 5, v0
    v_lshl_add_u32 v16, v17, 2, v16
    s_lshl_b32 s86, s48, 8
    s_add_u32 s86, s86, 132608
    v_lshl_add_u32 v17, v23, 4, s86
    v_lshl_add_u32 v17, v22, 2, v17
    s_waitcnt vmcnt(12)
    s_barrier
    s_add_u32 m0, s53, 81920
    s_lshl_b32 s90, s64, 7
    s_add_u32 s90, s90, s63
    buffer_load_dwordx4 v2, s[8:11], s90 offen offset:0 lds
    buffer_load_dwordx4 v3, s[8:11], s90 offen offset:1024 lds
    buffer_load_dwordx4 v4, s[8:11], s90 offen offset:2048 lds
    buffer_load_dwordx4 v5, s[8:11], s90 offen offset:3072 lds
    s_mul_i32 s91, s64, 393216
    s_add_u32 s64, s64, 1
    s_and_b32 s64, s64, 15
    s_add_u32 m0, s62, 81920
    s_nop 0
    buffer_load_dwordx4 v6, s[12:15], s91 offen offset:0 lds
    buffer_load_dwordx4 v7, s[12:15], s91 offen offset:1024 lds
    s_add_u32 m0, s62, 90112
    s_nop 0
    buffer_load_dwordx4 v8, s[12:15], s91 offen offset:0 lds
    buffer_load_dwordx4 v9, s[12:15], s91 offen offset:1024 lds
    s_add_u32 m0, s62, 98304
    s_nop 0
    buffer_load_dwordx4 v10, s[12:15], s91 offen offset:0 lds
    buffer_load_dwordx4 v11, s[12:15], s91 offen offset:1024 lds
    s_lshr_b32 s90, s67, 2
    s_add_u32 s90, s90, 3
    s_and_b32 s90, s90, 3
    s_mul_i32 s90, s90, 1572864
    buffer_load_dword v39, v37, s[12:15], s90 offen
    s_cmp_lg_u32 s65, 6
    s_cbranch_scc1 L_h0c6
    ds_read_b128 v[40:43], v28 offset:0
    ds_read_b128 v[44:47], v29 offset:1024
    ds_read_b128 v[48:51], v28 offset:2048
    ds_read_b128 v[52:55], v29 offset:3072
    ds_read_b128 v[56:59], v28 offset:4096
    ds_read_b128 v[60:63], v29 offset:5120
    ds_read_b128 v[64:67], v28 offset:6144
    ds_read_b128 v[68:71], v29 offset:7168
L_h0c6:
    s_waitcnt lgkmcnt(0)
    s_waitcnt vmcnt(13)
    s_barrier
    s_add_u32 m0, s53, 0
    s_lshl_b32 s90, s64, 7
    s_add_u32 s90, s90, s63
    buffer_load_dwordx4 v2, s[8:11], s90 offen offset:0 lds
    buffer_load_dwordx4 v3, s[8:11], s90 offen offset:1024 lds
    buffer_load_dwordx4 v4, s[8:11], s90 offen offset:2048 lds
    buffer_load_dwordx4 v5, s[8:11], s90 offen offset:3072 lds
    s_mul_i32 s91, s64, 393216
    s_add_u32 s64, s64, 1
    s_and_b32 s64, s64, 15
    s_add_u32 m0, s62, 0
    s_nop 0
    buffer_load_dwordx4 v6, s[12:15], s91 offen offset:0 lds
    buffer_load_dwordx4 v7, s[12:15], s91 offen offset:1024 lds
    s_add_u32 m0, s62, 8192
    s_nop 0
    buffer_load_dwordx4 v8, s[12:15], s91 offen offset:0 lds
    buffer_load_dwordx4 v9, s[12:15], s91 offen offset:1024 lds
    s_add_u32 m0, s62, 16384
    s_nop 0
    buffer_load_dwordx4 v10, s[12:15], s91 offen offset:0 lds
    buffer_load_dwordx4 v11, s[12:15], s91 offen offset:1024 lds
    s_cmp_lg_u32 s65, 7
    s_cbranch_scc1 L_h0c7
    ds_read_b128 v[40:43], v28 offset:0
    ds_read_b128 v[44:47], v29 offset:1024
    ds_read_b128 v[48:51], v28 offset:2048
    ds_read_b128 v[52:55], v29 offset:3072
    ds_read_b128 v[56:59], v28 offset:4096
    ds_read_b128 v[60:63], v29 offset:5120
    ds_read_b128 v[64:67], v28 offset:6144
    ds_read_b128 v[68:71], v29 offset:7168
L_h0c7:
    s_waitcnt lgkmcnt(0)
    s_waitcnt vmcnt(11)
    s_barrier
    s_add_u32 m0, s53, 40960
    s_lshl_b32 s90, s64, 7
    s_add_u32 s90, s90, s63
    buffer_load_dwordx4 v2, s[8:11], s90 offen offset:0 lds
    buffer_load_dwordx4 v3, s[8:11], s90 offen offset:1024 lds
    buffer_load_dwordx4 v4, s[8:11], s90 offen offset:2048 lds
    buffer_load_dwordx4 v5, s[8:11], s90 offen offset:3072 lds
    s_mul_i32 s91, s64, 393216
    s_add_u32 s64, s64, 1
    s_and_b32 s64, s64, 15
    s_add_u32 m0, s62, 40960
    s_nop 0
    buffer_load_dwordx4 v6, s[12:15], s91 offen offset:0 lds
    buffer_load_dwordx4 v7, s[12:15], s91 offen offset:1024 lds
    s_add_u32 m0, s62, 49152
    s_nop 0
    buffer_load_dwordx4 v8, s[12:15], s91 offen offset:0 lds
    buffer_load_dwordx4 v9, s[12:15], s91 offen offset:1024 lds
    s_add_u32 m0, s62, 57344
    s_nop 0
    buffer_load_dwordx4 v10, s[12:15], s91 offen offset:0 lds
    buffer_load_dwordx4 v11, s[12:15], s91 offen offset:1024 lds
    v_mfma_f32_16x16x32_bf16 v[108:111], v[104:107], v[40:43], 0
    v_mfma_f32_16x16x32_bf16 v[108:111], v[104:107], v[44:47], v[108:111]
    v_mfma_f32_16x16x32_bf16 v[108:111], v[104:107], v[48:51], v[108:111]
    v_mfma_f32_16x16x32_bf16 v[108:111], v[104:107], v[52:55], v[108:111]
    v_mfma_f32_16x16x32_bf16 v[108:111], v[104:107], v[56:59], v[108:111]
    v_mfma_f32_16x16x32_bf16 v[108:111], v[104:107], v[60:63], v[108:111]
    v_mfma_f32_16x16x32_bf16 v[108:111], v[104:107], v[64:67], v[108:111]
    v_mfma_f32_16x16x32_bf16 v[108:111], v[104:107], v[68:71], v[108:111]
    s_nop 7
    v_add_f32_dpp v108, v108, v108 row_ror:8 row_mask:0xf bank_mask:0xf
    v_add_f32_dpp v109, v109, v109 row_ror:8 row_mask:0xf bank_mask:0xf
    v_add_f32_dpp v110, v110, v110 row_ror:8 row_mask:0xf bank_mask:0xf
    v_add_f32_dpp v111, v111, v111 row_ror:8 row_mask:0xf bank_mask:0xf
    buffer_store_dwordx4 v[108:111], v34, s[16:19], 0 offen sc1
    s_waitcnt vmcnt(11)
    s_barrier
    s_add_u32 m0, s53, 81920
    s_lshl_b32 s90, s64, 7
    s_add_u32 s90, s90, s63
    buffer_load_dwordx4 v2, s[8:11], s90 offen offset:0 lds
    buffer_load_dwordx4 v3, s[8:11], s90 offen offset:1024 lds
    buffer_load_dwordx4 v4, s[8:11], s90 offen offset:2048 lds
    buffer_load_dwordx4 v5, s[8:11], s90 offen offset:3072 lds
    s_mul_i32 s91, s64, 393216
    s_add_u32 s64, s64, 1
    s_and_b32 s64, s64, 15
    s_add_u32 m0, s62, 81920
    s_nop 0
    buffer_load_dwordx4 v6, s[12:15], s91 offen offset:0 lds
    buffer_load_dwordx4 v7, s[12:15], s91 offen offset:1024 lds
    s_add_u32 m0, s62, 90112
    s_nop 0
    buffer_load_dwordx4 v8, s[12:15], s91 offen offset:0 lds
    buffer_load_dwordx4 v9, s[12:15], s91 offen offset:1024 lds
    s_add_u32 m0, s62, 98304
    s_nop 0
    buffer_load_dwordx4 v10, s[12:15], s91 offen offset:0 lds
    buffer_load_dwordx4 v11, s[12:15], s91 offen offset:1024 lds
    s_waitcnt vmcnt(10)
    s_barrier
    buffer_atomic_swap v35, v116, s[16:19], 0 offen sc1
    s_add_u32 m0, s53, 0
    s_lshl_b32 s90, s64, 7
    s_add_u32 s90, s90, s63
    buffer_load_dwordx4 v2, s[8:11], s90 offen offset:0 lds
    buffer_load_dwordx4 v3, s[8:11], s90 offen offset:1024 lds
    buffer_load_dwordx4 v4, s[8:11], s90 offen offset:2048 lds
    buffer_load_dwordx4 v5, s[8:11], s90 offen offset:3072 lds
    s_mul_i32 s91, s64, 393216
    s_add_u32 s64, s64, 1
    s_and_b32 s64, s64, 15
    s_add_u32 m0, s62, 0
    s_nop 0
    buffer_load_dwordx4 v6, s[12:15], s91 offen offset:0 lds
    buffer_load_dwordx4 v7, s[12:15], s91 offen offset:1024 lds
    s_add_u32 m0, s62, 8192
    s_nop 0
    buffer_load_dwordx4 v8, s[12:15], s91 offen offset:0 lds
    buffer_load_dwordx4 v9, s[12:15], s91 offen offset:1024 lds
    s_add_u32 m0, s62, 16384
    s_nop 0
    buffer_load_dwordx4 v10, s[12:15], s91 offen offset:0 lds
    buffer_load_dwordx4 v11, s[12:15], s91 offen offset:1024 lds
    s_waitcnt vmcnt(11)
    s_barrier
    s_add_u32 m0, s53, 40960
    s_lshl_b32 s90, s64, 7
    s_add_u32 s90, s90, s63
    buffer_load_dwordx4 v2, s[8:11], s90 offen offset:0 lds
    buffer_load_dwordx4 v3, s[8:11], s90 offen offset:1024 lds
    buffer_load_dwordx4 v4, s[8:11], s90 offen offset:2048 lds
    buffer_load_dwordx4 v5, s[8:11], s90 offen offset:3072 lds
    s_mul_i32 s91, s64, 393216
    s_add_u32 s64, s64, 1
    s_and_b32 s64, s64, 15
    s_add_u32 m0, s62, 40960
    s_nop 0
    buffer_load_dwordx4 v6, s[12:15], s91 offen offset:0 lds
    buffer_load_dwordx4 v7, s[12:15], s91 offen offset:1024 lds
    s_add_u32 m0, s62, 49152
    s_nop 0
    buffer_load_dwordx4 v8, s[12:15], s91 offen offset:0 lds
    buffer_load_dwordx4 v9, s[12:15], s91 offen offset:1024 lds
    s_add_u32 m0, s62, 57344
    s_nop 0
    buffer_load_dwordx4 v10, s[12:15], s91 offen offset:0 lds
    buffer_load_dwordx4 v11, s[12:15], s91 offen offset:1024 lds
    s_waitcnt vmcnt(10)
    s_barrier
    s_add_u32 m0, s53, 81920
    s_lshl_b32 s90, s64, 7
    s_add_u32 s90, s90, s63
    buffer_load_dwordx4 v2, s[8:11], s90 offen offset:0 lds
    buffer_load_dwordx4 v3, s[8:11], s90 offen offset:1024 lds
    buffer_load_dwordx4 v4, s[8:11], s90 offen offset:2048 lds
    buffer_load_dwordx4 v5, s[8:11], s90 offen offset:3072 lds
    s_mul_i32 s91, s64, 393216
    s_add_u32 s64, s64, 1
    s_and_b32 s64, s64, 15
    s_add_u32 m0, s62, 81920
    s_nop 0
    buffer_load_dwordx4 v6, s[12:15], s91 offen offset:0 lds
    buffer_load_dwordx4 v7, s[12:15], s91 offen offset:1024 lds
    s_add_u32 m0, s62, 90112
    s_nop 0
    buffer_load_dwordx4 v8, s[12:15], s91 offen offset:0 lds
    buffer_load_dwordx4 v9, s[12:15], s91 offen offset:1024 lds
    s_add_u32 m0, s62, 98304
    s_nop 0
    buffer_load_dwordx4 v10, s[12:15], s91 offen offset:0 lds
    buffer_load_dwordx4 v11, s[12:15], s91 offen offset:1024 lds
    s_waitcnt vmcnt(10)
    s_barrier
    v_mov_b32 v118, 0
    buffer_atomic_or v118, v117, s[16:19], 0 offen sc0 sc1
    s_add_u32 m0, s53, 0
    s_lshl_b32 s90, s64, 7
    s_add_u32 s90, s90, s63
    buffer_load_dwordx4 v2, s[8:11], s90 offen offset:0 lds
    buffer_load_dwordx4 v3, s[8:11], s90 offen offset:1024 lds
    buffer_load_dwordx4 v4, s[8:11], s90 offen offset:2048 lds
    buffer_load_dwordx4 v5, s[8:11], s90 offen offset:3072 lds
    s_mul_i32 s91, s64, 393216
    s_add_u32 s64, s64, 1
    s_and_b32 s64, s64, 15
    s_add_u32 m0, s62, 0
    s_nop 0
    buffer_load_dwordx4 v6, s[12:15], s91 offen offset:0 lds
    buffer_load_dwordx4 v7, s[12:15], s91 offen offset:1024 lds
    s_add_u32 m0, s62, 8192
    s_nop 0
    buffer_load_dwordx4 v8, s[12:15], s91 offen offset:0 lds
    buffer_load_dwordx4 v9, s[12:15], s91 offen offset:1024 lds
    s_add_u32 m0, s62, 16384
    s_nop 0
    buffer_load_dwordx4 v10, s[12:15], s91 offen offset:0 lds
    buffer_load_dwordx4 v11, s[12:15], s91 offen offset:1024 lds
    s_waitcnt vmcnt(11)
    s_barrier
    s_waitcnt vmcnt(10)
    s_branch L_h0_chk0
L_h0_spin:
    v_mov_b32 v118, 0
    buffer_atomic_or v118, v117, s[16:19], 0 offen sc0 sc1
    s_waitcnt vmcnt(0)
L_h0_chk0:
    v_cmp_ne_u32 vcc, s68, v118
    s_nop 0
    s_and_b64 vcc, vcc, s[76:77]
    s_cbranch_vccz L_ok_1
    s_sub_u32 s56, s56, 1
    s_cbranch_scc0 L_h0_spin
    s_mov_b32 s56, 0
L_ok_1:
    s_mov_b32 s90, 0
    buffer_load_dwordx4 v[40:43], v32, s[16:19], s90 offen sc1
    s_mov_b32 s90, 3072
    buffer_load_dwordx4 v[44:47], v32, s[16:19], s90 offen sc1
    s_mov_b32 s90, 6144
    buffer_load_dwordx4 v[48:51], v32, s[16:19], s90 offen sc1
    s_mov_b32 s90, 9216
    buffer_load_dwordx4 v[52:55], v32, s[16:19], s90 offen sc1
    buffer_load_dwordx4 v[56:59], v33, s[16:19], 0 offen sc1
    buffer_load_dwordx4 v[60:63], v33, s[16:19], s92 offen sc1
    buffer_load_dwordx4 v[64:67], v33, s[16:19], s93 offen sc1
    buffer_load_dwordx4 v[68:71], v33, s[16:19], s94 offen sc1
    s_waitcnt vmcnt(8)
    s_barrier
    s_add_u32 m0, s89, 40960
    s_mov_b32 s90, 655360
    buffer_load_dwordx4 v12, s[20:23], s90 offen lds
    s_add_u32 m0, s89, 45056
    s_mov_b32 s90, 720896
    buffer_load_dwordx4 v12, s[20:23], s90 offen lds
    s_add_u32 m0, s89, 49152
    s_mov_b32 s90, 786432
    buffer_load_dwordx4 v12, s[20:23], s90 offen lds
    s_add_u32 m0, s89, 53248
    s_mov_b32 s90, 851968
    buffer_load_dwordx4 v12, s[20:23], s90 offen lds
    s_add_u32 m0, s89, 57344
    s_mov_b32 s90, 917504
    buffer_load_dwordx4 v12, s[20:23], s90 offen lds
    s_add_u32 m0, s89, 61440
    s_mov_b32 s90, 983040
    buffer_load_dwordx4 v12, s[20:23], s90 offen lds
    s_add_u32 m0, s89, 65536
    s_mov_b32 s90, 1048576
    buffer_load_dwordx4 v12, s[20:23], s90 offen lds
    s_add_u32 m0, s89, 69632
    s_mov_b32 s90, 1114112
    buffer_load_dwordx4 v12, s[20:23], s90 offen lds
    s_add_u32 m0, s89, 73728
    s_mov_b32 s90, 1179648
    buffer_load_dwordx4 v12, s[20:23], s90 offen lds
    s_add_u32 m0, s89, 77824
    s_mov_b32 s90, 1245184
    buffer_load_dwordx4 v12, s[20:23], s90 offen lds
    s_waitcnt vmcnt(10)
    v_add_f32 v40, v40, v44
    v_add_f32 v41, v41, v45
    v_add_f32 v42, v42, v46
    v_add_f32 v43, v43, v47
    v_add_f32 v40, v40, v48
    v_add_f32 v41, v41, v49
    v_add_f32 v42, v42, v50
    v_add_f32 v43, v43, v51
    v_add_f32 v40, v40, v52
    v_add_f32 v41, v41, v53
    v_add_f32 v42, v42, v54
    v_add_f32 v43, v43, v55
    v_add_f32 v56, v56, v60
    v_add_f32 v57, v57, v61
    v_add_f32 v58, v58, v62
    v_add_f32 v59, v59, v63
    v_add_f32 v56, v56, v64
    v_add_f32 v57, v57, v65
    v_add_f32 v58, v58, v66
    v_add_f32 v59, v59, v67
    v_add_f32 v56, v56, v68
    v_add_f32 v57, v57, v69
    v_add_f32 v58, v58, v70
    v_add_f32 v59, v59, v71
    s_nop 0
    v_permlane32_swap_b32 v56, v58
    v_permlane32_swap_b32 v57, v59
    v_permlane32_swap_b32 v40, v42
    v_permlane32_swap_b32 v41, v43
    v_add_f32 v56, v56, v58
    v_add_f32 v57, v57, v59
    v_add_f32 v40, v40, v42
    v_add_f32 v41, v41, v43
    v_mov_b32 v58, v56
    v_mov_b32 v59, v57
    v_permlane16_swap_b32 v40, v41
    v_permlane16_swap_b32 v56, v58
    v_permlane16_swap_b32 v57, v59
    v_add_f32 v40, v40, v41
    v_add_f32 v56, v56, v58
    v_add_f32 v57, v57, v59
    ds_write_b32 v17, v40
    v_mul_f32 v56, 0x3a800000, v56
    v_mul_f32 v57, 0x3a800000, v57
    v_fma_f32 v57, -v56, v56, v57
    v_max_f32 v57, 0, v57
    v_cvt_pk_bf16_f32 v48, v56, v57
    v_lshlrev_b32 v44, 16, v48
    v_and_b32 v48, 0xffff0000, v48
    v_add_f32 v48, 0x3727c5ac, v48
    v_cvt_pk_bf16_f32 v48, v48, v48
    v_lshlrev_b32 v48, 16, v48
    v_sqrt_f32 v48, v48
    s_nop 0
    v_cvt_pk_bf16_f32 v48, v48, v48
    v_lshlrev_b32 v48, 16, v48
    v_rcp_f32 v46, v48
    v_sub_f32 v44, 0, v44
    v_mul_f32 v48, 0x3fb8aa3b, v46
    ds_write_b32 v16, v44
    ds_write_b32 v16, v46 offset:512
    ds_write_b32 v16, v48 offset:1024
    s_waitcnt lgkmcnt(0)
    s_barrier
    s_setprio 0
    s_add_u32 m0, s89, 81920
    s_mov_b32 s90, 1310720
    buffer_load_dwordx4 v12, s[20:23], s90 offen lds
    s_add_u32 m0, s89, 86016
    s_mov_b32 s90, 1376256
    buffer_load_dwordx4 v12, s[20:23], s90 offen lds
    s_add_u32 m0, s89, 90112
    s_mov_b32 s90, 1441792
    buffer_load_dwordx4 v12, s[20:23], s90 offen lds
    s_add_u32 m0, s89, 94208
    s_mov_b32 s90, 1507328
    buffer_load_dwordx4 v12, s[20:23], s90 offen lds
    s_add_u32 m0, s89, 98304
    s_mov_b32 s90, 1572864
    buffer_load_dwordx4 v12, s[20:23], s90 offen lds
    s_add_u32 m0, s89, 102400
    s_mov_b32 s90, 1638400
    buffer_load_dwordx4 v12, s[20:23], s90 offen lds
    s_add_u32 m0, s89, 106496
    s_mov_b32 s90, 1703936
    buffer_load_dwordx4 v12, s[20:23], s90 offen lds
    s_add_u32 m0, s89, 110592
    s_mov_b32 s90, 1769472
    buffer_load_dwordx4 v12, s[20:23], s90 offen lds
    s_add_u32 m0, s89, 114688
    s_mov_b32 s90, 1835008
    buffer_load_dwordx4 v12, s[20:23], s90 offen lds
    s_add_u32 m0, s89, 118784
    s_mov_b32 s90, 1900544
    buffer_load_dwordx4 v12, s[20:23], s90 offen lds
    s_add_u32 m0, s89, 122880
    s_mov_b32 s90, 1966080
    buffer_load_dwordx4 v12, s[20:23], s90 offen lds
    s_add_u32 m0, s89, 126976
    s_mov_b32 s90, 2031616
    buffer_load_dwordx4 v12, s[20:23], s90 offen lds
    s_add_u32 m0, s89, 0
    s_mov_b32 s90, 0
    buffer_load_dwordx4 v12, s[20:23], s90 offen lds
    s_add_u32 m0, s89, 4096
    s_mov_b32 s90, 65536
    buffer_load_dwordx4 v12, s[20:23], s90 offen lds
    s_add_u32 m0, s89, 8192
    s_mov_b32 s90, 131072
    buffer_load_dwordx4 v12, s[20:23], s90 offen lds
    s_add_u32 m0, s89, 12288
    s_mov_b32 s90, 196608
    buffer_load_dwordx4 v12, s[20:23], s90 offen lds
    s_add_u32 m0, s89, 16384
    s_mov_b32 s90, 262144
    buffer_load_dwordx4 v12, s[20:23], s90 offen lds
    s_add_u32 m0, s89, 20480
    s_mov_b32 s90, 327680
    buffer_load_dwordx4 v12, s[20:23], s90 offen lds
    s_add_u32 m0, s89, 24576
    s_mov_b32 s90, 393216
    buffer_load_dwordx4 v12, s[20:23], s90 offen lds
    s_add_u32 m0, s89, 28672
    s_mov_b32 s90, 458752
    buffer_load_dwordx4 v12, s[20:23], s90 offen lds
    s_add_u32 m0, s89, 32768
    s_mov_b32 s90, 524288
    buffer_load_dwordx4 v12, s[20:23], s90 offen lds
    s_add_u32 m0, s89, 36864
    s_mov_b32 s90, 589824
    buffer_load_dwordx4 v12, s[20:23], s90 offen lds
    s_lshl_b32 s86, s47, 2
    s_add_u32 s86, s86, s48
    s_lshl_b32 s87, s86, 7
    s_add_u32 s87, s87, 671744
    v_lshl_add_u32 v6, v0, 2, s87
    v_mov_b32 v4, 2147483648
    v_cmp_gt_u32 vcc, 16, v0
    s_nop 1
    v_cndmask_b32 v6, v4, v6, vcc
    s_lshl_b32 s86, s86, 14
    s_add_u32 s86, s86, 5242880
    v_lshl_add_u32 v2, v0, 4, s86
    s_lshl_b32 s86, s47, 1
    s_add_u32 s86, s86, s50
    s_lshl_b32 s86, s86, 11
    s_lshl_b32 s87, s49, 6
    s_add_u32 s86, s86, s87
    s_add_u32 s86, s86, 6881280
    v_lshl_add_u32 v3, v23, 7, s86
    v_lshl_add_u32 v3, v22, 4, v3
    v_mov_b32 v112, 0
    v_mov_b32 v113, 0
    v_mov_b32 v114, 0
    v_mov_b32 v115, 0
    v_mov_b32 v116, 0
    v_mov_b32 v117, 0
    v_mov_b32 v118, 0
    v_mov_b32 v119, 0
    s_lshr_b32 s62, s3, 2
    s_lshl_b32 s53, s51, 3
    s_lshl_b32 s86, s48, 1
    s_add_u32 s53, s53, s86
    s_add_u32 s53, s53, s62
    v_lshrrev_b32 v36, 4, v0
    v_and_b32 v37, 15, v0
    s_lshl_b32 s87, s53, 15
    s_lshl_b32 s86, s62, 14
    s_add_u32 s86, s86, s87
    s_add_u32 s86, s86, 1048576
    v_lshl_add_u32 v157, v0, 4, s86
    v_xor_b32 v158, 0x8000, v157
    s_lshl_b32 s86, s51, 1
    s_lshr_b32 s87, s48, 1
    s_add_u32 s86, s86, s87
    s_lshl_b32 s86, s86, 1
    s_add_u32 s86, s86, s62
    s_lshl_b32 s86, s86, 1
    s_and_b32 s87, s48, 1
    s_add_u32 s86, s86, s87
    s_lshl_b32 s86, s86, 7
    s_add_u32 s86, s86, 688128
    v_lshl_add_u32 v159, v0, 2, s86
    v_mov_b32 v38, 2147483648
    v_cmp_gt_u32 vcc, 16, v0
    s_nop 1
    v_cndmask_b32 v159, v38, v159, vcc
    v_bfe_u32 v38, v0, 2, 2
    v_lshl_add_u32 v38, v36, 2, v38
    v_bfe_u32 v39, v38, 1, 2
    v_lshlrev_b32 v38, 7, v38
    v_lshl_add_u32 v38, v39, 5, v38
    v_and_b32 v39, 3, v0
    v_lshl_add_u32 v38, v39, 3, v38
    s_lshl_b32 s86, s62, 16
    s_add_u32 s86, s86, 0
    v_add_u32 v144, s86, v38
    v_xor_b32 v145, 32, v144
    v_xor_b32 v146, 64, v144
    v_xor_b32 v147, 96, v144
    v_cmp_eq_u32 s[4:5], 1, v39
    v_cmp_eq_u32 s[6:7], 2, v39
    v_cmp_eq_u32 s[98:99], 3, v39
    s_lshl_b32 s86, s53, 8
    s_add_u32 s86, s86, 589824
    v_lshl_add_u32 v160, v0, 2, s86
    s_mov_b32 s72, 0x00f0000f
    s_mov_b32 s73, 0xf0000f00
    s_mov_b32 s74, 0x0f00f000
    s_mov_b32 s75, 0x0f00f000
    v_lshrrev_b32 v38, 2, v37
    v_lshl_add_u32 v161, v38, 4, v37
    v_lshlrev_b32 v161, 2, v161
    s_lshl_b32 s86, s3, 12
    s_add_u32 s86, s86, 131072
    v_lshl_add_u32 v162, v0, 4, s86
    v_xor_b32 v163, 0x4000, v162
    s_lshl_b32 s86, s52, 7
    v_lshl_add_u32 v36, v36, 3, s86
    s_lshl_b32 s87, s53, 15
    s_add_u32 s87, s87, s86
    s_lshl_b32 s86, s62, 6
    s_add_u32 s87, s87, s86
    v_lshl_add_u32 v39, v37, 11, s87
    v_and_b32 v38, 48, v0
    v_add_u32 v39, v39, v38
    v_xor_b32 v37, 0x8000, v39
    v_lshlrev_b32 v38, 4, v0
    buffer_load_dwordx2 v[148:149], v36, s[40:43], 0 offen offset:0
    buffer_load_dwordx2 v[150:151], v36, s[40:43], 0 offen offset:32
    buffer_load_dwordx2 v[152:153], v36, s[40:43], 0 offen offset:64
    buffer_load_dwordx2 v[154:155], v36, s[40:43], 0 offen offset:96
    buffer_load_dwordx4 v[164:167], v38, s[40:43], 0 offen
    buffer_load_dwordx4 v[168:171], v38, s[40:43], 0 offen offset:1024
    s_waitcnt vmcnt(0)
    v_mov_b32 v4, 0
    buffer_atomic_or v4, v6, s[16:19], 0 offen sc0 sc1
    v_bfe_u32 v36, v0, 2, 1
    v_cmp_eq_u32 vcc, 1, v36
    v_mov_b32 v36, s95
    v_mov_b32 v38, 0
    v_dot2c_f32_bf16 v38, s95, v164
    v_dot2c_f32_bf16 v38, s95, v165
    v_dot2c_f32_bf16 v38, s95, v166
    v_dot2c_f32_bf16 v38, s95, v167
    v_dot2c_f32_bf16 v38, s95, v168
    v_dot2c_f32_bf16 v38, s95, v169
    v_dot2c_f32_bf16 v38, s95, v170
    v_dot2c_f32_bf16 v38, s95, v171
    v_cndmask_b32 v148, v36, v148, vcc
    v_cndmask_b32 v149, v36, v149, vcc
    v_cndmask_b32 v150, v36, v150, vcc
    v_cndmask_b32 v151, v36, v151, vcc
    v_cndmask_b32 v152, v36, v152, vcc
    v_cndmask_b32 v153, v36, v153, vcc
    v_cndmask_b32 v154, v36, v154, vcc
    v_cndmask_b32 v155, v36, v155, vcc
    v_add_f32_dpp v38, v38, v38 row_ror:8 row_mask:0xf bank_mask:0xf
    s_nop 1
    v_add_f32_dpp v38, v38, v38 row_ror:4 row_mask:0xf bank_mask:0xf
    s_nop 1
    v_add_f32_dpp v38, v38, v38 row_ror:2 row_mask:0xf bank_mask:0xf
    s_nop 1
    v_add_f32_dpp v38, v38, v38 row_ror:1 row_mask:0xf bank_mask:0xf
    v_mov_b32 v36, v38
    s_nop 1
    v_permlane32_swap_b32 v38, v36
    v_add_f32 v38, v38, v36
    v_mov_b32 v36, v38
    s_nop 1
    v_permlane16_swap_b32 v38, v36
    v_add_f32 v38, v38, v36
    v_mov_b32 v36, 135200
    v_readfirstlane_b32 s57, v38
    ds_write_b32 v36, v38
    s_mul_i32 s86, s50, 3072
    s_add_u32 s86, s86, 151552
    v_lshl_add_u32 v7, v0, 4, s86
    s_lshl_b32 s86, s49, 10
    v_add_u32 v5, s86, v7
    s_lshl_b32 s86, s49, 3
    v_add_u32 v7, s86, v7
    s_mov_b32 s88, 0xffff0000
    s_mov_b32 s86, 0x00003f80
    s_mov_b32 s87, 0x3f800000
    s_branch L_h1_w0
L_h1_r0:
    s_ff1_i32_b32 s66, s65
    s_bitset0_b32 s65, s66
    s_lshl_b32 s66, s66, 10
    buffer_load_dwordx4 v[40:43], v2, s[16:19], s66 offen sc1
    s_cmp_eq_u32 s65, 0
    s_cbranch_scc1 L_h1_p1
L_h1_r1:
    s_ff1_i32_b32 s66, s65
    s_bitset0_b32 s65, s66
    s_lshl_b32 s66, s66, 10
    buffer_load_dwordx4 v[44:47], v2, s[16:19], s66 offen sc1
    s_cmp_eq_u32 s65, 0
    s_cbranch_scc1 L_h1_p2
L_h1_r2:
    s_ff1_i32_b32 s66, s65
    s_bitset0_b32 s65, s66
    s_lshl_b32 s66, s66, 10
    buffer_load_dwordx4 v[48:51], v2, s[16:19], s66 offen sc1
    s_cmp_eq_u32 s65, 0
    s_cbranch_scc1 L_h1_p3
L_h1_r3:
    s_ff1_i32_b32 s66, s65
    s_bitset0_b32 s65, s66
    s_lshl_b32 s66, s66, 10
    buffer_load_dwordx4 v[52:55], v2, s[16:19], s66 offen sc1
    s_cmp_eq_u32 s65, 0
    s_cbranch_scc1 L_h1_p4
L_h1_r4:
    s_ff1_i32_b32 s66, s65
    s_bitset0_b32 s65, s66
    s_lshl_b32 s66, s66, 10
    buffer_load_dwordx4 v[56:59], v2, s[16:19], s66 offen sc1
    s_cmp_eq_u32 s65, 0
    s_cbranch_scc1 L_h1_p5
L_h1_r5:
    s_ff1_i32_b32 s66, s65
    s_bitset0_b32 s65, s66
    s_lshl_b32 s66, s66, 10
    buffer_load_dwordx4 v[60:63], v2, s[16:19], s66 offen sc1
    s_cmp_eq_u32 s65, 0
    s_cbranch_scc1 L_h1_p6
L_h1_r6:
    s_ff1_i32_b32 s66, s65
    s_bitset0_b32 s65, s66
    s_lshl_b32 s66, s66, 10
    buffer_load_dwordx4 v[64:67], v2, s[16:19], s66 offen sc1
    s_cmp_eq_u32 s65, 0
    s_cbranch_scc1 L_h1_p7
L_h1_r7:
    s_ff1_i32_b32 s66, s65
    s_bitset0_b32 s65, s66
    s_lshl_b32 s66, s66, 10
    buffer_load_dwordx4 v[68:71], v2, s[16:19], s66 offen sc1
    s_cmp_eq_u32 s65, 0
    s_cbranch_scc1 L_h1_p8
L_h1_r8:
    s_ff1_i32_b32 s66, s65
    s_bitset0_b32 s65, s66
    s_lshl_b32 s66, s66, 10
    buffer_load_dwordx4 v[72:75], v2, s[16:19], s66 offen sc1
    s_cmp_eq_u32 s65, 0
    s_cbranch_scc1 L_h1_p9
L_h1_r9:
    s_ff1_i32_b32 s66, s65
    s_bitset0_b32 s65, s66
    s_lshl_b32 s66, s66, 10
    buffer_load_dwordx4 v[76:79], v2, s[16:19], s66 offen sc1
    s_cmp_eq_u32 s65, 0
    s_cbranch_scc1 L_h1_p10
L_h1_r10:
    s_ff1_i32_b32 s66, s65
    s_bitset0_b32 s65, s66
    s_lshl_b32 s66, s66, 10
    buffer_load_dwordx4 v[80:83], v2, s[16:19], s66 offen sc1
    s_cmp_eq_u32 s65, 0
    s_cbranch_scc1 L_h1_p11
L_h1_r11:
    s_ff1_i32_b32 s66, s65
    s_bitset0_b32 s65, s66
    s_lshl_b32 s66, s66, 10
    buffer_load_dwordx4 v[84:87], v2, s[16:19], s66 offen sc1
    s_cmp_eq_u32 s65, 0
    s_cbranch_scc1 L_h1_p12
L_h1_r12:
    s_ff1_i32_b32 s66, s65
    s_bitset0_b32 s65, s66
    s_lshl_b32 s66, s66, 10
    buffer_load_dwordx4 v[88:91], v2, s[16:19], s66 offen sc1
    s_cmp_eq_u32 s65, 0
    s_cbranch_scc1 L_h1_p13
L_h1_r13:
    s_ff1_i32_b32 s66, s65
    s_bitset0_b32 s65, s66
    s_lshl_b32 s66, s66, 10
    buffer_load_dwordx4 v[92:95], v2, s[16:19], s66 offen sc1
    s_cmp_eq_u32 s65, 0
    s_cbranch_scc1 L_h1_p14
L_h1_r14:
    s_ff1_i32_b32 s66, s65
    s_bitset0_b32 s65, s66
    s_lshl_b32 s66, s66, 10
    buffer_load_dwordx4 v[96:99], v2, s[16:19], s66 offen sc1
    s_cmp_eq_u32 s65, 0
    s_cbranch_scc1 L_h1_p15
L_h1_r15:
    s_ff1_i32_b32 s66, s65
    s_bitset0_b32 s65, s66
    s_lshl_b32 s66, s66, 10
    buffer_load_dwordx4 v[100:103], v2, s[16:19], s66 offen sc1
    buffer_load_dwordx4 v[104:107], v3, s[16:19], 0 offen sc1
L_h1_acc:
    s_waitcnt vmcnt(16)
    v_dot2c_f32_bf16 v112, s86, v40
    v_dot2c_f32_bf16 v113, s87, v40
    v_dot2c_f32_bf16 v114, s86, v41
    v_dot2c_f32_bf16 v115, s87, v41
    v_dot2c_f32_bf16 v116, s86, v42
    v_dot2c_f32_bf16 v117, s87, v42
    v_dot2c_f32_bf16 v118, s86, v43
    v_dot2c_f32_bf16 v119, s87, v43
    s_waitcnt vmcnt(15)
    v_dot2c_f32_bf16 v112, s86, v44
    v_dot2c_f32_bf16 v113, s87, v44
    v_dot2c_f32_bf16 v114, s86, v45
    v_dot2c_f32_bf16 v115, s87, v45
    v_dot2c_f32_bf16 v116, s86, v46
    v_dot2c_f32_bf16 v117, s87, v46
    v_dot2c_f32_bf16 v118, s86, v47
    v_dot2c_f32_bf16 v119, s87, v47
    s_waitcnt vmcnt(14)
    v_dot2c_f32_bf16 v112, s86, v48
    v_dot2c_f32_bf16 v113, s87, v48
    v_dot2c_f32_bf16 v114, s86, v49
    v_dot2c_f32_bf16 v115, s87, v49
    v_dot2c_f32_bf16 v116, s86, v50
    v_dot2c_f32_bf16 v117, s87, v50
    v_dot2c_f32_bf16 v118, s86, v51
    v_dot2c_f32_bf16 v119, s87, v51
    v_max3_u32 v4, v43, v47, v51
    s_waitcnt vmcnt(13)
    v_dot2c_f32_bf16 v112, s86, v52
    v_dot2c_f32_bf16 v113, s87, v52
    v_dot2c_f32_bf16 v114, s86, v53
    v_dot2c_f32_bf16 v115, s87, v53
    v_dot2c_f32_bf16 v116, s86, v54
    v_dot2c_f32_bf16 v117, s87, v54
    v_dot2c_f32_bf16 v118, s86, v55
    v_dot2c_f32_bf16 v119, s87, v55
    s_waitcnt vmcnt(12)
    v_dot2c_f32_bf16 v112, s86, v56
    v_dot2c_f32_bf16 v113, s87, v56
    v_dot2c_f32_bf16 v114, s86, v57
    v_dot2c_f32_bf16 v115, s87, v57
    v_dot2c_f32_bf16 v116, s86, v58
    v_dot2c_f32_bf16 v117, s87, v58
    v_dot2c_f32_bf16 v118, s86, v59
    v_dot2c_f32_bf16 v119, s87, v59
    v_max3_u32 v4, v4, v55, v59
    s_waitcnt vmcnt(11)
    v_dot2c_f32_bf16 v112, s86, v60
    v_dot2c_f32_bf16 v113, s87, v60
    v_dot2c_f32_bf16 v114, s86, v61
    v_dot2c_f32_bf16 v115, s87, v61
    v_dot2c_f32_bf16 v116, s86, v62
    v_dot2c_f32_bf16 v117, s87, v62
    v_dot2c_f32_bf16 v118, s86, v63
    v_dot2c_f32_bf16 v119, s87, v63
    s_waitcnt vmcnt(10)
    v_dot2c_f32_bf16 v112, s86, v64
    v_dot2c_f32_bf16 v113, s87, v64
    v_dot2c_f32_bf16 v114, s86, v65
    v_dot2c_f32_bf16 v115, s87, v65
    v_dot2c_f32_bf16 v116, s86, v66
    v_dot2c_f32_bf16 v117, s87, v66
    v_dot2c_f32_bf16 v118, s86, v67
    v_dot2c_f32_bf16 v119, s87, v67
    v_max3_u32 v4, v4, v63, v67
    s_waitcnt vmcnt(9)
    v_dot2c_f32_bf16 v112, s86, v68
    v_dot2c_f32_bf16 v113, s87, v68
    v_dot2c_f32_bf16 v114, s86, v69
    v_dot2c_f32_bf16 v115, s87, v69
    v_dot2c_f32_bf16 v116, s86, v70
    v_dot2c_f32_bf16 v117, s87, v70
    v_dot2c_f32_bf16 v118, s86, v71
    v_dot2c_f32_bf16 v119, s87, v71
    s_waitcnt vmcnt(8)
    v_dot2c_f32_bf16 v112, s86, v72
    v_dot2c_f32_bf16 v113, s87, v72
    v_dot2c_f32_bf16 v114, s86, v73
    v_dot2c_f32_bf16 v115, s87, v73
    v_dot2c_f32_bf16 v116, s86, v74
    v_dot2c_f32_bf16 v117, s87, v74
    v_dot2c_f32_bf16 v118, s86, v75
    v_dot2c_f32_bf16 v119, s87, v75
    v_max3_u32 v4, v4, v71, v75
    s_waitcnt vmcnt(7)
    v_dot2c_f32_bf16 v112, s86, v76
    v_dot2c_f32_bf16 v113, s87, v76
    v_dot2c_f32_bf16 v114, s86, v77
    v_dot2c_f32_bf16 v115, s87, v77
    v_dot2c_f32_bf16 v116, s86, v78
    v_dot2c_f32_bf16 v117, s87, v78
    v_dot2c_f32_bf16 v118, s86, v79
    v_dot2c_f32_bf16 v119, s87, v79
    s_waitcnt vmcnt(6)
    v_dot2c_f32_bf16 v112, s86, v80
    v_dot2c_f32_bf16 v113, s87, v80
    v_dot2c_f32_bf16 v114, s86, v81
    v_dot2c_f32_bf16 v115, s87, v81
    v_dot2c_f32_bf16 v116, s86, v82
    v_dot2c_f32_bf16 v117, s87, v82
    v_dot2c_f32_bf16 v118, s86, v83
    v_dot2c_f32_bf16 v119, s87, v83
    v_max3_u32 v4, v4, v79, v83
    s_waitcnt vmcnt(5)
    v_dot2c_f32_bf16 v112, s86, v84
    v_dot2c_f32_bf16 v113, s87, v84
    v_dot2c_f32_bf16 v114, s86, v85
    v_dot2c_f32_bf16 v115, s87, v85
    v_dot2c_f32_bf16 v116, s86, v86
    v_dot2c_f32_bf16 v117, s87, v86
    v_dot2c_f32_bf16 v118, s86, v87
    v_dot2c_f32_bf16 v119, s87, v87
    s_waitcnt vmcnt(4)
    v_dot2c_f32_bf16 v112, s86, v88
    v_dot2c_f32_bf16 v113, s87, v88
    v_dot2c_f32_bf16 v114, s86, v89
    v_dot2c_f32_bf16 v115, s87, v89
    v_dot2c_f32_bf16 v116, s86, v90
    v_dot2c_f32_bf16 v117, s87, v90
    v_dot2c_f32_bf16 v118, s86, v91
    v_dot2c_f32_bf16 v119, s87, v91
    v_max3_u32 v4, v4, v87, v91
    s_waitcnt vmcnt(3)
    v_dot2c_f32_bf16 v112, s86, v92
    v_dot2c_f32_bf16 v113, s87, v92
    v_dot2c_f32_bf16 v114, s86, v93
    v_dot2c_f32_bf16 v115, s87, v93
    v_dot2c_f32_bf16 v116, s86, v94
    v_dot2c_f32_bf16 v117, s87, v94
    v_dot2c_f32_bf16 v118, s86, v95
    v_dot2c_f32_bf16 v119, s87, v95
    s_waitcnt vmcnt(2)
    v_dot2c_f32_bf16 v112, s86, v96
    v_dot2c_f32_bf16 v113, s87, v96
    v_dot2c_f32_bf16 v114, s86, v97
    v_dot2c_f32_bf16 v115, s87, v97
    v_dot2c_f32_bf16 v116, s86, v98
    v_dot2c_f32_bf16 v117, s87, v98
    v_dot2c_f32_bf16 v118, s86, v99
    v_dot2c_f32_bf16 v119, s87, v99
    v_max3_u32 v4, v4, v95, v99
    s_waitcnt vmcnt(1)
    v_dot2c_f32_bf16 v112, s86, v100
    v_dot2c_f32_bf16 v113, s87, v100
    v_dot2c_f32_bf16 v114, s86, v101
    v_dot2c_f32_bf16 v115, s87, v101
    v_dot2c_f32_bf16 v116, s86, v102
    v_dot2c_f32_bf16 v117, s87, v102
    v_dot2c_f32_bf16 v118, s86, v103
    v_dot2c_f32_bf16 v119, s87, v103
    s_waitcnt vmcnt(0)
    v_max3_u32 v4, v4, v103, v107
    v_add_f32_dpp v104, v104, v104 row_ror:8 row_mask:0xf bank_mask:0xf
    v_add_f32_dpp v105, v105, v105 row_ror:8 row_mask:0xf bank_mask:0xf
    v_add_f32_dpp v106, v106, v106 row_ror:8 row_mask:0xf bank_mask:0xf
    v_add_f32_dpp v107, v107, v107 row_ror:8 row_mask:0xf bank_mask:0xf
    v_cvt_pk_bf16_f32 v120, v112, v113
    v_cvt_pk_bf16_f32 v121, v114, v115
    v_cvt_pk_bf16_f32 v122, v116, v117
    v_cvt_pk_bf16_f32 v123, v118, v119
    ds_write_b128 v5, v[120:123]
    v_add_f32_dpp v104, v104, v104 row_ror:4 row_mask:0xf bank_mask:0xf
    v_add_f32_dpp v105, v105, v105 row_ror:4 row_mask:0xf bank_mask:0xf
    v_add_f32_dpp v106, v106, v106 row_ror:4 row_mask:0xf bank_mask:0xf
    v_add_f32_dpp v107, v107, v107 row_ror:4 row_mask:0xf bank_mask:0xf
    v_add_f32_dpp v104, v104, v104 row_ror:2 row_mask:0xf bank_mask:0xf
    v_add_f32_dpp v105, v105, v105 row_ror:2 row_mask:0xf bank_mask:0xf
    v_add_f32_dpp v106, v106, v106 row_ror:2 row_mask:0xf bank_mask:0xf
    v_add_f32_dpp v107, v107, v107 row_ror:2 row_mask:0xf bank_mask:0xf
    v_add_f32_dpp v104, v104, v104 row_ror:1 row_mask:0xf bank_mask:0xf
    v_add_f32_dpp v105, v105, v105 row_ror:1 row_mask:0xf bank_mask:0xf
    v_add_f32_dpp v106, v106, v106 row_ror:1 row_mask:0xf bank_mask:0xf
    v_add_f32_dpp v107, v107, v107 row_ror:1 row_mask:0xf bank_mask:0xf
    v_cmp_eq_u32 vcc, -1, v4
    v_cvt_pk_bf16_f32 v124, v104, v105
    v_cvt_pk_bf16_f32 v125, v106, v107
    ds_write_b64 v7, v[124:125] offset:2048
    s_cbranch_vccnz L_h1_again
L_h1_done:
    s_waitcnt lgkmcnt(0)
    s_barrier
    buffer_load_dwordx4 v[136:139], v39, s[8:11], 0 offen
    buffer_load_dwordx4 v[140:143], v37, s[8:11], 0 offen
    s_or_b32 s86, s2, s48
    s_cmp_eq_u32 s86, 0
    s_cselect_b32 s86, 0, 2147483648
    s_add_u32 s86, s86, 524288
    v_mov_b32 v6, s86
    buffer_store_dword v35, v6, s[16:19], 0 offen sc1
    v_mov_b32 v11, v30
    v_mov_b32 v14, v31
    v_mov_b32 v8, 0
    buffer_atomic_or v8, v159, s[16:19], 0 offen sc0 sc1
    s_branch L_phaseB
L_h1_p0:
    v_mov_b32 v4, 0
    buffer_atomic_or v4, v6, s[16:19], 0 offen sc0 sc1
L_h1_w0:
    s_waitcnt vmcnt(0)
    v_cmp_eq_u32 vcc, s68, v4
    s_nop 0
    s_andn2_b32 s65, vcc_lo, s88
    s_or_b32 s88, s88, s65
    s_cmp_lg_u32 s65, 0
    s_cbranch_scc1 L_h1_r0
    s_sub_u32 s56, s56, 1
    s_cbranch_scc0 L_h1_p0
    s_mov_b32 s56, 0
    s_not_b32 s65, s88
    s_branch L_h1_r0
L_h1_p1:
    v_mov_b32 v4, 0
    buffer_atomic_or v4, v6, s[16:19], 0 offen sc0 sc1
    s_waitcnt vmcnt(0)
    v_cmp_eq_u32 vcc, s68, v4
    s_nop 0
    s_andn2_b32 s65, vcc_lo, s88
    s_or_b32 s88, s88, s65
    s_cmp_lg_u32 s65, 0
    s_cbranch_scc1 L_h1_r1
    s_sub_u32 s56, s56, 1
    s_cbranch_scc0 L_h1_p1
    s_mov_b32 s56, 0
    s_not_b32 s65, s88
    s_branch L_h1_r1
L_h1_p2:
    v_mov_b32 v4, 0
    buffer_atomic_or v4, v6, s[16:19], 0 offen sc0 sc1
    s_waitcnt vmcnt(0)
    v_cmp_eq_u32 vcc, s68, v4
    s_nop 0
    s_andn2_b32 s65, vcc_lo, s88
    s_or_b32 s88, s88, s65
    s_cmp_lg_u32 s65, 0
    s_cbranch_scc1 L_h1_r2
    s_sub_u32 s56, s56, 1
    s_cbranch_scc0 L_h1_p2
    s_mov_b32 s56, 0
    s_not_b32 s65, s88
    s_branch L_h1_r2
L_h1_p3:
    v_mov_b32 v4, 0
    buffer_atomic_or v4, v6, s[16:19], 0 offen sc0 sc1
    s_waitcnt vmcnt(0)
    v_cmp_eq_u32 vcc, s68, v4
    s_nop 0
    s_andn2_b32 s65, vcc_lo, s88
    s_or_b32 s88, s88, s65
    s_cmp_lg_u32 s65, 0
    s_cbranch_scc1 L_h1_r3
    s_sub_u32 s56, s56, 1
    s_cbranch_scc0 L_h1_p3
    s_mov_b32 s56, 0
    s_not_b32 s65, s88
    s_branch L_h1_r3
L_h1_p4:
    v_mov_b32 v4, 0
    buffer_atomic_or v4, v6, s[16:19], 0 offen sc0 sc1
    s_waitcnt vmcnt(0)
    v_cmp_eq_u32 vcc, s68, v4
    s_nop 0
    s_andn2_b32 s65, vcc_lo, s88
    s_or_b32 s88, s88, s65
    s_cmp_lg_u32 s65, 0
    s_cbranch_scc1 L_h1_r4
    s_sub_u32 s56, s56, 1
    s_cbranch_scc0 L_h1_p4
    s_mov_b32 s56, 0
    s_not_b32 s65, s88
    s_branch L_h1_r4
L_h1_p5:
    v_mov_b32 v4, 0
    buffer_atomic_or v4, v6, s[16:19], 0 offen sc0 sc1
    s_waitcnt vmcnt(0)
    v_cmp_eq_u32 vcc, s68, v4
    s_nop 0
    s_andn2_b32 s65, vcc_lo, s88
    s_or_b32 s88, s88, s65
    s_cmp_lg_u32 s65, 0
    s_cbranch_scc1 L_h1_r5
    s_sub_u32 s56, s56, 1
    s_cbranch_scc0 L_h1_p5
    s_mov_b32 s56, 0
    s_not_b32 s65, s88
    s_branch L_h1_r5
L_h1_p6:
    v_mov_b32 v4, 0
    buffer_atomic_or v4, v6, s[16:19], 0 offen sc0 sc1
    s_waitcnt vmcnt(0)
    v_cmp_eq_u32 vcc, s68, v4
    s_nop 0
    s_andn2_b32 s65, vcc_lo, s88
    s_or_b32 s88, s88, s65
    s_cmp_lg_u32 s65, 0
    s_cbranch_scc1 L_h1_r6
    s_sub_u32 s56, s56, 1
    s_cbranch_scc0 L_h1_p6
    s_mov_b32 s56, 0
    s_not_b32 s65, s88
    s_branch L_h1_r6
L_h1_p7:
    v_mov_b32 v4, 0
    buffer_atomic_or v4, v6, s[16:19], 0 offen sc0 sc1
    s_waitcnt vmcnt(0)
    v_cmp_eq_u32 vcc, s68, v4
    s_nop 0
    s_andn2_b32 s65, vcc_lo, s88
    s_or_b32 s88, s88, s65
    s_cmp_lg_u32 s65, 0
    s_cbranch_scc1 L_h1_r7
    s_sub_u32 s56, s56, 1
    s_cbranch_scc0 L_h1_p7
    s_mov_b32 s56, 0
    s_not_b32 s65, s88
    s_branch L_h1_r7
L_h1_p8:
    v_mov_b32 v4, 0
    buffer_atomic_or v4, v6, s[16:19], 0 offen sc0 sc1
    s_waitcnt vmcnt(0)
    v_cmp_eq_u32 vcc, s68, v4
    s_nop 0
    s_andn2_b32 s65, vcc_lo, s88
    s_or_b32 s88, s88, s65
    s_cmp_lg_u32 s65, 0
    s_cbranch_scc1 L_h1_r8
    s_sub_u32 s56, s56, 1
    s_cbranch_scc0 L_h1_p8
    s_mov_b32 s56, 0
    s_not_b32 s65, s88
    s_branch L_h1_r8
L_h1_p9:
    v_mov_b32 v4, 0
    buffer_atomic_or v4, v6, s[16:19], 0 offen sc0 sc1
    s_waitcnt vmcnt(0)
    v_cmp_eq_u32 vcc, s68, v4
    s_nop 0
    s_andn2_b32 s65, vcc_lo, s88
    s_or_b32 s88, s88, s65
    s_cmp_lg_u32 s65, 0
    s_cbranch_scc1 L_h1_r9
    s_sub_u32 s56, s56, 1
    s_cbranch_scc0 L_h1_p9
    s_mov_b32 s56, 0
    s_not_b32 s65, s88
    s_branch L_h1_r9
L_h1_p10:
    v_mov_b32 v4, 0
    buffer_atomic_or v4, v6, s[16:19], 0 offen sc0 sc1
    s_waitcnt vmcnt(0)
    v_cmp_eq_u32 vcc, s68, v4
    s_nop 0
    s_andn2_b32 s65, vcc_lo, s88
    s_or_b32 s88, s88, s65
    s_cmp_lg_u32 s65, 0
    s_cbranch_scc1 L_h1_r10
    s_sub_u32 s56, s56, 1
    s_cbranch_scc0 L_h1_p10
    s_mov_b32 s56, 0
    s_not_b32 s65, s88
    s_branch L_h1_r10
L_h1_p11:
    v_mov_b32 v4, 0
    buffer_atomic_or v4, v6, s[16:19], 0 offen sc0 sc1
    s_waitcnt vmcnt(0)
    v_cmp_eq_u32 vcc, s68, v4
    s_nop 0
    s_andn2_b32 s65, vcc_lo, s88
    s_or_b32 s88, s88, s65
    s_cmp_lg_u32 s65, 0
    s_cbranch_scc1 L_h1_r11
    s_sub_u32 s56, s56, 1
    s_cbranch_scc0 L_h1_p11
    s_mov_b32 s56, 0
    s_not_b32 s65, s88
    s_branch L_h1_r11
L_h1_p12:
    v_mov_b32 v4, 0
    buffer_atomic_or v4, v6, s[16:19], 0 offen sc0 sc1
    s_waitcnt vmcnt(0)
    v_cmp_eq_u32 vcc, s68, v4
    s_nop 0
    s_andn2_b32 s65, vcc_lo, s88
    s_or_b32 s88, s88, s65
    s_cmp_lg_u32 s65, 0
    s_cbranch_scc1 L_h1_r12
    s_sub_u32 s56, s56, 1
    s_cbranch_scc0 L_h1_p12
    s_mov_b32 s56, 0
    s_not_b32 s65, s88
    s_branch L_h1_r12
L_h1_p13:
    v_mov_b32 v4, 0
    buffer_atomic_or v4, v6, s[16:19], 0 offen sc0 sc1
    s_waitcnt vmcnt(0)
    v_cmp_eq_u32 vcc, s68, v4
    s_nop 0
    s_andn2_b32 s65, vcc_lo, s88
    s_or_b32 s88, s88, s65
    s_cmp_lg_u32 s65, 0
    s_cbranch_scc1 L_h1_r13
    s_sub_u32 s56, s56, 1
    s_cbranch_scc0 L_h1_p13
    s_mov_b32 s56, 0
    s_not_b32 s65, s88
    s_branch L_h1_r13
L_h1_p14:
    v_mov_b32 v4, 0
    buffer_atomic_or v4, v6, s[16:19], 0 offen sc0 sc1
    s_waitcnt vmcnt(0)
    v_cmp_eq_u32 vcc, s68, v4
    s_nop 0
    s_andn2_b32 s65, vcc_lo, s88
    s_or_b32 s88, s88, s65
    s_cmp_lg_u32 s65, 0
    s_cbranch_scc1 L_h1_r14
    s_sub_u32 s56, s56, 1
    s_cbranch_scc0 L_h1_p14
    s_mov_b32 s56, 0
    s_not_b32 s65, s88
    s_branch L_h1_r14
L_h1_p15:
    v_mov_b32 v4, 0
    buffer_atomic_or v4, v6, s[16:19], 0 offen sc0 sc1
    s_waitcnt vmcnt(0)
    v_cmp_eq_u32 vcc, s68, v4
    s_nop 0
    s_andn2_b32 s65, vcc_lo, s88
    s_or_b32 s88, s88, s65
    s_cmp_lg_u32 s65, 0
    s_cbranch_scc1 L_h1_r15
    s_sub_u32 s56, s56, 1
    s_cbranch_scc0 L_h1_p15
    s_mov_b32 s56, 0
    s_not_b32 s65, s88
    s_branch L_h1_r15
L_h1_again:
    s_sub_u32 s56, s56, 1
    s_cbranch_scc0 L_h1_re
    s_mov_b32 s56, 0
    s_branch L_h1_done
L_h1_re:
    buffer_load_dwordx4 v[40:43], v2, s[16:19], 0 offen offset:0 sc1
    buffer_load_dwordx4 v[44:47], v2, s[16:19], 0 offen offset:1024 sc1
    buffer_load_dwordx4 v[48:51], v2, s[16:19], 0 offen offset:2048 sc1
    buffer_load_dwordx4 v[52:55], v2, s[16:19], 0 offen offset:3072 sc1
    buffer_load_dwordx4 v[56:59], v2, s[16:19], s92 offen offset:0 sc1
    buffer_load_dwordx4 v[60:63], v2, s[16:19], s92 offen offset:1024 sc1
    buffer_load_dwordx4 v[64:67], v2, s[16:19], s92 offen offset:2048 sc1
    buffer_load_dwordx4 v[68:71], v2, s[16:19], s92 offen offset:3072 sc1
    buffer_load_dwordx4 v[72:75], v2, s[16:19], s93 offen offset:0 sc1
    buffer_load_dwordx4 v[76:79], v2, s[16:19], s93 offen offset:1024 sc1
    buffer_load_dwordx4 v[80:83], v2, s[16:19], s93 offen offset:2048 sc1
    buffer_load_dwordx4 v[84:87], v2, s[16:19], s93 offen offset:3072 sc1
    buffer_load_dwordx4 v[88:91], v2, s[16:19], s94 offen offset:0 sc1
    buffer_load_dwordx4 v[92:95], v2, s[16:19], s94 offen offset:1024 sc1
    buffer_load_dwordx4 v[96:99], v2, s[16:19], s94 offen offset:2048 sc1
    buffer_load_dwordx4 v[100:103], v2, s[16:19], s94 offen offset:3072 sc1
    buffer_load_dwordx4 v[104:107], v3, s[16:19], 0 offen sc1
    v_mov_b32 v112, 0
    v_mov_b32 v113, 0
    v_mov_b32 v114, 0
    v_mov_b32 v115, 0
    v_mov_b32 v116, 0
    v_mov_b32 v117, 0
    v_mov_b32 v118, 0
    v_mov_b32 v119, 0
    s_branch L_h1_acc
L_comp:
    v_and_b32 v20, 15, v0
    v_lshrrev_b32 v21, 4, v0
    v_bfe_u32 v22, v0, 1, 3
    s_lshl_b32 s86, s49, 13
    v_lshl_add_u32 v20, v20, 7, s86
    v_or_b32 v23, 0, v21
    v_xor_b32 v23, v23, v22
    v_lshl_add_u32 v2, v23, 4, v20
    v_or_b32 v23, 4, v21
    v_xor_b32 v23, v23, v22
    v_lshl_add_u32 v3, v23, 4, v20
    v_bfe_u32 v22, v0, 2, 2
    v_lshl_add_u32 v22, v21, 3, v22
    v_lshlrev_b32 v22, 7, v22
    v_bfe_u32 v23, v0, 3, 2
    s_lshl_b32 s86, s50, 1
    v_xor_b32 v23, s86, v23
    v_lshl_add_u32 v22, v23, 5, v22
    v_and_b32 v23, 3, v0
    v_lshl_add_u32 v22, v23, 3, v22
    v_add_u32 v4, 16384, v22
    v_xor_b32 v5, 32, v4
    s_lshl_b32 s53, s2, 2
    s_add_u32 s53, s53, s3
    s_lshl_b32 s86, s53, 12
    s_add_u32 s86, s86, 1048576
    v_lshl_add_u32 v6, v0, 4, s86
    s_mul_i32 s53, s53, 560
    s_add_u32 s53, s53, 6291456
    v_lshl_add_u32 v17, v0, 4, s53
    v_mov_b32 v16, 2147483648
    v_cmp_gt_u32 vcc, 35, v0
    s_nop 1
    v_cndmask_b32 v17, v16, v17, vcc
    s_lshl_b32 s86, s47, 1
    s_add_u32 s86, s86, s50
    s_lshl_b32 s87, s86, 4
    s_add_u32 s87, s87, s46
    s_lshl_b32 s87, s87, 1
    s_add_u32 s87, s87, s49
    s_lshl_b32 s87, s87, 6
    s_add_u32 s87, s87, 6880320
    v_lshl_add_u32 v16, v0, 4, s87
    v_cmp_le_u32 vcc, 60, v0
    s_nop 1
    v_cndmask_b32 v17, v17, v16, vcc
    s_lshl_b32 s87, s86, 1
    s_add_u32 s87, s87, s49
    s_lshl_b32 s87, s87, 4
    s_add_u32 s87, s87, s46
    s_lshl_b32 s87, s87, 10
    s_add_u32 s87, s87, 5242880
    v_lshl_add_u32 v16, v0, 4, s87
    v_mov_b32 v8, -1
    v_mov_b32 v9, -1
    v_mov_b32 v10, -1
    v_mov_b32 v11, -1
    s_waitcnt lgkmcnt(0)
    s_load_dword s61, s[84:85], 524288
    s_mov_b32 s16, s84
    s_and_b32 s17, s85, 0xffff
    s_mov_b32 s18, 268435456
    s_mov_b32 s19, 0x20000
    s_mov_b32 s8, s64
    s_and_b32 s9, s65, 0xffff
    s_mov_b32 s10, 4194304
    s_mov_b32 s11, 0x20000
    s_mov_b32 s20, s68
    s_and_b32 s21, s69, 0xffff
    s_mov_b32 s22, 2097152
    s_mov_b32 s23, 0x20000
    s_mov_b32 s24, s80
    s_and_b32 s25, s81, 0xffff
    s_mov_b32 s26, 4194304
    s_mov_b32 s27, 0x20000
    s_mov_b32 s28, s82
    s_and_b32 s29, s83, 0xffff
    s_mov_b32 s30, 256
    s_mov_b32 s31, 0x20000
    s_bitcmp1_b32 s2, 0
    s_cselect_b32 s32, s76, s74
    s_cselect_b32 s33, s77, s75
    s_and_b32 s33, s33, 0xffff
    s_mov_b32 s34, 7340032
    s_mov_b32 s35, 0x20000
    s_mov_b32 s36, s78
    s_and_b32 s37, s79, 0xffff
    s_mov_b32 s38, 7340032
    s_mov_b32 s39, 0x20000
    s_mov_b32 s40, s72
    s_and_b32 s41, s73, 0xffff
    s_mov_b32 s42, 2048
    s_mov_b32 s43, 0x20000
    s_lshl_b32 s86, s2, 7
    s_add_u32 s86, s86, 589824
    s_cmp_eq_u32 s3, 0
    s_cselect_b32 s86, s86, 2147483648
    v_lshl_add_u32 v7, v0, 2, s86
    v_mov_b32 v12, 2147483648
    v_cmp_gt_u32 vcc, 32, v0
    s_nop 1
    v_cndmask_b32 v7, v12, v7, vcc
    v_mov_b32 v12, 0
    buffer_store_dword v12, v7, s[16:19], 0 offen sc1
    v_mov_b32 v128, 0
    v_mov_b32 v129, 0
    v_mov_b32 v130, 0
    v_mov_b32 v131, 0
    v_mov_b32 v132, 0
    v_mov_b32 v133, 0
    v_mov_b32 v134, 0
    v_mov_b32 v135, 0
    v_mov_b32 v136, 0
    v_mov_b32 v137, 0
    v_mov_b32 v138, 0
    v_mov_b32 v139, 0
    v_mov_b32 v140, 0
    v_mov_b32 v141, 0
    v_mov_b32 v142, 0
    v_mov_b32 v143, 0
    v_mov_b32 v144, 0
    v_mov_b32 v145, 0
    v_mov_b32 v146, 0
    v_mov_b32 v147, 0
    v_mov_b32 v148, 0
    v_mov_b32 v149, 0
    v_mov_b32 v150, 0
    v_mov_b32 v151, 0
    v_mov_b32 v152, 0
    v_mov_b32 v153, 0
    v_mov_b32 v154, 0
    v_mov_b32 v155, 0
    v_mov_b32 v156, 0
    v_mov_b32 v157, 0
    v_mov_b32 v158, 0
    v_mov_b32 v159, 0
    v_mov_b32 v160, 0
    v_mov_b32 v161, 0
    v_mov_b32 v162, 0
    v_mov_b32 v163, 0
    v_mov_b32 v164, 0
    v_mov_b32 v165, 0
    v_mov_b32 v166, 0
    v_mov_b32 v167, 0
    v_mov_b32 v168, 0
    v_mov_b32 v169, 0
    v_mov_b32 v170, 0
    v_mov_b32 v171, 0
    v_mov_b32 v172, 0
    v_mov_b32 v173, 0
    v_mov_b32 v174, 0
    v_mov_b32 v175, 0
    v_mov_b32 v176, 0
    v_mov_b32 v177, 0
    v_mov_b32 v178, 0
    v_mov_b32 v179, 0
    v_mov_b32 v180, 0
    v_mov_b32 v181, 0
    v_mov_b32 v182, 0
    v_mov_b32 v183, 0
    v_mov_b32 v184, 0
    v_mov_b32 v185, 0
    v_mov_b32 v186, 0
    v_mov_b32 v187, 0
    v_mov_b32 v188, 0
    v_mov_b32 v189, 0
    v_mov_b32 v190, 0
    v_mov_b32 v191, 0
    v_mov_b32 v192, 0
    v_mov_b32 v193, 0
    v_mov_b32 v194, 0
    v_mov_b32 v195, 0
    v_mov_b32 v196, 0
    v_mov_b32 v197, 0
    v_mov_b32 v198, 0
    v_mov_b32 v199, 0
    v_mov_b32 v200, 0
    v_mov_b32 v201, 0
    v_mov_b32 v202, 0
    v_mov_b32 v203, 0
    v_mov_b32 v204, 0
    v_mov_b32 v205, 0
    v_mov_b32 v206, 0
    v_mov_b32 v207, 0
    v_mov_b32 v208, 0
    v_mov_b32 v209, 0
    v_mov_b32 v210, 0
    v_mov_b32 v211, 0
    v_mov_b32 v212, 0
    v_mov_b32 v213, 0
    v_mov_b32 v214, 0
    v_mov_b32 v215, 0
    v_mov_b32 v216, 0
    v_mov_b32 v217, 0
    v_mov_b32 v218, 0
    v_mov_b32 v219, 0
    v_mov_b32 v220, 0
    v_mov_b32 v221, 0
    v_mov_b32 v222, 0
    v_mov_b32 v223, 0
    s_mov_b32 s54, 0x358637bd
    s_mov_b32 s55, 0x358637bd
    s_mov_b32 s62, 0
    s_mov_b32 s63, 0
    s_waitcnt lgkmcnt(0)
    s_add_u32 s68, s61, 0x9e3779b9
    s_barrier
    ds_read_b128 v[40:43], v2 offset:0
    ds_read_b128 v[44:47], v2 offset:2048
    ds_read_b128 v[48:51], v2 offset:4096
    ds_read_b128 v[52:55], v2 offset:6144
    ds_read_b64_tr_b16 v[56:57], v4 offset:0
    ds_read_b64_tr_b16 v[58:59], v4 offset:512
    ds_read_b64_tr_b16 v[60:61], v5 offset:0
    ds_read_b64_tr_b16 v[62:63], v5 offset:512
    ds_read_b64_tr_b16 v[64:65], v4 offset:8192
    ds_read_b64_tr_b16 v[66:67], v4 offset:8704
    ds_read_b64_tr_b16 v[68:69], v5 offset:8192
    ds_read_b64_tr_b16 v[70:71], v5 offset:8704
    ds_read_b64_tr_b16 v[72:73], v4 offset:16384
    ds_read_b64_tr_b16 v[74:75], v4 offset:16896
    ds_read_b64_tr_b16 v[76:77], v5 offset:16384
    ds_read_b64_tr_b16 v[78:79], v5 offset:16896
L_cloop:
    s_waitcnt lgkmcnt(0)
    v_mfma_f32_16x16x32_bf16 v[128:131], v[56:59], v[40:43], v[128:131]
    ds_read_b128 v[80:83], v3 offset:0
    v_mfma_f32_16x16x32_bf16 v[132:135], v[56:59], v[44:47], v[132:135]
    ds_read_b128 v[84:87], v3 offset:2048
    v_mfma_f32_16x16x32_bf16 v[136:139], v[56:59], v[48:51], v[136:139]
    ds_read_b128 v[88:91], v3 offset:4096
    v_mfma_f32_16x16x32_bf16 v[140:143], v[56:59], v[52:55], v[140:143]
    ds_read_b128 v[92:95], v3 offset:6144
    v_mfma_f32_16x16x32_bf16 v[144:147], v[60:63], v[40:43], v[144:147]
    ds_read_b64_tr_b16 v[96:97], v4 offset:4096
    v_mfma_f32_16x16x32_bf16 v[148:151], v[60:63], v[44:47], v[148:151]
    ds_read_b64_tr_b16 v[98:99], v4 offset:4608
    v_mfma_f32_16x16x32_bf16 v[152:155], v[60:63], v[48:51], v[152:155]
    ds_read_b64_tr_b16 v[100:101], v5 offset:4096
    v_mfma_f32_16x16x32_bf16 v[156:159], v[60:63], v[52:55], v[156:159]
    ds_read_b64_tr_b16 v[102:103], v5 offset:4608
    v_mfma_f32_16x16x32_bf16 v[160:163], v[40:43], v[64:67], v[160:163]
    ds_read_b64_tr_b16 v[104:105], v4 offset:12288
    v_mfma_f32_16x16x32_bf16 v[164:167], v[44:47], v[64:67], v[164:167]
    ds_read_b64_tr_b16 v[106:107], v4 offset:12800
    v_mfma_f32_16x16x32_bf16 v[168:171], v[48:51], v[64:67], v[168:171]
    ds_read_b64_tr_b16 v[108:109], v5 offset:12288
    v_mfma_f32_16x16x32_bf16 v[172:175], v[52:55], v[64:67], v[172:175]
    ds_read_b64_tr_b16 v[110:111], v5 offset:12800
    v_mfma_f32_16x16x32_bf16 v[176:179], v[40:43], v[68:71], v[176:179]
    ds_read_b64_tr_b16 v[112:113], v4 offset:20480
    v_mfma_f32_16x16x32_bf16 v[180:183], v[44:47], v[68:71], v[180:183]
    ds_read_b64_tr_b16 v[114:115], v4 offset:20992
    v_mfma_f32_16x16x32_bf16 v[184:187], v[48:51], v[68:71], v[184:187]
    ds_read_b64_tr_b16 v[116:117], v5 offset:20480
    v_mfma_f32_16x16x32_bf16 v[188:191], v[52:55], v[68:71], v[188:191]
    ds_read_b64_tr_b16 v[118:119], v5 offset:20992
    v_mfma_f32_16x16x32_bf16 v[192:195], v[40:43], v[72:75], v[192:195]
    s_add_u32 s63, s63, 1
    s_cmp_eq_u32 s63, 3
    s_cselect_b32 s53, 4294844416, 0
    s_cselect_b32 s63, 0, s63
    s_add_u32 s53, s53, 40960
    v_mfma_f32_16x16x32_bf16 v[196:199], v[44:47], v[72:75], v[196:199]
    v_add_u32 v2, s53, v2
    v_mfma_f32_16x16x32_bf16 v[200:203], v[48:51], v[72:75], v[200:203]
    v_add_u32 v4, s53, v4
    v_mfma_f32_16x16x32_bf16 v[204:207], v[52:55], v[72:75], v[204:207]
    v_add_u32 v5, s53, v5
    v_mfma_f32_16x16x32_bf16 v[208:211], v[40:43], v[76:79], v[208:211]
    v_add_u32 v3, s53, v3
    v_mfma_f32_16x16x32_bf16 v[212:215], v[44:47], v[76:79], v[212:215]
    s_cmp_ge_u32 s62, 6
    s_cbranch_scc1 L_cl_none
    buffer_store_dwordx4 v[8:11], v6, s[16:19], 0 offen sc1
    v_add_u32 v6, 1024, v6
    s_cmp_lt_u32 s62, 3
    s_cbranch_scc1 L_cl_none
    v_mov_b32 v6, v16
    v_mov_b32 v16, v17
L_cl_none:
    v_mfma_f32_16x16x32_bf16 v[216:219], v[48:51], v[76:79], v[216:219]
    v_mfma_f32_16x16x32_bf16 v[220:223], v[52:55], v[76:79], v[220:223]
    s_waitcnt lgkmcnt(0)
    v_mfma_f32_16x16x32_bf16 v[128:131], v[96:99], v[80:83], v[128:131]
    s_barrier
    ds_read_b128 v[40:43], v2 offset:0
    v_mfma_f32_16x16x32_bf16 v[132:135], v[96:99], v[84:87], v[132:135]
    ds_read_b128 v[44:47], v2 offset:2048
    v_mfma_f32_16x16x32_bf16 v[136:139], v[96:99], v[88:91], v[136:139]
    ds_read_b128 v[48:51], v2 offset:4096
    v_mfma_f32_16x16x32_bf16 v[140:143], v[96:99], v[92:95], v[140:143]
    ds_read_b128 v[52:55], v2 offset:6144
    v_mfma_f32_16x16x32_bf16 v[144:147], v[100:103], v[80:83], v[144:147]
    ds_read_b64_tr_b16 v[56:57], v4 offset:0
    v_mfma_f32_16x16x32_bf16 v[148:151], v[100:103], v[84:87], v[148:151]
    ds_read_b64_tr_b16 v[58:59], v4 offset:512
    v_mfma_f32_16x16x32_bf16 v[152:155], v[100:103], v[88:91], v[152:155]
    ds_read_b64_tr_b16 v[60:61], v5 offset:0
    v_mfma_f32_16x16x32_bf16 v[156:159], v[100:103], v[92:95], v[156:159]
    ds_read_b64_tr_b16 v[62:63], v5 offset:512
    v_mfma_f32_16x16x32_bf16 v[160:163], v[80:83], v[104:107], v[160:163]
    ds_read_b64_tr_b16 v[64:65], v4 offset:8192
    v_mfma_f32_16x16x32_bf16 v[164:167], v[84:87], v[104:107], v[164:167]
    ds_read_b64_tr_b16 v[66:67], v4 offset:8704
    v_mfma_f32_16x16x32_bf16 v[168:171], v[88:91], v[104:107], v[168:171]
    ds_read_b64_tr_b16 v[68:69], v5 offset:8192
    v_mfma_f32_16x16x32_bf16 v[172:175], v[92:95], v[104:107], v[172:175]
    ds_read_b64_tr_b16 v[70:71], v5 offset:8704
    v_mfma_f32_16x16x32_bf16 v[176:179], v[80:83], v[108:111], v[176:179]
    ds_read_b64_tr_b16 v[72:73], v4 offset:16384
    v_mfma_f32_16x16x32_bf16 v[180:183], v[84:87], v[108:111], v[180:183]
    ds_read_b64_tr_b16 v[74:75], v4 offset:16896
    v_mfma_f32_16x16x32_bf16 v[184:187], v[88:91], v[108:111], v[184:187]
    ds_read_b64_tr_b16 v[76:77], v5 offset:16384
    v_mfma_f32_16x16x32_bf16 v[188:191], v[92:95], v[108:111], v[188:191]
    ds_read_b64_tr_b16 v[78:79], v5 offset:16896
    v_mfma_f32_16x16x32_bf16 v[192:195], v[80:83], v[112:115], v[192:195]
    v_mfma_f32_16x16x32_bf16 v[196:199], v[84:87], v[112:115], v[196:199]
    s_cmp_lg_u32 s62, 8
    s_cbranch_scc1 L_cl_nw
    s_waitcnt vmcnt(0)
L_cl_nw:
    v_mfma_f32_16x16x32_bf16 v[200:203], v[88:91], v[112:115], v[200:203]
    v_mfma_f32_16x16x32_bf16 v[204:207], v[92:95], v[112:115], v[204:207]
    v_mfma_f32_16x16x32_bf16 v[208:211], v[80:83], v[116:119], v[208:211]
    s_add_u32 s62, s62, 1
    v_mfma_f32_16x16x32_bf16 v[212:215], v[84:87], v[116:119], v[212:215]
    v_mfma_f32_16x16x32_bf16 v[216:219], v[88:91], v[116:119], v[216:219]
    v_mfma_f32_16x16x32_bf16 v[220:223], v[92:95], v[116:119], v[220:223]
    s_cmp_lt_u32 s62, 15
    s_cbranch_scc1 L_cloop
    s_waitcnt lgkmcnt(0)
    v_mfma_f32_16x16x32_bf16 v[128:131], v[56:59], v[40:43], v[128:131]
    ds_read_b128 v[80:83], v3 offset:0
    v_mfma_f32_16x16x32_bf16 v[132:135], v[56:59], v[44:47], v[132:135]
    ds_read_b128 v[84:87], v3 offset:2048
    v_mfma_f32_16x16x32_bf16 v[136:139], v[56:59], v[48:51], v[136:139]
    ds_read_b128 v[88:91], v3 offset:4096
    v_mfma_f32_16x16x32_bf16 v[140:143], v[56:59], v[52:55], v[140:143]
    ds_read_b128 v[92:95], v3 offset:6144
    v_mfma_f32_16x16x32_bf16 v[144:147], v[60:63], v[40:43], v[144:147]
    ds_read_b64_tr_b16 v[96:97], v4 offset:4096
    v_mfma_f32_16x16x32_bf16 v[148:151], v[60:63], v[44:47], v[148:151]
    ds_read_b64_tr_b16 v[98:99], v4 offset:4608
    v_mfma_f32_16x16x32_bf16 v[152:155], v[60:63], v[48:51], v[152:155]
    ds_read_b64_tr_b16 v[100:101], v5 offset:4096
    v_mfma_f32_16x16x32_bf16 v[156:159], v[60:63], v[52:55], v[156:159]
    ds_read_b64_tr_b16 v[102:103], v5 offset:4608
    v_mfma_f32_16x16x32_bf16 v[160:163], v[40:43], v[64:67], v[160:163]
    ds_read_b64_tr_b16 v[104:105], v4 offset:12288
    v_mfma_f32_16x16x32_bf16 v[164:167], v[44:47], v[64:67], v[164:167]
    ds_read_b64_tr_b16 v[106:107], v4 offset:12800
    v_mfma_f32_16x16x32_bf16 v[168:171], v[48:51], v[64:67], v[168:171]
    ds_read_b64_tr_b16 v[108:109], v5 offset:12288
    v_mfma_f32_16x16x32_bf16 v[172:175], v[52:55], v[64:67], v[172:175]
    ds_read_b64_tr_b16 v[110:111], v5 offset:12800
    v_mfma_f32_16x16x32_bf16 v[176:179], v[40:43], v[68:71], v[176:179]
    ds_read_b64_tr_b16 v[112:113], v4 offset:20480
    v_mfma_f32_16x16x32_bf16 v[180:183], v[44:47], v[68:71], v[180:183]
    ds_read_b64_tr_b16 v[114:115], v4 offset:20992
    v_mfma_f32_16x16x32_bf16 v[184:187], v[48:51], v[68:71], v[184:187]
    ds_read_b64_tr_b16 v[116:117], v5 offset:20480
    v_mfma_f32_16x16x32_bf16 v[188:191], v[52:55], v[68:71], v[188:191]
    ds_read_b64_tr_b16 v[118:119], v5 offset:20992
    v_mfma_f32_16x16x32_bf16 v[192:195], v[40:43], v[72:75], v[192:195]
    v_lshrrev_b32 v21, 4, v0
    v_and_b32 v22, 15, v0
    v_mfma_f32_16x16x32_bf16 v[196:199], v[44:47], v[72:75], v[196:199]
    s_lshl_b32 s86, s49, 8
    s_add_u32 s86, s86, 131072
    v_lshl_add_u32 v6, v21, 4, s86
    v_mfma_f32_16x16x32_bf16 v[200:203], v[48:51], v[72:75], v[200:203]
    v_lshl_add_u32 v7, v22, 2, s86
    v_mfma_f32_16x16x32_bf16 v[204:207], v[52:55], v[72:75], v[204:207]
    s_lshl_b32 s86, s50, 7
    s_add_u32 s86, s86, 132608
    v_lshl_add_u32 v8, v22, 2, s86
    v_mfma_f32_16x16x32_bf16 v[208:211], v[40:43], v[76:79], v[208:211]
    v_lshl_add_u32 v9, v21, 4, s86
    v_mfma_f32_16x16x32_bf16 v[212:215], v[44:47], v[76:79], v[212:215]
    s_lshl_b32 s86, s3, 2
    s_add_u32 s86, s86, 135168
    v_mov_b32 v12, s86
    v_mfma_f32_16x16x32_bf16 v[216:219], v[48:51], v[76:79], v[216:219]
    v_xor_b32 v13, 4, v12
    v_mfma_f32_16x16x32_bf16 v[220:223], v[52:55], v[76:79], v[220:223]
    s_waitcnt lgkmcnt(0)
    v_mfma_f32_16x16x32_bf16 v[160:163], v[80:83], v[104:107], v[160:163]
    v_mfma_f32_16x16x32_bf16 v[164:167], v[84:87], v[104:107], v[164:167]
    v_mfma_f32_16x16x32_bf16 v[168:171], v[88:91], v[104:107], v[168:171]
    v_mfma_f32_16x16x32_bf16 v[172:175], v[92:95], v[104:107], v[172:175]
    v_mfma_f32_16x16x32_bf16 v[176:179], v[80:83], v[108:111], v[176:179]
    v_mfma_f32_16x16x32_bf16 v[180:183], v[84:87], v[108:111], v[180:183]
    v_mfma_f32_16x16x32_bf16 v[184:187], v[88:91], v[108:111], v[184:187]
    v_mfma_f32_16x16x32_bf16 v[188:191], v[92:95], v[108:111], v[188:191]
    v_mfma_f32_16x16x32_bf16 v[192:195], v[80:83], v[112:115], v[192:195]
    v_mfma_f32_16x16x32_bf16 v[196:199], v[84:87], v[112:115], v[196:199]
    v_mfma_f32_16x16x32_bf16 v[200:203], v[88:91], v[112:115], v[200:203]
    v_mfma_f32_16x16x32_bf16 v[204:207], v[92:95], v[112:115], v[204:207]
    v_mfma_f32_16x16x32_bf16 v[208:211], v[80:83], v[116:119], v[208:211]
    s_barrier
    ds_read_b128 v[40:43], v6 offset:0
    ds_read_b128 v[44:47], v6 offset:64
    v_mfma_f32_16x16x32_bf16 v[212:215], v[84:87], v[116:119], v[212:215]
    ds_read_b128 v[48:51], v6 offset:128
    ds_read_b128 v[52:55], v6 offset:192
    v_mfma_f32_16x16x32_bf16 v[216:219], v[88:91], v[116:119], v[216:219]
    ds_read_b32 v72, v8 offset:256
    ds_read_b32 v73, v8 offset:320
    v_mfma_f32_16x16x32_bf16 v[220:223], v[92:95], v[116:119], v[220:223]
    ds_read_b32 v74, v8 offset:512
    ds_read_b32 v75, v8 offset:576
    v_mfma_f32_16x16x32_bf16 v[128:131], v[96:99], v[80:83], v[128:131]
    ds_read_b128 v[56:59], v6 offset:512
    ds_read_b128 v[60:63], v6 offset:576
    v_mfma_f32_16x16x32_bf16 v[132:135], v[96:99], v[84:87], v[132:135]
    ds_read_b128 v[64:67], v6 offset:640
    ds_read_b128 v[68:71], v6 offset:704
    v_mfma_f32_16x16x32_bf16 v[136:139], v[96:99], v[88:91], v[136:139]
    ds_read_b128 v[224:227], v6 offset:1024
    ds_read_b128 v[228:231], v6 offset:1088
    v_mfma_f32_16x16x32_bf16 v[140:143], v[96:99], v[92:95], v[140:143]
    ds_read_b128 v[232:235], v6 offset:1152
    ds_read_b128 v[236:239], v6 offset:1216
    v_mfma_f32_16x16x32_bf16 v[144:147], v[100:103], v[80:83], v[144:147]
    ds_read_b128 v[28:31], v9 offset:0
    ds_read_b128 v[32:35], v9 offset:64
    v_mfma_f32_16x16x32_bf16 v[148:151], v[100:103], v[84:87], v[148:151]
    v_mfma_f32_16x16x32_bf16 v[152:155], v[100:103], v[88:91], v[152:155]
    v_mfma_f32_16x16x32_bf16 v[156:159], v[100:103], v[92:95], v[156:159]
    ds_read_b32 v240, v7 offset:0
    ds_read_b32 v244, v7 offset:512
    ds_read_b32 v248, v7 offset:1024
    ds_read_b32 v241, v7 offset:64
    ds_read_b32 v245, v7 offset:576
    ds_read_b32 v249, v7 offset:1088
    ds_read_b32 v242, v7 offset:128
    ds_read_b32 v246, v7 offset:640
    ds_read_b32 v250, v7 offset:1152
    ds_read_b32 v243, v7 offset:192
    ds_read_b32 v247, v7 offset:704
    ds_read_b32 v251, v7 offset:1216
    s_waitcnt lgkmcnt(12)
    v_pk_fma_f32 v[160:161], v[40:41], v[72:73], v[160:161] op_sel_hi:[1,0,1]
    v_pk_mul_f32 v[112:113], v[160:161], v[224:225]
    v_pk_fma_f32 v[160:161], v[160:161], v[56:57], s[54:55]
    v_exp_f32 v112, v112 clamp
    v_exp_f32 v113, v113 clamp
    v_max_f32 v160, s54, v160
    v_max_f32 v161, s54, v161
    v_pk_add_f32 v[160:161], v[160:161], v[112:113]
    v_cvt_pk_bf16_f32 v80, v160, v161
    v_pk_fma_f32 v[162:163], v[42:43], v[72:73], v[162:163] op_sel_hi:[1,0,1]
    v_pk_mul_f32 v[114:115], v[162:163], v[226:227]
    v_pk_fma_f32 v[162:163], v[162:163], v[58:59], s[54:55]
    v_exp_f32 v114, v114 clamp
    v_exp_f32 v115, v115 clamp
    v_max_f32 v162, s54, v162
    v_max_f32 v163, s54, v163
    v_pk_add_f32 v[162:163], v[162:163], v[114:115]
    v_cvt_pk_bf16_f32 v81, v162, v163
    v_pk_fma_f32 v[164:165], v[44:45], v[72:73], v[164:165] op_sel_hi:[1,0,1]
    v_pk_mul_f32 v[116:117], v[164:165], v[228:229]
    v_pk_fma_f32 v[164:165], v[164:165], v[60:61], s[54:55]
    v_exp_f32 v116, v116 clamp
    v_exp_f32 v117, v117 clamp
    v_max_f32 v164, s54, v164
    v_max_f32 v165, s54, v165
    v_pk_add_f32 v[164:165], v[164:165], v[116:117]
    v_cvt_pk_bf16_f32 v82, v164, v165
    v_pk_fma_f32 v[166:167], v[46:47], v[72:73], v[166:167] op_sel_hi:[1,0,1]
    v_pk_mul_f32 v[118:119], v[166:167], v[230:231]
    v_pk_fma_f32 v[166:167], v[166:167], v[62:63], s[54:55]
    v_exp_f32 v118, v118 clamp
    v_exp_f32 v119, v119 clamp
    v_max_f32 v166, s54, v166
    v_max_f32 v167, s54, v167
    v_pk_add_f32 v[166:167], v[166:167], v[118:119]
    v_cvt_pk_bf16_f32 v83, v166, v167
    v_pk_fma_f32 v[168:169], v[48:49], v[72:73], v[168:169] op_sel_hi:[1,0,1]
    v_pk_mul_f32 v[112:113], v[168:169], v[232:233]
    v_pk_fma_f32 v[168:169], v[168:169], v[64:65], s[54:55]
    v_exp_f32 v112, v112 clamp
    v_exp_f32 v113, v113 clamp
    v_max_f32 v168, s54, v168
    v_max_f32 v169, s54, v169
    v_pk_add_f32 v[168:169], v[168:169], v[112:113]
    v_cvt_pk_bf16_f32 v84, v168, v169
    v_pk_fma_f32 v[170:171], v[50:51], v[72:73], v[170:171] op_sel_hi:[1,0,1]
    v_pk_mul_f32 v[114:115], v[170:171], v[234:235]
    v_pk_fma_f32 v[170:171], v[170:171], v[66:67], s[54:55]
    v_exp_f32 v114, v114 clamp
    v_exp_f32 v115, v115 clamp
    v_max_f32 v170, s54, v170
    v_max_f32 v171, s54, v171
    v_pk_add_f32 v[170:171], v[170:171], v[114:115]
    v_cvt_pk_bf16_f32 v85, v170, v171
    v_pk_fma_f32 v[172:173], v[52:53], v[72:73], v[172:173] op_sel_hi:[1,0,1]
    v_pk_mul_f32 v[116:117], v[172:173], v[236:237]
    v_pk_fma_f32 v[172:173], v[172:173], v[68:69], s[54:55]
    v_exp_f32 v116, v116 clamp
    v_exp_f32 v117, v117 clamp
    v_max_f32 v172, s54, v172
    v_max_f32 v173, s54, v173
    v_pk_add_f32 v[172:173], v[172:173], v[116:117]
    v_cvt_pk_bf16_f32 v86, v172, v173
    v_pk_fma_f32 v[174:175], v[54:55], v[72:73], v[174:175] op_sel_hi:[1,0,1]
    v_pk_mul_f32 v[118:119], v[174:175], v[238:239]
    v_pk_fma_f32 v[174:175], v[174:175], v[70:71], s[54:55]
    v_exp_f32 v118, v118 clamp
    v_exp_f32 v119, v119 clamp
    v_max_f32 v174, s54, v174
    v_max_f32 v175, s54, v175
    v_pk_add_f32 v[174:175], v[174:175], v[118:119]
    v_cvt_pk_bf16_f32 v87, v174, v175
    v_pk_fma_f32 v[176:177], v[40:41], v[72:73], v[176:177] op_sel:[0,1,0] op_sel_hi:[1,1,1]
    v_pk_mul_f32 v[112:113], v[176:177], v[224:225]
    v_pk_fma_f32 v[176:177], v[176:177], v[56:57], s[54:55]
    v_exp_f32 v112, v112 clamp
    v_exp_f32 v113, v113 clamp
    v_max_f32 v176, s54, v176
    v_max_f32 v177, s54, v177
    v_pk_add_f32 v[176:177], v[176:177], v[112:113]
    v_cvt_pk_bf16_f32 v88, v176, v177
    v_pk_fma_f32 v[178:179], v[42:43], v[72:73], v[178:179] op_sel:[0,1,0] op_sel_hi:[1,1,1]
    v_pk_mul_f32 v[114:115], v[178:179], v[226:227]
    v_pk_fma_f32 v[178:179], v[178:179], v[58:59], s[54:55]
    v_exp_f32 v114, v114 clamp
    v_exp_f32 v115, v115 clamp
    v_max_f32 v178, s54, v178
    v_max_f32 v179, s54, v179
    v_pk_add_f32 v[178:179], v[178:179], v[114:115]
    v_cvt_pk_bf16_f32 v89, v178, v179
    v_pk_fma_f32 v[180:181], v[44:45], v[72:73], v[180:181] op_sel:[0,1,0] op_sel_hi:[1,1,1]
    v_pk_mul_f32 v[116:117], v[180:181], v[228:229]
    v_pk_fma_f32 v[180:181], v[180:181], v[60:61], s[54:55]
    v_exp_f32 v116, v116 clamp
    v_exp_f32 v117, v117 clamp
    v_max_f32 v180, s54, v180
    v_max_f32 v181, s54, v181
    v_pk_add_f32 v[180:181], v[180:181], v[116:117]
    v_cvt_pk_bf16_f32 v90, v180, v181
    v_pk_fma_f32 v[182:183], v[46:47], v[72:73], v[182:183] op_sel:[0,1,0] op_sel_hi:[1,1,1]
    v_pk_mul_f32 v[118:119], v[182:183], v[230:231]
    v_pk_fma_f32 v[182:183], v[182:183], v[62:63], s[54:55]
    v_exp_f32 v118, v118 clamp
    v_exp_f32 v119, v119 clamp
    v_max_f32 v182, s54, v182
    v_max_f32 v183, s54, v183
    v_pk_add_f32 v[182:183], v[182:183], v[118:119]
    v_cvt_pk_bf16_f32 v91, v182, v183
    v_pk_fma_f32 v[184:185], v[48:49], v[72:73], v[184:185] op_sel:[0,1,0] op_sel_hi:[1,1,1]
    v_pk_mul_f32 v[112:113], v[184:185], v[232:233]
    v_pk_fma_f32 v[184:185], v[184:185], v[64:65], s[54:55]
    v_exp_f32 v112, v112 clamp
    v_exp_f32 v113, v113 clamp
    v_max_f32 v184, s54, v184
    v_max_f32 v185, s54, v185
    v_pk_add_f32 v[184:185], v[184:185], v[112:113]
    v_cvt_pk_bf16_f32 v92, v184, v185
    v_pk_fma_f32 v[186:187], v[50:51], v[72:73], v[186:187] op_sel:[0,1,0] op_sel_hi:[1,1,1]
    v_pk_mul_f32 v[114:115], v[186:187], v[234:235]
    v_pk_fma_f32 v[186:187], v[186:187], v[66:67], s[54:55]
    v_exp_f32 v114, v114 clamp
    v_exp_f32 v115, v115 clamp
    v_max_f32 v186, s54, v186
    v_max_f32 v187, s54, v187
    v_pk_add_f32 v[186:187], v[186:187], v[114:115]
    v_cvt_pk_bf16_f32 v93, v186, v187
    v_pk_fma_f32 v[188:189], v[52:53], v[72:73], v[188:189] op_sel:[0,1,0] op_sel_hi:[1,1,1]
    v_pk_mul_f32 v[116:117], v[188:189], v[236:237]
    v_pk_fma_f32 v[188:189], v[188:189], v[68:69], s[54:55]
    v_exp_f32 v116, v116 clamp
    v_exp_f32 v117, v117 clamp
    v_max_f32 v188, s54, v188
    v_max_f32 v189, s54, v189
    v_pk_add_f32 v[188:189], v[188:189], v[116:117]
    v_cvt_pk_bf16_f32 v94, v188, v189
    v_pk_fma_f32 v[190:191], v[54:55], v[72:73], v[190:191] op_sel:[0,1,0] op_sel_hi:[1,1,1]
    v_pk_mul_f32 v[118:119], v[190:191], v[238:239]
    v_pk_fma_f32 v[190:191], v[190:191], v[70:71], s[54:55]
    v_exp_f32 v118, v118 clamp
    v_exp_f32 v119, v119 clamp
    v_max_f32 v190, s54, v190
    v_max_f32 v191, s54, v191
    v_pk_add_f32 v[190:191], v[190:191], v[118:119]
    v_cvt_pk_bf16_f32 v95, v190, v191
    v_mov_b32 v120, s95
    v_mov_b32 v121, s95
    v_mov_b32 v122, s95
    v_mov_b32 v123, s95
    v_pk_fma_f32 v[192:193], v[40:41], v[74:75], v[192:193] op_sel_hi:[1,0,1]
    v_pk_mul_f32 v[192:193], v[192:193], v[56:57]
    v_cvt_pk_bf16_f32 v96, v192, v193
    v_pk_fma_f32 v[194:195], v[42:43], v[74:75], v[194:195] op_sel_hi:[1,0,1]
    v_pk_mul_f32 v[194:195], v[194:195], v[58:59]
    v_cvt_pk_bf16_f32 v97, v194, v195
    v_pk_fma_f32 v[196:197], v[44:45], v[74:75], v[196:197] op_sel_hi:[1,0,1]
    v_pk_mul_f32 v[196:197], v[196:197], v[60:61]
    v_cvt_pk_bf16_f32 v98, v196, v197
    v_pk_fma_f32 v[198:199], v[46:47], v[74:75], v[198:199] op_sel_hi:[1,0,1]
    v_pk_mul_f32 v[198:199], v[198:199], v[62:63]
    v_cvt_pk_bf16_f32 v99, v198, v199
    v_pk_fma_f32 v[200:201], v[48:49], v[74:75], v[200:201] op_sel_hi:[1,0,1]
    v_pk_mul_f32 v[200:201], v[200:201], v[64:65]
    v_cvt_pk_bf16_f32 v100, v200, v201
    v_pk_fma_f32 v[202:203], v[50:51], v[74:75], v[202:203] op_sel_hi:[1,0,1]
    v_pk_mul_f32 v[202:203], v[202:203], v[66:67]
    v_cvt_pk_bf16_f32 v101, v202, v203
    v_pk_fma_f32 v[204:205], v[52:53], v[74:75], v[204:205] op_sel_hi:[1,0,1]
    v_pk_mul_f32 v[204:205], v[204:205], v[68:69]
    v_cvt_pk_bf16_f32 v102, v204, v205
    v_pk_fma_f32 v[206:207], v[54:55], v[74:75], v[206:207] op_sel_hi:[1,0,1]
    v_pk_mul_f32 v[206:207], v[206:207], v[70:71]
    v_cvt_pk_bf16_f32 v103, v206, v207
    v_pk_fma_f32 v[208:209], v[40:41], v[74:75], v[208:209] op_sel:[0,1,0] op_sel_hi:[1,1,1]
    v_pk_mul_f32 v[208:209], v[208:209], v[56:57]
    v_cvt_pk_bf16_f32 v104, v208, v209
    v_pk_fma_f32 v[210:211], v[42:43], v[74:75], v[210:211] op_sel:[0,1,0] op_sel_hi:[1,1,1]
    v_pk_mul_f32 v[210:211], v[210:211], v[58:59]
    v_cvt_pk_bf16_f32 v105, v210, v211
    v_pk_fma_f32 v[212:213], v[44:45], v[74:75], v[212:213] op_sel:[0,1,0] op_sel_hi:[1,1,1]
    v_pk_mul_f32 v[212:213], v[212:213], v[60:61]
    v_cvt_pk_bf16_f32 v106, v212, v213
    v_pk_fma_f32 v[214:215], v[46:47], v[74:75], v[214:215] op_sel:[0,1,0] op_sel_hi:[1,1,1]
    v_pk_mul_f32 v[214:215], v[214:215], v[62:63]
    v_cvt_pk_bf16_f32 v107, v214, v215
    v_pk_fma_f32 v[216:217], v[48:49], v[74:75], v[216:217] op_sel:[0,1,0] op_sel_hi:[1,1,1]
    v_pk_mul_f32 v[216:217], v[216:217], v[64:65]
    v_cvt_pk_bf16_f32 v108, v216, v217
    v_pk_fma_f32 v[218:219], v[50:51], v[74:75], v[218:219] op_sel:[0,1,0] op_sel_hi:[1,1,1]
    v_pk_mul_f32 v[218:219], v[218:219], v[66:67]
    v_cvt_pk_bf16_f32 v109, v218, v219
    v_pk_fma_f32 v[220:221], v[52:53], v[74:75], v[220:221] op_sel:[0,1,0] op_sel_hi:[1,1,1]
    v_pk_mul_f32 v[220:221], v[220:221], v[68:69]
    v_cvt_pk_bf16_f32 v110, v220, v221
    v_pk_fma_f32 v[222:223], v[54:55], v[74:75], v[222:223] op_sel:[0,1,0] op_sel_hi:[1,1,1]
    v_pk_mul_f32 v[222:223], v[222:223], v[70:71]
    v_cvt_pk_bf16_f32 v111, v222, v223
    s_mul_i32 s86, s3, 3072
    s_add_u32 s86, s86, 139264
    v_lshl_add_u32 v6, v0, 4, s86
    s_xor_b32 s86, s3, 1
    s_mul_i32 s86, s86, 3072
    s_add_u32 s86, s86, 139264
    v_lshl_add_u32 v7, v0, 4, s86
    s_cmp_eq_u32 s49, 1
    s_cbranch_scc1 L_kv1
    v_mfma_f32_16x16x32_bf16 v[172:175], v[80:83], v[104:107], 0
    v_mfma_f32_16x16x32_bf16 v[176:179], v[88:91], v[104:107], 0
    v_mfma_f32_16x16x32_bf16 v[180:183], v[88:91], v[120:123], 0
    v_mfma_f32_16x16x32_bf16 v[160:163], v[80:83], v[96:99], 0
    v_mfma_f32_16x16x32_bf16 v[164:167], v[88:91], v[96:99], 0
    v_mfma_f32_16x16x32_bf16 v[168:171], v[80:83], v[120:123], 0
    v_mfma_f32_16x16x32_bf16 v[172:175], v[84:87], v[108:111], v[172:175]
    v_mfma_f32_16x16x32_bf16 v[176:179], v[92:95], v[108:111], v[176:179]
    v_mfma_f32_16x16x32_bf16 v[180:183], v[92:95], v[120:123], v[180:183]
    v_mfma_f32_16x16x32_bf16 v[160:163], v[84:87], v[100:103], v[160:163]
    v_mfma_f32_16x16x32_bf16 v[164:167], v[92:95], v[100:103], v[164:167]
    v_mfma_f32_16x16x32_bf16 v[168:171], v[84:87], v[120:123], v[168:171]
    s_branch L_kvd
L_kv1:
    v_mfma_f32_16x16x32_bf16 v[172:175], v[80:83], v[96:99], 0
    v_mfma_f32_16x16x32_bf16 v[176:179], v[88:91], v[96:99], 0
    v_mfma_f32_16x16x32_bf16 v[180:183], v[80:83], v[120:123], 0
    v_mfma_f32_16x16x32_bf16 v[160:163], v[80:83], v[104:107], 0
    v_mfma_f32_16x16x32_bf16 v[164:167], v[88:91], v[104:107], 0
    v_mfma_f32_16x16x32_bf16 v[168:171], v[88:91], v[120:123], 0
    v_mfma_f32_16x16x32_bf16 v[172:175], v[84:87], v[100:103], v[172:175]
    v_mfma_f32_16x16x32_bf16 v[176:179], v[92:95], v[100:103], v[176:179]
    v_mfma_f32_16x16x32_bf16 v[180:183], v[84:87], v[120:123], v[180:183]
    v_mfma_f32_16x16x32_bf16 v[160:163], v[84:87], v[108:111], v[160:163]
    v_mfma_f32_16x16x32_bf16 v[164:167], v[92:95], v[108:111], v[164:167]
    v_mfma_f32_16x16x32_bf16 v[168:171], v[92:95], v[120:123], v[168:171]
L_kvd:
    s_lshl_b32 s86, s47, 1
    s_add_u32 s86, s86, s50
    s_lshl_b32 s87, s86, 1
    s_add_u32 s87, s87, s49
    s_lshl_b32 s87, s87, 4
    s_add_u32 s87, s87, s46
    s_lshl_b32 s87, s87, 10
    s_add_u32 s87, s87, 5242880
    v_lshl_add_u32 v8, v0, 4, s87
    s_lshl_b32 s87, s86, 4
    s_add_u32 s87, s87, s46
    s_lshl_b32 s87, s87, 7
    s_lshl_b32 s88, s49, 6
    s_add_u32 s87, s87, s88
    s_add_u32 s87, s87, 6881280
    v_lshl_add_u32 v9, v21, 4, s87
    v_cmp_eq_u32 vcc, 0, v22
    v_mov_b32 v10, 2147483648
    s_nop 0
    v_cndmask_b32 v9, v10, v9, vcc
    ds_write_b128 v6, v[172:175] offset:0
    ds_write_b128 v6, v[176:179] offset:1024
    ds_write_b128 v6, v[180:183] offset:2048
    ds_write_b32 v12, v12
    s_lshl_b32 s87, s46, 3
    s_lshl_b32 s88, s49, 2
    s_add_u32 s87, s87, s88
    s_lshl_b32 s87, s87, 5
    s_add_u32 s87, s87, s86
    s_lshl_b32 s87, s87, 10
    s_add_u32 s87, s87, 1048576
    v_lshl_add_u32 v10, v0, 4, s87
    s_mul_i32 s87, s50, 3072
    s_add_u32 s87, s87, 151552
    v_lshl_add_u32 v11, v0, 4, s87
    s_lshl_b32 s87, s86, 1
    s_add_u32 s87, s87, s49
    s_lshl_b32 s87, s87, 5
    s_add_u32 s87, s87, s46
    s_lshl2_add_u32 s87, s87, 671744
    v_mov_b32 v16, 2147483648
    v_mov_b32 v18, 2147483648
    v_writelane_b32 v16, s87, 0
    s_lshl_b32 s87, s46, 1
    s_add_u32 s87, s87, s49
    s_lshl_b32 s87, s87, 1
    s_lshr_b32 s88, s86, 4
    s_add_u32 s87, s87, s88
    s_lshl_b32 s87, s87, 6
    s_and_b32 s88, s86, 15
    s_add_u32 s87, s87, s88
    s_lshl2_add_u32 s87, s87, 688128
    v_writelane_b32 v18, s87, 0
    s_add_u32 s87, s87, 128
    v_writelane_b32 v18, s87, 1
    v_mov_b32 v17, s68
L_xkv:
    ds_read_b32 v14, v13
    ds_read_b128 v[172:175], v7 offset:0
    ds_read_b128 v[176:179], v7 offset:1024
    ds_read_b128 v[180:183], v7 offset:2048
    s_waitcnt lgkmcnt(0)
    v_cmp_eq_u32 vcc, 0, v14
    s_cbranch_vccz L_ok_2
    s_sub_u32 s56, s56, 1
    s_cbranch_scc0 L_xkv
    s_mov_b32 s56, 0
L_ok_2:
    v_pk_add_f32 v[160:161], v[160:161], v[172:173]
    v_pk_add_f32 v[162:163], v[162:163], v[174:175]
    v_pk_add_f32 v[164:165], v[164:165], v[176:177]
    v_pk_add_f32 v[166:167], v[166:167], v[178:179]
    v_pk_add_f32 v[168:169], v[168:169], v[180:181]
    v_pk_add_f32 v[170:171], v[170:171], v[182:183]
    v_cvt_pk_bf16_f32 v184, v160, v161
    v_cvt_pk_bf16_f32 v185, v162, v163
    v_cvt_pk_bf16_f32 v186, v164, v165
    v_cvt_pk_bf16_f32 v187, v166, v167
    buffer_store_dwordx4 v[184:187], v8, s[16:19], 0 offen sc1
    buffer_store_dwordx4 v[168:171], v9, s[16:19], 0 offen sc1
    buffer_atomic_swap v17, v16, s[16:19], 0 offen sc1
    v_pk_fma_f32 v[128:129], v[28:29], v[240:241], v[128:129] op_sel_hi:[1,0,1]
    v_pk_mul_f32 v[112:113], v[128:129], v[248:249] op_sel_hi:[1,0]
    v_pk_fma_f32 v[128:129], v[128:129], v[244:245], s[54:55] op_sel_hi:[1,0,1]
    v_exp_f32 v112, v112 clamp
    v_exp_f32 v113, v113 clamp
    v_max_f32 v128, s54, v128
    v_max_f32 v129, s54, v129
    v_pk_add_f32 v[128:129], v[128:129], v[112:113]
    v_cvt_pk_bf16_f32 v192, v128, v129
    v_pk_fma_f32 v[130:131], v[30:31], v[240:241], v[130:131] op_sel_hi:[1,0,1]
    v_pk_mul_f32 v[114:115], v[130:131], v[248:249] op_sel_hi:[1,0]
    v_pk_fma_f32 v[130:131], v[130:131], v[244:245], s[54:55] op_sel_hi:[1,0,1]
    v_exp_f32 v114, v114 clamp
    v_exp_f32 v115, v115 clamp
    v_max_f32 v130, s54, v130
    v_max_f32 v131, s54, v131
    v_pk_add_f32 v[130:131], v[130:131], v[114:115]
    v_cvt_pk_bf16_f32 v193, v130, v131
    v_pk_fma_f32 v[144:145], v[32:33], v[240:241], v[144:145] op_sel_hi:[1,0,1]
    v_pk_mul_f32 v[116:117], v[144:145], v[248:249] op_sel_hi:[1,0]
    v_pk_fma_f32 v[144:145], v[144:145], v[244:245], s[54:55] op_sel_hi:[1,0,1]
    v_exp_f32 v116, v116 clamp
    v_exp_f32 v117, v117 clamp
    v_max_f32 v144, s54, v144
    v_max_f32 v145, s54, v145
    v_pk_add_f32 v[144:145], v[144:145], v[116:117]
    v_cvt_pk_bf16_f32 v194, v144, v145
    v_pk_fma_f32 v[146:147], v[34:35], v[240:241], v[146:147] op_sel_hi:[1,0,1]
    v_pk_mul_f32 v[118:119], v[146:147], v[248:249] op_sel_hi:[1,0]
    v_pk_fma_f32 v[146:147], v[146:147], v[244:245], s[54:55] op_sel_hi:[1,0,1]
    v_exp_f32 v118, v118 clamp
    v_exp_f32 v119, v119 clamp
    v_max_f32 v146, s54, v146
    v_max_f32 v147, s54, v147
    v_pk_add_f32 v[146:147], v[146:147], v[118:119]
    v_cvt_pk_bf16_f32 v195, v146, v147
    v_pk_fma_f32 v[132:133], v[28:29], v[240:241], v[132:133] op_sel:[0,1,0] op_sel_hi:[1,1,1]
    v_pk_mul_f32 v[112:113], v[132:133], v[248:249] op_sel:[0,1] op_sel_hi:[1,1]
    v_pk_fma_f32 v[132:133], v[132:133], v[244:245], s[54:55] op_sel:[0,1,0] op_sel_hi:[1,1,1]
    v_exp_f32 v112, v112 clamp
    v_exp_f32 v113, v113 clamp
    v_max_f32 v132, s54, v132
    v_max_f32 v133, s54, v133
    v_pk_add_f32 v[132:133], v[132:133], v[112:113]
    v_cvt_pk_bf16_f32 v196, v132, v133
    v_pk_fma_f32 v[134:135], v[30:31], v[240:241], v[134:135] op_sel:[0,1,0] op_sel_hi:[1,1,1]
    v_pk_mul_f32 v[114:115], v[134:135], v[248:249] op_sel:[0,1] op_sel_hi:[1,1]
    v_pk_fma_f32 v[134:135], v[134:135], v[244:245], s[54:55] op_sel:[0,1,0] op_sel_hi:[1,1,1]
    v_exp_f32 v114, v114 clamp
    v_exp_f32 v115, v115 clamp
    v_max_f32 v134, s54, v134
    v_max_f32 v135, s54, v135
    v_pk_add_f32 v[134:135], v[134:135], v[114:115]
    v_cvt_pk_bf16_f32 v197, v134, v135
    v_pk_fma_f32 v[148:149], v[32:33], v[240:241], v[148:149] op_sel:[0,1,0] op_sel_hi:[1,1,1]
    v_pk_mul_f32 v[116:117], v[148:149], v[248:249] op_sel:[0,1] op_sel_hi:[1,1]
    v_pk_fma_f32 v[148:149], v[148:149], v[244:245], s[54:55] op_sel:[0,1,0] op_sel_hi:[1,1,1]
    v_exp_f32 v116, v116 clamp
    v_exp_f32 v117, v117 clamp
    v_max_f32 v148, s54, v148
    v_max_f32 v149, s54, v149
    v_pk_add_f32 v[148:149], v[148:149], v[116:117]
    v_cvt_pk_bf16_f32 v198, v148, v149
    v_pk_fma_f32 v[150:151], v[34:35], v[240:241], v[150:151] op_sel:[0,1,0] op_sel_hi:[1,1,1]
    v_pk_mul_f32 v[118:119], v[150:151], v[248:249] op_sel:[0,1] op_sel_hi:[1,1]
    v_pk_fma_f32 v[150:151], v[150:151], v[244:245], s[54:55] op_sel:[0,1,0] op_sel_hi:[1,1,1]
    v_exp_f32 v118, v118 clamp
    v_exp_f32 v119, v119 clamp
    v_max_f32 v150, s54, v150
    v_max_f32 v151, s54, v151
    v_pk_add_f32 v[150:151], v[150:151], v[118:119]
    v_cvt_pk_bf16_f32 v199, v150, v151
    v_pk_fma_f32 v[136:137], v[28:29], v[242:243], v[136:137] op_sel_hi:[1,0,1]
    v_pk_mul_f32 v[112:113], v[136:137], v[250:251] op_sel_hi:[1,0]
    v_pk_fma_f32 v[136:137], v[136:137], v[246:247], s[54:55] op_sel_hi:[1,0,1]
    v_exp_f32 v112, v112 clamp
    v_exp_f32 v113, v113 clamp
    v_max_f32 v136, s54, v136
    v_max_f32 v137, s54, v137
    v_pk_add_f32 v[136:137], v[136:137], v[112:113]
    v_cvt_pk_bf16_f32 v200, v136, v137
    v_pk_fma_f32 v[138:139], v[30:31], v[242:243], v[138:139] op_sel_hi:[1,0,1]
    v_pk_mul_f32 v[114:115], v[138:139], v[250:251] op_sel_hi:[1,0]
    v_pk_fma_f32 v[138:139], v[138:139], v[246:247], s[54:55] op_sel_hi:[1,0,1]
    v_exp_f32 v114, v114 clamp
    v_exp_f32 v115, v115 clamp
    v_max_f32 v138, s54, v138
    v_max_f32 v139, s54, v139
    v_pk_add_f32 v[138:139], v[138:139], v[114:115]
    v_cvt_pk_bf16_f32 v201, v138, v139
    v_pk_fma_f32 v[152:153], v[32:33], v[242:243], v[152:153] op_sel_hi:[1,0,1]
    v_pk_mul_f32 v[116:117], v[152:153], v[250:251] op_sel_hi:[1,0]
    v_pk_fma_f32 v[152:153], v[152:153], v[246:247], s[54:55] op_sel_hi:[1,0,1]
    v_exp_f32 v116, v116 clamp
    v_exp_f32 v117, v117 clamp
    v_max_f32 v152, s54, v152
    v_max_f32 v153, s54, v153
    v_pk_add_f32 v[152:153], v[152:153], v[116:117]
    v_cvt_pk_bf16_f32 v202, v152, v153
    v_pk_fma_f32 v[154:155], v[34:35], v[242:243], v[154:155] op_sel_hi:[1,0,1]
    v_pk_mul_f32 v[118:119], v[154:155], v[250:251] op_sel_hi:[1,0]
    v_pk_fma_f32 v[154:155], v[154:155], v[246:247], s[54:55] op_sel_hi:[1,0,1]
    v_exp_f32 v118, v118 clamp
    v_exp_f32 v119, v119 clamp
    v_max_f32 v154, s54, v154
    v_max_f32 v155, s54, v155
    v_pk_add_f32 v[154:155], v[154:155], v[118:119]
    v_cvt_pk_bf16_f32 v203, v154, v155
    v_pk_fma_f32 v[140:141], v[28:29], v[242:243], v[140:141] op_sel:[0,1,0] op_sel_hi:[1,1,1]
    v_pk_mul_f32 v[112:113], v[140:141], v[250:251] op_sel:[0,1] op_sel_hi:[1,1]
    v_pk_fma_f32 v[140:141], v[140:141], v[246:247], s[54:55] op_sel:[0,1,0] op_sel_hi:[1,1,1]
    v_exp_f32 v112, v112 clamp
    v_exp_f32 v113, v113 clamp
    v_max_f32 v140, s54, v140
    v_max_f32 v141, s54, v141
    v_pk_add_f32 v[140:141], v[140:141], v[112:113]
    v_cvt_pk_bf16_f32 v204, v140, v141
    v_pk_fma_f32 v[142:143], v[30:31], v[242:243], v[142:143] op_sel:[0,1,0] op_sel_hi:[1,1,1]
    v_pk_mul_f32 v[114:115], v[142:143], v[250:251] op_sel:[0,1] op_sel_hi:[1,1]
    v_pk_fma_f32 v[142:143], v[142:143], v[246:247], s[54:55] op_sel:[0,1,0] op_sel_hi:[1,1,1]
    v_exp_f32 v114, v114 clamp
    v_exp_f32 v115, v115 clamp
    v_max_f32 v142, s54, v142
    v_max_f32 v143, s54, v143
    v_pk_add_f32 v[142:143], v[142:143], v[114:115]
    v_cvt_pk_bf16_f32 v205, v142, v143
    v_pk_fma_f32 v[156:157], v[32:33], v[242:243], v[156:157] op_sel:[0,1,0] op_sel_hi:[1,1,1]
    v_pk_mul_f32 v[116:117], v[156:157], v[250:251] op_sel:[0,1] op_sel_hi:[1,1]
    v_pk_fma_f32 v[156:157], v[156:157], v[246:247], s[54:55] op_sel:[0,1,0] op_sel_hi:[1,1,1]
    v_exp_f32 v116, v116 clamp
    v_exp_f32 v117, v117 clamp
    v_max_f32 v156, s54, v156
    v_max_f32 v157, s54, v157
    v_pk_add_f32 v[156:157], v[156:157], v[116:117]
    v_cvt_pk_bf16_f32 v206, v156, v157
    v_pk_fma_f32 v[158:159], v[34:35], v[242:243], v[158:159] op_sel:[0,1,0] op_sel_hi:[1,1,1]
    v_pk_mul_f32 v[118:119], v[158:159], v[250:251] op_sel:[0,1] op_sel_hi:[1,1]
    v_pk_fma_f32 v[158:159], v[158:159], v[246:247], s[54:55] op_sel:[0,1,0] op_sel_hi:[1,1,1]
    v_exp_f32 v118, v118 clamp
    v_exp_f32 v119, v119 clamp
    v_max_f32 v158, s54, v158
    v_max_f32 v159, s54, v159
    v_pk_add_f32 v[158:159], v[158:159], v[118:119]
    v_cvt_pk_bf16_f32 v207, v158, v159
    s_lshr_b32 s62, s3, 2
    s_lshl_b32 s53, s51, 3
    s_lshl_b32 s86, s48, 1
    s_add_u32 s53, s53, s86
    s_add_u32 s53, s53, s62
    v_lshrrev_b32 v36, 4, v0
    v_and_b32 v37, 15, v0
    s_lshl_b32 s87, s53, 15
    s_lshl_b32 s86, s62, 14
    s_add_u32 s86, s86, s87
    s_add_u32 s86, s86, 1048576
    v_lshl_add_u32 v157, v0, 4, s86
    v_xor_b32 v158, 0x8000, v157
    s_lshl_b32 s86, s51, 1
    s_lshr_b32 s87, s48, 1
    s_add_u32 s86, s86, s87
    s_lshl_b32 s86, s86, 1
    s_add_u32 s86, s86, s62
    s_lshl_b32 s86, s86, 1
    s_and_b32 s87, s48, 1
    s_add_u32 s86, s86, s87
    s_lshl_b32 s86, s86, 7
    s_add_u32 s86, s86, 688128
    v_lshl_add_u32 v159, v0, 2, s86
    v_mov_b32 v38, 2147483648
    v_cmp_gt_u32 vcc, 16, v0
    s_nop 1
    v_cndmask_b32 v159, v38, v159, vcc
    v_bfe_u32 v38, v0, 2, 2
    v_lshl_add_u32 v38, v36, 2, v38
    v_bfe_u32 v39, v38, 1, 2
    v_lshlrev_b32 v38, 7, v38
    v_lshl_add_u32 v38, v39, 5, v38
    v_and_b32 v39, 3, v0
    v_lshl_add_u32 v38, v39, 3, v38
    s_lshl_b32 s86, s62, 16
    s_add_u32 s86, s86, 0
    v_add_u32 v144, s86, v38
    v_xor_b32 v145, 32, v144
    v_xor_b32 v146, 64, v144
    v_xor_b32 v147, 96, v144
    v_cmp_eq_u32 s[4:5], 1, v39
    v_cmp_eq_u32 s[6:7], 2, v39
    v_cmp_eq_u32 s[98:99], 3, v39
    s_lshl_b32 s86, s53, 8
    s_add_u32 s86, s86, 589824
    v_lshl_add_u32 v160, v0, 2, s86
    s_mov_b32 s72, 0x00f0000f
    s_mov_b32 s73, 0xf0000f00
    s_mov_b32 s74, 0x0f00f000
    s_mov_b32 s75, 0x0f00f000
    v_lshrrev_b32 v38, 2, v37
    v_lshl_add_u32 v161, v38, 4, v37
    v_lshlrev_b32 v161, 2, v161
    s_lshl_b32 s86, s3, 12
    s_add_u32 s86, s86, 131072
    v_lshl_add_u32 v162, v0, 4, s86
    v_xor_b32 v163, 0x4000, v162
    s_lshl_b32 s86, s52, 7
    v_lshl_add_u32 v36, v36, 3, s86
    s_lshl_b32 s87, s53, 15
    s_add_u32 s87, s87, s86
    s_lshl_b32 s86, s62, 6
    s_add_u32 s87, s87, s86
    v_lshl_add_u32 v39, v37, 11, s87
    v_and_b32 v38, 48, v0
    v_add_u32 v39, v39, v38
    v_xor_b32 v37, 0x8000, v39
    s_barrier
    ds_read_b128 v[40:43], v11 offset:0
    ds_read_b128 v[44:47], v11 offset:1024
    ds_read_b128 v[48:51], v11 offset:2048
    v_mov_b32 v38, 135200
    ds_read_b32 v38, v38
    buffer_load_dwordx4 v[136:139], v39, s[8:11], 0 offen
    buffer_load_dwordx4 v[140:143], v37, s[8:11], 0 offen
    buffer_load_dwordx2 v[148:149], v36, s[40:43], 0 offen offset:0
    buffer_load_dwordx2 v[150:151], v36, s[40:43], 0 offen offset:32
    buffer_load_dwordx2 v[152:153], v36, s[40:43], 0 offen offset:64
    buffer_load_dwordx2 v[154:155], v36, s[40:43], 0 offen offset:96
    s_mov_b32 s86, 0x8000
    s_mov_b32 s87, 0x10000
    s_mov_b32 s88, 0x18000
    s_waitcnt lgkmcnt(0)
    v_mfma_f32_16x16x32_bf16 v[216:219], v[48:51], v[192:195], 0
    v_mfma_f32_16x16x32_bf16 v[208:211], v[40:43], v[192:195], 0
    v_mfma_f32_16x16x32_bf16 v[212:215], v[44:47], v[192:195], 0
    v_mfma_f32_16x16x32_bf16 v[228:231], v[48:51], v[196:199], 0
    v_mfma_f32_16x16x32_bf16 v[220:223], v[40:43], v[196:199], 0
    v_mfma_f32_16x16x32_bf16 v[224:227], v[44:47], v[196:199], 0
    v_mfma_f32_16x16x32_bf16 v[240:243], v[48:51], v[200:203], 0
    v_mfma_f32_16x16x32_bf16 v[232:235], v[40:43], v[200:203], 0
    v_mfma_f32_16x16x32_bf16 v[236:239], v[44:47], v[200:203], 0
    v_mfma_f32_16x16x32_bf16 v[252:255], v[48:51], v[204:207], 0
    v_mfma_f32_16x16x32_bf16 v[244:247], v[40:43], v[204:207], 0
    v_mfma_f32_16x16x32_bf16 v[248:251], v[44:47], v[204:207], 0
    v_add_f32 v216, s54, v216
    v_rcp_f32 v216, v216
    s_nop 0
    v_pk_mul_f32 v[208:209], v[208:209], v[216:217] op_sel_hi:[1,0]
    v_pk_mul_f32 v[210:211], v[210:211], v[216:217] op_sel_hi:[1,0]
    v_pk_mul_f32 v[212:213], v[212:213], v[216:217] op_sel_hi:[1,0]
    v_pk_mul_f32 v[214:215], v[214:215], v[216:217] op_sel_hi:[1,0]
    v_cvt_pk_bf16_f32 v60, v208, v209
    v_cvt_pk_bf16_f32 v61, v210, v211
    v_cvt_pk_bf16_f32 v62, v212, v213
    v_cvt_pk_bf16_f32 v63, v214, v215
    buffer_store_dwordx4 v[60:63], v10, s[16:19], 0 offen sc1
    v_add_f32 v228, s54, v228
    v_rcp_f32 v228, v228
    s_nop 0
    v_pk_mul_f32 v[220:221], v[220:221], v[228:229] op_sel_hi:[1,0]
    v_pk_mul_f32 v[222:223], v[222:223], v[228:229] op_sel_hi:[1,0]
    v_pk_mul_f32 v[224:225], v[224:225], v[228:229] op_sel_hi:[1,0]
    v_pk_mul_f32 v[226:227], v[226:227], v[228:229] op_sel_hi:[1,0]
    v_cvt_pk_bf16_f32 v64, v220, v221
    v_cvt_pk_bf16_f32 v65, v222, v223
    v_cvt_pk_bf16_f32 v66, v224, v225
    v_cvt_pk_bf16_f32 v67, v226, v227
    buffer_store_dwordx4 v[64:67], v10, s[16:19], s86 offen sc1
    v_add_f32 v240, s54, v240
    v_rcp_f32 v240, v240
    s_nop 0
    v_pk_mul_f32 v[232:233], v[232:233], v[240:241] op_sel_hi:[1,0]
    v_pk_mul_f32 v[234:235], v[234:235], v[240:241] op_sel_hi:[1,0]
    v_pk_mul_f32 v[236:237], v[236:237], v[240:241] op_sel_hi:[1,0]
    v_pk_mul_f32 v[238:239], v[238:239], v[240:241] op_sel_hi:[1,0]
    v_cvt_pk_bf16_f32 v68, v232, v233
    v_cvt_pk_bf16_f32 v69, v234, v235
    v_cvt_pk_bf16_f32 v70, v236, v237
    v_cvt_pk_bf16_f32 v71, v238, v239
    buffer_store_dwordx4 v[68:71], v10, s[16:19], s87 offen sc1
    v_add_f32 v252, s54, v252
    v_rcp_f32 v252, v252
    s_nop 0
    v_pk_mul_f32 v[244:245], v[244:245], v[252:253] op_sel_hi:[1,0]
    v_pk_mul_f32 v[246:247], v[246:247], v[252:253] op_sel_hi:[1,0]
    v_pk_mul_f32 v[248:249], v[248:249], v[252:253] op_sel_hi:[1,0]
    v_pk_mul_f32 v[250:251], v[250:251], v[252:253] op_sel_hi:[1,0]
    v_cvt_pk_bf16_f32 v72, v244, v245
    v_cvt_pk_bf16_f32 v73, v246, v247
    v_cvt_pk_bf16_f32 v74, v248, v249
    v_cvt_pk_bf16_f32 v75, v250, v251
    buffer_store_dwordx4 v[72:75], v10, s[16:19], s88 offen sc1
    buffer_atomic_swap v17, v18, s[16:19], 0 offen sc1
    v_mov_b32 v8, 0
    buffer_atomic_or v8, v159, s[16:19], 0 offen sc0 sc1
    v_mov_b32 v14, 2147483648
    v_mov_b32 v11, 2147483648
    s_waitcnt vmcnt(6)
    v_bfe_u32 v36, v0, 2, 1
    v_cmp_eq_u32 vcc, 1, v36
    v_mov_b32 v36, s95
    s_nop 0
    v_cndmask_b32 v148, v36, v148, vcc
    v_cndmask_b32 v149, v36, v149, vcc
    v_cndmask_b32 v150, v36, v150, vcc
    v_cndmask_b32 v151, v36, v151, vcc
    v_cndmask_b32 v152, v36, v152, vcc
    v_cndmask_b32 v153, v36, v153, vcc
    v_cndmask_b32 v154, v36, v154, vcc
    v_cndmask_b32 v155, v36, v155, vcc
    v_readfirstlane_b32 s57, v38
L_phaseB:
    v_lshrrev_b32 v1, 4, v0
    v_and_b32 v2, 15, v0
    v_mov_b32 v3, 0x3f80
    s_lshl_b32 s87, s53, 4
    v_add_u32 v6, s87, v2
    s_lshl_b32 s86, s52, 7
    v_lshl_add_u32 v5, v6, 11, s86
    v_sub_u32 v6, 2047, v6
    v_mov_b32 v7, v39
    v_lshrrev_b32 v9, 1, v1
    v_lshl_add_u32 v5, v9, 4, v5
    v_and_b32 v9, 1, v1
    v_lshl_add_u32 v5, v9, 5, v5
    s_mov_b32 s67, 0
    s_mov_b32 s66, 0xffffaaaa
L_b_init:
    v_bfe_u32 v9, v0, 3, 1
    v_bfe_u32 v10, v0, 4, 1
    v_xor_b32 v9, v9, v10
    v_bfe_u32 v10, v0, 1, 2
    v_lshl_add_u32 v9, v9, 3, v10
    v_lshrrev_b32 v10, 5, v0
    v_lshl_add_u32 v9, v10, 2, v9
    v_and_b32 v10, 1, v0
    v_lshlrev_b32 v10, 4, v10
    v_lshlrev_b32 v10, v10, v3
    v_cmp_eq_u32 vcc, 0, v9
    s_nop 1
    v_cndmask_b32 v128, 0, v10, vcc
    v_cmp_eq_u32 vcc, 1, v9
    s_nop 1
    v_cndmask_b32 v129, 0, v10, vcc
    v_cmp_eq_u32 vcc, 2, v9
    s_nop 1
    v_cndmask_b32 v130, 0, v10, vcc
    v_cmp_eq_u32 vcc, 3, v9
    s_nop 1
    v_cndmask_b32 v131, 0, v10, vcc
    v_cmp_eq_u32 vcc, 4, v9
    s_nop 1
    v_cndmask_b32 v132, 0, v10, vcc
    v_cmp_eq_u32 vcc, 5, v9
    s_nop 1
    v_cndmask_b32 v133, 0, v10, vcc
    v_cmp_eq_u32 vcc, 6, v9
    s_nop 1
    v_cndmask_b32 v134, 0, v10, vcc
    v_cmp_eq_u32 vcc, 7, v9
    s_nop 1
    v_cndmask_b32 v135, 0, v10, vcc
    v_mov_b32 v80, 0
    v_mov_b32 v81, 0
    v_mov_b32 v82, 0
    v_mov_b32 v83, 0
    v_mov_b32 v84, 0
    v_mov_b32 v85, 0
    v_mov_b32 v86, 0
    v_mov_b32 v87, 0
    v_mov_b32 v88, 0
    v_mov_b32 v89, 0
    v_mov_b32 v90, 0
    v_mov_b32 v91, 0
    v_mov_b32 v92, 0
    v_mov_b32 v93, 0
    v_mov_b32 v94, 0
    v_mov_b32 v95, 0
    v_mov_b32 v96, 0
    v_mov_b32 v97, 0
    v_mov_b32 v98, 0
    v_mov_b32 v99, 0
    v_mov_b32 v100, 0
    v_mov_b32 v101, 0
    v_mov_b32 v102, 0
    v_mov_b32 v103, 0
    v_mov_b32 v104, 0
    v_mov_b32 v105, 0
    v_mov_b32 v106, 0
    v_mov_b32 v107, 0
    v_mov_b32 v108, 0
    v_mov_b32 v109, 0
    v_mov_b32 v110, 0
    v_mov_b32 v111, 0
    v_mov_b32 v156, 0
    s_branch L_b_w0
L_b_r0:
    s_ff1_i32_b32 s91, s65
    s_bitset0_b32 s65, s91
    s_lshl_b32 s76, s91, 12
    s_lshl_b32 s91, s91, 10
    buffer_load_dwordx4 v[16:19], v157, s[16:19], s91 offen offset:0 sc1
    buffer_load_dwordx4 v[20:23], v158, s[16:19], s91 offen offset:0 sc1
    buffer_load_dwordx4 v[24:27], v157, s[16:19], s91 offen offset:1024 sc1
    buffer_load_dwordx4 v[28:31], v158, s[16:19], s91 offen offset:1024 sc1
    s_cmp_eq_u32 s65, 0
    s_cbranch_scc1 L_b_p1
L_b_r1:
    s_ff1_i32_b32 s91, s65
    s_bitset0_b32 s65, s91
    s_lshl_b32 s77, s91, 12
    s_lshl_b32 s91, s91, 10
    buffer_load_dwordx4 v[32:35], v157, s[16:19], s91 offen offset:0 sc1
    buffer_load_dwordx4 v[36:39], v158, s[16:19], s91 offen offset:0 sc1
    buffer_load_dwordx4 v[40:43], v157, s[16:19], s91 offen offset:1024 sc1
    buffer_load_dwordx4 v[44:47], v158, s[16:19], s91 offen offset:1024 sc1
    s_xor_b32 s89, s67, s76
    s_mov_b32 s67, s76
    v_xor_b32 v144, s89, v144
    ds_read_b64_tr_b16 v[112:113], v144 offset:0
    ds_read_b64_tr_b16 v[114:115], v144 offset:2048
    v_xor_b32 v145, s89, v145
    ds_read_b64_tr_b16 v[116:117], v145 offset:0
    ds_read_b64_tr_b16 v[118:119], v145 offset:2048
    v_xor_b32 v146, s89, v146
    ds_read_b64_tr_b16 v[120:121], v146 offset:0
    ds_read_b64_tr_b16 v[122:123], v146 offset:2048
    v_xor_b32 v147, s89, v147
    ds_read_b64_tr_b16 v[124:125], v147 offset:0
    ds_read_b64_tr_b16 v[126:127], v147 offset:2048
    s_cmp_eq_u32 s62, 0
    s_cbranch_scc0 L_b_x1
    v_mfma_f32_16x16x32_bf16 v[80:83], v[128:131], v[136:139], 0
    v_mfma_f32_16x16x32_bf16 v[96:99], v[128:131], v[140:143], 0
    v_mfma_f32_16x16x32_bf16 v[84:87], v[132:135], v[136:139], 0
    v_mfma_f32_16x16x32_bf16 v[100:103], v[132:135], v[140:143], 0
    s_branch L_b_xd
L_b_x1:
    v_mfma_f32_16x16x32_bf16 v[88:91], v[128:131], v[136:139], 0
    v_mfma_f32_16x16x32_bf16 v[104:107], v[128:131], v[140:143], 0
    v_mfma_f32_16x16x32_bf16 v[92:95], v[132:135], v[136:139], 0
    v_mfma_f32_16x16x32_bf16 v[108:111], v[132:135], v[140:143], 0
L_b_xd:
    s_waitcnt vmcnt(6) lgkmcnt(6)
    v_max3_u32 v156, v156, v19, v23
    v_mfma_f32_16x16x32_bf16 v[80:83], v[112:115], v[16:19], v[80:83]
    ds_read_b64_tr_b16 v[128:129], v144 offset:4096
    v_mfma_f32_16x16x32_bf16 v[96:99], v[112:115], v[20:23], v[96:99]
    ds_read_b64_tr_b16 v[130:131], v144 offset:6144
    s_waitcnt lgkmcnt(6)
    v_mfma_f32_16x16x32_bf16 v[84:87], v[116:119], v[16:19], v[84:87]
    ds_read_b64_tr_b16 v[132:133], v145 offset:4096
    v_mfma_f32_16x16x32_bf16 v[100:103], v[116:119], v[20:23], v[100:103]
    ds_read_b64_tr_b16 v[134:135], v145 offset:6144
    s_waitcnt lgkmcnt(6)
    v_mfma_f32_16x16x32_bf16 v[88:91], v[120:123], v[16:19], v[88:91]
    ds_read_b64_tr_b16 v[136:137], v146 offset:4096
    v_mfma_f32_16x16x32_bf16 v[104:107], v[120:123], v[20:23], v[104:107]
    ds_read_b64_tr_b16 v[138:139], v146 offset:6144
    s_waitcnt lgkmcnt(6)
    v_mfma_f32_16x16x32_bf16 v[92:95], v[124:127], v[16:19], v[92:95]
    ds_read_b64_tr_b16 v[140:141], v147 offset:4096
    v_mfma_f32_16x16x32_bf16 v[108:111], v[124:127], v[20:23], v[108:111]
    ds_read_b64_tr_b16 v[142:143], v147 offset:6144
    s_cmp_eq_u32 s65, 0
    s_cbranch_scc1 L_b_p2
L_b_r2:
    s_ff1_i32_b32 s91, s65
    s_bitset0_b32 s65, s91
    s_lshl_b32 s78, s91, 12
    s_lshl_b32 s91, s91, 10
    buffer_load_dwordx4 v[48:51], v157, s[16:19], s91 offen offset:0 sc1
    buffer_load_dwordx4 v[52:55], v158, s[16:19], s91 offen offset:0 sc1
    s_waitcnt vmcnt(6) lgkmcnt(6)
    v_max3_u32 v156, v156, v27, v31
    v_mfma_f32_16x16x32_bf16 v[80:83], v[128:131], v[24:27], v[80:83]
    s_xor_b32 s89, s67, s77
    s_mov_b32 s67, s77
    v_xor_b32 v144, s89, v144
    ds_read_b64_tr_b16 v[112:113], v144 offset:0
    v_mfma_f32_16x16x32_bf16 v[96:99], v[128:131], v[28:31], v[96:99]
    ds_read_b64_tr_b16 v[114:115], v144 offset:2048
    s_waitcnt lgkmcnt(6)
    v_mfma_f32_16x16x32_bf16 v[84:87], v[132:135], v[24:27], v[84:87]
    v_xor_b32 v145, s89, v145
    ds_read_b64_tr_b16 v[116:117], v145 offset:0
    v_mfma_f32_16x16x32_bf16 v[100:103], v[132:135], v[28:31], v[100:103]
    ds_read_b64_tr_b16 v[118:119], v145 offset:2048
    s_waitcnt lgkmcnt(6)
    v_mfma_f32_16x16x32_bf16 v[88:91], v[136:139], v[24:27], v[88:91]
    v_xor_b32 v146, s89, v146
    ds_read_b64_tr_b16 v[120:121], v146 offset:0
    v_mfma_f32_16x16x32_bf16 v[104:107], v[136:139], v[28:31], v[104:107]
    ds_read_b64_tr_b16 v[122:123], v146 offset:2048
    s_waitcnt lgkmcnt(6)
    v_mfma_f32_16x16x32_bf16 v[92:95], v[140:143], v[24:27], v[92:95]
    v_xor_b32 v147, s89, v147
    ds_read_b64_tr_b16 v[124:125], v147 offset:0
    v_mfma_f32_16x16x32_bf16 v[108:111], v[140:143], v[28:31], v[108:111]
    ds_read_b64_tr_b16 v[126:127], v147 offset:2048
    buffer_load_dwordx4 v[56:59], v157, s[16:19], s91 offen offset:1024 sc1
    buffer_load_dwordx4 v[60:63], v158, s[16:19], s91 offen offset:1024 sc1
    s_waitcnt vmcnt(6) lgkmcnt(6)
    v_max3_u32 v156, v156, v35, v39
    v_mfma_f32_16x16x32_bf16 v[80:83], v[112:115], v[32:35], v[80:83]
    ds_read_b64_tr_b16 v[128:129], v144 offset:4096
    v_mfma_f32_16x16x32_bf16 v[96:99], v[112:115], v[36:39], v[96:99]
    ds_read_b64_tr_b16 v[130:131], v144 offset:6144
    s_waitcnt lgkmcnt(6)
    v_mfma_f32_16x16x32_bf16 v[84:87], v[116:119], v[32:35], v[84:87]
    ds_read_b64_tr_b16 v[132:133], v145 offset:4096
    v_mfma_f32_16x16x32_bf16 v[100:103], v[116:119], v[36:39], v[100:103]
    ds_read_b64_tr_b16 v[134:135], v145 offset:6144
    s_waitcnt lgkmcnt(6)
    v_mfma_f32_16x16x32_bf16 v[88:91], v[120:123], v[32:35], v[88:91]
    ds_read_b64_tr_b16 v[136:137], v146 offset:4096
    v_mfma_f32_16x16x32_bf16 v[104:107], v[120:123], v[36:39], v[104:107]
    ds_read_b64_tr_b16 v[138:139], v146 offset:6144
    s_waitcnt lgkmcnt(6)
    v_mfma_f32_16x16x32_bf16 v[92:95], v[124:127], v[32:35], v[92:95]
    ds_read_b64_tr_b16 v[140:141], v147 offset:4096
    v_mfma_f32_16x16x32_bf16 v[108:111], v[124:127], v[36:39], v[108:111]
    ds_read_b64_tr_b16 v[142:143], v147 offset:6144
    s_cmp_eq_u32 s65, 0
    s_cbranch_scc1 L_b_p3
L_b_r3:
    s_ff1_i32_b32 s91, s65
    s_bitset0_b32 s65, s91
    s_lshl_b32 s79, s91, 12
    s_lshl_b32 s91, s91, 10
    buffer_load_dwordx4 v[64:67], v157, s[16:19], s91 offen offset:0 sc1
    buffer_load_dwordx4 v[68:71], v158, s[16:19], s91 offen offset:0 sc1
    s_waitcnt vmcnt(6) lgkmcnt(6)
    v_max3_u32 v156, v156, v43, v47
    v_mfma_f32_16x16x32_bf16 v[80:83], v[128:131], v[40:43], v[80:83]
    s_xor_b32 s89, s67, s78
    s_mov_b32 s67, s78
    v_xor_b32 v144, s89, v144
    ds_read_b64_tr_b16 v[112:113], v144 offset:0
    v_mfma_f32_16x16x32_bf16 v[96:99], v[128:131], v[44:47], v[96:99]
    ds_read_b64_tr_b16 v[114:115], v144 offset:2048
    s_waitcnt lgkmcnt(6)
    v_mfma_f32_16x16x32_bf16 v[84:87], v[132:135], v[40:43], v[84:87]
    v_xor_b32 v145, s89, v145
    ds_read_b64_tr_b16 v[116:117], v145 offset:0
    v_mfma_f32_16x16x32_bf16 v[100:103], v[132:135], v[44:47], v[100:103]
    ds_read_b64_tr_b16 v[118:119], v145 offset:2048
    s_waitcnt lgkmcnt(6)
    v_mfma_f32_16x16x32_bf16 v[88:91], v[136:139], v[40:43], v[88:91]
    v_xor_b32 v146, s89, v146
    ds_read_b64_tr_b16 v[120:121], v146 offset:0
    v_mfma_f32_16x16x32_bf16 v[104:107], v[136:139], v[44:47], v[104:107]
    ds_read_b64_tr_b16 v[122:123], v146 offset:2048
    s_waitcnt lgkmcnt(6)
    v_mfma_f32_16x16x32_bf16 v[92:95], v[140:143], v[40:43], v[92:95]
    v_xor_b32 v147, s89, v147
    ds_read_b64_tr_b16 v[124:125], v147 offset:0
    v_mfma_f32_16x16x32_bf16 v[108:111], v[140:143], v[44:47], v[108:111]
    ds_read_b64_tr_b16 v[126:127], v147 offset:2048
    buffer_load_dwordx4 v[72:75], v157, s[16:19], s91 offen offset:1024 sc1
    buffer_load_dwordx4 v[76:79], v158, s[16:19], s91 offen offset:1024 sc1
    s_waitcnt vmcnt(6) lgkmcnt(6)
    v_max3_u32 v156, v156, v51, v55
    v_mfma_f32_16x16x32_bf16 v[80:83], v[112:115], v[48:51], v[80:83]
    ds_read_b64_tr_b16 v[128:129], v144 offset:4096
    v_mfma_f32_16x16x32_bf16 v[96:99], v[112:115], v[52:55], v[96:99]
    ds_read_b64_tr_b16 v[130:131], v144 offset:6144
    s_waitcnt lgkmcnt(6)
    v_mfma_f32_16x16x32_bf16 v[84:87], v[116:119], v[48:51], v[84:87]
    ds_read_b64_tr_b16 v[132:133], v145 offset:4096
    v_mfma_f32_16x16x32_bf16 v[100:103], v[116:119], v[52:55], v[100:103]
    ds_read_b64_tr_b16 v[134:135], v145 offset:6144
    s_waitcnt lgkmcnt(6)
    v_mfma_f32_16x16x32_bf16 v[88:91], v[120:123], v[48:51], v[88:91]
    ds_read_b64_tr_b16 v[136:137], v146 offset:4096
    v_mfma_f32_16x16x32_bf16 v[104:107], v[120:123], v[52:55], v[104:107]
    ds_read_b64_tr_b16 v[138:139], v146 offset:6144
    s_waitcnt lgkmcnt(6)
    v_mfma_f32_16x16x32_bf16 v[92:95], v[124:127], v[48:51], v[92:95]
    ds_read_b64_tr_b16 v[140:141], v147 offset:4096
    v_mfma_f32_16x16x32_bf16 v[108:111], v[124:127], v[52:55], v[108:111]
    ds_read_b64_tr_b16 v[142:143], v147 offset:6144
    s_cmp_eq_u32 s65, 0
    s_cbranch_scc1 L_b_p4
L_b_r4:
    s_ff1_i32_b32 s91, s65
    s_bitset0_b32 s65, s91
    s_lshl_b32 s76, s91, 12
    s_lshl_b32 s91, s91, 10
    buffer_load_dwordx4 v[16:19], v157, s[16:19], s91 offen offset:0 sc1
    buffer_load_dwordx4 v[20:23], v158, s[16:19], s91 offen offset:0 sc1
    s_waitcnt vmcnt(6) lgkmcnt(6)
    v_max3_u32 v156, v156, v59, v63
    v_mfma_f32_16x16x32_bf16 v[80:83], v[128:131], v[56:59], v[80:83]
    s_xor_b32 s89, s67, s79
    s_mov_b32 s67, s79
    v_xor_b32 v144, s89, v144
    ds_read_b64_tr_b16 v[112:113], v144 offset:0
    v_mfma_f32_16x16x32_bf16 v[96:99], v[128:131], v[60:63], v[96:99]
    ds_read_b64_tr_b16 v[114:115], v144 offset:2048
    s_waitcnt lgkmcnt(6)
    v_mfma_f32_16x16x32_bf16 v[84:87], v[132:135], v[56:59], v[84:87]
    v_xor_b32 v145, s89, v145
    ds_read_b64_tr_b16 v[116:117], v145 offset:0
    v_mfma_f32_16x16x32_bf16 v[100:103], v[132:135], v[60:63], v[100:103]
    ds_read_b64_tr_b16 v[118:119], v145 offset:2048
    s_waitcnt lgkmcnt(6)
    v_mfma_f32_16x16x32_bf16 v[88:91], v[136:139], v[56:59], v[88:91]
    v_xor_b32 v146, s89, v146
    ds_read_b64_tr_b16 v[120:121], v146 offset:0
    v_mfma_f32_16x16x32_bf16 v[104:107], v[136:139], v[60:63], v[104:107]
    ds_read_b64_tr_b16 v[122:123], v146 offset:2048
    s_waitcnt lgkmcnt(6)
    v_mfma_f32_16x16x32_bf16 v[92:95], v[140:143], v[56:59], v[92:95]
    v_xor_b32 v147, s89, v147
    ds_read_b64_tr_b16 v[124:125], v147 offset:0
    v_mfma_f32_16x16x32_bf16 v[108:111], v[140:143], v[60:63], v[108:111]
    ds_read_b64_tr_b16 v[126:127], v147 offset:2048
    buffer_load_dwordx4 v[24:27], v157, s[16:19], s91 offen offset:1024 sc1
    buffer_load_dwordx4 v[28:31], v158, s[16:19], s91 offen offset:1024 sc1
    s_waitcnt vmcnt(6) lgkmcnt(6)
    v_max3_u32 v156, v156, v67, v71
    v_mfma_f32_16x16x32_bf16 v[80:83], v[112:115], v[64:67], v[80:83]
    ds_read_b64_tr_b16 v[128:129], v144 offset:4096
    v_mfma_f32_16x16x32_bf16 v[96:99], v[112:115], v[68:71], v[96:99]
    ds_read_b64_tr_b16 v[130:131], v144 offset:6144
    s_waitcnt lgkmcnt(6)
    v_mfma_f32_16x16x32_bf16 v[84:87], v[116:119], v[64:67], v[84:87]
    ds_read_b64_tr_b16 v[132:133], v145 offset:4096
    v_mfma_f32_16x16x32_bf16 v[100:103], v[116:119], v[68:71], v[100:103]
    ds_read_b64_tr_b16 v[134:135], v145 offset:6144
    s_waitcnt lgkmcnt(6)
    v_mfma_f32_16x16x32_bf16 v[88:91], v[120:123], v[64:67], v[88:91]
    ds_read_b64_tr_b16 v[136:137], v146 offset:4096
    v_mfma_f32_16x16x32_bf16 v[104:107], v[120:123], v[68:71], v[104:107]
    ds_read_b64_tr_b16 v[138:139], v146 offset:6144
    s_waitcnt lgkmcnt(6)
    v_mfma_f32_16x16x32_bf16 v[92:95], v[124:127], v[64:67], v[92:95]
    ds_read_b64_tr_b16 v[140:141], v147 offset:4096
    v_mfma_f32_16x16x32_bf16 v[108:111], v[124:127], v[68:71], v[108:111]
    ds_read_b64_tr_b16 v[142:143], v147 offset:6144
    s_cmp_eq_u32 s65, 0
    s_cbranch_scc1 L_b_p5
L_b_r5:
    s_ff1_i32_b32 s91, s65
    s_bitset0_b32 s65, s91
    s_lshl_b32 s77, s91, 12
    s_lshl_b32 s91, s91, 10
    buffer_load_dwordx4 v[32:35], v157, s[16:19], s91 offen offset:0 sc1
    buffer_load_dwordx4 v[36:39], v158, s[16:19], s91 offen offset:0 sc1
    s_waitcnt vmcnt(6) lgkmcnt(6)
    v_max3_u32 v156, v156, v75, v79
    v_mfma_f32_16x16x32_bf16 v[80:83], v[128:131], v[72:75], v[80:83]
    s_xor_b32 s89, s67, s76
    s_mov_b32 s67, s76
    v_xor_b32 v144, s89, v144
    ds_read_b64_tr_b16 v[112:113], v144 offset:0
    v_mfma_f32_16x16x32_bf16 v[96:99], v[128:131], v[76:79], v[96:99]
    ds_read_b64_tr_b16 v[114:115], v144 offset:2048
    s_waitcnt lgkmcnt(6)
    v_mfma_f32_16x16x32_bf16 v[84:87], v[132:135], v[72:75], v[84:87]
    v_xor_b32 v145, s89, v145
    ds_read_b64_tr_b16 v[116:117], v145 offset:0
    v_mfma_f32_16x16x32_bf16 v[100:103], v[132:135], v[76:79], v[100:103]
    ds_read_b64_tr_b16 v[118:119], v145 offset:2048
    s_waitcnt lgkmcnt(6)
    v_mfma_f32_16x16x32_bf16 v[88:91], v[136:139], v[72:75], v[88:91]
    v_xor_b32 v146, s89, v146
    ds_read_b64_tr_b16 v[120:121], v146 offset:0
    v_mfma_f32_16x16x32_bf16 v[104:107], v[136:139], v[76:79], v[104:107]
    ds_read_b64_tr_b16 v[122:123], v146 offset:2048
    s_waitcnt lgkmcnt(6)
    v_mfma_f32_16x16x32_bf16 v[92:95], v[140:143], v[72:75], v[92:95]
    v_xor_b32 v147, s89, v147
    ds_read_b64_tr_b16 v[124:125], v147 offset:0
    v_mfma_f32_16x16x32_bf16 v[108:111], v[140:143], v[76:79], v[108:111]
    ds_read_b64_tr_b16 v[126:127], v147 offset:2048
    buffer_load_dwordx4 v[40:43], v157, s[16:19], s91 offen offset:1024 sc1
    buffer_load_dwordx4 v[44:47], v158, s[16:19], s91 offen offset:1024 sc1
    s_waitcnt vmcnt(6) lgkmcnt(6)
    v_max3_u32 v156, v156, v19, v23
    v_mfma_f32_16x16x32_bf16 v[80:83], v[112:115], v[16:19], v[80:83]
    ds_read_b64_tr_b16 v[128:129], v144 offset:4096
    v_mfma_f32_16x16x32_bf16 v[96:99], v[112:115], v[20:23], v[96:99]
    ds_read_b64_tr_b16 v[130:131], v144 offset:6144
    s_waitcnt lgkmcnt(6)
    v_mfma_f32_16x16x32_bf16 v[84:87], v[116:119], v[16:19], v[84:87]
    ds_read_b64_tr_b16 v[132:133], v145 offset:4096
    v_mfma_f32_16x16x32_bf16 v[100:103], v[116:119], v[20:23], v[100:103]
    ds_read_b64_tr_b16 v[134:135], v145 offset:6144
    s_waitcnt lgkmcnt(6)
    v_mfma_f32_16x16x32_bf16 v[88:91], v[120:123], v[16:19], v[88:91]
    ds_read_b64_tr_b16 v[136:137], v146 offset:4096
    v_mfma_f32_16x16x32_bf16 v[104:107], v[120:123], v[20:23], v[104:107]
    ds_read_b64_tr_b16 v[138:139], v146 offset:6144
    s_waitcnt lgkmcnt(6)
    v_mfma_f32_16x16x32_bf16 v[92:95], v[124:127], v[16:19], v[92:95]
    ds_read_b64_tr_b16 v[140:141], v147 offset:4096
    v_mfma_f32_16x16x32_bf16 v[108:111], v[124:127], v[20:23], v[108:111]
    ds_read_b64_tr_b16 v[142:143], v147 offset:6144
    s_cmp_eq_u32 s65, 0
    s_cbranch_scc1 L_b_p6
L_b_r6:
    s_ff1_i32_b32 s91, s65
    s_bitset0_b32 s65, s91
    s_lshl_b32 s78, s91, 12
    s_lshl_b32 s91, s91, 10
    buffer_load_dwordx4 v[48:51], v157, s[16:19], s91 offen offset:0 sc1
    buffer_load_dwordx4 v[52:55], v158, s[16:19], s91 offen offset:0 sc1
    s_waitcnt vmcnt(6) lgkmcnt(6)
    v_max3_u32 v156, v156, v27, v31
    v_mfma_f32_16x16x32_bf16 v[80:83], v[128:131], v[24:27], v[80:83]
    s_xor_b32 s89, s67, s77
    s_mov_b32 s67, s77
    v_xor_b32 v144, s89, v144
    ds_read_b64_tr_b16 v[112:113], v144 offset:0
    v_mfma_f32_16x16x32_bf16 v[96:99], v[128:131], v[28:31], v[96:99]
    ds_read_b64_tr_b16 v[114:115], v144 offset:2048
    s_waitcnt lgkmcnt(6)
    v_mfma_f32_16x16x32_bf16 v[84:87], v[132:135], v[24:27], v[84:87]
    v_xor_b32 v145, s89, v145
    ds_read_b64_tr_b16 v[116:117], v145 offset:0
    v_mfma_f32_16x16x32_bf16 v[100:103], v[132:135], v[28:31], v[100:103]
    ds_read_b64_tr_b16 v[118:119], v145 offset:2048
    s_waitcnt lgkmcnt(6)
    v_mfma_f32_16x16x32_bf16 v[88:91], v[136:139], v[24:27], v[88:91]
    v_xor_b32 v146, s89, v146
    ds_read_b64_tr_b16 v[120:121], v146 offset:0
    v_mfma_f32_16x16x32_bf16 v[104:107], v[136:139], v[28:31], v[104:107]
    ds_read_b64_tr_b16 v[122:123], v146 offset:2048
    s_waitcnt lgkmcnt(6)
    v_mfma_f32_16x16x32_bf16 v[92:95], v[140:143], v[24:27], v[92:95]
    v_xor_b32 v147, s89, v147
    ds_read_b64_tr_b16 v[124:125], v147 offset:0
    v_mfma_f32_16x16x32_bf16 v[108:111], v[140:143], v[28:31], v[108:111]
    ds_read_b64_tr_b16 v[126:127], v147 offset:2048
    buffer_load_dwordx4 v[56:59], v157, s[16:19], s91 offen offset:1024 sc1
    buffer_load_dwordx4 v[60:63], v158, s[16:19], s91 offen offset:1024 sc1
    s_waitcnt vmcnt(6) lgkmcnt(6)
    v_max3_u32 v156, v156, v35, v39
    v_mfma_f32_16x16x32_bf16 v[80:83], v[112:115], v[32:35], v[80:83]
    ds_read_b64_tr_b16 v[128:129], v144 offset:4096
    v_mfma_f32_16x16x32_bf16 v[96:99], v[112:115], v[36:39], v[96:99]
    ds_read_b64_tr_b16 v[130:131], v144 offset:6144
    s_waitcnt lgkmcnt(6)
    v_mfma_f32_16x16x32_bf16 v[84:87], v[116:119], v[32:35], v[84:87]
    ds_read_b64_tr_b16 v[132:133], v145 offset:4096
    v_mfma_f32_16x16x32_bf16 v[100:103], v[116:119], v[36:39], v[100:103]
    ds_read_b64_tr_b16 v[134:135], v145 offset:6144
    s_waitcnt lgkmcnt(6)
    v_mfma_f32_16x16x32_bf16 v[88:91], v[120:123], v[32:35], v[88:91]
    ds_read_b64_tr_b16 v[136:137], v146 offset:4096
    v_mfma_f32_16x16x32_bf16 v[104:107], v[120:123], v[36:39], v[104:107]
    ds_read_b64_tr_b16 v[138:139], v146 offset:6144
    s_waitcnt lgkmcnt(6)
    v_mfma_f32_16x16x32_bf16 v[92:95], v[124:127], v[32:35], v[92:95]
    ds_read_b64_tr_b16 v[140:141], v147 offset:4096
    v_mfma_f32_16x16x32_bf16 v[108:111], v[124:127], v[36:39], v[108:111]
    ds_read_b64_tr_b16 v[142:143], v147 offset:6144
    s_cmp_eq_u32 s65, 0
    s_cbranch_scc1 L_b_p7
L_b_r7:
    s_ff1_i32_b32 s91, s65
    s_bitset0_b32 s65, s91
    s_lshl_b32 s79, s91, 12
    s_lshl_b32 s91, s91, 10
    buffer_load_dwordx4 v[64:67], v157, s[16:19], s91 offen offset:0 sc1
    buffer_load_dwordx4 v[68:71], v158, s[16:19], s91 offen offset:0 sc1
    s_waitcnt vmcnt(6) lgkmcnt(6)
    v_max3_u32 v156, v156, v43, v47
    v_mfma_f32_16x16x32_bf16 v[80:83], v[128:131], v[40:43], v[80:83]
    s_xor_b32 s89, s67, s78
    s_mov_b32 s67, s78
    v_xor_b32 v144, s89, v144
    ds_read_b64_tr_b16 v[112:113], v144 offset:0
    v_mfma_f32_16x16x32_bf16 v[96:99], v[128:131], v[44:47], v[96:99]
    ds_read_b64_tr_b16 v[114:115], v144 offset:2048
    s_waitcnt lgkmcnt(6)
    v_mfma_f32_16x16x32_bf16 v[84:87], v[132:135], v[40:43], v[84:87]
    v_xor_b32 v145, s89, v145
    ds_read_b64_tr_b16 v[116:117], v145 offset:0
    v_mfma_f32_16x16x32_bf16 v[100:103], v[132:135], v[44:47], v[100:103]
    ds_read_b64_tr_b16 v[118:119], v145 offset:2048
    s_waitcnt lgkmcnt(6)
    v_mfma_f32_16x16x32_bf16 v[88:91], v[136:139], v[40:43], v[88:91]
    v_xor_b32 v146, s89, v146
    ds_read_b64_tr_b16 v[120:121], v146 offset:0
    v_mfma_f32_16x16x32_bf16 v[104:107], v[136:139], v[44:47], v[104:107]
    ds_read_b64_tr_b16 v[122:123], v146 offset:2048
    s_waitcnt lgkmcnt(6)
    v_mfma_f32_16x16x32_bf16 v[92:95], v[140:143], v[40:43], v[92:95]
    v_xor_b32 v147, s89, v147
    ds_read_b64_tr_b16 v[124:125], v147 offset:0
    v_mfma_f32_16x16x32_bf16 v[108:111], v[140:143], v[44:47], v[108:111]
    ds_read_b64_tr_b16 v[126:127], v147 offset:2048
    buffer_load_dwordx4 v[72:75], v157, s[16:19], s91 offen offset:1024 sc1
    buffer_load_dwordx4 v[76:79], v158, s[16:19], s91 offen offset:1024 sc1
    s_waitcnt vmcnt(6) lgkmcnt(6)
    v_max3_u32 v156, v156, v51, v55
    v_mfma_f32_16x16x32_bf16 v[80:83], v[112:115], v[48:51], v[80:83]
    ds_read_b64_tr_b16 v[128:129], v144 offset:4096
    v_mfma_f32_16x16x32_bf16 v[96:99], v[112:115], v[52:55], v[96:99]
    ds_read_b64_tr_b16 v[130:131], v144 offset:6144
    s_mov_b32 s90, 0
    buffer_load_dwordx4 v[164:167], v11, s[32:35], s90 offen
    s_waitcnt lgkmcnt(6)
    v_mfma_f32_16x16x32_bf16 v[84:87], v[116:119], v[48:51], v[84:87]
    ds_read_b64_tr_b16 v[132:133], v145 offset:4096
    v_mfma_f32_16x16x32_bf16 v[100:103], v[116:119], v[52:55], v[100:103]
    ds_read_b64_tr_b16 v[134:135], v145 offset:6144
    s_mov_b32 s90, 7168
    buffer_load_dwordx4 v[168:171], v11, s[32:35], s90 offen
    s_waitcnt lgkmcnt(6)
    v_mfma_f32_16x16x32_bf16 v[88:91], v[120:123], v[48:51], v[88:91]
    ds_read_b64_tr_b16 v[136:137], v146 offset:4096
    v_mfma_f32_16x16x32_bf16 v[104:107], v[120:123], v[52:55], v[104:107]
    ds_read_b64_tr_b16 v[138:139], v146 offset:6144
    s_mov_b32 s90, 14336
    buffer_load_dwordx4 v[172:175], v11, s[32:35], s90 offen
    s_waitcnt lgkmcnt(6)
    v_mfma_f32_16x16x32_bf16 v[92:95], v[124:127], v[48:51], v[92:95]
    ds_read_b64_tr_b16 v[140:141], v147 offset:4096
    v_mfma_f32_16x16x32_bf16 v[108:111], v[124:127], v[52:55], v[108:111]
    ds_read_b64_tr_b16 v[142:143], v147 offset:6144
    s_mov_b32 s90, 21504
    buffer_load_dwordx4 v[176:179], v11, s[32:35], s90 offen
    s_waitcnt vmcnt(8) lgkmcnt(6)
    v_max3_u32 v156, v156, v59, v63
    v_mfma_f32_16x16x32_bf16 v[80:83], v[128:131], v[56:59], v[80:83]
    s_xor_b32 s89, s67, s79
    s_mov_b32 s67, s79
    v_xor_b32 v144, s89, v144
    ds_read_b64_tr_b16 v[112:113], v144 offset:0
    v_mfma_f32_16x16x32_bf16 v[96:99], v[128:131], v[60:63], v[96:99]
    ds_read_b64_tr_b16 v[114:115], v144 offset:2048
    s_mov_b32 s90, 28672
    buffer_load_dwordx4 v[180:183], v11, s[32:35], s90 offen
    s_waitcnt lgkmcnt(6)
    v_mfma_f32_16x16x32_bf16 v[84:87], v[132:135], v[56:59], v[84:87]
    v_xor_b32 v145, s89, v145
    ds_read_b64_tr_b16 v[116:117], v145 offset:0
    v_mfma_f32_16x16x32_bf16 v[100:103], v[132:135], v[60:63], v[100:103]
    ds_read_b64_tr_b16 v[118:119], v145 offset:2048
    s_mov_b32 s90, 35840
    buffer_load_dwordx4 v[184:187], v11, s[32:35], s90 offen
    s_waitcnt lgkmcnt(6)
    v_mfma_f32_16x16x32_bf16 v[88:91], v[136:139], v[56:59], v[88:91]
    v_xor_b32 v146, s89, v146
    ds_read_b64_tr_b16 v[120:121], v146 offset:0
    v_mfma_f32_16x16x32_bf16 v[104:107], v[136:139], v[60:63], v[104:107]
    ds_read_b64_tr_b16 v[122:123], v146 offset:2048
    s_mov_b32 s90, 43008
    buffer_load_dwordx4 v[188:191], v11, s[32:35], s90 offen
    s_waitcnt lgkmcnt(6)
    v_mfma_f32_16x16x32_bf16 v[92:95], v[140:143], v[56:59], v[92:95]
    v_xor_b32 v147, s89, v147
    ds_read_b64_tr_b16 v[124:125], v147 offset:0
    v_mfma_f32_16x16x32_bf16 v[108:111], v[140:143], v[60:63], v[108:111]
    ds_read_b64_tr_b16 v[126:127], v147 offset:2048
    s_mov_b32 s90, 50176
    buffer_load_dwordx4 v[192:195], v11, s[32:35], s90 offen
    s_waitcnt vmcnt(10) lgkmcnt(6)
    v_max3_u32 v156, v156, v67, v71
    v_mfma_f32_16x16x32_bf16 v[80:83], v[112:115], v[64:67], v[80:83]
    ds_read_b64_tr_b16 v[128:129], v144 offset:4096
    v_mfma_f32_16x16x32_bf16 v[96:99], v[112:115], v[68:71], v[96:99]
    ds_read_b64_tr_b16 v[130:131], v144 offset:6144
    s_mov_b32 s90, 57344
    buffer_load_dwordx4 v[196:199], v11, s[32:35], s90 offen
    s_waitcnt lgkmcnt(6)
    v_mfma_f32_16x16x32_bf16 v[84:87], v[116:119], v[64:67], v[84:87]
    ds_read_b64_tr_b16 v[132:133], v145 offset:4096
    v_mfma_f32_16x16x32_bf16 v[100:103], v[116:119], v[68:71], v[100:103]
    ds_read_b64_tr_b16 v[134:135], v145 offset:6144
    s_mov_b32 s90, 64512
    buffer_load_dwordx4 v[200:203], v11, s[32:35], s90 offen
    s_waitcnt lgkmcnt(6)
    v_mfma_f32_16x16x32_bf16 v[88:91], v[120:123], v[64:67], v[88:91]
    ds_read_b64_tr_b16 v[136:137], v146 offset:4096
    v_mfma_f32_16x16x32_bf16 v[104:107], v[120:123], v[68:71], v[104:107]
    ds_read_b64_tr_b16 v[138:139], v146 offset:6144
    s_mov_b32 s90, 71680
    buffer_load_dwordx4 v[204:207], v11, s[32:35], s90 offen
    s_waitcnt lgkmcnt(6)
    v_mfma_f32_16x16x32_bf16 v[92:95], v[124:127], v[64:67], v[92:95]
    ds_read_b64_tr_b16 v[140:141], v147 offset:4096
    v_mfma_f32_16x16x32_bf16 v[108:111], v[124:127], v[68:71], v[108:111]
    ds_read_b64_tr_b16 v[142:143], v147 offset:6144
    s_mov_b32 s90, 78848
    buffer_load_dwordx4 v[208:211], v11, s[32:35], s90 offen
    s_waitcnt vmcnt(12) lgkmcnt(6)
    v_max3_u32 v156, v156, v75, v79
    v_cmp_eq_u32 vcc, -1, v156
    s_cbranch_vccz L_ok_3
    s_sub_u32 s56, s56, 1
    s_cbranch_scc0 L_b_restart
    s_mov_b32 s56, 0
L_ok_3:
    v_mfma_f32_16x16x32_bf16 v[80:83], v[128:131], v[72:75], v[80:83]
    v_mfma_f32_16x16x32_bf16 v[96:99], v[128:131], v[76:79], v[96:99]
    s_mov_b32 s90, 86016
    buffer_load_dwordx4 v[212:215], v11, s[32:35], s90 offen
    s_waitcnt lgkmcnt(4)
    v_mfma_f32_16x16x32_bf16 v[84:87], v[132:135], v[72:75], v[84:87]
    v_mfma_f32_16x16x32_bf16 v[100:103], v[132:135], v[76:79], v[100:103]
    s_mov_b32 s90, 93184
    buffer_load_dwordx4 v[216:219], v11, s[32:35], s90 offen
    s_waitcnt lgkmcnt(2)
    v_mfma_f32_16x16x32_bf16 v[88:91], v[136:139], v[72:75], v[88:91]
    v_mfma_f32_16x16x32_bf16 v[104:107], v[136:139], v[76:79], v[104:107]
    s_mov_b32 s90, 100352
    buffer_load_dwordx4 v[220:223], v11, s[32:35], s90 offen
    s_waitcnt lgkmcnt(0)
    v_mfma_f32_16x16x32_bf16 v[92:95], v[140:143], v[72:75], v[92:95]
    v_mfma_f32_16x16x32_bf16 v[108:111], v[140:143], v[76:79], v[108:111]
    s_mov_b32 s90, 107520
    buffer_load_dwordx4 v[224:227], v11, s[32:35], s90 offen
    ds_write_b128 v162, v[96:99] offset:0
    ds_write_b128 v162, v[100:103] offset:1024
    ds_write_b128 v162, v[104:107] offset:2048
    s_nop 2
    ds_write_b128 v162, v[108:111] offset:3072
    s_waitcnt lgkmcnt(0)
    s_barrier
    ds_read_b128 v[16:19], v163 offset:0
    ds_read_b128 v[20:23], v163 offset:1024
    ds_read_b128 v[24:27], v163 offset:2048
    ds_read_b128 v[28:31], v163 offset:3072
    s_waitcnt lgkmcnt(3)
    v_pk_add_f32 v[80:81], v[80:81], v[16:17]
    v_pk_add_f32 v[82:83], v[82:83], v[18:19]
    v_cvt_pk_bf16_f32 v32, v80, v81
    v_cvt_pk_bf16_f32 v33, v82, v83
    s_waitcnt lgkmcnt(2)
    v_pk_add_f32 v[84:85], v[84:85], v[20:21]
    v_pk_add_f32 v[86:87], v[86:87], v[22:23]
    v_cvt_pk_bf16_f32 v34, v84, v85
    v_cvt_pk_bf16_f32 v35, v86, v87
    s_waitcnt lgkmcnt(1)
    v_pk_add_f32 v[88:89], v[88:89], v[24:25]
    v_pk_add_f32 v[90:91], v[90:91], v[26:27]
    v_cvt_pk_bf16_f32 v36, v88, v89
    v_cvt_pk_bf16_f32 v37, v90, v91
    s_waitcnt lgkmcnt(0)
    v_pk_add_f32 v[92:93], v[92:93], v[28:29]
    v_pk_add_f32 v[94:95], v[94:95], v[30:31]
    v_cvt_pk_bf16_f32 v38, v92, v93
    v_cvt_pk_bf16_f32 v39, v94, v95
    v_mfma_f32_16x16x32_bf16 v[60:63], v[32:35], v[32:35], 0
    v_mfma_f32_16x16x32_bf16 v[56:59], v[32:35], v[148:151], 0
    v_mfma_f32_16x16x32_bf16 v[60:63], v[36:39], v[36:39], v[60:63]
    v_mfma_f32_16x16x32_bf16 v[56:59], v[36:39], v[152:155], v[56:59]
    v_lshlrev_b32 v40, 16, v32
    v_and_b32 v41, 0xffff0000, v32
    v_lshlrev_b32 v42, 16, v33
    v_and_b32 v43, 0xffff0000, v33
    v_lshlrev_b32 v44, 16, v34
    v_and_b32 v45, 0xffff0000, v34
    s_nop 1
    v_cndmask_b32 v56, v56, v60, s[72:73]
    v_cndmask_b32 v57, v57, v61, s[72:73]
    v_cndmask_b32 v58, v58, v62, s[72:73]
    v_cndmask_b32 v59, v59, v63, s[72:73]
    v_cndmask_b32 v56, v56, v57, s[4:5]
    v_cndmask_b32 v58, v58, v59, s[98:99]
    s_or_b64 vcc, s[6:7], s[98:99]
    v_cndmask_b32 v56, v56, v58, vcc
    v_cndmask_b32 v56, v56, 1.0, s[74:75]
    buffer_atomic_add_f32 v56, v160, s[16:19], 0 offen sc1
    v_mov_b32 v67, 0
    buffer_atomic_or v67, v160, s[16:19], 0 offen sc0 sc1
    v_lshlrev_b32 v46, 16, v35
    v_and_b32 v47, 0xffff0000, v35
    v_lshlrev_b32 v48, 16, v36
    v_and_b32 v49, 0xffff0000, v36
    v_lshlrev_b32 v50, 16, v37
    v_and_b32 v51, 0xffff0000, v37
    v_lshlrev_b32 v52, 16, v38
    v_and_b32 v53, 0xffff0000, v38
    v_lshlrev_b32 v54, 16, v39
    v_and_b32 v55, 0xffff0000, v39
    v_lshrrev_b32 v8, 2, v2
    v_lshlrev_b32 v9, 4, v8
    v_sub_u32 v9, v161, v9
    v_cmp_eq_u32 vcc, 0, v8
    s_nop 1
    v_cndmask_b32 v10, 0, 32, vcc
    v_add_u32 v10, v9, v10
    v_cmp_eq_u32 vcc, 1, v8
    s_nop 1
    v_cndmask_b32 v8, 16, 48, vcc
    v_add_u32 v9, v9, v8
    s_branch L_h3_chk
L_h3:
    v_mov_b32 v67, 0
    buffer_atomic_or v67, v160, s[16:19], 0 offen sc0 sc1
L_h3_chk:
    s_waitcnt vmcnt(0)
    v_cmp_ne_u32 vcc, 0x41800000, v67
    s_nop 0
    s_and_b64 vcc, vcc, s[74:75]
    s_cbranch_vccz L_ok_4
    s_sub_u32 s56, s56, 1
    s_cbranch_scc0 L_h3
    s_mov_b32 s56, 0
L_ok_4:
    ds_bpermute_b32 v64, v10, v67
    ds_bpermute_b32 v66, v161, v67
    ds_bpermute_b32 v65, v9, v67
    s_waitcnt lgkmcnt(0)
    v_mul_f32 v64, 0x3a800000, v64
    v_mul_f32 v66, 0x3a800000, v66
    v_fma_f32 v66, -v64, v64, v66
    v_max_f32 v66, 0, v66
    v_cvt_pk_bf16_f32 v69, v64, v66
    v_lshlrev_b32 v68, 16, v69
    v_and_b32 v69, 0xffff0000, v69
    v_add_f32 v69, 0x3727c5ac, v69
    v_cvt_pk_bf16_f32 v69, v69, v69
    v_lshlrev_b32 v69, 16, v69
    v_sqrt_f32 v69, v69
    s_nop 0
    v_cvt_pk_bf16_f32 v69, v69, v69
    v_lshlrev_b32 v69, 16, v69
    v_rcp_f32 v70, v69
    v_fma_f32 v12, -v68, s57, v65
    v_mul_f32 v12, v12, v70
    v_mul_f32 v72, -v68, v70
    v_ashrrev_i32 v8, 31, v12
    v_or_b32 v8, 0x80000000, v8
    v_xor_b32 v8, v8, v12
    v_and_b32 v8, 0xfffff800, v8
    v_or_b32 v13, v8, v6
    s_lshl_b32 s86, s3, 6
    s_add_u32 s86, s86, 65536
    v_lshl_add_u32 v8, v2, 2, s86
    ds_write_b32 v8, v13
    v_pk_fma_f32 v[16:17], v[40:41], v[70:71], v[72:73] op_sel_hi:[1,0,0]
    v_pk_fma_f32 v[18:19], v[42:43], v[70:71], v[72:73] op_sel_hi:[1,0,0]
    v_pk_fma_f32 v[20:21], v[44:45], v[70:71], v[72:73] op_sel_hi:[1,0,0]
    v_pk_fma_f32 v[22:23], v[46:47], v[70:71], v[72:73] op_sel_hi:[1,0,0]
    v_pk_fma_f32 v[24:25], v[48:49], v[70:71], v[72:73] op_sel_hi:[1,0,0]
    v_pk_fma_f32 v[26:27], v[50:51], v[70:71], v[72:73] op_sel_hi:[1,0,0]
    v_pk_fma_f32 v[28:29], v[52:53], v[70:71], v[72:73] op_sel_hi:[1,0,0]
    v_pk_fma_f32 v[30:31], v[54:55], v[70:71], v[72:73] op_sel_hi:[1,0,0]
    v_lshlrev_b32 v8, 3, v0
    v_add_u32 v8, 65536, v8
    s_waitcnt lgkmcnt(0)
    s_barrier
    ds_read_b64 v[64:65], v8
    v_cvt_pk_bf16_f32 v96, v16, v17
    v_cvt_pk_bf16_f32 v97, v18, v19
    v_cvt_pk_bf16_f32 v98, v20, v21
    v_cvt_pk_bf16_f32 v99, v22, v23
    v_cvt_pk_bf16_f32 v100, v24, v25
    v_cvt_pk_bf16_f32 v101, v26, v27
    v_cvt_pk_bf16_f32 v102, v28, v29
    v_cvt_pk_bf16_f32 v103, v30, v31
    s_waitcnt lgkmcnt(0)
    v_max_u32 v66, v64, v65
    v_min_u32 v67, v64, v65
    s_nop 0
    v_mov_b32_dpp v64, v66 row_ror:8 row_mask:0xf bank_mask:0xf
    v_max_u32_dpp v65, v67, v67 row_ror:8 row_mask:0xf bank_mask:0xf
    v_med3_u32 v67, v66, v64, v65
    v_max_u32 v66, v66, v64
    s_nop 1
    v_mov_b32_dpp v64, v66 row_ror:4 row_mask:0xf bank_mask:0xf
    v_max_u32_dpp v65, v67, v67 row_ror:4 row_mask:0xf bank_mask:0xf
    v_med3_u32 v67, v66, v64, v65
    v_max_u32 v66, v66, v64
    s_nop 1
    v_mov_b32_dpp v64, v66 row_ror:2 row_mask:0xf bank_mask:0xf
    v_max_u32_dpp v65, v67, v67 row_ror:2 row_mask:0xf bank_mask:0xf
    v_med3_u32 v67, v66, v64, v65
    v_max_u32 v66, v66, v64
    s_nop 1
    v_mov_b32_dpp v64, v66 row_ror:1 row_mask:0xf bank_mask:0xf
    v_max_u32_dpp v65, v67, v67 row_ror:1 row_mask:0xf bank_mask:0xf
    v_med3_u32 v67, v66, v64, v65
    v_max_u32 v66, v66, v64
    s_nop 0
    v_readlane_b32 s58, v66, 0
    v_readlane_b32 s59, v67, 0
    v_readlane_b32 s86, v66, 16
    v_readlane_b32 s87, v67, 16
    s_nop 0
    s_max_u32 s59, s59, s87
    s_min_u32 s87, s58, s86
    s_max_u32 s58, s58, s86
    s_max_u32 s59, s59, s87
    v_readlane_b32 s86, v66, 32
    v_readlane_b32 s87, v67, 32
    s_nop 0
    s_max_u32 s59, s59, s87
    s_min_u32 s87, s58, s86
    s_max_u32 s58, s58, s86
    s_max_u32 s59, s59, s87
    v_readlane_b32 s86, v66, 48
    v_readlane_b32 s87, v67, 48
    s_nop 0
    s_max_u32 s59, s59, s87
    s_min_u32 s87, s58, s86
    s_max_u32 s58, s58, s86
    s_max_u32 s59, s59, s87
    v_cmp_eq_u32 s[4:5], s58, v13
    v_cmp_eq_u32 s[6:7], s59, v13
    s_nop 0
    s_or_b64 s[96:97], s[4:5], s[6:7]
    s_cbranch_scc0 L_nocand
    s_lshl_b32 s86, s51, 12
    s_lshl_b32 s87, s52, 7
    s_add_u32 s86, s86, s87
    s_add_u32 s86, s86, 6782976
    v_lshl_add_u32 v8, v1, 3, s86
    v_add_u32 v9, 2048, v8
    v_cndmask_b32 v8, v8, v9, s[6:7]
    v_mov_b32 v9, 2147483648
    v_cndmask_b32 v8, v9, v8, s[96:97]
    buffer_store_dwordx2 v[96:97], v8, s[16:19], 0 offen offset:0 sc1
    buffer_store_dwordx2 v[98:99], v8, s[16:19], 0 offen offset:32 sc1
    buffer_store_dwordx2 v[100:101], v8, s[16:19], 0 offen offset:64 sc1
    buffer_store_dwordx2 v[102:103], v8, s[16:19], 0 offen offset:96 sc1
L_nocand:
    s_cmp_lg_u32 s3, 0
    s_cbranch_scc1 L_nokey
    s_lshl_b32 s86, s52, 10
    s_lshl_b32 s87, s51, 3
    s_add_u32 s86, s86, s87
    s_add_u32 s86, s86, 6848512
    v_lshl_add_u32 v8, v0, 7, s86
    v_mov_b32 v9, 2147483648
    v_cmp_gt_u32 vcc, 8, v0
    s_nop 1
    v_cndmask_b32 v8, v9, v8, vcc
    v_mov_b32 v10, s58
    v_mov_b32 v11, s59
    buffer_atomic_swap_x2 v[10:11], v8, s[16:19], 0 offen sc1
L_nokey:
    s_bfe_u32 s89, s2, 0x20001
    s_lshl_b32 s89, s89, 2
    s_add_u32 s89, s89, s48
    s_lshl_b32 s86, s89, 3
    s_and_b32 s87, s45, 7
    s_add_u32 s86, s86, s87
    s_lshl_b32 s86, s86, 7
    s_add_u32 s86, s86, 6848512
    v_lshl_add_u32 v129, v0, 2, s86
    v_mov_b32 v8, 2147483648
    v_cmp_gt_u32 vcc, 32, v0
    s_nop 1
    v_cndmask_b32 v129, v8, v129, vcc
    s_cmp_lg_u64 s[96:97], 0
    s_cselect_b32 s63, 1, s62
    s_cmp_eq_u32 s63, 0
    s_cbranch_scc1 L_h4_skip1
    v_mov_b32 v128, 0
    buffer_atomic_or v128, v129, s[16:19], 0 offen sc0 sc1
L_h4_skip1:
    v_lshlrev_b32 v16, 16, v96
    v_and_b32 v17, 0xffff0000, v96
    v_lshlrev_b32 v18, 16, v97
    v_and_b32 v19, 0xffff0000, v97
    v_lshlrev_b32 v20, 16, v98
    v_and_b32 v21, 0xffff0000, v98
    v_lshlrev_b32 v22, 16, v99
    v_and_b32 v23, 0xffff0000, v99
    v_lshlrev_b32 v24, 16, v100
    v_and_b32 v25, 0xffff0000, v100
    v_lshlrev_b32 v26, 16, v101
    v_and_b32 v27, 0xffff0000, v101
    v_lshlrev_b32 v28, 16, v102
    v_and_b32 v29, 0xffff0000, v102
    v_lshlrev_b32 v30, 16, v103
    v_and_b32 v31, 0xffff0000, v103
    v_pk_add_f32 v[16:17], v[16:17], v[40:41]
    v_pk_add_f32 v[18:19], v[18:19], v[42:43]
    v_pk_add_f32 v[20:21], v[20:21], v[44:45]
    v_pk_add_f32 v[22:23], v[22:23], v[46:47]
    v_pk_add_f32 v[24:25], v[24:25], v[48:49]
    v_pk_add_f32 v[26:27], v[26:27], v[50:51]
    v_pk_add_f32 v[28:29], v[28:29], v[52:53]
    v_pk_add_f32 v[30:31], v[30:31], v[54:55]
    v_cvt_pk_bf16_f32 v104, v16, v17
    v_cvt_pk_bf16_f32 v105, v18, v19
    v_cvt_pk_bf16_f32 v106, v20, v21
    v_cvt_pk_bf16_f32 v107, v22, v23
    v_cvt_pk_bf16_f32 v108, v24, v25
    v_cvt_pk_bf16_f32 v109, v26, v27
    v_cvt_pk_bf16_f32 v110, v28, v29
    v_cvt_pk_bf16_f32 v111, v30, v31
    v_permlane16_swap_b32 v104, v106
    v_permlane16_swap_b32 v105, v107
    v_permlane16_swap_b32 v108, v110
    v_permlane16_swap_b32 v109, v111
    v_mov_b32 v9, 2147483648
    v_cndmask_b32 v8, v5, v9, s[96:97]
    buffer_store_dwordx4 v[104:107], v8, s[24:27], 0 offen sc1
    buffer_store_dwordx4 v[108:111], v8, s[24:27], 0 offen offset:64 sc1
    s_cmp_eq_u32 s63, 0
    s_cbranch_scc1 L_fin
    s_cmp_eq_u64 s[96:97], 0
    s_cbranch_scc1 L_nostash
    v_lshlrev_b32 v8, 3, v1
    v_add_u32 v8, 98304, v8
    v_add_u32 v9, 512, v8
    v_cndmask_b32 v8, v8, v9, s[6:7]
    v_cvt_pk_bf16_f32 v9, v12, v12
    v_lshlrev_b32 v9, 16, v9
    s_mov_b64 exec, s[96:97]
    ds_write_b64 v8, v[32:33] offset:0
    ds_write_b64 v8, v[96:97] offset:128
    ds_write_b64 v8, v[34:35] offset:32
    ds_write_b64 v8, v[98:99] offset:160
    ds_write_b64 v8, v[36:37] offset:64
    ds_write_b64 v8, v[100:101] offset:192
    ds_write_b64 v8, v[38:39] offset:96
    ds_write_b64 v8, v[102:103] offset:224
    ds_write_b32 v8, v9 offset:256
    s_mov_b64 exec, -1
L_nostash:
    s_waitcnt vmcnt(2)
    s_branch L_h4_chk
L_h4:
    v_mov_b32 v128, 0
    buffer_atomic_or v128, v129, s[16:19], 0 offen sc0 sc1
    s_waitcnt vmcnt(0)
L_h4_chk:
    v_cmp_eq_u32 vcc, -1, v128
    s_cbranch_vccz L_ok_5
    s_sub_u32 s56, s56, 1
    s_cbranch_scc0 L_h4
    s_mov_b32 s56, 0
L_ok_5:
    v_mov_b32 v64, v128
    v_mov_b32 v65, 0
    s_nop 0
    v_mov_b32_dpp v66, v64 row_ror:8 row_mask:0xf bank_mask:0xf
    v_max_u32_dpp v67, v65, v65 row_ror:8 row_mask:0xf bank_mask:0xf
    v_med3_u32 v65, v64, v66, v67
    v_max_u32 v64, v64, v66
    s_nop 1
    v_mov_b32_dpp v66, v64 row_ror:4 row_mask:0xf bank_mask:0xf
    v_max_u32_dpp v67, v65, v65 row_ror:4 row_mask:0xf bank_mask:0xf
    v_med3_u32 v65, v64, v66, v67
    v_max_u32 v64, v64, v66
    s_nop 1
    v_mov_b32_dpp v66, v64 row_ror:2 row_mask:0xf bank_mask:0xf
    v_max_u32_dpp v67, v65, v65 row_ror:2 row_mask:0xf bank_mask:0xf
    v_med3_u32 v65, v64, v66, v67
    v_max_u32 v64, v64, v66
    s_nop 1
    v_mov_b32_dpp v66, v64 row_ror:1 row_mask:0xf bank_mask:0xf
    v_max_u32_dpp v67, v65, v65 row_ror:1 row_mask:0xf bank_mask:0xf
    v_med3_u32 v65, v64, v66, v67
    v_max_u32 v64, v64, v66
    s_nop 0
    v_readlane_b32 s60, v64, 0
    v_readlane_b32 s61, v65, 0
    v_readlane_b32 s86, v64, 16
    v_readlane_b32 s87, v65, 16
    s_nop 0
    s_max_u32 s61, s61, s87
    s_min_u32 s87, s60, s86
    s_max_u32 s60, s60, s86
    s_max_u32 s61, s61, s87
    s_cmp_lg_u32 s62, 0
    s_cbranch_scc1 L_moe
    s_barrier
    s_barrier
    s_branch L_final
L_moe:
    v_cmp_eq_u32 vcc, s60, v128
    s_nop 0
    s_ff1_i32_b32 s86, vcc_lo
    v_cmp_eq_u32 vcc, s61, v128
    s_nop 0
    s_ff1_i32_b32 s87, vcc_lo
    s_and_b32 s86, s86, 31
    s_and_b32 s87, s87, 31
    v_bfe_u32 v8, v0, 3, 1
    v_cmp_eq_u32 vcc, 1, v8
    v_mov_b32 v9, s86
    v_mov_b32 v10, s87
    v_cndmask_b32 v9, v9, v10, vcc
    s_lshl_b32 s89, s89, 7
    s_add_u32 s89, s89, 6782976
    v_lshl_add_u32 v10, v1, 5, s89
    v_lshl_add_u32 v130, v9, 11, v10
    buffer_load_dwordx4 v[64:67], v130, s[16:19], 0 offen sc1
    buffer_load_dwordx4 v[68:71], v130, s[16:19], 0 offen offset:16 sc1
    s_mov_b32 s90, 0
    buffer_load_dwordx4 v[228:231], v14, s[36:39], s90 offen
    s_mov_b32 s90, 2048
    buffer_load_dwordx4 v[232:235], v14, s[36:39], s90 offen
    s_mov_b32 s90, 4096
    buffer_load_dwordx4 v[236:239], v14, s[36:39], s90 offen
    s_mov_b32 s90, 6144
    buffer_load_dwordx4 v[240:243], v14, s[36:39], s90 offen
    s_mov_b32 s90, 8192
    buffer_load_dwordx4 v[244:247], v14, s[36:39], s90 offen
    s_mov_b32 s90, 10240
    buffer_load_dwordx4 v[248:251], v14, s[36:39], s90 offen
    s_mov_b32 s90, 12288
    buffer_load_dwordx4 v[252:255], v14, s[36:39], s90 offen
    v_and_b32 v10, 1, v0
    v_cmp_eq_u32 vcc, 1, v10
    v_mov_b32 v10, 0x0c0c0100
    v_mov_b32 v11, 0x01000c0c
    v_cndmask_b32 v16, v10, v11, vcc
    v_mov_b32 v10, 0x0c0c0302
    v_mov_b32 v11, 0x03020c0c
    v_cndmask_b32 v17, v10, v11, vcc
    v_bfe_u32 v10, v0, 1, 2
    v_mov_b32 v11, 0x0c0c0c0c
    v_cmp_eq_u32 vcc, 0, v10
    s_nop 1
    v_cndmask_b32 v72, v11, v16, vcc
    v_cndmask_b32 v76, v11, v17, vcc
    v_cmp_eq_u32 vcc, 1, v10
    s_nop 1
    v_cndmask_b32 v73, v11, v16, vcc
    v_cndmask_b32 v77, v11, v17, vcc
    v_cmp_eq_u32 vcc, 2, v10
    s_nop 1
    v_cndmask_b32 v74, v11, v16, vcc
    v_cndmask_b32 v78, v11, v17, vcc
    v_cmp_eq_u32 vcc, 3, v10
    s_nop 1
    v_cndmask_b32 v75, v11, v16, vcc
    v_cndmask_b32 v79, v11, v17, vcc
    s_lshl_b32 s86, s48, 10
    s_add_u32 s86, s86, 90112
    v_lshl_add_u32 v18, v0, 4, s86
    s_and_b32 s86, s2, 1
    s_lshl_b32 s86, s86, 2
    s_bfe_u32 s87, s2, 0x20001
    s_add_u32 s86, s86, s87
    s_mul_i32 s86, s86, 28672
    s_lshl_b32 s87, s45, 9
    s_add_u32 s86, s86, s87
    s_add_u32 s86, s86, 6553600
    s_cmp_ge_u32 s2, 224
    s_cselect_b32 s86, 2147483648, s86
    v_lshl_add_u32 v19, v2, 5, s86
    v_and_b32 v10, 1, v1
    v_lshl_add_u32 v19, v10, 4, v19
    v_lshrrev_b32 v11, 1, v1
    v_mul_u32_u24 v16, 14336, v11
    v_add_u32 v19, v19, v16
    v_mov_b32 v131, s68
    s_and_b32 s86, s2, 1
    s_lshl_b32 s86, s86, 2
    s_bfe_u32 s87, s2, 0x20001
    s_add_u32 s86, s86, s87
    s_lshl_b32 s87, s45, 7
    s_add_u32 s86, s86, s87
    s_lshl2_add_u32 s86, s86, 704512
    s_cmp_ge_u32 s2, 224
    s_cselect_b32 s86, 2147483648, s86
    v_lshl_add_u32 v132, v0, 7, s86
    v_mov_b32 v133, 2147483648
    v_cmp_gt_u32 vcc, 4, v0
    s_nop 1
    v_cndmask_b32 v132, v133, v132, vcc
    s_lshl_b32 s86, s44, 5
    s_add_u32 s86, s86, s45
    s_lshl2_add_u32 s86, s86, 720896
    v_writelane_b32 v133, s86, 0
    s_mul_i32 s86, s45, 112
    s_mul_i32 s87, s48, 28
    s_add_u32 s86, s86, s87
    v_mul_u32_u24 v16, 27, v8
    v_add_u32 v16, s86, v16
    v_lshrrev_b32 v16, 7, v16
    s_lshl_b32 s87, s48, 7
    s_add_u32 s87, s87, 704512
    v_lshl_add_u32 v134, v16, 9, s87
    v_and_b32 v16, 7, v0
    v_lshl_add_u32 v134, v16, 2, v134
    v_mov_b32 v16, 2147483648
    v_cmp_gt_u32 vcc, 16, v0
    s_nop 1
    v_cndmask_b32 v134, v16, v134, vcc
    s_waitcnt vmcnt(7)
    s_branch L_seg_chk
L_seg:
    buffer_load_dwordx4 v[64:67], v130, s[16:19], 0 offen sc1
    buffer_load_dwordx4 v[68:71], v130, s[16:19], 0 offen offset:16 sc1
    s_waitcnt vmcnt(0)
L_seg_chk:
    v_max3_u32 v16, v65, v67, v69
    v_max_u32 v16, v16, v71
    v_cmp_eq_u32 vcc, -1, v16
    s_cbranch_vccz L_ok_6
    s_sub_u32 s56, s56, 1
    s_cbranch_scc0 L_seg
    s_mov_b32 s56, 0
L_ok_6:
    v_perm_b32 v80, v64, v64, v72
    v_perm_b32 v81, v64, v64, v73
    v_perm_b32 v82, v64, v64, v74
    v_perm_b32 v83, v64, v64, v75
    s_nop 1
    v_mfma_f32_16x16x32_bf16 v[88:91], v[80:83], v[164:167], 0
    v_perm_b32 v84, v64, v64, v76
    v_perm_b32 v85, v64, v64, v77
    v_perm_b32 v86, v64, v64, v78
    v_perm_b32 v87, v64, v64, v79
    s_nop 1
    v_mfma_f32_16x16x32_bf16 v[88:91], v[84:87], v[168:171], v[88:91]
    v_perm_b32 v80, v65, v65, v72
    v_perm_b32 v81, v65, v65, v73
    v_perm_b32 v82, v65, v65, v74
    v_perm_b32 v83, v65, v65, v75
    s_nop 1
    v_mfma_f32_16x16x32_bf16 v[88:91], v[80:83], v[172:175], v[88:91]
    v_perm_b32 v84, v65, v65, v76
    v_perm_b32 v85, v65, v65, v77
    v_perm_b32 v86, v65, v65, v78
    v_perm_b32 v87, v65, v65, v79
    s_nop 1
    v_mfma_f32_16x16x32_bf16 v[88:91], v[84:87], v[176:179], v[88:91]
    v_perm_b32 v80, v66, v66, v72
    v_perm_b32 v81, v66, v66, v73
    v_perm_b32 v82, v66, v66, v74
    v_perm_b32 v83, v66, v66, v75
    s_nop 1
    v_mfma_f32_16x16x32_bf16 v[88:91], v[80:83], v[180:183], v[88:91]
    v_perm_b32 v84, v66, v66, v76
    v_perm_b32 v85, v66, v66, v77
    v_perm_b32 v86, v66, v66, v78
    v_perm_b32 v87, v66, v66, v79
    s_nop 1
    v_mfma_f32_16x16x32_bf16 v[88:91], v[84:87], v[184:187], v[88:91]
    v_perm_b32 v80, v67, v67, v72
    v_perm_b32 v81, v67, v67, v73
    v_perm_b32 v82, v67, v67, v74
    v_perm_b32 v83, v67, v67, v75
    s_nop 1
    v_mfma_f32_16x16x32_bf16 v[88:91], v[80:83], v[188:191], v[88:91]
    v_perm_b32 v84, v67, v67, v76
    v_perm_b32 v85, v67, v67, v77
    v_perm_b32 v86, v67, v67, v78
    v_perm_b32 v87, v67, v67, v79
    s_nop 1
    v_mfma_f32_16x16x32_bf16 v[88:91], v[84:87], v[192:195], v[88:91]
    v_perm_b32 v80, v68, v68, v72
    v_perm_b32 v81, v68, v68, v73
    v_perm_b32 v82, v68, v68, v74
    v_perm_b32 v83, v68, v68, v75
    s_nop 1
    v_mfma_f32_16x16x32_bf16 v[88:91], v[80:83], v[196:199], v[88:91]
    v_perm_b32 v84, v68, v68, v76
    v_perm_b32 v85, v68, v68, v77
    v_perm_b32 v86, v68, v68, v78
    v_perm_b32 v87, v68, v68, v79
    s_nop 1
    v_mfma_f32_16x16x32_bf16 v[88:91], v[84:87], v[200:203], v[88:91]
    v_perm_b32 v80, v69, v69, v72
    v_perm_b32 v81, v69, v69, v73
    v_perm_b32 v82, v69, v69, v74
    v_perm_b32 v83, v69, v69, v75
    s_nop 1
    v_mfma_f32_16x16x32_bf16 v[88:91], v[80:83], v[204:207], v[88:91]
    v_perm_b32 v84, v69, v69, v76
    v_perm_b32 v85, v69, v69, v77
    v_perm_b32 v86, v69, v69, v78
    v_perm_b32 v87, v69, v69, v79
    s_nop 1
    v_mfma_f32_16x16x32_bf16 v[88:91], v[84:87], v[208:211], v[88:91]
    v_perm_b32 v80, v70, v70, v72
    v_perm_b32 v81, v70, v70, v73
    v_perm_b32 v82, v70, v70, v74
    v_perm_b32 v83, v70, v70, v75
    s_nop 1
    v_mfma_f32_16x16x32_bf16 v[88:91], v[80:83], v[212:215], v[88:91]
    v_perm_b32 v84, v70, v70, v76
    v_perm_b32 v85, v70, v70, v77
    v_perm_b32 v86, v70, v70, v78
    v_perm_b32 v87, v70, v70, v79
    s_nop 1
    v_mfma_f32_16x16x32_bf16 v[88:91], v[84:87], v[216:219], v[88:91]
    v_perm_b32 v80, v71, v71, v72
    v_perm_b32 v81, v71, v71, v73
    v_perm_b32 v82, v71, v71, v74
    v_perm_b32 v83, v71, v71, v75
    s_nop 1
    v_mfma_f32_16x16x32_bf16 v[88:91], v[80:83], v[220:223], v[88:91]
    v_perm_b32 v84, v71, v71, v76
    v_perm_b32 v85, v71, v71, v77
    v_perm_b32 v86, v71, v71, v78
    v_perm_b32 v87, v71, v71, v79
    s_nop 1
    v_mfma_f32_16x16x32_bf16 v[88:91], v[84:87], v[224:227], v[88:91]
    s_nop 7
    ds_write_b128 v18, v[88:91] offset:0
    s_waitcnt lgkmcnt(0)
    s_barrier
    s_cmp_lg_u32 s48, 0
    s_cbranch_scc1 L_gu_done
    ds_read_b128 v[20:23], v18 offset:1024
    ds_read_b128 v[24:27], v18 offset:2048
    ds_read_b128 v[28:31], v18 offset:3072
    s_waitcnt lgkmcnt(0)
    v_pk_add_f32 v[88:89], v[88:89], v[20:21]
    v_pk_add_f32 v[24:25], v[24:25], v[28:29]
    v_pk_add_f32 v[88:89], v[88:89], v[24:25]
    v_pk_add_f32 v[90:91], v[90:91], v[22:23]
    v_pk_add_f32 v[26:27], v[26:27], v[30:31]
    v_pk_add_f32 v[90:91], v[90:91], v[26:27]
    buffer_store_dwordx4 v[88:91], v19, s[16:19], 0 offen sc1
    buffer_atomic_swap v131, v132, s[16:19], 0 offen sc1
L_gu_done:
    v_mov_b32 v135, 0
    buffer_atomic_or v135, v134, s[16:19], 0 offen sc0 sc1
    s_mul_i32 s86, s45, 112
    s_mul_i32 s87, s48, 28
    s_add_u32 s86, s86, s87
    v_bfe_u32 v16, v0, 3, 2
    v_mul_u32_u24 v16, 7, v16
    v_and_b32 v17, 7, v0
    v_min_u32 v17, 6, v17
    v_add3_u32 v16, v16, v17, s86
    v_lshrrev_b32 v17, 5, v0
    v_mul_u32_u24 v17, 14336, v17
    v_lshl_add_u32 v16, v16, 2, v17
    v_add_u32 v16, 6553600, v16
    s_lshl_b32 s86, s45, 13
    s_lshl_b32 s87, s44, 9
    s_add_u32 s86, s86, s87
    s_add_u32 s86, s86, 6291456
    v_lshl_add_u32 v9, v2, 5, s86
    v_lshl_add_u32 v9, v10, 4, v9
    v_lshl_add_u32 v9, v11, 12, v9
    s_lshl_b32 s86, s48, 7
    s_add_u32 s86, s86, 100352
    v_lshl_add_u32 v10, v0, 1, s86
    v_lshl_add_u32 v11, v8, 6, s86
    v_lshl_add_u32 v11, v1, 4, v11
    s_branch L_h5f_chk
L_h5f:
    v_mov_b32 v135, 0
    buffer_atomic_or v135, v134, s[16:19], 0 offen sc0 sc1
L_h5f_chk:
    s_waitcnt vmcnt(0)
    v_cmp_ne_u32 vcc, s68, v135
    s_nop 0
    s_and_b64 vcc, vcc, 0xffff
    s_cbranch_vccz L_ok_7
    s_sub_u32 s56, s56, 1
    s_cbranch_scc0 L_h5f
    s_mov_b32 s56, 0
L_ok_7:
L_h5:
    s_mov_b32 s90, 0
    buffer_load_dword v24, v16, s[16:19], s90 offen sc1
    s_mov_b32 s90, 28672
    buffer_load_dword v25, v16, s[16:19], s90 offen sc1
    s_mov_b32 s90, 57344
    buffer_load_dword v26, v16, s[16:19], s90 offen sc1
    s_mov_b32 s90, 86016
    buffer_load_dword v27, v16, s[16:19], s90 offen sc1
    s_mov_b32 s90, 114688
    buffer_load_dword v28, v16, s[16:19], s90 offen sc1
    s_mov_b32 s90, 143360
    buffer_load_dword v29, v16, s[16:19], s90 offen sc1
    s_mov_b32 s90, 172032
    buffer_load_dword v30, v16, s[16:19], s90 offen sc1
    s_mov_b32 s90, 200704
    buffer_load_dword v31, v16, s[16:19], s90 offen sc1
    s_waitcnt vmcnt(0)
    v_max3_u32 v17, v24, v25, v26
    v_max3_u32 v17, v17, v27, v28
    v_max3_u32 v17, v17, v29, v30
    v_max_u32 v17, v17, v31
    v_cmp_eq_u32 vcc, -1, v17
    s_cbranch_vccz L_ok_8
    s_sub_u32 s56, s56, 1
    s_cbranch_scc0 L_h5
    s_mov_b32 s56, 0
L_ok_8:
    v_mov_b32 v19, v9
    v_add_f32 v24, v24, v25
    v_add_f32 v26, v26, v27
    v_add_f32 v28, v28, v29
    v_add_f32 v30, v30, v31
    v_add_f32 v24, v24, v26
    v_add_f32 v28, v28, v30
    v_cvt_pk_bf16_f32 v25, v24, v28
    v_lshlrev_b32 v24, 16, v25
    v_and_b32 v28, 0xffff0000, v25
    v_mul_f32 v25, 0xbfb8aa3b, v24
    v_exp_f32 v25, v25
    s_nop 0
    v_add_f32 v25, 1.0, v25
    v_rcp_f32 v25, v25
    s_nop 0
    v_mul_f32 v24, v24, v25
    v_cvt_pk_bf16_f32 v24, v24, v24
    v_lshlrev_b32 v24, 16, v24
    v_mul_f32 v24, v24, v28
    v_cvt_pk_bf16_f32 v24, v24, v24
    ds_write_b16 v10, v24
    s_waitcnt lgkmcnt(0)
    ds_read_b128 v[64:67], v11
    s_waitcnt lgkmcnt(0)
    v_perm_b32 v80, v64, v64, v72
    v_perm_b32 v81, v64, v64, v73
    v_perm_b32 v82, v64, v64, v74
    v_perm_b32 v83, v64, v64, v75
    s_nop 1
    v_mfma_f32_16x16x32_bf16 v[88:91], v[80:83], v[228:231], 0
    v_perm_b32 v84, v64, v64, v76
    v_perm_b32 v85, v64, v64, v77
    v_perm_b32 v86, v64, v64, v78
    v_perm_b32 v87, v64, v64, v79
    s_nop 1
    v_mfma_f32_16x16x32_bf16 v[88:91], v[84:87], v[232:235], v[88:91]
    v_perm_b32 v80, v65, v65, v72
    v_perm_b32 v81, v65, v65, v73
    v_perm_b32 v82, v65, v65, v74
    v_perm_b32 v83, v65, v65, v75
    s_nop 1
    v_mfma_f32_16x16x32_bf16 v[88:91], v[80:83], v[236:239], v[88:91]
    v_perm_b32 v84, v65, v65, v76
    v_perm_b32 v85, v65, v65, v77
    v_perm_b32 v86, v65, v65, v78
    v_perm_b32 v87, v65, v65, v79
    s_nop 1
    v_mfma_f32_16x16x32_bf16 v[88:91], v[84:87], v[240:243], v[88:91]
    v_perm_b32 v80, v66, v66, v72
    v_perm_b32 v81, v66, v66, v73
    v_perm_b32 v82, v66, v66, v74
    v_perm_b32 v83, v66, v66, v75
    s_nop 1
    v_mfma_f32_16x16x32_bf16 v[88:91], v[80:83], v[244:247], v[88:91]
    v_perm_b32 v84, v66, v66, v76
    v_perm_b32 v85, v66, v66, v77
    v_perm_b32 v86, v66, v66, v78
    v_perm_b32 v87, v66, v66, v79
    s_nop 1
    v_mfma_f32_16x16x32_bf16 v[88:91], v[84:87], v[248:251], v[88:91]
    v_perm_b32 v80, v67, v67, v72
    v_perm_b32 v81, v67, v67, v73
    v_perm_b32 v82, v67, v67, v74
    v_perm_b32 v83, v67, v67, v75
    s_nop 1
    v_mfma_f32_16x16x32_bf16 v[88:91], v[80:83], v[252:255], v[88:91]
    s_nop 7
    ds_write_b128 v18, v[88:91] offset:4096
    s_waitcnt lgkmcnt(0)
    s_barrier
    s_cmp_lg_u32 s48, 0
    s_cbranch_scc1 L_dn_done
    ds_read_b128 v[20:23], v18 offset:5120
    ds_read_b128 v[24:27], v18 offset:6144
    ds_read_b128 v[28:31], v18 offset:7168
    s_waitcnt lgkmcnt(0)
    v_pk_add_f32 v[88:89], v[88:89], v[20:21]
    v_pk_add_f32 v[24:25], v[24:25], v[28:29]
    v_pk_add_f32 v[88:89], v[88:89], v[24:25]
    v_pk_add_f32 v[90:91], v[90:91], v[22:23]
    v_pk_add_f32 v[26:27], v[26:27], v[30:31]
    v_pk_add_f32 v[90:91], v[90:91], v[26:27]
    buffer_store_dwordx4 v[88:91], v19, s[16:19], 0 offen sc1
    buffer_atomic_swap v131, v133, s[16:19], 0 offen sc1
L_dn_done:
L_final:
    s_cmp_eq_u64 s[96:97], 0
    s_cbranch_scc1 L_fin
    v_cmp_ne_u32 s[4:5], s60, v13
    v_cmp_ne_u32 s[6:7], s61, v13
    s_nop 0
    s_and_b64 s[4:5], s[4:5], s[6:7]
    s_and_b64 s[4:5], s[4:5], s[96:97]
    s_cbranch_scc0 L_nolost
    v_mov_b32 v9, 2147483648
    v_cndmask_b32 v8, v9, v5, s[4:5]
    buffer_store_dwordx4 v[104:107], v8, s[24:27], 0 offen sc1
    buffer_store_dwordx4 v[108:111], v8, s[24:27], 0 offen offset:64 sc1
L_nolost:
    s_mov_b32 s63, 0
L_fin_loop:
    v_cmp_eq_u32 vcc, s60, v13
    s_cbranch_vccz L_fin_next
    s_cmp_eq_u32 s60, s58
    s_cselect_b32 s86, 0, 512
    s_add_u32 s86, s86, 98304
    v_lshl_add_u32 v8, v2, 3, s86
    v_mov_b32 v9, s86
    ds_read_b64 v[56:57], v8
    ds_read_b64 v[58:59], v8 offset:128
    ds_read_b32 v60, v9 offset:256
    s_lshl_b32 s86, s63, 12
    s_lshl_b32 s87, s52, 8
    s_add_u32 s86, s86, s87
    s_add_u32 s86, s86, 6291456
    v_lshl_add_u32 v10, v2, 4, s86
    v_lshl_add_u32 v10, v1, 13, v10
    s_and_b32 s86, s60, 0x7ff
    s_sub_u32 s86, 2047, s86
    s_lshl_b32 s86, s86, 11
    s_lshl_b32 s87, s52, 7
    s_add_u32 s86, s86, s87
    v_lshl_add_u32 v11, v2, 3, s86
    v_cmp_eq_u32 vcc, 0, v1
    v_mov_b32 v9, 2147483648
    s_nop 0
    v_cndmask_b32 v11, v9, v11, vcc
    s_waitcnt lgkmcnt(0)
    v_mul_f32 v60, 0xbfb8aa3b, v60
    v_exp_f32 v60, v60
    s_nop 0
    v_add_f32 v60, 1.0, v60
    v_rcp_f32 v60, v60
    s_nop 0
    v_cvt_pk_bf16_f32 v60, v60, v60
    v_lshlrev_b32 v60, 16, v60
    v_lshlrev_b32 v64, 16, v56
    v_and_b32 v65, 0xffff0000, v56
    v_lshlrev_b32 v68, 16, v58
    v_and_b32 v69, 0xffff0000, v58
    v_lshlrev_b32 v66, 16, v57
    v_and_b32 v67, 0xffff0000, v57
    v_lshlrev_b32 v70, 16, v59
    v_and_b32 v71, 0xffff0000, v59
    s_lshr_b32 s86, s52, 1
    s_lshl_b32 s86, s86, 7
    s_add_u32 s86, s86, 720896
    v_lshl_add_u32 v9, v0, 2, s86
    v_mov_b32 v8, 2147483648
    v_cmp_gt_u32 vcc, 32, v0
    s_nop 1
    v_cndmask_b32 v9, v8, v9, vcc
L_h6f:
    v_mov_b32 v8, 0
    buffer_atomic_or v8, v9, s[16:19], 0 offen sc0 sc1
    s_waitcnt vmcnt(0)
    v_cmp_ne_u32 vcc, s68, v8
    s_mov_b32 vcc_hi, 0
    s_cbranch_vccz L_ok_9
    s_sub_u32 s56, s56, 1
    s_cbranch_scc0 L_h6f
    s_mov_b32 s56, 0
L_ok_9:
L_h6:
    s_mov_b32 s90, 0
    buffer_load_dwordx4 v[112:115], v10, s[16:19], s90 offen sc1
    s_mov_b32 s90, 32768
    buffer_load_dwordx4 v[116:119], v10, s[16:19], s90 offen sc1
    s_mov_b32 s90, 65536
    buffer_load_dwordx4 v[120:123], v10, s[16:19], s90 offen sc1
    s_mov_b32 s90, 98304
    buffer_load_dwordx4 v[124:127], v10, s[16:19], s90 offen sc1
    s_mov_b32 s90, 131072
    buffer_load_dwordx4 v[128:131], v10, s[16:19], s90 offen sc1
    s_mov_b32 s90, 163840
    buffer_load_dwordx4 v[132:135], v10, s[16:19], s90 offen sc1
    s_mov_b32 s90, 196608
    buffer_load_dwordx4 v[136:139], v10, s[16:19], s90 offen sc1
    s_mov_b32 s90, 229376
    buffer_load_dwordx4 v[140:143], v10, s[16:19], s90 offen sc1
    s_waitcnt vmcnt(0)
    v_max3_u32 v8, v115, v119, v123
    v_max3_u32 v8, v8, v127, v131
    v_max3_u32 v8, v8, v135, v139
    v_max_u32 v8, v8, v143
    v_cmp_eq_u32 vcc, -1, v8
    s_cbranch_vccz L_ok_10
    s_sub_u32 s56, s56, 1
    s_cbranch_scc0 L_h6
    s_mov_b32 s56, 0
L_ok_10:
    v_pk_add_f32 v[112:113], v[112:113], v[128:129]
    v_pk_add_f32 v[114:115], v[114:115], v[130:131]
    v_pk_add_f32 v[116:117], v[116:117], v[132:133]
    v_pk_add_f32 v[118:119], v[118:119], v[134:135]
    v_pk_add_f32 v[120:121], v[120:121], v[136:137]
    v_pk_add_f32 v[122:123], v[122:123], v[138:139]
    v_pk_add_f32 v[124:125], v[124:125], v[140:141]
    v_pk_add_f32 v[126:127], v[126:127], v[142:143]
    v_pk_add_f32 v[112:113], v[112:113], v[120:121]
    v_pk_add_f32 v[114:115], v[114:115], v[122:123]
    v_pk_add_f32 v[116:117], v[116:117], v[124:125]
    v_pk_add_f32 v[118:119], v[118:119], v[126:127]
    v_pk_add_f32 v[112:113], v[112:113], v[116:117]
    v_pk_add_f32 v[114:115], v[114:115], v[118:119]
    v_mov_b32 v116, v112
    v_mov_b32 v117, v113
    v_mov_b32 v118, v114
    v_mov_b32 v119, v115
    v_permlane32_swap_b32 v112, v116
    v_permlane32_swap_b32 v113, v117
    v_permlane32_swap_b32 v114, v118
    v_permlane32_swap_b32 v115, v119
    v_add_f32 v112, v112, v116
    v_add_f32 v113, v113, v117
    v_add_f32 v114, v114, v118
    v_add_f32 v115, v115, v119
    v_mov_b32 v116, v112
    v_mov_b32 v117, v113
    v_mov_b32 v118, v114
    v_mov_b32 v119, v115
    v_permlane16_swap_b32 v112, v116
    v_permlane16_swap_b32 v113, v117
    v_permlane16_swap_b32 v114, v118
    v_permlane16_swap_b32 v115, v119
    v_add_f32 v112, v112, v116
    v_add_f32 v113, v113, v117
    v_add_f32 v114, v114, v118
    v_add_f32 v115, v115, v119
    v_cvt_pk_bf16_f32 v116, v112, v113
    v_cvt_pk_bf16_f32 v117, v114, v115
    v_lshlrev_b32 v112, 16, v116
    v_and_b32 v113, 0xffff0000, v116
    v_lshlrev_b32 v114, 16, v117
    v_and_b32 v115, 0xffff0000, v117
    v_pk_mul_f32 v[112:113], v[112:113], v[60:61] op_sel_hi:[1,0]
    v_pk_mul_f32 v[114:115], v[114:115], v[60:61] op_sel_hi:[1,0]
    v_cvt_pk_bf16_f32 v116, v112, v113
    v_cvt_pk_bf16_f32 v117, v114, v115
    v_lshlrev_b32 v112, 16, v116
    v_and_b32 v113, 0xffff0000, v116
    v_lshlrev_b32 v114, 16, v117
    v_and_b32 v115, 0xffff0000, v117
    v_pk_add_f32 v[112:113], v[112:113], v[68:69]
    v_pk_add_f32 v[114:115], v[114:115], v[70:71]
    v_cvt_pk_bf16_f32 v116, v112, v113
    v_cvt_pk_bf16_f32 v117, v114, v115
    v_lshlrev_b32 v112, 16, v116
    v_and_b32 v113, 0xffff0000, v116
    v_lshlrev_b32 v114, 16, v117
    v_and_b32 v115, 0xffff0000, v117
    v_pk_add_f32 v[112:113], v[112:113], v[64:65]
    v_pk_add_f32 v[114:115], v[114:115], v[66:67]
    v_cvt_pk_bf16_f32 v116, v112, v113
    v_cvt_pk_bf16_f32 v117, v114, v115
    buffer_store_dwordx2 v[116:117], v11, s[24:27], 0 offen
L_fin_next:
    s_mov_b32 s60, s61
    s_add_u32 s63, s63, 1
    s_cmp_lt_u32 s63, 2
    s_cbranch_scc1 L_fin_loop
L_fin:
L_end:
    s_endpgm
L_b_restart:
    s_waitcnt vmcnt(0)
    v_xor_b32 v9, 0x8000, v7
    buffer_load_dwordx4 v[136:139], v7, s[8:11], 0 offen
    buffer_load_dwordx4 v[140:143], v9, s[8:11], 0 offen
    v_mov_b32 v8, s68
    s_mov_b32 s66, 0xffffaaaa
    s_branch L_b_init
L_b_p0:
    v_mov_b32 v8, 0
    buffer_atomic_or v8, v159, s[16:19], 0 offen sc0 sc1
L_b_w0:
    s_waitcnt vmcnt(0)
    v_cmp_eq_u32 vcc, s68, v8
    s_nop 0
    s_lshr_b32 s65, vcc_lo, 1
    s_and_b32 s65, s65, vcc_lo
    s_andn2_b32 s65, s65, s66
    s_cbranch_scc0 L_b_q0
    s_or_b32 s66, s66, s65
    s_branch L_b_r0
L_b_q0:
    s_sub_u32 s56, s56, 1
    s_cbranch_scc0 L_b_p0
    s_mov_b32 s56, 0
    s_not_b32 s65, s66
    s_branch L_b_r0
L_b_p1:
    v_mov_b32 v8, 0
    buffer_atomic_or v8, v159, s[16:19], 0 offen sc0 sc1
    s_waitcnt vmcnt(0)
    v_cmp_eq_u32 vcc, s68, v8
    s_nop 0
    s_lshr_b32 s65, vcc_lo, 1
    s_and_b32 s65, s65, vcc_lo
    s_andn2_b32 s65, s65, s66
    s_cbranch_scc0 L_b_q1
    s_or_b32 s66, s66, s65
    s_branch L_b_r1
L_b_q1:
    s_sub_u32 s56, s56, 1
    s_cbranch_scc0 L_b_p1
    s_mov_b32 s56, 0
    s_not_b32 s65, s66
    s_branch L_b_r1
L_b_p2:
    v_mov_b32 v8, 0
    buffer_atomic_or v8, v159, s[16:19], 0 offen sc0 sc1
    s_waitcnt vmcnt(0)
    v_cmp_eq_u32 vcc, s68, v8
    s_nop 0
    s_lshr_b32 s65, vcc_lo, 1
    s_and_b32 s65, s65, vcc_lo
    s_andn2_b32 s65, s65, s66
    s_cbranch_scc0 L_b_q2
    s_or_b32 s66, s66, s65
    s_branch L_b_r2
L_b_q2:
    s_sub_u32 s56, s56, 1
    s_cbranch_scc0 L_b_p2
    s_mov_b32 s56, 0
    s_not_b32 s65, s66
    s_branch L_b_r2
L_b_p3:
    v_mov_b32 v8, 0
    buffer_atomic_or v8, v159, s[16:19], 0 offen sc0 sc1
    s_waitcnt vmcnt(0)
    v_cmp_eq_u32 vcc, s68, v8
    s_nop 0
    s_lshr_b32 s65, vcc_lo, 1
    s_and_b32 s65, s65, vcc_lo
    s_andn2_b32 s65, s65, s66
    s_cbranch_scc0 L_b_q3
    s_or_b32 s66, s66, s65
    s_branch L_b_r3
L_b_q3:
    s_sub_u32 s56, s56, 1
    s_cbranch_scc0 L_b_p3
    s_mov_b32 s56, 0
    s_not_b32 s65, s66
    s_branch L_b_r3
L_b_p4:
    v_mov_b32 v8, 0
    buffer_atomic_or v8, v159, s[16:19], 0 offen sc0 sc1
    s_waitcnt vmcnt(0)
    v_cmp_eq_u32 vcc, s68, v8
    s_nop 0
    s_lshr_b32 s65, vcc_lo, 1
    s_and_b32 s65, s65, vcc_lo
    s_andn2_b32 s65, s65, s66
    s_cbranch_scc0 L_b_q4
    s_or_b32 s66, s66, s65
    s_branch L_b_r4
L_b_q4:
    s_sub_u32 s56, s56, 1
    s_cbranch_scc0 L_b_p4
    s_mov_b32 s56, 0
    s_not_b32 s65, s66
    s_branch L_b_r4
L_b_p5:
    v_mov_b32 v8, 0
    buffer_atomic_or v8, v159, s[16:19], 0 offen sc0 sc1
    s_waitcnt vmcnt(0)
    v_cmp_eq_u32 vcc, s68, v8
    s_nop 0
    s_lshr_b32 s65, vcc_lo, 1
    s_and_b32 s65, s65, vcc_lo
    s_andn2_b32 s65, s65, s66
    s_cbranch_scc0 L_b_q5
    s_or_b32 s66, s66, s65
    s_branch L_b_r5
L_b_q5:
    s_sub_u32 s56, s56, 1
    s_cbranch_scc0 L_b_p5
    s_mov_b32 s56, 0
    s_not_b32 s65, s66
    s_branch L_b_r5
L_b_p6:
    v_mov_b32 v8, 0
    buffer_atomic_or v8, v159, s[16:19], 0 offen sc0 sc1
    s_waitcnt vmcnt(0)
    v_cmp_eq_u32 vcc, s68, v8
    s_nop 0
    s_lshr_b32 s65, vcc_lo, 1
    s_and_b32 s65, s65, vcc_lo
    s_andn2_b32 s65, s65, s66
    s_cbranch_scc0 L_b_q6
    s_or_b32 s66, s66, s65
    s_branch L_b_r6
L_b_q6:
    s_sub_u32 s56, s56, 1
    s_cbranch_scc0 L_b_p6
    s_mov_b32 s56, 0
    s_not_b32 s65, s66
    s_branch L_b_r6
L_b_p7:
    v_mov_b32 v8, 0
    buffer_atomic_or v8, v159, s[16:19], 0 offen sc0 sc1
    s_waitcnt vmcnt(0)
    v_cmp_eq_u32 vcc, s68, v8
    s_nop 0
    s_lshr_b32 s65, vcc_lo, 1
    s_and_b32 s65, s65, vcc_lo
    s_andn2_b32 s65, s65, s66
    s_cbranch_scc0 L_b_q7
    s_or_b32 s66, s66, s65
    s_branch L_b_r7
L_b_q7:
    s_sub_u32 s56, s56, 1
    s_cbranch_scc0 L_b_p7
    s_mov_b32 s56, 0
    s_not_b32 s65, s66
    s_branch L_b_r7
    s_endpgm
.section .rodata,"a"
.p2align 6
.amdhsa_kernel sequential_preLN__linear_attn_block__moe_arch_mod__prompt_kernel
  .amdhsa_next_free_vgpr 256
  .amdhsa_next_free_sgpr 102
  .amdhsa_accum_offset 256
  .amdhsa_group_segment_fixed_size 0
  .amdhsa_kernarg_size 88
  .amdhsa_user_sgpr_count 2
  .amdhsa_user_sgpr_kernarg_segment_ptr 1
  .amdhsa_system_sgpr_workgroup_id_x 1
.end_amdhsa_kernel
```

```asm
; @launch grid=(256,1,1) block=(512,1,1) lds=163840
.amdgcn_target "amdgcn-amd-amdhsa--gfx950"
.text
.globl sequential_preLN__linear_attn_block__moe_arch_mod__prompt_kernel
.p2align 8
.type sequential_preLN__linear_attn_block__moe_arch_mod__prompt_kernel,@function
sequential_preLN__linear_attn_block__moe_arch_mod__prompt_kernel:
    s_cmp_ge_u32 s2, 256
    s_cbranch_scc1 L_end
    s_load_dwordx16 s[64:79], s[0:1], 0
    s_load_dwordx4 s[80:83], s[0:1], 64
    s_load_dwordx2 s[84:85], s[0:1], 80
    v_lshrrev_b32 v1, 6, v0
    v_and_b32 v0, 63, v0
    v_readfirstlane_b32 s3, v1
    s_and_b32 s44, s2, 7
    s_lshr_b32 s45, s2, 3
    s_and_b32 s46, s44, 1
    s_lshl_b32 s46, s46, 3
    s_and_b32 s86, s45, 7
    s_add_u32 s46, s46, s86
    s_lshr_b32 s47, s44, 1
    s_lshl_b32 s47, s47, 2
    s_lshr_b32 s86, s45, 3
    s_add_u32 s47, s47, s86
    s_mov_b32 s51, s47
    s_mov_b32 s52, s46
    s_and_b32 s48, s3, 3
    s_and_b32 s49, s3, 1
    s_bfe_u32 s50, s3, 0x10001
    s_mov_b32 s56, 65536
    s_mov_b32 s95, 0x3f803f80
    s_movk_i32 s92, 0x1000
    s_movk_i32 s93, 0x2000
    s_movk_i32 s94, 0x3000
    s_cmp_lt_u32 s3, 4
    s_cbranch_scc1 L_comp
    v_lshrrev_b32 v20, 3, v0
    v_and_b32 v21, 7, v0
    v_lshrrev_b32 v22, 4, v0
    v_xor_b32 v23, v21, v22
    v_xor_b32 v24, 4, v23
    s_lshl_b32 s86, s48, 5
    v_add_u32 v25, s86, v20
    v_lshlrev_b32 v25, 11, v25
    v_lshl_add_u32 v2, v23, 4, v25
    v_lshl_add_u32 v3, v24, 4, v25
    v_add_u32 v3, 15360, v3
    v_lshl_add_u32 v4, v23, 4, v25
    v_add_u32 v4, 30720, v4
    v_lshl_add_u32 v5, v24, 4, v25
    v_add_u32 v5, 46080, v5
    s_lshl_b32 s86, s48, 4
    v_add_u32 v25, s86, v20
    v_mul_u32_u24 v25, 6144, v25
    s_lshl_b32 s86, s47, 7
    v_add_u32 v25, s86, v25
    v_bfe_u32 v26, v0, 4, 1
    v_lshlrev_b32 v26, 1, v26
    v_xor_b32 v26, v26, v21
    v_xor_b32 v27, 4, v26
    v_lshl_add_u32 v6, v26, 4, v25
    v_lshl_add_u32 v7, v27, 4, v25
    v_add_u32 v7, 48128, v7
    v_lshl_add_u32 v8, v26, 4, v25
    v_add_u32 v8, 2048, v8
    v_lshl_add_u32 v9, v27, 4, v25
    v_add_u32 v9, 50176, v9
    v_lshl_add_u32 v10, v26, 4, v25
    v_add_u32 v10, 4096, v10
    v_lshl_add_u32 v11, v27, 4, v25
    v_add_u32 v11, 52224, v11
    s_lshl_b32 s63, s46, 18
    s_lshl_b32 s53, s48, 12
    s_lshl_b32 s62, s48, 11
    s_add_u32 s62, s62, 16384
    s_setprio 1
    s_lshl_b32 s86, s45, 2
    s_add_u32 s86, s86, s48
    s_mul_i32 s87, s86, 12288
    s_and_b32 s88, s47, 12
    s_lshl_b32 s88, s88, 7
    s_add_u32 s87, s87, s88
    s_add_u32 s87, s87, 384
    s_bitcmp1_b32 s47, 2
    s_cselect_b32 s87, 2147483648, s87
    v_lshl_add_u32 v37, v0, 11, s87
    v_mov_b32 v24, 2147483648
    v_cmp_gt_u32 vcc, 6, v0
    s_nop 1
    v_cndmask_b32 v37, v24, v37, vcc
    s_lshl_b32 s86, s86, 14
    s_and_b32 s88, s46, 8
    s_lshl_b32 s88, s88, 7
    s_add_u32 s86, s86, s88
    s_add_u32 s86, s86, 384
    v_lshl_add_u32 v38, v0, 11, s86
    v_cmp_gt_u32 vcc, 8, v0
    s_nop 1
    v_cndmask_b32 v38, v24, v38, vcc
    s_waitcnt lgkmcnt(0)
    s_mov_b32 s8, s64
    s_and_b32 s9, s65, 0xffff
    s_mov_b32 s10, 4194304
    s_mov_b32 s11, 0x20000
    s_mov_b32 s12, s66
    s_and_b32 s13, s67, 0xffff
    s_mov_b32 s14, 6291456
    s_mov_b32 s15, 0x20000
    s_and_b32 s86, s47, 12
    s_and_b32 s87, s46, 8
    s_add_u32 s64, s86, s87
    s_and_b32 s64, s64, 15
    s_mov_b32 s67, s64
    s_load_dword s61, s[84:85], 524288
    s_lshr_b32 s90, s67, 2
    s_mul_i32 s90, s90, 1572864
    buffer_load_dword v39, v37, s[12:15], s90 offen
    s_add_u32 m0, s53, 0
    s_lshl_b32 s90, s64, 7
    s_add_u32 s90, s90, s63
    buffer_load_dwordx4 v2, s[8:11], s90 offen offset:0 lds
    buffer_load_dwordx4 v3, s[8:11], s90 offen offset:1024 lds
    buffer_load_dwordx4 v4, s[8:11], s90 offen offset:2048 lds
    buffer_load_dwordx4 v5, s[8:11], s90 offen offset:3072 lds
    s_mul_i32 s91, s64, 393216
    s_add_u32 s64, s64, 1
    s_and_b32 s64, s64, 15
    s_add_u32 m0, s62, 0
    s_nop 0
    buffer_load_dwordx4 v6, s[12:15], s91 offen offset:0 lds
    buffer_load_dwordx4 v7, s[12:15], s91 offen offset:1024 lds
    s_add_u32 m0, s62, 8192
    s_nop 0
    buffer_load_dwordx4 v8, s[12:15], s91 offen offset:0 lds
    buffer_load_dwordx4 v9, s[12:15], s91 offen offset:1024 lds
    s_add_u32 m0, s62, 16384
    s_nop 0
    buffer_load_dwordx4 v10, s[12:15], s91 offen offset:0 lds
    buffer_load_dwordx4 v11, s[12:15], s91 offen offset:1024 lds
    s_mov_b32 s16, s84
    s_and_b32 s17, s85, 0xffff
    s_mov_b32 s18, 268435456
    s_mov_b32 s19, 0x20000
    s_mov_b32 s20, s68
    s_and_b32 s21, s69, 0xffff
    s_mov_b32 s22, 2097152
    s_mov_b32 s23, 0x20000
    s_mov_b32 s24, s80
    s_and_b32 s25, s81, 0xffff
    s_mov_b32 s26, 4194304
    s_mov_b32 s27, 0x20000
    s_mov_b32 s28, s82
    s_and_b32 s29, s83, 0xffff
    s_mov_b32 s30, 256
    s_mov_b32 s31, 0x20000
    s_bitcmp1_b32 s2, 0
    s_cselect_b32 s32, s76, s74
    s_cselect_b32 s33, s77, s75
    s_and_b32 s33, s33, 0xffff
    s_mov_b32 s34, 7340032
    s_mov_b32 s35, 0x20000
    s_mov_b32 s36, s78
    s_and_b32 s37, s79, 0xffff
    s_mov_b32 s38, 7340032
    s_mov_b32 s39, 0x20000
    s_mov_b32 s40, s72
    s_and_b32 s41, s73, 0xffff
    s_mov_b32 s42, 2048
    s_mov_b32 s43, 0x20000
    v_lshrrev_b32 v22, 4, v0
    v_and_b32 v23, 15, v0
    s_lshl_b32 s86, s45, 2
    s_add_u32 s86, s86, s48
    s_mul_i32 s87, s86, 6
    v_mul_u32_u24 v24, 43, v0
    v_lshrrev_b32 v24, 8, v24
    v_mul_u32_u24 v25, 6, v24
    v_sub_u32 v25, v0, v25
    v_add_u32 v25, s87, v25
    s_add_u32 s87, s67, 2
    v_add_u32 v24, s87, v24
    v_and_b32 v24, 15, v24
    v_mul_u32_u24 v124, 393216, v24
    v_lshrrev_b32 v24, 2, v25
    v_lshl_add_u32 v124, v24, 11, v124
    v_and_b32 v25, 3, v25
    s_and_b32 s88, s47, 12
    v_add_u32 v25, s88, v25
    v_lshl_add_u32 v124, v25, 7, v124
    v_mov_b32 v24, 2147483648
    v_cmp_gt_u32 vcc, 36, v0
    s_nop 1
    v_cndmask_b32 v124, v24, v124, vcc
    v_add_u32 v24, s87, v20
    v_and_b32 v24, 15, v24
    s_and_b32 s88, s46, 8
    s_lshl4_add_u32 s86, s88, s86
    s_lshl_b32 s86, s86, 14
    v_lshl_add_u32 v123, v21, 11, s86
    v_lshl_add_u32 v123, v24, 7, v123
    v_mov_b32 v24, 2147483648
    v_cmp_gt_u32 vcc, 16, v0
    s_nop 1
    v_cndmask_b32 v123, v24, v123, vcc
    s_add_u32 m0, s53, 40960
    s_lshl_b32 s90, s64, 7
    s_add_u32 s90, s90, s63
    buffer_load_dwordx4 v2, s[8:11], s90 offen offset:0 lds
    buffer_load_dwordx4 v3, s[8:11], s90 offen offset:1024 lds
    buffer_load_dwordx4 v4, s[8:11], s90 offen offset:2048 lds
    buffer_load_dwordx4 v5, s[8:11], s90 offen offset:3072 lds
    s_mul_i32 s91, s64, 393216
    s_add_u32 s64, s64, 1
    s_and_b32 s64, s64, 15
    s_add_u32 m0, s62, 40960
    s_nop 0
    buffer_load_dwordx4 v6, s[12:15], s91 offen offset:0 lds
    buffer_load_dwordx4 v7, s[12:15], s91 offen offset:1024 lds
    s_add_u32 m0, s62, 49152
    s_nop 0
    buffer_load_dwordx4 v8, s[12:15], s91 offen offset:0 lds
    buffer_load_dwordx4 v9, s[12:15], s91 offen offset:1024 lds
    s_add_u32 m0, s62, 57344
    s_nop 0
    buffer_load_dwordx4 v10, s[12:15], s91 offen offset:0 lds
    buffer_load_dwordx4 v11, s[12:15], s91 offen offset:1024 lds
    buffer_load_dword v122, v123, s[8:11], 0 offen
    buffer_load_dword v122, v124, s[12:15], 0 offen
    s_and_b32 s65, s45, 7
    s_lshr_b32 s66, s45, 3
    s_mul_i32 s86, s65, 11
    s_lshr_b32 s86, s86, 5
    s_mul_i32 s86, s86, 3
    s_sub_u32 s86, s65, s86
    s_mul_i32 s86, s86, 40960
    s_lshl_b32 s87, s48, 13
    s_cmp_eq_u32 s48, 3
    s_cselect_b32 s87, 0, s87
    s_add_u32 s86, s86, s87
    s_add_u32 s86, s86, 16384
    v_lshl_add_u32 v25, v20, 7, s86
    v_lshl_add_u32 v28, v26, 4, v25
    v_lshl_add_u32 v29, v27, 4, v25
    s_cmp_eq_u32 s66, 3
    s_cselect_b32 s86, 0, s66
    s_mul_i32 s86, s86, 40960
    s_add_u32 s86, s86, s53
    v_lshl_add_u32 v16, v0, 6, s86
    v_bfe_u32 v25, v0, 2, 2
    v_lshl_add_u32 v16, v25, 4, v16
    v_xor_b32 v17, 16, v16
    v_xor_b32 v18, 32, v16
    v_xor_b32 v19, 48, v16
    s_lshl_b32 s86, s46, 14
    s_lshl_b32 s87, s48, 8
    s_add_u32 s86, s86, s87
    s_add_u32 s86, s86, 262144
    v_lshl_add_u32 v33, v23, 4, s86
    v_lshl_add_u32 v33, v22, 10, v33
    s_lshl_b32 s87, s47, 10
    s_add_u32 s86, s86, s87
    v_lshl_add_u32 v13, v0, 2, s86
    v_and_b32 v25, 3, v0
    v_cmp_eq_u32 vcc, 0, v25
    v_mov_b32 v24, 2147483648
    s_nop 0
    v_cndmask_b32 v13, v24, v13, vcc
    s_mul_i32 s86, s47, 12288
    s_add_u32 s86, s86, 65536
    s_lshl_b32 s87, s48, 8
    s_cmp_eq_u32 s48, 3
    s_cselect_b32 s87, 0, s87
    s_cselect_b32 s88, 2147483648, 0
    s_add_u32 s86, s86, s87
    v_lshl_add_u32 v32, v23, 4, s86
    v_mul_u32_u24 v25, 768, v22
    v_add_u32 v32, v32, v25
    s_mul_i32 s87, s46, 768
    s_add_u32 s86, s86, s87
    s_add_u32 s86, s86, s88
    v_lshl_add_u32 v34, v23, 5, s86
    v_lshl_add_u32 v34, v22, 4, v34
    v_and_b32 v25, 0x28, v0
    v_cmp_eq_u32 vcc, 0, v25
    s_nop 1
    v_cndmask_b32 v34, v24, v34, vcc
    s_bfe_u32 s86, s2, 0x20001
    s_lshl_b32 s86, s86, 2
    s_add_u32 s86, s86, s48
    s_lshl_b32 s86, s86, 6
    v_lshl_add_u32 v30, v22, 4, s86
    v_mul_u32_u24 v30, 7168, v30
    s_lshl_b32 s86, s45, 1
    s_sub_u32 s86, s86, 14
    s_mul_i32 s87, s86, 37
    s_lshr_b32 s87, s87, 8
    s_add_u32 s80, s86, s87
    s_and_b32 s87, s80, 7
    s_cmp_ge_u32 s87, 3
    s_addc_u32 s80, s80, 0
    s_lshl_b32 s86, s45, 1
    s_sub_u32 s86, s86, 13
    s_mul_i32 s87, s86, 37
    s_lshr_b32 s87, s87, 8
    s_add_u32 s81, s86, s87
    s_and_b32 s87, s81, 7
    s_cmp_ge_u32 s87, 3
    s_addc_u32 s81, s81, 0
    s_lshl_b32 s86, s45, 3
    s_add_u32 s86, s86, 3
    s_cmp_lt_u32 s45, 7
    s_cselect_b32 s80, s86, s80
    s_cselect_b32 s81, 56, s81
    v_mov_b32 v24, s80
    v_mov_b32 v25, s81
    s_mov_b32 vcc_lo, 4278255360
    s_mov_b32 vcc_hi, vcc_lo
    v_cndmask_b32 v24, v24, v25, vcc
    v_cmp_gt_u32 vcc, 56, v24
    v_and_b32 v25, 7, v0
    v_lshlrev_b32 v24, 7, v24
    v_lshl_add_u32 v24, v25, 4, v24
    v_add_u32 v30, v30, v24
    v_mov_b32 v24, 2147483648
    v_cndmask_b32 v30, v24, v30, vcc
    s_mul_i32 s86, s45, 112
    s_mul_i32 s87, s48, 28
    s_add_u32 s86, s86, s87
    v_mul_u32_u24 v31, 7, v22
    v_add_u32 v31, s86, v31
    v_lshlrev_b32 v31, 11, v31
    s_lshl_b32 s86, s44, 8
    v_lshl_add_u32 v24, v23, 4, s86
    v_add_u32 v31, v31, v24
    v_lshlrev_b32 v24, 1, v22
    v_xor_b32 v24, v24, v21
    s_lshl_b32 s86, s48, 3
    v_add_u32 v12, s86, v20
    v_lshlrev_b32 v12, 11, v12
    s_lshl_b32 s86, s52, 7
    v_lshl_add_u32 v24, v24, 4, s86
    v_add_u32 v12, v12, v24
    s_lshl_b32 s89, s48, 10
    v_and_b32 v24, 1, v0
    v_lshlrev_b32 v24, 4, v24
    v_mov_b32 v25, 0x3f80
    v_lshlrev_b32 v24, v24, v25
    v_bfe_u32 v25, v0, 1, 2
    v_cmp_eq_u32 vcc, 0, v25
    s_nop 1
    v_cndmask_b32 v104, 0, v24, vcc
    v_cmp_eq_u32 vcc, 1, v25
    s_nop 1
    v_cndmask_b32 v105, 0, v24, vcc
    v_cmp_eq_u32 vcc, 2, v25
    s_nop 1
    v_cndmask_b32 v106, 0, v24, vcc
    v_cmp_eq_u32 vcc, 3, v25
    s_nop 1
    v_cndmask_b32 v107, 0, v24, vcc
    s_waitcnt lgkmcnt(0)
    s_add_u32 s68, s61, 0x9e3779b9
    v_mov_b32 v35, s68
    s_lshl_b32 s86, s46, 2
    s_add_u32 s86, s86, s48
    s_lshl_b32 s86, s86, 7
    s_add_u32 s86, s86, 655360
    s_lshl_b32 s87, s47, 2
    s_add_u32 s87, s87, s48
    s_lshl_b32 s87, s87, 7
    s_add_u32 s87, s87, 663552
    s_cmp_eq_u32 s48, 3
    s_cselect_b32 s87, 2147483648, s87
    s_cselect_b32 s76, 0xffff, -1
    s_mov_b32 s77, 0
    v_mov_b32 v24, s86
    v_mov_b32 v25, s87
    v_cmp_gt_u32 vcc, 16, v0
    s_nop 1
    v_cndmask_b32 v117, v25, v24, vcc
    v_lshl_add_u32 v117, v23, 2, v117
    v_mov_b32 v116, 2147483648
    v_cmp_gt_u32 vcc, 32, v0
    s_nop 1
    v_cndmask_b32 v117, v116, v117, vcc
    s_lshl2_add_u32 s86, s47, s86
    s_lshl2_add_u32 s87, s46, s87
    v_writelane_b32 v116, s86, 0
    v_writelane_b32 v116, s87, 1
    v_mov_b32 v24, 135168
    v_lshl_add_u32 v24, v21, 2, v24
    v_mov_b32 v25, 0
    ds_write_b32 v24, v25
    s_waitcnt lgkmcnt(0)
    s_waitcnt vmcnt(12)
    s_barrier
    s_add_u32 m0, s53, 81920
    s_lshl_b32 s90, s64, 7
    s_add_u32 s90, s90, s63
    buffer_load_dwordx4 v2, s[8:11], s90 offen offset:0 lds
    buffer_load_dwordx4 v3, s[8:11], s90 offen offset:1024 lds
    buffer_load_dwordx4 v4, s[8:11], s90 offen offset:2048 lds
    buffer_load_dwordx4 v5, s[8:11], s90 offen offset:3072 lds
    s_mul_i32 s91, s64, 393216
    s_add_u32 s64, s64, 1
    s_and_b32 s64, s64, 15
    s_add_u32 m0, s62, 81920
    s_nop 0
    buffer_load_dwordx4 v6, s[12:15], s91 offen offset:0 lds
    buffer_load_dwordx4 v7, s[12:15], s91 offen offset:1024 lds
    s_add_u32 m0, s62, 90112
    s_nop 0
    buffer_load_dwordx4 v8, s[12:15], s91 offen offset:0 lds
    buffer_load_dwordx4 v9, s[12:15], s91 offen offset:1024 lds
    s_add_u32 m0, s62, 98304
    s_nop 0
    buffer_load_dwordx4 v10, s[12:15], s91 offen offset:0 lds
    buffer_load_dwordx4 v11, s[12:15], s91 offen offset:1024 lds
    s_cmp_lg_u32 s65, 0
    s_cbranch_scc1 L_h0c0
    ds_read_b128 v[40:43], v28 offset:0
    ds_read_b128 v[44:47], v29 offset:1024
    ds_read_b128 v[48:51], v28 offset:2048
    ds_read_b128 v[52:55], v29 offset:3072
    ds_read_b128 v[56:59], v28 offset:4096
    ds_read_b128 v[60:63], v29 offset:5120
    ds_read_b128 v[64:67], v28 offset:6144
    ds_read_b128 v[68:71], v29 offset:7168
L_h0c0:
    s_cmp_lg_u32 s66, 0
    s_cbranch_scc1 L_h0r0
    ds_read_b128 v[72:75], v16
    ds_read_b128 v[76:79], v17
    ds_read_b128 v[80:83], v18
    ds_read_b128 v[84:87], v19
L_h0r0:
    s_waitcnt lgkmcnt(0)
    s_waitcnt vmcnt(12)
    s_barrier
    s_add_u32 m0, s53, 0
    s_lshl_b32 s90, s64, 7
    s_add_u32 s90, s90, s63
    buffer_load_dwordx4 v2, s[8:11], s90 offen offset:0 lds
    buffer_load_dwordx4 v3, s[8:11], s90 offen offset:1024 lds
    buffer_load_dwordx4 v4, s[8:11], s90 offen offset:2048 lds
    buffer_load_dwordx4 v5, s[8:11], s90 offen offset:3072 lds
    s_mul_i32 s91, s64, 393216
    s_add_u32 s64, s64, 1
    s_and_b32 s64, s64, 15
    s_add_u32 m0, s62, 0
    s_nop 0
    buffer_load_dwordx4 v6, s[12:15], s91 offen offset:0 lds
    buffer_load_dwordx4 v7, s[12:15], s91 offen offset:1024 lds
    s_add_u32 m0, s62, 8192
    s_nop 0
    buffer_load_dwordx4 v8, s[12:15], s91 offen offset:0 lds
    buffer_load_dwordx4 v9, s[12:15], s91 offen offset:1024 lds
    s_add_u32 m0, s62, 16384
    s_nop 0
    buffer_load_dwordx4 v10, s[12:15], s91 offen offset:0 lds
    buffer_load_dwordx4 v11, s[12:15], s91 offen offset:1024 lds
    s_cmp_lg_u32 s65, 1
    s_cbranch_scc1 L_h0c1
    ds_read_b128 v[40:43], v28 offset:0
    ds_read_b128 v[44:47], v29 offset:1024
    ds_read_b128 v[48:51], v28 offset:2048
    ds_read_b128 v[52:55], v29 offset:3072
    ds_read_b128 v[56:59], v28 offset:4096
    ds_read_b128 v[60:63], v29 offset:5120
    ds_read_b128 v[64:67], v28 offset:6144
    ds_read_b128 v[68:71], v29 offset:7168
L_h0c1:
    s_cmp_lg_u32 s66, 1
    s_cbranch_scc1 L_h0r1
    ds_read_b128 v[72:75], v16
    ds_read_b128 v[76:79], v17
    ds_read_b128 v[80:83], v18
    ds_read_b128 v[84:87], v19
L_h0r1:
    s_waitcnt lgkmcnt(0)
    s_waitcnt vmcnt(10)
    s_barrier
    s_add_u32 m0, s53, 40960
    s_lshl_b32 s90, s64, 7
    s_add_u32 s90, s90, s63
    buffer_load_dwordx4 v2, s[8:11], s90 offen offset:0 lds
    buffer_load_dwordx4 v3, s[8:11], s90 offen offset:1024 lds
    buffer_load_dwordx4 v4, s[8:11], s90 offen offset:2048 lds
    buffer_load_dwordx4 v5, s[8:11], s90 offen offset:3072 lds
    s_mul_i32 s91, s64, 393216
    s_add_u32 s64, s64, 1
    s_and_b32 s64, s64, 15
    s_add_u32 m0, s62, 40960
    s_nop 0
    buffer_load_dwordx4 v6, s[12:15], s91 offen offset:0 lds
    buffer_load_dwordx4 v7, s[12:15], s91 offen offset:1024 lds
    s_add_u32 m0, s62, 49152
    s_nop 0
    buffer_load_dwordx4 v8, s[12:15], s91 offen offset:0 lds
    buffer_load_dwordx4 v9, s[12:15], s91 offen offset:1024 lds
    s_add_u32 m0, s62, 57344
    s_nop 0
    buffer_load_dwordx4 v10, s[12:15], s91 offen offset:0 lds
    buffer_load_dwordx4 v11, s[12:15], s91 offen offset:1024 lds
    s_cmp_lg_u32 s65, 2
    s_cbranch_scc1 L_h0c2
    ds_read_b128 v[40:43], v28 offset:0
    ds_read_b128 v[44:47], v29 offset:1024
    ds_read_b128 v[48:51], v28 offset:2048
    ds_read_b128 v[52:55], v29 offset:3072
    ds_read_b128 v[56:59], v28 offset:4096
    ds_read_b128 v[60:63], v29 offset:5120
    ds_read_b128 v[64:67], v28 offset:6144
    ds_read_b128 v[68:71], v29 offset:7168
L_h0c2:
    s_cmp_lg_u32 s66, 2
    s_cbranch_scc1 L_h0r2
    ds_read_b128 v[72:75], v16
    ds_read_b128 v[76:79], v17
    ds_read_b128 v[80:83], v18
    ds_read_b128 v[84:87], v19
L_h0r2:
    s_waitcnt lgkmcnt(0)
    s_waitcnt vmcnt(10)
    s_barrier
    s_add_u32 m0, s53, 81920
    s_lshl_b32 s90, s64, 7
    s_add_u32 s90, s90, s63
    buffer_load_dwordx4 v2, s[8:11], s90 offen offset:0 lds
    buffer_load_dwordx4 v3, s[8:11], s90 offen offset:1024 lds
    buffer_load_dwordx4 v4, s[8:11], s90 offen offset:2048 lds
    buffer_load_dwordx4 v5, s[8:11], s90 offen offset:3072 lds
    s_mul_i32 s91, s64, 393216
    s_add_u32 s64, s64, 1
    s_and_b32 s64, s64, 15
    s_add_u32 m0, s62, 81920
    s_nop 0
    buffer_load_dwordx4 v6, s[12:15], s91 offen offset:0 lds
    buffer_load_dwordx4 v7, s[12:15], s91 offen offset:1024 lds
    s_add_u32 m0, s62, 90112
    s_nop 0
    buffer_load_dwordx4 v8, s[12:15], s91 offen offset:0 lds
    buffer_load_dwordx4 v9, s[12:15], s91 offen offset:1024 lds
    s_add_u32 m0, s62, 98304
    s_nop 0
    buffer_load_dwordx4 v10, s[12:15], s91 offen offset:0 lds
    buffer_load_dwordx4 v11, s[12:15], s91 offen offset:1024 lds
    s_lshr_b32 s90, s67, 2
    s_add_u32 s90, s90, 2
    s_and_b32 s90, s90, 3
    s_mul_i32 s90, s90, 1572864
    buffer_load_dword v39, v37, s[12:15], s90 offen
    s_cmp_lg_u32 s65, 3
    s_cbranch_scc1 L_h0c3
    ds_read_b128 v[40:43], v28 offset:0
    ds_read_b128 v[44:47], v29 offset:1024
    ds_read_b128 v[48:51], v28 offset:2048
    ds_read_b128 v[52:55], v29 offset:3072
    ds_read_b128 v[56:59], v28 offset:4096
    ds_read_b128 v[60:63], v29 offset:5120
    ds_read_b128 v[64:67], v28 offset:6144
    ds_read_b128 v[68:71], v29 offset:7168
L_h0c3:
    s_cmp_lg_u32 s66, 3
    s_cbranch_scc1 L_h0r3
    ds_read_b128 v[72:75], v16
    ds_read_b128 v[76:79], v17
    ds_read_b128 v[80:83], v18
    ds_read_b128 v[84:87], v19
L_h0r3:
    s_waitcnt lgkmcnt(0)
    s_waitcnt vmcnt(11)
    s_barrier
    s_add_u32 m0, s53, 0
    s_lshl_b32 s90, s64, 7
    s_add_u32 s90, s90, s63
    buffer_load_dwordx4 v2, s[8:11], s90 offen offset:0 lds
    buffer_load_dwordx4 v3, s[8:11], s90 offen offset:1024 lds
    buffer_load_dwordx4 v4, s[8:11], s90 offen offset:2048 lds
    buffer_load_dwordx4 v5, s[8:11], s90 offen offset:3072 lds
    s_mul_i32 s91, s64, 393216
    s_add_u32 s64, s64, 1
    s_and_b32 s64, s64, 15
    s_add_u32 m0, s62, 0
    s_nop 0
    buffer_load_dwordx4 v6, s[12:15], s91 offen offset:0 lds
    buffer_load_dwordx4 v7, s[12:15], s91 offen offset:1024 lds
    s_add_u32 m0, s62, 8192
    s_nop 0
    buffer_load_dwordx4 v8, s[12:15], s91 offen offset:0 lds
    buffer_load_dwordx4 v9, s[12:15], s91 offen offset:1024 lds
    s_add_u32 m0, s62, 16384
    s_nop 0
    buffer_load_dwordx4 v10, s[12:15], s91 offen offset:0 lds
    buffer_load_dwordx4 v11, s[12:15], s91 offen offset:1024 lds
    s_cmp_lg_u32 s65, 4
    s_cbranch_scc1 L_h0c4
    ds_read_b128 v[40:43], v28 offset:0
    ds_read_b128 v[44:47], v29 offset:1024
    ds_read_b128 v[48:51], v28 offset:2048
    ds_read_b128 v[52:55], v29 offset:3072
    ds_read_b128 v[56:59], v28 offset:4096
    ds_read_b128 v[60:63], v29 offset:5120
    ds_read_b128 v[64:67], v28 offset:6144
    ds_read_b128 v[68:71], v29 offset:7168
L_h0c4:
    s_waitcnt lgkmcnt(0)
    v_mov_b32 v88, 0
    v_mov_b32 v89, 0
    v_mov_b32 v90, 0
    v_mov_b32 v91, 0
    v_mov_b32 v92, 0
    v_mov_b32 v93, 0
    v_mov_b32 v94, 0
    v_mov_b32 v95, 0
    v_dot2c_f32_bf16 v88, s95, v72
    v_dot2c_f32_bf16 v89, s95, v73
    v_dot2c_f32_bf16 v90, s95, v74
    v_dot2c_f32_bf16 v91, s95, v75
    v_dot2c_f32_bf16 v92, v72, v72
    v_dot2c_f32_bf16 v93, v73, v73
    v_dot2c_f32_bf16 v94, v74, v74
    v_dot2c_f32_bf16 v95, v75, v75
    v_dot2c_f32_bf16 v88, s95, v76
    v_dot2c_f32_bf16 v89, s95, v77
    v_dot2c_f32_bf16 v90, s95, v78
    v_dot2c_f32_bf16 v91, s95, v79
    v_dot2c_f32_bf16 v92, v76, v76
    v_dot2c_f32_bf16 v93, v77, v77
    v_dot2c_f32_bf16 v94, v78, v78
    v_dot2c_f32_bf16 v95, v79, v79
    v_dot2c_f32_bf16 v88, s95, v80
    v_dot2c_f32_bf16 v89, s95, v81
    v_dot2c_f32_bf16 v90, s95, v82
    v_dot2c_f32_bf16 v91, s95, v83
    v_dot2c_f32_bf16 v92, v80, v80
    v_dot2c_f32_bf16 v93, v81, v81
    v_dot2c_f32_bf16 v94, v82, v82
    v_dot2c_f32_bf16 v95, v83, v83
    v_dot2c_f32_bf16 v88, s95, v84
    v_dot2c_f32_bf16 v89, s95, v85
    v_dot2c_f32_bf16 v90, s95, v86
    v_dot2c_f32_bf16 v91, s95, v87
    v_dot2c_f32_bf16 v92, v84, v84
    v_dot2c_f32_bf16 v93, v85, v85
    v_dot2c_f32_bf16 v94, v86, v86
    v_dot2c_f32_bf16 v95, v87, v87
    s_waitcnt vmcnt(11)
    s_barrier
    s_add_u32 m0, s53, 40960
    s_lshl_b32 s90, s64, 7
    s_add_u32 s90, s90, s63
    buffer_load_dwordx4 v2, s[8:11], s90 offen offset:0 lds
    buffer_load_dwordx4 v3, s[8:11], s90 offen offset:1024 lds
    buffer_load_dwordx4 v4, s[8:11], s90 offen offset:2048 lds
    buffer_load_dwordx4 v5, s[8:11], s90 offen offset:3072 lds
    s_mul_i32 s91, s64, 393216
    s_add_u32 s64, s64, 1
    s_and_b32 s64, s64, 15
    s_add_u32 m0, s62, 40960
    s_nop 0
    buffer_load_dwordx4 v6, s[12:15], s91 offen offset:0 lds
    buffer_load_dwordx4 v7, s[12:15], s91 offen offset:1024 lds
    s_add_u32 m0, s62, 49152
    s_nop 0
    buffer_load_dwordx4 v8, s[12:15], s91 offen offset:0 lds
    buffer_load_dwordx4 v9, s[12:15], s91 offen offset:1024 lds
    s_add_u32 m0, s62, 57344
    s_nop 0
    buffer_load_dwordx4 v10, s[12:15], s91 offen offset:0 lds
    buffer_load_dwordx4 v11, s[12:15], s91 offen offset:1024 lds
    buffer_load_dword v39, v38, s[20:23], 0 offen
    s_cmp_lg_u32 s65, 5
    s_cbranch_scc1 L_h0c5
    ds_read_b128 v[40:43], v28 offset:0
    ds_read_b128 v[44:47], v29 offset:1024
    ds_read_b128 v[48:51], v28 offset:2048
    ds_read_b128 v[52:55], v29 offset:3072
    ds_read_b128 v[56:59], v28 offset:4096
    ds_read_b128 v[60:63], v29 offset:5120
    ds_read_b128 v[64:67], v28 offset:6144
    ds_read_b128 v[68:71], v29 offset:7168
L_h0c5:
    s_waitcnt lgkmcnt(0)
    v_pk_add_f32 v[88:89], v[88:89], v[90:91]
    v_pk_add_f32 v[92:93], v[92:93], v[94:95]
    v_add_f32 v88, v88, v89
    v_add_f32 v89, v92, v93
    s_nop 0
    v_add_f32_dpp v88, v88, v88 quad_perm:[1,0,3,2] row_mask:0xf bank_mask:0xf
    v_add_f32_dpp v89, v89, v89 quad_perm:[1,0,3,2] row_mask:0xf bank_mask:0xf
    s_nop 0
    v_mov_b32_dpp v90, v88 quad_perm:[2,2,2,2] row_mask:0xf bank_mask:0xf
    v_mov_b32_dpp v91, v89 quad_perm:[2,2,2,2] row_mask:0xf bank_mask:0xf
    buffer_store_dwordx4 v[88:91], v13, s[16:19], 0 offen sc1
    s_lshl_b32 s86, s48, 7
    s_add_u32 s86, s86, 131072
    v_lshl_add_u32 v16, v23, 3, s86
    v_lshrrev_b32 v17, 5, v0
    v_lshl_add_u32 v16, v17, 2, v16
    s_lshl_b32 s86, s48, 8
    s_add_u32 s86, s86, 132608
    v_lshl_add_u32 v17, v23, 4, s86
    v_lshl_add_u32 v17, v22, 2, v17
    s_waitcnt vmcnt(12)
    s_barrier
    s_add_u32 m0, s53, 81920
    s_lshl_b32 s90, s64, 7
    s_add_u32 s90, s90, s63
    buffer_load_dwordx4 v2, s[8:11], s90 offen offset:0 lds
    buffer_load_dwordx4 v3, s[8:11], s90 offen offset:1024 lds
    buffer_load_dwordx4 v4, s[8:11], s90 offen offset:2048 lds
    buffer_load_dwordx4 v5, s[8:11], s90 offen offset:3072 lds
    s_mul_i32 s91, s64, 393216
    s_add_u32 s64, s64, 1
    s_and_b32 s64, s64, 15
    s_add_u32 m0, s62, 81920
    s_nop 0
    buffer_load_dwordx4 v6, s[12:15], s91 offen offset:0 lds
    buffer_load_dwordx4 v7, s[12:15], s91 offen offset:1024 lds
    s_add_u32 m0, s62, 90112
    s_nop 0
    buffer_load_dwordx4 v8, s[12:15], s91 offen offset:0 lds
    buffer_load_dwordx4 v9, s[12:15], s91 offen offset:1024 lds
    s_add_u32 m0, s62, 98304
    s_nop 0
    buffer_load_dwordx4 v10, s[12:15], s91 offen offset:0 lds
    buffer_load_dwordx4 v11, s[12:15], s91 offen offset:1024 lds
    s_lshr_b32 s90, s67, 2
    s_add_u32 s90, s90, 3
    s_and_b32 s90, s90, 3
    s_mul_i32 s90, s90, 1572864
    buffer_load_dword v39, v37, s[12:15], s90 offen
    s_cmp_lg_u32 s65, 6
    s_cbranch_scc1 L_h0c6
    ds_read_b128 v[40:43], v28 offset:0
    ds_read_b128 v[44:47], v29 offset:1024
    ds_read_b128 v[48:51], v28 offset:2048
    ds_read_b128 v[52:55], v29 offset:3072
    ds_read_b128 v[56:59], v28 offset:4096
    ds_read_b128 v[60:63], v29 offset:5120
    ds_read_b128 v[64:67], v28 offset:6144
    ds_read_b128 v[68:71], v29 offset:7168
L_h0c6:
    s_waitcnt lgkmcnt(0)
    s_waitcnt vmcnt(13)
    s_barrier
    s_add_u32 m0, s53, 0
    s_lshl_b32 s90, s64, 7
    s_add_u32 s90, s90, s63
    buffer_load_dwordx4 v2, s[8:11], s90 offen offset:0 lds
    buffer_load_dwordx4 v3, s[8:11], s90 offen offset:1024 lds
    buffer_load_dwordx4 v4, s[8:11], s90 offen offset:2048 lds
    buffer_load_dwordx4 v5, s[8:11], s90 offen offset:3072 lds
    s_mul_i32 s91, s64, 393216
    s_add_u32 s64, s64, 1
    s_and_b32 s64, s64, 15
    s_add_u32 m0, s62, 0
    s_nop 0
    buffer_load_dwordx4 v6, s[12:15], s91 offen offset:0 lds
    buffer_load_dwordx4 v7, s[12:15], s91 offen offset:1024 lds
    s_add_u32 m0, s62, 8192
    s_nop 0
    buffer_load_dwordx4 v8, s[12:15], s91 offen offset:0 lds
    buffer_load_dwordx4 v9, s[12:15], s91 offen offset:1024 lds
    s_add_u32 m0, s62, 16384
    s_nop 0
    buffer_load_dwordx4 v10, s[12:15], s91 offen offset:0 lds
    buffer_load_dwordx4 v11, s[12:15], s91 offen offset:1024 lds
    s_cmp_lg_u32 s65, 7
    s_cbranch_scc1 L_h0c7
    ds_read_b128 v[40:43], v28 offset:0
    ds_read_b128 v[44:47], v29 offset:1024
    ds_read_b128 v[48:51], v28 offset:2048
    ds_read_b128 v[52:55], v29 offset:3072
    ds_read_b128 v[56:59], v28 offset:4096
    ds_read_b128 v[60:63], v29 offset:5120
    ds_read_b128 v[64:67], v28 offset:6144
    ds_read_b128 v[68:71], v29 offset:7168
L_h0c7:
    s_waitcnt lgkmcnt(0)
    s_waitcnt vmcnt(11)
    s_barrier
    s_add_u32 m0, s53, 40960
    s_lshl_b32 s90, s64, 7
    s_add_u32 s90, s90, s63
    buffer_load_dwordx4 v2, s[8:11], s90 offen offset:0 lds
    buffer_load_dwordx4 v3, s[8:11], s90 offen offset:1024 lds
    buffer_load_dwordx4 v4, s[8:11], s90 offen offset:2048 lds
    buffer_load_dwordx4 v5, s[8:11], s90 offen offset:3072 lds
    s_mul_i32 s91, s64, 393216
    s_add_u32 s64, s64, 1
    s_and_b32 s64, s64, 15
    s_add_u32 m0, s62, 40960
    s_nop 0
    buffer_load_dwordx4 v6, s[12:15], s91 offen offset:0 lds
    buffer_load_dwordx4 v7, s[12:15], s91 offen offset:1024 lds
    s_add_u32 m0, s62, 49152
    s_nop 0
    buffer_load_dwordx4 v8, s[12:15], s91 offen offset:0 lds
    buffer_load_dwordx4 v9, s[12:15], s91 offen offset:1024 lds
    s_add_u32 m0, s62, 57344
    s_nop 0
    buffer_load_dwordx4 v10, s[12:15], s91 offen offset:0 lds
    buffer_load_dwordx4 v11, s[12:15], s91 offen offset:1024 lds
    v_mfma_f32_16x16x32_bf16 v[108:111], v[104:107], v[40:43], 0
    v_mfma_f32_16x16x32_bf16 v[108:111], v[104:107], v[44:47], v[108:111]
    v_mfma_f32_16x16x32_bf16 v[108:111], v[104:107], v[48:51], v[108:111]
    v_mfma_f32_16x16x32_bf16 v[108:111], v[104:107], v[52:55], v[108:111]
    v_mfma_f32_16x16x32_bf16 v[108:111], v[104:107], v[56:59], v[108:111]
    v_mfma_f32_16x16x32_bf16 v[108:111], v[104:107], v[60:63], v[108:111]
    v_mfma_f32_16x16x32_bf16 v[108:111], v[104:107], v[64:67], v[108:111]
    v_mfma_f32_16x16x32_bf16 v[108:111], v[104:107], v[68:71], v[108:111]
    s_nop 7
    v_add_f32_dpp v108, v108, v108 row_ror:8 row_mask:0xf bank_mask:0xf
    v_add_f32_dpp v109, v109, v109 row_ror:8 row_mask:0xf bank_mask:0xf
    v_add_f32_dpp v110, v110, v110 row_ror:8 row_mask:0xf bank_mask:0xf
    v_add_f32_dpp v111, v111, v111 row_ror:8 row_mask:0xf bank_mask:0xf
    buffer_store_dwordx4 v[108:111], v34, s[16:19], 0 offen sc1
    s_waitcnt vmcnt(11)
    s_barrier
    s_add_u32 m0, s53, 81920
    s_lshl_b32 s90, s64, 7
    s_add_u32 s90, s90, s63
    buffer_load_dwordx4 v2, s[8:11], s90 offen offset:0 lds
    buffer_load_dwordx4 v3, s[8:11], s90 offen offset:1024 lds
    buffer_load_dwordx4 v4, s[8:11], s90 offen offset:2048 lds
    buffer_load_dwordx4 v5, s[8:11], s90 offen offset:3072 lds
    s_mul_i32 s91, s64, 393216
    s_add_u32 s64, s64, 1
    s_and_b32 s64, s64, 15
    s_add_u32 m0, s62, 81920
    s_nop 0
    buffer_load_dwordx4 v6, s[12:15], s91 offen offset:0 lds
    buffer_load_dwordx4 v7, s[12:15], s91 offen offset:1024 lds
    s_add_u32 m0, s62, 90112
    s_nop 0
    buffer_load_dwordx4 v8, s[12:15], s91 offen offset:0 lds
    buffer_load_dwordx4 v9, s[12:15], s91 offen offset:1024 lds
    s_add_u32 m0, s62, 98304
    s_nop 0
    buffer_load_dwordx4 v10, s[12:15], s91 offen offset:0 lds
    buffer_load_dwordx4 v11, s[12:15], s91 offen offset:1024 lds
    s_waitcnt vmcnt(10)
    s_barrier
    buffer_atomic_swap v35, v116, s[16:19], 0 offen sc1
    s_add_u32 m0, s53, 0
    s_lshl_b32 s90, s64, 7
    s_add_u32 s90, s90, s63
    buffer_load_dwordx4 v2, s[8:11], s90 offen offset:0 lds
    buffer_load_dwordx4 v3, s[8:11], s90 offen offset:1024 lds
    buffer_load_dwordx4 v4, s[8:11], s90 offen offset:2048 lds
    buffer_load_dwordx4 v5, s[8:11], s90 offen offset:3072 lds
    s_mul_i32 s91, s64, 393216
    s_add_u32 s64, s64, 1
    s_and_b32 s64, s64, 15
    s_add_u32 m0, s62, 0
    s_nop 0
    buffer_load_dwordx4 v6, s[12:15], s91 offen offset:0 lds
    buffer_load_dwordx4 v7, s[12:15], s91 offen offset:1024 lds
    s_add_u32 m0, s62, 8192
    s_nop 0
    buffer_load_dwordx4 v8, s[12:15], s91 offen offset:0 lds
    buffer_load_dwordx4 v9, s[12:15], s91 offen offset:1024 lds
    s_add_u32 m0, s62, 16384
    s_nop 0
    buffer_load_dwordx4 v10, s[12:15], s91 offen offset:0 lds
    buffer_load_dwordx4 v11, s[12:15], s91 offen offset:1024 lds
    s_waitcnt vmcnt(11)
    s_barrier
    s_add_u32 m0, s53, 40960
    s_lshl_b32 s90, s64, 7
    s_add_u32 s90, s90, s63
    buffer_load_dwordx4 v2, s[8:11], s90 offen offset:0 lds
    buffer_load_dwordx4 v3, s[8:11], s90 offen offset:1024 lds
    buffer_load_dwordx4 v4, s[8:11], s90 offen offset:2048 lds
    buffer_load_dwordx4 v5, s[8:11], s90 offen offset:3072 lds
    s_mul_i32 s91, s64, 393216
    s_add_u32 s64, s64, 1
    s_and_b32 s64, s64, 15
    s_add_u32 m0, s62, 40960
    s_nop 0
    buffer_load_dwordx4 v6, s[12:15], s91 offen offset:0 lds
    buffer_load_dwordx4 v7, s[12:15], s91 offen offset:1024 lds
    s_add_u32 m0, s62, 49152
    s_nop 0
    buffer_load_dwordx4 v8, s[12:15], s91 offen offset:0 lds
    buffer_load_dwordx4 v9, s[12:15], s91 offen offset:1024 lds
    s_add_u32 m0, s62, 57344
    s_nop 0
    buffer_load_dwordx4 v10, s[12:15], s91 offen offset:0 lds
    buffer_load_dwordx4 v11, s[12:15], s91 offen offset:1024 lds
    s_waitcnt vmcnt(10)
    s_barrier
    s_add_u32 m0, s53, 81920
    s_lshl_b32 s90, s64, 7
    s_add_u32 s90, s90, s63
    buffer_load_dwordx4 v2, s[8:11], s90 offen offset:0 lds
    buffer_load_dwordx4 v3, s[8:11], s90 offen offset:1024 lds
    buffer_load_dwordx4 v4, s[8:11], s90 offen offset:2048 lds
    buffer_load_dwordx4 v5, s[8:11], s90 offen offset:3072 lds
    s_mul_i32 s91, s64, 393216
    s_add_u32 s64, s64, 1
    s_and_b32 s64, s64, 15
    s_add_u32 m0, s62, 81920
    s_nop 0
    buffer_load_dwordx4 v6, s[12:15], s91 offen offset:0 lds
    buffer_load_dwordx4 v7, s[12:15], s91 offen offset:1024 lds
    s_add_u32 m0, s62, 90112
    s_nop 0
    buffer_load_dwordx4 v8, s[12:15], s91 offen offset:0 lds
    buffer_load_dwordx4 v9, s[12:15], s91 offen offset:1024 lds
    s_add_u32 m0, s62, 98304
    s_nop 0
    buffer_load_dwordx4 v10, s[12:15], s91 offen offset:0 lds
    buffer_load_dwordx4 v11, s[12:15], s91 offen offset:1024 lds
    s_waitcnt vmcnt(10)
    s_barrier
    v_mov_b32 v118, 0
    buffer_atomic_or v118, v117, s[16:19], 0 offen sc0 sc1
    s_add_u32 m0, s53, 0
    s_lshl_b32 s90, s64, 7
    s_add_u32 s90, s90, s63
    buffer_load_dwordx4 v2, s[8:11], s90 offen offset:0 lds
    buffer_load_dwordx4 v3, s[8:11], s90 offen offset:1024 lds
    buffer_load_dwordx4 v4, s[8:11], s90 offen offset:2048 lds
    buffer_load_dwordx4 v5, s[8:11], s90 offen offset:3072 lds
    s_mul_i32 s91, s64, 393216
    s_add_u32 s64, s64, 1
    s_and_b32 s64, s64, 15
    s_add_u32 m0, s62, 0
    s_nop 0
    buffer_load_dwordx4 v6, s[12:15], s91 offen offset:0 lds
    buffer_load_dwordx4 v7, s[12:15], s91 offen offset:1024 lds
    s_add_u32 m0, s62, 8192
    s_nop 0
    buffer_load_dwordx4 v8, s[12:15], s91 offen offset:0 lds
    buffer_load_dwordx4 v9, s[12:15], s91 offen offset:1024 lds
    s_add_u32 m0, s62, 16384
    s_nop 0
    buffer_load_dwordx4 v10, s[12:15], s91 offen offset:0 lds
    buffer_load_dwordx4 v11, s[12:15], s91 offen offset:1024 lds
    s_waitcnt vmcnt(11)
    s_barrier
    s_waitcnt vmcnt(10)
    s_branch L_h0_chk0
L_h0_spin:
    v_mov_b32 v118, 0
    buffer_atomic_or v118, v117, s[16:19], 0 offen sc0 sc1
    s_waitcnt vmcnt(0)
L_h0_chk0:
    v_cmp_ne_u32 vcc, s68, v118
    s_nop 0
    s_and_b64 vcc, vcc, s[76:77]
    s_cbranch_vccz L_ok_1
    s_sub_u32 s56, s56, 1
    s_cbranch_scc0 L_h0_spin
    s_mov_b32 s56, 0
L_ok_1:
    s_mov_b32 s90, 0
    buffer_load_dwordx4 v[40:43], v32, s[16:19], s90 offen sc1
    s_mov_b32 s90, 3072
    buffer_load_dwordx4 v[44:47], v32, s[16:19], s90 offen sc1
    s_mov_b32 s90, 6144
    buffer_load_dwordx4 v[48:51], v32, s[16:19], s90 offen sc1
    s_mov_b32 s90, 9216
    buffer_load_dwordx4 v[52:55], v32, s[16:19], s90 offen sc1
    buffer_load_dwordx4 v[56:59], v33, s[16:19], 0 offen sc1
    buffer_load_dwordx4 v[60:63], v33, s[16:19], s92 offen sc1
    buffer_load_dwordx4 v[64:67], v33, s[16:19], s93 offen sc1
    buffer_load_dwordx4 v[68:71], v33, s[16:19], s94 offen sc1
    s_waitcnt vmcnt(8)
    s_barrier
    s_add_u32 m0, s89, 40960
    s_mov_b32 s90, 655360
    buffer_load_dwordx4 v12, s[20:23], s90 offen lds
    s_add_u32 m0, s89, 45056
    s_mov_b32 s90, 720896
    buffer_load_dwordx4 v12, s[20:23], s90 offen lds
    s_add_u32 m0, s89, 49152
    s_mov_b32 s90, 786432
    buffer_load_dwordx4 v12, s[20:23], s90 offen lds
    s_add_u32 m0, s89, 53248
    s_mov_b32 s90, 851968
    buffer_load_dwordx4 v12, s[20:23], s90 offen lds
    s_add_u32 m0, s89, 57344
    s_mov_b32 s90, 917504
    buffer_load_dwordx4 v12, s[20:23], s90 offen lds
    s_add_u32 m0, s89, 61440
    s_mov_b32 s90, 983040
    buffer_load_dwordx4 v12, s[20:23], s90 offen lds
    s_add_u32 m0, s89, 65536
    s_mov_b32 s90, 1048576
    buffer_load_dwordx4 v12, s[20:23], s90 offen lds
    s_add_u32 m0, s89, 69632
    s_mov_b32 s90, 1114112
    buffer_load_dwordx4 v12, s[20:23], s90 offen lds
    s_add_u32 m0, s89, 73728
    s_mov_b32 s90, 1179648
    buffer_load_dwordx4 v12, s[20:23], s90 offen lds
    s_add_u32 m0, s89, 77824
    s_mov_b32 s90, 1245184
    buffer_load_dwordx4 v12, s[20:23], s90 offen lds
    s_waitcnt vmcnt(10)
    v_add_f32 v40, v40, v44
    v_add_f32 v41, v41, v45
    v_add_f32 v42, v42, v46
    v_add_f32 v43, v43, v47
    v_add_f32 v40, v40, v48
    v_add_f32 v41, v41, v49
    v_add_f32 v42, v42, v50
    v_add_f32 v43, v43, v51
    v_add_f32 v40, v40, v52
    v_add_f32 v41, v41, v53
    v_add_f32 v42, v42, v54
    v_add_f32 v43, v43, v55
    v_add_f32 v56, v56, v60
    v_add_f32 v57, v57, v61
    v_add_f32 v58, v58, v62
    v_add_f32 v59, v59, v63
    v_add_f32 v56, v56, v64
    v_add_f32 v57, v57, v65
    v_add_f32 v58, v58, v66
    v_add_f32 v59, v59, v67
    v_add_f32 v56, v56, v68
    v_add_f32 v57, v57, v69
    v_add_f32 v58, v58, v70
    v_add_f32 v59, v59, v71
    s_nop 0
    v_permlane32_swap_b32 v56, v58
    v_permlane32_swap_b32 v57, v59
    v_permlane32_swap_b32 v40, v42
    v_permlane32_swap_b32 v41, v43
    v_add_f32 v56, v56, v58
    v_add_f32 v57, v57, v59
    v_add_f32 v40, v40, v42
    v_add_f32 v41, v41, v43
    v_mov_b32 v58, v56
    v_mov_b32 v59, v57
    v_permlane16_swap_b32 v40, v41
    v_permlane16_swap_b32 v56, v58
    v_permlane16_swap_b32 v57, v59
    v_add_f32 v40, v40, v41
    v_add_f32 v56, v56, v58
    v_add_f32 v57, v57, v59
    ds_write_b32 v17, v40
    v_mul_f32 v56, 0x3a800000, v56
    v_mul_f32 v57, 0x3a800000, v57
    v_fma_f32 v57, -v56, v56, v57
    v_max_f32 v57, 0, v57
    v_cvt_pk_bf16_f32 v48, v56, v57
    v_lshlrev_b32 v44, 16, v48
    v_and_b32 v48, 0xffff0000, v48
    v_add_f32 v48, 0x3727c5ac, v48
    v_cvt_pk_bf16_f32 v48, v48, v48
    v_lshlrev_b32 v48, 16, v48
    v_sqrt_f32 v48, v48
    s_nop 0
    v_cvt_pk_bf16_f32 v48, v48, v48
    v_lshlrev_b32 v48, 16, v48
    v_rcp_f32 v46, v48
    v_sub_f32 v44, 0, v44
    v_mul_f32 v48, 0x3fb8aa3b, v46
    ds_write_b32 v16, v44
    ds_write_b32 v16, v46 offset:512
    ds_write_b32 v16, v48 offset:1024
    s_waitcnt lgkmcnt(0)
    s_barrier
    s_setprio 0
    s_add_u32 m0, s89, 81920
    s_mov_b32 s90, 1310720
    buffer_load_dwordx4 v12, s[20:23], s90 offen lds
    s_add_u32 m0, s89, 86016
    s_mov_b32 s90, 1376256
    buffer_load_dwordx4 v12, s[20:23], s90 offen lds
    s_add_u32 m0, s89, 90112
    s_mov_b32 s90, 1441792
    buffer_load_dwordx4 v12, s[20:23], s90 offen lds
    s_add_u32 m0, s89, 94208
    s_mov_b32 s90, 1507328
    buffer_load_dwordx4 v12, s[20:23], s90 offen lds
    s_add_u32 m0, s89, 98304
    s_mov_b32 s90, 1572864
    buffer_load_dwordx4 v12, s[20:23], s90 offen lds
    s_add_u32 m0, s89, 102400
    s_mov_b32 s90, 1638400
    buffer_load_dwordx4 v12, s[20:23], s90 offen lds
    s_add_u32 m0, s89, 106496
    s_mov_b32 s90, 1703936
    buffer_load_dwordx4 v12, s[20:23], s90 offen lds
    s_add_u32 m0, s89, 110592
    s_mov_b32 s90, 1769472
    buffer_load_dwordx4 v12, s[20:23], s90 offen lds
    s_add_u32 m0, s89, 114688
    s_mov_b32 s90, 1835008
    buffer_load_dwordx4 v12, s[20:23], s90 offen lds
    s_add_u32 m0, s89, 118784
    s_mov_b32 s90, 1900544
    buffer_load_dwordx4 v12, s[20:23], s90 offen lds
    s_add_u32 m0, s89, 122880
    s_mov_b32 s90, 1966080
    buffer_load_dwordx4 v12, s[20:23], s90 offen lds
    s_add_u32 m0, s89, 126976
    s_mov_b32 s90, 2031616
    buffer_load_dwordx4 v12, s[20:23], s90 offen lds
    s_add_u32 m0, s89, 0
    s_mov_b32 s90, 0
    buffer_load_dwordx4 v12, s[20:23], s90 offen lds
    s_add_u32 m0, s89, 4096
    s_mov_b32 s90, 65536
    buffer_load_dwordx4 v12, s[20:23], s90 offen lds
    s_add_u32 m0, s89, 8192
    s_mov_b32 s90, 131072
    buffer_load_dwordx4 v12, s[20:23], s90 offen lds
    s_add_u32 m0, s89, 12288
    s_mov_b32 s90, 196608
    buffer_load_dwordx4 v12, s[20:23], s90 offen lds
    s_add_u32 m0, s89, 16384
    s_mov_b32 s90, 262144
    buffer_load_dwordx4 v12, s[20:23], s90 offen lds
    s_add_u32 m0, s89, 20480
    s_mov_b32 s90, 327680
    buffer_load_dwordx4 v12, s[20:23], s90 offen lds
    s_add_u32 m0, s89, 24576
    s_mov_b32 s90, 393216
    buffer_load_dwordx4 v12, s[20:23], s90 offen lds
    s_add_u32 m0, s89, 28672
    s_mov_b32 s90, 458752
    buffer_load_dwordx4 v12, s[20:23], s90 offen lds
    s_add_u32 m0, s89, 32768
    s_mov_b32 s90, 524288
    buffer_load_dwordx4 v12, s[20:23], s90 offen lds
    s_add_u32 m0, s89, 36864
    s_mov_b32 s90, 589824
    buffer_load_dwordx4 v12, s[20:23], s90 offen lds
    s_lshl_b32 s86, s47, 2
    s_add_u32 s86, s86, s48
    s_lshl_b32 s87, s86, 7
    s_add_u32 s87, s87, 671744
    v_lshl_add_u32 v6, v0, 2, s87
    v_mov_b32 v4, 2147483648
    v_cmp_gt_u32 vcc, 16, v0
    s_nop 1
    v_cndmask_b32 v6, v4, v6, vcc
    s_lshl_b32 s86, s86, 14
    s_add_u32 s86, s86, 5242880
    v_lshl_add_u32 v2, v0, 4, s86
    s_lshl_b32 s86, s47, 1
    s_add_u32 s86, s86, s50
    s_lshl_b32 s86, s86, 11
    s_lshl_b32 s87, s49, 6
    s_add_u32 s86, s86, s87
    s_add_u32 s86, s86, 6881280
    v_lshl_add_u32 v3, v23, 7, s86
    v_lshl_add_u32 v3, v22, 4, v3
    v_mov_b32 v112, 0
    v_mov_b32 v113, 0
    v_mov_b32 v114, 0
    v_mov_b32 v115, 0
    v_mov_b32 v116, 0
    v_mov_b32 v117, 0
    v_mov_b32 v118, 0
    v_mov_b32 v119, 0
    s_lshr_b32 s62, s3, 2
    s_lshl_b32 s53, s51, 3
    s_lshl_b32 s86, s48, 1
    s_add_u32 s53, s53, s86
    s_add_u32 s53, s53, s62
    v_lshrrev_b32 v36, 4, v0
    v_and_b32 v37, 15, v0
    s_lshl_b32 s87, s53, 15
    s_lshl_b32 s86, s62, 14
    s_add_u32 s86, s86, s87
    s_add_u32 s86, s86, 1048576
    v_lshl_add_u32 v157, v0, 4, s86
    v_xor_b32 v158, 0x8000, v157
    s_lshl_b32 s86, s51, 1
    s_lshr_b32 s87, s48, 1
    s_add_u32 s86, s86, s87
    s_lshl_b32 s86, s86, 1
    s_add_u32 s86, s86, s62
    s_lshl_b32 s86, s86, 1
    s_and_b32 s87, s48, 1
    s_add_u32 s86, s86, s87
    s_lshl_b32 s86, s86, 7
    s_add_u32 s86, s86, 688128
    v_lshl_add_u32 v159, v0, 2, s86
    v_mov_b32 v38, 2147483648
    v_cmp_gt_u32 vcc, 16, v0
    s_nop 1
    v_cndmask_b32 v159, v38, v159, vcc
    v_bfe_u32 v38, v0, 2, 2
    v_lshl_add_u32 v38, v36, 2, v38
    v_bfe_u32 v39, v38, 1, 2
    v_lshlrev_b32 v38, 7, v38
    v_lshl_add_u32 v38, v39, 5, v38
    v_and_b32 v39, 3, v0
    v_lshl_add_u32 v38, v39, 3, v38
    s_lshl_b32 s86, s62, 16
    s_add_u32 s86, s86, 0
    v_add_u32 v144, s86, v38
    v_xor_b32 v145, 32, v144
    v_xor_b32 v146, 64, v144
    v_xor_b32 v147, 96, v144
    v_cmp_eq_u32 s[4:5], 1, v39
    v_cmp_eq_u32 s[6:7], 2, v39
    v_cmp_eq_u32 s[98:99], 3, v39
    s_lshl_b32 s86, s53, 8
    s_add_u32 s86, s86, 589824
    v_lshl_add_u32 v160, v0, 2, s86
    s_mov_b32 s72, 0x00f0000f
    s_mov_b32 s73, 0xf0000f00
    s_mov_b32 s74, 0x0f00f000
    s_mov_b32 s75, 0x0f00f000
    v_lshrrev_b32 v38, 2, v37
    v_lshl_add_u32 v161, v38, 4, v37
    v_lshlrev_b32 v161, 2, v161
    s_lshl_b32 s86, s3, 12
    s_add_u32 s86, s86, 131072
    v_lshl_add_u32 v162, v0, 4, s86
    v_xor_b32 v163, 0x4000, v162
    s_lshl_b32 s86, s52, 7
    v_lshl_add_u32 v36, v36, 3, s86
    s_lshl_b32 s87, s53, 15
    s_add_u32 s87, s87, s86
    s_lshl_b32 s86, s62, 6
    s_add_u32 s87, s87, s86
    v_lshl_add_u32 v39, v37, 11, s87
    v_and_b32 v38, 48, v0
    v_add_u32 v39, v39, v38
    v_xor_b32 v37, 0x8000, v39
    v_lshlrev_b32 v38, 4, v0
    buffer_load_dwordx2 v[148:149], v36, s[40:43], 0 offen offset:0
    buffer_load_dwordx2 v[150:151], v36, s[40:43], 0 offen offset:32
    buffer_load_dwordx2 v[152:153], v36, s[40:43], 0 offen offset:64
    buffer_load_dwordx2 v[154:155], v36, s[40:43], 0 offen offset:96
    buffer_load_dwordx4 v[128:131], v38, s[40:43], 0 offen
    buffer_load_dwordx4 v[132:135], v38, s[40:43], 0 offen offset:1024
    buffer_load_dwordx4 v[136:139], v39, s[8:11], 0 offen
    buffer_load_dwordx4 v[140:143], v37, s[8:11], 0 offen
    s_mov_b32 s90, 0
    buffer_load_dwordx4 v[164:167], v30, s[32:35], s90 offen
    s_mov_b32 s90, 7168
    buffer_load_dwordx4 v[168:171], v30, s[32:35], s90 offen
    s_mov_b32 s90, 14336
    buffer_load_dwordx4 v[172:175], v30, s[32:35], s90 offen
    s_waitcnt vmcnt(5)
    v_mov_b32 v4, 0
    buffer_atomic_or v4, v6, s[16:19], 0 offen sc0 sc1
    v_bfe_u32 v36, v0, 2, 1
    v_cmp_eq_u32 vcc, 1, v36
    v_mov_b32 v36, s95
    v_mov_b32 v38, 0
    v_dot2c_f32_bf16 v38, s95, v128
    v_dot2c_f32_bf16 v38, s95, v129
    v_dot2c_f32_bf16 v38, s95, v130
    v_dot2c_f32_bf16 v38, s95, v131
    v_dot2c_f32_bf16 v38, s95, v132
    v_dot2c_f32_bf16 v38, s95, v133
    v_dot2c_f32_bf16 v38, s95, v134
    v_dot2c_f32_bf16 v38, s95, v135
    v_cndmask_b32 v148, v36, v148, vcc
    v_cndmask_b32 v149, v36, v149, vcc
    v_cndmask_b32 v150, v36, v150, vcc
    v_cndmask_b32 v151, v36, v151, vcc
    v_cndmask_b32 v152, v36, v152, vcc
    v_cndmask_b32 v153, v36, v153, vcc
    v_cndmask_b32 v154, v36, v154, vcc
    v_cndmask_b32 v155, v36, v155, vcc
    v_add_f32_dpp v38, v38, v38 row_ror:8 row_mask:0xf bank_mask:0xf
    s_nop 1
    v_add_f32_dpp v38, v38, v38 row_ror:4 row_mask:0xf bank_mask:0xf
    s_nop 1
    v_add_f32_dpp v38, v38, v38 row_ror:2 row_mask:0xf bank_mask:0xf
    s_nop 1
    v_add_f32_dpp v38, v38, v38 row_ror:1 row_mask:0xf bank_mask:0xf
    v_mov_b32 v36, v38
    s_nop 1
    v_permlane32_swap_b32 v38, v36
    v_add_f32 v38, v38, v36
    v_mov_b32 v36, v38
    s_nop 1
    v_permlane16_swap_b32 v38, v36
    v_add_f32 v38, v38, v36
    v_mov_b32 v36, 135200
    v_readfirstlane_b32 s57, v38
    ds_write_b32 v36, v38
    s_mul_i32 s86, s50, 3072
    s_add_u32 s86, s86, 151552
    v_lshl_add_u32 v7, v0, 4, s86
    s_lshl_b32 s86, s49, 10
    v_add_u32 v5, s86, v7
    s_lshl_b32 s86, s49, 3
    v_add_u32 v7, s86, v7
    s_mov_b32 s88, 0xffff0000
    s_mov_b32 s86, 0x00003f80
    s_mov_b32 s87, 0x3f800000
    s_branch L_h1_w0
L_h1_r0:
    s_ff1_i32_b32 s66, s65
    s_bitset0_b32 s65, s66
    s_lshl_b32 s66, s66, 10
    buffer_load_dwordx4 v[40:43], v2, s[16:19], s66 offen sc1
    s_cmp_eq_u32 s65, 0
    s_cbranch_scc1 L_h1_p1
L_h1_r1:
    s_ff1_i32_b32 s66, s65
    s_bitset0_b32 s65, s66
    s_lshl_b32 s66, s66, 10
    buffer_load_dwordx4 v[44:47], v2, s[16:19], s66 offen sc1
    s_cmp_eq_u32 s65, 0
    s_cbranch_scc1 L_h1_p2
L_h1_r2:
    s_ff1_i32_b32 s66, s65
    s_bitset0_b32 s65, s66
    s_lshl_b32 s66, s66, 10
    buffer_load_dwordx4 v[48:51], v2, s[16:19], s66 offen sc1
    s_cmp_eq_u32 s65, 0
    s_cbranch_scc1 L_h1_p3
L_h1_r3:
    s_ff1_i32_b32 s66, s65
    s_bitset0_b32 s65, s66
    s_lshl_b32 s66, s66, 10
    buffer_load_dwordx4 v[52:55], v2, s[16:19], s66 offen sc1
    s_cmp_eq_u32 s65, 0
    s_cbranch_scc1 L_h1_p4
L_h1_r4:
    s_ff1_i32_b32 s66, s65
    s_bitset0_b32 s65, s66
    s_lshl_b32 s66, s66, 10
    buffer_load_dwordx4 v[56:59], v2, s[16:19], s66 offen sc1
    s_cmp_eq_u32 s65, 0
    s_cbranch_scc1 L_h1_p5
L_h1_r5:
    s_ff1_i32_b32 s66, s65
    s_bitset0_b32 s65, s66
    s_lshl_b32 s66, s66, 10
    buffer_load_dwordx4 v[60:63], v2, s[16:19], s66 offen sc1
    s_cmp_eq_u32 s65, 0
    s_cbranch_scc1 L_h1_p6
L_h1_r6:
    s_ff1_i32_b32 s66, s65
    s_bitset0_b32 s65, s66
    s_lshl_b32 s66, s66, 10
    buffer_load_dwordx4 v[64:67], v2, s[16:19], s66 offen sc1
    s_cmp_eq_u32 s65, 0
    s_cbranch_scc1 L_h1_p7
L_h1_r7:
    s_ff1_i32_b32 s66, s65
    s_bitset0_b32 s65, s66
    s_lshl_b32 s66, s66, 10
    buffer_load_dwordx4 v[68:71], v2, s[16:19], s66 offen sc1
    s_cmp_eq_u32 s65, 0
    s_cbranch_scc1 L_h1_p8
L_h1_r8:
    s_ff1_i32_b32 s66, s65
    s_bitset0_b32 s65, s66
    s_lshl_b32 s66, s66, 10
    buffer_load_dwordx4 v[72:75], v2, s[16:19], s66 offen sc1
    s_cmp_eq_u32 s65, 0
    s_cbranch_scc1 L_h1_p9
L_h1_r9:
    s_ff1_i32_b32 s66, s65
    s_bitset0_b32 s65, s66
    s_lshl_b32 s66, s66, 10
    buffer_load_dwordx4 v[76:79], v2, s[16:19], s66 offen sc1
    s_cmp_eq_u32 s65, 0
    s_cbranch_scc1 L_h1_p10
L_h1_r10:
    s_ff1_i32_b32 s66, s65
    s_bitset0_b32 s65, s66
    s_lshl_b32 s66, s66, 10
    buffer_load_dwordx4 v[80:83], v2, s[16:19], s66 offen sc1
    s_cmp_eq_u32 s65, 0
    s_cbranch_scc1 L_h1_p11
L_h1_r11:
    s_ff1_i32_b32 s66, s65
    s_bitset0_b32 s65, s66
    s_lshl_b32 s66, s66, 10
    buffer_load_dwordx4 v[84:87], v2, s[16:19], s66 offen sc1
    s_cmp_eq_u32 s65, 0
    s_cbranch_scc1 L_h1_p12
L_h1_r12:
    s_ff1_i32_b32 s66, s65
    s_bitset0_b32 s65, s66
    s_lshl_b32 s66, s66, 10
    buffer_load_dwordx4 v[88:91], v2, s[16:19], s66 offen sc1
    s_cmp_eq_u32 s65, 0
    s_cbranch_scc1 L_h1_p13
L_h1_r13:
    s_ff1_i32_b32 s66, s65
    s_bitset0_b32 s65, s66
    s_lshl_b32 s66, s66, 10
    buffer_load_dwordx4 v[92:95], v2, s[16:19], s66 offen sc1
    s_cmp_eq_u32 s65, 0
    s_cbranch_scc1 L_h1_p14
L_h1_r14:
    s_ff1_i32_b32 s66, s65
    s_bitset0_b32 s65, s66
    s_lshl_b32 s66, s66, 10
    buffer_load_dwordx4 v[96:99], v2, s[16:19], s66 offen sc1
    s_cmp_eq_u32 s65, 0
    s_cbranch_scc1 L_h1_p15
L_h1_r15:
    s_ff1_i32_b32 s66, s65
    s_bitset0_b32 s65, s66
    s_lshl_b32 s66, s66, 10
    buffer_load_dwordx4 v[100:103], v2, s[16:19], s66 offen sc1
    buffer_load_dwordx4 v[104:107], v3, s[16:19], 0 offen sc1
L_h1_acc:
    s_waitcnt vmcnt(16)
    v_dot2c_f32_bf16 v112, s86, v40
    v_dot2c_f32_bf16 v113, s87, v40
    v_dot2c_f32_bf16 v114, s86, v41
    v_dot2c_f32_bf16 v115, s87, v41
    v_dot2c_f32_bf16 v116, s86, v42
    v_dot2c_f32_bf16 v117, s87, v42
    v_dot2c_f32_bf16 v118, s86, v43
    v_dot2c_f32_bf16 v119, s87, v43
    s_waitcnt vmcnt(15)
    v_dot2c_f32_bf16 v112, s86, v44
    v_dot2c_f32_bf16 v113, s87, v44
    v_dot2c_f32_bf16 v114, s86, v45
    v_dot2c_f32_bf16 v115, s87, v45
    v_dot2c_f32_bf16 v116, s86, v46
    v_dot2c_f32_bf16 v117, s87, v46
    v_dot2c_f32_bf16 v118, s86, v47
    v_dot2c_f32_bf16 v119, s87, v47
    s_waitcnt vmcnt(14)
    v_dot2c_f32_bf16 v112, s86, v48
    v_dot2c_f32_bf16 v113, s87, v48
    v_dot2c_f32_bf16 v114, s86, v49
    v_dot2c_f32_bf16 v115, s87, v49
    v_dot2c_f32_bf16 v116, s86, v50
    v_dot2c_f32_bf16 v117, s87, v50
    v_dot2c_f32_bf16 v118, s86, v51
    v_dot2c_f32_bf16 v119, s87, v51
    v_max3_u32 v4, v43, v47, v51
    s_waitcnt vmcnt(13)
    v_dot2c_f32_bf16 v112, s86, v52
    v_dot2c_f32_bf16 v113, s87, v52
    v_dot2c_f32_bf16 v114, s86, v53
    v_dot2c_f32_bf16 v115, s87, v53
    v_dot2c_f32_bf16 v116, s86, v54
    v_dot2c_f32_bf16 v117, s87, v54
    v_dot2c_f32_bf16 v118, s86, v55
    v_dot2c_f32_bf16 v119, s87, v55
    s_waitcnt vmcnt(12)
    v_dot2c_f32_bf16 v112, s86, v56
    v_dot2c_f32_bf16 v113, s87, v56
    v_dot2c_f32_bf16 v114, s86, v57
    v_dot2c_f32_bf16 v115, s87, v57
    v_dot2c_f32_bf16 v116, s86, v58
    v_dot2c_f32_bf16 v117, s87, v58
    v_dot2c_f32_bf16 v118, s86, v59
    v_dot2c_f32_bf16 v119, s87, v59
    v_max3_u32 v4, v4, v55, v59
    s_waitcnt vmcnt(11)
    v_dot2c_f32_bf16 v112, s86, v60
    v_dot2c_f32_bf16 v113, s87, v60
    v_dot2c_f32_bf16 v114, s86, v61
    v_dot2c_f32_bf16 v115, s87, v61
    v_dot2c_f32_bf16 v116, s86, v62
    v_dot2c_f32_bf16 v117, s87, v62
    v_dot2c_f32_bf16 v118, s86, v63
    v_dot2c_f32_bf16 v119, s87, v63
    s_waitcnt vmcnt(10)
    v_dot2c_f32_bf16 v112, s86, v64
    v_dot2c_f32_bf16 v113, s87, v64
    v_dot2c_f32_bf16 v114, s86, v65
    v_dot2c_f32_bf16 v115, s87, v65
    v_dot2c_f32_bf16 v116, s86, v66
    v_dot2c_f32_bf16 v117, s87, v66
    v_dot2c_f32_bf16 v118, s86, v67
    v_dot2c_f32_bf16 v119, s87, v67
    v_max3_u32 v4, v4, v63, v67
    s_waitcnt vmcnt(9)
    v_dot2c_f32_bf16 v112, s86, v68
    v_dot2c_f32_bf16 v113, s87, v68
    v_dot2c_f32_bf16 v114, s86, v69
    v_dot2c_f32_bf16 v115, s87, v69
    v_dot2c_f32_bf16 v116, s86, v70
    v_dot2c_f32_bf16 v117, s87, v70
    v_dot2c_f32_bf16 v118, s86, v71
    v_dot2c_f32_bf16 v119, s87, v71
    s_waitcnt vmcnt(8)
    v_dot2c_f32_bf16 v112, s86, v72
    v_dot2c_f32_bf16 v113, s87, v72
    v_dot2c_f32_bf16 v114, s86, v73
    v_dot2c_f32_bf16 v115, s87, v73
    v_dot2c_f32_bf16 v116, s86, v74
    v_dot2c_f32_bf16 v117, s87, v74
    v_dot2c_f32_bf16 v118, s86, v75
    v_dot2c_f32_bf16 v119, s87, v75
    v_max3_u32 v4, v4, v71, v75
    s_waitcnt vmcnt(7)
    v_dot2c_f32_bf16 v112, s86, v76
    v_dot2c_f32_bf16 v113, s87, v76
    v_dot2c_f32_bf16 v114, s86, v77
    v_dot2c_f32_bf16 v115, s87, v77
    v_dot2c_f32_bf16 v116, s86, v78
    v_dot2c_f32_bf16 v117, s87, v78
    v_dot2c_f32_bf16 v118, s86, v79
    v_dot2c_f32_bf16 v119, s87, v79
    s_waitcnt vmcnt(6)
    v_dot2c_f32_bf16 v112, s86, v80
    v_dot2c_f32_bf16 v113, s87, v80
    v_dot2c_f32_bf16 v114, s86, v81
    v_dot2c_f32_bf16 v115, s87, v81
    v_dot2c_f32_bf16 v116, s86, v82
    v_dot2c_f32_bf16 v117, s87, v82
    v_dot2c_f32_bf16 v118, s86, v83
    v_dot2c_f32_bf16 v119, s87, v83
    v_max3_u32 v4, v4, v79, v83
    s_waitcnt vmcnt(5)
    v_dot2c_f32_bf16 v112, s86, v84
    v_dot2c_f32_bf16 v113, s87, v84
    v_dot2c_f32_bf16 v114, s86, v85
    v_dot2c_f32_bf16 v115, s87, v85
    v_dot2c_f32_bf16 v116, s86, v86
    v_dot2c_f32_bf16 v117, s87, v86
    v_dot2c_f32_bf16 v118, s86, v87
    v_dot2c_f32_bf16 v119, s87, v87
    s_waitcnt vmcnt(4)
    v_dot2c_f32_bf16 v112, s86, v88
    v_dot2c_f32_bf16 v113, s87, v88
    v_dot2c_f32_bf16 v114, s86, v89
    v_dot2c_f32_bf16 v115, s87, v89
    v_dot2c_f32_bf16 v116, s86, v90
    v_dot2c_f32_bf16 v117, s87, v90
    v_dot2c_f32_bf16 v118, s86, v91
    v_dot2c_f32_bf16 v119, s87, v91
    v_max3_u32 v4, v4, v87, v91
    s_waitcnt vmcnt(3)
    v_dot2c_f32_bf16 v112, s86, v92
    v_dot2c_f32_bf16 v113, s87, v92
    v_dot2c_f32_bf16 v114, s86, v93
    v_dot2c_f32_bf16 v115, s87, v93
    v_dot2c_f32_bf16 v116, s86, v94
    v_dot2c_f32_bf16 v117, s87, v94
    v_dot2c_f32_bf16 v118, s86, v95
    v_dot2c_f32_bf16 v119, s87, v95
    s_waitcnt vmcnt(2)
    v_dot2c_f32_bf16 v112, s86, v96
    v_dot2c_f32_bf16 v113, s87, v96
    v_dot2c_f32_bf16 v114, s86, v97
    v_dot2c_f32_bf16 v115, s87, v97
    v_dot2c_f32_bf16 v116, s86, v98
    v_dot2c_f32_bf16 v117, s87, v98
    v_dot2c_f32_bf16 v118, s86, v99
    v_dot2c_f32_bf16 v119, s87, v99
    v_max3_u32 v4, v4, v95, v99
    s_waitcnt vmcnt(1)
    v_dot2c_f32_bf16 v112, s86, v100
    v_dot2c_f32_bf16 v113, s87, v100
    v_dot2c_f32_bf16 v114, s86, v101
    v_dot2c_f32_bf16 v115, s87, v101
    v_dot2c_f32_bf16 v116, s86, v102
    v_dot2c_f32_bf16 v117, s87, v102
    v_dot2c_f32_bf16 v118, s86, v103
    v_dot2c_f32_bf16 v119, s87, v103
    s_waitcnt vmcnt(0)
    v_max3_u32 v4, v4, v103, v107
    v_add_f32_dpp v104, v104, v104 row_ror:8 row_mask:0xf bank_mask:0xf
    v_add_f32_dpp v105, v105, v105 row_ror:8 row_mask:0xf bank_mask:0xf
    v_add_f32_dpp v106, v106, v106 row_ror:8 row_mask:0xf bank_mask:0xf
    v_add_f32_dpp v107, v107, v107 row_ror:8 row_mask:0xf bank_mask:0xf
    v_cvt_pk_bf16_f32 v120, v112, v113
    v_cvt_pk_bf16_f32 v121, v114, v115
    v_cvt_pk_bf16_f32 v122, v116, v117
    v_cvt_pk_bf16_f32 v123, v118, v119
    ds_write_b128 v5, v[120:123]
    v_add_f32_dpp v104, v104, v104 row_ror:4 row_mask:0xf bank_mask:0xf
    v_add_f32_dpp v105, v105, v105 row_ror:4 row_mask:0xf bank_mask:0xf
    v_add_f32_dpp v106, v106, v106 row_ror:4 row_mask:0xf bank_mask:0xf
    v_add_f32_dpp v107, v107, v107 row_ror:4 row_mask:0xf bank_mask:0xf
    v_add_f32_dpp v104, v104, v104 row_ror:2 row_mask:0xf bank_mask:0xf
    v_add_f32_dpp v105, v105, v105 row_ror:2 row_mask:0xf bank_mask:0xf
    v_add_f32_dpp v106, v106, v106 row_ror:2 row_mask:0xf bank_mask:0xf
    v_add_f32_dpp v107, v107, v107 row_ror:2 row_mask:0xf bank_mask:0xf
    v_add_f32_dpp v104, v104, v104 row_ror:1 row_mask:0xf bank_mask:0xf
    v_add_f32_dpp v105, v105, v105 row_ror:1 row_mask:0xf bank_mask:0xf
    v_add_f32_dpp v106, v106, v106 row_ror:1 row_mask:0xf bank_mask:0xf
    v_add_f32_dpp v107, v107, v107 row_ror:1 row_mask:0xf bank_mask:0xf
    v_cmp_eq_u32 vcc, -1, v4
    v_cvt_pk_bf16_f32 v124, v104, v105
    v_cvt_pk_bf16_f32 v125, v106, v107
    ds_write_b64 v7, v[124:125] offset:2048
    s_cbranch_vccnz L_h1_again
L_h1_done:
    s_waitcnt lgkmcnt(0)
    s_barrier
    s_or_b32 s86, s2, s48
    s_cmp_eq_u32 s86, 0
    s_cselect_b32 s86, 0, 2147483648
    s_add_u32 s86, s86, 524288
    v_mov_b32 v6, s86
    buffer_store_dword v35, v6, s[16:19], 0 offen sc1
    v_mov_b32 v11, v30
    v_mov_b32 v14, v31
    v_mov_b32 v8, 0
    buffer_atomic_or v8, v159, s[16:19], 0 offen sc0 sc1
    s_branch L_phaseB
L_h1_p0:
    v_mov_b32 v4, 0
    buffer_atomic_or v4, v6, s[16:19], 0 offen sc0 sc1
L_h1_w0:
    s_waitcnt vmcnt(0)
    v_cmp_eq_u32 vcc, s68, v4
    s_nop 0
    s_andn2_b32 s65, vcc_lo, s88
    s_or_b32 s88, s88, s65
    s_cmp_lg_u32 s65, 0
    s_cbranch_scc1 L_h1_r0
    s_sub_u32 s56, s56, 1
    s_cbranch_scc0 L_h1_p0
    s_mov_b32 s56, 0
    s_not_b32 s65, s88
    s_branch L_h1_r0
L_h1_p1:
    v_mov_b32 v4, 0
    buffer_atomic_or v4, v6, s[16:19], 0 offen sc0 sc1
    s_waitcnt vmcnt(0)
    v_cmp_eq_u32 vcc, s68, v4
    s_nop 0
    s_andn2_b32 s65, vcc_lo, s88
    s_or_b32 s88, s88, s65
    s_cmp_lg_u32 s65, 0
    s_cbranch_scc1 L_h1_r1
    s_sub_u32 s56, s56, 1
    s_cbranch_scc0 L_h1_p1
    s_mov_b32 s56, 0
    s_not_b32 s65, s88
    s_branch L_h1_r1
L_h1_p2:
    v_mov_b32 v4, 0
    buffer_atomic_or v4, v6, s[16:19], 0 offen sc0 sc1
    s_waitcnt vmcnt(0)
    v_cmp_eq_u32 vcc, s68, v4
    s_nop 0
    s_andn2_b32 s65, vcc_lo, s88
    s_or_b32 s88, s88, s65
    s_cmp_lg_u32 s65, 0
    s_cbranch_scc1 L_h1_r2
    s_sub_u32 s56, s56, 1
    s_cbranch_scc0 L_h1_p2
    s_mov_b32 s56, 0
    s_not_b32 s65, s88
    s_branch L_h1_r2
L_h1_p3:
    v_mov_b32 v4, 0
    buffer_atomic_or v4, v6, s[16:19], 0 offen sc0 sc1
    s_waitcnt vmcnt(0)
    v_cmp_eq_u32 vcc, s68, v4
    s_nop 0
    s_andn2_b32 s65, vcc_lo, s88
    s_or_b32 s88, s88, s65
    s_cmp_lg_u32 s65, 0
    s_cbranch_scc1 L_h1_r3
    s_sub_u32 s56, s56, 1
    s_cbranch_scc0 L_h1_p3
    s_mov_b32 s56, 0
    s_not_b32 s65, s88
    s_branch L_h1_r3
L_h1_p4:
    v_mov_b32 v4, 0
    buffer_atomic_or v4, v6, s[16:19], 0 offen sc0 sc1
    s_waitcnt vmcnt(0)
    v_cmp_eq_u32 vcc, s68, v4
    s_nop 0
    s_andn2_b32 s65, vcc_lo, s88
    s_or_b32 s88, s88, s65
    s_cmp_lg_u32 s65, 0
    s_cbranch_scc1 L_h1_r4
    s_sub_u32 s56, s56, 1
    s_cbranch_scc0 L_h1_p4
    s_mov_b32 s56, 0
    s_not_b32 s65, s88
    s_branch L_h1_r4
L_h1_p5:
    v_mov_b32 v4, 0
    buffer_atomic_or v4, v6, s[16:19], 0 offen sc0 sc1
    s_waitcnt vmcnt(0)
    v_cmp_eq_u32 vcc, s68, v4
    s_nop 0
    s_andn2_b32 s65, vcc_lo, s88
    s_or_b32 s88, s88, s65
    s_cmp_lg_u32 s65, 0
    s_cbranch_scc1 L_h1_r5
    s_sub_u32 s56, s56, 1
    s_cbranch_scc0 L_h1_p5
    s_mov_b32 s56, 0
    s_not_b32 s65, s88
    s_branch L_h1_r5
L_h1_p6:
    v_mov_b32 v4, 0
    buffer_atomic_or v4, v6, s[16:19], 0 offen sc0 sc1
    s_waitcnt vmcnt(0)
    v_cmp_eq_u32 vcc, s68, v4
    s_nop 0
    s_andn2_b32 s65, vcc_lo, s88
    s_or_b32 s88, s88, s65
    s_cmp_lg_u32 s65, 0
    s_cbranch_scc1 L_h1_r6
    s_sub_u32 s56, s56, 1
    s_cbranch_scc0 L_h1_p6
    s_mov_b32 s56, 0
    s_not_b32 s65, s88
    s_branch L_h1_r6
L_h1_p7:
    v_mov_b32 v4, 0
    buffer_atomic_or v4, v6, s[16:19], 0 offen sc0 sc1
    s_waitcnt vmcnt(0)
    v_cmp_eq_u32 vcc, s68, v4
    s_nop 0
    s_andn2_b32 s65, vcc_lo, s88
    s_or_b32 s88, s88, s65
    s_cmp_lg_u32 s65, 0
    s_cbranch_scc1 L_h1_r7
    s_sub_u32 s56, s56, 1
    s_cbranch_scc0 L_h1_p7
    s_mov_b32 s56, 0
    s_not_b32 s65, s88
    s_branch L_h1_r7
L_h1_p8:
    v_mov_b32 v4, 0
    buffer_atomic_or v4, v6, s[16:19], 0 offen sc0 sc1
    s_waitcnt vmcnt(0)
    v_cmp_eq_u32 vcc, s68, v4
    s_nop 0
    s_andn2_b32 s65, vcc_lo, s88
    s_or_b32 s88, s88, s65
    s_cmp_lg_u32 s65, 0
    s_cbranch_scc1 L_h1_r8
    s_sub_u32 s56, s56, 1
    s_cbranch_scc0 L_h1_p8
    s_mov_b32 s56, 0
    s_not_b32 s65, s88
    s_branch L_h1_r8
L_h1_p9:
    v_mov_b32 v4, 0
    buffer_atomic_or v4, v6, s[16:19], 0 offen sc0 sc1
    s_waitcnt vmcnt(0)
    v_cmp_eq_u32 vcc, s68, v4
    s_nop 0
    s_andn2_b32 s65, vcc_lo, s88
    s_or_b32 s88, s88, s65
    s_cmp_lg_u32 s65, 0
    s_cbranch_scc1 L_h1_r9
    s_sub_u32 s56, s56, 1
    s_cbranch_scc0 L_h1_p9
    s_mov_b32 s56, 0
    s_not_b32 s65, s88
    s_branch L_h1_r9
L_h1_p10:
    v_mov_b32 v4, 0
    buffer_atomic_or v4, v6, s[16:19], 0 offen sc0 sc1
    s_waitcnt vmcnt(0)
    v_cmp_eq_u32 vcc, s68, v4
    s_nop 0
    s_andn2_b32 s65, vcc_lo, s88
    s_or_b32 s88, s88, s65
    s_cmp_lg_u32 s65, 0
    s_cbranch_scc1 L_h1_r10
    s_sub_u32 s56, s56, 1
    s_cbranch_scc0 L_h1_p10
    s_mov_b32 s56, 0
    s_not_b32 s65, s88
    s_branch L_h1_r10
L_h1_p11:
    v_mov_b32 v4, 0
    buffer_atomic_or v4, v6, s[16:19], 0 offen sc0 sc1
    s_waitcnt vmcnt(0)
    v_cmp_eq_u32 vcc, s68, v4
    s_nop 0
    s_andn2_b32 s65, vcc_lo, s88
    s_or_b32 s88, s88, s65
    s_cmp_lg_u32 s65, 0
    s_cbranch_scc1 L_h1_r11
    s_sub_u32 s56, s56, 1
    s_cbranch_scc0 L_h1_p11
    s_mov_b32 s56, 0
    s_not_b32 s65, s88
    s_branch L_h1_r11
L_h1_p12:
    v_mov_b32 v4, 0
    buffer_atomic_or v4, v6, s[16:19], 0 offen sc0 sc1
    s_waitcnt vmcnt(0)
    v_cmp_eq_u32 vcc, s68, v4
    s_nop 0
    s_andn2_b32 s65, vcc_lo, s88
    s_or_b32 s88, s88, s65
    s_cmp_lg_u32 s65, 0
    s_cbranch_scc1 L_h1_r12
    s_sub_u32 s56, s56, 1
    s_cbranch_scc0 L_h1_p12
    s_mov_b32 s56, 0
    s_not_b32 s65, s88
    s_branch L_h1_r12
L_h1_p13:
    v_mov_b32 v4, 0
    buffer_atomic_or v4, v6, s[16:19], 0 offen sc0 sc1
    s_waitcnt vmcnt(0)
    v_cmp_eq_u32 vcc, s68, v4
    s_nop 0
    s_andn2_b32 s65, vcc_lo, s88
    s_or_b32 s88, s88, s65
    s_cmp_lg_u32 s65, 0
    s_cbranch_scc1 L_h1_r13
    s_sub_u32 s56, s56, 1
    s_cbranch_scc0 L_h1_p13
    s_mov_b32 s56, 0
    s_not_b32 s65, s88
    s_branch L_h1_r13
L_h1_p14:
    v_mov_b32 v4, 0
    buffer_atomic_or v4, v6, s[16:19], 0 offen sc0 sc1
    s_waitcnt vmcnt(0)
    v_cmp_eq_u32 vcc, s68, v4
    s_nop 0
    s_andn2_b32 s65, vcc_lo, s88
    s_or_b32 s88, s88, s65
    s_cmp_lg_u32 s65, 0
    s_cbranch_scc1 L_h1_r14
    s_sub_u32 s56, s56, 1
    s_cbranch_scc0 L_h1_p14
    s_mov_b32 s56, 0
    s_not_b32 s65, s88
    s_branch L_h1_r14
L_h1_p15:
    v_mov_b32 v4, 0
    buffer_atomic_or v4, v6, s[16:19], 0 offen sc0 sc1
    s_waitcnt vmcnt(0)
    v_cmp_eq_u32 vcc, s68, v4
    s_nop 0
    s_andn2_b32 s65, vcc_lo, s88
    s_or_b32 s88, s88, s65
    s_cmp_lg_u32 s65, 0
    s_cbranch_scc1 L_h1_r15
    s_sub_u32 s56, s56, 1
    s_cbranch_scc0 L_h1_p15
    s_mov_b32 s56, 0
    s_not_b32 s65, s88
    s_branch L_h1_r15
L_h1_again:
    s_sub_u32 s56, s56, 1
    s_cbranch_scc0 L_h1_re
    s_mov_b32 s56, 0
    s_branch L_h1_done
L_h1_re:
    buffer_load_dwordx4 v[40:43], v2, s[16:19], 0 offen offset:0 sc1
    buffer_load_dwordx4 v[44:47], v2, s[16:19], 0 offen offset:1024 sc1
    buffer_load_dwordx4 v[48:51], v2, s[16:19], 0 offen offset:2048 sc1
    buffer_load_dwordx4 v[52:55], v2, s[16:19], 0 offen offset:3072 sc1
    buffer_load_dwordx4 v[56:59], v2, s[16:19], s92 offen offset:0 sc1
    buffer_load_dwordx4 v[60:63], v2, s[16:19], s92 offen offset:1024 sc1
    buffer_load_dwordx4 v[64:67], v2, s[16:19], s92 offen offset:2048 sc1
    buffer_load_dwordx4 v[68:71], v2, s[16:19], s92 offen offset:3072 sc1
    buffer_load_dwordx4 v[72:75], v2, s[16:19], s93 offen offset:0 sc1
    buffer_load_dwordx4 v[76:79], v2, s[16:19], s93 offen offset:1024 sc1
    buffer_load_dwordx4 v[80:83], v2, s[16:19], s93 offen offset:2048 sc1
    buffer_load_dwordx4 v[84:87], v2, s[16:19], s93 offen offset:3072 sc1
    buffer_load_dwordx4 v[88:91], v2, s[16:19], s94 offen offset:0 sc1
    buffer_load_dwordx4 v[92:95], v2, s[16:19], s94 offen offset:1024 sc1
    buffer_load_dwordx4 v[96:99], v2, s[16:19], s94 offen offset:2048 sc1
    buffer_load_dwordx4 v[100:103], v2, s[16:19], s94 offen offset:3072 sc1
    buffer_load_dwordx4 v[104:107], v3, s[16:19], 0 offen sc1
    v_mov_b32 v112, 0
    v_mov_b32 v113, 0
    v_mov_b32 v114, 0
    v_mov_b32 v115, 0
    v_mov_b32 v116, 0
    v_mov_b32 v117, 0
    v_mov_b32 v118, 0
    v_mov_b32 v119, 0
    s_branch L_h1_acc
L_comp:
    v_and_b32 v20, 15, v0
    v_lshrrev_b32 v21, 4, v0
    v_bfe_u32 v22, v0, 1, 3
    s_lshl_b32 s86, s49, 13
    v_lshl_add_u32 v20, v20, 7, s86
    v_or_b32 v23, 0, v21
    v_xor_b32 v23, v23, v22
    v_lshl_add_u32 v2, v23, 4, v20
    v_or_b32 v23, 4, v21
    v_xor_b32 v23, v23, v22
    v_lshl_add_u32 v3, v23, 4, v20
    v_bfe_u32 v22, v0, 2, 2
    v_lshl_add_u32 v22, v21, 3, v22
    v_lshlrev_b32 v22, 7, v22
    v_bfe_u32 v23, v0, 3, 2
    s_lshl_b32 s86, s50, 1
    v_xor_b32 v23, s86, v23
    v_lshl_add_u32 v22, v23, 5, v22
    v_and_b32 v23, 3, v0
    v_lshl_add_u32 v22, v23, 3, v22
    v_add_u32 v4, 16384, v22
    v_xor_b32 v5, 32, v4
    s_lshl_b32 s53, s2, 2
    s_add_u32 s53, s53, s3
    s_lshl_b32 s86, s53, 12
    s_add_u32 s86, s86, 1048576
    v_lshl_add_u32 v6, v0, 4, s86
    s_mul_i32 s53, s53, 560
    s_add_u32 s53, s53, 6291456
    v_lshl_add_u32 v17, v0, 4, s53
    v_mov_b32 v16, 2147483648
    v_cmp_gt_u32 vcc, 35, v0
    s_nop 1
    v_cndmask_b32 v17, v16, v17, vcc
    s_lshl_b32 s86, s47, 1
    s_add_u32 s86, s86, s50
    s_lshl_b32 s87, s86, 4
    s_add_u32 s87, s87, s46
    s_lshl_b32 s87, s87, 1
    s_add_u32 s87, s87, s49
    s_lshl_b32 s87, s87, 6
    s_add_u32 s87, s87, 6880320
    v_lshl_add_u32 v16, v0, 4, s87
    v_cmp_le_u32 vcc, 60, v0
    s_nop 1
    v_cndmask_b32 v17, v17, v16, vcc
    s_lshl_b32 s87, s86, 1
    s_add_u32 s87, s87, s49
    s_lshl_b32 s87, s87, 4
    s_add_u32 s87, s87, s46
    s_lshl_b32 s87, s87, 10
    s_add_u32 s87, s87, 5242880
    v_lshl_add_u32 v16, v0, 4, s87
    v_mov_b32 v8, -1
    v_mov_b32 v9, -1
    v_mov_b32 v10, -1
    v_mov_b32 v11, -1
    s_waitcnt lgkmcnt(0)
    s_load_dword s61, s[84:85], 524288
    s_mov_b32 s16, s84
    s_and_b32 s17, s85, 0xffff
    s_mov_b32 s18, 268435456
    s_mov_b32 s19, 0x20000
    s_mov_b32 s8, s64
    s_and_b32 s9, s65, 0xffff
    s_mov_b32 s10, 4194304
    s_mov_b32 s11, 0x20000
    s_mov_b32 s20, s68
    s_and_b32 s21, s69, 0xffff
    s_mov_b32 s22, 2097152
    s_mov_b32 s23, 0x20000
    s_mov_b32 s24, s80
    s_and_b32 s25, s81, 0xffff
    s_mov_b32 s26, 4194304
    s_mov_b32 s27, 0x20000
    s_mov_b32 s28, s82
    s_and_b32 s29, s83, 0xffff
    s_mov_b32 s30, 256
    s_mov_b32 s31, 0x20000
    s_bitcmp1_b32 s2, 0
    s_cselect_b32 s32, s76, s74
    s_cselect_b32 s33, s77, s75
    s_and_b32 s33, s33, 0xffff
    s_mov_b32 s34, 7340032
    s_mov_b32 s35, 0x20000
    s_mov_b32 s36, s78
    s_and_b32 s37, s79, 0xffff
    s_mov_b32 s38, 7340032
    s_mov_b32 s39, 0x20000
    s_mov_b32 s40, s72
    s_and_b32 s41, s73, 0xffff
    s_mov_b32 s42, 2048
    s_mov_b32 s43, 0x20000
    s_lshl_b32 s86, s2, 7
    s_add_u32 s86, s86, 589824
    s_cmp_eq_u32 s3, 0
    s_cselect_b32 s86, s86, 2147483648
    v_lshl_add_u32 v7, v0, 2, s86
    v_mov_b32 v12, 2147483648
    v_cmp_gt_u32 vcc, 32, v0
    s_nop 1
    v_cndmask_b32 v7, v12, v7, vcc
    v_mov_b32 v12, 0
    buffer_store_dword v12, v7, s[16:19], 0 offen sc1
    v_mov_b32 v128, 0
    v_mov_b32 v129, 0
    v_mov_b32 v130, 0
    v_mov_b32 v131, 0
    v_mov_b32 v132, 0
    v_mov_b32 v133, 0
    v_mov_b32 v134, 0
    v_mov_b32 v135, 0
    v_mov_b32 v136, 0
    v_mov_b32 v137, 0
    v_mov_b32 v138, 0
    v_mov_b32 v139, 0
    v_mov_b32 v140, 0
    v_mov_b32 v141, 0
    v_mov_b32 v142, 0
    v_mov_b32 v143, 0
    v_mov_b32 v144, 0
    v_mov_b32 v145, 0
    v_mov_b32 v146, 0
    v_mov_b32 v147, 0
    v_mov_b32 v148, 0
    v_mov_b32 v149, 0
    v_mov_b32 v150, 0
    v_mov_b32 v151, 0
    v_mov_b32 v152, 0
    v_mov_b32 v153, 0
    v_mov_b32 v154, 0
    v_mov_b32 v155, 0
    v_mov_b32 v156, 0
    v_mov_b32 v157, 0
    v_mov_b32 v158, 0
    v_mov_b32 v159, 0
    v_mov_b32 v160, 0
    v_mov_b32 v161, 0
    v_mov_b32 v162, 0
    v_mov_b32 v163, 0
    v_mov_b32 v164, 0
    v_mov_b32 v165, 0
    v_mov_b32 v166, 0
    v_mov_b32 v167, 0
    v_mov_b32 v168, 0
    v_mov_b32 v169, 0
    v_mov_b32 v170, 0
    v_mov_b32 v171, 0
    v_mov_b32 v172, 0
    v_mov_b32 v173, 0
    v_mov_b32 v174, 0
    v_mov_b32 v175, 0
    v_mov_b32 v176, 0
    v_mov_b32 v177, 0
    v_mov_b32 v178, 0
    v_mov_b32 v179, 0
    v_mov_b32 v180, 0
    v_mov_b32 v181, 0
    v_mov_b32 v182, 0
    v_mov_b32 v183, 0
    v_mov_b32 v184, 0
    v_mov_b32 v185, 0
    v_mov_b32 v186, 0
    v_mov_b32 v187, 0
    v_mov_b32 v188, 0
    v_mov_b32 v189, 0
    v_mov_b32 v190, 0
    v_mov_b32 v191, 0
    v_mov_b32 v192, 0
    v_mov_b32 v193, 0
    v_mov_b32 v194, 0
    v_mov_b32 v195, 0
    v_mov_b32 v196, 0
    v_mov_b32 v197, 0
    v_mov_b32 v198, 0
    v_mov_b32 v199, 0
    v_mov_b32 v200, 0
    v_mov_b32 v201, 0
    v_mov_b32 v202, 0
    v_mov_b32 v203, 0
    v_mov_b32 v204, 0
    v_mov_b32 v205, 0
    v_mov_b32 v206, 0
    v_mov_b32 v207, 0
    v_mov_b32 v208, 0
    v_mov_b32 v209, 0
    v_mov_b32 v210, 0
    v_mov_b32 v211, 0
    v_mov_b32 v212, 0
    v_mov_b32 v213, 0
    v_mov_b32 v214, 0
    v_mov_b32 v215, 0
    v_mov_b32 v216, 0
    v_mov_b32 v217, 0
    v_mov_b32 v218, 0
    v_mov_b32 v219, 0
    v_mov_b32 v220, 0
    v_mov_b32 v221, 0
    v_mov_b32 v222, 0
    v_mov_b32 v223, 0
    s_mov_b32 s54, 0x358637bd
    s_mov_b32 s55, 0x358637bd
    s_mov_b32 s62, 0
    s_mov_b32 s63, 0
    s_waitcnt lgkmcnt(0)
    s_add_u32 s68, s61, 0x9e3779b9
    s_barrier
    ds_read_b128 v[40:43], v2 offset:0
    ds_read_b128 v[44:47], v2 offset:2048
    ds_read_b128 v[48:51], v2 offset:4096
    ds_read_b128 v[52:55], v2 offset:6144
    ds_read_b64_tr_b16 v[56:57], v4 offset:0
    ds_read_b64_tr_b16 v[58:59], v4 offset:512
    ds_read_b64_tr_b16 v[60:61], v5 offset:0
    ds_read_b64_tr_b16 v[62:63], v5 offset:512
    ds_read_b64_tr_b16 v[64:65], v4 offset:8192
    ds_read_b64_tr_b16 v[66:67], v4 offset:8704
    ds_read_b64_tr_b16 v[68:69], v5 offset:8192
    ds_read_b64_tr_b16 v[70:71], v5 offset:8704
    ds_read_b64_tr_b16 v[72:73], v4 offset:16384
    ds_read_b64_tr_b16 v[74:75], v4 offset:16896
    ds_read_b64_tr_b16 v[76:77], v5 offset:16384
    ds_read_b64_tr_b16 v[78:79], v5 offset:16896
L_cloop:
    s_waitcnt lgkmcnt(0)
    v_mfma_f32_16x16x32_bf16 v[128:131], v[56:59], v[40:43], v[128:131]
    ds_read_b128 v[80:83], v3 offset:0
    v_mfma_f32_16x16x32_bf16 v[132:135], v[56:59], v[44:47], v[132:135]
    ds_read_b128 v[84:87], v3 offset:2048
    v_mfma_f32_16x16x32_bf16 v[136:139], v[56:59], v[48:51], v[136:139]
    ds_read_b128 v[88:91], v3 offset:4096
    v_mfma_f32_16x16x32_bf16 v[140:143], v[56:59], v[52:55], v[140:143]
    ds_read_b128 v[92:95], v3 offset:6144
    v_mfma_f32_16x16x32_bf16 v[144:147], v[60:63], v[40:43], v[144:147]
    ds_read_b64_tr_b16 v[96:97], v4 offset:4096
    v_mfma_f32_16x16x32_bf16 v[148:151], v[60:63], v[44:47], v[148:151]
    ds_read_b64_tr_b16 v[98:99], v4 offset:4608
    v_mfma_f32_16x16x32_bf16 v[152:155], v[60:63], v[48:51], v[152:155]
    ds_read_b64_tr_b16 v[100:101], v5 offset:4096
    v_mfma_f32_16x16x32_bf16 v[156:159], v[60:63], v[52:55], v[156:159]
    ds_read_b64_tr_b16 v[102:103], v5 offset:4608
    v_mfma_f32_16x16x32_bf16 v[160:163], v[40:43], v[64:67], v[160:163]
    ds_read_b64_tr_b16 v[104:105], v4 offset:12288
    v_mfma_f32_16x16x32_bf16 v[164:167], v[44:47], v[64:67], v[164:167]
    ds_read_b64_tr_b16 v[106:107], v4 offset:12800
    v_mfma_f32_16x16x32_bf16 v[168:171], v[48:51], v[64:67], v[168:171]
    ds_read_b64_tr_b16 v[108:109], v5 offset:12288
    v_mfma_f32_16x16x32_bf16 v[172:175], v[52:55], v[64:67], v[172:175]
    ds_read_b64_tr_b16 v[110:111], v5 offset:12800
    v_mfma_f32_16x16x32_bf16 v[176:179], v[40:43], v[68:71], v[176:179]
    ds_read_b64_tr_b16 v[112:113], v4 offset:20480
    v_mfma_f32_16x16x32_bf16 v[180:183], v[44:47], v[68:71], v[180:183]
    ds_read_b64_tr_b16 v[114:115], v4 offset:20992
    v_mfma_f32_16x16x32_bf16 v[184:187], v[48:51], v[68:71], v[184:187]
    ds_read_b64_tr_b16 v[116:117], v5 offset:20480
    v_mfma_f32_16x16x32_bf16 v[188:191], v[52:55], v[68:71], v[188:191]
    ds_read_b64_tr_b16 v[118:119], v5 offset:20992
    v_mfma_f32_16x16x32_bf16 v[192:195], v[40:43], v[72:75], v[192:195]
    s_add_u32 s63, s63, 1
    s_cmp_eq_u32 s63, 3
    s_cselect_b32 s53, 4294844416, 0
    s_cselect_b32 s63, 0, s63
    s_add_u32 s53, s53, 40960
    v_mfma_f32_16x16x32_bf16 v[196:199], v[44:47], v[72:75], v[196:199]
    v_add_u32 v2, s53, v2
    v_mfma_f32_16x16x32_bf16 v[200:203], v[48:51], v[72:75], v[200:203]
    v_add_u32 v4, s53, v4
    v_mfma_f32_16x16x32_bf16 v[204:207], v[52:55], v[72:75], v[204:207]
    v_add_u32 v5, s53, v5
    v_mfma_f32_16x16x32_bf16 v[208:211], v[40:43], v[76:79], v[208:211]
    v_add_u32 v3, s53, v3
    v_mfma_f32_16x16x32_bf16 v[212:215], v[44:47], v[76:79], v[212:215]
    s_cmp_ge_u32 s62, 6
    s_cbranch_scc1 L_cl_none
    buffer_store_dwordx4 v[8:11], v6, s[16:19], 0 offen sc1
    v_add_u32 v6, 1024, v6
    s_cmp_lt_u32 s62, 3
    s_cbranch_scc1 L_cl_none
    v_mov_b32 v6, v16
    v_mov_b32 v16, v17
L_cl_none:
    v_mfma_f32_16x16x32_bf16 v[216:219], v[48:51], v[76:79], v[216:219]
    v_mfma_f32_16x16x32_bf16 v[220:223], v[52:55], v[76:79], v[220:223]
    s_waitcnt lgkmcnt(0)
    v_mfma_f32_16x16x32_bf16 v[128:131], v[96:99], v[80:83], v[128:131]
    s_barrier
    ds_read_b128 v[40:43], v2 offset:0
    v_mfma_f32_16x16x32_bf16 v[132:135], v[96:99], v[84:87], v[132:135]
    ds_read_b128 v[44:47], v2 offset:2048
    v_mfma_f32_16x16x32_bf16 v[136:139], v[96:99], v[88:91], v[136:139]
    ds_read_b128 v[48:51], v2 offset:4096
    v_mfma_f32_16x16x32_bf16 v[140:143], v[96:99], v[92:95], v[140:143]
    ds_read_b128 v[52:55], v2 offset:6144
    v_mfma_f32_16x16x32_bf16 v[144:147], v[100:103], v[80:83], v[144:147]
    ds_read_b64_tr_b16 v[56:57], v4 offset:0
    v_mfma_f32_16x16x32_bf16 v[148:151], v[100:103], v[84:87], v[148:151]
    ds_read_b64_tr_b16 v[58:59], v4 offset:512
    v_mfma_f32_16x16x32_bf16 v[152:155], v[100:103], v[88:91], v[152:155]
    ds_read_b64_tr_b16 v[60:61], v5 offset:0
    v_mfma_f32_16x16x32_bf16 v[156:159], v[100:103], v[92:95], v[156:159]
    ds_read_b64_tr_b16 v[62:63], v5 offset:512
    v_mfma_f32_16x16x32_bf16 v[160:163], v[80:83], v[104:107], v[160:163]
    ds_read_b64_tr_b16 v[64:65], v4 offset:8192
    v_mfma_f32_16x16x32_bf16 v[164:167], v[84:87], v[104:107], v[164:167]
    ds_read_b64_tr_b16 v[66:67], v4 offset:8704
    v_mfma_f32_16x16x32_bf16 v[168:171], v[88:91], v[104:107], v[168:171]
    ds_read_b64_tr_b16 v[68:69], v5 offset:8192
    v_mfma_f32_16x16x32_bf16 v[172:175], v[92:95], v[104:107], v[172:175]
    ds_read_b64_tr_b16 v[70:71], v5 offset:8704
    v_mfma_f32_16x16x32_bf16 v[176:179], v[80:83], v[108:111], v[176:179]
    ds_read_b64_tr_b16 v[72:73], v4 offset:16384
    v_mfma_f32_16x16x32_bf16 v[180:183], v[84:87], v[108:111], v[180:183]
    ds_read_b64_tr_b16 v[74:75], v4 offset:16896
    v_mfma_f32_16x16x32_bf16 v[184:187], v[88:91], v[108:111], v[184:187]
    ds_read_b64_tr_b16 v[76:77], v5 offset:16384
    v_mfma_f32_16x16x32_bf16 v[188:191], v[92:95], v[108:111], v[188:191]
    ds_read_b64_tr_b16 v[78:79], v5 offset:16896
    v_mfma_f32_16x16x32_bf16 v[192:195], v[80:83], v[112:115], v[192:195]
    v_mfma_f32_16x16x32_bf16 v[196:199], v[84:87], v[112:115], v[196:199]
    s_cmp_lg_u32 s62, 8
    s_cbranch_scc1 L_cl_nw
    s_waitcnt vmcnt(0)
L_cl_nw:
    v_mfma_f32_16x16x32_bf16 v[200:203], v[88:91], v[112:115], v[200:203]
    v_mfma_f32_16x16x32_bf16 v[204:207], v[92:95], v[112:115], v[204:207]
    v_mfma_f32_16x16x32_bf16 v[208:211], v[80:83], v[116:119], v[208:211]
    s_add_u32 s62, s62, 1
    v_mfma_f32_16x16x32_bf16 v[212:215], v[84:87], v[116:119], v[212:215]
    v_mfma_f32_16x16x32_bf16 v[216:219], v[88:91], v[116:119], v[216:219]
    v_mfma_f32_16x16x32_bf16 v[220:223], v[92:95], v[116:119], v[220:223]
    s_cmp_lt_u32 s62, 15
    s_cbranch_scc1 L_cloop
    s_waitcnt lgkmcnt(0)
    v_mfma_f32_16x16x32_bf16 v[128:131], v[56:59], v[40:43], v[128:131]
    ds_read_b128 v[80:83], v3 offset:0
    v_mfma_f32_16x16x32_bf16 v[132:135], v[56:59], v[44:47], v[132:135]
    ds_read_b128 v[84:87], v3 offset:2048
    v_mfma_f32_16x16x32_bf16 v[136:139], v[56:59], v[48:51], v[136:139]
    ds_read_b128 v[88:91], v3 offset:4096
    v_mfma_f32_16x16x32_bf16 v[140:143], v[56:59], v[52:55], v[140:143]
    ds_read_b128 v[92:95], v3 offset:6144
    v_mfma_f32_16x16x32_bf16 v[144:147], v[60:63], v[40:43], v[144:147]
    ds_read_b64_tr_b16 v[96:97], v4 offset:4096
    v_mfma_f32_16x16x32_bf16 v[148:151], v[60:63], v[44:47], v[148:151]
    ds_read_b64_tr_b16 v[98:99], v4 offset:4608
    v_mfma_f32_16x16x32_bf16 v[152:155], v[60:63], v[48:51], v[152:155]
    ds_read_b64_tr_b16 v[100:101], v5 offset:4096
    v_mfma_f32_16x16x32_bf16 v[156:159], v[60:63], v[52:55], v[156:159]
    ds_read_b64_tr_b16 v[102:103], v5 offset:4608
    v_mfma_f32_16x16x32_bf16 v[160:163], v[40:43], v[64:67], v[160:163]
    ds_read_b64_tr_b16 v[104:105], v4 offset:12288
    v_mfma_f32_16x16x32_bf16 v[164:167], v[44:47], v[64:67], v[164:167]
    ds_read_b64_tr_b16 v[106:107], v4 offset:12800
    v_mfma_f32_16x16x32_bf16 v[168:171], v[48:51], v[64:67], v[168:171]
    ds_read_b64_tr_b16 v[108:109], v5 offset:12288
    v_mfma_f32_16x16x32_bf16 v[172:175], v[52:55], v[64:67], v[172:175]
    ds_read_b64_tr_b16 v[110:111], v5 offset:12800
    v_mfma_f32_16x16x32_bf16 v[176:179], v[40:43], v[68:71], v[176:179]
    ds_read_b64_tr_b16 v[112:113], v4 offset:20480
    v_mfma_f32_16x16x32_bf16 v[180:183], v[44:47], v[68:71], v[180:183]
    ds_read_b64_tr_b16 v[114:115], v4 offset:20992
    v_mfma_f32_16x16x32_bf16 v[184:187], v[48:51], v[68:71], v[184:187]
    ds_read_b64_tr_b16 v[116:117], v5 offset:20480
    v_mfma_f32_16x16x32_bf16 v[188:191], v[52:55], v[68:71], v[188:191]
    ds_read_b64_tr_b16 v[118:119], v5 offset:20992
    v_mfma_f32_16x16x32_bf16 v[192:195], v[40:43], v[72:75], v[192:195]
    v_lshrrev_b32 v21, 4, v0
    v_and_b32 v22, 15, v0
    v_mfma_f32_16x16x32_bf16 v[196:199], v[44:47], v[72:75], v[196:199]
    s_lshl_b32 s86, s49, 8
    s_add_u32 s86, s86, 131072
    v_lshl_add_u32 v6, v21, 4, s86
    v_mfma_f32_16x16x32_bf16 v[200:203], v[48:51], v[72:75], v[200:203]
    v_lshl_add_u32 v7, v22, 2, s86
    v_mfma_f32_16x16x32_bf16 v[204:207], v[52:55], v[72:75], v[204:207]
    s_lshl_b32 s86, s50, 7
    s_add_u32 s86, s86, 132608
    v_lshl_add_u32 v8, v22, 2, s86
    v_mfma_f32_16x16x32_bf16 v[208:211], v[40:43], v[76:79], v[208:211]
    v_lshl_add_u32 v9, v21, 4, s86
    v_mfma_f32_16x16x32_bf16 v[212:215], v[44:47], v[76:79], v[212:215]
    s_lshl_b32 s86, s3, 2
    s_add_u32 s86, s86, 135168
    v_mov_b32 v12, s86
    v_mfma_f32_16x16x32_bf16 v[216:219], v[48:51], v[76:79], v[216:219]
    v_xor_b32 v13, 4, v12
    v_mfma_f32_16x16x32_bf16 v[220:223], v[52:55], v[76:79], v[220:223]
    s_waitcnt lgkmcnt(0)
    v_mfma_f32_16x16x32_bf16 v[160:163], v[80:83], v[104:107], v[160:163]
    v_mfma_f32_16x16x32_bf16 v[164:167], v[84:87], v[104:107], v[164:167]
    v_mfma_f32_16x16x32_bf16 v[168:171], v[88:91], v[104:107], v[168:171]
    v_mfma_f32_16x16x32_bf16 v[172:175], v[92:95], v[104:107], v[172:175]
    v_mfma_f32_16x16x32_bf16 v[176:179], v[80:83], v[108:111], v[176:179]
    v_mfma_f32_16x16x32_bf16 v[180:183], v[84:87], v[108:111], v[180:183]
    v_mfma_f32_16x16x32_bf16 v[184:187], v[88:91], v[108:111], v[184:187]
    v_mfma_f32_16x16x32_bf16 v[188:191], v[92:95], v[108:111], v[188:191]
    v_mfma_f32_16x16x32_bf16 v[192:195], v[80:83], v[112:115], v[192:195]
    v_mfma_f32_16x16x32_bf16 v[196:199], v[84:87], v[112:115], v[196:199]
    v_mfma_f32_16x16x32_bf16 v[200:203], v[88:91], v[112:115], v[200:203]
    v_mfma_f32_16x16x32_bf16 v[204:207], v[92:95], v[112:115], v[204:207]
    v_mfma_f32_16x16x32_bf16 v[208:211], v[80:83], v[116:119], v[208:211]
    s_barrier
    ds_read_b128 v[40:43], v6 offset:0
    ds_read_b128 v[44:47], v6 offset:64
    v_mfma_f32_16x16x32_bf16 v[212:215], v[84:87], v[116:119], v[212:215]
    ds_read_b128 v[48:51], v6 offset:128
    ds_read_b128 v[52:55], v6 offset:192
    v_mfma_f32_16x16x32_bf16 v[216:219], v[88:91], v[116:119], v[216:219]
    ds_read_b32 v72, v8 offset:256
    ds_read_b32 v73, v8 offset:320
    v_mfma_f32_16x16x32_bf16 v[220:223], v[92:95], v[116:119], v[220:223]
    ds_read_b32 v74, v8 offset:512
    ds_read_b32 v75, v8 offset:576
    v_mfma_f32_16x16x32_bf16 v[128:131], v[96:99], v[80:83], v[128:131]
    ds_read_b128 v[56:59], v6 offset:512
    ds_read_b128 v[60:63], v6 offset:576
    v_mfma_f32_16x16x32_bf16 v[132:135], v[96:99], v[84:87], v[132:135]
    ds_read_b128 v[64:67], v6 offset:640
    ds_read_b128 v[68:71], v6 offset:704
    v_mfma_f32_16x16x32_bf16 v[136:139], v[96:99], v[88:91], v[136:139]
    ds_read_b128 v[224:227], v6 offset:1024
    ds_read_b128 v[228:231], v6 offset:1088
    v_mfma_f32_16x16x32_bf16 v[140:143], v[96:99], v[92:95], v[140:143]
    ds_read_b128 v[232:235], v6 offset:1152
    ds_read_b128 v[236:239], v6 offset:1216
    v_mfma_f32_16x16x32_bf16 v[144:147], v[100:103], v[80:83], v[144:147]
    ds_read_b128 v[28:31], v9 offset:0
    ds_read_b128 v[32:35], v9 offset:64
    v_mfma_f32_16x16x32_bf16 v[148:151], v[100:103], v[84:87], v[148:151]
    v_mfma_f32_16x16x32_bf16 v[152:155], v[100:103], v[88:91], v[152:155]
    v_mfma_f32_16x16x32_bf16 v[156:159], v[100:103], v[92:95], v[156:159]
    ds_read_b32 v240, v7 offset:0
    ds_read_b32 v244, v7 offset:512
    ds_read_b32 v248, v7 offset:1024
    ds_read_b32 v241, v7 offset:64
    ds_read_b32 v245, v7 offset:576
    ds_read_b32 v249, v7 offset:1088
    ds_read_b32 v242, v7 offset:128
    ds_read_b32 v246, v7 offset:640
    ds_read_b32 v250, v7 offset:1152
    ds_read_b32 v243, v7 offset:192
    ds_read_b32 v247, v7 offset:704
    ds_read_b32 v251, v7 offset:1216
    s_waitcnt lgkmcnt(12)
    v_pk_fma_f32 v[160:161], v[40:41], v[72:73], v[160:161] op_sel_hi:[1,0,1]
    v_pk_mul_f32 v[112:113], v[160:161], v[224:225]
    v_pk_fma_f32 v[160:161], v[160:161], v[56:57], s[54:55]
    v_exp_f32 v112, v112 clamp
    v_exp_f32 v113, v113 clamp
    v_max_f32 v160, s54, v160
    v_max_f32 v161, s54, v161
    v_pk_add_f32 v[160:161], v[160:161], v[112:113]
    v_cvt_pk_bf16_f32 v80, v160, v161
    v_pk_fma_f32 v[162:163], v[42:43], v[72:73], v[162:163] op_sel_hi:[1,0,1]
    v_pk_mul_f32 v[114:115], v[162:163], v[226:227]
    v_pk_fma_f32 v[162:163], v[162:163], v[58:59], s[54:55]
    v_exp_f32 v114, v114 clamp
    v_exp_f32 v115, v115 clamp
    v_max_f32 v162, s54, v162
    v_max_f32 v163, s54, v163
    v_pk_add_f32 v[162:163], v[162:163], v[114:115]
    v_cvt_pk_bf16_f32 v81, v162, v163
    v_pk_fma_f32 v[164:165], v[44:45], v[72:73], v[164:165] op_sel_hi:[1,0,1]
    v_pk_mul_f32 v[116:117], v[164:165], v[228:229]
    v_pk_fma_f32 v[164:165], v[164:165], v[60:61], s[54:55]
    v_exp_f32 v116, v116 clamp
    v_exp_f32 v117, v117 clamp
    v_max_f32 v164, s54, v164
    v_max_f32 v165, s54, v165
    v_pk_add_f32 v[164:165], v[164:165], v[116:117]
    v_cvt_pk_bf16_f32 v82, v164, v165
    v_pk_fma_f32 v[166:167], v[46:47], v[72:73], v[166:167] op_sel_hi:[1,0,1]
    v_pk_mul_f32 v[118:119], v[166:167], v[230:231]
    v_pk_fma_f32 v[166:167], v[166:167], v[62:63], s[54:55]
    v_exp_f32 v118, v118 clamp
    v_exp_f32 v119, v119 clamp
    v_max_f32 v166, s54, v166
    v_max_f32 v167, s54, v167
    v_pk_add_f32 v[166:167], v[166:167], v[118:119]
    v_cvt_pk_bf16_f32 v83, v166, v167
    v_pk_fma_f32 v[168:169], v[48:49], v[72:73], v[168:169] op_sel_hi:[1,0,1]
    v_pk_mul_f32 v[112:113], v[168:169], v[232:233]
    v_pk_fma_f32 v[168:169], v[168:169], v[64:65], s[54:55]
    v_exp_f32 v112, v112 clamp
    v_exp_f32 v113, v113 clamp
    v_max_f32 v168, s54, v168
    v_max_f32 v169, s54, v169
    v_pk_add_f32 v[168:169], v[168:169], v[112:113]
    v_cvt_pk_bf16_f32 v84, v168, v169
    v_pk_fma_f32 v[170:171], v[50:51], v[72:73], v[170:171] op_sel_hi:[1,0,1]
    v_pk_mul_f32 v[114:115], v[170:171], v[234:235]
    v_pk_fma_f32 v[170:171], v[170:171], v[66:67], s[54:55]
    v_exp_f32 v114, v114 clamp
    v_exp_f32 v115, v115 clamp
    v_max_f32 v170, s54, v170
    v_max_f32 v171, s54, v171
    v_pk_add_f32 v[170:171], v[170:171], v[114:115]
    v_cvt_pk_bf16_f32 v85, v170, v171
    v_pk_fma_f32 v[172:173], v[52:53], v[72:73], v[172:173] op_sel_hi:[1,0,1]
    v_pk_mul_f32 v[116:117], v[172:173], v[236:237]
    v_pk_fma_f32 v[172:173], v[172:173], v[68:69], s[54:55]
    v_exp_f32 v116, v116 clamp
    v_exp_f32 v117, v117 clamp
    v_max_f32 v172, s54, v172
    v_max_f32 v173, s54, v173
    v_pk_add_f32 v[172:173], v[172:173], v[116:117]
    v_cvt_pk_bf16_f32 v86, v172, v173
    v_pk_fma_f32 v[174:175], v[54:55], v[72:73], v[174:175] op_sel_hi:[1,0,1]
    v_pk_mul_f32 v[118:119], v[174:175], v[238:239]
    v_pk_fma_f32 v[174:175], v[174:175], v[70:71], s[54:55]
    v_exp_f32 v118, v118 clamp
    v_exp_f32 v119, v119 clamp
    v_max_f32 v174, s54, v174
    v_max_f32 v175, s54, v175
    v_pk_add_f32 v[174:175], v[174:175], v[118:119]
    v_cvt_pk_bf16_f32 v87, v174, v175
    v_pk_fma_f32 v[176:177], v[40:41], v[72:73], v[176:177] op_sel:[0,1,0] op_sel_hi:[1,1,1]
    v_pk_mul_f32 v[112:113], v[176:177], v[224:225]
    v_pk_fma_f32 v[176:177], v[176:177], v[56:57], s[54:55]
    v_exp_f32 v112, v112 clamp
    v_exp_f32 v113, v113 clamp
    v_max_f32 v176, s54, v176
    v_max_f32 v177, s54, v177
    v_pk_add_f32 v[176:177], v[176:177], v[112:113]
    v_cvt_pk_bf16_f32 v88, v176, v177
    v_pk_fma_f32 v[178:179], v[42:43], v[72:73], v[178:179] op_sel:[0,1,0] op_sel_hi:[1,1,1]
    v_pk_mul_f32 v[114:115], v[178:179], v[226:227]
    v_pk_fma_f32 v[178:179], v[178:179], v[58:59], s[54:55]
    v_exp_f32 v114, v114 clamp
    v_exp_f32 v115, v115 clamp
    v_max_f32 v178, s54, v178
    v_max_f32 v179, s54, v179
    v_pk_add_f32 v[178:179], v[178:179], v[114:115]
    v_cvt_pk_bf16_f32 v89, v178, v179
    v_pk_fma_f32 v[180:181], v[44:45], v[72:73], v[180:181] op_sel:[0,1,0] op_sel_hi:[1,1,1]
    v_pk_mul_f32 v[116:117], v[180:181], v[228:229]
    v_pk_fma_f32 v[180:181], v[180:181], v[60:61], s[54:55]
    v_exp_f32 v116, v116 clamp
    v_exp_f32 v117, v117 clamp
    v_max_f32 v180, s54, v180
    v_max_f32 v181, s54, v181
    v_pk_add_f32 v[180:181], v[180:181], v[116:117]
    v_cvt_pk_bf16_f32 v90, v180, v181
    v_pk_fma_f32 v[182:183], v[46:47], v[72:73], v[182:183] op_sel:[0,1,0] op_sel_hi:[1,1,1]
    v_pk_mul_f32 v[118:119], v[182:183], v[230:231]
    v_pk_fma_f32 v[182:183], v[182:183], v[62:63], s[54:55]
    v_exp_f32 v118, v118 clamp
    v_exp_f32 v119, v119 clamp
    v_max_f32 v182, s54, v182
    v_max_f32 v183, s54, v183
    v_pk_add_f32 v[182:183], v[182:183], v[118:119]
    v_cvt_pk_bf16_f32 v91, v182, v183
    v_pk_fma_f32 v[184:185], v[48:49], v[72:73], v[184:185] op_sel:[0,1,0] op_sel_hi:[1,1,1]
    v_pk_mul_f32 v[112:113], v[184:185], v[232:233]
    v_pk_fma_f32 v[184:185], v[184:185], v[64:65], s[54:55]
    v_exp_f32 v112, v112 clamp
    v_exp_f32 v113, v113 clamp
    v_max_f32 v184, s54, v184
    v_max_f32 v185, s54, v185
    v_pk_add_f32 v[184:185], v[184:185], v[112:113]
    v_cvt_pk_bf16_f32 v92, v184, v185
    v_pk_fma_f32 v[186:187], v[50:51], v[72:73], v[186:187] op_sel:[0,1,0] op_sel_hi:[1,1,1]
    v_pk_mul_f32 v[114:115], v[186:187], v[234:235]
    v_pk_fma_f32 v[186:187], v[186:187], v[66:67], s[54:55]
    v_exp_f32 v114, v114 clamp
    v_exp_f32 v115, v115 clamp
    v_max_f32 v186, s54, v186
    v_max_f32 v187, s54, v187
    v_pk_add_f32 v[186:187], v[186:187], v[114:115]
    v_cvt_pk_bf16_f32 v93, v186, v187
    v_pk_fma_f32 v[188:189], v[52:53], v[72:73], v[188:189] op_sel:[0,1,0] op_sel_hi:[1,1,1]
    v_pk_mul_f32 v[116:117], v[188:189], v[236:237]
    v_pk_fma_f32 v[188:189], v[188:189], v[68:69], s[54:55]
    v_exp_f32 v116, v116 clamp
    v_exp_f32 v117, v117 clamp
    v_max_f32 v188, s54, v188
    v_max_f32 v189, s54, v189
    v_pk_add_f32 v[188:189], v[188:189], v[116:117]
    v_cvt_pk_bf16_f32 v94, v188, v189
    v_pk_fma_f32 v[190:191], v[54:55], v[72:73], v[190:191] op_sel:[0,1,0] op_sel_hi:[1,1,1]
    v_pk_mul_f32 v[118:119], v[190:191], v[238:239]
    v_pk_fma_f32 v[190:191], v[190:191], v[70:71], s[54:55]
    v_exp_f32 v118, v118 clamp
    v_exp_f32 v119, v119 clamp
    v_max_f32 v190, s54, v190
    v_max_f32 v191, s54, v191
    v_pk_add_f32 v[190:191], v[190:191], v[118:119]
    v_cvt_pk_bf16_f32 v95, v190, v191
    v_mov_b32 v120, s95
    v_mov_b32 v121, s95
    v_mov_b32 v122, s95
    v_mov_b32 v123, s95
    v_pk_fma_f32 v[192:193], v[40:41], v[74:75], v[192:193] op_sel_hi:[1,0,1]
    v_pk_mul_f32 v[192:193], v[192:193], v[56:57]
    v_cvt_pk_bf16_f32 v96, v192, v193
    v_pk_fma_f32 v[194:195], v[42:43], v[74:75], v[194:195] op_sel_hi:[1,0,1]
    v_pk_mul_f32 v[194:195], v[194:195], v[58:59]
    v_cvt_pk_bf16_f32 v97, v194, v195
    v_pk_fma_f32 v[196:197], v[44:45], v[74:75], v[196:197] op_sel_hi:[1,0,1]
    v_pk_mul_f32 v[196:197], v[196:197], v[60:61]
    v_cvt_pk_bf16_f32 v98, v196, v197
    v_pk_fma_f32 v[198:199], v[46:47], v[74:75], v[198:199] op_sel_hi:[1,0,1]
    v_pk_mul_f32 v[198:199], v[198:199], v[62:63]
    v_cvt_pk_bf16_f32 v99, v198, v199
    v_pk_fma_f32 v[200:201], v[48:49], v[74:75], v[200:201] op_sel_hi:[1,0,1]
    v_pk_mul_f32 v[200:201], v[200:201], v[64:65]
    v_cvt_pk_bf16_f32 v100, v200, v201
    v_pk_fma_f32 v[202:203], v[50:51], v[74:75], v[202:203] op_sel_hi:[1,0,1]
    v_pk_mul_f32 v[202:203], v[202:203], v[66:67]
    v_cvt_pk_bf16_f32 v101, v202, v203
    v_pk_fma_f32 v[204:205], v[52:53], v[74:75], v[204:205] op_sel_hi:[1,0,1]
    v_pk_mul_f32 v[204:205], v[204:205], v[68:69]
    v_cvt_pk_bf16_f32 v102, v204, v205
    v_pk_fma_f32 v[206:207], v[54:55], v[74:75], v[206:207] op_sel_hi:[1,0,1]
    v_pk_mul_f32 v[206:207], v[206:207], v[70:71]
    v_cvt_pk_bf16_f32 v103, v206, v207
    v_pk_fma_f32 v[208:209], v[40:41], v[74:75], v[208:209] op_sel:[0,1,0] op_sel_hi:[1,1,1]
    v_pk_mul_f32 v[208:209], v[208:209], v[56:57]
    v_cvt_pk_bf16_f32 v104, v208, v209
    v_pk_fma_f32 v[210:211], v[42:43], v[74:75], v[210:211] op_sel:[0,1,0] op_sel_hi:[1,1,1]
    v_pk_mul_f32 v[210:211], v[210:211], v[58:59]
    v_cvt_pk_bf16_f32 v105, v210, v211
    v_pk_fma_f32 v[212:213], v[44:45], v[74:75], v[212:213] op_sel:[0,1,0] op_sel_hi:[1,1,1]
    v_pk_mul_f32 v[212:213], v[212:213], v[60:61]
    v_cvt_pk_bf16_f32 v106, v212, v213
    v_pk_fma_f32 v[214:215], v[46:47], v[74:75], v[214:215] op_sel:[0,1,0] op_sel_hi:[1,1,1]
    v_pk_mul_f32 v[214:215], v[214:215], v[62:63]
    v_cvt_pk_bf16_f32 v107, v214, v215
    v_pk_fma_f32 v[216:217], v[48:49], v[74:75], v[216:217] op_sel:[0,1,0] op_sel_hi:[1,1,1]
    v_pk_mul_f32 v[216:217], v[216:217], v[64:65]
    v_cvt_pk_bf16_f32 v108, v216, v217
    v_pk_fma_f32 v[218:219], v[50:51], v[74:75], v[218:219] op_sel:[0,1,0] op_sel_hi:[1,1,1]
    v_pk_mul_f32 v[218:219], v[218:219], v[66:67]
    v_cvt_pk_bf16_f32 v109, v218, v219
    v_pk_fma_f32 v[220:221], v[52:53], v[74:75], v[220:221] op_sel:[0,1,0] op_sel_hi:[1,1,1]
    v_pk_mul_f32 v[220:221], v[220:221], v[68:69]
    v_cvt_pk_bf16_f32 v110, v220, v221
    v_pk_fma_f32 v[222:223], v[54:55], v[74:75], v[222:223] op_sel:[0,1,0] op_sel_hi:[1,1,1]
    v_pk_mul_f32 v[222:223], v[222:223], v[70:71]
    v_cvt_pk_bf16_f32 v111, v222, v223
    s_mul_i32 s86, s3, 3072
    s_add_u32 s86, s86, 139264
    v_lshl_add_u32 v6, v0, 4, s86
    s_xor_b32 s86, s3, 1
    s_mul_i32 s86, s86, 3072
    s_add_u32 s86, s86, 139264
    v_lshl_add_u32 v7, v0, 4, s86
    s_cmp_eq_u32 s49, 1
    s_cbranch_scc1 L_kv1
    v_mfma_f32_16x16x32_bf16 v[172:175], v[80:83], v[104:107], 0
    v_mfma_f32_16x16x32_bf16 v[176:179], v[88:91], v[104:107], 0
    v_mfma_f32_16x16x32_bf16 v[180:183], v[88:91], v[120:123], 0
    v_mfma_f32_16x16x32_bf16 v[160:163], v[80:83], v[96:99], 0
    v_mfma_f32_16x16x32_bf16 v[164:167], v[88:91], v[96:99], 0
    v_mfma_f32_16x16x32_bf16 v[168:171], v[80:83], v[120:123], 0
    v_mfma_f32_16x16x32_bf16 v[172:175], v[84:87], v[108:111], v[172:175]
    v_mfma_f32_16x16x32_bf16 v[176:179], v[92:95], v[108:111], v[176:179]
    v_mfma_f32_16x16x32_bf16 v[180:183], v[92:95], v[120:123], v[180:183]
    v_mfma_f32_16x16x32_bf16 v[160:163], v[84:87], v[100:103], v[160:163]
    v_mfma_f32_16x16x32_bf16 v[164:167], v[92:95], v[100:103], v[164:167]
    v_mfma_f32_16x16x32_bf16 v[168:171], v[84:87], v[120:123], v[168:171]
    s_branch L_kvd
L_kv1:
    v_mfma_f32_16x16x32_bf16 v[172:175], v[80:83], v[96:99], 0
    v_mfma_f32_16x16x32_bf16 v[176:179], v[88:91], v[96:99], 0
    v_mfma_f32_16x16x32_bf16 v[180:183], v[80:83], v[120:123], 0
    v_mfma_f32_16x16x32_bf16 v[160:163], v[80:83], v[104:107], 0
    v_mfma_f32_16x16x32_bf16 v[164:167], v[88:91], v[104:107], 0
    v_mfma_f32_16x16x32_bf16 v[168:171], v[88:91], v[120:123], 0
    v_mfma_f32_16x16x32_bf16 v[172:175], v[84:87], v[100:103], v[172:175]
    v_mfma_f32_16x16x32_bf16 v[176:179], v[92:95], v[100:103], v[176:179]
    v_mfma_f32_16x16x32_bf16 v[180:183], v[84:87], v[120:123], v[180:183]
    v_mfma_f32_16x16x32_bf16 v[160:163], v[84:87], v[108:111], v[160:163]
    v_mfma_f32_16x16x32_bf16 v[164:167], v[92:95], v[108:111], v[164:167]
    v_mfma_f32_16x16x32_bf16 v[168:171], v[92:95], v[120:123], v[168:171]
L_kvd:
    s_lshl_b32 s86, s47, 1
    s_add_u32 s86, s86, s50
    s_lshl_b32 s87, s86, 1
    s_add_u32 s87, s87, s49
    s_lshl_b32 s87, s87, 4
    s_add_u32 s87, s87, s46
    s_lshl_b32 s87, s87, 10
    s_add_u32 s87, s87, 5242880
    v_lshl_add_u32 v8, v0, 4, s87
    s_lshl_b32 s87, s86, 4
    s_add_u32 s87, s87, s46
    s_lshl_b32 s87, s87, 7
    s_lshl_b32 s88, s49, 6
    s_add_u32 s87, s87, s88
    s_add_u32 s87, s87, 6881280
    v_lshl_add_u32 v9, v21, 4, s87
    v_cmp_eq_u32 vcc, 0, v22
    v_mov_b32 v10, 2147483648
    s_nop 0
    v_cndmask_b32 v9, v10, v9, vcc
    ds_write_b128 v6, v[172:175] offset:0
    ds_write_b128 v6, v[176:179] offset:1024
    ds_write_b128 v6, v[180:183] offset:2048
    ds_write_b32 v12, v12
    s_lshl_b32 s87, s46, 3
    s_lshl_b32 s88, s49, 2
    s_add_u32 s87, s87, s88
    s_lshl_b32 s87, s87, 5
    s_add_u32 s87, s87, s86
    s_lshl_b32 s87, s87, 10
    s_add_u32 s87, s87, 1048576
    v_lshl_add_u32 v10, v0, 4, s87
    s_mul_i32 s87, s50, 3072
    s_add_u32 s87, s87, 151552
    v_lshl_add_u32 v11, v0, 4, s87
    s_lshl_b32 s87, s86, 1
    s_add_u32 s87, s87, s49
    s_lshl_b32 s87, s87, 5
    s_add_u32 s87, s87, s46
    s_lshl2_add_u32 s87, s87, 671744
    v_mov_b32 v16, 2147483648
    v_mov_b32 v18, 2147483648
    v_writelane_b32 v16, s87, 0
    s_lshl_b32 s87, s46, 1
    s_add_u32 s87, s87, s49
    s_lshl_b32 s87, s87, 1
    s_lshr_b32 s88, s86, 4
    s_add_u32 s87, s87, s88
    s_lshl_b32 s87, s87, 6
    s_and_b32 s88, s86, 15
    s_add_u32 s87, s87, s88
    s_lshl2_add_u32 s87, s87, 688128
    v_writelane_b32 v18, s87, 0
    s_add_u32 s87, s87, 128
    v_writelane_b32 v18, s87, 1
    v_mov_b32 v17, s68
L_xkv:
    ds_read_b32 v14, v13
    ds_read_b128 v[172:175], v7 offset:0
    ds_read_b128 v[176:179], v7 offset:1024
    ds_read_b128 v[180:183], v7 offset:2048
    s_waitcnt lgkmcnt(0)
    v_cmp_eq_u32 vcc, 0, v14
    s_cbranch_vccz L_ok_2
    s_sub_u32 s56, s56, 1
    s_cbranch_scc0 L_xkv
    s_mov_b32 s56, 0
L_ok_2:
    v_pk_add_f32 v[160:161], v[160:161], v[172:173]
    v_pk_add_f32 v[162:163], v[162:163], v[174:175]
    v_pk_add_f32 v[164:165], v[164:165], v[176:177]
    v_pk_add_f32 v[166:167], v[166:167], v[178:179]
    v_pk_add_f32 v[168:169], v[168:169], v[180:181]
    v_pk_add_f32 v[170:171], v[170:171], v[182:183]
    v_cvt_pk_bf16_f32 v184, v160, v161
    v_cvt_pk_bf16_f32 v185, v162, v163
    v_cvt_pk_bf16_f32 v186, v164, v165
    v_cvt_pk_bf16_f32 v187, v166, v167
    buffer_store_dwordx4 v[184:187], v8, s[16:19], 0 offen sc1
    buffer_store_dwordx4 v[168:171], v9, s[16:19], 0 offen sc1
    buffer_atomic_swap v17, v16, s[16:19], 0 offen sc1
    v_pk_fma_f32 v[128:129], v[28:29], v[240:241], v[128:129] op_sel_hi:[1,0,1]
    v_pk_mul_f32 v[112:113], v[128:129], v[248:249] op_sel_hi:[1,0]
    v_pk_fma_f32 v[128:129], v[128:129], v[244:245], s[54:55] op_sel_hi:[1,0,1]
    v_exp_f32 v112, v112 clamp
    v_exp_f32 v113, v113 clamp
    v_max_f32 v128, s54, v128
    v_max_f32 v129, s54, v129
    v_pk_add_f32 v[128:129], v[128:129], v[112:113]
    v_cvt_pk_bf16_f32 v192, v128, v129
    v_pk_fma_f32 v[130:131], v[30:31], v[240:241], v[130:131] op_sel_hi:[1,0,1]
    v_pk_mul_f32 v[114:115], v[130:131], v[248:249] op_sel_hi:[1,0]
    v_pk_fma_f32 v[130:131], v[130:131], v[244:245], s[54:55] op_sel_hi:[1,0,1]
    v_exp_f32 v114, v114 clamp
    v_exp_f32 v115, v115 clamp
    v_max_f32 v130, s54, v130
    v_max_f32 v131, s54, v131
    v_pk_add_f32 v[130:131], v[130:131], v[114:115]
    v_cvt_pk_bf16_f32 v193, v130, v131
    v_pk_fma_f32 v[144:145], v[32:33], v[240:241], v[144:145] op_sel_hi:[1,0,1]
    v_pk_mul_f32 v[116:117], v[144:145], v[248:249] op_sel_hi:[1,0]
    v_pk_fma_f32 v[144:145], v[144:145], v[244:245], s[54:55] op_sel_hi:[1,0,1]
    v_exp_f32 v116, v116 clamp
    v_exp_f32 v117, v117 clamp
    v_max_f32 v144, s54, v144
    v_max_f32 v145, s54, v145
    v_pk_add_f32 v[144:145], v[144:145], v[116:117]
    v_cvt_pk_bf16_f32 v194, v144, v145
    v_pk_fma_f32 v[146:147], v[34:35], v[240:241], v[146:147] op_sel_hi:[1,0,1]
    v_pk_mul_f32 v[118:119], v[146:147], v[248:249] op_sel_hi:[1,0]
    v_pk_fma_f32 v[146:147], v[146:147], v[244:245], s[54:55] op_sel_hi:[1,0,1]
    v_exp_f32 v118, v118 clamp
    v_exp_f32 v119, v119 clamp
    v_max_f32 v146, s54, v146
    v_max_f32 v147, s54, v147
    v_pk_add_f32 v[146:147], v[146:147], v[118:119]
    v_cvt_pk_bf16_f32 v195, v146, v147
    v_pk_fma_f32 v[132:133], v[28:29], v[240:241], v[132:133] op_sel:[0,1,0] op_sel_hi:[1,1,1]
    v_pk_mul_f32 v[112:113], v[132:133], v[248:249] op_sel:[0,1] op_sel_hi:[1,1]
    v_pk_fma_f32 v[132:133], v[132:133], v[244:245], s[54:55] op_sel:[0,1,0] op_sel_hi:[1,1,1]
    v_exp_f32 v112, v112 clamp
    v_exp_f32 v113, v113 clamp
    v_max_f32 v132, s54, v132
    v_max_f32 v133, s54, v133
    v_pk_add_f32 v[132:133], v[132:133], v[112:113]
    v_cvt_pk_bf16_f32 v196, v132, v133
    v_pk_fma_f32 v[134:135], v[30:31], v[240:241], v[134:135] op_sel:[0,1,0] op_sel_hi:[1,1,1]
    v_pk_mul_f32 v[114:115], v[134:135], v[248:249] op_sel:[0,1] op_sel_hi:[1,1]
    v_pk_fma_f32 v[134:135], v[134:135], v[244:245], s[54:55] op_sel:[0,1,0] op_sel_hi:[1,1,1]
    v_exp_f32 v114, v114 clamp
    v_exp_f32 v115, v115 clamp
    v_max_f32 v134, s54, v134
    v_max_f32 v135, s54, v135
    v_pk_add_f32 v[134:135], v[134:135], v[114:115]
    v_cvt_pk_bf16_f32 v197, v134, v135
    v_pk_fma_f32 v[148:149], v[32:33], v[240:241], v[148:149] op_sel:[0,1,0] op_sel_hi:[1,1,1]
    v_pk_mul_f32 v[116:117], v[148:149], v[248:249] op_sel:[0,1] op_sel_hi:[1,1]
    v_pk_fma_f32 v[148:149], v[148:149], v[244:245], s[54:55] op_sel:[0,1,0] op_sel_hi:[1,1,1]
    v_exp_f32 v116, v116 clamp
    v_exp_f32 v117, v117 clamp
    v_max_f32 v148, s54, v148
    v_max_f32 v149, s54, v149
    v_pk_add_f32 v[148:149], v[148:149], v[116:117]
    v_cvt_pk_bf16_f32 v198, v148, v149
    v_pk_fma_f32 v[150:151], v[34:35], v[240:241], v[150:151] op_sel:[0,1,0] op_sel_hi:[1,1,1]
    v_pk_mul_f32 v[118:119], v[150:151], v[248:249] op_sel:[0,1] op_sel_hi:[1,1]
    v_pk_fma_f32 v[150:151], v[150:151], v[244:245], s[54:55] op_sel:[0,1,0] op_sel_hi:[1,1,1]
    v_exp_f32 v118, v118 clamp
    v_exp_f32 v119, v119 clamp
    v_max_f32 v150, s54, v150
    v_max_f32 v151, s54, v151
    v_pk_add_f32 v[150:151], v[150:151], v[118:119]
    v_cvt_pk_bf16_f32 v199, v150, v151
    v_pk_fma_f32 v[136:137], v[28:29], v[242:243], v[136:137] op_sel_hi:[1,0,1]
    v_pk_mul_f32 v[112:113], v[136:137], v[250:251] op_sel_hi:[1,0]
    v_pk_fma_f32 v[136:137], v[136:137], v[246:247], s[54:55] op_sel_hi:[1,0,1]
    v_exp_f32 v112, v112 clamp
    v_exp_f32 v113, v113 clamp
    v_max_f32 v136, s54, v136
    v_max_f32 v137, s54, v137
    v_pk_add_f32 v[136:137], v[136:137], v[112:113]
    v_cvt_pk_bf16_f32 v200, v136, v137
    v_pk_fma_f32 v[138:139], v[30:31], v[242:243], v[138:139] op_sel_hi:[1,0,1]
    v_pk_mul_f32 v[114:115], v[138:139], v[250:251] op_sel_hi:[1,0]
    v_pk_fma_f32 v[138:139], v[138:139], v[246:247], s[54:55] op_sel_hi:[1,0,1]
    v_exp_f32 v114, v114 clamp
    v_exp_f32 v115, v115 clamp
    v_max_f32 v138, s54, v138
    v_max_f32 v139, s54, v139
    v_pk_add_f32 v[138:139], v[138:139], v[114:115]
    v_cvt_pk_bf16_f32 v201, v138, v139
    v_pk_fma_f32 v[152:153], v[32:33], v[242:243], v[152:153] op_sel_hi:[1,0,1]
    v_pk_mul_f32 v[116:117], v[152:153], v[250:251] op_sel_hi:[1,0]
    v_pk_fma_f32 v[152:153], v[152:153], v[246:247], s[54:55] op_sel_hi:[1,0,1]
    v_exp_f32 v116, v116 clamp
    v_exp_f32 v117, v117 clamp
    v_max_f32 v152, s54, v152
    v_max_f32 v153, s54, v153
    v_pk_add_f32 v[152:153], v[152:153], v[116:117]
    v_cvt_pk_bf16_f32 v202, v152, v153
    v_pk_fma_f32 v[154:155], v[34:35], v[242:243], v[154:155] op_sel_hi:[1,0,1]
    v_pk_mul_f32 v[118:119], v[154:155], v[250:251] op_sel_hi:[1,0]
    v_pk_fma_f32 v[154:155], v[154:155], v[246:247], s[54:55] op_sel_hi:[1,0,1]
    v_exp_f32 v118, v118 clamp
    v_exp_f32 v119, v119 clamp
    v_max_f32 v154, s54, v154
    v_max_f32 v155, s54, v155
    v_pk_add_f32 v[154:155], v[154:155], v[118:119]
    v_cvt_pk_bf16_f32 v203, v154, v155
    v_pk_fma_f32 v[140:141], v[28:29], v[242:243], v[140:141] op_sel:[0,1,0] op_sel_hi:[1,1,1]
    v_pk_mul_f32 v[112:113], v[140:141], v[250:251] op_sel:[0,1] op_sel_hi:[1,1]
    v_pk_fma_f32 v[140:141], v[140:141], v[246:247], s[54:55] op_sel:[0,1,0] op_sel_hi:[1,1,1]
    v_exp_f32 v112, v112 clamp
    v_exp_f32 v113, v113 clamp
    v_max_f32 v140, s54, v140
    v_max_f32 v141, s54, v141
    v_pk_add_f32 v[140:141], v[140:141], v[112:113]
    v_cvt_pk_bf16_f32 v204, v140, v141
    v_pk_fma_f32 v[142:143], v[30:31], v[242:243], v[142:143] op_sel:[0,1,0] op_sel_hi:[1,1,1]
    v_pk_mul_f32 v[114:115], v[142:143], v[250:251] op_sel:[0,1] op_sel_hi:[1,1]
    v_pk_fma_f32 v[142:143], v[142:143], v[246:247], s[54:55] op_sel:[0,1,0] op_sel_hi:[1,1,1]
    v_exp_f32 v114, v114 clamp
    v_exp_f32 v115, v115 clamp
    v_max_f32 v142, s54, v142
    v_max_f32 v143, s54, v143
    v_pk_add_f32 v[142:143], v[142:143], v[114:115]
    v_cvt_pk_bf16_f32 v205, v142, v143
    v_pk_fma_f32 v[156:157], v[32:33], v[242:243], v[156:157] op_sel:[0,1,0] op_sel_hi:[1,1,1]
    v_pk_mul_f32 v[116:117], v[156:157], v[250:251] op_sel:[0,1] op_sel_hi:[1,1]
    v_pk_fma_f32 v[156:157], v[156:157], v[246:247], s[54:55] op_sel:[0,1,0] op_sel_hi:[1,1,1]
    v_exp_f32 v116, v116 clamp
    v_exp_f32 v117, v117 clamp
    v_max_f32 v156, s54, v156
    v_max_f32 v157, s54, v157
    v_pk_add_f32 v[156:157], v[156:157], v[116:117]
    v_cvt_pk_bf16_f32 v206, v156, v157
    v_pk_fma_f32 v[158:159], v[34:35], v[242:243], v[158:159] op_sel:[0,1,0] op_sel_hi:[1,1,1]
    v_pk_mul_f32 v[118:119], v[158:159], v[250:251] op_sel:[0,1] op_sel_hi:[1,1]
    v_pk_fma_f32 v[158:159], v[158:159], v[246:247], s[54:55] op_sel:[0,1,0] op_sel_hi:[1,1,1]
    v_exp_f32 v118, v118 clamp
    v_exp_f32 v119, v119 clamp
    v_max_f32 v158, s54, v158
    v_max_f32 v159, s54, v159
    v_pk_add_f32 v[158:159], v[158:159], v[118:119]
    v_cvt_pk_bf16_f32 v207, v158, v159
    s_lshr_b32 s62, s3, 2
    s_lshl_b32 s53, s51, 3
    s_lshl_b32 s86, s48, 1
    s_add_u32 s53, s53, s86
    s_add_u32 s53, s53, s62
    v_lshrrev_b32 v36, 4, v0
    v_and_b32 v37, 15, v0
    s_lshl_b32 s87, s53, 15
    s_lshl_b32 s86, s62, 14
    s_add_u32 s86, s86, s87
    s_add_u32 s86, s86, 1048576
    v_lshl_add_u32 v157, v0, 4, s86
    v_xor_b32 v158, 0x8000, v157
    s_lshl_b32 s86, s51, 1
    s_lshr_b32 s87, s48, 1
    s_add_u32 s86, s86, s87
    s_lshl_b32 s86, s86, 1
    s_add_u32 s86, s86, s62
    s_lshl_b32 s86, s86, 1
    s_and_b32 s87, s48, 1
    s_add_u32 s86, s86, s87
    s_lshl_b32 s86, s86, 7
    s_add_u32 s86, s86, 688128
    v_lshl_add_u32 v159, v0, 2, s86
    v_mov_b32 v38, 2147483648
    v_cmp_gt_u32 vcc, 16, v0
    s_nop 1
    v_cndmask_b32 v159, v38, v159, vcc
    v_bfe_u32 v38, v0, 2, 2
    v_lshl_add_u32 v38, v36, 2, v38
    v_bfe_u32 v39, v38, 1, 2
    v_lshlrev_b32 v38, 7, v38
    v_lshl_add_u32 v38, v39, 5, v38
    v_and_b32 v39, 3, v0
    v_lshl_add_u32 v38, v39, 3, v38
    s_lshl_b32 s86, s62, 16
    s_add_u32 s86, s86, 0
    v_add_u32 v144, s86, v38
    v_xor_b32 v145, 32, v144
    v_xor_b32 v146, 64, v144
    v_xor_b32 v147, 96, v144
    v_cmp_eq_u32 s[4:5], 1, v39
    v_cmp_eq_u32 s[6:7], 2, v39
    v_cmp_eq_u32 s[98:99], 3, v39
    s_lshl_b32 s86, s53, 8
    s_add_u32 s86, s86, 589824
    v_lshl_add_u32 v160, v0, 2, s86
    s_mov_b32 s72, 0x00f0000f
    s_mov_b32 s73, 0xf0000f00
    s_mov_b32 s74, 0x0f00f000
    s_mov_b32 s75, 0x0f00f000
    v_lshrrev_b32 v38, 2, v37
    v_lshl_add_u32 v161, v38, 4, v37
    v_lshlrev_b32 v161, 2, v161
    s_lshl_b32 s86, s3, 12
    s_add_u32 s86, s86, 131072
    v_lshl_add_u32 v162, v0, 4, s86
    v_xor_b32 v163, 0x4000, v162
    s_lshl_b32 s86, s52, 7
    v_lshl_add_u32 v36, v36, 3, s86
    s_lshl_b32 s87, s53, 15
    s_add_u32 s87, s87, s86
    s_lshl_b32 s86, s62, 6
    s_add_u32 s87, s87, s86
    v_lshl_add_u32 v39, v37, 11, s87
    v_and_b32 v38, 48, v0
    v_add_u32 v39, v39, v38
    v_xor_b32 v37, 0x8000, v39
    buffer_load_dwordx4 v[136:139], v39, s[8:11], 0 offen
    buffer_load_dwordx4 v[140:143], v37, s[8:11], 0 offen
    buffer_load_dwordx2 v[148:149], v36, s[40:43], 0 offen offset:0
    buffer_load_dwordx2 v[150:151], v36, s[40:43], 0 offen offset:32
    buffer_load_dwordx2 v[152:153], v36, s[40:43], 0 offen offset:64
    buffer_load_dwordx2 v[154:155], v36, s[40:43], 0 offen offset:96
    s_barrier
    ds_read_b128 v[40:43], v11 offset:0
    ds_read_b128 v[44:47], v11 offset:1024
    ds_read_b128 v[48:51], v11 offset:2048
    v_mov_b32 v38, 135200
    ds_read_b32 v38, v38
    s_mov_b32 s86, 0x8000
    s_mov_b32 s87, 0x10000
    s_mov_b32 s88, 0x18000
    s_waitcnt lgkmcnt(0)
    v_mfma_f32_16x16x32_bf16 v[216:219], v[48:51], v[192:195], 0
    v_mfma_f32_16x16x32_bf16 v[208:211], v[40:43], v[192:195], 0
    v_mfma_f32_16x16x32_bf16 v[212:215], v[44:47], v[192:195], 0
    v_mfma_f32_16x16x32_bf16 v[228:231], v[48:51], v[196:199], 0
    v_mfma_f32_16x16x32_bf16 v[220:223], v[40:43], v[196:199], 0
    v_mfma_f32_16x16x32_bf16 v[224:227], v[44:47], v[196:199], 0
    v_mfma_f32_16x16x32_bf16 v[240:243], v[48:51], v[200:203], 0
    v_mfma_f32_16x16x32_bf16 v[232:235], v[40:43], v[200:203], 0
    v_mfma_f32_16x16x32_bf16 v[236:239], v[44:47], v[200:203], 0
    v_mfma_f32_16x16x32_bf16 v[252:255], v[48:51], v[204:207], 0
    v_mfma_f32_16x16x32_bf16 v[244:247], v[40:43], v[204:207], 0
    v_mfma_f32_16x16x32_bf16 v[248:251], v[44:47], v[204:207], 0
    v_add_f32 v216, s54, v216
    v_rcp_f32 v216, v216
    s_nop 0
    v_pk_mul_f32 v[208:209], v[208:209], v[216:217] op_sel_hi:[1,0]
    v_pk_mul_f32 v[210:211], v[210:211], v[216:217] op_sel_hi:[1,0]
    v_pk_mul_f32 v[212:213], v[212:213], v[216:217] op_sel_hi:[1,0]
    v_pk_mul_f32 v[214:215], v[214:215], v[216:217] op_sel_hi:[1,0]
    v_cvt_pk_bf16_f32 v60, v208, v209
    v_cvt_pk_bf16_f32 v61, v210, v211
    v_cvt_pk_bf16_f32 v62, v212, v213
    v_cvt_pk_bf16_f32 v63, v214, v215
    buffer_store_dwordx4 v[60:63], v10, s[16:19], 0 offen sc1
    v_add_f32 v228, s54, v228
    v_rcp_f32 v228, v228
    s_nop 0
    v_pk_mul_f32 v[220:221], v[220:221], v[228:229] op_sel_hi:[1,0]
    v_pk_mul_f32 v[222:223], v[222:223], v[228:229] op_sel_hi:[1,0]
    v_pk_mul_f32 v[224:225], v[224:225], v[228:229] op_sel_hi:[1,0]
    v_pk_mul_f32 v[226:227], v[226:227], v[228:229] op_sel_hi:[1,0]
    v_cvt_pk_bf16_f32 v64, v220, v221
    v_cvt_pk_bf16_f32 v65, v222, v223
    v_cvt_pk_bf16_f32 v66, v224, v225
    v_cvt_pk_bf16_f32 v67, v226, v227
    buffer_store_dwordx4 v[64:67], v10, s[16:19], s86 offen sc1
    v_add_f32 v240, s54, v240
    v_rcp_f32 v240, v240
    s_nop 0
    v_pk_mul_f32 v[232:233], v[232:233], v[240:241] op_sel_hi:[1,0]
    v_pk_mul_f32 v[234:235], v[234:235], v[240:241] op_sel_hi:[1,0]
    v_pk_mul_f32 v[236:237], v[236:237], v[240:241] op_sel_hi:[1,0]
    v_pk_mul_f32 v[238:239], v[238:239], v[240:241] op_sel_hi:[1,0]
    v_cvt_pk_bf16_f32 v68, v232, v233
    v_cvt_pk_bf16_f32 v69, v234, v235
    v_cvt_pk_bf16_f32 v70, v236, v237
    v_cvt_pk_bf16_f32 v71, v238, v239
    buffer_store_dwordx4 v[68:71], v10, s[16:19], s87 offen sc1
    v_add_f32 v252, s54, v252
    v_rcp_f32 v252, v252
    s_nop 0
    v_pk_mul_f32 v[244:245], v[244:245], v[252:253] op_sel_hi:[1,0]
    v_pk_mul_f32 v[246:247], v[246:247], v[252:253] op_sel_hi:[1,0]
    v_pk_mul_f32 v[248:249], v[248:249], v[252:253] op_sel_hi:[1,0]
    v_pk_mul_f32 v[250:251], v[250:251], v[252:253] op_sel_hi:[1,0]
    v_cvt_pk_bf16_f32 v72, v244, v245
    v_cvt_pk_bf16_f32 v73, v246, v247
    v_cvt_pk_bf16_f32 v74, v248, v249
    v_cvt_pk_bf16_f32 v75, v250, v251
    buffer_store_dwordx4 v[72:75], v10, s[16:19], s88 offen sc1
    buffer_atomic_swap v17, v18, s[16:19], 0 offen sc1
    v_mov_b32 v8, 0
    buffer_atomic_or v8, v159, s[16:19], 0 offen sc0 sc1
    v_mov_b32 v14, 2147483648
    v_mov_b32 v11, 2147483648
    s_waitcnt vmcnt(6)
    v_bfe_u32 v36, v0, 2, 1
    v_cmp_eq_u32 vcc, 1, v36
    v_mov_b32 v36, s95
    s_nop 0
    v_cndmask_b32 v148, v36, v148, vcc
    v_cndmask_b32 v149, v36, v149, vcc
    v_cndmask_b32 v150, v36, v150, vcc
    v_cndmask_b32 v151, v36, v151, vcc
    v_cndmask_b32 v152, v36, v152, vcc
    v_cndmask_b32 v153, v36, v153, vcc
    v_cndmask_b32 v154, v36, v154, vcc
    v_cndmask_b32 v155, v36, v155, vcc
    v_readfirstlane_b32 s57, v38
L_phaseB:
    v_lshrrev_b32 v1, 4, v0
    v_and_b32 v2, 15, v0
    v_mov_b32 v3, 0x3f80
    s_lshl_b32 s87, s53, 4
    v_add_u32 v6, s87, v2
    s_lshl_b32 s86, s52, 7
    v_lshl_add_u32 v5, v6, 11, s86
    v_sub_u32 v6, 2047, v6
    v_mov_b32 v7, v39
    v_lshrrev_b32 v9, 1, v1
    v_lshl_add_u32 v5, v9, 4, v5
    v_and_b32 v9, 1, v1
    v_lshl_add_u32 v5, v9, 5, v5
    s_mov_b32 s67, 0
    s_mov_b32 s66, 0xffffaaaa
    s_mov_b32 s63, 0
L_b_init:
    v_bfe_u32 v9, v0, 3, 1
    v_bfe_u32 v10, v0, 4, 1
    v_xor_b32 v9, v9, v10
    v_bfe_u32 v10, v0, 1, 2
    v_lshl_add_u32 v9, v9, 3, v10
    v_lshrrev_b32 v10, 5, v0
    v_lshl_add_u32 v9, v10, 2, v9
    v_and_b32 v10, 1, v0
    v_lshlrev_b32 v10, 4, v10
    v_lshlrev_b32 v10, v10, v3
    v_cmp_eq_u32 vcc, 0, v9
    s_nop 1
    v_cndmask_b32 v128, 0, v10, vcc
    v_cmp_eq_u32 vcc, 1, v9
    s_nop 1
    v_cndmask_b32 v129, 0, v10, vcc
    v_cmp_eq_u32 vcc, 2, v9
    s_nop 1
    v_cndmask_b32 v130, 0, v10, vcc
    v_cmp_eq_u32 vcc, 3, v9
    s_nop 1
    v_cndmask_b32 v131, 0, v10, vcc
    v_cmp_eq_u32 vcc, 4, v9
    s_nop 1
    v_cndmask_b32 v132, 0, v10, vcc
    v_cmp_eq_u32 vcc, 5, v9
    s_nop 1
    v_cndmask_b32 v133, 0, v10, vcc
    v_cmp_eq_u32 vcc, 6, v9
    s_nop 1
    v_cndmask_b32 v134, 0, v10, vcc
    v_cmp_eq_u32 vcc, 7, v9
    s_nop 1
    v_cndmask_b32 v135, 0, v10, vcc
    v_mov_b32 v80, 0
    v_mov_b32 v81, 0
    v_mov_b32 v82, 0
    v_mov_b32 v83, 0
    v_mov_b32 v84, 0
    v_mov_b32 v85, 0
    v_mov_b32 v86, 0
    v_mov_b32 v87, 0
    v_mov_b32 v88, 0
    v_mov_b32 v89, 0
    v_mov_b32 v90, 0
    v_mov_b32 v91, 0
    v_mov_b32 v92, 0
    v_mov_b32 v93, 0
    v_mov_b32 v94, 0
    v_mov_b32 v95, 0
    v_mov_b32 v96, 0
    v_mov_b32 v97, 0
    v_mov_b32 v98, 0
    v_mov_b32 v99, 0
    v_mov_b32 v100, 0
    v_mov_b32 v101, 0
    v_mov_b32 v102, 0
    v_mov_b32 v103, 0
    v_mov_b32 v104, 0
    v_mov_b32 v105, 0
    v_mov_b32 v106, 0
    v_mov_b32 v107, 0
    v_mov_b32 v108, 0
    v_mov_b32 v109, 0
    v_mov_b32 v110, 0
    v_mov_b32 v111, 0
    v_mov_b32 v156, 0
    s_branch L_b_w0
L_b_r0:
    s_ff1_i32_b32 s91, s65
    s_bitset0_b32 s65, s91
    s_lshl_b32 s76, s91, 12
    s_lshl_b32 s91, s91, 10
    buffer_load_dwordx4 v[16:19], v157, s[16:19], s91 offen offset:0 sc1
    buffer_load_dwordx4 v[20:23], v158, s[16:19], s91 offen offset:0 sc1
    buffer_load_dwordx4 v[24:27], v157, s[16:19], s91 offen offset:1024 sc1
    buffer_load_dwordx4 v[28:31], v158, s[16:19], s91 offen offset:1024 sc1
    s_cmp_eq_u32 s65, 0
    s_cbranch_scc1 L_b_p1
L_b_r1:
    s_ff1_i32_b32 s91, s65
    s_bitset0_b32 s65, s91
    s_lshl_b32 s77, s91, 12
    s_lshl_b32 s91, s91, 10
    buffer_load_dwordx4 v[32:35], v157, s[16:19], s91 offen offset:0 sc1
    buffer_load_dwordx4 v[36:39], v158, s[16:19], s91 offen offset:0 sc1
    buffer_load_dwordx4 v[40:43], v157, s[16:19], s91 offen offset:1024 sc1
    buffer_load_dwordx4 v[44:47], v158, s[16:19], s91 offen offset:1024 sc1
    s_xor_b32 s89, s67, s76
    s_mov_b32 s67, s76
    v_xor_b32 v144, s89, v144
    ds_read_b64_tr_b16 v[112:113], v144 offset:0
    ds_read_b64_tr_b16 v[114:115], v144 offset:2048
    v_xor_b32 v145, s89, v145
    ds_read_b64_tr_b16 v[116:117], v145 offset:0
    ds_read_b64_tr_b16 v[118:119], v145 offset:2048
    v_xor_b32 v146, s89, v146
    ds_read_b64_tr_b16 v[120:121], v146 offset:0
    ds_read_b64_tr_b16 v[122:123], v146 offset:2048
    v_xor_b32 v147, s89, v147
    ds_read_b64_tr_b16 v[124:125], v147 offset:0
    ds_read_b64_tr_b16 v[126:127], v147 offset:2048
    s_cmp_eq_u32 s62, 0
    s_cbranch_scc0 L_b_x1
    v_mfma_f32_16x16x32_bf16 v[80:83], v[128:131], v[136:139], 0
    v_mfma_f32_16x16x32_bf16 v[96:99], v[128:131], v[140:143], 0
    v_mfma_f32_16x16x32_bf16 v[84:87], v[132:135], v[136:139], 0
    v_mfma_f32_16x16x32_bf16 v[100:103], v[132:135], v[140:143], 0
    s_branch L_b_xd
L_b_x1:
    v_mfma_f32_16x16x32_bf16 v[88:91], v[128:131], v[136:139], 0
    v_mfma_f32_16x16x32_bf16 v[104:107], v[128:131], v[140:143], 0
    v_mfma_f32_16x16x32_bf16 v[92:95], v[132:135], v[136:139], 0
    v_mfma_f32_16x16x32_bf16 v[108:111], v[132:135], v[140:143], 0
L_b_xd:
    s_waitcnt vmcnt(6) lgkmcnt(6)
    v_max3_u32 v156, v156, v19, v23
    v_mfma_f32_16x16x32_bf16 v[80:83], v[112:115], v[16:19], v[80:83]
    ds_read_b64_tr_b16 v[128:129], v144 offset:4096
    v_mfma_f32_16x16x32_bf16 v[96:99], v[112:115], v[20:23], v[96:99]
    ds_read_b64_tr_b16 v[130:131], v144 offset:6144
    s_waitcnt lgkmcnt(6)
    v_mfma_f32_16x16x32_bf16 v[84:87], v[116:119], v[16:19], v[84:87]
    ds_read_b64_tr_b16 v[132:133], v145 offset:4096
    v_mfma_f32_16x16x32_bf16 v[100:103], v[116:119], v[20:23], v[100:103]
    ds_read_b64_tr_b16 v[134:135], v145 offset:6144
    s_waitcnt lgkmcnt(6)
    v_mfma_f32_16x16x32_bf16 v[88:91], v[120:123], v[16:19], v[88:91]
    ds_read_b64_tr_b16 v[136:137], v146 offset:4096
    v_mfma_f32_16x16x32_bf16 v[104:107], v[120:123], v[20:23], v[104:107]
    ds_read_b64_tr_b16 v[138:139], v146 offset:6144
    s_waitcnt lgkmcnt(6)
    v_mfma_f32_16x16x32_bf16 v[92:95], v[124:127], v[16:19], v[92:95]
    ds_read_b64_tr_b16 v[140:141], v147 offset:4096
    v_mfma_f32_16x16x32_bf16 v[108:111], v[124:127], v[20:23], v[108:111]
    ds_read_b64_tr_b16 v[142:143], v147 offset:6144
    s_cmp_eq_u32 s65, 0
    s_cbranch_scc1 L_b_p2
L_b_r2:
    s_ff1_i32_b32 s91, s65
    s_bitset0_b32 s65, s91
    s_lshl_b32 s78, s91, 12
    s_lshl_b32 s91, s91, 10
    buffer_load_dwordx4 v[48:51], v157, s[16:19], s91 offen offset:0 sc1
    buffer_load_dwordx4 v[52:55], v158, s[16:19], s91 offen offset:0 sc1
    s_waitcnt vmcnt(6) lgkmcnt(6)
    v_max3_u32 v156, v156, v27, v31
    v_mfma_f32_16x16x32_bf16 v[80:83], v[128:131], v[24:27], v[80:83]
    s_xor_b32 s89, s67, s77
    s_mov_b32 s67, s77
    v_xor_b32 v144, s89, v144
    ds_read_b64_tr_b16 v[112:113], v144 offset:0
    v_mfma_f32_16x16x32_bf16 v[96:99], v[128:131], v[28:31], v[96:99]
    ds_read_b64_tr_b16 v[114:115], v144 offset:2048
    s_waitcnt lgkmcnt(6)
    v_mfma_f32_16x16x32_bf16 v[84:87], v[132:135], v[24:27], v[84:87]
    v_xor_b32 v145, s89, v145
    ds_read_b64_tr_b16 v[116:117], v145 offset:0
    v_mfma_f32_16x16x32_bf16 v[100:103], v[132:135], v[28:31], v[100:103]
    ds_read_b64_tr_b16 v[118:119], v145 offset:2048
    s_waitcnt lgkmcnt(6)
    v_mfma_f32_16x16x32_bf16 v[88:91], v[136:139], v[24:27], v[88:91]
    v_xor_b32 v146, s89, v146
    ds_read_b64_tr_b16 v[120:121], v146 offset:0
    v_mfma_f32_16x16x32_bf16 v[104:107], v[136:139], v[28:31], v[104:107]
    ds_read_b64_tr_b16 v[122:123], v146 offset:2048
    s_waitcnt lgkmcnt(6)
    v_mfma_f32_16x16x32_bf16 v[92:95], v[140:143], v[24:27], v[92:95]
    v_xor_b32 v147, s89, v147
    ds_read_b64_tr_b16 v[124:125], v147 offset:0
    v_mfma_f32_16x16x32_bf16 v[108:111], v[140:143], v[28:31], v[108:111]
    ds_read_b64_tr_b16 v[126:127], v147 offset:2048
    buffer_load_dwordx4 v[56:59], v157, s[16:19], s91 offen offset:1024 sc1
    buffer_load_dwordx4 v[60:63], v158, s[16:19], s91 offen offset:1024 sc1
    s_waitcnt vmcnt(6) lgkmcnt(6)
    v_max3_u32 v156, v156, v35, v39
    v_mfma_f32_16x16x32_bf16 v[80:83], v[112:115], v[32:35], v[80:83]
    ds_read_b64_tr_b16 v[128:129], v144 offset:4096
    v_mfma_f32_16x16x32_bf16 v[96:99], v[112:115], v[36:39], v[96:99]
    ds_read_b64_tr_b16 v[130:131], v144 offset:6144
    s_waitcnt lgkmcnt(6)
    v_mfma_f32_16x16x32_bf16 v[84:87], v[116:119], v[32:35], v[84:87]
    ds_read_b64_tr_b16 v[132:133], v145 offset:4096
    v_mfma_f32_16x16x32_bf16 v[100:103], v[116:119], v[36:39], v[100:103]
    ds_read_b64_tr_b16 v[134:135], v145 offset:6144
    s_waitcnt lgkmcnt(6)
    v_mfma_f32_16x16x32_bf16 v[88:91], v[120:123], v[32:35], v[88:91]
    ds_read_b64_tr_b16 v[136:137], v146 offset:4096
    v_mfma_f32_16x16x32_bf16 v[104:107], v[120:123], v[36:39], v[104:107]
    ds_read_b64_tr_b16 v[138:139], v146 offset:6144
    s_waitcnt lgkmcnt(6)
    v_mfma_f32_16x16x32_bf16 v[92:95], v[124:127], v[32:35], v[92:95]
    ds_read_b64_tr_b16 v[140:141], v147 offset:4096
    v_mfma_f32_16x16x32_bf16 v[108:111], v[124:127], v[36:39], v[108:111]
    ds_read_b64_tr_b16 v[142:143], v147 offset:6144
    s_cmp_eq_u32 s65, 0
    s_cbranch_scc1 L_b_p3
L_b_r3:
    s_ff1_i32_b32 s91, s65
    s_bitset0_b32 s65, s91
    s_lshl_b32 s79, s91, 12
    s_lshl_b32 s91, s91, 10
    buffer_load_dwordx4 v[64:67], v157, s[16:19], s91 offen offset:0 sc1
    buffer_load_dwordx4 v[68:71], v158, s[16:19], s91 offen offset:0 sc1
    s_waitcnt vmcnt(6) lgkmcnt(6)
    v_max3_u32 v156, v156, v43, v47
    v_mfma_f32_16x16x32_bf16 v[80:83], v[128:131], v[40:43], v[80:83]
    s_xor_b32 s89, s67, s78
    s_mov_b32 s67, s78
    v_xor_b32 v144, s89, v144
    ds_read_b64_tr_b16 v[112:113], v144 offset:0
    v_mfma_f32_16x16x32_bf16 v[96:99], v[128:131], v[44:47], v[96:99]
    ds_read_b64_tr_b16 v[114:115], v144 offset:2048
    s_waitcnt lgkmcnt(6)
    v_mfma_f32_16x16x32_bf16 v[84:87], v[132:135], v[40:43], v[84:87]
    v_xor_b32 v145, s89, v145
    ds_read_b64_tr_b16 v[116:117], v145 offset:0
    v_mfma_f32_16x16x32_bf16 v[100:103], v[132:135], v[44:47], v[100:103]
    ds_read_b64_tr_b16 v[118:119], v145 offset:2048
    s_waitcnt lgkmcnt(6)
    v_mfma_f32_16x16x32_bf16 v[88:91], v[136:139], v[40:43], v[88:91]
    v_xor_b32 v146, s89, v146
    ds_read_b64_tr_b16 v[120:121], v146 offset:0
    v_mfma_f32_16x16x32_bf16 v[104:107], v[136:139], v[44:47], v[104:107]
    ds_read_b64_tr_b16 v[122:123], v146 offset:2048
    s_waitcnt lgkmcnt(6)
    v_mfma_f32_16x16x32_bf16 v[92:95], v[140:143], v[40:43], v[92:95]
    v_xor_b32 v147, s89, v147
    ds_read_b64_tr_b16 v[124:125], v147 offset:0
    v_mfma_f32_16x16x32_bf16 v[108:111], v[140:143], v[44:47], v[108:111]
    ds_read_b64_tr_b16 v[126:127], v147 offset:2048
    buffer_load_dwordx4 v[72:75], v157, s[16:19], s91 offen offset:1024 sc1
    buffer_load_dwordx4 v[76:79], v158, s[16:19], s91 offen offset:1024 sc1
    s_waitcnt vmcnt(6) lgkmcnt(6)
    v_max3_u32 v156, v156, v51, v55
    v_mfma_f32_16x16x32_bf16 v[80:83], v[112:115], v[48:51], v[80:83]
    ds_read_b64_tr_b16 v[128:129], v144 offset:4096
    v_mfma_f32_16x16x32_bf16 v[96:99], v[112:115], v[52:55], v[96:99]
    ds_read_b64_tr_b16 v[130:131], v144 offset:6144
    s_waitcnt lgkmcnt(6)
    v_mfma_f32_16x16x32_bf16 v[84:87], v[116:119], v[48:51], v[84:87]
    ds_read_b64_tr_b16 v[132:133], v145 offset:4096
    v_mfma_f32_16x16x32_bf16 v[100:103], v[116:119], v[52:55], v[100:103]
    ds_read_b64_tr_b16 v[134:135], v145 offset:6144
    s_waitcnt lgkmcnt(6)
    v_mfma_f32_16x16x32_bf16 v[88:91], v[120:123], v[48:51], v[88:91]
    ds_read_b64_tr_b16 v[136:137], v146 offset:4096
    v_mfma_f32_16x16x32_bf16 v[104:107], v[120:123], v[52:55], v[104:107]
    ds_read_b64_tr_b16 v[138:139], v146 offset:6144
    s_waitcnt lgkmcnt(6)
    v_mfma_f32_16x16x32_bf16 v[92:95], v[124:127], v[48:51], v[92:95]
    ds_read_b64_tr_b16 v[140:141], v147 offset:4096
    v_mfma_f32_16x16x32_bf16 v[108:111], v[124:127], v[52:55], v[108:111]
    ds_read_b64_tr_b16 v[142:143], v147 offset:6144
    s_cmp_eq_u32 s65, 0
    s_cbranch_scc1 L_b_p4
L_b_r4:
    s_ff1_i32_b32 s91, s65
    s_bitset0_b32 s65, s91
    s_lshl_b32 s76, s91, 12
    s_lshl_b32 s91, s91, 10
    buffer_load_dwordx4 v[16:19], v157, s[16:19], s91 offen offset:0 sc1
    buffer_load_dwordx4 v[20:23], v158, s[16:19], s91 offen offset:0 sc1
    s_waitcnt vmcnt(6) lgkmcnt(6)
    v_max3_u32 v156, v156, v59, v63
    v_mfma_f32_16x16x32_bf16 v[80:83], v[128:131], v[56:59], v[80:83]
    s_xor_b32 s89, s67, s79
    s_mov_b32 s67, s79
    v_xor_b32 v144, s89, v144
    ds_read_b64_tr_b16 v[112:113], v144 offset:0
    v_mfma_f32_16x16x32_bf16 v[96:99], v[128:131], v[60:63], v[96:99]
    ds_read_b64_tr_b16 v[114:115], v144 offset:2048
    s_waitcnt lgkmcnt(6)
    v_mfma_f32_16x16x32_bf16 v[84:87], v[132:135], v[56:59], v[84:87]
    v_xor_b32 v145, s89, v145
    ds_read_b64_tr_b16 v[116:117], v145 offset:0
    v_mfma_f32_16x16x32_bf16 v[100:103], v[132:135], v[60:63], v[100:103]
    ds_read_b64_tr_b16 v[118:119], v145 offset:2048
    s_waitcnt lgkmcnt(6)
    v_mfma_f32_16x16x32_bf16 v[88:91], v[136:139], v[56:59], v[88:91]
    v_xor_b32 v146, s89, v146
    ds_read_b64_tr_b16 v[120:121], v146 offset:0
    v_mfma_f32_16x16x32_bf16 v[104:107], v[136:139], v[60:63], v[104:107]
    ds_read_b64_tr_b16 v[122:123], v146 offset:2048
    s_waitcnt lgkmcnt(6)
    v_mfma_f32_16x16x32_bf16 v[92:95], v[140:143], v[56:59], v[92:95]
    v_xor_b32 v147, s89, v147
    ds_read_b64_tr_b16 v[124:125], v147 offset:0
    v_mfma_f32_16x16x32_bf16 v[108:111], v[140:143], v[60:63], v[108:111]
    ds_read_b64_tr_b16 v[126:127], v147 offset:2048
    buffer_load_dwordx4 v[24:27], v157, s[16:19], s91 offen offset:1024 sc1
    buffer_load_dwordx4 v[28:31], v158, s[16:19], s91 offen offset:1024 sc1
    s_waitcnt vmcnt(6) lgkmcnt(6)
    v_max3_u32 v156, v156, v67, v71
    v_mfma_f32_16x16x32_bf16 v[80:83], v[112:115], v[64:67], v[80:83]
    ds_read_b64_tr_b16 v[128:129], v144 offset:4096
    v_mfma_f32_16x16x32_bf16 v[96:99], v[112:115], v[68:71], v[96:99]
    ds_read_b64_tr_b16 v[130:131], v144 offset:6144
    s_waitcnt lgkmcnt(6)
    v_mfma_f32_16x16x32_bf16 v[84:87], v[116:119], v[64:67], v[84:87]
    ds_read_b64_tr_b16 v[132:133], v145 offset:4096
    v_mfma_f32_16x16x32_bf16 v[100:103], v[116:119], v[68:71], v[100:103]
    ds_read_b64_tr_b16 v[134:135], v145 offset:6144
    s_waitcnt lgkmcnt(6)
    v_mfma_f32_16x16x32_bf16 v[88:91], v[120:123], v[64:67], v[88:91]
    ds_read_b64_tr_b16 v[136:137], v146 offset:4096
    v_mfma_f32_16x16x32_bf16 v[104:107], v[120:123], v[68:71], v[104:107]
    ds_read_b64_tr_b16 v[138:139], v146 offset:6144
    s_waitcnt lgkmcnt(6)
    v_mfma_f32_16x16x32_bf16 v[92:95], v[124:127], v[64:67], v[92:95]
    ds_read_b64_tr_b16 v[140:141], v147 offset:4096
    v_mfma_f32_16x16x32_bf16 v[108:111], v[124:127], v[68:71], v[108:111]
    ds_read_b64_tr_b16 v[142:143], v147 offset:6144
    s_cmp_eq_u32 s65, 0
    s_cbranch_scc1 L_b_p5
L_b_r5:
    s_ff1_i32_b32 s91, s65
    s_bitset0_b32 s65, s91
    s_lshl_b32 s77, s91, 12
    s_lshl_b32 s91, s91, 10
    buffer_load_dwordx4 v[32:35], v157, s[16:19], s91 offen offset:0 sc1
    buffer_load_dwordx4 v[36:39], v158, s[16:19], s91 offen offset:0 sc1
    s_waitcnt vmcnt(6) lgkmcnt(6)
    v_max3_u32 v156, v156, v75, v79
    v_mfma_f32_16x16x32_bf16 v[80:83], v[128:131], v[72:75], v[80:83]
    s_xor_b32 s89, s67, s76
    s_mov_b32 s67, s76
    v_xor_b32 v144, s89, v144
    ds_read_b64_tr_b16 v[112:113], v144 offset:0
    v_mfma_f32_16x16x32_bf16 v[96:99], v[128:131], v[76:79], v[96:99]
    ds_read_b64_tr_b16 v[114:115], v144 offset:2048
    s_waitcnt lgkmcnt(6)
    v_mfma_f32_16x16x32_bf16 v[84:87], v[132:135], v[72:75], v[84:87]
    v_xor_b32 v145, s89, v145
    ds_read_b64_tr_b16 v[116:117], v145 offset:0
    v_mfma_f32_16x16x32_bf16 v[100:103], v[132:135], v[76:79], v[100:103]
    ds_read_b64_tr_b16 v[118:119], v145 offset:2048
    s_waitcnt lgkmcnt(6)
    v_mfma_f32_16x16x32_bf16 v[88:91], v[136:139], v[72:75], v[88:91]
    v_xor_b32 v146, s89, v146
    ds_read_b64_tr_b16 v[120:121], v146 offset:0
    v_mfma_f32_16x16x32_bf16 v[104:107], v[136:139], v[76:79], v[104:107]
    ds_read_b64_tr_b16 v[122:123], v146 offset:2048
    s_waitcnt lgkmcnt(6)
    v_mfma_f32_16x16x32_bf16 v[92:95], v[140:143], v[72:75], v[92:95]
    v_xor_b32 v147, s89, v147
    ds_read_b64_tr_b16 v[124:125], v147 offset:0
    v_mfma_f32_16x16x32_bf16 v[108:111], v[140:143], v[76:79], v[108:111]
    ds_read_b64_tr_b16 v[126:127], v147 offset:2048
    buffer_load_dwordx4 v[40:43], v157, s[16:19], s91 offen offset:1024 sc1
    buffer_load_dwordx4 v[44:47], v158, s[16:19], s91 offen offset:1024 sc1
    s_waitcnt vmcnt(6) lgkmcnt(6)
    v_max3_u32 v156, v156, v19, v23
    v_mfma_f32_16x16x32_bf16 v[80:83], v[112:115], v[16:19], v[80:83]
    ds_read_b64_tr_b16 v[128:129], v144 offset:4096
    v_mfma_f32_16x16x32_bf16 v[96:99], v[112:115], v[20:23], v[96:99]
    ds_read_b64_tr_b16 v[130:131], v144 offset:6144
    s_waitcnt lgkmcnt(6)
    v_mfma_f32_16x16x32_bf16 v[84:87], v[116:119], v[16:19], v[84:87]
    ds_read_b64_tr_b16 v[132:133], v145 offset:4096
    v_mfma_f32_16x16x32_bf16 v[100:103], v[116:119], v[20:23], v[100:103]
    ds_read_b64_tr_b16 v[134:135], v145 offset:6144
    s_waitcnt lgkmcnt(6)
    v_mfma_f32_16x16x32_bf16 v[88:91], v[120:123], v[16:19], v[88:91]
    ds_read_b64_tr_b16 v[136:137], v146 offset:4096
    v_mfma_f32_16x16x32_bf16 v[104:107], v[120:123], v[20:23], v[104:107]
    ds_read_b64_tr_b16 v[138:139], v146 offset:6144
    s_waitcnt lgkmcnt(6)
    v_mfma_f32_16x16x32_bf16 v[92:95], v[124:127], v[16:19], v[92:95]
    ds_read_b64_tr_b16 v[140:141], v147 offset:4096
    v_mfma_f32_16x16x32_bf16 v[108:111], v[124:127], v[20:23], v[108:111]
    ds_read_b64_tr_b16 v[142:143], v147 offset:6144
    s_cmp_eq_u32 s65, 0
    s_cbranch_scc1 L_b_p6
L_b_r6:
    s_ff1_i32_b32 s91, s65
    s_bitset0_b32 s65, s91
    s_lshl_b32 s78, s91, 12
    s_lshl_b32 s91, s91, 10
    buffer_load_dwordx4 v[48:51], v157, s[16:19], s91 offen offset:0 sc1
    buffer_load_dwordx4 v[52:55], v158, s[16:19], s91 offen offset:0 sc1
    s_waitcnt vmcnt(6) lgkmcnt(6)
    v_max3_u32 v156, v156, v27, v31
    v_mfma_f32_16x16x32_bf16 v[80:83], v[128:131], v[24:27], v[80:83]
    s_xor_b32 s89, s67, s77
    s_mov_b32 s67, s77
    v_xor_b32 v144, s89, v144
    ds_read_b64_tr_b16 v[112:113], v144 offset:0
    v_mfma_f32_16x16x32_bf16 v[96:99], v[128:131], v[28:31], v[96:99]
    ds_read_b64_tr_b16 v[114:115], v144 offset:2048
    s_waitcnt lgkmcnt(6)
    v_mfma_f32_16x16x32_bf16 v[84:87], v[132:135], v[24:27], v[84:87]
    v_xor_b32 v145, s89, v145
    ds_read_b64_tr_b16 v[116:117], v145 offset:0
    v_mfma_f32_16x16x32_bf16 v[100:103], v[132:135], v[28:31], v[100:103]
    ds_read_b64_tr_b16 v[118:119], v145 offset:2048
    s_waitcnt lgkmcnt(6)
    v_mfma_f32_16x16x32_bf16 v[88:91], v[136:139], v[24:27], v[88:91]
    v_xor_b32 v146, s89, v146
    ds_read_b64_tr_b16 v[120:121], v146 offset:0
    v_mfma_f32_16x16x32_bf16 v[104:107], v[136:139], v[28:31], v[104:107]
    ds_read_b64_tr_b16 v[122:123], v146 offset:2048
    s_waitcnt lgkmcnt(6)
    v_mfma_f32_16x16x32_bf16 v[92:95], v[140:143], v[24:27], v[92:95]
    v_xor_b32 v147, s89, v147
    ds_read_b64_tr_b16 v[124:125], v147 offset:0
    v_mfma_f32_16x16x32_bf16 v[108:111], v[140:143], v[28:31], v[108:111]
    ds_read_b64_tr_b16 v[126:127], v147 offset:2048
    buffer_load_dwordx4 v[56:59], v157, s[16:19], s91 offen offset:1024 sc1
    buffer_load_dwordx4 v[60:63], v158, s[16:19], s91 offen offset:1024 sc1
    s_waitcnt vmcnt(6) lgkmcnt(6)
    v_max3_u32 v156, v156, v35, v39
    v_mfma_f32_16x16x32_bf16 v[80:83], v[112:115], v[32:35], v[80:83]
    ds_read_b64_tr_b16 v[128:129], v144 offset:4096
    v_mfma_f32_16x16x32_bf16 v[96:99], v[112:115], v[36:39], v[96:99]
    ds_read_b64_tr_b16 v[130:131], v144 offset:6144
    s_waitcnt lgkmcnt(6)
    v_mfma_f32_16x16x32_bf16 v[84:87], v[116:119], v[32:35], v[84:87]
    ds_read_b64_tr_b16 v[132:133], v145 offset:4096
    v_mfma_f32_16x16x32_bf16 v[100:103], v[116:119], v[36:39], v[100:103]
    ds_read_b64_tr_b16 v[134:135], v145 offset:6144
    s_waitcnt lgkmcnt(6)
    v_mfma_f32_16x16x32_bf16 v[88:91], v[120:123], v[32:35], v[88:91]
    ds_read_b64_tr_b16 v[136:137], v146 offset:4096
    v_mfma_f32_16x16x32_bf16 v[104:107], v[120:123], v[36:39], v[104:107]
    ds_read_b64_tr_b16 v[138:139], v146 offset:6144
    s_waitcnt lgkmcnt(6)
    v_mfma_f32_16x16x32_bf16 v[92:95], v[124:127], v[32:35], v[92:95]
    ds_read_b64_tr_b16 v[140:141], v147 offset:4096
    v_mfma_f32_16x16x32_bf16 v[108:111], v[124:127], v[36:39], v[108:111]
    ds_read_b64_tr_b16 v[142:143], v147 offset:6144
    s_cmp_eq_u32 s65, 0
    s_cbranch_scc1 L_b_p7
L_b_r7:
    s_ff1_i32_b32 s91, s65
    s_bitset0_b32 s65, s91
    s_lshl_b32 s79, s91, 12
    s_lshl_b32 s91, s91, 10
    buffer_load_dwordx4 v[64:67], v157, s[16:19], s91 offen offset:0 sc1
    buffer_load_dwordx4 v[68:71], v158, s[16:19], s91 offen offset:0 sc1
    s_waitcnt vmcnt(6) lgkmcnt(6)
    v_max3_u32 v156, v156, v43, v47
    v_mfma_f32_16x16x32_bf16 v[80:83], v[128:131], v[40:43], v[80:83]
    s_xor_b32 s89, s67, s78
    s_mov_b32 s67, s78
    v_xor_b32 v144, s89, v144
    ds_read_b64_tr_b16 v[112:113], v144 offset:0
    v_mfma_f32_16x16x32_bf16 v[96:99], v[128:131], v[44:47], v[96:99]
    ds_read_b64_tr_b16 v[114:115], v144 offset:2048
    s_waitcnt lgkmcnt(6)
    v_mfma_f32_16x16x32_bf16 v[84:87], v[132:135], v[40:43], v[84:87]
    v_xor_b32 v145, s89, v145
    ds_read_b64_tr_b16 v[116:117], v145 offset:0
    v_mfma_f32_16x16x32_bf16 v[100:103], v[132:135], v[44:47], v[100:103]
    ds_read_b64_tr_b16 v[118:119], v145 offset:2048
    s_waitcnt lgkmcnt(6)
    v_mfma_f32_16x16x32_bf16 v[88:91], v[136:139], v[40:43], v[88:91]
    v_xor_b32 v146, s89, v146
    ds_read_b64_tr_b16 v[120:121], v146 offset:0
    v_mfma_f32_16x16x32_bf16 v[104:107], v[136:139], v[44:47], v[104:107]
    ds_read_b64_tr_b16 v[122:123], v146 offset:2048
    s_waitcnt lgkmcnt(6)
    v_mfma_f32_16x16x32_bf16 v[92:95], v[140:143], v[40:43], v[92:95]
    v_xor_b32 v147, s89, v147
    ds_read_b64_tr_b16 v[124:125], v147 offset:0
    v_mfma_f32_16x16x32_bf16 v[108:111], v[140:143], v[44:47], v[108:111]
    ds_read_b64_tr_b16 v[126:127], v147 offset:2048
    buffer_load_dwordx4 v[72:75], v157, s[16:19], s91 offen offset:1024 sc1
    buffer_load_dwordx4 v[76:79], v158, s[16:19], s91 offen offset:1024 sc1
    s_waitcnt vmcnt(6) lgkmcnt(6)
    v_max3_u32 v156, v156, v51, v55
    v_mfma_f32_16x16x32_bf16 v[80:83], v[112:115], v[48:51], v[80:83]
    ds_read_b64_tr_b16 v[128:129], v144 offset:4096
    v_mfma_f32_16x16x32_bf16 v[96:99], v[112:115], v[52:55], v[96:99]
    ds_read_b64_tr_b16 v[130:131], v144 offset:6144
    s_mov_b32 s90, 21504
    buffer_load_dwordx4 v[176:179], v11, s[32:35], s90 offen
    s_waitcnt lgkmcnt(6)
    v_mfma_f32_16x16x32_bf16 v[84:87], v[116:119], v[48:51], v[84:87]
    ds_read_b64_tr_b16 v[132:133], v145 offset:4096
    v_mfma_f32_16x16x32_bf16 v[100:103], v[116:119], v[52:55], v[100:103]
    ds_read_b64_tr_b16 v[134:135], v145 offset:6144
    s_waitcnt lgkmcnt(6)
    v_mfma_f32_16x16x32_bf16 v[88:91], v[120:123], v[48:51], v[88:91]
    ds_read_b64_tr_b16 v[136:137], v146 offset:4096
    v_mfma_f32_16x16x32_bf16 v[104:107], v[120:123], v[52:55], v[104:107]
    ds_read_b64_tr_b16 v[138:139], v146 offset:6144
    s_mov_b32 s90, 28672
    buffer_load_dwordx4 v[180:183], v11, s[32:35], s90 offen
    s_waitcnt lgkmcnt(6)
    v_mfma_f32_16x16x32_bf16 v[92:95], v[124:127], v[48:51], v[92:95]
    ds_read_b64_tr_b16 v[140:141], v147 offset:4096
    v_mfma_f32_16x16x32_bf16 v[108:111], v[124:127], v[52:55], v[108:111]
    ds_read_b64_tr_b16 v[142:143], v147 offset:6144
    s_waitcnt vmcnt(6) lgkmcnt(6)
    v_max3_u32 v156, v156, v59, v63
    v_mfma_f32_16x16x32_bf16 v[80:83], v[128:131], v[56:59], v[80:83]
    s_xor_b32 s89, s67, s79
    s_mov_b32 s67, s79
    v_xor_b32 v144, s89, v144
    ds_read_b64_tr_b16 v[112:113], v144 offset:0
    v_mfma_f32_16x16x32_bf16 v[96:99], v[128:131], v[60:63], v[96:99]
    ds_read_b64_tr_b16 v[114:115], v144 offset:2048
    s_mov_b32 s90, 35840
    buffer_load_dwordx4 v[184:187], v11, s[32:35], s90 offen
    s_waitcnt lgkmcnt(6)
    v_mfma_f32_16x16x32_bf16 v[84:87], v[132:135], v[56:59], v[84:87]
    v_xor_b32 v145, s89, v145
    ds_read_b64_tr_b16 v[116:117], v145 offset:0
    v_mfma_f32_16x16x32_bf16 v[100:103], v[132:135], v[60:63], v[100:103]
    ds_read_b64_tr_b16 v[118:119], v145 offset:2048
    s_waitcnt lgkmcnt(6)
    v_mfma_f32_16x16x32_bf16 v[88:91], v[136:139], v[56:59], v[88:91]
    v_xor_b32 v146, s89, v146
    ds_read_b64_tr_b16 v[120:121], v146 offset:0
    v_mfma_f32_16x16x32_bf16 v[104:107], v[136:139], v[60:63], v[104:107]
    ds_read_b64_tr_b16 v[122:123], v146 offset:2048
    s_mov_b32 s90, 43008
    buffer_load_dwordx4 v[188:191], v11, s[32:35], s90 offen
    s_waitcnt lgkmcnt(6)
    v_mfma_f32_16x16x32_bf16 v[92:95], v[140:143], v[56:59], v[92:95]
    v_xor_b32 v147, s89, v147
    ds_read_b64_tr_b16 v[124:125], v147 offset:0
    v_mfma_f32_16x16x32_bf16 v[108:111], v[140:143], v[60:63], v[108:111]
    ds_read_b64_tr_b16 v[126:127], v147 offset:2048
    s_waitcnt vmcnt(6) lgkmcnt(6)
    v_max3_u32 v156, v156, v67, v71
    v_mfma_f32_16x16x32_bf16 v[80:83], v[112:115], v[64:67], v[80:83]
    ds_read_b64_tr_b16 v[128:129], v144 offset:4096
    v_mfma_f32_16x16x32_bf16 v[96:99], v[112:115], v[68:71], v[96:99]
    ds_read_b64_tr_b16 v[130:131], v144 offset:6144
    s_mov_b32 s90, 50176
    buffer_load_dwordx4 v[192:195], v11, s[32:35], s90 offen
    s_waitcnt lgkmcnt(6)
    v_mfma_f32_16x16x32_bf16 v[84:87], v[116:119], v[64:67], v[84:87]
    ds_read_b64_tr_b16 v[132:133], v145 offset:4096
    v_mfma_f32_16x16x32_bf16 v[100:103], v[116:119], v[68:71], v[100:103]
    ds_read_b64_tr_b16 v[134:135], v145 offset:6144
    s_waitcnt lgkmcnt(6)
    v_mfma_f32_16x16x32_bf16 v[88:91], v[120:123], v[64:67], v[88:91]
    ds_read_b64_tr_b16 v[136:137], v146 offset:4096
    v_mfma_f32_16x16x32_bf16 v[104:107], v[120:123], v[68:71], v[104:107]
    ds_read_b64_tr_b16 v[138:139], v146 offset:6144
    s_waitcnt lgkmcnt(6)
    v_mfma_f32_16x16x32_bf16 v[92:95], v[124:127], v[64:67], v[92:95]
    ds_read_b64_tr_b16 v[140:141], v147 offset:4096
    v_mfma_f32_16x16x32_bf16 v[108:111], v[124:127], v[68:71], v[108:111]
    ds_read_b64_tr_b16 v[142:143], v147 offset:6144
    s_waitcnt vmcnt(5) lgkmcnt(6)
    v_max3_u32 v156, v156, v75, v79
    v_cmp_eq_u32 vcc, -1, v156
    s_cbranch_vccz L_ok_3
    s_sub_u32 s56, s56, 1
    s_cbranch_scc0 L_b_restart
    s_mov_b32 s56, 0
L_ok_3:
    v_mfma_f32_16x16x32_bf16 v[80:83], v[128:131], v[72:75], v[80:83]
    v_mfma_f32_16x16x32_bf16 v[96:99], v[128:131], v[76:79], v[96:99]
    s_mov_b32 s90, 57344
    buffer_load_dwordx4 v[196:199], v11, s[32:35], s90 offen
    s_waitcnt lgkmcnt(4)
    v_mfma_f32_16x16x32_bf16 v[84:87], v[132:135], v[72:75], v[84:87]
    v_mfma_f32_16x16x32_bf16 v[100:103], v[132:135], v[76:79], v[100:103]
    s_waitcnt lgkmcnt(2)
    v_mfma_f32_16x16x32_bf16 v[88:91], v[136:139], v[72:75], v[88:91]
    v_mfma_f32_16x16x32_bf16 v[104:107], v[136:139], v[76:79], v[104:107]
    s_waitcnt lgkmcnt(0)
    v_mfma_f32_16x16x32_bf16 v[92:95], v[140:143], v[72:75], v[92:95]
    v_mfma_f32_16x16x32_bf16 v[108:111], v[140:143], v[76:79], v[108:111]
    ds_write_b128 v162, v[96:99] offset:0
    s_nop 0
    ds_write_b128 v162, v[100:103] offset:1024
    s_nop 1
    ds_write_b128 v162, v[104:107] offset:2048
    s_nop 1
    ds_write_b128 v162, v[108:111] offset:3072
    s_waitcnt lgkmcnt(0)
    s_barrier
    ds_read_b128 v[16:19], v163 offset:0
    ds_read_b128 v[20:23], v163 offset:1024
    ds_read_b128 v[24:27], v163 offset:2048
    ds_read_b128 v[28:31], v163 offset:3072
    s_waitcnt lgkmcnt(3)
    v_pk_add_f32 v[80:81], v[80:81], v[16:17]
    v_pk_add_f32 v[82:83], v[82:83], v[18:19]
    v_cvt_pk_bf16_f32 v32, v80, v81
    v_cvt_pk_bf16_f32 v33, v82, v83
    s_waitcnt lgkmcnt(2)
    v_pk_add_f32 v[84:85], v[84:85], v[20:21]
    v_pk_add_f32 v[86:87], v[86:87], v[22:23]
    v_cvt_pk_bf16_f32 v34, v84, v85
    v_cvt_pk_bf16_f32 v35, v86, v87
    s_waitcnt lgkmcnt(1)
    v_pk_add_f32 v[88:89], v[88:89], v[24:25]
    v_pk_add_f32 v[90:91], v[90:91], v[26:27]
    v_cvt_pk_bf16_f32 v36, v88, v89
    v_cvt_pk_bf16_f32 v37, v90, v91
    s_waitcnt lgkmcnt(0)
    v_pk_add_f32 v[92:93], v[92:93], v[28:29]
    v_pk_add_f32 v[94:95], v[94:95], v[30:31]
    v_cvt_pk_bf16_f32 v38, v92, v93
    v_cvt_pk_bf16_f32 v39, v94, v95
    v_mfma_f32_16x16x32_bf16 v[60:63], v[32:35], v[32:35], 0
    v_mfma_f32_16x16x32_bf16 v[56:59], v[32:35], v[148:151], 0
    v_mfma_f32_16x16x32_bf16 v[60:63], v[36:39], v[36:39], v[60:63]
    v_mfma_f32_16x16x32_bf16 v[56:59], v[36:39], v[152:155], v[56:59]
    v_lshlrev_b32 v40, 16, v32
    v_and_b32 v41, 0xffff0000, v32
    v_lshlrev_b32 v42, 16, v33
    v_and_b32 v43, 0xffff0000, v33
    v_lshlrev_b32 v44, 16, v34
    v_and_b32 v45, 0xffff0000, v34
    s_nop 1
    v_cndmask_b32 v56, v56, v60, s[72:73]
    v_cndmask_b32 v57, v57, v61, s[72:73]
    v_cndmask_b32 v58, v58, v62, s[72:73]
    v_cndmask_b32 v59, v59, v63, s[72:73]
    v_cndmask_b32 v56, v56, v57, s[4:5]
    v_cndmask_b32 v58, v58, v59, s[98:99]
    s_or_b64 vcc, s[6:7], s[98:99]
    v_cndmask_b32 v56, v56, v58, vcc
    v_cndmask_b32 v56, v56, 1.0, s[74:75]
    buffer_atomic_add_f32 v56, v160, s[16:19], 0 offen sc1
    v_mov_b32 v67, 0
    buffer_atomic_or v67, v160, s[16:19], 0 offen sc0 sc1
    s_mov_b32 s90, 64512
    buffer_load_dwordx4 v[200:203], v11, s[32:35], s90 offen
    s_mov_b32 s90, 71680
    buffer_load_dwordx4 v[204:207], v11, s[32:35], s90 offen
    s_mov_b32 s90, 78848
    buffer_load_dwordx4 v[208:211], v11, s[32:35], s90 offen
    s_mov_b32 s90, 86016
    buffer_load_dwordx4 v[212:215], v11, s[32:35], s90 offen
    v_lshlrev_b32 v46, 16, v35
    v_and_b32 v47, 0xffff0000, v35
    v_lshlrev_b32 v48, 16, v36
    v_and_b32 v49, 0xffff0000, v36
    v_lshlrev_b32 v50, 16, v37
    v_and_b32 v51, 0xffff0000, v37
    v_lshlrev_b32 v52, 16, v38
    v_and_b32 v53, 0xffff0000, v38
    v_lshlrev_b32 v54, 16, v39
    v_and_b32 v55, 0xffff0000, v39
    v_lshrrev_b32 v8, 2, v2
    v_lshlrev_b32 v9, 4, v8
    v_sub_u32 v9, v161, v9
    v_cmp_eq_u32 vcc, 0, v8
    s_nop 1
    v_cndmask_b32 v10, 0, 32, vcc
    v_add_u32 v10, v9, v10
    v_cmp_eq_u32 vcc, 1, v8
    s_nop 1
    v_cndmask_b32 v8, 16, 48, vcc
    v_add_u32 v9, v9, v8
    s_waitcnt vmcnt(4)
    s_branch L_h3_chk
L_h3:
    v_mov_b32 v67, 0
    buffer_atomic_or v67, v160, s[16:19], 0 offen sc0 sc1
    s_waitcnt vmcnt(0)
L_h3_chk:
    v_cmp_ne_u32 vcc, 0x41800000, v67
    s_nop 0
    s_and_b64 vcc, vcc, s[74:75]
    s_cbranch_vccz L_ok_4
    s_sub_u32 s56, s56, 1
    s_cbranch_scc0 L_h3
    s_mov_b32 s56, 0
L_ok_4:
    ds_bpermute_b32 v64, v10, v67
    ds_bpermute_b32 v66, v161, v67
    ds_bpermute_b32 v65, v9, v67
    s_mov_b32 s90, 93184
    buffer_load_dwordx4 v[216:219], v11, s[32:35], s90 offen
    s_mov_b32 s90, 100352
    buffer_load_dwordx4 v[220:223], v11, s[32:35], s90 offen
    s_mov_b32 s90, 107520
    buffer_load_dwordx4 v[224:227], v11, s[32:35], s90 offen
    s_waitcnt lgkmcnt(0)
    v_mul_f32 v64, 0x3a800000, v64
    v_mul_f32 v66, 0x3a800000, v66
    v_fma_f32 v66, -v64, v64, v66
    v_max_f32 v66, 0, v66
    v_cvt_pk_bf16_f32 v69, v64, v66
    v_lshlrev_b32 v68, 16, v69
    v_and_b32 v69, 0xffff0000, v69
    v_add_f32 v69, 0x3727c5ac, v69
    v_cvt_pk_bf16_f32 v69, v69, v69
    v_lshlrev_b32 v69, 16, v69
    v_sqrt_f32 v69, v69
    s_nop 0
    v_cvt_pk_bf16_f32 v69, v69, v69
    v_lshlrev_b32 v69, 16, v69
    v_rcp_f32 v70, v69
    v_fma_f32 v12, -v68, s57, v65
    v_mul_f32 v12, v12, v70
    v_mul_f32 v72, -v68, v70
    v_ashrrev_i32 v8, 31, v12
    v_or_b32 v8, 0x80000000, v8
    v_xor_b32 v8, v8, v12
    v_and_b32 v8, 0xfffff800, v8
    v_or_b32 v13, v8, v6
    s_lshl_b32 s86, s3, 6
    s_add_u32 s86, s86, 65536
    v_lshl_add_u32 v8, v2, 2, s86
    ds_write_b32 v8, v13
    v_pk_fma_f32 v[16:17], v[40:41], v[70:71], v[72:73] op_sel_hi:[1,0,0]
    v_pk_fma_f32 v[18:19], v[42:43], v[70:71], v[72:73] op_sel_hi:[1,0,0]
    v_pk_fma_f32 v[20:21], v[44:45], v[70:71], v[72:73] op_sel_hi:[1,0,0]
    v_pk_fma_f32 v[22:23], v[46:47], v[70:71], v[72:73] op_sel_hi:[1,0,0]
    v_pk_fma_f32 v[24:25], v[48:49], v[70:71], v[72:73] op_sel_hi:[1,0,0]
    v_pk_fma_f32 v[26:27], v[50:51], v[70:71], v[72:73] op_sel_hi:[1,0,0]
    v_pk_fma_f32 v[28:29], v[52:53], v[70:71], v[72:73] op_sel_hi:[1,0,0]
    v_pk_fma_f32 v[30:31], v[54:55], v[70:71], v[72:73] op_sel_hi:[1,0,0]
    v_lshlrev_b32 v8, 3, v0
    v_add_u32 v8, 65536, v8
    s_waitcnt lgkmcnt(0)
    s_barrier
    ds_read_b64 v[64:65], v8
    v_cvt_pk_bf16_f32 v96, v16, v17
    v_cvt_pk_bf16_f32 v97, v18, v19
    v_cvt_pk_bf16_f32 v98, v20, v21
    v_cvt_pk_bf16_f32 v99, v22, v23
    v_cvt_pk_bf16_f32 v100, v24, v25
    v_cvt_pk_bf16_f32 v101, v26, v27
    v_cvt_pk_bf16_f32 v102, v28, v29
    v_cvt_pk_bf16_f32 v103, v30, v31
    s_waitcnt lgkmcnt(0)
    v_max_u32 v66, v64, v65
    v_min_u32 v67, v64, v65
    s_nop 0
    v_mov_b32_dpp v64, v66 row_ror:8 row_mask:0xf bank_mask:0xf
    v_max_u32_dpp v65, v67, v67 row_ror:8 row_mask:0xf bank_mask:0xf
    v_med3_u32 v67, v66, v64, v65
    v_max_u32 v66, v66, v64
    s_nop 1
    v_mov_b32_dpp v64, v66 row_ror:4 row_mask:0xf bank_mask:0xf
    v_max_u32_dpp v65, v67, v67 row_ror:4 row_mask:0xf bank_mask:0xf
    v_med3_u32 v67, v66, v64, v65
    v_max_u32 v66, v66, v64
    s_nop 1
    v_mov_b32_dpp v64, v66 row_ror:2 row_mask:0xf bank_mask:0xf
    v_max_u32_dpp v65, v67, v67 row_ror:2 row_mask:0xf bank_mask:0xf
    v_med3_u32 v67, v66, v64, v65
    v_max_u32 v66, v66, v64
    s_nop 1
    v_mov_b32_dpp v64, v66 row_ror:1 row_mask:0xf bank_mask:0xf
    v_max_u32_dpp v65, v67, v67 row_ror:1 row_mask:0xf bank_mask:0xf
    v_med3_u32 v67, v66, v64, v65
    v_max_u32 v66, v66, v64
    s_nop 0
    v_readlane_b32 s58, v66, 0
    v_readlane_b32 s59, v67, 0
    v_readlane_b32 s86, v66, 16
    v_readlane_b32 s87, v67, 16
    s_nop 0
    s_max_u32 s59, s59, s87
    s_min_u32 s87, s58, s86
    s_max_u32 s58, s58, s86
    s_max_u32 s59, s59, s87
    v_readlane_b32 s86, v66, 32
    v_readlane_b32 s87, v67, 32
    s_nop 0
    s_max_u32 s59, s59, s87
    s_min_u32 s87, s58, s86
    s_max_u32 s58, s58, s86
    s_max_u32 s59, s59, s87
    v_readlane_b32 s86, v66, 48
    v_readlane_b32 s87, v67, 48
    s_nop 0
    s_max_u32 s59, s59, s87
    s_min_u32 s87, s58, s86
    s_max_u32 s58, s58, s86
    s_max_u32 s59, s59, s87
    v_cmp_eq_u32 s[4:5], s58, v13
    v_cmp_eq_u32 s[6:7], s59, v13
    s_nop 0
    s_or_b64 s[96:97], s[4:5], s[6:7]
    s_cbranch_scc0 L_nocand
    s_lshl_b32 s86, s51, 12
    s_lshl_b32 s87, s52, 7
    s_add_u32 s86, s86, s87
    s_add_u32 s86, s86, 6782976
    v_lshl_add_u32 v8, v1, 3, s86
    v_add_u32 v9, 2048, v8
    v_cndmask_b32 v8, v8, v9, s[6:7]
    v_mov_b32 v9, 2147483648
    v_cndmask_b32 v8, v9, v8, s[96:97]
    buffer_store_dwordx2 v[96:97], v8, s[16:19], 0 offen offset:0 sc1
    buffer_store_dwordx2 v[98:99], v8, s[16:19], 0 offen offset:32 sc1
    buffer_store_dwordx2 v[100:101], v8, s[16:19], 0 offen offset:64 sc1
    buffer_store_dwordx2 v[102:103], v8, s[16:19], 0 offen offset:96 sc1
L_nocand:
    s_cmp_lg_u32 s3, 0
    s_cbranch_scc1 L_nokey
    s_lshl_b32 s86, s52, 10
    s_lshl_b32 s87, s51, 3
    s_add_u32 s86, s86, s87
    s_add_u32 s86, s86, 6848512
    v_lshl_add_u32 v8, v0, 7, s86
    v_mov_b32 v9, 2147483648
    v_cmp_gt_u32 vcc, 8, v0
    s_nop 1
    v_cndmask_b32 v8, v9, v8, vcc
    v_mov_b32 v10, s58
    v_mov_b32 v11, s59
    buffer_atomic_swap_x2 v[10:11], v8, s[16:19], 0 offen sc1
L_nokey:
    s_bfe_u32 s89, s2, 0x20001
    s_lshl_b32 s89, s89, 2
    s_add_u32 s89, s89, s48
    s_lshl_b32 s86, s89, 3
    s_and_b32 s87, s45, 7
    s_add_u32 s86, s86, s87
    s_lshl_b32 s86, s86, 7
    s_add_u32 s86, s86, 6848512
    v_lshl_add_u32 v129, v0, 2, s86
    v_mov_b32 v8, 2147483648
    v_cmp_gt_u32 vcc, 32, v0
    s_nop 1
    v_cndmask_b32 v129, v8, v129, vcc
    s_cmp_lg_u64 s[96:97], 0
    s_cselect_b32 s63, 1, s62
    s_cmp_eq_u32 s63, 0
    s_cbranch_scc1 L_h4_skip1
    v_mov_b32 v128, 0
    buffer_atomic_or v128, v129, s[16:19], 0 offen sc0 sc1
L_h4_skip1:
    v_lshlrev_b32 v16, 16, v96
    v_and_b32 v17, 0xffff0000, v96
    v_lshlrev_b32 v18, 16, v97
    v_and_b32 v19, 0xffff0000, v97
    v_lshlrev_b32 v20, 16, v98
    v_and_b32 v21, 0xffff0000, v98
    v_lshlrev_b32 v22, 16, v99
    v_and_b32 v23, 0xffff0000, v99
    v_lshlrev_b32 v24, 16, v100
    v_and_b32 v25, 0xffff0000, v100
    v_lshlrev_b32 v26, 16, v101
    v_and_b32 v27, 0xffff0000, v101
    v_lshlrev_b32 v28, 16, v102
    v_and_b32 v29, 0xffff0000, v102
    v_lshlrev_b32 v30, 16, v103
    v_and_b32 v31, 0xffff0000, v103
    v_pk_add_f32 v[16:17], v[16:17], v[40:41]
    v_pk_add_f32 v[18:19], v[18:19], v[42:43]
    v_pk_add_f32 v[20:21], v[20:21], v[44:45]
    v_pk_add_f32 v[22:23], v[22:23], v[46:47]
    v_pk_add_f32 v[24:25], v[24:25], v[48:49]
    v_pk_add_f32 v[26:27], v[26:27], v[50:51]
    v_pk_add_f32 v[28:29], v[28:29], v[52:53]
    v_pk_add_f32 v[30:31], v[30:31], v[54:55]
    v_cvt_pk_bf16_f32 v104, v16, v17
    v_cvt_pk_bf16_f32 v105, v18, v19
    v_cvt_pk_bf16_f32 v106, v20, v21
    v_cvt_pk_bf16_f32 v107, v22, v23
    v_cvt_pk_bf16_f32 v108, v24, v25
    v_cvt_pk_bf16_f32 v109, v26, v27
    v_cvt_pk_bf16_f32 v110, v28, v29
    v_cvt_pk_bf16_f32 v111, v30, v31
    v_permlane16_swap_b32 v104, v106
    v_permlane16_swap_b32 v105, v107
    v_permlane16_swap_b32 v108, v110
    v_permlane16_swap_b32 v109, v111
    v_mov_b32 v9, 2147483648
    v_cndmask_b32 v8, v5, v9, s[96:97]
    buffer_store_dwordx4 v[104:107], v8, s[24:27], 0 offen sc1
    buffer_store_dwordx4 v[108:111], v8, s[24:27], 0 offen offset:64 sc1
    s_cmp_eq_u32 s63, 0
    s_cbranch_scc1 L_fin
    s_cmp_eq_u64 s[96:97], 0
    s_cbranch_scc1 L_nostash
    v_lshlrev_b32 v8, 3, v1
    v_add_u32 v8, 98304, v8
    v_add_u32 v9, 512, v8
    v_cndmask_b32 v8, v8, v9, s[6:7]
    v_cvt_pk_bf16_f32 v9, v12, v12
    v_lshlrev_b32 v9, 16, v9
    s_mov_b64 exec, s[96:97]
    ds_write_b64 v8, v[32:33] offset:0
    ds_write_b64 v8, v[96:97] offset:128
    ds_write_b64 v8, v[34:35] offset:32
    ds_write_b64 v8, v[98:99] offset:160
    ds_write_b64 v8, v[36:37] offset:64
    ds_write_b64 v8, v[100:101] offset:192
    ds_write_b64 v8, v[38:39] offset:96
    ds_write_b64 v8, v[102:103] offset:224
    ds_write_b32 v8, v9 offset:256
    s_mov_b64 exec, -1
L_nostash:
    s_waitcnt vmcnt(2)
    s_branch L_h4_chk
L_h4:
    v_mov_b32 v128, 0
    buffer_atomic_or v128, v129, s[16:19], 0 offen sc0 sc1
    s_waitcnt vmcnt(0)
L_h4_chk:
    v_cmp_eq_u32 vcc, -1, v128
    s_cbranch_vccz L_ok_5
    s_sub_u32 s56, s56, 1
    s_cbranch_scc0 L_h4
    s_mov_b32 s56, 0
L_ok_5:
    v_mov_b32 v64, v128
    v_mov_b32 v65, 0
    s_nop 0
    v_mov_b32_dpp v66, v64 row_ror:8 row_mask:0xf bank_mask:0xf
    v_max_u32_dpp v67, v65, v65 row_ror:8 row_mask:0xf bank_mask:0xf
    v_med3_u32 v65, v64, v66, v67
    v_max_u32 v64, v64, v66
    s_nop 1
    v_mov_b32_dpp v66, v64 row_ror:4 row_mask:0xf bank_mask:0xf
    v_max_u32_dpp v67, v65, v65 row_ror:4 row_mask:0xf bank_mask:0xf
    v_med3_u32 v65, v64, v66, v67
    v_max_u32 v64, v64, v66
    s_nop 1
    v_mov_b32_dpp v66, v64 row_ror:2 row_mask:0xf bank_mask:0xf
    v_max_u32_dpp v67, v65, v65 row_ror:2 row_mask:0xf bank_mask:0xf
    v_med3_u32 v65, v64, v66, v67
    v_max_u32 v64, v64, v66
    s_nop 1
    v_mov_b32_dpp v66, v64 row_ror:1 row_mask:0xf bank_mask:0xf
    v_max_u32_dpp v67, v65, v65 row_ror:1 row_mask:0xf bank_mask:0xf
    v_med3_u32 v65, v64, v66, v67
    v_max_u32 v64, v64, v66
    s_nop 0
    v_readlane_b32 s60, v64, 0
    v_readlane_b32 s61, v65, 0
    v_readlane_b32 s86, v64, 16
    v_readlane_b32 s87, v65, 16
    s_nop 0
    s_max_u32 s61, s61, s87
    s_min_u32 s87, s60, s86
    s_max_u32 s60, s60, s86
    s_max_u32 s61, s61, s87
    s_cmp_lg_u32 s62, 0
    s_cbranch_scc1 L_moe
    s_barrier
    s_barrier
    s_branch L_final
L_moe:
    v_cmp_eq_u32 vcc, s60, v128
    s_nop 0
    s_ff1_i32_b32 s86, vcc_lo
    v_cmp_eq_u32 vcc, s61, v128
    s_nop 0
    s_ff1_i32_b32 s87, vcc_lo
    s_and_b32 s86, s86, 31
    s_and_b32 s87, s87, 31
    v_bfe_u32 v8, v0, 3, 1
    v_cmp_eq_u32 vcc, 1, v8
    v_mov_b32 v9, s86
    v_mov_b32 v10, s87
    v_cndmask_b32 v9, v9, v10, vcc
    s_lshl_b32 s89, s89, 7
    s_add_u32 s89, s89, 6782976
    v_lshl_add_u32 v10, v1, 5, s89
    v_lshl_add_u32 v130, v9, 11, v10
    buffer_load_dwordx4 v[64:67], v130, s[16:19], 0 offen sc1
    buffer_load_dwordx4 v[68:71], v130, s[16:19], 0 offen offset:16 sc1
    s_mov_b32 s90, 0
    buffer_load_dwordx4 v[228:231], v14, s[36:39], s90 offen
    s_mov_b32 s90, 2048
    buffer_load_dwordx4 v[232:235], v14, s[36:39], s90 offen
    s_mov_b32 s90, 4096
    buffer_load_dwordx4 v[236:239], v14, s[36:39], s90 offen
    s_mov_b32 s90, 6144
    buffer_load_dwordx4 v[240:243], v14, s[36:39], s90 offen
    s_mov_b32 s90, 8192
    buffer_load_dwordx4 v[244:247], v14, s[36:39], s90 offen
    s_mov_b32 s90, 10240
    buffer_load_dwordx4 v[248:251], v14, s[36:39], s90 offen
    s_mov_b32 s90, 12288
    buffer_load_dwordx4 v[252:255], v14, s[36:39], s90 offen
    v_and_b32 v10, 1, v0
    v_cmp_eq_u32 vcc, 1, v10
    v_mov_b32 v10, 0x0c0c0100
    v_mov_b32 v11, 0x01000c0c
    v_cndmask_b32 v16, v10, v11, vcc
    v_mov_b32 v10, 0x0c0c0302
    v_mov_b32 v11, 0x03020c0c
    v_cndmask_b32 v17, v10, v11, vcc
    v_bfe_u32 v10, v0, 1, 2
    v_mov_b32 v11, 0x0c0c0c0c
    v_cmp_eq_u32 vcc, 0, v10
    s_nop 1
    v_cndmask_b32 v72, v11, v16, vcc
    v_cndmask_b32 v76, v11, v17, vcc
    v_cmp_eq_u32 vcc, 1, v10
    s_nop 1
    v_cndmask_b32 v73, v11, v16, vcc
    v_cndmask_b32 v77, v11, v17, vcc
    v_cmp_eq_u32 vcc, 2, v10
    s_nop 1
    v_cndmask_b32 v74, v11, v16, vcc
    v_cndmask_b32 v78, v11, v17, vcc
    v_cmp_eq_u32 vcc, 3, v10
    s_nop 1
    v_cndmask_b32 v75, v11, v16, vcc
    v_cndmask_b32 v79, v11, v17, vcc
    s_lshl_b32 s86, s48, 10
    s_add_u32 s86, s86, 90112
    v_lshl_add_u32 v18, v0, 4, s86
    s_and_b32 s86, s2, 1
    s_lshl_b32 s86, s86, 2
    s_bfe_u32 s87, s2, 0x20001
    s_add_u32 s88, s86, s87
    s_mul_i32 s86, s88, 28672
    s_add_u32 s86, s86, 6553600
    v_mov_b32 v16, s80
    v_mov_b32 v17, s81
    s_mov_b32 vcc_lo, 4278255360
    s_mov_b32 vcc_hi, vcc_lo
    v_cndmask_b32 v16, v16, v17, vcc
    v_cmp_gt_u32 vcc, 56, v16
    v_lshl_add_u32 v19, v16, 8, s86
    v_and_b32 v16, 7, v0
    v_lshl_add_u32 v19, v16, 5, v19
    v_and_b32 v10, 1, v1
    v_lshl_add_u32 v19, v10, 4, v19
    v_lshrrev_b32 v11, 1, v1
    v_mul_u32_u24 v16, 14336, v11
    v_add_u32 v19, v19, v16
    v_mov_b32 v133, 2147483648
    v_cndmask_b32 v19, v133, v19, vcc
    v_mov_b32 v131, s68
    s_lshl2_add_u32 s86, s88, 704512
    v_mov_b32 v16, s80
    v_mov_b32 v17, s81
    s_mov_b32 vcc_lo, 4042322160
    s_mov_b32 vcc_hi, vcc_lo
    v_cndmask_b32 v16, v16, v17, vcc
    v_cmp_gt_u32 vcc, 56, v16
    v_lshl_add_u32 v132, v16, 9, s86
    v_and_b32 v16, 3, v0
    v_lshl_add_u32 v132, v16, 7, v132
    s_and_b64 vcc, vcc, 0xff
    v_cndmask_b32 v132, v133, v132, vcc
    s_lshl_b32 s86, s44, 5
    s_add_u32 s86, s86, s45
    s_lshl2_add_u32 s86, s86, 737280
    v_writelane_b32 v133, s86, 0
    s_mul_i32 s86, s45, 112
    s_mul_i32 s87, s48, 28
    s_add_u32 s86, s86, s87
    v_mul_u32_u24 v16, 27, v8
    v_add_u32 v16, s86, v16
    v_lshrrev_b32 v16, 6, v16
    s_lshl_b32 s87, s48, 7
    s_add_u32 s87, s87, 704512
    v_lshl_add_u32 v134, v16, 9, s87
    v_and_b32 v16, 7, v0
    v_lshl_add_u32 v134, v16, 2, v134
    v_mov_b32 v16, 2147483648
    v_cmp_gt_u32 vcc, 16, v0
    s_nop 1
    v_cndmask_b32 v134, v16, v134, vcc
    s_waitcnt vmcnt(7)
    s_branch L_seg_chk
L_seg:
    buffer_load_dwordx4 v[64:67], v130, s[16:19], 0 offen sc1
    buffer_load_dwordx4 v[68:71], v130, s[16:19], 0 offen offset:16 sc1
    s_waitcnt vmcnt(0)
L_seg_chk:
    v_max3_u32 v16, v65, v67, v69
    v_max_u32 v16, v16, v71
    v_cmp_eq_u32 vcc, -1, v16
    s_cbranch_vccz L_ok_6
    s_sub_u32 s56, s56, 1
    s_cbranch_scc0 L_seg
    s_mov_b32 s56, 0
L_ok_6:
    v_perm_b32 v80, v64, v64, v72
    v_perm_b32 v81, v64, v64, v73
    v_perm_b32 v82, v64, v64, v74
    v_perm_b32 v83, v64, v64, v75
    s_nop 1
    v_mfma_f32_16x16x32_bf16 v[88:91], v[80:83], v[164:167], 0
    v_perm_b32 v84, v64, v64, v76
    v_perm_b32 v85, v64, v64, v77
    v_perm_b32 v86, v64, v64, v78
    v_perm_b32 v87, v64, v64, v79
    s_nop 1
    v_mfma_f32_16x16x32_bf16 v[88:91], v[84:87], v[168:171], v[88:91]
    v_perm_b32 v80, v65, v65, v72
    v_perm_b32 v81, v65, v65, v73
    v_perm_b32 v82, v65, v65, v74
    v_perm_b32 v83, v65, v65, v75
    s_nop 1
    v_mfma_f32_16x16x32_bf16 v[88:91], v[80:83], v[172:175], v[88:91]
    v_perm_b32 v84, v65, v65, v76
    v_perm_b32 v85, v65, v65, v77
    v_perm_b32 v86, v65, v65, v78
    v_perm_b32 v87, v65, v65, v79
    s_nop 1
    v_mfma_f32_16x16x32_bf16 v[88:91], v[84:87], v[176:179], v[88:91]
    v_perm_b32 v80, v66, v66, v72
    v_perm_b32 v81, v66, v66, v73
    v_perm_b32 v82, v66, v66, v74
    v_perm_b32 v83, v66, v66, v75
    s_nop 1
    v_mfma_f32_16x16x32_bf16 v[88:91], v[80:83], v[180:183], v[88:91]
    v_perm_b32 v84, v66, v66, v76
    v_perm_b32 v85, v66, v66, v77
    v_perm_b32 v86, v66, v66, v78
    v_perm_b32 v87, v66, v66, v79
    s_nop 1
    v_mfma_f32_16x16x32_bf16 v[88:91], v[84:87], v[184:187], v[88:91]
    v_perm_b32 v80, v67, v67, v72
    v_perm_b32 v81, v67, v67, v73
    v_perm_b32 v82, v67, v67, v74
    v_perm_b32 v83, v67, v67, v75
    s_nop 1
    v_mfma_f32_16x16x32_bf16 v[88:91], v[80:83], v[188:191], v[88:91]
    v_perm_b32 v84, v67, v67, v76
    v_perm_b32 v85, v67, v67, v77
    v_perm_b32 v86, v67, v67, v78
    v_perm_b32 v87, v67, v67, v79
    s_nop 1
    v_mfma_f32_16x16x32_bf16 v[88:91], v[84:87], v[192:195], v[88:91]
    v_perm_b32 v80, v68, v68, v72
    v_perm_b32 v81, v68, v68, v73
    v_perm_b32 v82, v68, v68, v74
    v_perm_b32 v83, v68, v68, v75
    s_nop 1
    v_mfma_f32_16x16x32_bf16 v[88:91], v[80:83], v[196:199], v[88:91]
    v_perm_b32 v84, v68, v68, v76
    v_perm_b32 v85, v68, v68, v77
    v_perm_b32 v86, v68, v68, v78
    v_perm_b32 v87, v68, v68, v79
    s_nop 1
    v_mfma_f32_16x16x32_bf16 v[88:91], v[84:87], v[200:203], v[88:91]
    v_perm_b32 v80, v69, v69, v72
    v_perm_b32 v81, v69, v69, v73
    v_perm_b32 v82, v69, v69, v74
    v_perm_b32 v83, v69, v69, v75
    s_nop 1
    v_mfma_f32_16x16x32_bf16 v[88:91], v[80:83], v[204:207], v[88:91]
    v_perm_b32 v84, v69, v69, v76
    v_perm_b32 v85, v69, v69, v77
    v_perm_b32 v86, v69, v69, v78
    v_perm_b32 v87, v69, v69, v79
    s_nop 1
    v_mfma_f32_16x16x32_bf16 v[88:91], v[84:87], v[208:211], v[88:91]
    v_perm_b32 v80, v70, v70, v72
    v_perm_b32 v81, v70, v70, v73
    v_perm_b32 v82, v70, v70, v74
    v_perm_b32 v83, v70, v70, v75
    s_nop 1
    v_mfma_f32_16x16x32_bf16 v[88:91], v[80:83], v[212:215], v[88:91]
    v_perm_b32 v84, v70, v70, v76
    v_perm_b32 v85, v70, v70, v77
    v_perm_b32 v86, v70, v70, v78
    v_perm_b32 v87, v70, v70, v79
    s_nop 1
    v_mfma_f32_16x16x32_bf16 v[88:91], v[84:87], v[216:219], v[88:91]
    v_perm_b32 v80, v71, v71, v72
    v_perm_b32 v81, v71, v71, v73
    v_perm_b32 v82, v71, v71, v74
    v_perm_b32 v83, v71, v71, v75
    s_nop 1
    v_mfma_f32_16x16x32_bf16 v[88:91], v[80:83], v[220:223], v[88:91]
    v_perm_b32 v84, v71, v71, v76
    v_perm_b32 v85, v71, v71, v77
    v_perm_b32 v86, v71, v71, v78
    v_perm_b32 v87, v71, v71, v79
    s_nop 1
    v_mfma_f32_16x16x32_bf16 v[88:91], v[84:87], v[224:227], v[88:91]
    s_nop 7
    ds_write_b128 v18, v[88:91] offset:0
    s_waitcnt lgkmcnt(0)
    s_barrier
    s_cmp_lg_u32 s48, 0
    s_cbranch_scc1 L_gu_done
    ds_read_b128 v[20:23], v18 offset:1024
    ds_read_b128 v[24:27], v18 offset:2048
    ds_read_b128 v[28:31], v18 offset:3072
    s_waitcnt lgkmcnt(0)
    v_pk_add_f32 v[88:89], v[88:89], v[20:21]
    v_pk_add_f32 v[24:25], v[24:25], v[28:29]
    v_pk_add_f32 v[88:89], v[88:89], v[24:25]
    v_pk_add_f32 v[90:91], v[90:91], v[22:23]
    v_pk_add_f32 v[26:27], v[26:27], v[30:31]
    v_pk_add_f32 v[90:91], v[90:91], v[26:27]
    buffer_store_dwordx4 v[88:91], v19, s[16:19], 0 offen sc1
    buffer_atomic_swap v131, v132, s[16:19], 0 offen sc1
L_gu_done:
    v_mov_b32 v135, 0
    buffer_atomic_or v135, v134, s[16:19], 0 offen sc0 sc1
    s_mul_i32 s86, s45, 112
    s_mul_i32 s87, s48, 28
    s_add_u32 s86, s86, s87
    v_bfe_u32 v16, v0, 3, 2
    v_mul_u32_u24 v16, 7, v16
    v_and_b32 v17, 7, v0
    v_min_u32 v17, 6, v17
    v_add3_u32 v16, v16, v17, s86
    v_lshrrev_b32 v17, 5, v0
    v_mul_u32_u24 v17, 14336, v17
    v_lshl_add_u32 v16, v16, 2, v17
    v_add_u32 v16, 6553600, v16
    s_lshl_b32 s86, s45, 13
    s_lshl_b32 s87, s44, 9
    s_add_u32 s86, s86, s87
    s_add_u32 s86, s86, 6291456
    v_lshl_add_u32 v9, v2, 5, s86
    v_lshl_add_u32 v9, v10, 4, v9
    v_lshl_add_u32 v9, v11, 12, v9
    s_lshl_b32 s86, s48, 7
    s_add_u32 s86, s86, 100352
    v_lshl_add_u32 v10, v0, 1, s86
    v_lshl_add_u32 v11, v8, 6, s86
    v_lshl_add_u32 v11, v1, 4, v11
    s_branch L_h5f_chk
L_h5f:
    v_mov_b32 v135, 0
    buffer_atomic_or v135, v134, s[16:19], 0 offen sc0 sc1
L_h5f_chk:
    s_waitcnt vmcnt(0)
    v_cmp_ne_u32 vcc, s68, v135
    s_nop 0
    s_and_b64 vcc, vcc, 0xffff
    s_cbranch_vccz L_ok_7
    s_sub_u32 s56, s56, 1
    s_cbranch_scc0 L_h5f
    s_mov_b32 s56, 0
L_ok_7:
L_h5:
    s_mov_b32 s90, 0
    buffer_load_dword v24, v16, s[16:19], s90 offen sc1
    s_mov_b32 s90, 28672
    buffer_load_dword v25, v16, s[16:19], s90 offen sc1
    s_mov_b32 s90, 57344
    buffer_load_dword v26, v16, s[16:19], s90 offen sc1
    s_mov_b32 s90, 86016
    buffer_load_dword v27, v16, s[16:19], s90 offen sc1
    s_mov_b32 s90, 114688
    buffer_load_dword v28, v16, s[16:19], s90 offen sc1
    s_mov_b32 s90, 143360
    buffer_load_dword v29, v16, s[16:19], s90 offen sc1
    s_mov_b32 s90, 172032
    buffer_load_dword v30, v16, s[16:19], s90 offen sc1
    s_mov_b32 s90, 200704
    buffer_load_dword v31, v16, s[16:19], s90 offen sc1
    s_waitcnt vmcnt(0)
    v_max3_u32 v17, v24, v25, v26
    v_max3_u32 v17, v17, v27, v28
    v_max3_u32 v17, v17, v29, v30
    v_max_u32 v17, v17, v31
    v_cmp_eq_u32 vcc, -1, v17
    s_cbranch_vccz L_ok_8
    s_sub_u32 s56, s56, 1
    s_cbranch_scc0 L_h5
    s_mov_b32 s56, 0
L_ok_8:
    v_mov_b32 v19, v9
    v_add_f32 v24, v24, v25
    v_add_f32 v26, v26, v27
    v_add_f32 v28, v28, v29
    v_add_f32 v30, v30, v31
    v_add_f32 v24, v24, v26
    v_add_f32 v28, v28, v30
    v_cvt_pk_bf16_f32 v25, v24, v28
    v_lshlrev_b32 v24, 16, v25
    v_and_b32 v28, 0xffff0000, v25
    v_mul_f32 v25, 0xbfb8aa3b, v24
    v_exp_f32 v25, v25
    s_nop 0
    v_add_f32 v25, 1.0, v25
    v_rcp_f32 v25, v25
    s_nop 0
    v_mul_f32 v24, v24, v25
    v_cvt_pk_bf16_f32 v24, v24, v24
    v_lshlrev_b32 v24, 16, v24
    v_mul_f32 v24, v24, v28
    v_cvt_pk_bf16_f32 v24, v24, v24
    ds_write_b16 v10, v24
    s_waitcnt lgkmcnt(0)
    ds_read_b128 v[64:67], v11
    s_waitcnt lgkmcnt(0)
    v_perm_b32 v80, v64, v64, v72
    v_perm_b32 v81, v64, v64, v73
    v_perm_b32 v82, v64, v64, v74
    v_perm_b32 v83, v64, v64, v75
    s_nop 1
    v_mfma_f32_16x16x32_bf16 v[88:91], v[80:83], v[228:231], 0
    v_perm_b32 v84, v64, v64, v76
    v_perm_b32 v85, v64, v64, v77
    v_perm_b32 v86, v64, v64, v78
    v_perm_b32 v87, v64, v64, v79
    s_nop 1
    v_mfma_f32_16x16x32_bf16 v[88:91], v[84:87], v[232:235], v[88:91]
    v_perm_b32 v80, v65, v65, v72
    v_perm_b32 v81, v65, v65, v73
    v_perm_b32 v82, v65, v65, v74
    v_perm_b32 v83, v65, v65, v75
    s_nop 1
    v_mfma_f32_16x16x32_bf16 v[88:91], v[80:83], v[236:239], v[88:91]
    v_perm_b32 v84, v65, v65, v76
    v_perm_b32 v85, v65, v65, v77
    v_perm_b32 v86, v65, v65, v78
    v_perm_b32 v87, v65, v65, v79
    s_nop 1
    v_mfma_f32_16x16x32_bf16 v[88:91], v[84:87], v[240:243], v[88:91]
    v_perm_b32 v80, v66, v66, v72
    v_perm_b32 v81, v66, v66, v73
    v_perm_b32 v82, v66, v66, v74
    v_perm_b32 v83, v66, v66, v75
    s_nop 1
    v_mfma_f32_16x16x32_bf16 v[88:91], v[80:83], v[244:247], v[88:91]
    v_perm_b32 v84, v66, v66, v76
    v_perm_b32 v85, v66, v66, v77
    v_perm_b32 v86, v66, v66, v78
    v_perm_b32 v87, v66, v66, v79
    s_nop 1
    v_mfma_f32_16x16x32_bf16 v[88:91], v[84:87], v[248:251], v[88:91]
    v_perm_b32 v80, v67, v67, v72
    v_perm_b32 v81, v67, v67, v73
    v_perm_b32 v82, v67, v67, v74
    v_perm_b32 v83, v67, v67, v75
    s_nop 1
    v_mfma_f32_16x16x32_bf16 v[88:91], v[80:83], v[252:255], v[88:91]
    s_nop 7
    ds_write_b128 v18, v[88:91] offset:4096
    s_waitcnt lgkmcnt(0)
    s_barrier
    s_cmp_lg_u32 s48, 0
    s_cbranch_scc1 L_dn_done
    ds_read_b128 v[20:23], v18 offset:5120
    ds_read_b128 v[24:27], v18 offset:6144
    ds_read_b128 v[28:31], v18 offset:7168
    s_waitcnt lgkmcnt(0)
    v_pk_add_f32 v[88:89], v[88:89], v[20:21]
    v_pk_add_f32 v[24:25], v[24:25], v[28:29]
    v_pk_add_f32 v[88:89], v[88:89], v[24:25]
    v_pk_add_f32 v[90:91], v[90:91], v[22:23]
    v_pk_add_f32 v[26:27], v[26:27], v[30:31]
    v_pk_add_f32 v[90:91], v[90:91], v[26:27]
    buffer_store_dwordx4 v[88:91], v19, s[16:19], 0 offen sc1
    buffer_atomic_swap v131, v133, s[16:19], 0 offen sc1
L_dn_done:
L_final:
    s_cmp_eq_u64 s[96:97], 0
    s_cbranch_scc1 L_fin
    v_cmp_ne_u32 s[4:5], s60, v13
    v_cmp_ne_u32 s[6:7], s61, v13
    s_nop 0
    s_and_b64 s[4:5], s[4:5], s[6:7]
    s_and_b64 s[4:5], s[4:5], s[96:97]
    s_cbranch_scc0 L_nolost
    v_mov_b32 v9, 2147483648
    v_cndmask_b32 v8, v9, v5, s[4:5]
    buffer_store_dwordx4 v[104:107], v8, s[24:27], 0 offen sc1
    buffer_store_dwordx4 v[108:111], v8, s[24:27], 0 offen offset:64 sc1
L_nolost:
    s_mov_b32 s63, 0
L_fin_loop:
    v_cmp_eq_u32 vcc, s60, v13
    s_cbranch_vccz L_fin_next
    s_cmp_eq_u32 s60, s58
    s_cselect_b32 s86, 0, 512
    s_add_u32 s86, s86, 98304
    v_lshl_add_u32 v8, v2, 3, s86
    v_mov_b32 v9, s86
    ds_read_b64 v[56:57], v8
    ds_read_b64 v[58:59], v8 offset:128
    ds_read_b32 v60, v9 offset:256
    s_lshl_b32 s86, s63, 12
    s_lshl_b32 s87, s52, 8
    s_add_u32 s86, s86, s87
    s_add_u32 s86, s86, 6291456
    v_lshl_add_u32 v10, v2, 4, s86
    v_lshl_add_u32 v10, v1, 13, v10
    s_and_b32 s86, s60, 0x7ff
    s_sub_u32 s86, 2047, s86
    s_lshl_b32 s86, s86, 11
    s_lshl_b32 s87, s52, 7
    s_add_u32 s86, s86, s87
    v_lshl_add_u32 v11, v2, 3, s86
    v_cmp_eq_u32 vcc, 0, v1
    v_mov_b32 v9, 2147483648
    s_nop 0
    v_cndmask_b32 v11, v9, v11, vcc
    s_waitcnt lgkmcnt(0)
    v_mul_f32 v60, 0xbfb8aa3b, v60
    v_exp_f32 v60, v60
    s_nop 0
    v_add_f32 v60, 1.0, v60
    v_rcp_f32 v60, v60
    s_nop 0
    v_cvt_pk_bf16_f32 v60, v60, v60
    v_lshlrev_b32 v60, 16, v60
    v_lshlrev_b32 v64, 16, v56
    v_and_b32 v65, 0xffff0000, v56
    v_lshlrev_b32 v68, 16, v58
    v_and_b32 v69, 0xffff0000, v58
    v_lshlrev_b32 v66, 16, v57
    v_and_b32 v67, 0xffff0000, v57
    v_lshlrev_b32 v70, 16, v59
    v_and_b32 v71, 0xffff0000, v59
    s_lshr_b32 s86, s52, 1
    s_lshl_b32 s86, s86, 7
    s_add_u32 s86, s86, 737280
    v_lshl_add_u32 v9, v0, 2, s86
    v_mov_b32 v8, 2147483648
    v_cmp_gt_u32 vcc, 32, v0
    s_nop 1
    v_cndmask_b32 v9, v8, v9, vcc
L_h6f:
    v_mov_b32 v8, 0
    buffer_atomic_or v8, v9, s[16:19], 0 offen sc0 sc1
    s_waitcnt vmcnt(0)
    v_cmp_ne_u32 vcc, s68, v8
    s_mov_b32 vcc_hi, 0
    s_cbranch_vccz L_ok_9
    s_sub_u32 s56, s56, 1
    s_cbranch_scc0 L_h6f
    s_mov_b32 s56, 0
L_ok_9:
L_h6:
    s_mov_b32 s90, 0
    buffer_load_dwordx4 v[112:115], v10, s[16:19], s90 offen sc1
    s_mov_b32 s90, 32768
    buffer_load_dwordx4 v[116:119], v10, s[16:19], s90 offen sc1
    s_mov_b32 s90, 65536
    buffer_load_dwordx4 v[120:123], v10, s[16:19], s90 offen sc1
    s_mov_b32 s90, 98304
    buffer_load_dwordx4 v[124:127], v10, s[16:19], s90 offen sc1
    s_mov_b32 s90, 131072
    buffer_load_dwordx4 v[128:131], v10, s[16:19], s90 offen sc1
    s_mov_b32 s90, 163840
    buffer_load_dwordx4 v[132:135], v10, s[16:19], s90 offen sc1
    s_mov_b32 s90, 196608
    buffer_load_dwordx4 v[136:139], v10, s[16:19], s90 offen sc1
    s_mov_b32 s90, 229376
    buffer_load_dwordx4 v[140:143], v10, s[16:19], s90 offen sc1
    s_waitcnt vmcnt(0)
    v_max3_u32 v8, v115, v119, v123
    v_max3_u32 v8, v8, v127, v131
    v_max3_u32 v8, v8, v135, v139
    v_max_u32 v8, v8, v143
    v_cmp_eq_u32 vcc, -1, v8
    s_cbranch_vccz L_ok_10
    s_sub_u32 s56, s56, 1
    s_cbranch_scc0 L_h6
    s_mov_b32 s56, 0
L_ok_10:
    v_pk_add_f32 v[112:113], v[112:113], v[128:129]
    v_pk_add_f32 v[114:115], v[114:115], v[130:131]
    v_pk_add_f32 v[116:117], v[116:117], v[132:133]
    v_pk_add_f32 v[118:119], v[118:119], v[134:135]
    v_pk_add_f32 v[120:121], v[120:121], v[136:137]
    v_pk_add_f32 v[122:123], v[122:123], v[138:139]
    v_pk_add_f32 v[124:125], v[124:125], v[140:141]
    v_pk_add_f32 v[126:127], v[126:127], v[142:143]
    v_pk_add_f32 v[112:113], v[112:113], v[120:121]
    v_pk_add_f32 v[114:115], v[114:115], v[122:123]
    v_pk_add_f32 v[116:117], v[116:117], v[124:125]
    v_pk_add_f32 v[118:119], v[118:119], v[126:127]
    v_pk_add_f32 v[112:113], v[112:113], v[116:117]
    v_pk_add_f32 v[114:115], v[114:115], v[118:119]
    v_mov_b32 v116, v112
    v_mov_b32 v117, v113
    v_mov_b32 v118, v114
    v_mov_b32 v119, v115
    v_permlane32_swap_b32 v112, v116
    v_permlane32_swap_b32 v113, v117
    v_permlane32_swap_b32 v114, v118
    v_permlane32_swap_b32 v115, v119
    v_add_f32 v112, v112, v116
    v_add_f32 v113, v113, v117
    v_add_f32 v114, v114, v118
    v_add_f32 v115, v115, v119
    v_mov_b32 v116, v112
    v_mov_b32 v117, v113
    v_mov_b32 v118, v114
    v_mov_b32 v119, v115
    v_permlane16_swap_b32 v112, v116
    v_permlane16_swap_b32 v113, v117
    v_permlane16_swap_b32 v114, v118
    v_permlane16_swap_b32 v115, v119
    v_add_f32 v112, v112, v116
    v_add_f32 v113, v113, v117
    v_add_f32 v114, v114, v118
    v_add_f32 v115, v115, v119
    v_cvt_pk_bf16_f32 v116, v112, v113
    v_cvt_pk_bf16_f32 v117, v114, v115
    v_lshlrev_b32 v112, 16, v116
    v_and_b32 v113, 0xffff0000, v116
    v_lshlrev_b32 v114, 16, v117
    v_and_b32 v115, 0xffff0000, v117
    v_pk_mul_f32 v[112:113], v[112:113], v[60:61] op_sel_hi:[1,0]
    v_pk_mul_f32 v[114:115], v[114:115], v[60:61] op_sel_hi:[1,0]
    v_cvt_pk_bf16_f32 v116, v112, v113
    v_cvt_pk_bf16_f32 v117, v114, v115
    v_lshlrev_b32 v112, 16, v116
    v_and_b32 v113, 0xffff0000, v116
    v_lshlrev_b32 v114, 16, v117
    v_and_b32 v115, 0xffff0000, v117
    v_pk_add_f32 v[112:113], v[112:113], v[68:69]
    v_pk_add_f32 v[114:115], v[114:115], v[70:71]
    v_cvt_pk_bf16_f32 v116, v112, v113
    v_cvt_pk_bf16_f32 v117, v114, v115
    v_lshlrev_b32 v112, 16, v116
    v_and_b32 v113, 0xffff0000, v116
    v_lshlrev_b32 v114, 16, v117
    v_and_b32 v115, 0xffff0000, v117
    v_pk_add_f32 v[112:113], v[112:113], v[64:65]
    v_pk_add_f32 v[114:115], v[114:115], v[66:67]
    v_cvt_pk_bf16_f32 v116, v112, v113
    v_cvt_pk_bf16_f32 v117, v114, v115
    buffer_store_dwordx2 v[116:117], v11, s[24:27], 0 offen
L_fin_next:
    s_mov_b32 s60, s61
    s_add_u32 s63, s63, 1
    s_cmp_lt_u32 s63, 2
    s_cbranch_scc1 L_fin_loop
L_fin:
L_end:
    s_endpgm
L_b_restart:
    s_waitcnt vmcnt(0)
    v_xor_b32 v9, 0x8000, v7
    buffer_load_dwordx4 v[136:139], v7, s[8:11], 0 offen
    buffer_load_dwordx4 v[140:143], v9, s[8:11], 0 offen
    v_mov_b32 v8, s68
    s_mov_b32 s66, 0xffffaaaa
    s_mov_b32 s63, 1
    s_branch L_b_init
L_b_p0:
    v_mov_b32 v8, 0
    buffer_atomic_or v8, v159, s[16:19], 0 offen sc0 sc1
L_b_w0:
    s_waitcnt vmcnt(0)
    v_cmp_eq_u32 vcc, s68, v8
    s_nop 0
    s_lshr_b32 s65, vcc_lo, 1
    s_and_b32 s65, s65, vcc_lo
    s_andn2_b32 s65, s65, s66
    s_cbranch_scc0 L_b_q0
    s_or_b32 s66, s66, s65
    s_branch L_b_r0
L_b_q0:
    s_sub_u32 s56, s56, 1
    s_cbranch_scc0 L_b_p0
    s_mov_b32 s56, 0
    s_not_b32 s65, s66
    s_branch L_b_r0
L_b_p1:
    v_mov_b32 v8, 0
    buffer_atomic_or v8, v159, s[16:19], 0 offen sc0 sc1
    s_waitcnt vmcnt(0)
    v_cmp_eq_u32 vcc, s68, v8
    s_nop 0
    s_lshr_b32 s65, vcc_lo, 1
    s_and_b32 s65, s65, vcc_lo
    s_andn2_b32 s65, s65, s66
    s_cbranch_scc0 L_b_q1
    s_or_b32 s66, s66, s65
    s_branch L_b_r1
L_b_q1:
    s_sub_u32 s56, s56, 1
    s_cbranch_scc0 L_b_p1
    s_mov_b32 s56, 0
    s_not_b32 s65, s66
    s_branch L_b_r1
L_b_p2:
    v_mov_b32 v8, 0
    buffer_atomic_or v8, v159, s[16:19], 0 offen sc0 sc1
    s_waitcnt vmcnt(0)
    v_cmp_eq_u32 vcc, s68, v8
    s_nop 0
    s_lshr_b32 s65, vcc_lo, 1
    s_and_b32 s65, s65, vcc_lo
    s_andn2_b32 s65, s65, s66
    s_cbranch_scc0 L_b_q2
    s_or_b32 s66, s66, s65
    s_branch L_b_r2
L_b_q2:
    s_sub_u32 s56, s56, 1
    s_cbranch_scc0 L_b_p2
    s_mov_b32 s56, 0
    s_not_b32 s65, s66
    s_branch L_b_r2
L_b_p3:
    v_mov_b32 v8, 0
    buffer_atomic_or v8, v159, s[16:19], 0 offen sc0 sc1
    s_waitcnt vmcnt(0)
    v_cmp_eq_u32 vcc, s68, v8
    s_nop 0
    s_lshr_b32 s65, vcc_lo, 1
    s_and_b32 s65, s65, vcc_lo
    s_andn2_b32 s65, s65, s66
    s_cbranch_scc0 L_b_q3
    s_or_b32 s66, s66, s65
    s_branch L_b_r3
L_b_q3:
    s_sub_u32 s56, s56, 1
    s_cbranch_scc0 L_b_p3
    s_mov_b32 s56, 0
    s_not_b32 s65, s66
    s_branch L_b_r3
L_b_p4:
    v_mov_b32 v8, 0
    buffer_atomic_or v8, v159, s[16:19], 0 offen sc0 sc1
    s_waitcnt vmcnt(0)
    v_cmp_eq_u32 vcc, s68, v8
    s_nop 0
    s_lshr_b32 s65, vcc_lo, 1
    s_and_b32 s65, s65, vcc_lo
    s_andn2_b32 s65, s65, s66
    s_cbranch_scc0 L_b_q4
    s_or_b32 s66, s66, s65
    s_branch L_b_r4
L_b_q4:
    s_sub_u32 s56, s56, 1
    s_cbranch_scc0 L_b_p4
    s_mov_b32 s56, 0
    s_not_b32 s65, s66
    s_branch L_b_r4
L_b_p5:
    v_mov_b32 v8, 0
    buffer_atomic_or v8, v159, s[16:19], 0 offen sc0 sc1
    s_waitcnt vmcnt(0)
    v_cmp_eq_u32 vcc, s68, v8
    s_nop 0
    s_lshr_b32 s65, vcc_lo, 1
    s_and_b32 s65, s65, vcc_lo
    s_andn2_b32 s65, s65, s66
    s_cbranch_scc0 L_b_q5
    s_or_b32 s66, s66, s65
    s_branch L_b_r5
L_b_q5:
    s_sub_u32 s56, s56, 1
    s_cbranch_scc0 L_b_p5
    s_mov_b32 s56, 0
    s_not_b32 s65, s66
    s_branch L_b_r5
L_b_p6:
    v_mov_b32 v8, 0
    buffer_atomic_or v8, v159, s[16:19], 0 offen sc0 sc1
    s_waitcnt vmcnt(0)
    v_cmp_eq_u32 vcc, s68, v8
    s_nop 0
    s_lshr_b32 s65, vcc_lo, 1
    s_and_b32 s65, s65, vcc_lo
    s_andn2_b32 s65, s65, s66
    s_cbranch_scc0 L_b_q6
    s_or_b32 s66, s66, s65
    s_branch L_b_r6
L_b_q6:
    s_sub_u32 s56, s56, 1
    s_cbranch_scc0 L_b_p6
    s_mov_b32 s56, 0
    s_not_b32 s65, s66
    s_branch L_b_r6
L_b_p7:
    v_mov_b32 v8, 0
    buffer_atomic_or v8, v159, s[16:19], 0 offen sc0 sc1
    s_waitcnt vmcnt(0)
    v_cmp_eq_u32 vcc, s68, v8
    s_nop 0
    s_lshr_b32 s65, vcc_lo, 1
    s_and_b32 s65, s65, vcc_lo
    s_andn2_b32 s65, s65, s66
    s_cbranch_scc0 L_b_q7
    s_or_b32 s66, s66, s65
    s_branch L_b_r7
L_b_q7:
    s_sub_u32 s56, s56, 1
    s_cbranch_scc0 L_b_p7
    s_mov_b32 s56, 0
    s_not_b32 s65, s66
    s_branch L_b_r7
    s_endpgm
.section .rodata,"a"
.p2align 6
.amdhsa_kernel sequential_preLN__linear_attn_block__moe_arch_mod__prompt_kernel
  .amdhsa_next_free_vgpr 256
  .amdhsa_next_free_sgpr 102
  .amdhsa_accum_offset 256
  .amdhsa_group_segment_fixed_size 0
  .amdhsa_kernarg_size 88
  .amdhsa_user_sgpr_count 2
  .amdhsa_user_sgpr_kernarg_segment_ptr 1
  .amdhsa_system_sgpr_workgroup_id_x 1
.end_amdhsa_kernel
```

```asm
; @launch grid=(256,1,1) block=(512,1,1) lds=163840
.amdgcn_target "amdgcn-amd-amdhsa--gfx950"
.text
.globl sequential_preLN__linear_attn_block__moe_arch_mod__prompt_kernel
.p2align 8
.type sequential_preLN__linear_attn_block__moe_arch_mod__prompt_kernel,@function
sequential_preLN__linear_attn_block__moe_arch_mod__prompt_kernel:
    s_cmp_ge_u32 s2, 256
    s_cbranch_scc1 L_end
    s_load_dwordx16 s[64:79], s[0:1], 0
    s_load_dwordx4 s[80:83], s[0:1], 64
    s_load_dwordx2 s[84:85], s[0:1], 80
    v_lshrrev_b32 v1, 6, v0
    v_and_b32 v0, 63, v0
    v_readfirstlane_b32 s3, v1
    s_and_b32 s44, s2, 7
    s_lshr_b32 s45, s2, 3
    s_and_b32 s46, s44, 1
    s_lshl_b32 s46, s46, 3
    s_and_b32 s86, s45, 7
    s_add_u32 s46, s46, s86
    s_lshr_b32 s47, s44, 1
    s_lshl_b32 s47, s47, 2
    s_lshr_b32 s86, s45, 3
    s_add_u32 s47, s47, s86
    s_mov_b32 s51, s47
    s_mov_b32 s52, s46
    s_and_b32 s48, s3, 3
    s_and_b32 s49, s3, 1
    s_bfe_u32 s50, s3, 0x10001
    s_mov_b32 s56, 65536
    s_mov_b32 s95, 0x3f803f80
    s_movk_i32 s92, 0x1000
    s_movk_i32 s93, 0x2000
    s_movk_i32 s94, 0x3000
    s_cmp_lt_u32 s3, 4
    s_cbranch_scc1 L_comp
    v_lshrrev_b32 v20, 3, v0
    v_and_b32 v21, 7, v0
    v_lshrrev_b32 v22, 4, v0
    v_xor_b32 v23, v21, v22
    v_xor_b32 v24, 4, v23
    s_lshl_b32 s86, s48, 5
    v_add_u32 v25, s86, v20
    v_lshlrev_b32 v25, 11, v25
    v_lshl_add_u32 v2, v23, 4, v25
    v_lshl_add_u32 v3, v24, 4, v25
    v_add_u32 v3, 15360, v3
    v_lshl_add_u32 v4, v23, 4, v25
    v_add_u32 v4, 30720, v4
    v_lshl_add_u32 v5, v24, 4, v25
    v_add_u32 v5, 46080, v5
    s_lshl_b32 s86, s48, 4
    v_add_u32 v25, s86, v20
    v_mul_u32_u24 v25, 6144, v25
    s_lshl_b32 s86, s47, 7
    v_add_u32 v25, s86, v25
    v_bfe_u32 v26, v0, 4, 1
    v_lshlrev_b32 v26, 1, v26
    v_xor_b32 v26, v26, v21
    v_xor_b32 v27, 4, v26
    v_lshl_add_u32 v6, v26, 4, v25
    v_lshl_add_u32 v7, v27, 4, v25
    v_add_u32 v7, 48128, v7
    v_lshl_add_u32 v8, v26, 4, v25
    v_add_u32 v8, 2048, v8
    v_lshl_add_u32 v9, v27, 4, v25
    v_add_u32 v9, 50176, v9
    v_lshl_add_u32 v10, v26, 4, v25
    v_add_u32 v10, 4096, v10
    v_lshl_add_u32 v11, v27, 4, v25
    v_add_u32 v11, 52224, v11
    s_lshl_b32 s63, s46, 18
    s_lshl_b32 s53, s48, 12
    s_lshl_b32 s62, s48, 11
    s_add_u32 s62, s62, 16384
    s_setprio 1
    s_lshl_b32 s86, s45, 2
    s_add_u32 s86, s86, s48
    s_mul_i32 s87, s86, 12288
    s_and_b32 s88, s47, 12
    s_lshl_b32 s88, s88, 7
    s_add_u32 s87, s87, s88
    s_add_u32 s87, s87, 384
    s_bitcmp1_b32 s47, 2
    s_cselect_b32 s87, 2147483648, s87
    v_lshl_add_u32 v37, v0, 11, s87
    v_mov_b32 v24, 2147483648
    v_cmp_gt_u32 vcc, 6, v0
    s_nop 1
    v_cndmask_b32 v37, v24, v37, vcc
    s_lshl_b32 s86, s86, 14
    s_and_b32 s88, s46, 8
    s_lshl_b32 s88, s88, 7
    s_add_u32 s86, s86, s88
    s_add_u32 s86, s86, 384
    v_lshl_add_u32 v38, v0, 11, s86
    v_cmp_gt_u32 vcc, 8, v0
    s_nop 1
    v_cndmask_b32 v38, v24, v38, vcc
    s_waitcnt lgkmcnt(0)
    s_mov_b32 s8, s64
    s_and_b32 s9, s65, 0xffff
    s_mov_b32 s10, 4194304
    s_mov_b32 s11, 0x20000
    s_mov_b32 s12, s66
    s_and_b32 s13, s67, 0xffff
    s_mov_b32 s14, 6291456
    s_mov_b32 s15, 0x20000
    s_and_b32 s86, s47, 12
    s_and_b32 s87, s46, 8
    s_add_u32 s64, s86, s87
    s_and_b32 s64, s64, 15
    s_mov_b32 s67, s64
    s_load_dword s61, s[84:85], 524288
    s_lshr_b32 s90, s67, 2
    s_mul_i32 s90, s90, 1572864
    buffer_load_dword v39, v37, s[12:15], s90 offen
    s_add_u32 m0, s53, 40960
    s_lshl_b32 s70, s64, 7
    s_add_u32 s70, s70, s63
    buffer_load_dwordx4 v2, s[8:11], s70 offen offset:0 lds
    buffer_load_dwordx4 v3, s[8:11], s70 offen offset:1024 lds
    buffer_load_dwordx4 v4, s[8:11], s70 offen offset:2048 lds
    buffer_load_dwordx4 v5, s[8:11], s70 offen offset:3072 lds
    s_mul_i32 s91, s64, 393216
    s_add_u32 s64, s64, 1
    s_and_b32 s64, s64, 15
    s_add_u32 m0, s62, 40960
    s_nop 0
    buffer_load_dwordx4 v6, s[12:15], s91 offen offset:0 lds
    buffer_load_dwordx4 v7, s[12:15], s91 offen offset:1024 lds
    s_add_u32 m0, s62, 49152
    s_nop 0
    buffer_load_dwordx4 v8, s[12:15], s91 offen offset:0 lds
    buffer_load_dwordx4 v9, s[12:15], s91 offen offset:1024 lds
    s_add_u32 m0, s62, 57344
    s_nop 0
    buffer_load_dwordx4 v10, s[12:15], s91 offen offset:0 lds
    buffer_load_dwordx4 v11, s[12:15], s91 offen offset:1024 lds
    s_mov_b32 s16, s84
    s_and_b32 s17, s85, 0xffff
    s_mov_b32 s18, 268435456
    s_mov_b32 s19, 0x20000
    s_mov_b32 s20, s68
    s_and_b32 s21, s69, 0xffff
    s_mov_b32 s22, 2097152
    s_mov_b32 s23, 0x20000
    s_mov_b32 s24, s80
    s_and_b32 s25, s81, 0xffff
    s_mov_b32 s26, 4194304
    s_mov_b32 s27, 0x20000
    s_mov_b32 s28, s82
    s_and_b32 s29, s83, 0xffff
    s_mov_b32 s30, 256
    s_mov_b32 s31, 0x20000
    s_bitcmp1_b32 s2, 0
    s_cselect_b32 s32, s76, s74
    s_cselect_b32 s33, s77, s75
    s_and_b32 s33, s33, 0xffff
    s_mov_b32 s34, 7340032
    s_mov_b32 s35, 0x20000
    s_mov_b32 s36, s78
    s_and_b32 s37, s79, 0xffff
    s_mov_b32 s38, 7340032
    s_mov_b32 s39, 0x20000
    s_mov_b32 s40, s72
    s_and_b32 s41, s73, 0xffff
    s_mov_b32 s42, 2048
    s_mov_b32 s43, 0x20000
    v_lshrrev_b32 v22, 4, v0
    v_and_b32 v23, 15, v0
    s_lshl_b32 s86, s45, 2
    s_add_u32 s86, s86, s48
    s_mul_i32 s87, s86, 6
    v_mul_u32_u24 v24, 43, v0
    v_lshrrev_b32 v24, 8, v24
    v_mul_u32_u24 v25, 6, v24
    v_sub_u32 v25, v0, v25
    v_add_u32 v25, s87, v25
    s_add_u32 s87, s67, 2
    v_add_u32 v24, s87, v24
    v_and_b32 v24, 15, v24
    v_mul_u32_u24 v124, 393216, v24
    v_lshrrev_b32 v24, 2, v25
    v_lshl_add_u32 v124, v24, 11, v124
    v_and_b32 v25, 3, v25
    s_and_b32 s88, s47, 12
    v_add_u32 v25, s88, v25
    v_lshl_add_u32 v124, v25, 7, v124
    v_mov_b32 v24, 2147483648
    v_cmp_gt_u32 vcc, 36, v0
    s_nop 1
    v_cndmask_b32 v124, v24, v124, vcc
    v_add_u32 v24, s87, v20
    v_and_b32 v24, 15, v24
    s_and_b32 s88, s46, 8
    s_lshl4_add_u32 s86, s88, s86
    s_lshl_b32 s86, s86, 14
    v_lshl_add_u32 v123, v21, 11, s86
    v_lshl_add_u32 v123, v24, 7, v123
    v_mov_b32 v24, 2147483648
    v_cmp_gt_u32 vcc, 16, v0
    s_nop 1
    v_cndmask_b32 v123, v24, v123, vcc
    s_add_u32 m0, s53, 81920
    s_lshl_b32 s70, s64, 7
    s_add_u32 s70, s70, s63
    buffer_load_dwordx4 v2, s[8:11], s70 offen offset:0 lds
    buffer_load_dwordx4 v3, s[8:11], s70 offen offset:1024 lds
    buffer_load_dwordx4 v4, s[8:11], s70 offen offset:2048 lds
    buffer_load_dwordx4 v5, s[8:11], s70 offen offset:3072 lds
    s_mul_i32 s91, s64, 393216
    s_add_u32 s64, s64, 1
    s_and_b32 s64, s64, 15
    s_add_u32 m0, s62, 81920
    s_nop 0
    buffer_load_dwordx4 v6, s[12:15], s91 offen offset:0 lds
    buffer_load_dwordx4 v7, s[12:15], s91 offen offset:1024 lds
    s_add_u32 m0, s62, 90112
    s_nop 0
    buffer_load_dwordx4 v8, s[12:15], s91 offen offset:0 lds
    buffer_load_dwordx4 v9, s[12:15], s91 offen offset:1024 lds
    s_add_u32 m0, s62, 98304
    s_nop 0
    buffer_load_dwordx4 v10, s[12:15], s91 offen offset:0 lds
    buffer_load_dwordx4 v11, s[12:15], s91 offen offset:1024 lds
    buffer_load_dword v122, v123, s[8:11], 0 offen
    buffer_load_dword v122, v124, s[12:15], 0 offen
    s_and_b32 s65, s45, 7
    s_lshr_b32 s66, s45, 3
    s_add_u32 s86, s65, 1
    s_and_b32 s86, s86, 3
    s_mul_i32 s86, s86, 40960
    s_lshl_b32 s87, s48, 13
    s_cmp_eq_u32 s48, 3
    s_cselect_b32 s87, 0, s87
    s_add_u32 s86, s86, s87
    s_add_u32 s86, s86, 16384
    v_lshl_add_u32 v25, v20, 7, s86
    v_lshl_add_u32 v28, v26, 4, v25
    v_lshl_add_u32 v29, v27, 4, v25
    s_add_u32 s86, s66, 1
    s_and_b32 s86, s86, 3
    s_mul_i32 s86, s86, 40960
    s_add_u32 s86, s86, s53
    v_lshl_add_u32 v16, v0, 6, s86
    v_bfe_u32 v25, v0, 2, 2
    v_lshl_add_u32 v16, v25, 4, v16
    v_xor_b32 v17, 16, v16
    v_xor_b32 v18, 32, v16
    v_xor_b32 v19, 48, v16
    s_lshl_b32 s86, s46, 14
    s_lshl_b32 s87, s48, 8
    s_add_u32 s86, s86, s87
    s_add_u32 s86, s86, 262144
    v_lshl_add_u32 v33, v23, 4, s86
    v_lshl_add_u32 v33, v22, 10, v33
    s_lshl_b32 s87, s47, 10
    s_add_u32 s86, s86, s87
    v_lshl_add_u32 v13, v0, 2, s86
    v_and_b32 v25, 3, v0
    v_cmp_eq_u32 vcc, 0, v25
    v_mov_b32 v24, 2147483648
    s_nop 0
    v_cndmask_b32 v13, v24, v13, vcc
    s_mul_i32 s86, s47, 12288
    s_add_u32 s86, s86, 65536
    s_lshl_b32 s87, s48, 8
    s_cmp_eq_u32 s48, 3
    s_cselect_b32 s87, 2147483648, s87
    s_mov_b32 s88, 0
    s_add_u32 s86, s86, s87
    v_lshl_add_u32 v32, v23, 4, s86
    v_mul_u32_u24 v25, 768, v22
    v_add_u32 v32, v32, v25
    s_mul_i32 s87, s46, 768
    s_add_u32 s86, s86, s87
    s_add_u32 s86, s86, s88
    v_lshl_add_u32 v34, v23, 5, s86
    v_lshl_add_u32 v34, v22, 4, v34
    v_and_b32 v25, 0x28, v0
    v_cmp_eq_u32 vcc, 0, v25
    s_nop 1
    v_cndmask_b32 v34, v24, v34, vcc
    s_bfe_u32 s86, s2, 0x20001
    s_lshl_b32 s86, s86, 2
    s_add_u32 s86, s86, s48
    s_lshl_b32 s86, s86, 6
    v_lshl_add_u32 v30, v22, 4, s86
    v_mul_u32_u24 v30, 7168, v30
    s_lshl_b32 s86, s45, 1
    s_sub_u32 s86, s86, 14
    s_mul_i32 s87, s86, 37
    s_lshr_b32 s87, s87, 8
    s_add_u32 s80, s86, s87
    s_and_b32 s87, s80, 7
    s_cmp_ge_u32 s87, 3
    s_addc_u32 s80, s80, 0
    s_lshl_b32 s86, s45, 1
    s_sub_u32 s86, s86, 13
    s_mul_i32 s87, s86, 37
    s_lshr_b32 s87, s87, 8
    s_add_u32 s81, s86, s87
    s_and_b32 s87, s81, 7
    s_cmp_ge_u32 s87, 3
    s_addc_u32 s81, s81, 0
    s_lshl_b32 s86, s45, 3
    s_add_u32 s86, s86, 3
    s_cmp_lt_u32 s45, 7
    s_cselect_b32 s80, s86, s80
    s_cselect_b32 s81, 56, s81
    v_mov_b32 v24, s80
    v_mov_b32 v25, s81
    s_mov_b32 vcc_lo, 4278255360
    s_mov_b32 vcc_hi, vcc_lo
    v_cndmask_b32 v24, v24, v25, vcc
    v_cmp_gt_u32 vcc, 56, v24
    v_and_b32 v25, 7, v0
    v_lshlrev_b32 v24, 7, v24
    v_lshl_add_u32 v24, v25, 4, v24
    v_add_u32 v30, v30, v24
    v_mov_b32 v24, 2147483648
    v_cndmask_b32 v30, v24, v30, vcc
    s_mul_i32 s86, s45, 112
    s_mul_i32 s87, s48, 28
    s_add_u32 s86, s86, s87
    v_mul_u32_u24 v31, 7, v22
    v_add_u32 v31, s86, v31
    v_lshlrev_b32 v31, 11, v31
    s_lshl_b32 s86, s44, 8
    v_lshl_add_u32 v24, v23, 4, s86
    v_add_u32 v31, v31, v24
    v_lshlrev_b32 v24, 1, v22
    v_xor_b32 v24, v24, v21
    s_lshl_b32 s86, s48, 3
    v_add_u32 v12, s86, v20
    v_lshlrev_b32 v12, 11, v12
    s_lshl_b32 s86, s52, 7
    v_lshl_add_u32 v24, v24, 4, s86
    v_add_u32 v12, v12, v24
    s_lshl_b32 s89, s48, 10
    v_and_b32 v24, 1, v0
    v_lshlrev_b32 v24, 4, v24
    v_mov_b32 v25, 0x3f80
    v_lshlrev_b32 v24, v24, v25
    v_bfe_u32 v25, v0, 1, 2
    v_cmp_eq_u32 vcc, 0, v25
    s_nop 1
    v_cndmask_b32 v104, 0, v24, vcc
    v_cmp_eq_u32 vcc, 1, v25
    s_nop 1
    v_cndmask_b32 v105, 0, v24, vcc
    v_cmp_eq_u32 vcc, 2, v25
    s_nop 1
    v_cndmask_b32 v106, 0, v24, vcc
    v_cmp_eq_u32 vcc, 3, v25
    s_nop 1
    v_cndmask_b32 v107, 0, v24, vcc
    s_waitcnt lgkmcnt(0)
    s_add_u32 s68, s61, 0x9e3779b9
    v_mov_b32 v35, s68
    s_lshl_b32 s86, s46, 2
    s_add_u32 s86, s86, s48
    s_lshl_b32 s86, s86, 7
    s_add_u32 s86, s86, 655360
    s_lshl_b32 s87, s47, 2
    s_add_u32 s87, s87, s48
    s_lshl_b32 s87, s87, 7
    s_add_u32 s87, s87, 663552
    s_cmp_eq_u32 s48, 3
    s_cselect_b32 s87, 2147483648, s87
    s_cselect_b32 s76, 0xffff, -1
    s_mov_b32 s77, 0
    v_mov_b32 v24, s86
    v_mov_b32 v25, s87
    v_cmp_gt_u32 vcc, 16, v0
    s_nop 1
    v_cndmask_b32 v117, v25, v24, vcc
    v_lshl_add_u32 v117, v23, 2, v117
    v_mov_b32 v116, 2147483648
    v_cmp_gt_u32 vcc, 32, v0
    s_nop 1
    v_cndmask_b32 v117, v116, v117, vcc
    s_lshl2_add_u32 s86, s47, s86
    s_lshl2_add_u32 s87, s46, s87
    v_writelane_b32 v116, s86, 0
    v_writelane_b32 v116, s87, 1
    s_waitcnt vmcnt(12)
    s_barrier
    s_add_u32 m0, s53, 122880
    s_lshl_b32 s70, s64, 7
    s_add_u32 s70, s70, s63
    buffer_load_dwordx4 v2, s[8:11], s70 offen offset:0 lds
    buffer_load_dwordx4 v3, s[8:11], s70 offen offset:1024 lds
    buffer_load_dwordx4 v4, s[8:11], s70 offen offset:2048 lds
    buffer_load_dwordx4 v5, s[8:11], s70 offen offset:3072 lds
    s_mul_i32 s91, s64, 393216
    s_add_u32 s64, s64, 1
    s_and_b32 s64, s64, 15
    s_add_u32 m0, s62, 122880
    s_nop 0
    buffer_load_dwordx4 v6, s[12:15], s91 offen offset:0 lds
    buffer_load_dwordx4 v7, s[12:15], s91 offen offset:1024 lds
    s_add_u32 m0, s62, 131072
    s_nop 0
    buffer_load_dwordx4 v8, s[12:15], s91 offen offset:0 lds
    buffer_load_dwordx4 v9, s[12:15], s91 offen offset:1024 lds
    s_add_u32 m0, s62, 139264
    s_nop 0
    buffer_load_dwordx4 v10, s[12:15], s91 offen offset:0 lds
    buffer_load_dwordx4 v11, s[12:15], s91 offen offset:1024 lds
    s_cmp_lg_u32 s65, 0
    s_cbranch_scc1 L_h0c0
    ds_read_b128 v[40:43], v28 offset:0
    ds_read_b128 v[44:47], v29 offset:1024
    ds_read_b128 v[48:51], v28 offset:2048
    ds_read_b128 v[52:55], v29 offset:3072
    ds_read_b128 v[56:59], v28 offset:4096
    ds_read_b128 v[60:63], v29 offset:5120
    ds_read_b128 v[64:67], v28 offset:6144
    ds_read_b128 v[68:71], v29 offset:7168
L_h0c0:
    s_cmp_lg_u32 s66, 0
    s_cbranch_scc1 L_h0r0
    ds_read_b128 v[72:75], v16
    ds_read_b128 v[76:79], v17
    ds_read_b128 v[80:83], v18
    ds_read_b128 v[84:87], v19
L_h0r0:
    s_waitcnt lgkmcnt(0)
    s_waitcnt vmcnt(12)
    s_barrier
    s_add_u32 m0, s53, 0
    s_lshl_b32 s70, s64, 7
    s_add_u32 s70, s70, s63
    buffer_load_dwordx4 v2, s[8:11], s70 offen offset:0 lds
    buffer_load_dwordx4 v3, s[8:11], s70 offen offset:1024 lds
    buffer_load_dwordx4 v4, s[8:11], s70 offen offset:2048 lds
    buffer_load_dwordx4 v5, s[8:11], s70 offen offset:3072 lds
    s_mul_i32 s91, s64, 393216
    s_add_u32 s64, s64, 1
    s_and_b32 s64, s64, 15
    s_add_u32 m0, s62, 0
    s_nop 0
    buffer_load_dwordx4 v6, s[12:15], s91 offen offset:0 lds
    buffer_load_dwordx4 v7, s[12:15], s91 offen offset:1024 lds
    s_add_u32 m0, s62, 8192
    s_nop 0
    buffer_load_dwordx4 v8, s[12:15], s91 offen offset:0 lds
    buffer_load_dwordx4 v9, s[12:15], s91 offen offset:1024 lds
    s_add_u32 m0, s62, 16384
    s_nop 0
    buffer_load_dwordx4 v10, s[12:15], s91 offen offset:0 lds
    buffer_load_dwordx4 v11, s[12:15], s91 offen offset:1024 lds
    s_cmp_lg_u32 s65, 1
    s_cbranch_scc1 L_h0c1
    ds_read_b128 v[40:43], v28 offset:0
    ds_read_b128 v[44:47], v29 offset:1024
    ds_read_b128 v[48:51], v28 offset:2048
    ds_read_b128 v[52:55], v29 offset:3072
    ds_read_b128 v[56:59], v28 offset:4096
    ds_read_b128 v[60:63], v29 offset:5120
    ds_read_b128 v[64:67], v28 offset:6144
    ds_read_b128 v[68:71], v29 offset:7168
L_h0c1:
    s_cmp_lg_u32 s66, 1
    s_cbranch_scc1 L_h0r1
    ds_read_b128 v[72:75], v16
    ds_read_b128 v[76:79], v17
    ds_read_b128 v[80:83], v18
    ds_read_b128 v[84:87], v19
L_h0r1:
    s_waitcnt lgkmcnt(0)
    s_waitcnt vmcnt(10)
    s_barrier
    s_add_u32 m0, s53, 40960
    s_lshl_b32 s70, s64, 7
    s_add_u32 s70, s70, s63
    buffer_load_dwordx4 v2, s[8:11], s70 offen offset:0 lds
    buffer_load_dwordx4 v3, s[8:11], s70 offen offset:1024 lds
    buffer_load_dwordx4 v4, s[8:11], s70 offen offset:2048 lds
    buffer_load_dwordx4 v5, s[8:11], s70 offen offset:3072 lds
    s_mul_i32 s91, s64, 393216
    s_add_u32 s64, s64, 1
    s_and_b32 s64, s64, 15
    s_add_u32 m0, s62, 40960
    s_nop 0
    buffer_load_dwordx4 v6, s[12:15], s91 offen offset:0 lds
    buffer_load_dwordx4 v7, s[12:15], s91 offen offset:1024 lds
    s_add_u32 m0, s62, 49152
    s_nop 0
    buffer_load_dwordx4 v8, s[12:15], s91 offen offset:0 lds
    buffer_load_dwordx4 v9, s[12:15], s91 offen offset:1024 lds
    s_add_u32 m0, s62, 57344
    s_nop 0
    buffer_load_dwordx4 v10, s[12:15], s91 offen offset:0 lds
    buffer_load_dwordx4 v11, s[12:15], s91 offen offset:1024 lds
    s_cmp_lg_u32 s65, 2
    s_cbranch_scc1 L_h0c2
    ds_read_b128 v[40:43], v28 offset:0
    ds_read_b128 v[44:47], v29 offset:1024
    ds_read_b128 v[48:51], v28 offset:2048
    ds_read_b128 v[52:55], v29 offset:3072
    ds_read_b128 v[56:59], v28 offset:4096
    ds_read_b128 v[60:63], v29 offset:5120
    ds_read_b128 v[64:67], v28 offset:6144
    ds_read_b128 v[68:71], v29 offset:7168
L_h0c2:
    s_cmp_lg_u32 s66, 2
    s_cbranch_scc1 L_h0r2
    ds_read_b128 v[72:75], v16
    ds_read_b128 v[76:79], v17
    ds_read_b128 v[80:83], v18
    ds_read_b128 v[84:87], v19
L_h0r2:
    s_waitcnt lgkmcnt(0)
    s_waitcnt vmcnt(10)
    s_barrier
    s_add_u32 m0, s53, 81920
    s_lshl_b32 s70, s64, 7
    s_add_u32 s70, s70, s63
    buffer_load_dwordx4 v2, s[8:11], s70 offen offset:0 lds
    buffer_load_dwordx4 v3, s[8:11], s70 offen offset:1024 lds
    buffer_load_dwordx4 v4, s[8:11], s70 offen offset:2048 lds
    buffer_load_dwordx4 v5, s[8:11], s70 offen offset:3072 lds
    s_mul_i32 s91, s64, 393216
    s_add_u32 s64, s64, 1
    s_and_b32 s64, s64, 15
    s_add_u32 m0, s62, 81920
    s_nop 0
    buffer_load_dwordx4 v6, s[12:15], s91 offen offset:0 lds
    buffer_load_dwordx4 v7, s[12:15], s91 offen offset:1024 lds
    s_add_u32 m0, s62, 90112
    s_nop 0
    buffer_load_dwordx4 v8, s[12:15], s91 offen offset:0 lds
    buffer_load_dwordx4 v9, s[12:15], s91 offen offset:1024 lds
    s_add_u32 m0, s62, 98304
    s_nop 0
    buffer_load_dwordx4 v10, s[12:15], s91 offen offset:0 lds
    buffer_load_dwordx4 v11, s[12:15], s91 offen offset:1024 lds
    s_lshr_b32 s90, s67, 2
    s_add_u32 s90, s90, 2
    s_and_b32 s90, s90, 3
    s_mul_i32 s90, s90, 1572864
    buffer_load_dword v39, v37, s[12:15], s90 offen
    s_cmp_lg_u32 s65, 3
    s_cbranch_scc1 L_h0c3
    ds_read_b128 v[40:43], v28 offset:0
    ds_read_b128 v[44:47], v29 offset:1024
    ds_read_b128 v[48:51], v28 offset:2048
    ds_read_b128 v[52:55], v29 offset:3072
    ds_read_b128 v[56:59], v28 offset:4096
    ds_read_b128 v[60:63], v29 offset:5120
    ds_read_b128 v[64:67], v28 offset:6144
    ds_read_b128 v[68:71], v29 offset:7168
L_h0c3:
    s_cmp_lg_u32 s66, 3
    s_cbranch_scc1 L_h0r3
    ds_read_b128 v[72:75], v16
    ds_read_b128 v[76:79], v17
    ds_read_b128 v[80:83], v18
    ds_read_b128 v[84:87], v19
L_h0r3:
    s_waitcnt lgkmcnt(0)
    s_waitcnt vmcnt(11)
    s_barrier
    s_add_u32 m0, s53, 122880
    s_lshl_b32 s70, s64, 7
    s_add_u32 s70, s70, s63
    buffer_load_dwordx4 v2, s[8:11], s70 offen offset:0 lds
    buffer_load_dwordx4 v3, s[8:11], s70 offen offset:1024 lds
    buffer_load_dwordx4 v4, s[8:11], s70 offen offset:2048 lds
    buffer_load_dwordx4 v5, s[8:11], s70 offen offset:3072 lds
    s_mul_i32 s91, s64, 393216
    s_add_u32 s64, s64, 1
    s_and_b32 s64, s64, 15
    s_add_u32 m0, s62, 122880
    s_nop 0
    buffer_load_dwordx4 v6, s[12:15], s91 offen offset:0 lds
    buffer_load_dwordx4 v7, s[12:15], s91 offen offset:1024 lds
    s_add_u32 m0, s62, 131072
    s_nop 0
    buffer_load_dwordx4 v8, s[12:15], s91 offen offset:0 lds
    buffer_load_dwordx4 v9, s[12:15], s91 offen offset:1024 lds
    s_add_u32 m0, s62, 139264
    s_nop 0
    buffer_load_dwordx4 v10, s[12:15], s91 offen offset:0 lds
    buffer_load_dwordx4 v11, s[12:15], s91 offen offset:1024 lds
    s_cmp_lg_u32 s65, 4
    s_cbranch_scc1 L_h0c4
    ds_read_b128 v[40:43], v28 offset:0
    ds_read_b128 v[44:47], v29 offset:1024
    ds_read_b128 v[48:51], v28 offset:2048
    ds_read_b128 v[52:55], v29 offset:3072
    ds_read_b128 v[56:59], v28 offset:4096
    ds_read_b128 v[60:63], v29 offset:5120
    ds_read_b128 v[64:67], v28 offset:6144
    ds_read_b128 v[68:71], v29 offset:7168
L_h0c4:
    s_waitcnt lgkmcnt(0)
    v_mov_b32 v88, 0
    v_mov_b32 v89, 0
    v_mov_b32 v90, 0
    v_mov_b32 v91, 0
    v_mov_b32 v92, 0
    v_mov_b32 v93, 0
    v_mov_b32 v94, 0
    v_mov_b32 v95, 0
    v_dot2c_f32_bf16 v88, s95, v72
    v_dot2c_f32_bf16 v89, s95, v73
    v_dot2c_f32_bf16 v90, s95, v74
    v_dot2c_f32_bf16 v91, s95, v75
    v_dot2c_f32_bf16 v92, v72, v72
    v_dot2c_f32_bf16 v93, v73, v73
    v_dot2c_f32_bf16 v94, v74, v74
    v_dot2c_f32_bf16 v95, v75, v75
    v_dot2c_f32_bf16 v88, s95, v76
    v_dot2c_f32_bf16 v89, s95, v77
    v_dot2c_f32_bf16 v90, s95, v78
    v_dot2c_f32_bf16 v91, s95, v79
    v_dot2c_f32_bf16 v92, v76, v76
    v_dot2c_f32_bf16 v93, v77, v77
    v_dot2c_f32_bf16 v94, v78, v78
    v_dot2c_f32_bf16 v95, v79, v79
    v_dot2c_f32_bf16 v88, s95, v80
    v_dot2c_f32_bf16 v89, s95, v81
    v_dot2c_f32_bf16 v90, s95, v82
    v_dot2c_f32_bf16 v91, s95, v83
    v_dot2c_f32_bf16 v92, v80, v80
    v_dot2c_f32_bf16 v93, v81, v81
    v_dot2c_f32_bf16 v94, v82, v82
    v_dot2c_f32_bf16 v95, v83, v83
    v_dot2c_f32_bf16 v88, s95, v84
    v_dot2c_f32_bf16 v89, s95, v85
    v_dot2c_f32_bf16 v90, s95, v86
    v_dot2c_f32_bf16 v91, s95, v87
    v_dot2c_f32_bf16 v92, v84, v84
    v_dot2c_f32_bf16 v93, v85, v85
    v_dot2c_f32_bf16 v94, v86, v86
    v_dot2c_f32_bf16 v95, v87, v87
    s_waitcnt vmcnt(11)
    s_barrier
    s_add_u32 m0, s53, 0
    s_lshl_b32 s70, s64, 7
    s_add_u32 s70, s70, s63
    buffer_load_dwordx4 v2, s[8:11], s70 offen offset:0 lds
    buffer_load_dwordx4 v3, s[8:11], s70 offen offset:1024 lds
    buffer_load_dwordx4 v4, s[8:11], s70 offen offset:2048 lds
    buffer_load_dwordx4 v5, s[8:11], s70 offen offset:3072 lds
    s_mul_i32 s91, s64, 393216
    s_add_u32 s64, s64, 1
    s_and_b32 s64, s64, 15
    s_add_u32 m0, s62, 0
    s_nop 0
    buffer_load_dwordx4 v6, s[12:15], s91 offen offset:0 lds
    buffer_load_dwordx4 v7, s[12:15], s91 offen offset:1024 lds
    s_add_u32 m0, s62, 8192
    s_nop 0
    buffer_load_dwordx4 v8, s[12:15], s91 offen offset:0 lds
    buffer_load_dwordx4 v9, s[12:15], s91 offen offset:1024 lds
    s_add_u32 m0, s62, 16384
    s_nop 0
    buffer_load_dwordx4 v10, s[12:15], s91 offen offset:0 lds
    buffer_load_dwordx4 v11, s[12:15], s91 offen offset:1024 lds
    buffer_load_dword v39, v38, s[20:23], 0 offen
    s_cmp_lg_u32 s65, 5
    s_cbranch_scc1 L_h0c5
    ds_read_b128 v[40:43], v28 offset:0
    ds_read_b128 v[44:47], v29 offset:1024
    ds_read_b128 v[48:51], v28 offset:2048
    ds_read_b128 v[52:55], v29 offset:3072
    ds_read_b128 v[56:59], v28 offset:4096
    ds_read_b128 v[60:63], v29 offset:5120
    ds_read_b128 v[64:67], v28 offset:6144
    ds_read_b128 v[68:71], v29 offset:7168
L_h0c5:
    s_waitcnt lgkmcnt(0)
    v_pk_add_f32 v[88:89], v[88:89], v[90:91]
    v_pk_add_f32 v[92:93], v[92:93], v[94:95]
    v_add_f32 v88, v88, v89
    v_add_f32 v89, v92, v93
    s_nop 0
    v_add_f32_dpp v88, v88, v88 quad_perm:[1,0,3,2] row_mask:0xf bank_mask:0xf
    v_add_f32_dpp v89, v89, v89 quad_perm:[1,0,3,2] row_mask:0xf bank_mask:0xf
    s_nop 0
    v_mov_b32_dpp v90, v88 quad_perm:[2,2,2,2] row_mask:0xf bank_mask:0xf
    v_mov_b32_dpp v91, v89 quad_perm:[2,2,2,2] row_mask:0xf bank_mask:0xf
    buffer_store_dwordx4 v[88:91], v13, s[16:19], 0 offen sc1
    s_lshl_b32 s86, s48, 7
    s_add_u32 s86, s86, 131072
    v_lshl_add_u32 v16, v23, 3, s86
    v_lshrrev_b32 v17, 5, v0
    v_lshl_add_u32 v16, v17, 2, v16
    s_lshl_b32 s86, s48, 8
    s_add_u32 s86, s86, 132608
    v_lshl_add_u32 v17, v23, 4, s86
    v_lshl_add_u32 v17, v22, 2, v17
    s_waitcnt vmcnt(12)
    s_barrier
    s_add_u32 m0, s53, 40960
    s_lshl_b32 s70, s64, 7
    s_add_u32 s70, s70, s63
    buffer_load_dwordx4 v2, s[8:11], s70 offen offset:0 lds
    buffer_load_dwordx4 v3, s[8:11], s70 offen offset:1024 lds
    buffer_load_dwordx4 v4, s[8:11], s70 offen offset:2048 lds
    buffer_load_dwordx4 v5, s[8:11], s70 offen offset:3072 lds
    s_mul_i32 s91, s64, 393216
    s_add_u32 s64, s64, 1
    s_and_b32 s64, s64, 15
    s_add_u32 m0, s62, 40960
    s_nop 0
    buffer_load_dwordx4 v6, s[12:15], s91 offen offset:0 lds
    buffer_load_dwordx4 v7, s[12:15], s91 offen offset:1024 lds
    s_add_u32 m0, s62, 49152
    s_nop 0
    buffer_load_dwordx4 v8, s[12:15], s91 offen offset:0 lds
    buffer_load_dwordx4 v9, s[12:15], s91 offen offset:1024 lds
    s_add_u32 m0, s62, 57344
    s_nop 0
    buffer_load_dwordx4 v10, s[12:15], s91 offen offset:0 lds
    buffer_load_dwordx4 v11, s[12:15], s91 offen offset:1024 lds
    s_lshr_b32 s90, s67, 2
    s_add_u32 s90, s90, 3
    s_and_b32 s90, s90, 3
    s_mul_i32 s90, s90, 1572864
    buffer_load_dword v39, v37, s[12:15], s90 offen
    s_cmp_lg_u32 s65, 6
    s_cbranch_scc1 L_h0c6
    ds_read_b128 v[40:43], v28 offset:0
    ds_read_b128 v[44:47], v29 offset:1024
    ds_read_b128 v[48:51], v28 offset:2048
    ds_read_b128 v[52:55], v29 offset:3072
    ds_read_b128 v[56:59], v28 offset:4096
    ds_read_b128 v[60:63], v29 offset:5120
    ds_read_b128 v[64:67], v28 offset:6144
    ds_read_b128 v[68:71], v29 offset:7168
L_h0c6:
    s_waitcnt lgkmcnt(0)
    s_waitcnt vmcnt(13)
    s_barrier
    s_add_u32 m0, s53, 81920
    s_lshl_b32 s70, s64, 7
    s_add_u32 s70, s70, s63
    buffer_load_dwordx4 v2, s[8:11], s70 offen offset:0 lds
    buffer_load_dwordx4 v3, s[8:11], s70 offen offset:1024 lds
    buffer_load_dwordx4 v4, s[8:11], s70 offen offset:2048 lds
    buffer_load_dwordx4 v5, s[8:11], s70 offen offset:3072 lds
    s_mul_i32 s91, s64, 393216
    s_add_u32 s64, s64, 1
    s_and_b32 s64, s64, 15
    s_add_u32 m0, s62, 81920
    s_nop 0
    buffer_load_dwordx4 v6, s[12:15], s91 offen offset:0 lds
    buffer_load_dwordx4 v7, s[12:15], s91 offen offset:1024 lds
    s_add_u32 m0, s62, 90112
    s_nop 0
    buffer_load_dwordx4 v8, s[12:15], s91 offen offset:0 lds
    buffer_load_dwordx4 v9, s[12:15], s91 offen offset:1024 lds
    s_add_u32 m0, s62, 98304
    s_nop 0
    buffer_load_dwordx4 v10, s[12:15], s91 offen offset:0 lds
    buffer_load_dwordx4 v11, s[12:15], s91 offen offset:1024 lds
    s_add_u32 m0, s53, 122880
    s_lshl_b32 s70, s64, 7
    s_add_u32 s70, s70, s63
    buffer_load_dwordx4 v2, s[8:11], s70 offen offset:0 lds
    buffer_load_dwordx4 v3, s[8:11], s70 offen offset:1024 lds
    s_cmp_lg_u32 s65, 7
    s_cbranch_scc1 L_h0c7
    ds_read_b128 v[40:43], v28 offset:0
    ds_read_b128 v[44:47], v29 offset:1024
    ds_read_b128 v[48:51], v28 offset:2048
    ds_read_b128 v[52:55], v29 offset:3072
    ds_read_b128 v[56:59], v28 offset:4096
    ds_read_b128 v[60:63], v29 offset:5120
    ds_read_b128 v[64:67], v28 offset:6144
    ds_read_b128 v[68:71], v29 offset:7168
L_h0c7:
    s_waitcnt lgkmcnt(0)
    s_waitcnt vmcnt(13)
    s_barrier
    s_add_u32 m0, s53, 122880
    s_nop 0
    buffer_load_dwordx4 v4, s[8:11], s70 offen offset:2048 lds
    buffer_load_dwordx4 v5, s[8:11], s70 offen offset:3072 lds
    s_mul_i32 s91, s64, 393216
    s_add_u32 s64, s64, 1
    s_and_b32 s64, s64, 15
    s_add_u32 m0, s62, 122880
    s_nop 0
    buffer_load_dwordx4 v6, s[12:15], s91 offen offset:0 lds
    buffer_load_dwordx4 v7, s[12:15], s91 offen offset:1024 lds
    s_add_u32 m0, s62, 131072
    s_nop 0
    buffer_load_dwordx4 v8, s[12:15], s91 offen offset:0 lds
    buffer_load_dwordx4 v9, s[12:15], s91 offen offset:1024 lds
    s_add_u32 m0, s62, 139264
    s_nop 0
    buffer_load_dwordx4 v10, s[12:15], s91 offen offset:0 lds
    buffer_load_dwordx4 v11, s[12:15], s91 offen offset:1024 lds
    s_add_u32 m0, s53, 0
    s_lshl_b32 s70, s64, 7
    s_add_u32 s70, s70, s63
    buffer_load_dwordx4 v2, s[8:11], s70 offen offset:0 lds
    buffer_load_dwordx4 v3, s[8:11], s70 offen offset:1024 lds
    v_mfma_f32_16x16x32_bf16 v[108:111], v[104:107], v[40:43], 0
    v_mfma_f32_16x16x32_bf16 v[108:111], v[104:107], v[44:47], v[108:111]
    v_mfma_f32_16x16x32_bf16 v[108:111], v[104:107], v[48:51], v[108:111]
    v_mfma_f32_16x16x32_bf16 v[108:111], v[104:107], v[52:55], v[108:111]
    v_mfma_f32_16x16x32_bf16 v[108:111], v[104:107], v[56:59], v[108:111]
    v_mfma_f32_16x16x32_bf16 v[108:111], v[104:107], v[60:63], v[108:111]
    v_mfma_f32_16x16x32_bf16 v[108:111], v[104:107], v[64:67], v[108:111]
    v_mfma_f32_16x16x32_bf16 v[108:111], v[104:107], v[68:71], v[108:111]
    s_nop 7
    v_add_f32_dpp v108, v108, v108 row_ror:8 row_mask:0xf bank_mask:0xf
    v_add_f32_dpp v109, v109, v109 row_ror:8 row_mask:0xf bank_mask:0xf
    v_add_f32_dpp v110, v110, v110 row_ror:8 row_mask:0xf bank_mask:0xf
    v_add_f32_dpp v111, v111, v111 row_ror:8 row_mask:0xf bank_mask:0xf
    buffer_store_dwordx4 v[108:111], v34, s[16:19], 0 offen sc1
    s_waitcnt vmcnt(13)
    s_barrier
    s_add_u32 m0, s53, 0
    s_nop 0
    buffer_load_dwordx4 v4, s[8:11], s70 offen offset:2048 lds
    buffer_load_dwordx4 v5, s[8:11], s70 offen offset:3072 lds
    s_mul_i32 s91, s64, 393216
    s_add_u32 s64, s64, 1
    s_and_b32 s64, s64, 15
    s_add_u32 m0, s62, 0
    s_nop 0
    buffer_load_dwordx4 v6, s[12:15], s91 offen offset:0 lds
    buffer_load_dwordx4 v7, s[12:15], s91 offen offset:1024 lds
    s_add_u32 m0, s62, 8192
    s_nop 0
    buffer_load_dwordx4 v8, s[12:15], s91 offen offset:0 lds
    buffer_load_dwordx4 v9, s[12:15], s91 offen offset:1024 lds
    s_add_u32 m0, s62, 16384
    s_nop 0
    buffer_load_dwordx4 v10, s[12:15], s91 offen offset:0 lds
    buffer_load_dwordx4 v11, s[12:15], s91 offen offset:1024 lds
    s_add_u32 m0, s53, 40960
    s_lshl_b32 s70, s64, 7
    s_add_u32 s70, s70, s63
    buffer_load_dwordx4 v2, s[8:11], s70 offen offset:0 lds
    buffer_load_dwordx4 v3, s[8:11], s70 offen offset:1024 lds
    buffer_load_dwordx4 v4, s[8:11], s70 offen offset:2048 lds
    buffer_load_dwordx4 v5, s[8:11], s70 offen offset:3072 lds
    s_mul_i32 s91, s64, 393216
    s_add_u32 s64, s64, 1
    s_and_b32 s64, s64, 15
    s_waitcnt vmcnt(12)
    s_barrier
    buffer_atomic_swap v35, v116, s[16:19], 0 offen sc1
    s_add_u32 m0, s62, 40960
    s_nop 0
    buffer_load_dwordx4 v6, s[12:15], s91 offen offset:0 lds
    buffer_load_dwordx4 v7, s[12:15], s91 offen offset:1024 lds
    s_add_u32 m0, s62, 49152
    s_nop 0
    buffer_load_dwordx4 v8, s[12:15], s91 offen offset:0 lds
    buffer_load_dwordx4 v9, s[12:15], s91 offen offset:1024 lds
    s_add_u32 m0, s62, 57344
    s_nop 0
    buffer_load_dwordx4 v10, s[12:15], s91 offen offset:0 lds
    buffer_load_dwordx4 v11, s[12:15], s91 offen offset:1024 lds
    s_add_u32 m0, s53, 81920
    s_lshl_b32 s70, s64, 7
    s_add_u32 s70, s70, s63
    buffer_load_dwordx4 v2, s[8:11], s70 offen offset:0 lds
    buffer_load_dwordx4 v3, s[8:11], s70 offen offset:1024 lds
    buffer_load_dwordx4 v4, s[8:11], s70 offen offset:2048 lds
    buffer_load_dwordx4 v5, s[8:11], s70 offen offset:3072 lds
    s_mul_i32 s91, s64, 393216
    s_add_u32 s64, s64, 1
    s_and_b32 s64, s64, 15
    s_add_u32 m0, s62, 81920
    s_nop 0
    buffer_load_dwordx4 v6, s[12:15], s91 offen offset:0 lds
    buffer_load_dwordx4 v7, s[12:15], s91 offen offset:1024 lds
    s_waitcnt vmcnt(17)
    s_barrier
    s_add_u32 m0, s62, 90112
    s_nop 0
    buffer_load_dwordx4 v8, s[12:15], s91 offen offset:0 lds
    buffer_load_dwordx4 v9, s[12:15], s91 offen offset:1024 lds
    s_add_u32 m0, s62, 98304
    s_nop 0
    buffer_load_dwordx4 v10, s[12:15], s91 offen offset:0 lds
    buffer_load_dwordx4 v11, s[12:15], s91 offen offset:1024 lds
    s_add_u32 m0, s53, 122880
    s_lshl_b32 s70, s64, 7
    s_add_u32 s70, s70, s63
    buffer_load_dwordx4 v2, s[8:11], s70 offen offset:0 lds
    buffer_load_dwordx4 v3, s[8:11], s70 offen offset:1024 lds
    buffer_load_dwordx4 v4, s[8:11], s70 offen offset:2048 lds
    buffer_load_dwordx4 v5, s[8:11], s70 offen offset:3072 lds
    s_mul_i32 s91, s64, 393216
    s_add_u32 s64, s64, 1
    s_and_b32 s64, s64, 15
    s_add_u32 m0, s62, 122880
    s_nop 0
    buffer_load_dwordx4 v6, s[12:15], s91 offen offset:0 lds
    buffer_load_dwordx4 v7, s[12:15], s91 offen offset:1024 lds
    s_add_u32 m0, s62, 131072
    s_nop 0
    buffer_load_dwordx4 v8, s[12:15], s91 offen offset:0 lds
    buffer_load_dwordx4 v9, s[12:15], s91 offen offset:1024 lds
    s_waitcnt vmcnt(18)
    s_barrier
    s_add_u32 m0, s62, 139264
    s_nop 0
    buffer_load_dwordx4 v10, s[12:15], s91 offen offset:0 lds
    buffer_load_dwordx4 v11, s[12:15], s91 offen offset:1024 lds
    s_add_u32 m0, s53, 0
    s_lshl_b32 s70, s64, 7
    s_add_u32 s70, s70, s63
    buffer_load_dwordx4 v2, s[8:11], s70 offen offset:0 lds
    buffer_load_dwordx4 v3, s[8:11], s70 offen offset:1024 lds
    buffer_load_dwordx4 v4, s[8:11], s70 offen offset:2048 lds
    buffer_load_dwordx4 v5, s[8:11], s70 offen offset:3072 lds
    s_mul_i32 s91, s64, 393216
    s_add_u32 s64, s64, 1
    s_and_b32 s64, s64, 15
    s_add_u32 m0, s62, 0
    s_nop 0
    buffer_load_dwordx4 v6, s[12:15], s91 offen offset:0 lds
    buffer_load_dwordx4 v7, s[12:15], s91 offen offset:1024 lds
    s_add_u32 m0, s62, 8192
    s_nop 0
    buffer_load_dwordx4 v8, s[12:15], s91 offen offset:0 lds
    buffer_load_dwordx4 v9, s[12:15], s91 offen offset:1024 lds
    s_add_u32 m0, s62, 16384
    s_nop 0
    buffer_load_dwordx4 v10, s[12:15], s91 offen offset:0 lds
    buffer_load_dwordx4 v11, s[12:15], s91 offen offset:1024 lds
    s_waitcnt vmcnt(20)
    s_barrier
    v_mov_b32 v118, 0
    buffer_atomic_or v118, v117, s[16:19], 0 offen sc0 sc1
    s_add_u32 m0, s89, 40960
    s_mov_b32 s90, 655360
    buffer_load_dwordx4 v12, s[20:23], s90 offen lds
    s_add_u32 m0, s89, 45056
    s_mov_b32 s90, 720896
    buffer_load_dwordx4 v12, s[20:23], s90 offen lds
    s_add_u32 m0, s89, 49152
    s_mov_b32 s90, 786432
    buffer_load_dwordx4 v12, s[20:23], s90 offen lds
    s_add_u32 m0, s89, 53248
    s_mov_b32 s90, 851968
    buffer_load_dwordx4 v12, s[20:23], s90 offen lds
    s_mov_b32 s90, 0
    buffer_load_dwordx4 v[164:167], v30, s[32:35], s90 offen
    s_mov_b32 s90, 7168
    buffer_load_dwordx4 v[168:171], v30, s[32:35], s90 offen
    s_mov_b32 s90, 14336
    buffer_load_dwordx4 v[172:175], v30, s[32:35], s90 offen
    s_mov_b32 s90, 21504
    buffer_load_dwordx4 v[176:179], v30, s[32:35], s90 offen
    s_waitcnt vmcnt(19)
    s_barrier
    s_waitcnt vmcnt(8)
    s_branch L_h0_chk0
L_h0_spin:
    v_mov_b32 v118, 0
    buffer_atomic_or v118, v117, s[16:19], 0 offen sc0 sc1
    s_waitcnt vmcnt(0)
L_h0_chk0:
    v_cmp_ne_u32 vcc, s68, v118
    s_nop 0
    s_and_b64 vcc, vcc, s[76:77]
    s_cbranch_vccz L_ok_1
    s_sub_u32 s56, s56, 1
    s_cbranch_scc0 L_h0_spin
    s_mov_b32 s56, 0
L_ok_1:
    s_mov_b32 s90, 0
    buffer_load_dwordx4 v[40:43], v32, s[16:19], s90 offen sc1
    s_mov_b32 s90, 3072
    buffer_load_dwordx4 v[44:47], v32, s[16:19], s90 offen sc1
    s_mov_b32 s90, 6144
    buffer_load_dwordx4 v[48:51], v32, s[16:19], s90 offen sc1
    s_mov_b32 s90, 9216
    buffer_load_dwordx4 v[52:55], v32, s[16:19], s90 offen sc1
    buffer_load_dwordx4 v[56:59], v33, s[16:19], 0 offen sc1
    buffer_load_dwordx4 v[60:63], v33, s[16:19], s92 offen sc1
    buffer_load_dwordx4 v[64:67], v33, s[16:19], s93 offen sc1
    buffer_load_dwordx4 v[68:71], v33, s[16:19], s94 offen sc1
    s_mov_b32 s90, 28672
    buffer_load_dwordx4 v[180:183], v30, s[32:35], s90 offen
    s_mov_b32 s90, 35840
    buffer_load_dwordx4 v[184:187], v30, s[32:35], s90 offen
    s_mov_b32 s90, 43008
    buffer_load_dwordx4 v[188:191], v30, s[32:35], s90 offen
    s_waitcnt vmcnt(20)
    s_barrier
    v_mov_b32 v24, 135168
    v_lshl_add_u32 v24, v21, 2, v24
    v_mov_b32 v25, 0
    ds_write_b32 v24, v25
    s_add_u32 m0, s89, 57344
    s_mov_b32 s90, 917504
    buffer_load_dwordx4 v12, s[20:23], s90 offen lds
    s_add_u32 m0, s89, 61440
    s_mov_b32 s90, 983040
    buffer_load_dwordx4 v12, s[20:23], s90 offen lds
    s_add_u32 m0, s89, 65536
    s_mov_b32 s90, 1048576
    buffer_load_dwordx4 v12, s[20:23], s90 offen lds
    s_add_u32 m0, s89, 69632
    s_mov_b32 s90, 1114112
    buffer_load_dwordx4 v12, s[20:23], s90 offen lds
    s_add_u32 m0, s89, 73728
    s_mov_b32 s90, 1179648
    buffer_load_dwordx4 v12, s[20:23], s90 offen lds
    s_add_u32 m0, s89, 77824
    s_mov_b32 s90, 1245184
    buffer_load_dwordx4 v12, s[20:23], s90 offen lds
    s_waitcnt vmcnt(9)
    v_add_f32 v40, v40, v44
    v_add_f32 v41, v41, v45
    v_add_f32 v42, v42, v46
    v_add_f32 v43, v43, v47
    v_add_f32 v40, v40, v48
    v_add_f32 v41, v41, v49
    v_add_f32 v42, v42, v50
    v_add_f32 v43, v43, v51
    v_add_f32 v40, v40, v52
    v_add_f32 v41, v41, v53
    v_add_f32 v42, v42, v54
    v_add_f32 v43, v43, v55
    v_add_f32 v56, v56, v60
    v_add_f32 v57, v57, v61
    v_add_f32 v58, v58, v62
    v_add_f32 v59, v59, v63
    v_add_f32 v56, v56, v64
    v_add_f32 v57, v57, v65
    v_add_f32 v58, v58, v66
    v_add_f32 v59, v59, v67
    v_add_f32 v56, v56, v68
    v_add_f32 v57, v57, v69
    v_add_f32 v58, v58, v70
    v_add_f32 v59, v59, v71
    s_nop 0
    v_permlane32_swap_b32 v56, v58
    v_permlane32_swap_b32 v57, v59
    v_permlane32_swap_b32 v40, v42
    v_permlane32_swap_b32 v41, v43
    v_add_f32 v56, v56, v58
    v_add_f32 v57, v57, v59
    v_add_f32 v40, v40, v42
    v_add_f32 v41, v41, v43
    v_mov_b32 v58, v56
    v_mov_b32 v59, v57
    v_permlane16_swap_b32 v40, v41
    v_permlane16_swap_b32 v56, v58
    v_permlane16_swap_b32 v57, v59
    v_add_f32 v40, v40, v41
    v_add_f32 v56, v56, v58
    v_add_f32 v57, v57, v59
    ds_write_b32 v17, v40
    v_mul_f32 v56, 0x3a800000, v56
    v_mul_f32 v57, 0x3a800000, v57
    v_fma_f32 v57, -v56, v56, v57
    v_max_f32 v57, 0, v57
    v_cvt_pk_bf16_f32 v48, v56, v57
    v_lshlrev_b32 v44, 16, v48
    v_and_b32 v48, 0xffff0000, v48
    v_add_f32 v48, 0x3727c5ac, v48
    v_cvt_pk_bf16_f32 v48, v48, v48
    v_lshlrev_b32 v48, 16, v48
    v_sqrt_f32 v48, v48
    s_nop 0
    v_cvt_pk_bf16_f32 v48, v48, v48
    v_lshlrev_b32 v48, 16, v48
    v_rcp_f32 v46, v48
    v_sub_f32 v44, 0, v44
    v_mul_f32 v48, 0x3fb8aa3b, v46
    ds_write_b32 v16, v44
    ds_write_b32 v16, v46 offset:512
    ds_write_b32 v16, v48 offset:1024
    s_waitcnt lgkmcnt(0)
    s_barrier
    s_setprio 0
    s_add_u32 m0, s89, 81920
    s_mov_b32 s90, 1310720
    buffer_load_dwordx4 v12, s[20:23], s90 offen lds
    s_add_u32 m0, s89, 86016
    s_mov_b32 s90, 1376256
    buffer_load_dwordx4 v12, s[20:23], s90 offen lds
    s_add_u32 m0, s89, 90112
    s_mov_b32 s90, 1441792
    buffer_load_dwordx4 v12, s[20:23], s90 offen lds
    s_add_u32 m0, s89, 94208
    s_mov_b32 s90, 1507328
    buffer_load_dwordx4 v12, s[20:23], s90 offen lds
    s_add_u32 m0, s89, 98304
    s_mov_b32 s90, 1572864
    buffer_load_dwordx4 v12, s[20:23], s90 offen lds
    s_add_u32 m0, s89, 102400
    s_mov_b32 s90, 1638400
    buffer_load_dwordx4 v12, s[20:23], s90 offen lds
    s_add_u32 m0, s89, 106496
    s_mov_b32 s90, 1703936
    buffer_load_dwordx4 v12, s[20:23], s90 offen lds
    s_add_u32 m0, s89, 110592
    s_mov_b32 s90, 1769472
    buffer_load_dwordx4 v12, s[20:23], s90 offen lds
    s_add_u32 m0, s89, 114688
    s_mov_b32 s90, 1835008
    buffer_load_dwordx4 v12, s[20:23], s90 offen lds
    s_add_u32 m0, s89, 118784
    s_mov_b32 s90, 1900544
    buffer_load_dwordx4 v12, s[20:23], s90 offen lds
    s_add_u32 m0, s89, 122880
    s_mov_b32 s90, 1966080
    buffer_load_dwordx4 v12, s[20:23], s90 offen lds
    s_add_u32 m0, s89, 126976
    s_mov_b32 s90, 2031616
    buffer_load_dwordx4 v12, s[20:23], s90 offen lds
    s_add_u32 m0, s89, 0
    s_mov_b32 s90, 0
    buffer_load_dwordx4 v12, s[20:23], s90 offen lds
    s_add_u32 m0, s89, 4096
    s_mov_b32 s90, 65536
    buffer_load_dwordx4 v12, s[20:23], s90 offen lds
    s_add_u32 m0, s89, 8192
    s_mov_b32 s90, 131072
    buffer_load_dwordx4 v12, s[20:23], s90 offen lds
    s_add_u32 m0, s89, 12288
    s_mov_b32 s90, 196608
    buffer_load_dwordx4 v12, s[20:23], s90 offen lds
    s_add_u32 m0, s89, 16384
    s_mov_b32 s90, 262144
    buffer_load_dwordx4 v12, s[20:23], s90 offen lds
    s_add_u32 m0, s89, 20480
    s_mov_b32 s90, 327680
    buffer_load_dwordx4 v12, s[20:23], s90 offen lds
    s_add_u32 m0, s89, 24576
    s_mov_b32 s90, 393216
    buffer_load_dwordx4 v12, s[20:23], s90 offen lds
    s_add_u32 m0, s89, 28672
    s_mov_b32 s90, 458752
    buffer_load_dwordx4 v12, s[20:23], s90 offen lds
    s_add_u32 m0, s89, 32768
    s_mov_b32 s90, 524288
    buffer_load_dwordx4 v12, s[20:23], s90 offen lds
    s_add_u32 m0, s89, 36864
    s_mov_b32 s90, 589824
    buffer_load_dwordx4 v12, s[20:23], s90 offen lds
    s_lshl_b32 s86, s47, 2
    s_add_u32 s86, s86, s48
    s_lshl_b32 s87, s86, 7
    s_add_u32 s87, s87, 671744
    v_lshl_add_u32 v6, v0, 2, s87
    v_mov_b32 v4, 2147483648
    v_cmp_gt_u32 vcc, 16, v0
    s_nop 1
    v_cndmask_b32 v6, v4, v6, vcc
    s_lshl_b32 s86, s86, 14
    s_add_u32 s86, s86, 5242880
    v_lshl_add_u32 v2, v0, 4, s86
    s_lshl_b32 s86, s47, 1
    s_add_u32 s86, s86, s50
    s_lshl_b32 s86, s86, 11
    s_lshl_b32 s87, s49, 6
    s_add_u32 s86, s86, s87
    s_add_u32 s86, s86, 6881280
    v_lshl_add_u32 v3, v23, 7, s86
    v_lshl_add_u32 v3, v22, 4, v3
    v_mov_b32 v112, 0
    v_mov_b32 v113, 0
    v_mov_b32 v114, 0
    v_mov_b32 v115, 0
    v_mov_b32 v116, 0
    v_mov_b32 v117, 0
    v_mov_b32 v118, 0
    v_mov_b32 v119, 0
    s_lshr_b32 s62, s3, 2
    s_lshl_b32 s53, s51, 3
    s_lshl_b32 s86, s48, 1
    s_add_u32 s53, s53, s86
    s_add_u32 s53, s53, s62
    v_lshrrev_b32 v36, 4, v0
    v_and_b32 v37, 15, v0
    s_lshl_b32 s87, s53, 15
    s_lshl_b32 s86, s62, 14
    s_add_u32 s86, s86, s87
    s_add_u32 s86, s86, 1048576
    v_lshl_add_u32 v157, v0, 4, s86
    v_xor_b32 v158, 0x8000, v157
    s_lshl_b32 s86, s51, 1
    s_lshr_b32 s87, s48, 1
    s_add_u32 s86, s86, s87
    s_lshl_b32 s86, s86, 1
    s_add_u32 s86, s86, s62
    s_lshl_b32 s86, s86, 1
    s_and_b32 s87, s48, 1
    s_add_u32 s86, s86, s87
    s_lshl_b32 s86, s86, 7
    s_add_u32 s86, s86, 688128
    v_lshl_add_u32 v159, v0, 2, s86
    v_mov_b32 v38, 2147483648
    v_cmp_gt_u32 vcc, 16, v0
    s_nop 1
    v_cndmask_b32 v159, v38, v159, vcc
    v_bfe_u32 v38, v0, 2, 2
    v_lshl_add_u32 v38, v36, 2, v38
    v_bfe_u32 v39, v38, 1, 2
    v_lshlrev_b32 v38, 7, v38
    v_lshl_add_u32 v38, v39, 5, v38
    v_and_b32 v39, 3, v0
    v_lshl_add_u32 v38, v39, 3, v38
    s_lshl_b32 s86, s62, 16
    s_add_u32 s86, s86, 0
    v_add_u32 v144, s86, v38
    v_xor_b32 v145, 32, v144
    v_xor_b32 v146, 64, v144
    v_xor_b32 v147, 96, v144
    v_cmp_eq_u32 s[4:5], 1, v39
    v_cmp_eq_u32 s[6:7], 2, v39
    v_cmp_eq_u32 s[98:99], 3, v39
    s_lshl_b32 s86, s53, 10
    s_add_u32 s86, s86, 786432
    v_lshl_add_u32 v160, v0, 2, s86
    v_mul_u32_u24 v161, 192, v36
    v_add_u32 v160, v160, v161
    s_mov_b32 s72, 0x00f0000f
    s_mov_b32 s73, 0xf0000f00
    s_mov_b32 s74, 0x0f00f000
    s_mov_b32 s75, 0x0f00f000
    v_lshrrev_b32 v38, 2, v37
    v_lshl_add_u32 v161, v38, 4, v37
    v_lshlrev_b32 v161, 2, v161
    s_lshl_b32 s86, s3, 12
    s_add_u32 s86, s86, 131072
    v_lshl_add_u32 v162, v0, 4, s86
    v_xor_b32 v163, 0x4000, v162
    s_lshl_b32 s86, s52, 7
    v_lshl_add_u32 v36, v36, 3, s86
    s_lshl_b32 s87, s53, 15
    s_add_u32 s87, s87, s86
    s_lshl_b32 s86, s62, 6
    s_add_u32 s87, s87, s86
    v_lshl_add_u32 v39, v37, 11, s87
    v_and_b32 v38, 48, v0
    v_add_u32 v39, v39, v38
    v_xor_b32 v37, 0x8000, v39
    v_lshlrev_b32 v38, 4, v0
    buffer_load_dwordx2 v[148:149], v36, s[40:43], 0 offen offset:0
    buffer_load_dwordx2 v[150:151], v36, s[40:43], 0 offen offset:32
    buffer_load_dwordx2 v[152:153], v36, s[40:43], 0 offen offset:64
    buffer_load_dwordx2 v[154:155], v36, s[40:43], 0 offen offset:96
    buffer_load_dwordx4 v[128:131], v38, s[40:43], 0 offen
    buffer_load_dwordx4 v[132:135], v38, s[40:43], 0 offen offset:1024
    buffer_load_dwordx4 v[136:139], v39, s[8:11], 0 offen
    buffer_load_dwordx4 v[140:143], v37, s[8:11], 0 offen
    s_mov_b32 s90, 50176
    buffer_load_dwordx4 v[192:195], v30, s[32:35], s90 offen
    s_mov_b32 s90, 57344
    buffer_load_dwordx4 v[196:199], v30, s[32:35], s90 offen
    s_mov_b32 s90, 64512
    buffer_load_dwordx4 v[200:203], v30, s[32:35], s90 offen
    s_waitcnt vmcnt(5)
    v_mov_b32 v4, 0
    buffer_atomic_or v4, v6, s[16:19], 0 offen sc0 sc1
    v_bfe_u32 v36, v0, 2, 1
    v_cmp_eq_u32 vcc, 1, v36
    v_mov_b32 v36, s95
    v_mov_b32 v38, 0
    v_dot2c_f32_bf16 v38, s95, v128
    v_dot2c_f32_bf16 v38, s95, v129
    v_dot2c_f32_bf16 v38, s95, v130
    v_dot2c_f32_bf16 v38, s95, v131
    v_dot2c_f32_bf16 v38, s95, v132
    v_dot2c_f32_bf16 v38, s95, v133
    v_dot2c_f32_bf16 v38, s95, v134
    v_dot2c_f32_bf16 v38, s95, v135
    v_cndmask_b32 v148, v36, v148, vcc
    v_cndmask_b32 v149, v36, v149, vcc
    v_cndmask_b32 v150, v36, v150, vcc
    v_cndmask_b32 v151, v36, v151, vcc
    v_cndmask_b32 v152, v36, v152, vcc
    v_cndmask_b32 v153, v36, v153, vcc
    v_cndmask_b32 v154, v36, v154, vcc
    v_cndmask_b32 v155, v36, v155, vcc
    v_add_f32_dpp v38, v38, v38 row_ror:8 row_mask:0xf bank_mask:0xf
    s_nop 1
    v_add_f32_dpp v38, v38, v38 row_ror:4 row_mask:0xf bank_mask:0xf
    s_nop 1
    v_add_f32_dpp v38, v38, v38 row_ror:2 row_mask:0xf bank_mask:0xf
    s_nop 1
    v_add_f32_dpp v38, v38, v38 row_ror:1 row_mask:0xf bank_mask:0xf
    v_mov_b32 v36, v38
    s_nop 1
    v_permlane32_swap_b32 v38, v36
    v_add_f32 v38, v38, v36
    v_mov_b32 v36, v38
    s_nop 1
    v_permlane16_swap_b32 v38, v36
    v_add_f32 v38, v38, v36
    v_mov_b32 v36, 135200
    v_readfirstlane_b32 s57, v38
    ds_write_b32 v36, v38
    s_mul_i32 s86, s50, 3072
    s_add_u32 s86, s86, 151552
    v_lshl_add_u32 v7, v0, 4, s86
    s_lshl_b32 s86, s49, 10
    v_add_u32 v5, s86, v7
    s_lshl_b32 s86, s49, 3
    v_add_u32 v7, s86, v7
    s_mov_b32 s88, 0xffff0000
    s_mov_b32 s86, 0x00003f80
    s_mov_b32 s87, 0x3f800000
    s_branch L_h1_w0
L_h1_r0:
    s_ff1_i32_b32 s66, s65
    s_bitset0_b32 s65, s66
    s_lshl_b32 s66, s66, 10
    buffer_load_dwordx4 v[40:43], v2, s[16:19], s66 offen sc1
    s_cmp_eq_u32 s65, 0
    s_cbranch_scc1 L_h1_p1
L_h1_r1:
    s_ff1_i32_b32 s66, s65
    s_bitset0_b32 s65, s66
    s_lshl_b32 s66, s66, 10
    buffer_load_dwordx4 v[44:47], v2, s[16:19], s66 offen sc1
    s_cmp_eq_u32 s65, 0
    s_cbranch_scc1 L_h1_p2
L_h1_r2:
    s_ff1_i32_b32 s66, s65
    s_bitset0_b32 s65, s66
    s_lshl_b32 s66, s66, 10
    buffer_load_dwordx4 v[48:51], v2, s[16:19], s66 offen sc1
    s_cmp_eq_u32 s65, 0
    s_cbranch_scc1 L_h1_p3
L_h1_r3:
    s_ff1_i32_b32 s66, s65
    s_bitset0_b32 s65, s66
    s_lshl_b32 s66, s66, 10
    buffer_load_dwordx4 v[52:55], v2, s[16:19], s66 offen sc1
    s_cmp_eq_u32 s65, 0
    s_cbranch_scc1 L_h1_p4
L_h1_r4:
    s_ff1_i32_b32 s66, s65
    s_bitset0_b32 s65, s66
    s_lshl_b32 s66, s66, 10
    buffer_load_dwordx4 v[56:59], v2, s[16:19], s66 offen sc1
    s_cmp_eq_u32 s65, 0
    s_cbranch_scc1 L_h1_p5
L_h1_r5:
    s_ff1_i32_b32 s66, s65
    s_bitset0_b32 s65, s66
    s_lshl_b32 s66, s66, 10
    buffer_load_dwordx4 v[60:63], v2, s[16:19], s66 offen sc1
    s_cmp_eq_u32 s65, 0
    s_cbranch_scc1 L_h1_p6
L_h1_r6:
    s_ff1_i32_b32 s66, s65
    s_bitset0_b32 s65, s66
    s_lshl_b32 s66, s66, 10
    buffer_load_dwordx4 v[64:67], v2, s[16:19], s66 offen sc1
    s_cmp_eq_u32 s65, 0
    s_cbranch_scc1 L_h1_p7
L_h1_r7:
    s_ff1_i32_b32 s66, s65
    s_bitset0_b32 s65, s66
    s_lshl_b32 s66, s66, 10
    buffer_load_dwordx4 v[68:71], v2, s[16:19], s66 offen sc1
    s_cmp_eq_u32 s65, 0
    s_cbranch_scc1 L_h1_p8
L_h1_r8:
    s_ff1_i32_b32 s66, s65
    s_bitset0_b32 s65, s66
    s_lshl_b32 s66, s66, 10
    buffer_load_dwordx4 v[72:75], v2, s[16:19], s66 offen sc1
    s_cmp_eq_u32 s65, 0
    s_cbranch_scc1 L_h1_p9
L_h1_r9:
    s_ff1_i32_b32 s66, s65
    s_bitset0_b32 s65, s66
    s_lshl_b32 s66, s66, 10
    buffer_load_dwordx4 v[76:79], v2, s[16:19], s66 offen sc1
    s_cmp_eq_u32 s65, 0
    s_cbranch_scc1 L_h1_p10
L_h1_r10:
    s_ff1_i32_b32 s66, s65
    s_bitset0_b32 s65, s66
    s_lshl_b32 s66, s66, 10
    buffer_load_dwordx4 v[80:83], v2, s[16:19], s66 offen sc1
    s_cmp_eq_u32 s65, 0
    s_cbranch_scc1 L_h1_p11
L_h1_r11:
    s_ff1_i32_b32 s66, s65
    s_bitset0_b32 s65, s66
    s_lshl_b32 s66, s66, 10
    buffer_load_dwordx4 v[84:87], v2, s[16:19], s66 offen sc1
    s_cmp_eq_u32 s65, 0
    s_cbranch_scc1 L_h1_p12
L_h1_r12:
    s_ff1_i32_b32 s66, s65
    s_bitset0_b32 s65, s66
    s_lshl_b32 s66, s66, 10
    buffer_load_dwordx4 v[88:91], v2, s[16:19], s66 offen sc1
    s_cmp_eq_u32 s65, 0
    s_cbranch_scc1 L_h1_p13
L_h1_r13:
    s_ff1_i32_b32 s66, s65
    s_bitset0_b32 s65, s66
    s_lshl_b32 s66, s66, 10
    buffer_load_dwordx4 v[92:95], v2, s[16:19], s66 offen sc1
    s_cmp_eq_u32 s65, 0
    s_cbranch_scc1 L_h1_p14
L_h1_r14:
    s_ff1_i32_b32 s66, s65
    s_bitset0_b32 s65, s66
    s_lshl_b32 s66, s66, 10
    buffer_load_dwordx4 v[96:99], v2, s[16:19], s66 offen sc1
    s_cmp_eq_u32 s65, 0
    s_cbranch_scc1 L_h1_p15
L_h1_r15:
    s_ff1_i32_b32 s66, s65
    s_bitset0_b32 s65, s66
    s_lshl_b32 s66, s66, 10
    buffer_load_dwordx4 v[100:103], v2, s[16:19], s66 offen sc1
    buffer_load_dwordx4 v[104:107], v3, s[16:19], 0 offen sc1
L_h1_acc:
    s_waitcnt vmcnt(16)
    v_dot2c_f32_bf16 v112, s86, v40
    v_dot2c_f32_bf16 v113, s87, v40
    v_dot2c_f32_bf16 v114, s86, v41
    v_dot2c_f32_bf16 v115, s87, v41
    v_dot2c_f32_bf16 v116, s86, v42
    v_dot2c_f32_bf16 v117, s87, v42
    v_dot2c_f32_bf16 v118, s86, v43
    v_dot2c_f32_bf16 v119, s87, v43
    s_waitcnt vmcnt(15)
    v_dot2c_f32_bf16 v112, s86, v44
    v_dot2c_f32_bf16 v113, s87, v44
    v_dot2c_f32_bf16 v114, s86, v45
    v_dot2c_f32_bf16 v115, s87, v45
    v_dot2c_f32_bf16 v116, s86, v46
    v_dot2c_f32_bf16 v117, s87, v46
    v_dot2c_f32_bf16 v118, s86, v47
    v_dot2c_f32_bf16 v119, s87, v47
    s_waitcnt vmcnt(14)
    v_dot2c_f32_bf16 v112, s86, v48
    v_dot2c_f32_bf16 v113, s87, v48
    v_dot2c_f32_bf16 v114, s86, v49
    v_dot2c_f32_bf16 v115, s87, v49
    v_dot2c_f32_bf16 v116, s86, v50
    v_dot2c_f32_bf16 v117, s87, v50
    v_dot2c_f32_bf16 v118, s86, v51
    v_dot2c_f32_bf16 v119, s87, v51
    v_max3_u32 v4, v43, v47, v51
    s_waitcnt vmcnt(13)
    v_dot2c_f32_bf16 v112, s86, v52
    v_dot2c_f32_bf16 v113, s87, v52
    v_dot2c_f32_bf16 v114, s86, v53
    v_dot2c_f32_bf16 v115, s87, v53
    v_dot2c_f32_bf16 v116, s86, v54
    v_dot2c_f32_bf16 v117, s87, v54
    v_dot2c_f32_bf16 v118, s86, v55
    v_dot2c_f32_bf16 v119, s87, v55
    s_waitcnt vmcnt(12)
    v_dot2c_f32_bf16 v112, s86, v56
    v_dot2c_f32_bf16 v113, s87, v56
    v_dot2c_f32_bf16 v114, s86, v57
    v_dot2c_f32_bf16 v115, s87, v57
    v_dot2c_f32_bf16 v116, s86, v58
    v_dot2c_f32_bf16 v117, s87, v58
    v_dot2c_f32_bf16 v118, s86, v59
    v_dot2c_f32_bf16 v119, s87, v59
    v_max3_u32 v4, v4, v55, v59
    s_waitcnt vmcnt(11)
    v_dot2c_f32_bf16 v112, s86, v60
    v_dot2c_f32_bf16 v113, s87, v60
    v_dot2c_f32_bf16 v114, s86, v61
    v_dot2c_f32_bf16 v115, s87, v61
    v_dot2c_f32_bf16 v116, s86, v62
    v_dot2c_f32_bf16 v117, s87, v62
    v_dot2c_f32_bf16 v118, s86, v63
    v_dot2c_f32_bf16 v119, s87, v63
    s_waitcnt vmcnt(10)
    v_dot2c_f32_bf16 v112, s86, v64
    v_dot2c_f32_bf16 v113, s87, v64
    v_dot2c_f32_bf16 v114, s86, v65
    v_dot2c_f32_bf16 v115, s87, v65
    v_dot2c_f32_bf16 v116, s86, v66
    v_dot2c_f32_bf16 v117, s87, v66
    v_dot2c_f32_bf16 v118, s86, v67
    v_dot2c_f32_bf16 v119, s87, v67
    v_max3_u32 v4, v4, v63, v67
    s_waitcnt vmcnt(9)
    v_dot2c_f32_bf16 v112, s86, v68
    v_dot2c_f32_bf16 v113, s87, v68
    v_dot2c_f32_bf16 v114, s86, v69
    v_dot2c_f32_bf16 v115, s87, v69
    v_dot2c_f32_bf16 v116, s86, v70
    v_dot2c_f32_bf16 v117, s87, v70
    v_dot2c_f32_bf16 v118, s86, v71
    v_dot2c_f32_bf16 v119, s87, v71
    s_waitcnt vmcnt(8)
    v_dot2c_f32_bf16 v112, s86, v72
    v_dot2c_f32_bf16 v113, s87, v72
    v_dot2c_f32_bf16 v114, s86, v73
    v_dot2c_f32_bf16 v115, s87, v73
    v_dot2c_f32_bf16 v116, s86, v74
    v_dot2c_f32_bf16 v117, s87, v74
    v_dot2c_f32_bf16 v118, s86, v75
    v_dot2c_f32_bf16 v119, s87, v75
    v_max3_u32 v4, v4, v71, v75
    s_waitcnt vmcnt(7)
    v_dot2c_f32_bf16 v112, s86, v76
    v_dot2c_f32_bf16 v113, s87, v76
    v_dot2c_f32_bf16 v114, s86, v77
    v_dot2c_f32_bf16 v115, s87, v77
    v_dot2c_f32_bf16 v116, s86, v78
    v_dot2c_f32_bf16 v117, s87, v78
    v_dot2c_f32_bf16 v118, s86, v79
    v_dot2c_f32_bf16 v119, s87, v79
    s_waitcnt vmcnt(6)
    v_dot2c_f32_bf16 v112, s86, v80
    v_dot2c_f32_bf16 v113, s87, v80
    v_dot2c_f32_bf16 v114, s86, v81
    v_dot2c_f32_bf16 v115, s87, v81
    v_dot2c_f32_bf16 v116, s86, v82
    v_dot2c_f32_bf16 v117, s87, v82
    v_dot2c_f32_bf16 v118, s86, v83
    v_dot2c_f32_bf16 v119, s87, v83
    v_max3_u32 v4, v4, v79, v83
    s_waitcnt vmcnt(5)
    v_dot2c_f32_bf16 v112, s86, v84
    v_dot2c_f32_bf16 v113, s87, v84
    v_dot2c_f32_bf16 v114, s86, v85
    v_dot2c_f32_bf16 v115, s87, v85
    v_dot2c_f32_bf16 v116, s86, v86
    v_dot2c_f32_bf16 v117, s87, v86
    v_dot2c_f32_bf16 v118, s86, v87
    v_dot2c_f32_bf16 v119, s87, v87
    s_waitcnt vmcnt(4)
    v_dot2c_f32_bf16 v112, s86, v88
    v_dot2c_f32_bf16 v113, s87, v88
    v_dot2c_f32_bf16 v114, s86, v89
    v_dot2c_f32_bf16 v115, s87, v89
    v_dot2c_f32_bf16 v116, s86, v90
    v_dot2c_f32_bf16 v117, s87, v90
    v_dot2c_f32_bf16 v118, s86, v91
    v_dot2c_f32_bf16 v119, s87, v91
    v_max3_u32 v4, v4, v87, v91
    s_waitcnt vmcnt(3)
    v_dot2c_f32_bf16 v112, s86, v92
    v_dot2c_f32_bf16 v113, s87, v92
    v_dot2c_f32_bf16 v114, s86, v93
    v_dot2c_f32_bf16 v115, s87, v93
    v_dot2c_f32_bf16 v116, s86, v94
    v_dot2c_f32_bf16 v117, s87, v94
    v_dot2c_f32_bf16 v118, s86, v95
    v_dot2c_f32_bf16 v119, s87, v95
    s_waitcnt vmcnt(2)
    v_dot2c_f32_bf16 v112, s86, v96
    v_dot2c_f32_bf16 v113, s87, v96
    v_dot2c_f32_bf16 v114, s86, v97
    v_dot2c_f32_bf16 v115, s87, v97
    v_dot2c_f32_bf16 v116, s86, v98
    v_dot2c_f32_bf16 v117, s87, v98
    v_dot2c_f32_bf16 v118, s86, v99
    v_dot2c_f32_bf16 v119, s87, v99
    v_max3_u32 v4, v4, v95, v99
    s_waitcnt vmcnt(1)
    v_dot2c_f32_bf16 v112, s86, v100
    v_dot2c_f32_bf16 v113, s87, v100
    v_dot2c_f32_bf16 v114, s86, v101
    v_dot2c_f32_bf16 v115, s87, v101
    v_dot2c_f32_bf16 v116, s86, v102
    v_dot2c_f32_bf16 v117, s87, v102
    v_dot2c_f32_bf16 v118, s86, v103
    v_dot2c_f32_bf16 v119, s87, v103
    s_waitcnt vmcnt(0)
    v_max3_u32 v4, v4, v103, v107
    v_add_f32_dpp v104, v104, v104 row_ror:8 row_mask:0xf bank_mask:0xf
    v_add_f32_dpp v105, v105, v105 row_ror:8 row_mask:0xf bank_mask:0xf
    v_add_f32_dpp v106, v106, v106 row_ror:8 row_mask:0xf bank_mask:0xf
    v_add_f32_dpp v107, v107, v107 row_ror:8 row_mask:0xf bank_mask:0xf
    v_cvt_pk_bf16_f32 v120, v112, v113
    v_cvt_pk_bf16_f32 v121, v114, v115
    v_cvt_pk_bf16_f32 v122, v116, v117
    v_cvt_pk_bf16_f32 v123, v118, v119
    ds_write_b128 v5, v[120:123]
    v_add_f32_dpp v104, v104, v104 row_ror:4 row_mask:0xf bank_mask:0xf
    v_add_f32_dpp v105, v105, v105 row_ror:4 row_mask:0xf bank_mask:0xf
    v_add_f32_dpp v106, v106, v106 row_ror:4 row_mask:0xf bank_mask:0xf
    v_add_f32_dpp v107, v107, v107 row_ror:4 row_mask:0xf bank_mask:0xf
    v_add_f32_dpp v104, v104, v104 row_ror:2 row_mask:0xf bank_mask:0xf
    v_add_f32_dpp v105, v105, v105 row_ror:2 row_mask:0xf bank_mask:0xf
    v_add_f32_dpp v106, v106, v106 row_ror:2 row_mask:0xf bank_mask:0xf
    v_add_f32_dpp v107, v107, v107 row_ror:2 row_mask:0xf bank_mask:0xf
    v_add_f32_dpp v104, v104, v104 row_ror:1 row_mask:0xf bank_mask:0xf
    v_add_f32_dpp v105, v105, v105 row_ror:1 row_mask:0xf bank_mask:0xf
    v_add_f32_dpp v106, v106, v106 row_ror:1 row_mask:0xf bank_mask:0xf
    v_add_f32_dpp v107, v107, v107 row_ror:1 row_mask:0xf bank_mask:0xf
    v_cmp_eq_u32 vcc, -1, v4
    v_cvt_pk_bf16_f32 v124, v104, v105
    v_cvt_pk_bf16_f32 v125, v106, v107
    ds_write_b64 v7, v[124:125] offset:2048
    s_cbranch_vccnz L_h1_again
L_h1_done:
    s_waitcnt lgkmcnt(0)
    s_barrier
    s_or_b32 s86, s2, s48
    s_cmp_eq_u32 s86, 0
    s_cselect_b32 s86, 0, 2147483648
    s_add_u32 s86, s86, 524288
    v_mov_b32 v6, s86
    buffer_store_dword v35, v6, s[16:19], 0 offen sc1
    v_mov_b32 v11, v30
    v_mov_b32 v14, v31
    v_mov_b32 v8, 0
    buffer_atomic_or v8, v159, s[16:19], 0 offen sc0 sc1
    s_branch L_phaseB
L_h1_p0:
    v_mov_b32 v4, 0
    buffer_atomic_or v4, v6, s[16:19], 0 offen sc0 sc1
L_h1_w0:
    s_waitcnt vmcnt(0)
    v_cmp_eq_u32 vcc, s68, v4
    s_nop 0
    s_andn2_b32 s65, vcc_lo, s88
    s_or_b32 s88, s88, s65
    s_cmp_lg_u32 s65, 0
    s_cbranch_scc1 L_h1_r0
    s_sub_u32 s56, s56, 1
    s_cbranch_scc0 L_h1_p0
    s_mov_b32 s56, 0
    s_not_b32 s65, s88
    s_branch L_h1_r0
L_h1_p1:
    v_mov_b32 v4, 0
    buffer_atomic_or v4, v6, s[16:19], 0 offen sc0 sc1
    s_waitcnt vmcnt(0)
    v_cmp_eq_u32 vcc, s68, v4
    s_nop 0
    s_andn2_b32 s65, vcc_lo, s88
    s_or_b32 s88, s88, s65
    s_cmp_lg_u32 s65, 0
    s_cbranch_scc1 L_h1_r1
    s_sub_u32 s56, s56, 1
    s_cbranch_scc0 L_h1_p1
    s_mov_b32 s56, 0
    s_not_b32 s65, s88
    s_branch L_h1_r1
L_h1_p2:
    v_mov_b32 v4, 0
    buffer_atomic_or v4, v6, s[16:19], 0 offen sc0 sc1
    s_waitcnt vmcnt(0)
    v_cmp_eq_u32 vcc, s68, v4
    s_nop 0
    s_andn2_b32 s65, vcc_lo, s88
    s_or_b32 s88, s88, s65
    s_cmp_lg_u32 s65, 0
    s_cbranch_scc1 L_h1_r2
    s_sub_u32 s56, s56, 1
    s_cbranch_scc0 L_h1_p2
    s_mov_b32 s56, 0
    s_not_b32 s65, s88
    s_branch L_h1_r2
L_h1_p3:
    v_mov_b32 v4, 0
    buffer_atomic_or v4, v6, s[16:19], 0 offen sc0 sc1
    s_waitcnt vmcnt(0)
    v_cmp_eq_u32 vcc, s68, v4
    s_nop 0
    s_andn2_b32 s65, vcc_lo, s88
    s_or_b32 s88, s88, s65
    s_cmp_lg_u32 s65, 0
    s_cbranch_scc1 L_h1_r3
    s_sub_u32 s56, s56, 1
    s_cbranch_scc0 L_h1_p3
    s_mov_b32 s56, 0
    s_not_b32 s65, s88
    s_branch L_h1_r3
L_h1_p4:
    v_mov_b32 v4, 0
    buffer_atomic_or v4, v6, s[16:19], 0 offen sc0 sc1
    s_waitcnt vmcnt(0)
    v_cmp_eq_u32 vcc, s68, v4
    s_nop 0
    s_andn2_b32 s65, vcc_lo, s88
    s_or_b32 s88, s88, s65
    s_cmp_lg_u32 s65, 0
    s_cbranch_scc1 L_h1_r4
    s_sub_u32 s56, s56, 1
    s_cbranch_scc0 L_h1_p4
    s_mov_b32 s56, 0
    s_not_b32 s65, s88
    s_branch L_h1_r4
L_h1_p5:
    v_mov_b32 v4, 0
    buffer_atomic_or v4, v6, s[16:19], 0 offen sc0 sc1
    s_waitcnt vmcnt(0)
    v_cmp_eq_u32 vcc, s68, v4
    s_nop 0
    s_andn2_b32 s65, vcc_lo, s88
    s_or_b32 s88, s88, s65
    s_cmp_lg_u32 s65, 0
    s_cbranch_scc1 L_h1_r5
    s_sub_u32 s56, s56, 1
    s_cbranch_scc0 L_h1_p5
    s_mov_b32 s56, 0
    s_not_b32 s65, s88
    s_branch L_h1_r5
L_h1_p6:
    v_mov_b32 v4, 0
    buffer_atomic_or v4, v6, s[16:19], 0 offen sc0 sc1
    s_waitcnt vmcnt(0)
    v_cmp_eq_u32 vcc, s68, v4
    s_nop 0
    s_andn2_b32 s65, vcc_lo, s88
    s_or_b32 s88, s88, s65
    s_cmp_lg_u32 s65, 0
    s_cbranch_scc1 L_h1_r6
    s_sub_u32 s56, s56, 1
    s_cbranch_scc0 L_h1_p6
    s_mov_b32 s56, 0
    s_not_b32 s65, s88
    s_branch L_h1_r6
L_h1_p7:
    v_mov_b32 v4, 0
    buffer_atomic_or v4, v6, s[16:19], 0 offen sc0 sc1
    s_waitcnt vmcnt(0)
    v_cmp_eq_u32 vcc, s68, v4
    s_nop 0
    s_andn2_b32 s65, vcc_lo, s88
    s_or_b32 s88, s88, s65
    s_cmp_lg_u32 s65, 0
    s_cbranch_scc1 L_h1_r7
    s_sub_u32 s56, s56, 1
    s_cbranch_scc0 L_h1_p7
    s_mov_b32 s56, 0
    s_not_b32 s65, s88
    s_branch L_h1_r7
L_h1_p8:
    v_mov_b32 v4, 0
    buffer_atomic_or v4, v6, s[16:19], 0 offen sc0 sc1
    s_waitcnt vmcnt(0)
    v_cmp_eq_u32 vcc, s68, v4
    s_nop 0
    s_andn2_b32 s65, vcc_lo, s88
    s_or_b32 s88, s88, s65
    s_cmp_lg_u32 s65, 0
    s_cbranch_scc1 L_h1_r8
    s_sub_u32 s56, s56, 1
    s_cbranch_scc0 L_h1_p8
    s_mov_b32 s56, 0
    s_not_b32 s65, s88
    s_branch L_h1_r8
L_h1_p9:
    v_mov_b32 v4, 0
    buffer_atomic_or v4, v6, s[16:19], 0 offen sc0 sc1
    s_waitcnt vmcnt(0)
    v_cmp_eq_u32 vcc, s68, v4
    s_nop 0
    s_andn2_b32 s65, vcc_lo, s88
    s_or_b32 s88, s88, s65
    s_cmp_lg_u32 s65, 0
    s_cbranch_scc1 L_h1_r9
    s_sub_u32 s56, s56, 1
    s_cbranch_scc0 L_h1_p9
    s_mov_b32 s56, 0
    s_not_b32 s65, s88
    s_branch L_h1_r9
L_h1_p10:
    v_mov_b32 v4, 0
    buffer_atomic_or v4, v6, s[16:19], 0 offen sc0 sc1
    s_waitcnt vmcnt(0)
    v_cmp_eq_u32 vcc, s68, v4
    s_nop 0
    s_andn2_b32 s65, vcc_lo, s88
    s_or_b32 s88, s88, s65
    s_cmp_lg_u32 s65, 0
    s_cbranch_scc1 L_h1_r10
    s_sub_u32 s56, s56, 1
    s_cbranch_scc0 L_h1_p10
    s_mov_b32 s56, 0
    s_not_b32 s65, s88
    s_branch L_h1_r10
L_h1_p11:
    v_mov_b32 v4, 0
    buffer_atomic_or v4, v6, s[16:19], 0 offen sc0 sc1
    s_waitcnt vmcnt(0)
    v_cmp_eq_u32 vcc, s68, v4
    s_nop 0
    s_andn2_b32 s65, vcc_lo, s88
    s_or_b32 s88, s88, s65
    s_cmp_lg_u32 s65, 0
    s_cbranch_scc1 L_h1_r11
    s_sub_u32 s56, s56, 1
    s_cbranch_scc0 L_h1_p11
    s_mov_b32 s56, 0
    s_not_b32 s65, s88
    s_branch L_h1_r11
L_h1_p12:
    v_mov_b32 v4, 0
    buffer_atomic_or v4, v6, s[16:19], 0 offen sc0 sc1
    s_waitcnt vmcnt(0)
    v_cmp_eq_u32 vcc, s68, v4
    s_nop 0
    s_andn2_b32 s65, vcc_lo, s88
    s_or_b32 s88, s88, s65
    s_cmp_lg_u32 s65, 0
    s_cbranch_scc1 L_h1_r12
    s_sub_u32 s56, s56, 1
    s_cbranch_scc0 L_h1_p12
    s_mov_b32 s56, 0
    s_not_b32 s65, s88
    s_branch L_h1_r12
L_h1_p13:
    v_mov_b32 v4, 0
    buffer_atomic_or v4, v6, s[16:19], 0 offen sc0 sc1
    s_waitcnt vmcnt(0)
    v_cmp_eq_u32 vcc, s68, v4
    s_nop 0
    s_andn2_b32 s65, vcc_lo, s88
    s_or_b32 s88, s88, s65
    s_cmp_lg_u32 s65, 0
    s_cbranch_scc1 L_h1_r13
    s_sub_u32 s56, s56, 1
    s_cbranch_scc0 L_h1_p13
    s_mov_b32 s56, 0
    s_not_b32 s65, s88
    s_branch L_h1_r13
L_h1_p14:
    v_mov_b32 v4, 0
    buffer_atomic_or v4, v6, s[16:19], 0 offen sc0 sc1
    s_waitcnt vmcnt(0)
    v_cmp_eq_u32 vcc, s68, v4
    s_nop 0
    s_andn2_b32 s65, vcc_lo, s88
    s_or_b32 s88, s88, s65
    s_cmp_lg_u32 s65, 0
    s_cbranch_scc1 L_h1_r14
    s_sub_u32 s56, s56, 1
    s_cbranch_scc0 L_h1_p14
    s_mov_b32 s56, 0
    s_not_b32 s65, s88
    s_branch L_h1_r14
L_h1_p15:
    v_mov_b32 v4, 0
    buffer_atomic_or v4, v6, s[16:19], 0 offen sc0 sc1
    s_waitcnt vmcnt(0)
    v_cmp_eq_u32 vcc, s68, v4
    s_nop 0
    s_andn2_b32 s65, vcc_lo, s88
    s_or_b32 s88, s88, s65
    s_cmp_lg_u32 s65, 0
    s_cbranch_scc1 L_h1_r15
    s_sub_u32 s56, s56, 1
    s_cbranch_scc0 L_h1_p15
    s_mov_b32 s56, 0
    s_not_b32 s65, s88
    s_branch L_h1_r15
L_h1_again:
    s_sub_u32 s56, s56, 1
    s_cbranch_scc0 L_h1_re
    s_mov_b32 s56, 0
    s_branch L_h1_done
L_h1_re:
    buffer_load_dwordx4 v[40:43], v2, s[16:19], 0 offen offset:0 sc1
    buffer_load_dwordx4 v[44:47], v2, s[16:19], 0 offen offset:1024 sc1
    buffer_load_dwordx4 v[48:51], v2, s[16:19], 0 offen offset:2048 sc1
    buffer_load_dwordx4 v[52:55], v2, s[16:19], 0 offen offset:3072 sc1
    buffer_load_dwordx4 v[56:59], v2, s[16:19], s92 offen offset:0 sc1
    buffer_load_dwordx4 v[60:63], v2, s[16:19], s92 offen offset:1024 sc1
    buffer_load_dwordx4 v[64:67], v2, s[16:19], s92 offen offset:2048 sc1
    buffer_load_dwordx4 v[68:71], v2, s[16:19], s92 offen offset:3072 sc1
    buffer_load_dwordx4 v[72:75], v2, s[16:19], s93 offen offset:0 sc1
    buffer_load_dwordx4 v[76:79], v2, s[16:19], s93 offen offset:1024 sc1
    buffer_load_dwordx4 v[80:83], v2, s[16:19], s93 offen offset:2048 sc1
    buffer_load_dwordx4 v[84:87], v2, s[16:19], s93 offen offset:3072 sc1
    buffer_load_dwordx4 v[88:91], v2, s[16:19], s94 offen offset:0 sc1
    buffer_load_dwordx4 v[92:95], v2, s[16:19], s94 offen offset:1024 sc1
    buffer_load_dwordx4 v[96:99], v2, s[16:19], s94 offen offset:2048 sc1
    buffer_load_dwordx4 v[100:103], v2, s[16:19], s94 offen offset:3072 sc1
    buffer_load_dwordx4 v[104:107], v3, s[16:19], 0 offen sc1
    v_mov_b32 v112, 0
    v_mov_b32 v113, 0
    v_mov_b32 v114, 0
    v_mov_b32 v115, 0
    v_mov_b32 v116, 0
    v_mov_b32 v117, 0
    v_mov_b32 v118, 0
    v_mov_b32 v119, 0
    s_branch L_h1_acc
L_comp:
    v_and_b32 v20, 15, v0
    v_lshrrev_b32 v21, 4, v0
    v_bfe_u32 v22, v0, 1, 3
    s_lshl_b32 s86, s49, 13
    v_lshl_add_u32 v20, v20, 7, s86
    v_or_b32 v23, 0, v21
    v_xor_b32 v23, v23, v22
    v_lshl_add_u32 v2, v23, 4, v20
    v_or_b32 v23, 4, v21
    v_xor_b32 v23, v23, v22
    v_lshl_add_u32 v3, v23, 4, v20
    v_bfe_u32 v22, v0, 2, 2
    v_lshl_add_u32 v22, v21, 3, v22
    v_lshlrev_b32 v22, 7, v22
    v_bfe_u32 v23, v0, 3, 2
    s_lshl_b32 s86, s50, 1
    v_xor_b32 v23, s86, v23
    v_lshl_add_u32 v22, v23, 5, v22
    v_and_b32 v23, 3, v0
    v_lshl_add_u32 v22, v23, 3, v22
    v_add_u32 v4, 16384, v22
    v_xor_b32 v5, 32, v4
    s_lshl_b32 s53, s2, 2
    s_add_u32 s53, s53, s3
    s_lshl_b32 s86, s53, 12
    s_add_u32 s86, s86, 1048576
    v_lshl_add_u32 v6, v0, 4, s86
    s_mul_i32 s53, s53, 560
    s_add_u32 s53, s53, 6291456
    v_lshl_add_u32 v17, v0, 4, s53
    v_mov_b32 v16, 2147483648
    v_cmp_gt_u32 vcc, 35, v0
    s_nop 1
    v_cndmask_b32 v17, v16, v17, vcc
    s_lshl_b32 s86, s47, 1
    s_add_u32 s86, s86, s50
    s_lshl_b32 s87, s86, 4
    s_add_u32 s87, s87, s46
    s_lshl_b32 s87, s87, 1
    s_add_u32 s87, s87, s49
    s_lshl_b32 s87, s87, 6
    s_add_u32 s87, s87, 6880320
    v_lshl_add_u32 v16, v0, 4, s87
    v_cmp_le_u32 vcc, 60, v0
    s_nop 1
    v_cndmask_b32 v17, v17, v16, vcc
    s_lshl_b32 s87, s86, 1
    s_add_u32 s87, s87, s49
    s_lshl_b32 s87, s87, 4
    s_add_u32 s87, s87, s46
    s_lshl_b32 s87, s87, 10
    s_add_u32 s87, s87, 5242880
    v_lshl_add_u32 v16, v0, 4, s87
    v_mov_b32 v8, -1
    v_mov_b32 v9, -1
    v_mov_b32 v10, -1
    v_mov_b32 v11, -1
    s_waitcnt lgkmcnt(0)
    s_load_dword s61, s[84:85], 524288
    s_mov_b32 s16, s84
    s_and_b32 s17, s85, 0xffff
    s_mov_b32 s18, 268435456
    s_mov_b32 s19, 0x20000
    s_mov_b32 s8, s64
    s_and_b32 s9, s65, 0xffff
    s_mov_b32 s10, 4194304
    s_mov_b32 s11, 0x20000
    s_mov_b32 s20, s68
    s_and_b32 s21, s69, 0xffff
    s_mov_b32 s22, 2097152
    s_mov_b32 s23, 0x20000
    s_mov_b32 s24, s80
    s_and_b32 s25, s81, 0xffff
    s_mov_b32 s26, 4194304
    s_mov_b32 s27, 0x20000
    s_mov_b32 s28, s82
    s_and_b32 s29, s83, 0xffff
    s_mov_b32 s30, 256
    s_mov_b32 s31, 0x20000
    s_bitcmp1_b32 s2, 0
    s_cselect_b32 s32, s76, s74
    s_cselect_b32 s33, s77, s75
    s_and_b32 s33, s33, 0xffff
    s_mov_b32 s34, 7340032
    s_mov_b32 s35, 0x20000
    s_mov_b32 s36, s78
    s_and_b32 s37, s79, 0xffff
    s_mov_b32 s38, 7340032
    s_mov_b32 s39, 0x20000
    s_mov_b32 s40, s72
    s_and_b32 s41, s73, 0xffff
    s_mov_b32 s42, 2048
    s_mov_b32 s43, 0x20000
    s_lshl_b32 s86, s2, 9
    s_add_u32 s86, s86, 786432
    s_cmp_eq_u32 s3, 0
    s_cselect_b32 s86, s86, 2147483648
    v_lshl_add_u32 v7, v0, 2, s86
    v_mul_u32_u24 v12, 192, v21
    v_add_u32 v7, v7, v12
    v_mov_b32 v12, 2147483648
    v_cmp_gt_u32 vcc, 32, v0
    s_nop 1
    v_cndmask_b32 v7, v12, v7, vcc
    v_mov_b32 v12, 0
    buffer_store_dword v12, v7, s[16:19], 0 offen sc1
    v_mov_b32 v128, 0
    v_mov_b32 v129, 0
    v_mov_b32 v130, 0
    v_mov_b32 v131, 0
    v_mov_b32 v132, 0
    v_mov_b32 v133, 0
    v_mov_b32 v134, 0
    v_mov_b32 v135, 0
    v_mov_b32 v136, 0
    v_mov_b32 v137, 0
    v_mov_b32 v138, 0
    v_mov_b32 v139, 0
    v_mov_b32 v140, 0
    v_mov_b32 v141, 0
    v_mov_b32 v142, 0
    v_mov_b32 v143, 0
    v_mov_b32 v144, 0
    v_mov_b32 v145, 0
    v_mov_b32 v146, 0
    v_mov_b32 v147, 0
    v_mov_b32 v148, 0
    v_mov_b32 v149, 0
    v_mov_b32 v150, 0
    v_mov_b32 v151, 0
    v_mov_b32 v152, 0
    v_mov_b32 v153, 0
    v_mov_b32 v154, 0
    v_mov_b32 v155, 0
    v_mov_b32 v156, 0
    v_mov_b32 v157, 0
    v_mov_b32 v158, 0
    v_mov_b32 v159, 0
    v_mov_b32 v160, 0
    v_mov_b32 v161, 0
    v_mov_b32 v162, 0
    v_mov_b32 v163, 0
    v_mov_b32 v164, 0
    v_mov_b32 v165, 0
    v_mov_b32 v166, 0
    v_mov_b32 v167, 0
    v_mov_b32 v168, 0
    v_mov_b32 v169, 0
    v_mov_b32 v170, 0
    v_mov_b32 v171, 0
    v_mov_b32 v172, 0
    v_mov_b32 v173, 0
    v_mov_b32 v174, 0
    v_mov_b32 v175, 0
    v_mov_b32 v176, 0
    v_mov_b32 v177, 0
    v_mov_b32 v178, 0
    v_mov_b32 v179, 0
    v_mov_b32 v180, 0
    v_mov_b32 v181, 0
    v_mov_b32 v182, 0
    v_mov_b32 v183, 0
    v_mov_b32 v184, 0
    v_mov_b32 v185, 0
    v_mov_b32 v186, 0
    v_mov_b32 v187, 0
    v_mov_b32 v188, 0
    v_mov_b32 v189, 0
    v_mov_b32 v190, 0
    v_mov_b32 v191, 0
    v_mov_b32 v192, 0
    v_mov_b32 v193, 0
    v_mov_b32 v194, 0
    v_mov_b32 v195, 0
    v_mov_b32 v196, 0
    v_mov_b32 v197, 0
    v_mov_b32 v198, 0
    v_mov_b32 v199, 0
    v_mov_b32 v200, 0
    v_mov_b32 v201, 0
    v_mov_b32 v202, 0
    v_mov_b32 v203, 0
    v_mov_b32 v204, 0
    v_mov_b32 v205, 0
    v_mov_b32 v206, 0
    v_mov_b32 v207, 0
    v_mov_b32 v208, 0
    v_mov_b32 v209, 0
    v_mov_b32 v210, 0
    v_mov_b32 v211, 0
    v_mov_b32 v212, 0
    v_mov_b32 v213, 0
    v_mov_b32 v214, 0
    v_mov_b32 v215, 0
    v_mov_b32 v216, 0
    v_mov_b32 v217, 0
    v_mov_b32 v218, 0
    v_mov_b32 v219, 0
    v_mov_b32 v220, 0
    v_mov_b32 v221, 0
    v_mov_b32 v222, 0
    v_mov_b32 v223, 0
    s_mov_b32 s54, 0x358637bd
    s_mov_b32 s55, 0x358637bd
    s_mov_b32 s62, 0
    s_mov_b32 s63, 1
    v_add_u32 v2, 40960, v2
    v_add_u32 v3, 40960, v3
    v_add_u32 v4, 40960, v4
    v_add_u32 v5, 40960, v5
    s_waitcnt lgkmcnt(0)
    s_add_u32 s68, s61, 0x9e3779b9
    s_barrier
    ds_read_b128 v[40:43], v2 offset:0
    ds_read_b128 v[44:47], v2 offset:2048
    ds_read_b128 v[48:51], v2 offset:4096
    ds_read_b128 v[52:55], v2 offset:6144
    ds_read_b64_tr_b16 v[56:57], v4 offset:0
    ds_read_b64_tr_b16 v[58:59], v4 offset:512
    ds_read_b64_tr_b16 v[60:61], v5 offset:0
    ds_read_b64_tr_b16 v[62:63], v5 offset:512
    ds_read_b64_tr_b16 v[64:65], v4 offset:8192
    ds_read_b64_tr_b16 v[66:67], v4 offset:8704
    ds_read_b64_tr_b16 v[68:69], v5 offset:8192
    ds_read_b64_tr_b16 v[70:71], v5 offset:8704
    ds_read_b64_tr_b16 v[72:73], v4 offset:16384
    ds_read_b64_tr_b16 v[74:75], v4 offset:16896
    ds_read_b64_tr_b16 v[76:77], v5 offset:16384
    ds_read_b64_tr_b16 v[78:79], v5 offset:16896
L_cloop:
    s_waitcnt lgkmcnt(0)
    v_mfma_f32_16x16x32_bf16 v[128:131], v[56:59], v[40:43], v[128:131]
    ds_read_b128 v[80:83], v3 offset:0
    v_mfma_f32_16x16x32_bf16 v[132:135], v[56:59], v[44:47], v[132:135]
    ds_read_b128 v[84:87], v3 offset:2048
    v_mfma_f32_16x16x32_bf16 v[136:139], v[56:59], v[48:51], v[136:139]
    ds_read_b128 v[88:91], v3 offset:4096
    v_mfma_f32_16x16x32_bf16 v[140:143], v[56:59], v[52:55], v[140:143]
    ds_read_b128 v[92:95], v3 offset:6144
    v_mfma_f32_16x16x32_bf16 v[144:147], v[60:63], v[40:43], v[144:147]
    ds_read_b64_tr_b16 v[96:97], v4 offset:4096
    v_mfma_f32_16x16x32_bf16 v[148:151], v[60:63], v[44:47], v[148:151]
    ds_read_b64_tr_b16 v[98:99], v4 offset:4608
    v_mfma_f32_16x16x32_bf16 v[152:155], v[60:63], v[48:51], v[152:155]
    ds_read_b64_tr_b16 v[100:101], v5 offset:4096
    v_mfma_f32_16x16x32_bf16 v[156:159], v[60:63], v[52:55], v[156:159]
    ds_read_b64_tr_b16 v[102:103], v5 offset:4608
    v_mfma_f32_16x16x32_bf16 v[160:163], v[40:43], v[64:67], v[160:163]
    ds_read_b64_tr_b16 v[104:105], v4 offset:12288
    v_mfma_f32_16x16x32_bf16 v[164:167], v[44:47], v[64:67], v[164:167]
    ds_read_b64_tr_b16 v[106:107], v4 offset:12800
    v_mfma_f32_16x16x32_bf16 v[168:171], v[48:51], v[64:67], v[168:171]
    ds_read_b64_tr_b16 v[108:109], v5 offset:12288
    v_mfma_f32_16x16x32_bf16 v[172:175], v[52:55], v[64:67], v[172:175]
    ds_read_b64_tr_b16 v[110:111], v5 offset:12800
    v_mfma_f32_16x16x32_bf16 v[176:179], v[40:43], v[68:71], v[176:179]
    ds_read_b64_tr_b16 v[112:113], v4 offset:20480
    v_mfma_f32_16x16x32_bf16 v[180:183], v[44:47], v[68:71], v[180:183]
    ds_read_b64_tr_b16 v[114:115], v4 offset:20992
    v_mfma_f32_16x16x32_bf16 v[184:187], v[48:51], v[68:71], v[184:187]
    ds_read_b64_tr_b16 v[116:117], v5 offset:20480
    v_mfma_f32_16x16x32_bf16 v[188:191], v[52:55], v[68:71], v[188:191]
    ds_read_b64_tr_b16 v[118:119], v5 offset:20992
    v_mfma_f32_16x16x32_bf16 v[192:195], v[40:43], v[72:75], v[192:195]
    s_add_u32 s63, s63, 1
    s_cmp_eq_u32 s63, 4
    s_cselect_b32 s53, 4294803456, 0
    s_cselect_b32 s63, 0, s63
    s_add_u32 s53, s53, 40960
    v_mfma_f32_16x16x32_bf16 v[196:199], v[44:47], v[72:75], v[196:199]
    v_add_u32 v2, s53, v2
    v_mfma_f32_16x16x32_bf16 v[200:203], v[48:51], v[72:75], v[200:203]
    v_add_u32 v4, s53, v4
    v_mfma_f32_16x16x32_bf16 v[204:207], v[52:55], v[72:75], v[204:207]
    v_add_u32 v5, s53, v5
    v_mfma_f32_16x16x32_bf16 v[208:211], v[40:43], v[76:79], v[208:211]
    v_add_u32 v3, s53, v3
    v_mfma_f32_16x16x32_bf16 v[212:215], v[44:47], v[76:79], v[212:215]
    s_cmp_ge_u32 s62, 6
    s_cbranch_scc1 L_cl_none
    buffer_store_dwordx4 v[8:11], v6, s[16:19], 0 offen sc1
    v_add_u32 v6, 1024, v6
    s_cmp_lt_u32 s62, 3
    s_cbranch_scc1 L_cl_none
    v_mov_b32 v6, v16
    v_mov_b32 v16, v17
L_cl_none:
    v_mfma_f32_16x16x32_bf16 v[216:219], v[48:51], v[76:79], v[216:219]
    v_mfma_f32_16x16x32_bf16 v[220:223], v[52:55], v[76:79], v[220:223]
    s_waitcnt lgkmcnt(0)
    v_mfma_f32_16x16x32_bf16 v[128:131], v[96:99], v[80:83], v[128:131]
    s_barrier
    ds_read_b128 v[40:43], v2 offset:0
    v_mfma_f32_16x16x32_bf16 v[132:135], v[96:99], v[84:87], v[132:135]
    ds_read_b128 v[44:47], v2 offset:2048
    v_mfma_f32_16x16x32_bf16 v[136:139], v[96:99], v[88:91], v[136:139]
    ds_read_b128 v[48:51], v2 offset:4096
    v_mfma_f32_16x16x32_bf16 v[140:143], v[96:99], v[92:95], v[140:143]
    ds_read_b128 v[52:55], v2 offset:6144
    v_mfma_f32_16x16x32_bf16 v[144:147], v[100:103], v[80:83], v[144:147]
    ds_read_b64_tr_b16 v[56:57], v4 offset:0
    v_mfma_f32_16x16x32_bf16 v[148:151], v[100:103], v[84:87], v[148:151]
    ds_read_b64_tr_b16 v[58:59], v4 offset:512
    v_mfma_f32_16x16x32_bf16 v[152:155], v[100:103], v[88:91], v[152:155]
    ds_read_b64_tr_b16 v[60:61], v5 offset:0
    v_mfma_f32_16x16x32_bf16 v[156:159], v[100:103], v[92:95], v[156:159]
    ds_read_b64_tr_b16 v[62:63], v5 offset:512
    v_mfma_f32_16x16x32_bf16 v[160:163], v[80:83], v[104:107], v[160:163]
    ds_read_b64_tr_b16 v[64:65], v4 offset:8192
    v_mfma_f32_16x16x32_bf16 v[164:167], v[84:87], v[104:107], v[164:167]
    ds_read_b64_tr_b16 v[66:67], v4 offset:8704
    v_mfma_f32_16x16x32_bf16 v[168:171], v[88:91], v[104:107], v[168:171]
    ds_read_b64_tr_b16 v[68:69], v5 offset:8192
    v_mfma_f32_16x16x32_bf16 v[172:175], v[92:95], v[104:107], v[172:175]
    ds_read_b64_tr_b16 v[70:71], v5 offset:8704
    v_mfma_f32_16x16x32_bf16 v[176:179], v[80:83], v[108:111], v[176:179]
    ds_read_b64_tr_b16 v[72:73], v4 offset:16384
    v_mfma_f32_16x16x32_bf16 v[180:183], v[84:87], v[108:111], v[180:183]
    ds_read_b64_tr_b16 v[74:75], v4 offset:16896
    v_mfma_f32_16x16x32_bf16 v[184:187], v[88:91], v[108:111], v[184:187]
    ds_read_b64_tr_b16 v[76:77], v5 offset:16384
    v_mfma_f32_16x16x32_bf16 v[188:191], v[92:95], v[108:111], v[188:191]
    ds_read_b64_tr_b16 v[78:79], v5 offset:16896
    v_mfma_f32_16x16x32_bf16 v[192:195], v[80:83], v[112:115], v[192:195]
    v_mfma_f32_16x16x32_bf16 v[196:199], v[84:87], v[112:115], v[196:199]
    s_cmp_lg_u32 s62, 8
    s_cbranch_scc1 L_cl_nw
    s_waitcnt vmcnt(0)
L_cl_nw:
    v_mfma_f32_16x16x32_bf16 v[200:203], v[88:91], v[112:115], v[200:203]
    v_mfma_f32_16x16x32_bf16 v[204:207], v[92:95], v[112:115], v[204:207]
    v_mfma_f32_16x16x32_bf16 v[208:211], v[80:83], v[116:119], v[208:211]
    s_add_u32 s62, s62, 1
    v_mfma_f32_16x16x32_bf16 v[212:215], v[84:87], v[116:119], v[212:215]
    v_mfma_f32_16x16x32_bf16 v[216:219], v[88:91], v[116:119], v[216:219]
    v_mfma_f32_16x16x32_bf16 v[220:223], v[92:95], v[116:119], v[220:223]
    s_cmp_lt_u32 s62, 15
    s_cbranch_scc1 L_cloop
    s_waitcnt lgkmcnt(0)
    v_mfma_f32_16x16x32_bf16 v[128:131], v[56:59], v[40:43], v[128:131]
    ds_read_b128 v[80:83], v3 offset:0
    v_mfma_f32_16x16x32_bf16 v[132:135], v[56:59], v[44:47], v[132:135]
    ds_read_b128 v[84:87], v3 offset:2048
    v_mfma_f32_16x16x32_bf16 v[136:139], v[56:59], v[48:51], v[136:139]
    ds_read_b128 v[88:91], v3 offset:4096
    v_mfma_f32_16x16x32_bf16 v[140:143], v[56:59], v[52:55], v[140:143]
    ds_read_b128 v[92:95], v3 offset:6144
    v_mfma_f32_16x16x32_bf16 v[144:147], v[60:63], v[40:43], v[144:147]
    ds_read_b64_tr_b16 v[96:97], v4 offset:4096
    v_mfma_f32_16x16x32_bf16 v[148:151], v[60:63], v[44:47], v[148:151]
    ds_read_b64_tr_b16 v[98:99], v4 offset:4608
    v_mfma_f32_16x16x32_bf16 v[152:155], v[60:63], v[48:51], v[152:155]
    ds_read_b64_tr_b16 v[100:101], v5 offset:4096
    v_mfma_f32_16x16x32_bf16 v[156:159], v[60:63], v[52:55], v[156:159]
    ds_read_b64_tr_b16 v[102:103], v5 offset:4608
    v_mfma_f32_16x16x32_bf16 v[160:163], v[40:43], v[64:67], v[160:163]
    ds_read_b64_tr_b16 v[104:105], v4 offset:12288
    v_mfma_f32_16x16x32_bf16 v[164:167], v[44:47], v[64:67], v[164:167]
    ds_read_b64_tr_b16 v[106:107], v4 offset:12800
    v_mfma_f32_16x16x32_bf16 v[168:171], v[48:51], v[64:67], v[168:171]
    ds_read_b64_tr_b16 v[108:109], v5 offset:12288
    v_mfma_f32_16x16x32_bf16 v[172:175], v[52:55], v[64:67], v[172:175]
    ds_read_b64_tr_b16 v[110:111], v5 offset:12800
    v_mfma_f32_16x16x32_bf16 v[176:179], v[40:43], v[68:71], v[176:179]
    ds_read_b64_tr_b16 v[112:113], v4 offset:20480
    v_mfma_f32_16x16x32_bf16 v[180:183], v[44:47], v[68:71], v[180:183]
    ds_read_b64_tr_b16 v[114:115], v4 offset:20992
    v_mfma_f32_16x16x32_bf16 v[184:187], v[48:51], v[68:71], v[184:187]
    ds_read_b64_tr_b16 v[116:117], v5 offset:20480
    v_mfma_f32_16x16x32_bf16 v[188:191], v[52:55], v[68:71], v[188:191]
    ds_read_b64_tr_b16 v[118:119], v5 offset:20992
    v_mfma_f32_16x16x32_bf16 v[192:195], v[40:43], v[72:75], v[192:195]
    v_lshrrev_b32 v21, 4, v0
    v_and_b32 v22, 15, v0
    v_mfma_f32_16x16x32_bf16 v[196:199], v[44:47], v[72:75], v[196:199]
    s_lshl_b32 s86, s49, 8
    s_add_u32 s86, s86, 131072
    v_lshl_add_u32 v6, v21, 4, s86
    v_mfma_f32_16x16x32_bf16 v[200:203], v[48:51], v[72:75], v[200:203]
    v_lshl_add_u32 v7, v22, 2, s86
    v_mfma_f32_16x16x32_bf16 v[204:207], v[52:55], v[72:75], v[204:207]
    s_lshl_b32 s86, s50, 7
    s_add_u32 s86, s86, 132608
    v_lshl_add_u32 v8, v22, 2, s86
    v_mfma_f32_16x16x32_bf16 v[208:211], v[40:43], v[76:79], v[208:211]
    v_lshl_add_u32 v9, v21, 4, s86
    v_mfma_f32_16x16x32_bf16 v[212:215], v[44:47], v[76:79], v[212:215]
    s_lshl_b32 s86, s3, 2
    s_add_u32 s86, s86, 135168
    v_mov_b32 v12, s86
    v_mfma_f32_16x16x32_bf16 v[216:219], v[48:51], v[76:79], v[216:219]
    v_xor_b32 v13, 4, v12
    v_mfma_f32_16x16x32_bf16 v[220:223], v[52:55], v[76:79], v[220:223]
    s_waitcnt lgkmcnt(0)
    v_mfma_f32_16x16x32_bf16 v[160:163], v[80:83], v[104:107], v[160:163]
    v_mfma_f32_16x16x32_bf16 v[164:167], v[84:87], v[104:107], v[164:167]
    v_mfma_f32_16x16x32_bf16 v[168:171], v[88:91], v[104:107], v[168:171]
    v_mfma_f32_16x16x32_bf16 v[172:175], v[92:95], v[104:107], v[172:175]
    v_mfma_f32_16x16x32_bf16 v[176:179], v[80:83], v[108:111], v[176:179]
    v_mfma_f32_16x16x32_bf16 v[180:183], v[84:87], v[108:111], v[180:183]
    v_mfma_f32_16x16x32_bf16 v[184:187], v[88:91], v[108:111], v[184:187]
    v_mfma_f32_16x16x32_bf16 v[188:191], v[92:95], v[108:111], v[188:191]
    v_mfma_f32_16x16x32_bf16 v[192:195], v[80:83], v[112:115], v[192:195]
    v_mfma_f32_16x16x32_bf16 v[196:199], v[84:87], v[112:115], v[196:199]
    v_mfma_f32_16x16x32_bf16 v[200:203], v[88:91], v[112:115], v[200:203]
    v_mfma_f32_16x16x32_bf16 v[204:207], v[92:95], v[112:115], v[204:207]
    v_mfma_f32_16x16x32_bf16 v[208:211], v[80:83], v[116:119], v[208:211]
    s_barrier
    ds_read_b128 v[40:43], v6 offset:0
    ds_read_b128 v[44:47], v6 offset:64
    v_mfma_f32_16x16x32_bf16 v[212:215], v[84:87], v[116:119], v[212:215]
    ds_read_b128 v[48:51], v6 offset:128
    ds_read_b128 v[52:55], v6 offset:192
    v_mfma_f32_16x16x32_bf16 v[216:219], v[88:91], v[116:119], v[216:219]
    ds_read_b32 v72, v8 offset:256
    ds_read_b32 v73, v8 offset:320
    v_mfma_f32_16x16x32_bf16 v[220:223], v[92:95], v[116:119], v[220:223]
    ds_read_b32 v74, v8 offset:512
    ds_read_b32 v75, v8 offset:576
    v_mfma_f32_16x16x32_bf16 v[128:131], v[96:99], v[80:83], v[128:131]
    ds_read_b128 v[56:59], v6 offset:512
    ds_read_b128 v[60:63], v6 offset:576
    v_mfma_f32_16x16x32_bf16 v[132:135], v[96:99], v[84:87], v[132:135]
    ds_read_b128 v[64:67], v6 offset:640
    ds_read_b128 v[68:71], v6 offset:704
    v_mfma_f32_16x16x32_bf16 v[136:139], v[96:99], v[88:91], v[136:139]
    ds_read_b128 v[224:227], v6 offset:1024
    ds_read_b128 v[228:231], v6 offset:1088
    v_mfma_f32_16x16x32_bf16 v[140:143], v[96:99], v[92:95], v[140:143]
    ds_read_b128 v[232:235], v6 offset:1152
    ds_read_b128 v[236:239], v6 offset:1216
    v_mfma_f32_16x16x32_bf16 v[144:147], v[100:103], v[80:83], v[144:147]
    ds_read_b128 v[28:31], v9 offset:0
    ds_read_b128 v[32:35], v9 offset:64
    v_mfma_f32_16x16x32_bf16 v[148:151], v[100:103], v[84:87], v[148:151]
    v_mfma_f32_16x16x32_bf16 v[152:155], v[100:103], v[88:91], v[152:155]
    v_mfma_f32_16x16x32_bf16 v[156:159], v[100:103], v[92:95], v[156:159]
    ds_read_b32 v240, v7 offset:0
    ds_read_b32 v244, v7 offset:512
    ds_read_b32 v248, v7 offset:1024
    ds_read_b32 v241, v7 offset:64
    ds_read_b32 v245, v7 offset:576
    ds_read_b32 v249, v7 offset:1088
    ds_read_b32 v242, v7 offset:128
    ds_read_b32 v246, v7 offset:640
    ds_read_b32 v250, v7 offset:1152
    ds_read_b32 v243, v7 offset:192
    ds_read_b32 v247, v7 offset:704
    ds_read_b32 v251, v7 offset:1216
    s_waitcnt lgkmcnt(12)
    v_pk_fma_f32 v[160:161], v[40:41], v[72:73], v[160:161] op_sel_hi:[1,0,1]
    v_pk_mul_f32 v[112:113], v[160:161], v[224:225]
    v_pk_fma_f32 v[160:161], v[160:161], v[56:57], s[54:55]
    v_exp_f32 v112, v112 clamp
    v_exp_f32 v113, v113 clamp
    v_max_f32 v160, s54, v160
    v_max_f32 v161, s54, v161
    v_pk_add_f32 v[160:161], v[160:161], v[112:113]
    v_cvt_pk_bf16_f32 v80, v160, v161
    v_pk_fma_f32 v[162:163], v[42:43], v[72:73], v[162:163] op_sel_hi:[1,0,1]
    v_pk_mul_f32 v[114:115], v[162:163], v[226:227]
    v_pk_fma_f32 v[162:163], v[162:163], v[58:59], s[54:55]
    v_exp_f32 v114, v114 clamp
    v_exp_f32 v115, v115 clamp
    v_max_f32 v162, s54, v162
    v_max_f32 v163, s54, v163
    v_pk_add_f32 v[162:163], v[162:163], v[114:115]
    v_cvt_pk_bf16_f32 v81, v162, v163
    v_pk_fma_f32 v[164:165], v[44:45], v[72:73], v[164:165] op_sel_hi:[1,0,1]
    v_pk_mul_f32 v[116:117], v[164:165], v[228:229]
    v_pk_fma_f32 v[164:165], v[164:165], v[60:61], s[54:55]
    v_exp_f32 v116, v116 clamp
    v_exp_f32 v117, v117 clamp
    v_max_f32 v164, s54, v164
    v_max_f32 v165, s54, v165
    v_pk_add_f32 v[164:165], v[164:165], v[116:117]
    v_cvt_pk_bf16_f32 v82, v164, v165
    v_pk_fma_f32 v[166:167], v[46:47], v[72:73], v[166:167] op_sel_hi:[1,0,1]
    v_pk_mul_f32 v[118:119], v[166:167], v[230:231]
    v_pk_fma_f32 v[166:167], v[166:167], v[62:63], s[54:55]
    v_exp_f32 v118, v118 clamp
    v_exp_f32 v119, v119 clamp
    v_max_f32 v166, s54, v166
    v_max_f32 v167, s54, v167
    v_pk_add_f32 v[166:167], v[166:167], v[118:119]
    v_cvt_pk_bf16_f32 v83, v166, v167
    v_pk_fma_f32 v[168:169], v[48:49], v[72:73], v[168:169] op_sel_hi:[1,0,1]
    v_pk_mul_f32 v[112:113], v[168:169], v[232:233]
    v_pk_fma_f32 v[168:169], v[168:169], v[64:65], s[54:55]
    v_exp_f32 v112, v112 clamp
    v_exp_f32 v113, v113 clamp
    v_max_f32 v168, s54, v168
    v_max_f32 v169, s54, v169
    v_pk_add_f32 v[168:169], v[168:169], v[112:113]
    v_cvt_pk_bf16_f32 v84, v168, v169
    v_pk_fma_f32 v[170:171], v[50:51], v[72:73], v[170:171] op_sel_hi:[1,0,1]
    v_pk_mul_f32 v[114:115], v[170:171], v[234:235]
    v_pk_fma_f32 v[170:171], v[170:171], v[66:67], s[54:55]
    v_exp_f32 v114, v114 clamp
    v_exp_f32 v115, v115 clamp
    v_max_f32 v170, s54, v170
    v_max_f32 v171, s54, v171
    v_pk_add_f32 v[170:171], v[170:171], v[114:115]
    v_cvt_pk_bf16_f32 v85, v170, v171
    v_pk_fma_f32 v[172:173], v[52:53], v[72:73], v[172:173] op_sel_hi:[1,0,1]
    v_pk_mul_f32 v[116:117], v[172:173], v[236:237]
    v_pk_fma_f32 v[172:173], v[172:173], v[68:69], s[54:55]
    v_exp_f32 v116, v116 clamp
    v_exp_f32 v117, v117 clamp
    v_max_f32 v172, s54, v172
    v_max_f32 v173, s54, v173
    v_pk_add_f32 v[172:173], v[172:173], v[116:117]
    v_cvt_pk_bf16_f32 v86, v172, v173
    v_pk_fma_f32 v[174:175], v[54:55], v[72:73], v[174:175] op_sel_hi:[1,0,1]
    v_pk_mul_f32 v[118:119], v[174:175], v[238:239]
    v_pk_fma_f32 v[174:175], v[174:175], v[70:71], s[54:55]
    v_exp_f32 v118, v118 clamp
    v_exp_f32 v119, v119 clamp
    v_max_f32 v174, s54, v174
    v_max_f32 v175, s54, v175
    v_pk_add_f32 v[174:175], v[174:175], v[118:119]
    v_cvt_pk_bf16_f32 v87, v174, v175
    v_pk_fma_f32 v[176:177], v[40:41], v[72:73], v[176:177] op_sel:[0,1,0] op_sel_hi:[1,1,1]
    v_pk_mul_f32 v[112:113], v[176:177], v[224:225]
    v_pk_fma_f32 v[176:177], v[176:177], v[56:57], s[54:55]
    v_exp_f32 v112, v112 clamp
    v_exp_f32 v113, v113 clamp
    v_max_f32 v176, s54, v176
    v_max_f32 v177, s54, v177
    v_pk_add_f32 v[176:177], v[176:177], v[112:113]
    v_cvt_pk_bf16_f32 v88, v176, v177
    v_pk_fma_f32 v[178:179], v[42:43], v[72:73], v[178:179] op_sel:[0,1,0] op_sel_hi:[1,1,1]
    v_pk_mul_f32 v[114:115], v[178:179], v[226:227]
    v_pk_fma_f32 v[178:179], v[178:179], v[58:59], s[54:55]
    v_exp_f32 v114, v114 clamp
    v_exp_f32 v115, v115 clamp
    v_max_f32 v178, s54, v178
    v_max_f32 v179, s54, v179
    v_pk_add_f32 v[178:179], v[178:179], v[114:115]
    v_cvt_pk_bf16_f32 v89, v178, v179
    v_pk_fma_f32 v[180:181], v[44:45], v[72:73], v[180:181] op_sel:[0,1,0] op_sel_hi:[1,1,1]
    v_pk_mul_f32 v[116:117], v[180:181], v[228:229]
    v_pk_fma_f32 v[180:181], v[180:181], v[60:61], s[54:55]
    v_exp_f32 v116, v116 clamp
    v_exp_f32 v117, v117 clamp
    v_max_f32 v180, s54, v180
    v_max_f32 v181, s54, v181
    v_pk_add_f32 v[180:181], v[180:181], v[116:117]
    v_cvt_pk_bf16_f32 v90, v180, v181
    v_pk_fma_f32 v[182:183], v[46:47], v[72:73], v[182:183] op_sel:[0,1,0] op_sel_hi:[1,1,1]
    v_pk_mul_f32 v[118:119], v[182:183], v[230:231]
    v_pk_fma_f32 v[182:183], v[182:183], v[62:63], s[54:55]
    v_exp_f32 v118, v118 clamp
    v_exp_f32 v119, v119 clamp
    v_max_f32 v182, s54, v182
    v_max_f32 v183, s54, v183
    v_pk_add_f32 v[182:183], v[182:183], v[118:119]
    v_cvt_pk_bf16_f32 v91, v182, v183
    v_pk_fma_f32 v[184:185], v[48:49], v[72:73], v[184:185] op_sel:[0,1,0] op_sel_hi:[1,1,1]
    v_pk_mul_f32 v[112:113], v[184:185], v[232:233]
    v_pk_fma_f32 v[184:185], v[184:185], v[64:65], s[54:55]
    v_exp_f32 v112, v112 clamp
    v_exp_f32 v113, v113 clamp
    v_max_f32 v184, s54, v184
    v_max_f32 v185, s54, v185
    v_pk_add_f32 v[184:185], v[184:185], v[112:113]
    v_cvt_pk_bf16_f32 v92, v184, v185
    v_pk_fma_f32 v[186:187], v[50:51], v[72:73], v[186:187] op_sel:[0,1,0] op_sel_hi:[1,1,1]
    v_pk_mul_f32 v[114:115], v[186:187], v[234:235]
    v_pk_fma_f32 v[186:187], v[186:187], v[66:67], s[54:55]
    v_exp_f32 v114, v114 clamp
    v_exp_f32 v115, v115 clamp
    v_max_f32 v186, s54, v186
    v_max_f32 v187, s54, v187
    v_pk_add_f32 v[186:187], v[186:187], v[114:115]
    v_cvt_pk_bf16_f32 v93, v186, v187
    v_pk_fma_f32 v[188:189], v[52:53], v[72:73], v[188:189] op_sel:[0,1,0] op_sel_hi:[1,1,1]
    v_pk_mul_f32 v[116:117], v[188:189], v[236:237]
    v_pk_fma_f32 v[188:189], v[188:189], v[68:69], s[54:55]
    v_exp_f32 v116, v116 clamp
    v_exp_f32 v117, v117 clamp
    v_max_f32 v188, s54, v188
    v_max_f32 v189, s54, v189
    v_pk_add_f32 v[188:189], v[188:189], v[116:117]
    v_cvt_pk_bf16_f32 v94, v188, v189
    v_pk_fma_f32 v[190:191], v[54:55], v[72:73], v[190:191] op_sel:[0,1,0] op_sel_hi:[1,1,1]
    v_pk_mul_f32 v[118:119], v[190:191], v[238:239]
    v_pk_fma_f32 v[190:191], v[190:191], v[70:71], s[54:55]
    v_exp_f32 v118, v118 clamp
    v_exp_f32 v119, v119 clamp
    v_max_f32 v190, s54, v190
    v_max_f32 v191, s54, v191
    v_pk_add_f32 v[190:191], v[190:191], v[118:119]
    v_cvt_pk_bf16_f32 v95, v190, v191
    v_mov_b32 v120, s95
    v_mov_b32 v121, s95
    v_mov_b32 v122, s95
    v_mov_b32 v123, s95
    v_pk_fma_f32 v[192:193], v[40:41], v[74:75], v[192:193] op_sel_hi:[1,0,1]
    v_pk_mul_f32 v[192:193], v[192:193], v[56:57]
    v_cvt_pk_bf16_f32 v96, v192, v193
    v_pk_fma_f32 v[194:195], v[42:43], v[74:75], v[194:195] op_sel_hi:[1,0,1]
    v_pk_mul_f32 v[194:195], v[194:195], v[58:59]
    v_cvt_pk_bf16_f32 v97, v194, v195
    v_pk_fma_f32 v[196:197], v[44:45], v[74:75], v[196:197] op_sel_hi:[1,0,1]
    v_pk_mul_f32 v[196:197], v[196:197], v[60:61]
    v_cvt_pk_bf16_f32 v98, v196, v197
    v_pk_fma_f32 v[198:199], v[46:47], v[74:75], v[198:199] op_sel_hi:[1,0,1]
    v_pk_mul_f32 v[198:199], v[198:199], v[62:63]
    v_cvt_pk_bf16_f32 v99, v198, v199
    v_pk_fma_f32 v[200:201], v[48:49], v[74:75], v[200:201] op_sel_hi:[1,0,1]
    v_pk_mul_f32 v[200:201], v[200:201], v[64:65]
    v_cvt_pk_bf16_f32 v100, v200, v201
    v_pk_fma_f32 v[202:203], v[50:51], v[74:75], v[202:203] op_sel_hi:[1,0,1]
    v_pk_mul_f32 v[202:203], v[202:203], v[66:67]
    v_cvt_pk_bf16_f32 v101, v202, v203
    v_pk_fma_f32 v[204:205], v[52:53], v[74:75], v[204:205] op_sel_hi:[1,0,1]
    v_pk_mul_f32 v[204:205], v[204:205], v[68:69]
    v_cvt_pk_bf16_f32 v102, v204, v205
    v_pk_fma_f32 v[206:207], v[54:55], v[74:75], v[206:207] op_sel_hi:[1,0,1]
    v_pk_mul_f32 v[206:207], v[206:207], v[70:71]
    v_cvt_pk_bf16_f32 v103, v206, v207
    v_pk_fma_f32 v[208:209], v[40:41], v[74:75], v[208:209] op_sel:[0,1,0] op_sel_hi:[1,1,1]
    v_pk_mul_f32 v[208:209], v[208:209], v[56:57]
    v_cvt_pk_bf16_f32 v104, v208, v209
    v_pk_fma_f32 v[210:211], v[42:43], v[74:75], v[210:211] op_sel:[0,1,0] op_sel_hi:[1,1,1]
    v_pk_mul_f32 v[210:211], v[210:211], v[58:59]
    v_cvt_pk_bf16_f32 v105, v210, v211
    v_pk_fma_f32 v[212:213], v[44:45], v[74:75], v[212:213] op_sel:[0,1,0] op_sel_hi:[1,1,1]
    v_pk_mul_f32 v[212:213], v[212:213], v[60:61]
    v_cvt_pk_bf16_f32 v106, v212, v213
    v_pk_fma_f32 v[214:215], v[46:47], v[74:75], v[214:215] op_sel:[0,1,0] op_sel_hi:[1,1,1]
    v_pk_mul_f32 v[214:215], v[214:215], v[62:63]
    v_cvt_pk_bf16_f32 v107, v214, v215
    v_pk_fma_f32 v[216:217], v[48:49], v[74:75], v[216:217] op_sel:[0,1,0] op_sel_hi:[1,1,1]
    v_pk_mul_f32 v[216:217], v[216:217], v[64:65]
    v_cvt_pk_bf16_f32 v108, v216, v217
    v_pk_fma_f32 v[218:219], v[50:51], v[74:75], v[218:219] op_sel:[0,1,0] op_sel_hi:[1,1,1]
    v_pk_mul_f32 v[218:219], v[218:219], v[66:67]
    v_cvt_pk_bf16_f32 v109, v218, v219
    v_pk_fma_f32 v[220:221], v[52:53], v[74:75], v[220:221] op_sel:[0,1,0] op_sel_hi:[1,1,1]
    v_pk_mul_f32 v[220:221], v[220:221], v[68:69]
    v_cvt_pk_bf16_f32 v110, v220, v221
    v_pk_fma_f32 v[222:223], v[54:55], v[74:75], v[222:223] op_sel:[0,1,0] op_sel_hi:[1,1,1]
    v_pk_mul_f32 v[222:223], v[222:223], v[70:71]
    v_cvt_pk_bf16_f32 v111, v222, v223
    s_mul_i32 s86, s3, 3072
    s_add_u32 s86, s86, 139264
    v_lshl_add_u32 v6, v0, 4, s86
    s_xor_b32 s86, s3, 1
    s_mul_i32 s86, s86, 3072
    s_add_u32 s86, s86, 139264
    v_lshl_add_u32 v7, v0, 4, s86
    s_cmp_eq_u32 s49, 1
    s_cbranch_scc1 L_kv1
    v_mfma_f32_16x16x32_bf16 v[172:175], v[80:83], v[104:107], 0
    v_mfma_f32_16x16x32_bf16 v[176:179], v[88:91], v[104:107], 0
    v_mfma_f32_16x16x32_bf16 v[180:183], v[88:91], v[120:123], 0
    v_mfma_f32_16x16x32_bf16 v[160:163], v[80:83], v[96:99], 0
    v_mfma_f32_16x16x32_bf16 v[164:167], v[88:91], v[96:99], 0
    v_mfma_f32_16x16x32_bf16 v[168:171], v[80:83], v[120:123], 0
    v_mfma_f32_16x16x32_bf16 v[172:175], v[84:87], v[108:111], v[172:175]
    v_mfma_f32_16x16x32_bf16 v[176:179], v[92:95], v[108:111], v[176:179]
    v_mfma_f32_16x16x32_bf16 v[180:183], v[92:95], v[120:123], v[180:183]
    v_mfma_f32_16x16x32_bf16 v[160:163], v[84:87], v[100:103], v[160:163]
    v_mfma_f32_16x16x32_bf16 v[164:167], v[92:95], v[100:103], v[164:167]
    v_mfma_f32_16x16x32_bf16 v[168:171], v[84:87], v[120:123], v[168:171]
    s_branch L_kvd
L_kv1:
    v_mfma_f32_16x16x32_bf16 v[172:175], v[80:83], v[96:99], 0
    v_mfma_f32_16x16x32_bf16 v[176:179], v[88:91], v[96:99], 0
    v_mfma_f32_16x16x32_bf16 v[180:183], v[80:83], v[120:123], 0
    v_mfma_f32_16x16x32_bf16 v[160:163], v[80:83], v[104:107], 0
    v_mfma_f32_16x16x32_bf16 v[164:167], v[88:91], v[104:107], 0
    v_mfma_f32_16x16x32_bf16 v[168:171], v[88:91], v[120:123], 0
    v_mfma_f32_16x16x32_bf16 v[172:175], v[84:87], v[100:103], v[172:175]
    v_mfma_f32_16x16x32_bf16 v[176:179], v[92:95], v[100:103], v[176:179]
    v_mfma_f32_16x16x32_bf16 v[180:183], v[84:87], v[120:123], v[180:183]
    v_mfma_f32_16x16x32_bf16 v[160:163], v[84:87], v[108:111], v[160:163]
    v_mfma_f32_16x16x32_bf16 v[164:167], v[92:95], v[108:111], v[164:167]
    v_mfma_f32_16x16x32_bf16 v[168:171], v[92:95], v[120:123], v[168:171]
L_kvd:
    s_lshl_b32 s86, s47, 1
    s_add_u32 s86, s86, s50
    s_lshl_b32 s87, s86, 1
    s_add_u32 s87, s87, s49
    s_lshl_b32 s87, s87, 4
    s_add_u32 s87, s87, s46
    s_lshl_b32 s87, s87, 10
    s_add_u32 s87, s87, 5242880
    v_lshl_add_u32 v8, v0, 4, s87
    s_lshl_b32 s87, s86, 4
    s_add_u32 s87, s87, s46
    s_lshl_b32 s87, s87, 7
    s_lshl_b32 s88, s49, 6
    s_add_u32 s87, s87, s88
    s_add_u32 s87, s87, 6881280
    v_lshl_add_u32 v9, v21, 4, s87
    v_cmp_eq_u32 vcc, 0, v22
    v_mov_b32 v10, 2147483648
    s_nop 0
    v_cndmask_b32 v9, v10, v9, vcc
    ds_write_b128 v6, v[172:175] offset:0
    ds_write_b128 v6, v[176:179] offset:1024
    ds_write_b128 v6, v[180:183] offset:2048
    ds_write_b32 v12, v12
    s_lshl_b32 s87, s46, 3
    s_lshl_b32 s88, s49, 2
    s_add_u32 s87, s87, s88
    s_lshl_b32 s87, s87, 5
    s_add_u32 s87, s87, s86
    s_lshl_b32 s87, s87, 10
    s_add_u32 s87, s87, 1048576
    v_lshl_add_u32 v10, v0, 4, s87
    s_mul_i32 s87, s50, 3072
    s_add_u32 s87, s87, 151552
    v_lshl_add_u32 v11, v0, 4, s87
    s_lshl_b32 s87, s86, 1
    s_add_u32 s87, s87, s49
    s_lshl_b32 s87, s87, 5
    s_add_u32 s87, s87, s46
    s_lshl2_add_u32 s87, s87, 671744
    v_mov_b32 v16, 2147483648
    v_mov_b32 v18, 2147483648
    v_writelane_b32 v16, s87, 0
    s_lshl_b32 s87, s46, 1
    s_add_u32 s87, s87, s49
    s_lshl_b32 s87, s87, 1
    s_lshr_b32 s88, s86, 4
    s_add_u32 s87, s87, s88
    s_lshl_b32 s87, s87, 6
    s_and_b32 s88, s86, 15
    s_add_u32 s87, s87, s88
    s_lshl2_add_u32 s87, s87, 688128
    v_writelane_b32 v18, s87, 0
    s_add_u32 s87, s87, 128
    v_writelane_b32 v18, s87, 1
    v_mov_b32 v17, s68
L_xkv:
    ds_read_b32 v14, v13
    ds_read_b128 v[172:175], v7 offset:0
    ds_read_b128 v[176:179], v7 offset:1024
    ds_read_b128 v[180:183], v7 offset:2048
    s_waitcnt lgkmcnt(0)
    v_cmp_eq_u32 vcc, 0, v14
    s_cbranch_vccz L_ok_2
    s_sub_u32 s56, s56, 1
    s_cbranch_scc0 L_xkv
    s_mov_b32 s56, 0
L_ok_2:
    v_pk_add_f32 v[160:161], v[160:161], v[172:173]
    v_pk_add_f32 v[162:163], v[162:163], v[174:175]
    v_pk_add_f32 v[164:165], v[164:165], v[176:177]
    v_pk_add_f32 v[166:167], v[166:167], v[178:179]
    v_pk_add_f32 v[168:169], v[168:169], v[180:181]
    v_pk_add_f32 v[170:171], v[170:171], v[182:183]
    v_cvt_pk_bf16_f32 v184, v160, v161
    v_cvt_pk_bf16_f32 v185, v162, v163
    v_cvt_pk_bf16_f32 v186, v164, v165
    v_cvt_pk_bf16_f32 v187, v166, v167
    buffer_store_dwordx4 v[184:187], v8, s[16:19], 0 offen sc1
    buffer_store_dwordx4 v[168:171], v9, s[16:19], 0 offen sc1
    buffer_atomic_swap v17, v16, s[16:19], 0 offen sc1
    v_pk_fma_f32 v[128:129], v[28:29], v[240:241], v[128:129] op_sel_hi:[1,0,1]
    v_pk_mul_f32 v[112:113], v[128:129], v[248:249] op_sel_hi:[1,0]
    v_pk_fma_f32 v[128:129], v[128:129], v[244:245], s[54:55] op_sel_hi:[1,0,1]
    v_exp_f32 v112, v112 clamp
    v_exp_f32 v113, v113 clamp
    v_max_f32 v128, s54, v128
    v_max_f32 v129, s54, v129
    v_pk_add_f32 v[128:129], v[128:129], v[112:113]
    v_cvt_pk_bf16_f32 v192, v128, v129
    v_pk_fma_f32 v[130:131], v[30:31], v[240:241], v[130:131] op_sel_hi:[1,0,1]
    v_pk_mul_f32 v[114:115], v[130:131], v[248:249] op_sel_hi:[1,0]
    v_pk_fma_f32 v[130:131], v[130:131], v[244:245], s[54:55] op_sel_hi:[1,0,1]
    v_exp_f32 v114, v114 clamp
    v_exp_f32 v115, v115 clamp
    v_max_f32 v130, s54, v130
    v_max_f32 v131, s54, v131
    v_pk_add_f32 v[130:131], v[130:131], v[114:115]
    v_cvt_pk_bf16_f32 v193, v130, v131
    v_pk_fma_f32 v[144:145], v[32:33], v[240:241], v[144:145] op_sel_hi:[1,0,1]
    v_pk_mul_f32 v[116:117], v[144:145], v[248:249] op_sel_hi:[1,0]
    v_pk_fma_f32 v[144:145], v[144:145], v[244:245], s[54:55] op_sel_hi:[1,0,1]
    v_exp_f32 v116, v116 clamp
    v_exp_f32 v117, v117 clamp
    v_max_f32 v144, s54, v144
    v_max_f32 v145, s54, v145
    v_pk_add_f32 v[144:145], v[144:145], v[116:117]
    v_cvt_pk_bf16_f32 v194, v144, v145
    v_pk_fma_f32 v[146:147], v[34:35], v[240:241], v[146:147] op_sel_hi:[1,0,1]
    v_pk_mul_f32 v[118:119], v[146:147], v[248:249] op_sel_hi:[1,0]
    v_pk_fma_f32 v[146:147], v[146:147], v[244:245], s[54:55] op_sel_hi:[1,0,1]
    v_exp_f32 v118, v118 clamp
    v_exp_f32 v119, v119 clamp
    v_max_f32 v146, s54, v146
    v_max_f32 v147, s54, v147
    v_pk_add_f32 v[146:147], v[146:147], v[118:119]
    v_cvt_pk_bf16_f32 v195, v146, v147
    v_pk_fma_f32 v[132:133], v[28:29], v[240:241], v[132:133] op_sel:[0,1,0] op_sel_hi:[1,1,1]
    v_pk_mul_f32 v[112:113], v[132:133], v[248:249] op_sel:[0,1] op_sel_hi:[1,1]
    v_pk_fma_f32 v[132:133], v[132:133], v[244:245], s[54:55] op_sel:[0,1,0] op_sel_hi:[1,1,1]
    v_exp_f32 v112, v112 clamp
    v_exp_f32 v113, v113 clamp
    v_max_f32 v132, s54, v132
    v_max_f32 v133, s54, v133
    v_pk_add_f32 v[132:133], v[132:133], v[112:113]
    v_cvt_pk_bf16_f32 v196, v132, v133
    v_pk_fma_f32 v[134:135], v[30:31], v[240:241], v[134:135] op_sel:[0,1,0] op_sel_hi:[1,1,1]
    v_pk_mul_f32 v[114:115], v[134:135], v[248:249] op_sel:[0,1] op_sel_hi:[1,1]
    v_pk_fma_f32 v[134:135], v[134:135], v[244:245], s[54:55] op_sel:[0,1,0] op_sel_hi:[1,1,1]
    v_exp_f32 v114, v114 clamp
    v_exp_f32 v115, v115 clamp
    v_max_f32 v134, s54, v134
    v_max_f32 v135, s54, v135
    v_pk_add_f32 v[134:135], v[134:135], v[114:115]
    v_cvt_pk_bf16_f32 v197, v134, v135
    v_pk_fma_f32 v[148:149], v[32:33], v[240:241], v[148:149] op_sel:[0,1,0] op_sel_hi:[1,1,1]
    v_pk_mul_f32 v[116:117], v[148:149], v[248:249] op_sel:[0,1] op_sel_hi:[1,1]
    v_pk_fma_f32 v[148:149], v[148:149], v[244:245], s[54:55] op_sel:[0,1,0] op_sel_hi:[1,1,1]
    v_exp_f32 v116, v116 clamp
    v_exp_f32 v117, v117 clamp
    v_max_f32 v148, s54, v148
    v_max_f32 v149, s54, v149
    v_pk_add_f32 v[148:149], v[148:149], v[116:117]
    v_cvt_pk_bf16_f32 v198, v148, v149
    v_pk_fma_f32 v[150:151], v[34:35], v[240:241], v[150:151] op_sel:[0,1,0] op_sel_hi:[1,1,1]
    v_pk_mul_f32 v[118:119], v[150:151], v[248:249] op_sel:[0,1] op_sel_hi:[1,1]
    v_pk_fma_f32 v[150:151], v[150:151], v[244:245], s[54:55] op_sel:[0,1,0] op_sel_hi:[1,1,1]
    v_exp_f32 v118, v118 clamp
    v_exp_f32 v119, v119 clamp
    v_max_f32 v150, s54, v150
    v_max_f32 v151, s54, v151
    v_pk_add_f32 v[150:151], v[150:151], v[118:119]
    v_cvt_pk_bf16_f32 v199, v150, v151
    v_pk_fma_f32 v[136:137], v[28:29], v[242:243], v[136:137] op_sel_hi:[1,0,1]
    v_pk_mul_f32 v[112:113], v[136:137], v[250:251] op_sel_hi:[1,0]
    v_pk_fma_f32 v[136:137], v[136:137], v[246:247], s[54:55] op_sel_hi:[1,0,1]
    v_exp_f32 v112, v112 clamp
    v_exp_f32 v113, v113 clamp
    v_max_f32 v136, s54, v136
    v_max_f32 v137, s54, v137
    v_pk_add_f32 v[136:137], v[136:137], v[112:113]
    v_cvt_pk_bf16_f32 v200, v136, v137
    v_pk_fma_f32 v[138:139], v[30:31], v[242:243], v[138:139] op_sel_hi:[1,0,1]
    v_pk_mul_f32 v[114:115], v[138:139], v[250:251] op_sel_hi:[1,0]
    v_pk_fma_f32 v[138:139], v[138:139], v[246:247], s[54:55] op_sel_hi:[1,0,1]
    v_exp_f32 v114, v114 clamp
    v_exp_f32 v115, v115 clamp
    v_max_f32 v138, s54, v138
    v_max_f32 v139, s54, v139
    v_pk_add_f32 v[138:139], v[138:139], v[114:115]
    v_cvt_pk_bf16_f32 v201, v138, v139
    v_pk_fma_f32 v[152:153], v[32:33], v[242:243], v[152:153] op_sel_hi:[1,0,1]
    v_pk_mul_f32 v[116:117], v[152:153], v[250:251] op_sel_hi:[1,0]
    v_pk_fma_f32 v[152:153], v[152:153], v[246:247], s[54:55] op_sel_hi:[1,0,1]
    v_exp_f32 v116, v116 clamp
    v_exp_f32 v117, v117 clamp
    v_max_f32 v152, s54, v152
    v_max_f32 v153, s54, v153
    v_pk_add_f32 v[152:153], v[152:153], v[116:117]
    v_cvt_pk_bf16_f32 v202, v152, v153
    v_pk_fma_f32 v[154:155], v[34:35], v[242:243], v[154:155] op_sel_hi:[1,0,1]
    v_pk_mul_f32 v[118:119], v[154:155], v[250:251] op_sel_hi:[1,0]
    v_pk_fma_f32 v[154:155], v[154:155], v[246:247], s[54:55] op_sel_hi:[1,0,1]
    v_exp_f32 v118, v118 clamp
    v_exp_f32 v119, v119 clamp
    v_max_f32 v154, s54, v154
    v_max_f32 v155, s54, v155
    v_pk_add_f32 v[154:155], v[154:155], v[118:119]
    v_cvt_pk_bf16_f32 v203, v154, v155
    v_pk_fma_f32 v[140:141], v[28:29], v[242:243], v[140:141] op_sel:[0,1,0] op_sel_hi:[1,1,1]
    v_pk_mul_f32 v[112:113], v[140:141], v[250:251] op_sel:[0,1] op_sel_hi:[1,1]
    v_pk_fma_f32 v[140:141], v[140:141], v[246:247], s[54:55] op_sel:[0,1,0] op_sel_hi:[1,1,1]
    v_exp_f32 v112, v112 clamp
    v_exp_f32 v113, v113 clamp
    v_max_f32 v140, s54, v140
    v_max_f32 v141, s54, v141
    v_pk_add_f32 v[140:141], v[140:141], v[112:113]
    v_cvt_pk_bf16_f32 v204, v140, v141
    v_pk_fma_f32 v[142:143], v[30:31], v[242:243], v[142:143] op_sel:[0,1,0] op_sel_hi:[1,1,1]
    v_pk_mul_f32 v[114:115], v[142:143], v[250:251] op_sel:[0,1] op_sel_hi:[1,1]
    v_pk_fma_f32 v[142:143], v[142:143], v[246:247], s[54:55] op_sel:[0,1,0] op_sel_hi:[1,1,1]
    v_exp_f32 v114, v114 clamp
    v_exp_f32 v115, v115 clamp
    v_max_f32 v142, s54, v142
    v_max_f32 v143, s54, v143
    v_pk_add_f32 v[142:143], v[142:143], v[114:115]
    v_cvt_pk_bf16_f32 v205, v142, v143
    v_pk_fma_f32 v[156:157], v[32:33], v[242:243], v[156:157] op_sel:[0,1,0] op_sel_hi:[1,1,1]
    v_pk_mul_f32 v[116:117], v[156:157], v[250:251] op_sel:[0,1] op_sel_hi:[1,1]
    v_pk_fma_f32 v[156:157], v[156:157], v[246:247], s[54:55] op_sel:[0,1,0] op_sel_hi:[1,1,1]
    v_exp_f32 v116, v116 clamp
    v_exp_f32 v117, v117 clamp
    v_max_f32 v156, s54, v156
    v_max_f32 v157, s54, v157
    v_pk_add_f32 v[156:157], v[156:157], v[116:117]
    v_cvt_pk_bf16_f32 v206, v156, v157
    v_pk_fma_f32 v[158:159], v[34:35], v[242:243], v[158:159] op_sel:[0,1,0] op_sel_hi:[1,1,1]
    v_pk_mul_f32 v[118:119], v[158:159], v[250:251] op_sel:[0,1] op_sel_hi:[1,1]
    v_pk_fma_f32 v[158:159], v[158:159], v[246:247], s[54:55] op_sel:[0,1,0] op_sel_hi:[1,1,1]
    v_exp_f32 v118, v118 clamp
    v_exp_f32 v119, v119 clamp
    v_max_f32 v158, s54, v158
    v_max_f32 v159, s54, v159
    v_pk_add_f32 v[158:159], v[158:159], v[118:119]
    v_cvt_pk_bf16_f32 v207, v158, v159
    s_lshr_b32 s62, s3, 2
    s_lshl_b32 s53, s51, 3
    s_lshl_b32 s86, s48, 1
    s_add_u32 s53, s53, s86
    s_add_u32 s53, s53, s62
    v_lshrrev_b32 v36, 4, v0
    v_and_b32 v37, 15, v0
    s_lshl_b32 s87, s53, 15
    s_lshl_b32 s86, s62, 14
    s_add_u32 s86, s86, s87
    s_add_u32 s86, s86, 1048576
    v_lshl_add_u32 v157, v0, 4, s86
    v_xor_b32 v158, 0x8000, v157
    s_lshl_b32 s86, s51, 1
    s_lshr_b32 s87, s48, 1
    s_add_u32 s86, s86, s87
    s_lshl_b32 s86, s86, 1
    s_add_u32 s86, s86, s62
    s_lshl_b32 s86, s86, 1
    s_and_b32 s87, s48, 1
    s_add_u32 s86, s86, s87
    s_lshl_b32 s86, s86, 7
    s_add_u32 s86, s86, 688128
    v_lshl_add_u32 v159, v0, 2, s86
    v_mov_b32 v38, 2147483648
    v_cmp_gt_u32 vcc, 16, v0
    s_nop 1
    v_cndmask_b32 v159, v38, v159, vcc
    v_bfe_u32 v38, v0, 2, 2
    v_lshl_add_u32 v38, v36, 2, v38
    v_bfe_u32 v39, v38, 1, 2
    v_lshlrev_b32 v38, 7, v38
    v_lshl_add_u32 v38, v39, 5, v38
    v_and_b32 v39, 3, v0
    v_lshl_add_u32 v38, v39, 3, v38
    s_lshl_b32 s86, s62, 16
    s_add_u32 s86, s86, 0
    v_add_u32 v144, s86, v38
    v_xor_b32 v145, 32, v144
    v_xor_b32 v146, 64, v144
    v_xor_b32 v147, 96, v144
    v_cmp_eq_u32 s[4:5], 1, v39
    v_cmp_eq_u32 s[6:7], 2, v39
    v_cmp_eq_u32 s[98:99], 3, v39
    s_lshl_b32 s86, s53, 10
    s_add_u32 s86, s86, 786432
    v_lshl_add_u32 v160, v0, 2, s86
    v_mul_u32_u24 v161, 192, v36
    v_add_u32 v160, v160, v161
    s_mov_b32 s72, 0x00f0000f
    s_mov_b32 s73, 0xf0000f00
    s_mov_b32 s74, 0x0f00f000
    s_mov_b32 s75, 0x0f00f000
    v_lshrrev_b32 v38, 2, v37
    v_lshl_add_u32 v161, v38, 4, v37
    v_lshlrev_b32 v161, 2, v161
    s_lshl_b32 s86, s3, 12
    s_add_u32 s86, s86, 131072
    v_lshl_add_u32 v162, v0, 4, s86
    v_xor_b32 v163, 0x4000, v162
    s_lshl_b32 s86, s52, 7
    v_lshl_add_u32 v36, v36, 3, s86
    s_lshl_b32 s87, s53, 15
    s_add_u32 s87, s87, s86
    s_lshl_b32 s86, s62, 6
    s_add_u32 s87, s87, s86
    v_lshl_add_u32 v39, v37, 11, s87
    v_and_b32 v38, 48, v0
    v_add_u32 v39, v39, v38
    v_xor_b32 v37, 0x8000, v39
    buffer_load_dwordx4 v[136:139], v39, s[8:11], 0 offen
    buffer_load_dwordx4 v[140:143], v37, s[8:11], 0 offen
    buffer_load_dwordx2 v[148:149], v36, s[40:43], 0 offen offset:0
    buffer_load_dwordx2 v[150:151], v36, s[40:43], 0 offen offset:32
    buffer_load_dwordx2 v[152:153], v36, s[40:43], 0 offen offset:64
    buffer_load_dwordx2 v[154:155], v36, s[40:43], 0 offen offset:96
    s_barrier
    ds_read_b128 v[40:43], v11 offset:0
    ds_read_b128 v[44:47], v11 offset:1024
    ds_read_b128 v[48:51], v11 offset:2048
    v_mov_b32 v38, 135200
    ds_read_b32 v38, v38
    s_mov_b32 s86, 0x8000
    s_mov_b32 s87, 0x10000
    s_mov_b32 s88, 0x18000
    s_waitcnt lgkmcnt(0)
    v_mfma_f32_16x16x32_bf16 v[216:219], v[48:51], v[192:195], 0
    v_mfma_f32_16x16x32_bf16 v[208:211], v[40:43], v[192:195], 0
    v_mfma_f32_16x16x32_bf16 v[212:215], v[44:47], v[192:195], 0
    v_mfma_f32_16x16x32_bf16 v[228:231], v[48:51], v[196:199], 0
    v_mfma_f32_16x16x32_bf16 v[220:223], v[40:43], v[196:199], 0
    v_mfma_f32_16x16x32_bf16 v[224:227], v[44:47], v[196:199], 0
    v_mfma_f32_16x16x32_bf16 v[240:243], v[48:51], v[200:203], 0
    v_mfma_f32_16x16x32_bf16 v[232:235], v[40:43], v[200:203], 0
    v_mfma_f32_16x16x32_bf16 v[236:239], v[44:47], v[200:203], 0
    v_mfma_f32_16x16x32_bf16 v[252:255], v[48:51], v[204:207], 0
    v_mfma_f32_16x16x32_bf16 v[244:247], v[40:43], v[204:207], 0
    v_mfma_f32_16x16x32_bf16 v[248:251], v[44:47], v[204:207], 0
    v_add_f32 v216, s54, v216
    v_rcp_f32 v216, v216
    s_nop 0
    v_pk_mul_f32 v[208:209], v[208:209], v[216:217] op_sel_hi:[1,0]
    v_pk_mul_f32 v[210:211], v[210:211], v[216:217] op_sel_hi:[1,0]
    v_pk_mul_f32 v[212:213], v[212:213], v[216:217] op_sel_hi:[1,0]
    v_pk_mul_f32 v[214:215], v[214:215], v[216:217] op_sel_hi:[1,0]
    v_cvt_pk_bf16_f32 v60, v208, v209
    v_cvt_pk_bf16_f32 v61, v210, v211
    v_cvt_pk_bf16_f32 v62, v212, v213
    v_cvt_pk_bf16_f32 v63, v214, v215
    buffer_store_dwordx4 v[60:63], v10, s[16:19], 0 offen sc1
    v_add_f32 v228, s54, v228
    v_rcp_f32 v228, v228
    s_nop 0
    v_pk_mul_f32 v[220:221], v[220:221], v[228:229] op_sel_hi:[1,0]
    v_pk_mul_f32 v[222:223], v[222:223], v[228:229] op_sel_hi:[1,0]
    v_pk_mul_f32 v[224:225], v[224:225], v[228:229] op_sel_hi:[1,0]
    v_pk_mul_f32 v[226:227], v[226:227], v[228:229] op_sel_hi:[1,0]
    v_cvt_pk_bf16_f32 v64, v220, v221
    v_cvt_pk_bf16_f32 v65, v222, v223
    v_cvt_pk_bf16_f32 v66, v224, v225
    v_cvt_pk_bf16_f32 v67, v226, v227
    buffer_store_dwordx4 v[64:67], v10, s[16:19], s86 offen sc1
    v_add_f32 v240, s54, v240
    v_rcp_f32 v240, v240
    s_nop 0
    v_pk_mul_f32 v[232:233], v[232:233], v[240:241] op_sel_hi:[1,0]
    v_pk_mul_f32 v[234:235], v[234:235], v[240:241] op_sel_hi:[1,0]
    v_pk_mul_f32 v[236:237], v[236:237], v[240:241] op_sel_hi:[1,0]
    v_pk_mul_f32 v[238:239], v[238:239], v[240:241] op_sel_hi:[1,0]
    v_cvt_pk_bf16_f32 v68, v232, v233
    v_cvt_pk_bf16_f32 v69, v234, v235
    v_cvt_pk_bf16_f32 v70, v236, v237
    v_cvt_pk_bf16_f32 v71, v238, v239
    buffer_store_dwordx4 v[68:71], v10, s[16:19], s87 offen sc1
    v_add_f32 v252, s54, v252
    v_rcp_f32 v252, v252
    s_nop 0
    v_pk_mul_f32 v[244:245], v[244:245], v[252:253] op_sel_hi:[1,0]
    v_pk_mul_f32 v[246:247], v[246:247], v[252:253] op_sel_hi:[1,0]
    v_pk_mul_f32 v[248:249], v[248:249], v[252:253] op_sel_hi:[1,0]
    v_pk_mul_f32 v[250:251], v[250:251], v[252:253] op_sel_hi:[1,0]
    v_cvt_pk_bf16_f32 v72, v244, v245
    v_cvt_pk_bf16_f32 v73, v246, v247
    v_cvt_pk_bf16_f32 v74, v248, v249
    v_cvt_pk_bf16_f32 v75, v250, v251
    buffer_store_dwordx4 v[72:75], v10, s[16:19], s88 offen sc1
    buffer_atomic_swap v17, v18, s[16:19], 0 offen sc1
    v_mov_b32 v8, 0
    buffer_atomic_or v8, v159, s[16:19], 0 offen sc0 sc1
    v_mov_b32 v14, 2147483648
    v_mov_b32 v11, 2147483648
    s_waitcnt vmcnt(6)
    v_bfe_u32 v36, v0, 2, 1
    v_cmp_eq_u32 vcc, 1, v36
    v_mov_b32 v36, s95
    s_nop 0
    v_cndmask_b32 v148, v36, v148, vcc
    v_cndmask_b32 v149, v36, v149, vcc
    v_cndmask_b32 v150, v36, v150, vcc
    v_cndmask_b32 v151, v36, v151, vcc
    v_cndmask_b32 v152, v36, v152, vcc
    v_cndmask_b32 v153, v36, v153, vcc
    v_cndmask_b32 v154, v36, v154, vcc
    v_cndmask_b32 v155, v36, v155, vcc
    v_readfirstlane_b32 s57, v38
L_phaseB:
    v_lshrrev_b32 v1, 4, v0
    v_and_b32 v2, 15, v0
    v_mov_b32 v3, 0x3f80
    s_lshl_b32 s87, s53, 4
    v_add_u32 v6, s87, v2
    s_lshl_b32 s86, s52, 7
    v_lshl_add_u32 v5, v6, 11, s86
    v_sub_u32 v6, 2047, v6
    v_mov_b32 v7, v39
    v_lshrrev_b32 v9, 1, v1
    v_lshl_add_u32 v5, v9, 4, v5
    v_and_b32 v9, 1, v1
    v_lshl_add_u32 v5, v9, 5, v5
    s_mov_b32 s67, 0
    s_mov_b32 s66, 0xffffaaaa
    s_mov_b32 s63, 0
L_b_init:
    v_bfe_u32 v9, v0, 3, 1
    v_bfe_u32 v10, v0, 4, 1
    v_xor_b32 v9, v9, v10
    v_bfe_u32 v10, v0, 1, 2
    v_lshl_add_u32 v9, v9, 3, v10
    v_lshrrev_b32 v10, 5, v0
    v_lshl_add_u32 v9, v10, 2, v9
    v_and_b32 v10, 1, v0
    v_lshlrev_b32 v10, 4, v10
    v_lshlrev_b32 v10, v10, v3
    v_cmp_eq_u32 vcc, 0, v9
    s_nop 1
    v_cndmask_b32 v128, 0, v10, vcc
    v_cmp_eq_u32 vcc, 1, v9
    s_nop 1
    v_cndmask_b32 v129, 0, v10, vcc
    v_cmp_eq_u32 vcc, 2, v9
    s_nop 1
    v_cndmask_b32 v130, 0, v10, vcc
    v_cmp_eq_u32 vcc, 3, v9
    s_nop 1
    v_cndmask_b32 v131, 0, v10, vcc
    v_cmp_eq_u32 vcc, 4, v9
    s_nop 1
    v_cndmask_b32 v132, 0, v10, vcc
    v_cmp_eq_u32 vcc, 5, v9
    s_nop 1
    v_cndmask_b32 v133, 0, v10, vcc
    v_cmp_eq_u32 vcc, 6, v9
    s_nop 1
    v_cndmask_b32 v134, 0, v10, vcc
    v_cmp_eq_u32 vcc, 7, v9
    s_nop 1
    v_cndmask_b32 v135, 0, v10, vcc
    v_mov_b32 v80, 0
    v_mov_b32 v81, 0
    v_mov_b32 v82, 0
    v_mov_b32 v83, 0
    v_mov_b32 v84, 0
    v_mov_b32 v85, 0
    v_mov_b32 v86, 0
    v_mov_b32 v87, 0
    v_mov_b32 v88, 0
    v_mov_b32 v89, 0
    v_mov_b32 v90, 0
    v_mov_b32 v91, 0
    v_mov_b32 v92, 0
    v_mov_b32 v93, 0
    v_mov_b32 v94, 0
    v_mov_b32 v95, 0
    v_mov_b32 v96, 0
    v_mov_b32 v97, 0
    v_mov_b32 v98, 0
    v_mov_b32 v99, 0
    v_mov_b32 v100, 0
    v_mov_b32 v101, 0
    v_mov_b32 v102, 0
    v_mov_b32 v103, 0
    v_mov_b32 v104, 0
    v_mov_b32 v105, 0
    v_mov_b32 v106, 0
    v_mov_b32 v107, 0
    v_mov_b32 v108, 0
    v_mov_b32 v109, 0
    v_mov_b32 v110, 0
    v_mov_b32 v111, 0
    v_mov_b32 v156, 0
    s_branch L_b_w0
L_b_r0:
    s_ff1_i32_b32 s91, s65
    s_bitset0_b32 s65, s91
    s_lshl_b32 s76, s91, 12
    s_lshl_b32 s91, s91, 10
    buffer_load_dwordx4 v[16:19], v157, s[16:19], s91 offen offset:0 sc1
    buffer_load_dwordx4 v[20:23], v158, s[16:19], s91 offen offset:0 sc1
    buffer_load_dwordx4 v[24:27], v157, s[16:19], s91 offen offset:1024 sc1
    buffer_load_dwordx4 v[28:31], v158, s[16:19], s91 offen offset:1024 sc1
    s_cmp_eq_u32 s65, 0
    s_cbranch_scc1 L_b_p1
L_b_r1:
    s_ff1_i32_b32 s91, s65
    s_bitset0_b32 s65, s91
    s_lshl_b32 s77, s91, 12
    s_lshl_b32 s91, s91, 10
    buffer_load_dwordx4 v[32:35], v157, s[16:19], s91 offen offset:0 sc1
    buffer_load_dwordx4 v[36:39], v158, s[16:19], s91 offen offset:0 sc1
    buffer_load_dwordx4 v[40:43], v157, s[16:19], s91 offen offset:1024 sc1
    buffer_load_dwordx4 v[44:47], v158, s[16:19], s91 offen offset:1024 sc1
    s_xor_b32 s89, s67, s76
    s_mov_b32 s67, s76
    v_xor_b32 v144, s89, v144
    ds_read_b64_tr_b16 v[112:113], v144 offset:0
    ds_read_b64_tr_b16 v[114:115], v144 offset:2048
    v_xor_b32 v145, s89, v145
    ds_read_b64_tr_b16 v[116:117], v145 offset:0
    ds_read_b64_tr_b16 v[118:119], v145 offset:2048
    v_xor_b32 v146, s89, v146
    ds_read_b64_tr_b16 v[120:121], v146 offset:0
    ds_read_b64_tr_b16 v[122:123], v146 offset:2048
    v_xor_b32 v147, s89, v147
    ds_read_b64_tr_b16 v[124:125], v147 offset:0
    ds_read_b64_tr_b16 v[126:127], v147 offset:2048
    s_cmp_eq_u32 s62, 0
    s_cbranch_scc0 L_b_x1
    v_mfma_f32_16x16x32_bf16 v[80:83], v[128:131], v[136:139], 0
    v_mfma_f32_16x16x32_bf16 v[96:99], v[128:131], v[140:143], 0
    v_mfma_f32_16x16x32_bf16 v[84:87], v[132:135], v[136:139], 0
    v_mfma_f32_16x16x32_bf16 v[100:103], v[132:135], v[140:143], 0
    s_branch L_b_xd
L_b_x1:
    v_mfma_f32_16x16x32_bf16 v[88:91], v[128:131], v[136:139], 0
    v_mfma_f32_16x16x32_bf16 v[104:107], v[128:131], v[140:143], 0
    v_mfma_f32_16x16x32_bf16 v[92:95], v[132:135], v[136:139], 0
    v_mfma_f32_16x16x32_bf16 v[108:111], v[132:135], v[140:143], 0
L_b_xd:
    s_waitcnt vmcnt(6) lgkmcnt(6)
    v_max3_u32 v156, v156, v19, v23
    v_mfma_f32_16x16x32_bf16 v[80:83], v[112:115], v[16:19], v[80:83]
    ds_read_b64_tr_b16 v[128:129], v144 offset:4096
    v_mfma_f32_16x16x32_bf16 v[96:99], v[112:115], v[20:23], v[96:99]
    ds_read_b64_tr_b16 v[130:131], v144 offset:6144
    s_waitcnt lgkmcnt(6)
    v_mfma_f32_16x16x32_bf16 v[84:87], v[116:119], v[16:19], v[84:87]
    ds_read_b64_tr_b16 v[132:133], v145 offset:4096
    v_mfma_f32_16x16x32_bf16 v[100:103], v[116:119], v[20:23], v[100:103]
    ds_read_b64_tr_b16 v[134:135], v145 offset:6144
    s_waitcnt lgkmcnt(6)
    v_mfma_f32_16x16x32_bf16 v[88:91], v[120:123], v[16:19], v[88:91]
    ds_read_b64_tr_b16 v[136:137], v146 offset:4096
    v_mfma_f32_16x16x32_bf16 v[104:107], v[120:123], v[20:23], v[104:107]
    ds_read_b64_tr_b16 v[138:139], v146 offset:6144
    s_waitcnt lgkmcnt(6)
    v_mfma_f32_16x16x32_bf16 v[92:95], v[124:127], v[16:19], v[92:95]
    ds_read_b64_tr_b16 v[140:141], v147 offset:4096
    v_mfma_f32_16x16x32_bf16 v[108:111], v[124:127], v[20:23], v[108:111]
    ds_read_b64_tr_b16 v[142:143], v147 offset:6144
    s_cmp_eq_u32 s65, 0
    s_cbranch_scc1 L_b_p2
L_b_r2:
    s_ff1_i32_b32 s91, s65
    s_bitset0_b32 s65, s91
    s_lshl_b32 s78, s91, 12
    s_lshl_b32 s91, s91, 10
    buffer_load_dwordx4 v[48:51], v157, s[16:19], s91 offen offset:0 sc1
    buffer_load_dwordx4 v[52:55], v158, s[16:19], s91 offen offset:0 sc1
    s_waitcnt vmcnt(6) lgkmcnt(6)
    v_max3_u32 v156, v156, v27, v31
    v_mfma_f32_16x16x32_bf16 v[80:83], v[128:131], v[24:27], v[80:83]
    s_xor_b32 s89, s67, s77
    s_mov_b32 s67, s77
    v_xor_b32 v144, s89, v144
    ds_read_b64_tr_b16 v[112:113], v144 offset:0
    v_mfma_f32_16x16x32_bf16 v[96:99], v[128:131], v[28:31], v[96:99]
    ds_read_b64_tr_b16 v[114:115], v144 offset:2048
    s_waitcnt lgkmcnt(6)
    v_mfma_f32_16x16x32_bf16 v[84:87], v[132:135], v[24:27], v[84:87]
    v_xor_b32 v145, s89, v145
    ds_read_b64_tr_b16 v[116:117], v145 offset:0
    v_mfma_f32_16x16x32_bf16 v[100:103], v[132:135], v[28:31], v[100:103]
    ds_read_b64_tr_b16 v[118:119], v145 offset:2048
    s_waitcnt lgkmcnt(6)
    v_mfma_f32_16x16x32_bf16 v[88:91], v[136:139], v[24:27], v[88:91]
    v_xor_b32 v146, s89, v146
    ds_read_b64_tr_b16 v[120:121], v146 offset:0
    v_mfma_f32_16x16x32_bf16 v[104:107], v[136:139], v[28:31], v[104:107]
    ds_read_b64_tr_b16 v[122:123], v146 offset:2048
    s_waitcnt lgkmcnt(6)
    v_mfma_f32_16x16x32_bf16 v[92:95], v[140:143], v[24:27], v[92:95]
    v_xor_b32 v147, s89, v147
    ds_read_b64_tr_b16 v[124:125], v147 offset:0
    v_mfma_f32_16x16x32_bf16 v[108:111], v[140:143], v[28:31], v[108:111]
    ds_read_b64_tr_b16 v[126:127], v147 offset:2048
    buffer_load_dwordx4 v[56:59], v157, s[16:19], s91 offen offset:1024 sc1
    buffer_load_dwordx4 v[60:63], v158, s[16:19], s91 offen offset:1024 sc1
    s_waitcnt vmcnt(6) lgkmcnt(6)
    v_max3_u32 v156, v156, v35, v39
    v_mfma_f32_16x16x32_bf16 v[80:83], v[112:115], v[32:35], v[80:83]
    ds_read_b64_tr_b16 v[128:129], v144 offset:4096
    v_mfma_f32_16x16x32_bf16 v[96:99], v[112:115], v[36:39], v[96:99]
    ds_read_b64_tr_b16 v[130:131], v144 offset:6144
    s_waitcnt lgkmcnt(6)
    v_mfma_f32_16x16x32_bf16 v[84:87], v[116:119], v[32:35], v[84:87]
    ds_read_b64_tr_b16 v[132:133], v145 offset:4096
    v_mfma_f32_16x16x32_bf16 v[100:103], v[116:119], v[36:39], v[100:103]
    ds_read_b64_tr_b16 v[134:135], v145 offset:6144
    s_waitcnt lgkmcnt(6)
    v_mfma_f32_16x16x32_bf16 v[88:91], v[120:123], v[32:35], v[88:91]
    ds_read_b64_tr_b16 v[136:137], v146 offset:4096
    v_mfma_f32_16x16x32_bf16 v[104:107], v[120:123], v[36:39], v[104:107]
    ds_read_b64_tr_b16 v[138:139], v146 offset:6144
    s_waitcnt lgkmcnt(6)
    v_mfma_f32_16x16x32_bf16 v[92:95], v[124:127], v[32:35], v[92:95]
    ds_read_b64_tr_b16 v[140:141], v147 offset:4096
    v_mfma_f32_16x16x32_bf16 v[108:111], v[124:127], v[36:39], v[108:111]
    ds_read_b64_tr_b16 v[142:143], v147 offset:6144
    s_cmp_eq_u32 s65, 0
    s_cbranch_scc1 L_b_p3
L_b_r3:
    s_ff1_i32_b32 s91, s65
    s_bitset0_b32 s65, s91
    s_lshl_b32 s79, s91, 12
    s_lshl_b32 s91, s91, 10
    buffer_load_dwordx4 v[64:67], v157, s[16:19], s91 offen offset:0 sc1
    buffer_load_dwordx4 v[68:71], v158, s[16:19], s91 offen offset:0 sc1
    s_waitcnt vmcnt(6) lgkmcnt(6)
    v_max3_u32 v156, v156, v43, v47
    v_mfma_f32_16x16x32_bf16 v[80:83], v[128:131], v[40:43], v[80:83]
    s_xor_b32 s89, s67, s78
    s_mov_b32 s67, s78
    v_xor_b32 v144, s89, v144
    ds_read_b64_tr_b16 v[112:113], v144 offset:0
    v_mfma_f32_16x16x32_bf16 v[96:99], v[128:131], v[44:47], v[96:99]
    ds_read_b64_tr_b16 v[114:115], v144 offset:2048
    s_waitcnt lgkmcnt(6)
    v_mfma_f32_16x16x32_bf16 v[84:87], v[132:135], v[40:43], v[84:87]
    v_xor_b32 v145, s89, v145
    ds_read_b64_tr_b16 v[116:117], v145 offset:0
    v_mfma_f32_16x16x32_bf16 v[100:103], v[132:135], v[44:47], v[100:103]
    ds_read_b64_tr_b16 v[118:119], v145 offset:2048
    s_waitcnt lgkmcnt(6)
    v_mfma_f32_16x16x32_bf16 v[88:91], v[136:139], v[40:43], v[88:91]
    v_xor_b32 v146, s89, v146
    ds_read_b64_tr_b16 v[120:121], v146 offset:0
    v_mfma_f32_16x16x32_bf16 v[104:107], v[136:139], v[44:47], v[104:107]
    ds_read_b64_tr_b16 v[122:123], v146 offset:2048
    s_waitcnt lgkmcnt(6)
    v_mfma_f32_16x16x32_bf16 v[92:95], v[140:143], v[40:43], v[92:95]
    v_xor_b32 v147, s89, v147
    ds_read_b64_tr_b16 v[124:125], v147 offset:0
    v_mfma_f32_16x16x32_bf16 v[108:111], v[140:143], v[44:47], v[108:111]
    ds_read_b64_tr_b16 v[126:127], v147 offset:2048
    buffer_load_dwordx4 v[72:75], v157, s[16:19], s91 offen offset:1024 sc1
    buffer_load_dwordx4 v[76:79], v158, s[16:19], s91 offen offset:1024 sc1
    s_waitcnt vmcnt(6) lgkmcnt(6)
    v_max3_u32 v156, v156, v51, v55
    v_mfma_f32_16x16x32_bf16 v[80:83], v[112:115], v[48:51], v[80:83]
    ds_read_b64_tr_b16 v[128:129], v144 offset:4096
    v_mfma_f32_16x16x32_bf16 v[96:99], v[112:115], v[52:55], v[96:99]
    ds_read_b64_tr_b16 v[130:131], v144 offset:6144
    s_waitcnt lgkmcnt(6)
    v_mfma_f32_16x16x32_bf16 v[84:87], v[116:119], v[48:51], v[84:87]
    ds_read_b64_tr_b16 v[132:133], v145 offset:4096
    v_mfma_f32_16x16x32_bf16 v[100:103], v[116:119], v[52:55], v[100:103]
    ds_read_b64_tr_b16 v[134:135], v145 offset:6144
    s_waitcnt lgkmcnt(6)
    v_mfma_f32_16x16x32_bf16 v[88:91], v[120:123], v[48:51], v[88:91]
    ds_read_b64_tr_b16 v[136:137], v146 offset:4096
    v_mfma_f32_16x16x32_bf16 v[104:107], v[120:123], v[52:55], v[104:107]
    ds_read_b64_tr_b16 v[138:139], v146 offset:6144
    s_waitcnt lgkmcnt(6)
    v_mfma_f32_16x16x32_bf16 v[92:95], v[124:127], v[48:51], v[92:95]
    ds_read_b64_tr_b16 v[140:141], v147 offset:4096
    v_mfma_f32_16x16x32_bf16 v[108:111], v[124:127], v[52:55], v[108:111]
    ds_read_b64_tr_b16 v[142:143], v147 offset:6144
    s_cmp_eq_u32 s65, 0
    s_cbranch_scc1 L_b_p4
L_b_r4:
    s_ff1_i32_b32 s91, s65
    s_bitset0_b32 s65, s91
    s_lshl_b32 s76, s91, 12
    s_lshl_b32 s91, s91, 10
    buffer_load_dwordx4 v[16:19], v157, s[16:19], s91 offen offset:0 sc1
    buffer_load_dwordx4 v[20:23], v158, s[16:19], s91 offen offset:0 sc1
    s_waitcnt vmcnt(6) lgkmcnt(6)
    v_max3_u32 v156, v156, v59, v63
    v_mfma_f32_16x16x32_bf16 v[80:83], v[128:131], v[56:59], v[80:83]
    s_xor_b32 s89, s67, s79
    s_mov_b32 s67, s79
    v_xor_b32 v144, s89, v144
    ds_read_b64_tr_b16 v[112:113], v144 offset:0
    v_mfma_f32_16x16x32_bf16 v[96:99], v[128:131], v[60:63], v[96:99]
    ds_read_b64_tr_b16 v[114:115], v144 offset:2048
    s_waitcnt lgkmcnt(6)
    v_mfma_f32_16x16x32_bf16 v[84:87], v[132:135], v[56:59], v[84:87]
    v_xor_b32 v145, s89, v145
    ds_read_b64_tr_b16 v[116:117], v145 offset:0
    v_mfma_f32_16x16x32_bf16 v[100:103], v[132:135], v[60:63], v[100:103]
    ds_read_b64_tr_b16 v[118:119], v145 offset:2048
    s_waitcnt lgkmcnt(6)
    v_mfma_f32_16x16x32_bf16 v[88:91], v[136:139], v[56:59], v[88:91]
    v_xor_b32 v146, s89, v146
    ds_read_b64_tr_b16 v[120:121], v146 offset:0
    v_mfma_f32_16x16x32_bf16 v[104:107], v[136:139], v[60:63], v[104:107]
    ds_read_b64_tr_b16 v[122:123], v146 offset:2048
    s_waitcnt lgkmcnt(6)
    v_mfma_f32_16x16x32_bf16 v[92:95], v[140:143], v[56:59], v[92:95]
    v_xor_b32 v147, s89, v147
    ds_read_b64_tr_b16 v[124:125], v147 offset:0
    v_mfma_f32_16x16x32_bf16 v[108:111], v[140:143], v[60:63], v[108:111]
    ds_read_b64_tr_b16 v[126:127], v147 offset:2048
    buffer_load_dwordx4 v[24:27], v157, s[16:19], s91 offen offset:1024 sc1
    buffer_load_dwordx4 v[28:31], v158, s[16:19], s91 offen offset:1024 sc1
    s_waitcnt vmcnt(6) lgkmcnt(6)
    v_max3_u32 v156, v156, v67, v71
    v_mfma_f32_16x16x32_bf16 v[80:83], v[112:115], v[64:67], v[80:83]
    ds_read_b64_tr_b16 v[128:129], v144 offset:4096
    v_mfma_f32_16x16x32_bf16 v[96:99], v[112:115], v[68:71], v[96:99]
    ds_read_b64_tr_b16 v[130:131], v144 offset:6144
    s_waitcnt lgkmcnt(6)
    v_mfma_f32_16x16x32_bf16 v[84:87], v[116:119], v[64:67], v[84:87]
    ds_read_b64_tr_b16 v[132:133], v145 offset:4096
    v_mfma_f32_16x16x32_bf16 v[100:103], v[116:119], v[68:71], v[100:103]
    ds_read_b64_tr_b16 v[134:135], v145 offset:6144
    s_waitcnt lgkmcnt(6)
    v_mfma_f32_16x16x32_bf16 v[88:91], v[120:123], v[64:67], v[88:91]
    ds_read_b64_tr_b16 v[136:137], v146 offset:4096
    v_mfma_f32_16x16x32_bf16 v[104:107], v[120:123], v[68:71], v[104:107]
    ds_read_b64_tr_b16 v[138:139], v146 offset:6144
    s_waitcnt lgkmcnt(6)
    v_mfma_f32_16x16x32_bf16 v[92:95], v[124:127], v[64:67], v[92:95]
    ds_read_b64_tr_b16 v[140:141], v147 offset:4096
    v_mfma_f32_16x16x32_bf16 v[108:111], v[124:127], v[68:71], v[108:111]
    ds_read_b64_tr_b16 v[142:143], v147 offset:6144
    s_cmp_eq_u32 s65, 0
    s_cbranch_scc1 L_b_p5
L_b_r5:
    s_ff1_i32_b32 s91, s65
    s_bitset0_b32 s65, s91
    s_lshl_b32 s77, s91, 12
    s_lshl_b32 s91, s91, 10
    buffer_load_dwordx4 v[32:35], v157, s[16:19], s91 offen offset:0 sc1
    buffer_load_dwordx4 v[36:39], v158, s[16:19], s91 offen offset:0 sc1
    s_waitcnt vmcnt(6) lgkmcnt(6)
    v_max3_u32 v156, v156, v75, v79
    v_mfma_f32_16x16x32_bf16 v[80:83], v[128:131], v[72:75], v[80:83]
    s_xor_b32 s89, s67, s76
    s_mov_b32 s67, s76
    v_xor_b32 v144, s89, v144
    ds_read_b64_tr_b16 v[112:113], v144 offset:0
    v_mfma_f32_16x16x32_bf16 v[96:99], v[128:131], v[76:79], v[96:99]
    ds_read_b64_tr_b16 v[114:115], v144 offset:2048
    s_waitcnt lgkmcnt(6)
    v_mfma_f32_16x16x32_bf16 v[84:87], v[132:135], v[72:75], v[84:87]
    v_xor_b32 v145, s89, v145
    ds_read_b64_tr_b16 v[116:117], v145 offset:0
    v_mfma_f32_16x16x32_bf16 v[100:103], v[132:135], v[76:79], v[100:103]
    ds_read_b64_tr_b16 v[118:119], v145 offset:2048
    s_waitcnt lgkmcnt(6)
    v_mfma_f32_16x16x32_bf16 v[88:91], v[136:139], v[72:75], v[88:91]
    v_xor_b32 v146, s89, v146
    ds_read_b64_tr_b16 v[120:121], v146 offset:0
    v_mfma_f32_16x16x32_bf16 v[104:107], v[136:139], v[76:79], v[104:107]
    ds_read_b64_tr_b16 v[122:123], v146 offset:2048
    s_waitcnt lgkmcnt(6)
    v_mfma_f32_16x16x32_bf16 v[92:95], v[140:143], v[72:75], v[92:95]
    v_xor_b32 v147, s89, v147
    ds_read_b64_tr_b16 v[124:125], v147 offset:0
    v_mfma_f32_16x16x32_bf16 v[108:111], v[140:143], v[76:79], v[108:111]
    ds_read_b64_tr_b16 v[126:127], v147 offset:2048
    buffer_load_dwordx4 v[40:43], v157, s[16:19], s91 offen offset:1024 sc1
    buffer_load_dwordx4 v[44:47], v158, s[16:19], s91 offen offset:1024 sc1
    s_waitcnt vmcnt(6) lgkmcnt(6)
    v_max3_u32 v156, v156, v19, v23
    v_mfma_f32_16x16x32_bf16 v[80:83], v[112:115], v[16:19], v[80:83]
    ds_read_b64_tr_b16 v[128:129], v144 offset:4096
    v_mfma_f32_16x16x32_bf16 v[96:99], v[112:115], v[20:23], v[96:99]
    ds_read_b64_tr_b16 v[130:131], v144 offset:6144
    s_waitcnt lgkmcnt(6)
    v_mfma_f32_16x16x32_bf16 v[84:87], v[116:119], v[16:19], v[84:87]
    ds_read_b64_tr_b16 v[132:133], v145 offset:4096
    v_mfma_f32_16x16x32_bf16 v[100:103], v[116:119], v[20:23], v[100:103]
    ds_read_b64_tr_b16 v[134:135], v145 offset:6144
    s_waitcnt lgkmcnt(6)
    v_mfma_f32_16x16x32_bf16 v[88:91], v[120:123], v[16:19], v[88:91]
    ds_read_b64_tr_b16 v[136:137], v146 offset:4096
    v_mfma_f32_16x16x32_bf16 v[104:107], v[120:123], v[20:23], v[104:107]
    ds_read_b64_tr_b16 v[138:139], v146 offset:6144
    s_waitcnt lgkmcnt(6)
    v_mfma_f32_16x16x32_bf16 v[92:95], v[124:127], v[16:19], v[92:95]
    ds_read_b64_tr_b16 v[140:141], v147 offset:4096
    v_mfma_f32_16x16x32_bf16 v[108:111], v[124:127], v[20:23], v[108:111]
    ds_read_b64_tr_b16 v[142:143], v147 offset:6144
    s_cmp_eq_u32 s65, 0
    s_cbranch_scc1 L_b_p6
L_b_r6:
    s_ff1_i32_b32 s91, s65
    s_bitset0_b32 s65, s91
    s_lshl_b32 s78, s91, 12
    s_lshl_b32 s91, s91, 10
    buffer_load_dwordx4 v[48:51], v157, s[16:19], s91 offen offset:0 sc1
    buffer_load_dwordx4 v[52:55], v158, s[16:19], s91 offen offset:0 sc1
    s_waitcnt vmcnt(6) lgkmcnt(6)
    v_max3_u32 v156, v156, v27, v31
    v_mfma_f32_16x16x32_bf16 v[80:83], v[128:131], v[24:27], v[80:83]
    s_xor_b32 s89, s67, s77
    s_mov_b32 s67, s77
    v_xor_b32 v144, s89, v144
    ds_read_b64_tr_b16 v[112:113], v144 offset:0
    v_mfma_f32_16x16x32_bf16 v[96:99], v[128:131], v[28:31], v[96:99]
    ds_read_b64_tr_b16 v[114:115], v144 offset:2048
    s_waitcnt lgkmcnt(6)
    v_mfma_f32_16x16x32_bf16 v[84:87], v[132:135], v[24:27], v[84:87]
    v_xor_b32 v145, s89, v145
    ds_read_b64_tr_b16 v[116:117], v145 offset:0
    v_mfma_f32_16x16x32_bf16 v[100:103], v[132:135], v[28:31], v[100:103]
    ds_read_b64_tr_b16 v[118:119], v145 offset:2048
    s_waitcnt lgkmcnt(6)
    v_mfma_f32_16x16x32_bf16 v[88:91], v[136:139], v[24:27], v[88:91]
    v_xor_b32 v146, s89, v146
    ds_read_b64_tr_b16 v[120:121], v146 offset:0
    v_mfma_f32_16x16x32_bf16 v[104:107], v[136:139], v[28:31], v[104:107]
    ds_read_b64_tr_b16 v[122:123], v146 offset:2048
    s_waitcnt lgkmcnt(6)
    v_mfma_f32_16x16x32_bf16 v[92:95], v[140:143], v[24:27], v[92:95]
    v_xor_b32 v147, s89, v147
    ds_read_b64_tr_b16 v[124:125], v147 offset:0
    v_mfma_f32_16x16x32_bf16 v[108:111], v[140:143], v[28:31], v[108:111]
    ds_read_b64_tr_b16 v[126:127], v147 offset:2048
    buffer_load_dwordx4 v[56:59], v157, s[16:19], s91 offen offset:1024 sc1
    buffer_load_dwordx4 v[60:63], v158, s[16:19], s91 offen offset:1024 sc1
    s_waitcnt vmcnt(6) lgkmcnt(6)
    v_max3_u32 v156, v156, v35, v39
    v_mfma_f32_16x16x32_bf16 v[80:83], v[112:115], v[32:35], v[80:83]
    ds_read_b64_tr_b16 v[128:129], v144 offset:4096
    v_mfma_f32_16x16x32_bf16 v[96:99], v[112:115], v[36:39], v[96:99]
    ds_read_b64_tr_b16 v[130:131], v144 offset:6144
    s_waitcnt lgkmcnt(6)
    v_mfma_f32_16x16x32_bf16 v[84:87], v[116:119], v[32:35], v[84:87]
    ds_read_b64_tr_b16 v[132:133], v145 offset:4096
    v_mfma_f32_16x16x32_bf16 v[100:103], v[116:119], v[36:39], v[100:103]
    ds_read_b64_tr_b16 v[134:135], v145 offset:6144
    s_waitcnt lgkmcnt(6)
    v_mfma_f32_16x16x32_bf16 v[88:91], v[120:123], v[32:35], v[88:91]
    ds_read_b64_tr_b16 v[136:137], v146 offset:4096
    v_mfma_f32_16x16x32_bf16 v[104:107], v[120:123], v[36:39], v[104:107]
    ds_read_b64_tr_b16 v[138:139], v146 offset:6144
    s_waitcnt lgkmcnt(6)
    v_mfma_f32_16x16x32_bf16 v[92:95], v[124:127], v[32:35], v[92:95]
    ds_read_b64_tr_b16 v[140:141], v147 offset:4096
    v_mfma_f32_16x16x32_bf16 v[108:111], v[124:127], v[36:39], v[108:111]
    ds_read_b64_tr_b16 v[142:143], v147 offset:6144
    s_cmp_eq_u32 s65, 0
    s_cbranch_scc1 L_b_p7
L_b_r7:
    s_ff1_i32_b32 s91, s65
    s_bitset0_b32 s65, s91
    s_lshl_b32 s79, s91, 12
    s_lshl_b32 s91, s91, 10
    buffer_load_dwordx4 v[64:67], v157, s[16:19], s91 offen offset:0 sc1
    buffer_load_dwordx4 v[68:71], v158, s[16:19], s91 offen offset:0 sc1
    s_waitcnt vmcnt(6) lgkmcnt(6)
    v_max3_u32 v156, v156, v43, v47
    v_mfma_f32_16x16x32_bf16 v[80:83], v[128:131], v[40:43], v[80:83]
    s_xor_b32 s89, s67, s78
    s_mov_b32 s67, s78
    v_xor_b32 v144, s89, v144
    ds_read_b64_tr_b16 v[112:113], v144 offset:0
    v_mfma_f32_16x16x32_bf16 v[96:99], v[128:131], v[44:47], v[96:99]
    ds_read_b64_tr_b16 v[114:115], v144 offset:2048
    s_waitcnt lgkmcnt(6)
    v_mfma_f32_16x16x32_bf16 v[84:87], v[132:135], v[40:43], v[84:87]
    v_xor_b32 v145, s89, v145
    ds_read_b64_tr_b16 v[116:117], v145 offset:0
    v_mfma_f32_16x16x32_bf16 v[100:103], v[132:135], v[44:47], v[100:103]
    ds_read_b64_tr_b16 v[118:119], v145 offset:2048
    s_waitcnt lgkmcnt(6)
    v_mfma_f32_16x16x32_bf16 v[88:91], v[136:139], v[40:43], v[88:91]
    v_xor_b32 v146, s89, v146
    ds_read_b64_tr_b16 v[120:121], v146 offset:0
    v_mfma_f32_16x16x32_bf16 v[104:107], v[136:139], v[44:47], v[104:107]
    ds_read_b64_tr_b16 v[122:123], v146 offset:2048
    s_waitcnt lgkmcnt(6)
    v_mfma_f32_16x16x32_bf16 v[92:95], v[140:143], v[40:43], v[92:95]
    v_xor_b32 v147, s89, v147
    ds_read_b64_tr_b16 v[124:125], v147 offset:0
    v_mfma_f32_16x16x32_bf16 v[108:111], v[140:143], v[44:47], v[108:111]
    ds_read_b64_tr_b16 v[126:127], v147 offset:2048
    buffer_load_dwordx4 v[72:75], v157, s[16:19], s91 offen offset:1024 sc1
    buffer_load_dwordx4 v[76:79], v158, s[16:19], s91 offen offset:1024 sc1
    s_waitcnt vmcnt(6) lgkmcnt(6)
    v_max3_u32 v156, v156, v51, v55
    v_mfma_f32_16x16x32_bf16 v[80:83], v[112:115], v[48:51], v[80:83]
    ds_read_b64_tr_b16 v[128:129], v144 offset:4096
    v_mfma_f32_16x16x32_bf16 v[96:99], v[112:115], v[52:55], v[96:99]
    ds_read_b64_tr_b16 v[130:131], v144 offset:6144
    s_mov_b32 s90, 71680
    buffer_load_dwordx4 v[204:207], v11, s[32:35], s90 offen
    s_waitcnt lgkmcnt(6)
    v_mfma_f32_16x16x32_bf16 v[84:87], v[116:119], v[48:51], v[84:87]
    ds_read_b64_tr_b16 v[132:133], v145 offset:4096
    v_mfma_f32_16x16x32_bf16 v[100:103], v[116:119], v[52:55], v[100:103]
    ds_read_b64_tr_b16 v[134:135], v145 offset:6144
    s_waitcnt lgkmcnt(6)
    v_mfma_f32_16x16x32_bf16 v[88:91], v[120:123], v[48:51], v[88:91]
    ds_read_b64_tr_b16 v[136:137], v146 offset:4096
    v_mfma_f32_16x16x32_bf16 v[104:107], v[120:123], v[52:55], v[104:107]
    ds_read_b64_tr_b16 v[138:139], v146 offset:6144
    s_mov_b32 s90, 78848
    buffer_load_dwordx4 v[208:211], v11, s[32:35], s90 offen
    s_waitcnt lgkmcnt(6)
    v_mfma_f32_16x16x32_bf16 v[92:95], v[124:127], v[48:51], v[92:95]
    ds_read_b64_tr_b16 v[140:141], v147 offset:4096
    v_mfma_f32_16x16x32_bf16 v[108:111], v[124:127], v[52:55], v[108:111]
    ds_read_b64_tr_b16 v[142:143], v147 offset:6144
    s_waitcnt vmcnt(6) lgkmcnt(6)
    v_max3_u32 v156, v156, v59, v63
    v_mfma_f32_16x16x32_bf16 v[80:83], v[128:131], v[56:59], v[80:83]
    s_xor_b32 s89, s67, s79
    s_mov_b32 s67, s79
    v_xor_b32 v144, s89, v144
    ds_read_b64_tr_b16 v[112:113], v144 offset:0
    v_mfma_f32_16x16x32_bf16 v[96:99], v[128:131], v[60:63], v[96:99]
    ds_read_b64_tr_b16 v[114:115], v144 offset:2048
    s_mov_b32 s90, 86016
    buffer_load_dwordx4 v[212:215], v11, s[32:35], s90 offen
    s_waitcnt lgkmcnt(6)
    v_mfma_f32_16x16x32_bf16 v[84:87], v[132:135], v[56:59], v[84:87]
    v_xor_b32 v145, s89, v145
    ds_read_b64_tr_b16 v[116:117], v145 offset:0
    v_mfma_f32_16x16x32_bf16 v[100:103], v[132:135], v[60:63], v[100:103]
    ds_read_b64_tr_b16 v[118:119], v145 offset:2048
    s_waitcnt lgkmcnt(6)
    v_mfma_f32_16x16x32_bf16 v[88:91], v[136:139], v[56:59], v[88:91]
    v_xor_b32 v146, s89, v146
    ds_read_b64_tr_b16 v[120:121], v146 offset:0
    v_mfma_f32_16x16x32_bf16 v[104:107], v[136:139], v[60:63], v[104:107]
    ds_read_b64_tr_b16 v[122:123], v146 offset:2048
    s_mov_b32 s90, 93184
    buffer_load_dwordx4 v[216:219], v11, s[32:35], s90 offen
    s_waitcnt lgkmcnt(6)
    v_mfma_f32_16x16x32_bf16 v[92:95], v[140:143], v[56:59], v[92:95]
    v_xor_b32 v147, s89, v147
    ds_read_b64_tr_b16 v[124:125], v147 offset:0
    v_mfma_f32_16x16x32_bf16 v[108:111], v[140:143], v[60:63], v[108:111]
    ds_read_b64_tr_b16 v[126:127], v147 offset:2048
    s_waitcnt vmcnt(6) lgkmcnt(6)
    v_max3_u32 v156, v156, v67, v71
    v_mfma_f32_16x16x32_bf16 v[80:83], v[112:115], v[64:67], v[80:83]
    ds_read_b64_tr_b16 v[128:129], v144 offset:4096
    v_mfma_f32_16x16x32_bf16 v[96:99], v[112:115], v[68:71], v[96:99]
    ds_read_b64_tr_b16 v[130:131], v144 offset:6144
    s_mov_b32 s90, 100352
    buffer_load_dwordx4 v[220:223], v11, s[32:35], s90 offen
    s_waitcnt lgkmcnt(6)
    v_mfma_f32_16x16x32_bf16 v[84:87], v[116:119], v[64:67], v[84:87]
    ds_read_b64_tr_b16 v[132:133], v145 offset:4096
    v_mfma_f32_16x16x32_bf16 v[100:103], v[116:119], v[68:71], v[100:103]
    ds_read_b64_tr_b16 v[134:135], v145 offset:6144
    s_waitcnt lgkmcnt(6)
    v_mfma_f32_16x16x32_bf16 v[88:91], v[120:123], v[64:67], v[88:91]
    ds_read_b64_tr_b16 v[136:137], v146 offset:4096
    v_mfma_f32_16x16x32_bf16 v[104:107], v[120:123], v[68:71], v[104:107]
    ds_read_b64_tr_b16 v[138:139], v146 offset:6144
    s_waitcnt lgkmcnt(6)
    v_mfma_f32_16x16x32_bf16 v[92:95], v[124:127], v[64:67], v[92:95]
    ds_read_b64_tr_b16 v[140:141], v147 offset:4096
    v_mfma_f32_16x16x32_bf16 v[108:111], v[124:127], v[68:71], v[108:111]
    ds_read_b64_tr_b16 v[142:143], v147 offset:6144
    s_waitcnt vmcnt(5) lgkmcnt(6)
    v_max3_u32 v156, v156, v75, v79
    v_cmp_eq_u32 vcc, -1, v156
    s_cbranch_vccz L_ok_3
    s_sub_u32 s56, s56, 1
    s_cbranch_scc0 L_b_restart
    s_mov_b32 s56, 0
L_ok_3:
    v_mfma_f32_16x16x32_bf16 v[80:83], v[128:131], v[72:75], v[80:83]
    v_mfma_f32_16x16x32_bf16 v[96:99], v[128:131], v[76:79], v[96:99]
    s_mov_b32 s90, 107520
    buffer_load_dwordx4 v[224:227], v11, s[32:35], s90 offen
    s_waitcnt lgkmcnt(4)
    v_mfma_f32_16x16x32_bf16 v[84:87], v[132:135], v[72:75], v[84:87]
    v_mfma_f32_16x16x32_bf16 v[100:103], v[132:135], v[76:79], v[100:103]
    s_waitcnt lgkmcnt(2)
    v_mfma_f32_16x16x32_bf16 v[88:91], v[136:139], v[72:75], v[88:91]
    v_mfma_f32_16x16x32_bf16 v[104:107], v[136:139], v[76:79], v[104:107]
    s_waitcnt lgkmcnt(0)
    v_mfma_f32_16x16x32_bf16 v[92:95], v[140:143], v[72:75], v[92:95]
    v_mfma_f32_16x16x32_bf16 v[108:111], v[140:143], v[76:79], v[108:111]
    ds_write_b128 v162, v[96:99] offset:0
    s_nop 0
    ds_write_b128 v162, v[100:103] offset:1024
    s_nop 1
    ds_write_b128 v162, v[104:107] offset:2048
    s_nop 1
    ds_write_b128 v162, v[108:111] offset:3072
    s_waitcnt lgkmcnt(0)
    s_barrier
    ds_read_b128 v[16:19], v163 offset:0
    ds_read_b128 v[20:23], v163 offset:1024
    ds_read_b128 v[24:27], v163 offset:2048
    ds_read_b128 v[28:31], v163 offset:3072
    s_waitcnt lgkmcnt(3)
    v_pk_add_f32 v[80:81], v[80:81], v[16:17]
    v_pk_add_f32 v[82:83], v[82:83], v[18:19]
    v_cvt_pk_bf16_f32 v32, v80, v81
    v_cvt_pk_bf16_f32 v33, v82, v83
    s_waitcnt lgkmcnt(2)
    v_pk_add_f32 v[84:85], v[84:85], v[20:21]
    v_pk_add_f32 v[86:87], v[86:87], v[22:23]
    v_cvt_pk_bf16_f32 v34, v84, v85
    v_cvt_pk_bf16_f32 v35, v86, v87
    s_waitcnt lgkmcnt(1)
    v_pk_add_f32 v[88:89], v[88:89], v[24:25]
    v_pk_add_f32 v[90:91], v[90:91], v[26:27]
    v_cvt_pk_bf16_f32 v36, v88, v89
    v_cvt_pk_bf16_f32 v37, v90, v91
    s_waitcnt lgkmcnt(0)
    v_pk_add_f32 v[92:93], v[92:93], v[28:29]
    v_pk_add_f32 v[94:95], v[94:95], v[30:31]
    v_cvt_pk_bf16_f32 v38, v92, v93
    v_cvt_pk_bf16_f32 v39, v94, v95
    v_mfma_f32_16x16x32_bf16 v[60:63], v[32:35], v[32:35], 0
    v_mfma_f32_16x16x32_bf16 v[56:59], v[32:35], v[148:151], 0
    v_mfma_f32_16x16x32_bf16 v[60:63], v[36:39], v[36:39], v[60:63]
    v_mfma_f32_16x16x32_bf16 v[56:59], v[36:39], v[152:155], v[56:59]
    v_lshlrev_b32 v40, 16, v32
    v_and_b32 v41, 0xffff0000, v32
    v_lshlrev_b32 v42, 16, v33
    v_and_b32 v43, 0xffff0000, v33
    v_lshlrev_b32 v44, 16, v34
    v_and_b32 v45, 0xffff0000, v34
    s_nop 1
    v_cndmask_b32 v56, v56, v60, s[72:73]
    v_cndmask_b32 v57, v57, v61, s[72:73]
    v_cndmask_b32 v58, v58, v62, s[72:73]
    v_cndmask_b32 v59, v59, v63, s[72:73]
    v_cndmask_b32 v56, v56, v57, s[4:5]
    v_cndmask_b32 v58, v58, v59, s[98:99]
    s_or_b64 vcc, s[6:7], s[98:99]
    v_cndmask_b32 v56, v56, v58, vcc
    v_cndmask_b32 v56, v56, 1.0, s[74:75]
    v_mov_b32 v67, v56
    buffer_atomic_add_f32 v67, v160, s[16:19], 0 offen sc0 sc1
    s_mov_b32 s90, 0
    buffer_load_dwordx4 v[228:231], v14, s[36:39], s90 offen
    s_mov_b32 s90, 2048
    buffer_load_dwordx4 v[232:235], v14, s[36:39], s90 offen
    s_mov_b32 s90, 4096
    buffer_load_dwordx4 v[236:239], v14, s[36:39], s90 offen
    v_lshlrev_b32 v46, 16, v35
    v_and_b32 v47, 0xffff0000, v35
    v_lshlrev_b32 v48, 16, v36
    v_and_b32 v49, 0xffff0000, v36
    v_lshlrev_b32 v50, 16, v37
    v_and_b32 v51, 0xffff0000, v37
    v_lshlrev_b32 v52, 16, v38
    v_and_b32 v53, 0xffff0000, v38
    v_lshlrev_b32 v54, 16, v39
    v_and_b32 v55, 0xffff0000, v39
    v_lshrrev_b32 v8, 2, v2
    v_lshlrev_b32 v9, 4, v8
    v_sub_u32 v9, v161, v9
    v_cmp_eq_u32 vcc, 0, v8
    s_nop 1
    v_cndmask_b32 v10, 0, 32, vcc
    v_add_u32 v10, v9, v10
    v_cmp_eq_u32 vcc, 1, v8
    s_nop 1
    v_cndmask_b32 v8, 16, 48, vcc
    v_add_u32 v9, v9, v8
    s_waitcnt vmcnt(3)
    v_add_f32 v67, v67, v56
    s_branch L_h3_chk
L_h3:
    v_mov_b32 v67, 0
    buffer_atomic_or v67, v160, s[16:19], 0 offen sc0 sc1
    s_waitcnt vmcnt(0)
L_h3_chk:
    v_cmp_ne_u32 vcc, 0x41800000, v67
    s_nop 0
    s_and_b64 vcc, vcc, s[74:75]
    s_cbranch_vccz L_ok_4
    s_sub_u32 s56, s56, 1
    s_cbranch_scc0 L_h3
    s_mov_b32 s56, 0
L_ok_4:
    ds_bpermute_b32 v64, v10, v67
    ds_bpermute_b32 v66, v161, v67
    ds_bpermute_b32 v65, v9, v67
    s_waitcnt lgkmcnt(0)
    v_mul_f32 v64, 0x3a800000, v64
    v_mul_f32 v66, 0x3a800000, v66
    v_fma_f32 v66, -v64, v64, v66
    v_max_f32 v66, 0, v66
    v_cvt_pk_bf16_f32 v69, v64, v66
    v_lshlrev_b32 v68, 16, v69
    v_and_b32 v69, 0xffff0000, v69
    v_add_f32 v69, 0x3727c5ac, v69
    v_cvt_pk_bf16_f32 v69, v69, v69
    v_lshlrev_b32 v69, 16, v69
    v_sqrt_f32 v69, v69
    s_nop 0
    v_cvt_pk_bf16_f32 v69, v69, v69
    v_lshlrev_b32 v69, 16, v69
    v_rcp_f32 v70, v69
    v_fma_f32 v12, -v68, s57, v65
    v_mul_f32 v12, v12, v70
    v_mul_f32 v72, -v68, v70
    v_ashrrev_i32 v8, 31, v12
    v_or_b32 v8, 0x80000000, v8
    v_xor_b32 v8, v8, v12
    v_and_b32 v8, 0xfffff800, v8
    v_or_b32 v13, v8, v6
    s_lshl_b32 s86, s3, 6
    s_add_u32 s86, s86, 65536
    v_lshl_add_u32 v8, v2, 2, s86
    ds_write_b32 v8, v13
    v_pk_fma_f32 v[16:17], v[40:41], v[70:71], v[72:73] op_sel_hi:[1,0,0]
    v_pk_fma_f32 v[18:19], v[42:43], v[70:71], v[72:73] op_sel_hi:[1,0,0]
    v_pk_fma_f32 v[20:21], v[44:45], v[70:71], v[72:73] op_sel_hi:[1,0,0]
    v_pk_fma_f32 v[22:23], v[46:47], v[70:71], v[72:73] op_sel_hi:[1,0,0]
    v_pk_fma_f32 v[24:25], v[48:49], v[70:71], v[72:73] op_sel_hi:[1,0,0]
    v_pk_fma_f32 v[26:27], v[50:51], v[70:71], v[72:73] op_sel_hi:[1,0,0]
    v_pk_fma_f32 v[28:29], v[52:53], v[70:71], v[72:73] op_sel_hi:[1,0,0]
    v_pk_fma_f32 v[30:31], v[54:55], v[70:71], v[72:73] op_sel_hi:[1,0,0]
    v_lshlrev_b32 v8, 3, v0
    v_add_u32 v8, 65536, v8
    s_waitcnt lgkmcnt(0)
    s_barrier
    ds_read_b64 v[64:65], v8
    v_cvt_pk_bf16_f32 v96, v16, v17
    v_cvt_pk_bf16_f32 v97, v18, v19
    v_cvt_pk_bf16_f32 v98, v20, v21
    v_cvt_pk_bf16_f32 v99, v22, v23
    v_cvt_pk_bf16_f32 v100, v24, v25
    v_cvt_pk_bf16_f32 v101, v26, v27
    v_cvt_pk_bf16_f32 v102, v28, v29
    v_cvt_pk_bf16_f32 v103, v30, v31
    s_waitcnt lgkmcnt(0)
    v_max_u32 v66, v64, v65
    v_min_u32 v67, v64, v65
    s_nop 0
    v_mov_b32_dpp v64, v66 row_ror:8 row_mask:0xf bank_mask:0xf
    v_max_u32_dpp v65, v67, v67 row_ror:8 row_mask:0xf bank_mask:0xf
    v_med3_u32 v67, v66, v64, v65
    v_max_u32 v66, v66, v64
    s_nop 1
    v_mov_b32_dpp v64, v66 row_ror:4 row_mask:0xf bank_mask:0xf
    v_max_u32_dpp v65, v67, v67 row_ror:4 row_mask:0xf bank_mask:0xf
    v_med3_u32 v67, v66, v64, v65
    v_max_u32 v66, v66, v64
    s_nop 1
    v_mov_b32_dpp v64, v66 row_ror:2 row_mask:0xf bank_mask:0xf
    v_max_u32_dpp v65, v67, v67 row_ror:2 row_mask:0xf bank_mask:0xf
    v_med3_u32 v67, v66, v64, v65
    v_max_u32 v66, v66, v64
    s_nop 1
    v_mov_b32_dpp v64, v66 row_ror:1 row_mask:0xf bank_mask:0xf
    v_max_u32_dpp v65, v67, v67 row_ror:1 row_mask:0xf bank_mask:0xf
    v_med3_u32 v67, v66, v64, v65
    v_max_u32 v66, v66, v64
    s_nop 0
    v_readlane_b32 s58, v66, 0
    v_readlane_b32 s59, v67, 0
    v_readlane_b32 s86, v66, 16
    v_readlane_b32 s87, v67, 16
    s_nop 0
    s_max_u32 s59, s59, s87
    s_min_u32 s87, s58, s86
    s_max_u32 s58, s58, s86
    s_max_u32 s59, s59, s87
    v_readlane_b32 s86, v66, 32
    v_readlane_b32 s87, v67, 32
    s_nop 0
    s_max_u32 s59, s59, s87
    s_min_u32 s87, s58, s86
    s_max_u32 s58, s58, s86
    s_max_u32 s59, s59, s87
    v_readlane_b32 s86, v66, 48
    v_readlane_b32 s87, v67, 48
    s_nop 0
    s_max_u32 s59, s59, s87
    s_min_u32 s87, s58, s86
    s_max_u32 s58, s58, s86
    s_max_u32 s59, s59, s87
    v_cmp_eq_u32 s[4:5], s58, v13
    v_cmp_eq_u32 s[6:7], s59, v13
    s_nop 0
    s_or_b64 s[96:97], s[4:5], s[6:7]
    s_cbranch_scc0 L_nocand
    s_lshl_b32 s86, s51, 12
    s_lshl_b32 s87, s52, 7
    s_add_u32 s86, s86, s87
    s_add_u32 s86, s86, 6782976
    v_lshl_add_u32 v8, v1, 3, s86
    v_add_u32 v9, 2048, v8
    v_cndmask_b32 v8, v8, v9, s[6:7]
    v_mov_b32 v9, 2147483648
    v_cndmask_b32 v8, v9, v8, s[96:97]
    buffer_store_dwordx2 v[96:97], v8, s[16:19], 0 offen offset:0 sc1
    buffer_store_dwordx2 v[98:99], v8, s[16:19], 0 offen offset:32 sc1
    buffer_store_dwordx2 v[100:101], v8, s[16:19], 0 offen offset:64 sc1
    buffer_store_dwordx2 v[102:103], v8, s[16:19], 0 offen offset:96 sc1
L_nocand:
    s_cmp_lg_u32 s3, 0
    s_cbranch_scc1 L_nokey
    s_lshl_b32 s86, s52, 10
    s_lshl_b32 s87, s51, 3
    s_add_u32 s86, s86, s87
    s_add_u32 s86, s86, 6848512
    v_lshl_add_u32 v8, v0, 7, s86
    v_mov_b32 v9, 2147483648
    v_cmp_gt_u32 vcc, 8, v0
    s_nop 1
    v_cndmask_b32 v8, v9, v8, vcc
    v_mov_b32 v10, s58
    v_mov_b32 v11, s59
    buffer_atomic_swap_x2 v[10:11], v8, s[16:19], 0 offen sc1
L_nokey:
    s_bfe_u32 s89, s2, 0x20001
    s_lshl_b32 s89, s89, 2
    s_add_u32 s89, s89, s48
    s_lshl_b32 s86, s89, 3
    s_and_b32 s87, s45, 7
    s_add_u32 s86, s86, s87
    s_lshl_b32 s86, s86, 7
    s_add_u32 s86, s86, 6848512
    v_lshl_add_u32 v129, v0, 2, s86
    v_mov_b32 v8, 2147483648
    v_cmp_gt_u32 vcc, 32, v0
    s_nop 1
    v_cndmask_b32 v129, v8, v129, vcc
    s_cmp_lg_u64 s[96:97], 0
    s_cselect_b32 s63, 1, s62
    s_cmp_eq_u32 s63, 0
    s_cbranch_scc1 L_h4_skip1
    v_mov_b32 v128, 0
    buffer_atomic_or v128, v129, s[16:19], 0 offen sc0 sc1
L_h4_skip1:
    v_lshlrev_b32 v16, 16, v96
    v_and_b32 v17, 0xffff0000, v96
    v_lshlrev_b32 v18, 16, v97
    v_and_b32 v19, 0xffff0000, v97
    v_lshlrev_b32 v20, 16, v98
    v_and_b32 v21, 0xffff0000, v98
    v_lshlrev_b32 v22, 16, v99
    v_and_b32 v23, 0xffff0000, v99
    v_lshlrev_b32 v24, 16, v100
    v_and_b32 v25, 0xffff0000, v100
    v_lshlrev_b32 v26, 16, v101
    v_and_b32 v27, 0xffff0000, v101
    v_lshlrev_b32 v28, 16, v102
    v_and_b32 v29, 0xffff0000, v102
    v_lshlrev_b32 v30, 16, v103
    v_and_b32 v31, 0xffff0000, v103
    v_pk_add_f32 v[16:17], v[16:17], v[40:41]
    v_pk_add_f32 v[18:19], v[18:19], v[42:43]
    v_pk_add_f32 v[20:21], v[20:21], v[44:45]
    v_pk_add_f32 v[22:23], v[22:23], v[46:47]
    v_pk_add_f32 v[24:25], v[24:25], v[48:49]
    v_pk_add_f32 v[26:27], v[26:27], v[50:51]
    v_pk_add_f32 v[28:29], v[28:29], v[52:53]
    v_pk_add_f32 v[30:31], v[30:31], v[54:55]
    v_cvt_pk_bf16_f32 v104, v16, v17
    v_cvt_pk_bf16_f32 v105, v18, v19
    v_cvt_pk_bf16_f32 v106, v20, v21
    v_cvt_pk_bf16_f32 v107, v22, v23
    v_cvt_pk_bf16_f32 v108, v24, v25
    v_cvt_pk_bf16_f32 v109, v26, v27
    v_cvt_pk_bf16_f32 v110, v28, v29
    v_cvt_pk_bf16_f32 v111, v30, v31
    v_permlane16_swap_b32 v104, v106
    v_permlane16_swap_b32 v105, v107
    v_permlane16_swap_b32 v108, v110
    v_permlane16_swap_b32 v109, v111
    v_mov_b32 v9, 2147483648
    v_cndmask_b32 v8, v5, v9, s[96:97]
    buffer_store_dwordx4 v[104:107], v8, s[24:27], 0 offen sc1
    buffer_store_dwordx4 v[108:111], v8, s[24:27], 0 offen offset:64 sc1
    s_cmp_eq_u32 s63, 0
    s_cbranch_scc1 L_fin
    s_cmp_eq_u64 s[96:97], 0
    s_cbranch_scc1 L_nostash
    v_lshlrev_b32 v8, 3, v1
    v_add_u32 v8, 98304, v8
    v_add_u32 v9, 512, v8
    v_cndmask_b32 v8, v8, v9, s[6:7]
    v_cvt_pk_bf16_f32 v9, v12, v12
    v_lshlrev_b32 v9, 16, v9
    s_mov_b64 exec, s[96:97]
    ds_write_b64 v8, v[32:33] offset:0
    ds_write_b64 v8, v[96:97] offset:128
    ds_write_b64 v8, v[34:35] offset:32
    ds_write_b64 v8, v[98:99] offset:160
    ds_write_b64 v8, v[36:37] offset:64
    ds_write_b64 v8, v[100:101] offset:192
    ds_write_b64 v8, v[38:39] offset:96
    ds_write_b64 v8, v[102:103] offset:224
    ds_write_b32 v8, v9 offset:256
    s_mov_b64 exec, -1
L_nostash:
    s_waitcnt vmcnt(2)
    s_branch L_h4_chk
L_h4:
    v_mov_b32 v128, 0
    buffer_atomic_or v128, v129, s[16:19], 0 offen sc0 sc1
    s_waitcnt vmcnt(0)
L_h4_chk:
    v_cmp_eq_u32 vcc, -1, v128
    s_cbranch_vccz L_ok_5
    s_sub_u32 s56, s56, 1
    s_cbranch_scc0 L_h4
    s_mov_b32 s56, 0
L_ok_5:
    v_mov_b32 v64, v128
    v_mov_b32 v65, 0
    s_nop 0
    v_mov_b32_dpp v66, v64 row_ror:8 row_mask:0xf bank_mask:0xf
    v_max_u32_dpp v67, v65, v65 row_ror:8 row_mask:0xf bank_mask:0xf
    v_med3_u32 v65, v64, v66, v67
    v_max_u32 v64, v64, v66
    s_nop 1
    v_mov_b32_dpp v66, v64 row_ror:4 row_mask:0xf bank_mask:0xf
    v_max_u32_dpp v67, v65, v65 row_ror:4 row_mask:0xf bank_mask:0xf
    v_med3_u32 v65, v64, v66, v67
    v_max_u32 v64, v64, v66
    s_nop 1
    v_mov_b32_dpp v66, v64 row_ror:2 row_mask:0xf bank_mask:0xf
    v_max_u32_dpp v67, v65, v65 row_ror:2 row_mask:0xf bank_mask:0xf
    v_med3_u32 v65, v64, v66, v67
    v_max_u32 v64, v64, v66
    s_nop 1
    v_mov_b32_dpp v66, v64 row_ror:1 row_mask:0xf bank_mask:0xf
    v_max_u32_dpp v67, v65, v65 row_ror:1 row_mask:0xf bank_mask:0xf
    v_med3_u32 v65, v64, v66, v67
    v_max_u32 v64, v64, v66
    s_nop 0
    v_readlane_b32 s60, v64, 0
    v_readlane_b32 s61, v65, 0
    v_readlane_b32 s86, v64, 16
    v_readlane_b32 s87, v65, 16
    s_nop 0
    s_max_u32 s61, s61, s87
    s_min_u32 s87, s60, s86
    s_max_u32 s60, s60, s86
    s_max_u32 s61, s61, s87
    s_cmp_lg_u32 s62, 0
    s_cbranch_scc1 L_moe
    s_barrier
    s_barrier
    s_branch L_final
L_moe:
    v_cmp_eq_u32 vcc, s60, v128
    s_nop 0
    s_ff1_i32_b32 s86, vcc_lo
    v_cmp_eq_u32 vcc, s61, v128
    s_nop 0
    s_ff1_i32_b32 s87, vcc_lo
    s_and_b32 s86, s86, 31
    s_and_b32 s87, s87, 31
    v_bfe_u32 v8, v0, 3, 1
    v_cmp_eq_u32 vcc, 1, v8
    v_mov_b32 v9, s86
    v_mov_b32 v10, s87
    v_cndmask_b32 v9, v9, v10, vcc
    s_lshl_b32 s89, s89, 7
    s_add_u32 s89, s89, 6782976
    v_lshl_add_u32 v10, v1, 5, s89
    v_lshl_add_u32 v130, v9, 11, v10
    buffer_load_dwordx4 v[64:67], v130, s[16:19], 0 offen sc1
    buffer_load_dwordx4 v[68:71], v130, s[16:19], 0 offen offset:16 sc1
    s_mov_b32 s90, 6144
    buffer_load_dwordx4 v[240:243], v14, s[36:39], s90 offen
    s_mov_b32 s90, 8192
    buffer_load_dwordx4 v[244:247], v14, s[36:39], s90 offen
    s_mov_b32 s90, 10240
    buffer_load_dwordx4 v[248:251], v14, s[36:39], s90 offen
    s_mov_b32 s90, 12288
    buffer_load_dwordx4 v[252:255], v14, s[36:39], s90 offen
    v_and_b32 v10, 1, v0
    v_cmp_eq_u32 vcc, 1, v10
    v_mov_b32 v10, 0x0c0c0100
    v_mov_b32 v11, 0x01000c0c
    v_cndmask_b32 v16, v10, v11, vcc
    v_mov_b32 v10, 0x0c0c0302
    v_mov_b32 v11, 0x03020c0c
    v_cndmask_b32 v17, v10, v11, vcc
    v_bfe_u32 v10, v0, 1, 2
    v_mov_b32 v11, 0x0c0c0c0c
    v_cmp_eq_u32 vcc, 0, v10
    s_nop 1
    v_cndmask_b32 v72, v11, v16, vcc
    v_cndmask_b32 v76, v11, v17, vcc
    v_cmp_eq_u32 vcc, 1, v10
    s_nop 1
    v_cndmask_b32 v73, v11, v16, vcc
    v_cndmask_b32 v77, v11, v17, vcc
    v_cmp_eq_u32 vcc, 2, v10
    s_nop 1
    v_cndmask_b32 v74, v11, v16, vcc
    v_cndmask_b32 v78, v11, v17, vcc
    v_cmp_eq_u32 vcc, 3, v10
    s_nop 1
    v_cndmask_b32 v75, v11, v16, vcc
    v_cndmask_b32 v79, v11, v17, vcc
    s_lshl_b32 s86, s48, 10
    s_add_u32 s86, s86, 90112
    v_lshl_add_u32 v18, v0, 4, s86
    s_and_b32 s86, s2, 1
    s_lshl_b32 s86, s86, 2
    s_bfe_u32 s87, s2, 0x20001
    s_add_u32 s88, s86, s87
    s_mul_i32 s86, s88, 28672
    s_add_u32 s86, s86, 6553600
    v_mov_b32 v16, s80
    v_mov_b32 v17, s81
    s_mov_b32 vcc_lo, 4278255360
    s_mov_b32 vcc_hi, vcc_lo
    v_cndmask_b32 v16, v16, v17, vcc
    v_cmp_gt_u32 vcc, 56, v16
    v_lshl_add_u32 v19, v16, 8, s86
    v_and_b32 v16, 7, v0
    v_lshl_add_u32 v19, v16, 5, v19
    v_and_b32 v10, 1, v1
    v_lshl_add_u32 v19, v10, 4, v19
    v_lshrrev_b32 v11, 1, v1
    v_mul_u32_u24 v16, 14336, v11
    v_add_u32 v19, v19, v16
    v_mov_b32 v133, 2147483648
    v_cndmask_b32 v19, v133, v19, vcc
    v_mov_b32 v131, s68
    s_lshl2_add_u32 s86, s88, 704512
    v_mov_b32 v16, s80
    v_mov_b32 v17, s81
    s_mov_b32 vcc_lo, 4042322160
    s_mov_b32 vcc_hi, vcc_lo
    v_cndmask_b32 v16, v16, v17, vcc
    v_cmp_gt_u32 vcc, 56, v16
    v_lshl_add_u32 v132, v16, 9, s86
    v_and_b32 v16, 3, v0
    v_lshl_add_u32 v132, v16, 7, v132
    s_and_b64 vcc, vcc, 0xff
    v_cndmask_b32 v132, v133, v132, vcc
    s_lshl_b32 s86, s44, 5
    s_add_u32 s86, s86, s45
    s_lshl2_add_u32 s86, s86, 737280
    v_writelane_b32 v133, s86, 0
    s_mul_i32 s86, s45, 112
    s_mul_i32 s87, s48, 28
    s_add_u32 s86, s86, s87
    v_mul_u32_u24 v16, 27, v8
    v_add_u32 v16, s86, v16
    v_lshrrev_b32 v16, 6, v16
    s_lshl_b32 s87, s48, 7
    s_add_u32 s87, s87, 704512
    v_lshl_add_u32 v134, v16, 9, s87
    v_and_b32 v16, 7, v0
    v_lshl_add_u32 v134, v16, 2, v134
    v_mov_b32 v16, 2147483648
    v_cmp_gt_u32 vcc, 16, v0
    s_nop 1
    v_cndmask_b32 v134, v16, v134, vcc
    s_waitcnt vmcnt(4)
    s_branch L_seg_chk
L_seg:
    buffer_load_dwordx4 v[64:67], v130, s[16:19], 0 offen sc1
    buffer_load_dwordx4 v[68:71], v130, s[16:19], 0 offen offset:16 sc1
    s_waitcnt vmcnt(0)
L_seg_chk:
    v_max3_u32 v16, v65, v67, v69
    v_max_u32 v16, v16, v71
    v_cmp_eq_u32 vcc, -1, v16
    s_cbranch_vccz L_ok_6
    s_sub_u32 s56, s56, 1
    s_cbranch_scc0 L_seg
    s_mov_b32 s56, 0
L_ok_6:
    v_perm_b32 v80, v64, v64, v72
    v_perm_b32 v81, v64, v64, v73
    v_perm_b32 v82, v64, v64, v74
    v_perm_b32 v83, v64, v64, v75
    s_nop 1
    v_mfma_f32_16x16x32_bf16 v[88:91], v[80:83], v[164:167], 0
    v_perm_b32 v84, v64, v64, v76
    v_perm_b32 v85, v64, v64, v77
    v_perm_b32 v86, v64, v64, v78
    v_perm_b32 v87, v64, v64, v79
    s_nop 1
    v_mfma_f32_16x16x32_bf16 v[88:91], v[84:87], v[168:171], v[88:91]
    v_perm_b32 v80, v65, v65, v72
    v_perm_b32 v81, v65, v65, v73
    v_perm_b32 v82, v65, v65, v74
    v_perm_b32 v83, v65, v65, v75
    s_nop 1
    v_mfma_f32_16x16x32_bf16 v[88:91], v[80:83], v[172:175], v[88:91]
    v_perm_b32 v84, v65, v65, v76
    v_perm_b32 v85, v65, v65, v77
    v_perm_b32 v86, v65, v65, v78
    v_perm_b32 v87, v65, v65, v79
    s_nop 1
    v_mfma_f32_16x16x32_bf16 v[88:91], v[84:87], v[176:179], v[88:91]
    v_perm_b32 v80, v66, v66, v72
    v_perm_b32 v81, v66, v66, v73
    v_perm_b32 v82, v66, v66, v74
    v_perm_b32 v83, v66, v66, v75
    s_nop 1
    v_mfma_f32_16x16x32_bf16 v[88:91], v[80:83], v[180:183], v[88:91]
    v_perm_b32 v84, v66, v66, v76
    v_perm_b32 v85, v66, v66, v77
    v_perm_b32 v86, v66, v66, v78
    v_perm_b32 v87, v66, v66, v79
    s_nop 1
    v_mfma_f32_16x16x32_bf16 v[88:91], v[84:87], v[184:187], v[88:91]
    v_perm_b32 v80, v67, v67, v72
    v_perm_b32 v81, v67, v67, v73
    v_perm_b32 v82, v67, v67, v74
    v_perm_b32 v83, v67, v67, v75
    s_nop 1
    v_mfma_f32_16x16x32_bf16 v[88:91], v[80:83], v[188:191], v[88:91]
    v_perm_b32 v84, v67, v67, v76
    v_perm_b32 v85, v67, v67, v77
    v_perm_b32 v86, v67, v67, v78
    v_perm_b32 v87, v67, v67, v79
    s_nop 1
    v_mfma_f32_16x16x32_bf16 v[88:91], v[84:87], v[192:195], v[88:91]
    v_perm_b32 v80, v68, v68, v72
    v_perm_b32 v81, v68, v68, v73
    v_perm_b32 v82, v68, v68, v74
    v_perm_b32 v83, v68, v68, v75
    s_nop 1
    v_mfma_f32_16x16x32_bf16 v[88:91], v[80:83], v[196:199], v[88:91]
    v_perm_b32 v84, v68, v68, v76
    v_perm_b32 v85, v68, v68, v77
    v_perm_b32 v86, v68, v68, v78
    v_perm_b32 v87, v68, v68, v79
    s_nop 1
    v_mfma_f32_16x16x32_bf16 v[88:91], v[84:87], v[200:203], v[88:91]
    v_perm_b32 v80, v69, v69, v72
    v_perm_b32 v81, v69, v69, v73
    v_perm_b32 v82, v69, v69, v74
    v_perm_b32 v83, v69, v69, v75
    s_nop 1
    v_mfma_f32_16x16x32_bf16 v[88:91], v[80:83], v[204:207], v[88:91]
    v_perm_b32 v84, v69, v69, v76
    v_perm_b32 v85, v69, v69, v77
    v_perm_b32 v86, v69, v69, v78
    v_perm_b32 v87, v69, v69, v79
    s_nop 1
    v_mfma_f32_16x16x32_bf16 v[88:91], v[84:87], v[208:211], v[88:91]
    v_perm_b32 v80, v70, v70, v72
    v_perm_b32 v81, v70, v70, v73
    v_perm_b32 v82, v70, v70, v74
    v_perm_b32 v83, v70, v70, v75
    s_nop 1
    v_mfma_f32_16x16x32_bf16 v[88:91], v[80:83], v[212:215], v[88:91]
    v_perm_b32 v84, v70, v70, v76
    v_perm_b32 v85, v70, v70, v77
    v_perm_b32 v86, v70, v70, v78
    v_perm_b32 v87, v70, v70, v79
    s_nop 1
    v_mfma_f32_16x16x32_bf16 v[88:91], v[84:87], v[216:219], v[88:91]
    v_perm_b32 v80, v71, v71, v72
    v_perm_b32 v81, v71, v71, v73
    v_perm_b32 v82, v71, v71, v74
    v_perm_b32 v83, v71, v71, v75
    s_nop 1
    v_mfma_f32_16x16x32_bf16 v[88:91], v[80:83], v[220:223], v[88:91]
    v_perm_b32 v84, v71, v71, v76
    v_perm_b32 v85, v71, v71, v77
    v_perm_b32 v86, v71, v71, v78
    v_perm_b32 v87, v71, v71, v79
    s_nop 1
    v_mfma_f32_16x16x32_bf16 v[88:91], v[84:87], v[224:227], v[88:91]
    s_nop 7
    ds_write_b128 v18, v[88:91] offset:0
    s_waitcnt lgkmcnt(0)
    s_barrier
    s_cmp_lg_u32 s48, 0
    s_cbranch_scc1 L_gu_done
    ds_read_b128 v[20:23], v18 offset:1024
    ds_read_b128 v[24:27], v18 offset:2048
    ds_read_b128 v[28:31], v18 offset:3072
    s_waitcnt lgkmcnt(0)
    v_pk_add_f32 v[88:89], v[88:89], v[20:21]
    v_pk_add_f32 v[24:25], v[24:25], v[28:29]
    v_pk_add_f32 v[88:89], v[88:89], v[24:25]
    v_pk_add_f32 v[90:91], v[90:91], v[22:23]
    v_pk_add_f32 v[26:27], v[26:27], v[30:31]
    v_pk_add_f32 v[90:91], v[90:91], v[26:27]
    buffer_store_dwordx4 v[88:91], v19, s[16:19], 0 offen sc1
    buffer_atomic_swap v131, v132, s[16:19], 0 offen sc1
L_gu_done:
    v_mov_b32 v135, 0
    buffer_atomic_or v135, v134, s[16:19], 0 offen sc0 sc1
    s_mul_i32 s86, s45, 112
    s_mul_i32 s87, s48, 28
    s_add_u32 s86, s86, s87
    v_bfe_u32 v16, v0, 3, 2
    v_mul_u32_u24 v16, 7, v16
    v_and_b32 v17, 7, v0
    v_min_u32 v17, 6, v17
    v_add3_u32 v16, v16, v17, s86
    v_lshrrev_b32 v17, 5, v0
    v_mul_u32_u24 v17, 14336, v17
    v_lshl_add_u32 v16, v16, 2, v17
    v_add_u32 v16, 6553600, v16
    s_lshl_b32 s86, s45, 13
    s_lshl_b32 s87, s44, 9
    s_add_u32 s86, s86, s87
    s_add_u32 s86, s86, 6291456
    v_lshl_add_u32 v9, v2, 5, s86
    v_lshl_add_u32 v9, v10, 4, v9
    v_lshl_add_u32 v9, v11, 12, v9
    s_lshl_b32 s86, s48, 7
    s_add_u32 s86, s86, 100352
    v_lshl_add_u32 v10, v0, 1, s86
    v_lshl_add_u32 v11, v8, 6, s86
    v_lshl_add_u32 v11, v1, 4, v11
    s_branch L_h5f_chk
L_h5f:
    v_mov_b32 v135, 0
    buffer_atomic_or v135, v134, s[16:19], 0 offen sc0 sc1
L_h5f_chk:
    s_waitcnt vmcnt(0)
    v_cmp_ne_u32 vcc, s68, v135
    s_nop 0
    s_and_b64 vcc, vcc, 0xffff
    s_cbranch_vccz L_ok_7
    s_sub_u32 s56, s56, 1
    s_cbranch_scc0 L_h5f
    s_mov_b32 s56, 0
L_ok_7:
L_h5:
    s_mov_b32 s90, 0
    buffer_load_dword v24, v16, s[16:19], s90 offen sc1
    s_mov_b32 s90, 28672
    buffer_load_dword v25, v16, s[16:19], s90 offen sc1
    s_mov_b32 s90, 57344
    buffer_load_dword v26, v16, s[16:19], s90 offen sc1
    s_mov_b32 s90, 86016
    buffer_load_dword v27, v16, s[16:19], s90 offen sc1
    s_mov_b32 s90, 114688
    buffer_load_dword v28, v16, s[16:19], s90 offen sc1
    s_mov_b32 s90, 143360
    buffer_load_dword v29, v16, s[16:19], s90 offen sc1
    s_mov_b32 s90, 172032
    buffer_load_dword v30, v16, s[16:19], s90 offen sc1
    s_mov_b32 s90, 200704
    buffer_load_dword v31, v16, s[16:19], s90 offen sc1
    s_waitcnt vmcnt(0)
    v_max3_u32 v17, v24, v25, v26
    v_max3_u32 v17, v17, v27, v28
    v_max3_u32 v17, v17, v29, v30
    v_max_u32 v17, v17, v31
    v_cmp_eq_u32 vcc, -1, v17
    s_cbranch_vccz L_ok_8
    s_sub_u32 s56, s56, 1
    s_cbranch_scc0 L_h5
    s_mov_b32 s56, 0
L_ok_8:
    v_mov_b32 v19, v9
    v_add_f32 v24, v24, v25
    v_add_f32 v26, v26, v27
    v_add_f32 v28, v28, v29
    v_add_f32 v30, v30, v31
    v_add_f32 v24, v24, v26
    v_add_f32 v28, v28, v30
    v_cvt_pk_bf16_f32 v25, v24, v28
    v_lshlrev_b32 v24, 16, v25
    v_and_b32 v28, 0xffff0000, v25
    v_mul_f32 v25, 0xbfb8aa3b, v24
    v_exp_f32 v25, v25
    s_nop 0
    v_add_f32 v25, 1.0, v25
    v_rcp_f32 v25, v25
    s_nop 0
    v_mul_f32 v24, v24, v25
    v_cvt_pk_bf16_f32 v24, v24, v24
    v_lshlrev_b32 v24, 16, v24
    v_mul_f32 v24, v24, v28
    v_cvt_pk_bf16_f32 v24, v24, v24
    ds_write_b16 v10, v24
    s_waitcnt lgkmcnt(0)
    ds_read_b128 v[64:67], v11
    s_waitcnt lgkmcnt(0)
    v_perm_b32 v80, v64, v64, v72
    v_perm_b32 v81, v64, v64, v73
    v_perm_b32 v82, v64, v64, v74
    v_perm_b32 v83, v64, v64, v75
    s_nop 1
    v_mfma_f32_16x16x32_bf16 v[88:91], v[80:83], v[228:231], 0
    v_perm_b32 v84, v64, v64, v76
    v_perm_b32 v85, v64, v64, v77
    v_perm_b32 v86, v64, v64, v78
    v_perm_b32 v87, v64, v64, v79
    s_nop 1
    v_mfma_f32_16x16x32_bf16 v[88:91], v[84:87], v[232:235], v[88:91]
    v_perm_b32 v80, v65, v65, v72
    v_perm_b32 v81, v65, v65, v73
    v_perm_b32 v82, v65, v65, v74
    v_perm_b32 v83, v65, v65, v75
    s_nop 1
    v_mfma_f32_16x16x32_bf16 v[88:91], v[80:83], v[236:239], v[88:91]
    v_perm_b32 v84, v65, v65, v76
    v_perm_b32 v85, v65, v65, v77
    v_perm_b32 v86, v65, v65, v78
    v_perm_b32 v87, v65, v65, v79
    s_nop 1
    v_mfma_f32_16x16x32_bf16 v[88:91], v[84:87], v[240:243], v[88:91]
    v_perm_b32 v80, v66, v66, v72
    v_perm_b32 v81, v66, v66, v73
    v_perm_b32 v82, v66, v66, v74
    v_perm_b32 v83, v66, v66, v75
    s_nop 1
    v_mfma_f32_16x16x32_bf16 v[88:91], v[80:83], v[244:247], v[88:91]
    v_perm_b32 v84, v66, v66, v76
    v_perm_b32 v85, v66, v66, v77
    v_perm_b32 v86, v66, v66, v78
    v_perm_b32 v87, v66, v66, v79
    s_nop 1
    v_mfma_f32_16x16x32_bf16 v[88:91], v[84:87], v[248:251], v[88:91]
    v_perm_b32 v80, v67, v67, v72
    v_perm_b32 v81, v67, v67, v73
    v_perm_b32 v82, v67, v67, v74
    v_perm_b32 v83, v67, v67, v75
    s_nop 1
    v_mfma_f32_16x16x32_bf16 v[88:91], v[80:83], v[252:255], v[88:91]
    s_nop 7
    ds_write_b128 v18, v[88:91] offset:4096
    s_waitcnt lgkmcnt(0)
    s_barrier
    s_cmp_lg_u32 s48, 0
    s_cbranch_scc1 L_dn_done
    ds_read_b128 v[20:23], v18 offset:5120
    ds_read_b128 v[24:27], v18 offset:6144
    ds_read_b128 v[28:31], v18 offset:7168
    s_waitcnt lgkmcnt(0)
    v_pk_add_f32 v[88:89], v[88:89], v[20:21]
    v_pk_add_f32 v[24:25], v[24:25], v[28:29]
    v_pk_add_f32 v[88:89], v[88:89], v[24:25]
    v_pk_add_f32 v[90:91], v[90:91], v[22:23]
    v_pk_add_f32 v[26:27], v[26:27], v[30:31]
    v_pk_add_f32 v[90:91], v[90:91], v[26:27]
    buffer_store_dwordx4 v[88:91], v19, s[16:19], 0 offen sc1
    buffer_atomic_swap v131, v133, s[16:19], 0 offen sc1
L_dn_done:
L_final:
    s_cmp_eq_u64 s[96:97], 0
    s_cbranch_scc1 L_fin
    v_cmp_ne_u32 s[4:5], s60, v13
    v_cmp_ne_u32 s[6:7], s61, v13
    s_nop 0
    s_and_b64 s[4:5], s[4:5], s[6:7]
    s_and_b64 s[4:5], s[4:5], s[96:97]
    s_cbranch_scc0 L_nolost
    v_mov_b32 v9, 2147483648
    v_cndmask_b32 v8, v9, v5, s[4:5]
    buffer_store_dwordx4 v[104:107], v8, s[24:27], 0 offen sc1
    buffer_store_dwordx4 v[108:111], v8, s[24:27], 0 offen offset:64 sc1
L_nolost:
    s_mov_b32 s63, 0
L_fin_loop:
    v_cmp_eq_u32 vcc, s60, v13
    s_cbranch_vccz L_fin_next
    s_cmp_eq_u32 s60, s58
    s_cselect_b32 s86, 0, 512
    s_add_u32 s86, s86, 98304
    v_lshl_add_u32 v8, v2, 3, s86
    v_mov_b32 v9, s86
    ds_read_b64 v[56:57], v8
    ds_read_b64 v[58:59], v8 offset:128
    ds_read_b32 v60, v9 offset:256
    s_lshl_b32 s86, s63, 12
    s_lshl_b32 s87, s52, 8
    s_add_u32 s86, s86, s87
    s_add_u32 s86, s86, 6291456
    v_lshl_add_u32 v10, v2, 4, s86
    v_lshl_add_u32 v10, v1, 13, v10
    s_and_b32 s86, s60, 0x7ff
    s_sub_u32 s86, 2047, s86
    s_lshl_b32 s86, s86, 11
    s_lshl_b32 s87, s52, 7
    s_add_u32 s86, s86, s87
    v_lshl_add_u32 v11, v2, 3, s86
    v_cmp_eq_u32 vcc, 0, v1
    v_mov_b32 v9, 2147483648
    s_nop 0
    v_cndmask_b32 v11, v9, v11, vcc
    s_waitcnt lgkmcnt(0)
    v_mul_f32 v60, 0xbfb8aa3b, v60
    v_exp_f32 v60, v60
    s_nop 0
    v_add_f32 v60, 1.0, v60
    v_rcp_f32 v60, v60
    s_nop 0
    v_cvt_pk_bf16_f32 v60, v60, v60
    v_lshlrev_b32 v60, 16, v60
    v_lshlrev_b32 v64, 16, v56
    v_and_b32 v65, 0xffff0000, v56
    v_lshlrev_b32 v68, 16, v58
    v_and_b32 v69, 0xffff0000, v58
    v_lshlrev_b32 v66, 16, v57
    v_and_b32 v67, 0xffff0000, v57
    v_lshlrev_b32 v70, 16, v59
    v_and_b32 v71, 0xffff0000, v59
    s_lshr_b32 s86, s52, 1
    s_lshl_b32 s86, s86, 7
    s_add_u32 s86, s86, 737280
    v_lshl_add_u32 v9, v0, 2, s86
    v_mov_b32 v8, 2147483648
    v_cmp_gt_u32 vcc, 32, v0
    s_nop 1
    v_cndmask_b32 v9, v8, v9, vcc
L_h6f:
    v_mov_b32 v8, 0
    buffer_atomic_or v8, v9, s[16:19], 0 offen sc0 sc1
    s_waitcnt vmcnt(0)
    v_cmp_ne_u32 vcc, s68, v8
    s_mov_b32 vcc_hi, 0
    s_cbranch_vccz L_ok_9
    s_sub_u32 s56, s56, 1
    s_cbranch_scc0 L_h6f
    s_mov_b32 s56, 0
L_ok_9:
L_h6:
    s_mov_b32 s90, 0
    buffer_load_dwordx4 v[112:115], v10, s[16:19], s90 offen sc1
    s_mov_b32 s90, 32768
    buffer_load_dwordx4 v[116:119], v10, s[16:19], s90 offen sc1
    s_mov_b32 s90, 65536
    buffer_load_dwordx4 v[120:123], v10, s[16:19], s90 offen sc1
    s_mov_b32 s90, 98304
    buffer_load_dwordx4 v[124:127], v10, s[16:19], s90 offen sc1
    s_mov_b32 s90, 131072
    buffer_load_dwordx4 v[128:131], v10, s[16:19], s90 offen sc1
    s_mov_b32 s90, 163840
    buffer_load_dwordx4 v[132:135], v10, s[16:19], s90 offen sc1
    s_mov_b32 s90, 196608
    buffer_load_dwordx4 v[136:139], v10, s[16:19], s90 offen sc1
    s_mov_b32 s90, 229376
    buffer_load_dwordx4 v[140:143], v10, s[16:19], s90 offen sc1
    s_waitcnt vmcnt(0)
    v_max3_u32 v8, v115, v119, v123
    v_max3_u32 v8, v8, v127, v131
    v_max3_u32 v8, v8, v135, v139
    v_max_u32 v8, v8, v143
    v_cmp_eq_u32 vcc, -1, v8
    s_cbranch_vccz L_ok_10
    s_sub_u32 s56, s56, 1
    s_cbranch_scc0 L_h6
    s_mov_b32 s56, 0
L_ok_10:
    v_pk_add_f32 v[112:113], v[112:113], v[128:129]
    v_pk_add_f32 v[114:115], v[114:115], v[130:131]
    v_pk_add_f32 v[116:117], v[116:117], v[132:133]
    v_pk_add_f32 v[118:119], v[118:119], v[134:135]
    v_pk_add_f32 v[120:121], v[120:121], v[136:137]
    v_pk_add_f32 v[122:123], v[122:123], v[138:139]
    v_pk_add_f32 v[124:125], v[124:125], v[140:141]
    v_pk_add_f32 v[126:127], v[126:127], v[142:143]
    v_pk_add_f32 v[112:113], v[112:113], v[120:121]
    v_pk_add_f32 v[114:115], v[114:115], v[122:123]
    v_pk_add_f32 v[116:117], v[116:117], v[124:125]
    v_pk_add_f32 v[118:119], v[118:119], v[126:127]
    v_pk_add_f32 v[112:113], v[112:113], v[116:117]
    v_pk_add_f32 v[114:115], v[114:115], v[118:119]
    v_mov_b32 v116, v112
    v_mov_b32 v117, v113
    v_mov_b32 v118, v114
    v_mov_b32 v119, v115
    v_permlane32_swap_b32 v112, v116
    v_permlane32_swap_b32 v113, v117
    v_permlane32_swap_b32 v114, v118
    v_permlane32_swap_b32 v115, v119
    v_add_f32 v112, v112, v116
    v_add_f32 v113, v113, v117
    v_add_f32 v114, v114, v118
    v_add_f32 v115, v115, v119
    v_mov_b32 v116, v112
    v_mov_b32 v117, v113
    v_mov_b32 v118, v114
    v_mov_b32 v119, v115
    v_permlane16_swap_b32 v112, v116
    v_permlane16_swap_b32 v113, v117
    v_permlane16_swap_b32 v114, v118
    v_permlane16_swap_b32 v115, v119
    v_add_f32 v112, v112, v116
    v_add_f32 v113, v113, v117
    v_add_f32 v114, v114, v118
    v_add_f32 v115, v115, v119
    v_cvt_pk_bf16_f32 v116, v112, v113
    v_cvt_pk_bf16_f32 v117, v114, v115
    v_lshlrev_b32 v112, 16, v116
    v_and_b32 v113, 0xffff0000, v116
    v_lshlrev_b32 v114, 16, v117
    v_and_b32 v115, 0xffff0000, v117
    v_pk_mul_f32 v[112:113], v[112:113], v[60:61] op_sel_hi:[1,0]
    v_pk_mul_f32 v[114:115], v[114:115], v[60:61] op_sel_hi:[1,0]
    v_cvt_pk_bf16_f32 v116, v112, v113
    v_cvt_pk_bf16_f32 v117, v114, v115
    v_lshlrev_b32 v112, 16, v116
    v_and_b32 v113, 0xffff0000, v116
    v_lshlrev_b32 v114, 16, v117
    v_and_b32 v115, 0xffff0000, v117
    v_pk_add_f32 v[112:113], v[112:113], v[68:69]
    v_pk_add_f32 v[114:115], v[114:115], v[70:71]
    v_cvt_pk_bf16_f32 v116, v112, v113
    v_cvt_pk_bf16_f32 v117, v114, v115
    v_lshlrev_b32 v112, 16, v116
    v_and_b32 v113, 0xffff0000, v116
    v_lshlrev_b32 v114, 16, v117
    v_and_b32 v115, 0xffff0000, v117
    v_pk_add_f32 v[112:113], v[112:113], v[64:65]
    v_pk_add_f32 v[114:115], v[114:115], v[66:67]
    v_cvt_pk_bf16_f32 v116, v112, v113
    v_cvt_pk_bf16_f32 v117, v114, v115
    buffer_store_dwordx2 v[116:117], v11, s[24:27], 0 offen
L_fin_next:
    s_mov_b32 s60, s61
    s_add_u32 s63, s63, 1
    s_cmp_lt_u32 s63, 2
    s_cbranch_scc1 L_fin_loop
L_fin:
L_end:
    s_endpgm
L_b_restart:
    s_waitcnt vmcnt(0)
    v_xor_b32 v9, 0x8000, v7
    buffer_load_dwordx4 v[136:139], v7, s[8:11], 0 offen
    buffer_load_dwordx4 v[140:143], v9, s[8:11], 0 offen
    v_mov_b32 v8, s68
    s_mov_b32 s66, 0xffffaaaa
    s_mov_b32 s63, 1
    s_branch L_b_init
L_b_p0:
    v_mov_b32 v8, 0
    buffer_atomic_or v8, v159, s[16:19], 0 offen sc0 sc1
L_b_w0:
    s_waitcnt vmcnt(0)
    v_cmp_eq_u32 vcc, s68, v8
    s_nop 0
    s_lshr_b32 s65, vcc_lo, 1
    s_and_b32 s65, s65, vcc_lo
    s_andn2_b32 s65, s65, s66
    s_cbranch_scc0 L_b_q0
    s_or_b32 s66, s66, s65
    s_branch L_b_r0
L_b_q0:
    s_sub_u32 s56, s56, 1
    s_cbranch_scc0 L_b_p0
    s_mov_b32 s56, 0
    s_not_b32 s65, s66
    s_branch L_b_r0
L_b_p1:
    v_mov_b32 v8, 0
    buffer_atomic_or v8, v159, s[16:19], 0 offen sc0 sc1
    s_waitcnt vmcnt(0)
    v_cmp_eq_u32 vcc, s68, v8
    s_nop 0
    s_lshr_b32 s65, vcc_lo, 1
    s_and_b32 s65, s65, vcc_lo
    s_andn2_b32 s65, s65, s66
    s_cbranch_scc0 L_b_q1
    s_or_b32 s66, s66, s65
    s_branch L_b_r1
L_b_q1:
    s_sub_u32 s56, s56, 1
    s_cbranch_scc0 L_b_p1
    s_mov_b32 s56, 0
    s_not_b32 s65, s66
    s_branch L_b_r1
L_b_p2:
    v_mov_b32 v8, 0
    buffer_atomic_or v8, v159, s[16:19], 0 offen sc0 sc1
    s_waitcnt vmcnt(0)
    v_cmp_eq_u32 vcc, s68, v8
    s_nop 0
    s_lshr_b32 s65, vcc_lo, 1
    s_and_b32 s65, s65, vcc_lo
    s_andn2_b32 s65, s65, s66
    s_cbranch_scc0 L_b_q2
    s_or_b32 s66, s66, s65
    s_branch L_b_r2
L_b_q2:
    s_sub_u32 s56, s56, 1
    s_cbranch_scc0 L_b_p2
    s_mov_b32 s56, 0
    s_not_b32 s65, s66
    s_branch L_b_r2
L_b_p3:
    v_mov_b32 v8, 0
    buffer_atomic_or v8, v159, s[16:19], 0 offen sc0 sc1
    s_waitcnt vmcnt(0)
    v_cmp_eq_u32 vcc, s68, v8
    s_nop 0
    s_lshr_b32 s65, vcc_lo, 1
    s_and_b32 s65, s65, vcc_lo
    s_andn2_b32 s65, s65, s66
    s_cbranch_scc0 L_b_q3
    s_or_b32 s66, s66, s65
    s_branch L_b_r3
L_b_q3:
    s_sub_u32 s56, s56, 1
    s_cbranch_scc0 L_b_p3
    s_mov_b32 s56, 0
    s_not_b32 s65, s66
    s_branch L_b_r3
L_b_p4:
    v_mov_b32 v8, 0
    buffer_atomic_or v8, v159, s[16:19], 0 offen sc0 sc1
    s_waitcnt vmcnt(0)
    v_cmp_eq_u32 vcc, s68, v8
    s_nop 0
    s_lshr_b32 s65, vcc_lo, 1
    s_and_b32 s65, s65, vcc_lo
    s_andn2_b32 s65, s65, s66
    s_cbranch_scc0 L_b_q4
    s_or_b32 s66, s66, s65
    s_branch L_b_r4
L_b_q4:
    s_sub_u32 s56, s56, 1
    s_cbranch_scc0 L_b_p4
    s_mov_b32 s56, 0
    s_not_b32 s65, s66
    s_branch L_b_r4
L_b_p5:
    v_mov_b32 v8, 0
    buffer_atomic_or v8, v159, s[16:19], 0 offen sc0 sc1
    s_waitcnt vmcnt(0)
    v_cmp_eq_u32 vcc, s68, v8
    s_nop 0
    s_lshr_b32 s65, vcc_lo, 1
    s_and_b32 s65, s65, vcc_lo
    s_andn2_b32 s65, s65, s66
    s_cbranch_scc0 L_b_q5
    s_or_b32 s66, s66, s65
    s_branch L_b_r5
L_b_q5:
    s_sub_u32 s56, s56, 1
    s_cbranch_scc0 L_b_p5
    s_mov_b32 s56, 0
    s_not_b32 s65, s66
    s_branch L_b_r5
L_b_p6:
    v_mov_b32 v8, 0
    buffer_atomic_or v8, v159, s[16:19], 0 offen sc0 sc1
    s_waitcnt vmcnt(0)
    v_cmp_eq_u32 vcc, s68, v8
    s_nop 0
    s_lshr_b32 s65, vcc_lo, 1
    s_and_b32 s65, s65, vcc_lo
    s_andn2_b32 s65, s65, s66
    s_cbranch_scc0 L_b_q6
    s_or_b32 s66, s66, s65
    s_branch L_b_r6
L_b_q6:
    s_sub_u32 s56, s56, 1
    s_cbranch_scc0 L_b_p6
    s_mov_b32 s56, 0
    s_not_b32 s65, s66
    s_branch L_b_r6
L_b_p7:
    v_mov_b32 v8, 0
    buffer_atomic_or v8, v159, s[16:19], 0 offen sc0 sc1
    s_waitcnt vmcnt(0)
    v_cmp_eq_u32 vcc, s68, v8
    s_nop 0
    s_lshr_b32 s65, vcc_lo, 1
    s_and_b32 s65, s65, vcc_lo
    s_andn2_b32 s65, s65, s66
    s_cbranch_scc0 L_b_q7
    s_or_b32 s66, s66, s65
    s_branch L_b_r7
L_b_q7:
    s_sub_u32 s56, s56, 1
    s_cbranch_scc0 L_b_p7
    s_mov_b32 s56, 0
    s_not_b32 s65, s66
    s_branch L_b_r7
    s_endpgm
.section .rodata,"a"
.p2align 6
.amdhsa_kernel sequential_preLN__linear_attn_block__moe_arch_mod__prompt_kernel
  .amdhsa_next_free_vgpr 256
  .amdhsa_next_free_sgpr 102
  .amdhsa_accum_offset 256
  .amdhsa_group_segment_fixed_size 0
  .amdhsa_kernarg_size 88
  .amdhsa_user_sgpr_count 2
  .amdhsa_user_sgpr_kernarg_segment_ptr 1
  .amdhsa_system_sgpr_workgroup_id_x 1
.end_amdhsa_kernel
```

```asm
; @launch grid=(256,1,1) block=(512,1,1) lds=163840
.amdgcn_target "amdgcn-amd-amdhsa--gfx950"
.text
.globl sequential_preLN__linear_attn_block__moe_arch_mod__prompt_kernel
.p2align 8
.type sequential_preLN__linear_attn_block__moe_arch_mod__prompt_kernel,@function
sequential_preLN__linear_attn_block__moe_arch_mod__prompt_kernel:
    s_cmp_ge_u32 s2, 256
    s_cbranch_scc1 L_end
    s_load_dwordx16 s[64:79], s[0:1], 0
    s_load_dwordx4 s[80:83], s[0:1], 64
    s_load_dwordx2 s[84:85], s[0:1], 80
    v_lshrrev_b32 v1, 6, v0
    v_and_b32 v0, 63, v0
    v_readfirstlane_b32 s3, v1
    s_and_b32 s44, s2, 7
    s_lshr_b32 s45, s2, 3
    s_and_b32 s46, s44, 1
    s_lshl_b32 s46, s46, 3
    s_and_b32 s86, s45, 7
    s_add_u32 s46, s46, s86
    s_lshr_b32 s47, s44, 1
    s_lshl_b32 s47, s47, 2
    s_lshr_b32 s86, s45, 3
    s_add_u32 s47, s47, s86
    s_mov_b32 s51, s47
    s_mov_b32 s52, s46
    s_and_b32 s48, s3, 3
    s_and_b32 s49, s3, 1
    s_bfe_u32 s50, s3, 0x10001
    s_mov_b32 s56, 65536
    s_mov_b32 s95, 0x3f803f80
    s_movk_i32 s92, 0x1000
    s_movk_i32 s93, 0x2000
    s_movk_i32 s94, 0x3000
    s_cmp_lt_u32 s3, 4
    s_cbranch_scc1 L_comp
    v_lshrrev_b32 v20, 3, v0
    v_and_b32 v21, 7, v0
    v_lshrrev_b32 v22, 4, v0
    v_xor_b32 v23, v21, v22
    v_xor_b32 v24, 4, v23
    s_lshl_b32 s86, s48, 5
    v_add_u32 v25, s86, v20
    v_lshlrev_b32 v25, 11, v25
    v_lshl_add_u32 v2, v23, 4, v25
    v_lshl_add_u32 v3, v24, 4, v25
    v_add_u32 v3, 15360, v3
    v_lshl_add_u32 v4, v23, 4, v25
    v_add_u32 v4, 30720, v4
    v_lshl_add_u32 v5, v24, 4, v25
    v_add_u32 v5, 46080, v5
    s_lshl_b32 s86, s48, 4
    v_add_u32 v25, s86, v20
    v_mul_u32_u24 v25, 6144, v25
    s_lshl_b32 s86, s47, 7
    v_add_u32 v25, s86, v25
    v_bfe_u32 v26, v0, 4, 1
    v_lshlrev_b32 v26, 1, v26
    v_xor_b32 v26, v26, v21
    v_xor_b32 v27, 4, v26
    v_lshl_add_u32 v6, v26, 4, v25
    v_lshl_add_u32 v7, v27, 4, v25
    v_add_u32 v7, 48128, v7
    v_lshl_add_u32 v8, v26, 4, v25
    v_add_u32 v8, 2048, v8
    v_lshl_add_u32 v9, v27, 4, v25
    v_add_u32 v9, 50176, v9
    v_lshl_add_u32 v10, v26, 4, v25
    v_add_u32 v10, 4096, v10
    v_lshl_add_u32 v11, v27, 4, v25
    v_add_u32 v11, 52224, v11
    s_lshl_b32 s63, s46, 18
    s_lshl_b32 s53, s48, 12
    s_lshl_b32 s62, s48, 11
    s_add_u32 s62, s62, 16384
    s_setprio 1
    s_lshl_b32 s86, s45, 2
    s_add_u32 s86, s86, s48
    s_mul_i32 s87, s86, 12288
    s_and_b32 s88, s47, 12
    s_lshl_b32 s88, s88, 7
    s_add_u32 s87, s87, s88
    s_add_u32 s87, s87, 384
    s_bitcmp1_b32 s47, 2
    s_cselect_b32 s87, 2147483648, s87
    v_lshl_add_u32 v37, v0, 11, s87
    v_mov_b32 v24, 2147483648
    v_cmp_gt_u32 vcc, 6, v0
    s_nop 1
    v_cndmask_b32 v37, v24, v37, vcc
    s_lshl_b32 s86, s86, 14
    s_and_b32 s88, s46, 8
    s_lshl_b32 s88, s88, 7
    s_add_u32 s86, s86, s88
    s_add_u32 s86, s86, 384
    v_lshl_add_u32 v38, v0, 11, s86
    v_cmp_gt_u32 vcc, 8, v0
    s_nop 1
    v_cndmask_b32 v38, v24, v38, vcc
    s_waitcnt lgkmcnt(0)
    s_mov_b32 s8, s64
    s_and_b32 s9, s65, 0xffff
    s_mov_b32 s10, 4194304
    s_mov_b32 s11, 0x20000
    s_mov_b32 s12, s66
    s_and_b32 s13, s67, 0xffff
    s_mov_b32 s14, 6291456
    s_mov_b32 s15, 0x20000
    s_and_b32 s86, s47, 12
    s_and_b32 s87, s46, 8
    s_add_u32 s64, s86, s87
    s_and_b32 s64, s64, 15
    s_mov_b32 s67, s64
    s_load_dword s61, s[84:85], 524288
    s_lshr_b32 s90, s67, 2
    s_mul_i32 s90, s90, 1572864
    buffer_load_dword v39, v37, s[12:15], s90 offen
    s_add_u32 m0, s53, 40960
    s_lshl_b32 s70, s64, 7
    s_add_u32 s70, s70, s63
    buffer_load_dwordx4 v2, s[8:11], s70 offen offset:0 lds
    buffer_load_dwordx4 v3, s[8:11], s70 offen offset:1024 lds
    buffer_load_dwordx4 v4, s[8:11], s70 offen offset:2048 lds
    buffer_load_dwordx4 v5, s[8:11], s70 offen offset:3072 lds
    s_mul_i32 s91, s64, 393216
    s_add_u32 s64, s64, 1
    s_and_b32 s64, s64, 15
    s_add_u32 m0, s62, 40960
    s_nop 0
    buffer_load_dwordx4 v6, s[12:15], s91 offen offset:0 lds
    buffer_load_dwordx4 v7, s[12:15], s91 offen offset:1024 lds
    s_add_u32 m0, s62, 49152
    s_nop 0
    buffer_load_dwordx4 v8, s[12:15], s91 offen offset:0 lds
    buffer_load_dwordx4 v9, s[12:15], s91 offen offset:1024 lds
    s_add_u32 m0, s62, 57344
    s_nop 0
    buffer_load_dwordx4 v10, s[12:15], s91 offen offset:0 lds
    buffer_load_dwordx4 v11, s[12:15], s91 offen offset:1024 lds
    s_mov_b32 s16, s84
    s_and_b32 s17, s85, 0xffff
    s_mov_b32 s18, 268435456
    s_mov_b32 s19, 0x20000
    s_mov_b32 s20, s68
    s_and_b32 s21, s69, 0xffff
    s_mov_b32 s22, 2097152
    s_mov_b32 s23, 0x20000
    s_mov_b32 s24, s80
    s_and_b32 s25, s81, 0xffff
    s_mov_b32 s26, 4194304
    s_mov_b32 s27, 0x20000
    s_mov_b32 s28, s82
    s_and_b32 s29, s83, 0xffff
    s_mov_b32 s30, 256
    s_mov_b32 s31, 0x20000
    s_bitcmp1_b32 s2, 0
    s_cselect_b32 s32, s76, s74
    s_cselect_b32 s33, s77, s75
    s_and_b32 s33, s33, 0xffff
    s_mov_b32 s34, 7340032
    s_mov_b32 s35, 0x20000
    s_mov_b32 s36, s78
    s_and_b32 s37, s79, 0xffff
    s_mov_b32 s38, 7340032
    s_mov_b32 s39, 0x20000
    s_mov_b32 s40, s72
    s_and_b32 s41, s73, 0xffff
    s_mov_b32 s42, 2048
    s_mov_b32 s43, 0x20000
    v_lshrrev_b32 v22, 4, v0
    v_and_b32 v23, 15, v0
    s_lshl_b32 s86, s45, 2
    s_add_u32 s86, s86, s48
    s_mul_i32 s87, s86, 6
    v_mul_u32_u24 v24, 43, v0
    v_lshrrev_b32 v24, 8, v24
    v_mul_u32_u24 v25, 6, v24
    v_sub_u32 v25, v0, v25
    v_add_u32 v25, s87, v25
    s_add_u32 s87, s67, 2
    v_add_u32 v24, s87, v24
    v_and_b32 v24, 15, v24
    v_mul_u32_u24 v124, 393216, v24
    v_lshrrev_b32 v24, 2, v25
    v_lshl_add_u32 v124, v24, 11, v124
    v_and_b32 v25, 3, v25
    s_and_b32 s88, s47, 12
    v_add_u32 v25, s88, v25
    v_lshl_add_u32 v124, v25, 7, v124
    v_mov_b32 v24, 2147483648
    v_cmp_gt_u32 vcc, 36, v0
    s_nop 1
    v_cndmask_b32 v124, v24, v124, vcc
    v_add_u32 v24, s87, v20
    v_and_b32 v24, 15, v24
    s_and_b32 s88, s46, 8
    s_lshl4_add_u32 s86, s88, s86
    s_lshl_b32 s86, s86, 14
    v_lshl_add_u32 v123, v21, 11, s86
    v_lshl_add_u32 v123, v24, 7, v123
    v_mov_b32 v24, 2147483648
    v_cmp_gt_u32 vcc, 16, v0
    s_nop 1
    v_cndmask_b32 v123, v24, v123, vcc
    s_add_u32 m0, s53, 81920
    s_lshl_b32 s70, s64, 7
    s_add_u32 s70, s70, s63
    buffer_load_dwordx4 v2, s[8:11], s70 offen offset:0 lds
    buffer_load_dwordx4 v3, s[8:11], s70 offen offset:1024 lds
    buffer_load_dwordx4 v4, s[8:11], s70 offen offset:2048 lds
    buffer_load_dwordx4 v5, s[8:11], s70 offen offset:3072 lds
    s_mul_i32 s91, s64, 393216
    s_add_u32 s64, s64, 1
    s_and_b32 s64, s64, 15
    s_add_u32 m0, s62, 81920
    s_nop 0
    buffer_load_dwordx4 v6, s[12:15], s91 offen offset:0 lds
    buffer_load_dwordx4 v7, s[12:15], s91 offen offset:1024 lds
    s_add_u32 m0, s62, 90112
    s_nop 0
    buffer_load_dwordx4 v8, s[12:15], s91 offen offset:0 lds
    buffer_load_dwordx4 v9, s[12:15], s91 offen offset:1024 lds
    s_add_u32 m0, s62, 98304
    s_nop 0
    buffer_load_dwordx4 v10, s[12:15], s91 offen offset:0 lds
    buffer_load_dwordx4 v11, s[12:15], s91 offen offset:1024 lds
    buffer_load_dword v122, v123, s[8:11], 0 offen
    buffer_load_dword v122, v124, s[12:15], 0 offen
    s_and_b32 s65, s45, 7
    s_lshr_b32 s66, s45, 3
    s_add_u32 s86, s65, 1
    s_and_b32 s86, s86, 3
    s_mul_i32 s86, s86, 40960
    s_lshl_b32 s87, s48, 13
    s_cmp_eq_u32 s48, 3
    s_cselect_b32 s87, 0, s87
    s_add_u32 s86, s86, s87
    s_add_u32 s86, s86, 16384
    v_lshl_add_u32 v25, v20, 7, s86
    v_lshl_add_u32 v28, v26, 4, v25
    v_lshl_add_u32 v29, v27, 4, v25
    s_add_u32 s86, s66, 1
    s_and_b32 s86, s86, 3
    s_mul_i32 s86, s86, 40960
    s_add_u32 s86, s86, s53
    v_lshl_add_u32 v16, v0, 6, s86
    v_bfe_u32 v25, v0, 2, 2
    v_lshl_add_u32 v16, v25, 4, v16
    v_xor_b32 v17, 16, v16
    v_xor_b32 v18, 32, v16
    v_xor_b32 v19, 48, v16
    s_lshl_b32 s86, s46, 14
    s_lshl_b32 s87, s48, 8
    s_add_u32 s86, s86, s87
    s_add_u32 s86, s86, 262144
    v_lshl_add_u32 v33, v23, 4, s86
    v_lshl_add_u32 v33, v22, 10, v33
    s_lshl_b32 s87, s47, 10
    s_add_u32 s86, s86, s87
    v_lshl_add_u32 v13, v0, 2, s86
    v_and_b32 v25, 3, v0
    v_cmp_eq_u32 vcc, 0, v25
    v_mov_b32 v24, 2147483648
    s_nop 0
    v_cndmask_b32 v13, v24, v13, vcc
    s_mul_i32 s86, s47, 12288
    s_add_u32 s86, s86, 65536
    s_lshl_b32 s87, s48, 8
    s_cmp_eq_u32 s48, 3
    s_cselect_b32 s87, 2147483648, s87
    s_mov_b32 s88, 0
    s_add_u32 s86, s86, s87
    v_lshl_add_u32 v32, v23, 4, s86
    v_mul_u32_u24 v25, 768, v22
    v_add_u32 v32, v32, v25
    s_mul_i32 s87, s46, 768
    s_add_u32 s86, s86, s87
    s_add_u32 s86, s86, s88
    v_lshl_add_u32 v34, v23, 5, s86
    v_lshl_add_u32 v34, v22, 4, v34
    v_and_b32 v25, 0x28, v0
    v_cmp_eq_u32 vcc, 0, v25
    s_nop 1
    v_cndmask_b32 v34, v24, v34, vcc
    s_bfe_u32 s86, s2, 0x20001
    s_lshl_b32 s86, s86, 2
    s_add_u32 s86, s86, s48
    s_lshl_b32 s86, s86, 6
    v_lshl_add_u32 v30, v22, 4, s86
    v_mul_u32_u24 v30, 7168, v30
    s_lshl_b32 s86, s45, 1
    s_sub_u32 s86, s86, 14
    s_mul_i32 s87, s86, 37
    s_lshr_b32 s87, s87, 8
    s_add_u32 s80, s86, s87
    s_and_b32 s87, s80, 7
    s_cmp_ge_u32 s87, 3
    s_addc_u32 s80, s80, 0
    s_lshl_b32 s86, s45, 1
    s_sub_u32 s86, s86, 13
    s_mul_i32 s87, s86, 37
    s_lshr_b32 s87, s87, 8
    s_add_u32 s81, s86, s87
    s_and_b32 s87, s81, 7
    s_cmp_ge_u32 s87, 3
    s_addc_u32 s81, s81, 0
    s_lshl_b32 s86, s45, 3
    s_add_u32 s86, s86, 3
    s_cmp_lt_u32 s45, 7
    s_cselect_b32 s80, s86, s80
    s_cselect_b32 s81, 56, s81
    v_mov_b32 v24, s80
    v_mov_b32 v25, s81
    s_mov_b32 vcc_lo, 4278255360
    s_mov_b32 vcc_hi, vcc_lo
    v_cndmask_b32 v24, v24, v25, vcc
    v_cmp_gt_u32 vcc, 56, v24
    v_and_b32 v25, 7, v0
    v_lshlrev_b32 v24, 7, v24
    v_lshl_add_u32 v24, v25, 4, v24
    v_add_u32 v30, v30, v24
    v_mov_b32 v24, 2147483648
    v_cndmask_b32 v30, v24, v30, vcc
    s_mul_i32 s86, s45, 112
    s_mul_i32 s87, s48, 28
    s_add_u32 s86, s86, s87
    v_mul_u32_u24 v31, 7, v22
    v_add_u32 v31, s86, v31
    v_lshlrev_b32 v31, 11, v31
    s_lshl_b32 s86, s44, 8
    v_lshl_add_u32 v24, v23, 4, s86
    v_add_u32 v31, v31, v24
    v_lshlrev_b32 v24, 1, v22
    v_xor_b32 v24, v24, v21
    s_lshl_b32 s86, s48, 3
    v_add_u32 v12, s86, v20
    v_lshlrev_b32 v12, 11, v12
    s_lshl_b32 s86, s52, 7
    v_lshl_add_u32 v24, v24, 4, s86
    v_add_u32 v12, v12, v24
    s_lshl_b32 s89, s48, 10
    v_and_b32 v24, 1, v0
    v_lshlrev_b32 v24, 4, v24
    v_mov_b32 v25, 0x3f80
    v_lshlrev_b32 v24, v24, v25
    v_bfe_u32 v25, v0, 1, 2
    v_cmp_eq_u32 vcc, 0, v25
    s_nop 1
    v_cndmask_b32 v104, 0, v24, vcc
    v_cmp_eq_u32 vcc, 1, v25
    s_nop 1
    v_cndmask_b32 v105, 0, v24, vcc
    v_cmp_eq_u32 vcc, 2, v25
    s_nop 1
    v_cndmask_b32 v106, 0, v24, vcc
    v_cmp_eq_u32 vcc, 3, v25
    s_nop 1
    v_cndmask_b32 v107, 0, v24, vcc
    s_waitcnt lgkmcnt(0)
    s_add_u32 s68, s61, 0x9e3779b9
    v_mov_b32 v35, s68
    s_lshl_b32 s86, s46, 2
    s_add_u32 s86, s86, s48
    s_lshl_b32 s86, s86, 7
    s_add_u32 s86, s86, 655360
    s_lshl_b32 s87, s47, 2
    s_add_u32 s87, s87, s48
    s_lshl_b32 s87, s87, 7
    s_add_u32 s87, s87, 663552
    s_cmp_eq_u32 s48, 3
    s_cselect_b32 s87, 2147483648, s87
    s_cselect_b32 s76, 0xffff, -1
    s_mov_b32 s77, 0
    v_mov_b32 v24, s86
    v_mov_b32 v25, s87
    v_cmp_gt_u32 vcc, 16, v0
    s_nop 1
    v_cndmask_b32 v117, v25, v24, vcc
    v_lshl_add_u32 v117, v23, 2, v117
    v_mov_b32 v116, 2147483648
    v_cmp_gt_u32 vcc, 32, v0
    s_nop 1
    v_cndmask_b32 v117, v116, v117, vcc
    s_lshl2_add_u32 s86, s47, s86
    s_lshl2_add_u32 s87, s46, s87
    v_writelane_b32 v116, s86, 0
    v_writelane_b32 v116, s87, 1
    s_waitcnt vmcnt(12)
    s_barrier
    s_add_u32 m0, s53, 122880
    s_lshl_b32 s70, s64, 7
    s_add_u32 s70, s70, s63
    buffer_load_dwordx4 v2, s[8:11], s70 offen offset:0 lds
    buffer_load_dwordx4 v3, s[8:11], s70 offen offset:1024 lds
    buffer_load_dwordx4 v4, s[8:11], s70 offen offset:2048 lds
    buffer_load_dwordx4 v5, s[8:11], s70 offen offset:3072 lds
    s_mul_i32 s91, s64, 393216
    s_add_u32 s64, s64, 1
    s_and_b32 s64, s64, 15
    s_add_u32 m0, s62, 122880
    s_nop 0
    buffer_load_dwordx4 v6, s[12:15], s91 offen offset:0 lds
    buffer_load_dwordx4 v7, s[12:15], s91 offen offset:1024 lds
    s_add_u32 m0, s62, 131072
    s_nop 0
    buffer_load_dwordx4 v8, s[12:15], s91 offen offset:0 lds
    buffer_load_dwordx4 v9, s[12:15], s91 offen offset:1024 lds
    s_add_u32 m0, s62, 139264
    s_nop 0
    buffer_load_dwordx4 v10, s[12:15], s91 offen offset:0 lds
    buffer_load_dwordx4 v11, s[12:15], s91 offen offset:1024 lds
    s_cmp_lg_u32 s65, 0
    s_cbranch_scc1 L_h0c0
    ds_read_b128 v[40:43], v28 offset:0
    ds_read_b128 v[44:47], v29 offset:1024
    ds_read_b128 v[48:51], v28 offset:2048
    ds_read_b128 v[52:55], v29 offset:3072
    ds_read_b128 v[56:59], v28 offset:4096
    ds_read_b128 v[60:63], v29 offset:5120
    ds_read_b128 v[64:67], v28 offset:6144
    ds_read_b128 v[68:71], v29 offset:7168
L_h0c0:
    s_cmp_lg_u32 s66, 0
    s_cbranch_scc1 L_h0r0
    ds_read_b128 v[72:75], v16
    ds_read_b128 v[76:79], v17
    ds_read_b128 v[80:83], v18
    ds_read_b128 v[84:87], v19
L_h0r0:
    s_waitcnt lgkmcnt(0)
    s_waitcnt vmcnt(12)
    s_barrier
    s_add_u32 m0, s53, 0
    s_lshl_b32 s70, s64, 7
    s_add_u32 s70, s70, s63
    buffer_load_dwordx4 v2, s[8:11], s70 offen offset:0 lds
    buffer_load_dwordx4 v3, s[8:11], s70 offen offset:1024 lds
    buffer_load_dwordx4 v4, s[8:11], s70 offen offset:2048 lds
    buffer_load_dwordx4 v5, s[8:11], s70 offen offset:3072 lds
    s_mul_i32 s91, s64, 393216
    s_add_u32 s64, s64, 1
    s_and_b32 s64, s64, 15
    s_add_u32 m0, s62, 0
    s_nop 0
    buffer_load_dwordx4 v6, s[12:15], s91 offen offset:0 lds
    buffer_load_dwordx4 v7, s[12:15], s91 offen offset:1024 lds
    s_add_u32 m0, s62, 8192
    s_nop 0
    buffer_load_dwordx4 v8, s[12:15], s91 offen offset:0 lds
    buffer_load_dwordx4 v9, s[12:15], s91 offen offset:1024 lds
    s_add_u32 m0, s62, 16384
    s_nop 0
    buffer_load_dwordx4 v10, s[12:15], s91 offen offset:0 lds
    buffer_load_dwordx4 v11, s[12:15], s91 offen offset:1024 lds
    s_cmp_lg_u32 s65, 1
    s_cbranch_scc1 L_h0c1
    ds_read_b128 v[40:43], v28 offset:0
    ds_read_b128 v[44:47], v29 offset:1024
    ds_read_b128 v[48:51], v28 offset:2048
    ds_read_b128 v[52:55], v29 offset:3072
    ds_read_b128 v[56:59], v28 offset:4096
    ds_read_b128 v[60:63], v29 offset:5120
    ds_read_b128 v[64:67], v28 offset:6144
    ds_read_b128 v[68:71], v29 offset:7168
L_h0c1:
    s_cmp_lg_u32 s66, 1
    s_cbranch_scc1 L_h0r1
    ds_read_b128 v[72:75], v16
    ds_read_b128 v[76:79], v17
    ds_read_b128 v[80:83], v18
    ds_read_b128 v[84:87], v19
L_h0r1:
    s_waitcnt lgkmcnt(0)
    s_waitcnt vmcnt(10)
    s_barrier
    s_add_u32 m0, s53, 40960
    s_lshl_b32 s70, s64, 7
    s_add_u32 s70, s70, s63
    buffer_load_dwordx4 v2, s[8:11], s70 offen offset:0 lds
    buffer_load_dwordx4 v3, s[8:11], s70 offen offset:1024 lds
    buffer_load_dwordx4 v4, s[8:11], s70 offen offset:2048 lds
    buffer_load_dwordx4 v5, s[8:11], s70 offen offset:3072 lds
    s_mul_i32 s91, s64, 393216
    s_add_u32 s64, s64, 1
    s_and_b32 s64, s64, 15
    s_add_u32 m0, s62, 40960
    s_nop 0
    buffer_load_dwordx4 v6, s[12:15], s91 offen offset:0 lds
    buffer_load_dwordx4 v7, s[12:15], s91 offen offset:1024 lds
    s_add_u32 m0, s62, 49152
    s_nop 0
    buffer_load_dwordx4 v8, s[12:15], s91 offen offset:0 lds
    buffer_load_dwordx4 v9, s[12:15], s91 offen offset:1024 lds
    s_add_u32 m0, s62, 57344
    s_nop 0
    buffer_load_dwordx4 v10, s[12:15], s91 offen offset:0 lds
    buffer_load_dwordx4 v11, s[12:15], s91 offen offset:1024 lds
    s_cmp_lg_u32 s65, 2
    s_cbranch_scc1 L_h0c2
    ds_read_b128 v[40:43], v28 offset:0
    ds_read_b128 v[44:47], v29 offset:1024
    ds_read_b128 v[48:51], v28 offset:2048
    ds_read_b128 v[52:55], v29 offset:3072
    ds_read_b128 v[56:59], v28 offset:4096
    ds_read_b128 v[60:63], v29 offset:5120
    ds_read_b128 v[64:67], v28 offset:6144
    ds_read_b128 v[68:71], v29 offset:7168
L_h0c2:
    s_cmp_lg_u32 s66, 2
    s_cbranch_scc1 L_h0r2
    ds_read_b128 v[72:75], v16
    ds_read_b128 v[76:79], v17
    ds_read_b128 v[80:83], v18
    ds_read_b128 v[84:87], v19
L_h0r2:
    s_waitcnt lgkmcnt(0)
    s_waitcnt vmcnt(10)
    s_barrier
    s_add_u32 m0, s53, 81920
    s_lshl_b32 s70, s64, 7
    s_add_u32 s70, s70, s63
    buffer_load_dwordx4 v2, s[8:11], s70 offen offset:0 lds
    buffer_load_dwordx4 v3, s[8:11], s70 offen offset:1024 lds
    buffer_load_dwordx4 v4, s[8:11], s70 offen offset:2048 lds
    buffer_load_dwordx4 v5, s[8:11], s70 offen offset:3072 lds
    s_mul_i32 s91, s64, 393216
    s_add_u32 s64, s64, 1
    s_and_b32 s64, s64, 15
    s_add_u32 m0, s62, 81920
    s_nop 0
    buffer_load_dwordx4 v6, s[12:15], s91 offen offset:0 lds
    buffer_load_dwordx4 v7, s[12:15], s91 offen offset:1024 lds
    s_add_u32 m0, s62, 90112
    s_nop 0
    buffer_load_dwordx4 v8, s[12:15], s91 offen offset:0 lds
    buffer_load_dwordx4 v9, s[12:15], s91 offen offset:1024 lds
    s_add_u32 m0, s62, 98304
    s_nop 0
    buffer_load_dwordx4 v10, s[12:15], s91 offen offset:0 lds
    buffer_load_dwordx4 v11, s[12:15], s91 offen offset:1024 lds
    s_lshr_b32 s90, s67, 2
    s_add_u32 s90, s90, 2
    s_and_b32 s90, s90, 3
    s_mul_i32 s90, s90, 1572864
    buffer_load_dword v39, v37, s[12:15], s90 offen
    s_cmp_lg_u32 s65, 3
    s_cbranch_scc1 L_h0c3
    ds_read_b128 v[40:43], v28 offset:0
    ds_read_b128 v[44:47], v29 offset:1024
    ds_read_b128 v[48:51], v28 offset:2048
    ds_read_b128 v[52:55], v29 offset:3072
    ds_read_b128 v[56:59], v28 offset:4096
    ds_read_b128 v[60:63], v29 offset:5120
    ds_read_b128 v[64:67], v28 offset:6144
    ds_read_b128 v[68:71], v29 offset:7168
L_h0c3:
    s_cmp_lg_u32 s66, 3
    s_cbranch_scc1 L_h0r3
    ds_read_b128 v[72:75], v16
    ds_read_b128 v[76:79], v17
    ds_read_b128 v[80:83], v18
    ds_read_b128 v[84:87], v19
L_h0r3:
    s_waitcnt lgkmcnt(0)
    s_waitcnt vmcnt(11)
    s_barrier
    s_add_u32 m0, s53, 122880
    s_lshl_b32 s70, s64, 7
    s_add_u32 s70, s70, s63
    buffer_load_dwordx4 v2, s[8:11], s70 offen offset:0 lds
    buffer_load_dwordx4 v3, s[8:11], s70 offen offset:1024 lds
    buffer_load_dwordx4 v4, s[8:11], s70 offen offset:2048 lds
    buffer_load_dwordx4 v5, s[8:11], s70 offen offset:3072 lds
    s_mul_i32 s91, s64, 393216
    s_add_u32 s64, s64, 1
    s_and_b32 s64, s64, 15
    s_add_u32 m0, s62, 122880
    s_nop 0
    buffer_load_dwordx4 v6, s[12:15], s91 offen offset:0 lds
    buffer_load_dwordx4 v7, s[12:15], s91 offen offset:1024 lds
    s_add_u32 m0, s62, 131072
    s_nop 0
    buffer_load_dwordx4 v8, s[12:15], s91 offen offset:0 lds
    buffer_load_dwordx4 v9, s[12:15], s91 offen offset:1024 lds
    s_add_u32 m0, s62, 139264
    s_nop 0
    buffer_load_dwordx4 v10, s[12:15], s91 offen offset:0 lds
    buffer_load_dwordx4 v11, s[12:15], s91 offen offset:1024 lds
    s_cmp_lg_u32 s65, 4
    s_cbranch_scc1 L_h0c4
    ds_read_b128 v[40:43], v28 offset:0
    ds_read_b128 v[44:47], v29 offset:1024
    ds_read_b128 v[48:51], v28 offset:2048
    ds_read_b128 v[52:55], v29 offset:3072
    ds_read_b128 v[56:59], v28 offset:4096
    ds_read_b128 v[60:63], v29 offset:5120
    ds_read_b128 v[64:67], v28 offset:6144
    ds_read_b128 v[68:71], v29 offset:7168
L_h0c4:
    s_waitcnt lgkmcnt(0)
    v_mov_b32 v88, 0
    v_mov_b32 v89, 0
    v_mov_b32 v90, 0
    v_mov_b32 v91, 0
    v_mov_b32 v92, 0
    v_mov_b32 v93, 0
    v_mov_b32 v94, 0
    v_mov_b32 v95, 0
    v_dot2c_f32_bf16 v88, s95, v72
    v_dot2c_f32_bf16 v89, s95, v73
    v_dot2c_f32_bf16 v90, s95, v74
    v_dot2c_f32_bf16 v91, s95, v75
    v_dot2c_f32_bf16 v92, v72, v72
    v_dot2c_f32_bf16 v93, v73, v73
    v_dot2c_f32_bf16 v94, v74, v74
    v_dot2c_f32_bf16 v95, v75, v75
    v_dot2c_f32_bf16 v88, s95, v76
    v_dot2c_f32_bf16 v89, s95, v77
    v_dot2c_f32_bf16 v90, s95, v78
    v_dot2c_f32_bf16 v91, s95, v79
    v_dot2c_f32_bf16 v92, v76, v76
    v_dot2c_f32_bf16 v93, v77, v77
    v_dot2c_f32_bf16 v94, v78, v78
    v_dot2c_f32_bf16 v95, v79, v79
    v_dot2c_f32_bf16 v88, s95, v80
    v_dot2c_f32_bf16 v89, s95, v81
    v_dot2c_f32_bf16 v90, s95, v82
    v_dot2c_f32_bf16 v91, s95, v83
    v_dot2c_f32_bf16 v92, v80, v80
    v_dot2c_f32_bf16 v93, v81, v81
    v_dot2c_f32_bf16 v94, v82, v82
    v_dot2c_f32_bf16 v95, v83, v83
    v_dot2c_f32_bf16 v88, s95, v84
    v_dot2c_f32_bf16 v89, s95, v85
    v_dot2c_f32_bf16 v90, s95, v86
    v_dot2c_f32_bf16 v91, s95, v87
    v_dot2c_f32_bf16 v92, v84, v84
    v_dot2c_f32_bf16 v93, v85, v85
    v_dot2c_f32_bf16 v94, v86, v86
    v_dot2c_f32_bf16 v95, v87, v87
    s_waitcnt vmcnt(11)
    s_barrier
    s_add_u32 m0, s53, 0
    s_lshl_b32 s70, s64, 7
    s_add_u32 s70, s70, s63
    buffer_load_dwordx4 v2, s[8:11], s70 offen offset:0 lds
    buffer_load_dwordx4 v3, s[8:11], s70 offen offset:1024 lds
    buffer_load_dwordx4 v4, s[8:11], s70 offen offset:2048 lds
    buffer_load_dwordx4 v5, s[8:11], s70 offen offset:3072 lds
    s_mul_i32 s91, s64, 393216
    s_add_u32 s64, s64, 1
    s_and_b32 s64, s64, 15
    s_add_u32 m0, s62, 0
    s_nop 0
    buffer_load_dwordx4 v6, s[12:15], s91 offen offset:0 lds
    buffer_load_dwordx4 v7, s[12:15], s91 offen offset:1024 lds
    s_add_u32 m0, s62, 8192
    s_nop 0
    buffer_load_dwordx4 v8, s[12:15], s91 offen offset:0 lds
    buffer_load_dwordx4 v9, s[12:15], s91 offen offset:1024 lds
    s_add_u32 m0, s62, 16384
    s_nop 0
    buffer_load_dwordx4 v10, s[12:15], s91 offen offset:0 lds
    buffer_load_dwordx4 v11, s[12:15], s91 offen offset:1024 lds
    buffer_load_dword v39, v38, s[20:23], 0 offen
    s_cmp_lg_u32 s65, 5
    s_cbranch_scc1 L_h0c5
    ds_read_b128 v[40:43], v28 offset:0
    ds_read_b128 v[44:47], v29 offset:1024
    ds_read_b128 v[48:51], v28 offset:2048
    ds_read_b128 v[52:55], v29 offset:3072
    ds_read_b128 v[56:59], v28 offset:4096
    ds_read_b128 v[60:63], v29 offset:5120
    ds_read_b128 v[64:67], v28 offset:6144
    ds_read_b128 v[68:71], v29 offset:7168
L_h0c5:
    s_waitcnt lgkmcnt(0)
    v_pk_add_f32 v[88:89], v[88:89], v[90:91]
    v_pk_add_f32 v[92:93], v[92:93], v[94:95]
    v_add_f32 v88, v88, v89
    v_add_f32 v89, v92, v93
    s_nop 0
    v_add_f32_dpp v88, v88, v88 quad_perm:[1,0,3,2] row_mask:0xf bank_mask:0xf
    v_add_f32_dpp v89, v89, v89 quad_perm:[1,0,3,2] row_mask:0xf bank_mask:0xf
    s_nop 0
    v_mov_b32_dpp v90, v88 quad_perm:[2,2,2,2] row_mask:0xf bank_mask:0xf
    v_mov_b32_dpp v91, v89 quad_perm:[2,2,2,2] row_mask:0xf bank_mask:0xf
    buffer_store_dwordx4 v[88:91], v13, s[16:19], 0 offen sc1
    s_lshl_b32 s86, s48, 7
    s_add_u32 s86, s86, 131072
    v_lshl_add_u32 v16, v23, 3, s86
    v_lshrrev_b32 v17, 5, v0
    v_lshl_add_u32 v16, v17, 2, v16
    s_lshl_b32 s86, s48, 8
    s_add_u32 s86, s86, 132608
    v_lshl_add_u32 v17, v23, 4, s86
    v_lshl_add_u32 v17, v22, 2, v17
    s_waitcnt vmcnt(12)
    s_barrier
    s_add_u32 m0, s53, 40960
    s_lshl_b32 s70, s64, 7
    s_add_u32 s70, s70, s63
    buffer_load_dwordx4 v2, s[8:11], s70 offen offset:0 lds
    buffer_load_dwordx4 v3, s[8:11], s70 offen offset:1024 lds
    buffer_load_dwordx4 v4, s[8:11], s70 offen offset:2048 lds
    buffer_load_dwordx4 v5, s[8:11], s70 offen offset:3072 lds
    s_mul_i32 s91, s64, 393216
    s_add_u32 s64, s64, 1
    s_and_b32 s64, s64, 15
    s_add_u32 m0, s62, 40960
    s_nop 0
    buffer_load_dwordx4 v6, s[12:15], s91 offen offset:0 lds
    buffer_load_dwordx4 v7, s[12:15], s91 offen offset:1024 lds
    s_add_u32 m0, s62, 49152
    s_nop 0
    buffer_load_dwordx4 v8, s[12:15], s91 offen offset:0 lds
    buffer_load_dwordx4 v9, s[12:15], s91 offen offset:1024 lds
    s_add_u32 m0, s62, 57344
    s_nop 0
    buffer_load_dwordx4 v10, s[12:15], s91 offen offset:0 lds
    buffer_load_dwordx4 v11, s[12:15], s91 offen offset:1024 lds
    s_lshr_b32 s90, s67, 2
    s_add_u32 s90, s90, 3
    s_and_b32 s90, s90, 3
    s_mul_i32 s90, s90, 1572864
    buffer_load_dword v39, v37, s[12:15], s90 offen
    s_cmp_lg_u32 s65, 6
    s_cbranch_scc1 L_h0c6
    ds_read_b128 v[40:43], v28 offset:0
    ds_read_b128 v[44:47], v29 offset:1024
    ds_read_b128 v[48:51], v28 offset:2048
    ds_read_b128 v[52:55], v29 offset:3072
    ds_read_b128 v[56:59], v28 offset:4096
    ds_read_b128 v[60:63], v29 offset:5120
    ds_read_b128 v[64:67], v28 offset:6144
    ds_read_b128 v[68:71], v29 offset:7168
L_h0c6:
    s_waitcnt lgkmcnt(0)
    s_waitcnt vmcnt(13)
    s_barrier
    s_add_u32 m0, s53, 81920
    s_lshl_b32 s70, s64, 7
    s_add_u32 s70, s70, s63
    buffer_load_dwordx4 v2, s[8:11], s70 offen offset:0 lds
    buffer_load_dwordx4 v3, s[8:11], s70 offen offset:1024 lds
    buffer_load_dwordx4 v4, s[8:11], s70 offen offset:2048 lds
    buffer_load_dwordx4 v5, s[8:11], s70 offen offset:3072 lds
    s_mul_i32 s91, s64, 393216
    s_add_u32 s64, s64, 1
    s_and_b32 s64, s64, 15
    s_add_u32 m0, s62, 81920
    s_nop 0
    buffer_load_dwordx4 v6, s[12:15], s91 offen offset:0 lds
    buffer_load_dwordx4 v7, s[12:15], s91 offen offset:1024 lds
    s_add_u32 m0, s62, 90112
    s_nop 0
    buffer_load_dwordx4 v8, s[12:15], s91 offen offset:0 lds
    buffer_load_dwordx4 v9, s[12:15], s91 offen offset:1024 lds
    s_add_u32 m0, s62, 98304
    s_nop 0
    buffer_load_dwordx4 v10, s[12:15], s91 offen offset:0 lds
    buffer_load_dwordx4 v11, s[12:15], s91 offen offset:1024 lds
    s_add_u32 m0, s53, 122880
    s_lshl_b32 s70, s64, 7
    s_add_u32 s70, s70, s63
    buffer_load_dwordx4 v2, s[8:11], s70 offen offset:0 lds
    buffer_load_dwordx4 v3, s[8:11], s70 offen offset:1024 lds
    s_cmp_lg_u32 s65, 7
    s_cbranch_scc1 L_h0c7
    ds_read_b128 v[40:43], v28 offset:0
    ds_read_b128 v[44:47], v29 offset:1024
    ds_read_b128 v[48:51], v28 offset:2048
    ds_read_b128 v[52:55], v29 offset:3072
    ds_read_b128 v[56:59], v28 offset:4096
    ds_read_b128 v[60:63], v29 offset:5120
    ds_read_b128 v[64:67], v28 offset:6144
    ds_read_b128 v[68:71], v29 offset:7168
L_h0c7:
    s_waitcnt lgkmcnt(0)
    s_waitcnt vmcnt(13)
    s_barrier
    s_add_u32 m0, s53, 122880
    s_nop 0
    buffer_load_dwordx4 v4, s[8:11], s70 offen offset:2048 lds
    buffer_load_dwordx4 v5, s[8:11], s70 offen offset:3072 lds
    s_mul_i32 s91, s64, 393216
    s_add_u32 s64, s64, 1
    s_and_b32 s64, s64, 15
    s_add_u32 m0, s62, 122880
    s_nop 0
    buffer_load_dwordx4 v6, s[12:15], s91 offen offset:0 lds
    buffer_load_dwordx4 v7, s[12:15], s91 offen offset:1024 lds
    s_add_u32 m0, s62, 131072
    s_nop 0
    buffer_load_dwordx4 v8, s[12:15], s91 offen offset:0 lds
    buffer_load_dwordx4 v9, s[12:15], s91 offen offset:1024 lds
    s_add_u32 m0, s62, 139264
    s_nop 0
    buffer_load_dwordx4 v10, s[12:15], s91 offen offset:0 lds
    buffer_load_dwordx4 v11, s[12:15], s91 offen offset:1024 lds
    s_add_u32 m0, s53, 0
    s_lshl_b32 s70, s64, 7
    s_add_u32 s70, s70, s63
    buffer_load_dwordx4 v2, s[8:11], s70 offen offset:0 lds
    buffer_load_dwordx4 v3, s[8:11], s70 offen offset:1024 lds
    v_mfma_f32_16x16x32_bf16 v[108:111], v[104:107], v[40:43], 0
    v_mfma_f32_16x16x32_bf16 v[108:111], v[104:107], v[44:47], v[108:111]
    v_mfma_f32_16x16x32_bf16 v[108:111], v[104:107], v[48:51], v[108:111]
    v_mfma_f32_16x16x32_bf16 v[108:111], v[104:107], v[52:55], v[108:111]
    v_mfma_f32_16x16x32_bf16 v[108:111], v[104:107], v[56:59], v[108:111]
    v_mfma_f32_16x16x32_bf16 v[108:111], v[104:107], v[60:63], v[108:111]
    v_mfma_f32_16x16x32_bf16 v[108:111], v[104:107], v[64:67], v[108:111]
    v_mfma_f32_16x16x32_bf16 v[108:111], v[104:107], v[68:71], v[108:111]
    s_nop 7
    v_add_f32_dpp v108, v108, v108 row_ror:8 row_mask:0xf bank_mask:0xf
    v_add_f32_dpp v109, v109, v109 row_ror:8 row_mask:0xf bank_mask:0xf
    v_add_f32_dpp v110, v110, v110 row_ror:8 row_mask:0xf bank_mask:0xf
    v_add_f32_dpp v111, v111, v111 row_ror:8 row_mask:0xf bank_mask:0xf
    buffer_store_dwordx4 v[108:111], v34, s[16:19], 0 offen sc1
    s_waitcnt vmcnt(13)
    s_barrier
    s_add_u32 m0, s53, 0
    s_nop 0
    buffer_load_dwordx4 v4, s[8:11], s70 offen offset:2048 lds
    buffer_load_dwordx4 v5, s[8:11], s70 offen offset:3072 lds
    s_mul_i32 s91, s64, 393216
    s_add_u32 s64, s64, 1
    s_and_b32 s64, s64, 15
    s_add_u32 m0, s62, 0
    s_nop 0
    buffer_load_dwordx4 v6, s[12:15], s91 offen offset:0 lds
    buffer_load_dwordx4 v7, s[12:15], s91 offen offset:1024 lds
    s_add_u32 m0, s62, 8192
    s_nop 0
    buffer_load_dwordx4 v8, s[12:15], s91 offen offset:0 lds
    buffer_load_dwordx4 v9, s[12:15], s91 offen offset:1024 lds
    s_add_u32 m0, s62, 16384
    s_nop 0
    buffer_load_dwordx4 v10, s[12:15], s91 offen offset:0 lds
    buffer_load_dwordx4 v11, s[12:15], s91 offen offset:1024 lds
    s_add_u32 m0, s53, 40960
    s_lshl_b32 s70, s64, 7
    s_add_u32 s70, s70, s63
    buffer_load_dwordx4 v2, s[8:11], s70 offen offset:0 lds
    buffer_load_dwordx4 v3, s[8:11], s70 offen offset:1024 lds
    buffer_load_dwordx4 v4, s[8:11], s70 offen offset:2048 lds
    buffer_load_dwordx4 v5, s[8:11], s70 offen offset:3072 lds
    s_mul_i32 s91, s64, 393216
    s_add_u32 s64, s64, 1
    s_and_b32 s64, s64, 15
    s_waitcnt vmcnt(12)
    s_barrier
    buffer_atomic_swap v35, v116, s[16:19], 0 offen sc1
    s_add_u32 m0, s62, 40960
    s_nop 0
    buffer_load_dwordx4 v6, s[12:15], s91 offen offset:0 lds
    buffer_load_dwordx4 v7, s[12:15], s91 offen offset:1024 lds
    s_add_u32 m0, s62, 49152
    s_nop 0
    buffer_load_dwordx4 v8, s[12:15], s91 offen offset:0 lds
    buffer_load_dwordx4 v9, s[12:15], s91 offen offset:1024 lds
    s_add_u32 m0, s62, 57344
    s_nop 0
    buffer_load_dwordx4 v10, s[12:15], s91 offen offset:0 lds
    buffer_load_dwordx4 v11, s[12:15], s91 offen offset:1024 lds
    s_add_u32 m0, s53, 81920
    s_lshl_b32 s70, s64, 7
    s_add_u32 s70, s70, s63
    buffer_load_dwordx4 v2, s[8:11], s70 offen offset:0 lds
    buffer_load_dwordx4 v3, s[8:11], s70 offen offset:1024 lds
    buffer_load_dwordx4 v4, s[8:11], s70 offen offset:2048 lds
    buffer_load_dwordx4 v5, s[8:11], s70 offen offset:3072 lds
    s_mul_i32 s91, s64, 393216
    s_add_u32 s64, s64, 1
    s_and_b32 s64, s64, 15
    s_add_u32 m0, s62, 81920
    s_nop 0
    buffer_load_dwordx4 v6, s[12:15], s91 offen offset:0 lds
    buffer_load_dwordx4 v7, s[12:15], s91 offen offset:1024 lds
    s_waitcnt vmcnt(17)
    s_barrier
    s_add_u32 m0, s62, 90112
    s_nop 0
    buffer_load_dwordx4 v8, s[12:15], s91 offen offset:0 lds
    buffer_load_dwordx4 v9, s[12:15], s91 offen offset:1024 lds
    s_add_u32 m0, s62, 98304
    s_nop 0
    buffer_load_dwordx4 v10, s[12:15], s91 offen offset:0 lds
    buffer_load_dwordx4 v11, s[12:15], s91 offen offset:1024 lds
    s_add_u32 m0, s53, 122880
    s_lshl_b32 s70, s64, 7
    s_add_u32 s70, s70, s63
    buffer_load_dwordx4 v2, s[8:11], s70 offen offset:0 lds
    buffer_load_dwordx4 v3, s[8:11], s70 offen offset:1024 lds
    buffer_load_dwordx4 v4, s[8:11], s70 offen offset:2048 lds
    buffer_load_dwordx4 v5, s[8:11], s70 offen offset:3072 lds
    s_mul_i32 s91, s64, 393216
    s_add_u32 s64, s64, 1
    s_and_b32 s64, s64, 15
    s_add_u32 m0, s62, 122880
    s_nop 0
    buffer_load_dwordx4 v6, s[12:15], s91 offen offset:0 lds
    buffer_load_dwordx4 v7, s[12:15], s91 offen offset:1024 lds
    s_add_u32 m0, s62, 131072
    s_nop 0
    buffer_load_dwordx4 v8, s[12:15], s91 offen offset:0 lds
    buffer_load_dwordx4 v9, s[12:15], s91 offen offset:1024 lds
    s_waitcnt vmcnt(18)
    s_barrier
    s_add_u32 m0, s62, 139264
    s_nop 0
    buffer_load_dwordx4 v10, s[12:15], s91 offen offset:0 lds
    buffer_load_dwordx4 v11, s[12:15], s91 offen offset:1024 lds
    s_add_u32 m0, s53, 0
    s_lshl_b32 s70, s64, 7
    s_add_u32 s70, s70, s63
    buffer_load_dwordx4 v2, s[8:11], s70 offen offset:0 lds
    buffer_load_dwordx4 v3, s[8:11], s70 offen offset:1024 lds
    buffer_load_dwordx4 v4, s[8:11], s70 offen offset:2048 lds
    buffer_load_dwordx4 v5, s[8:11], s70 offen offset:3072 lds
    s_mul_i32 s91, s64, 393216
    s_add_u32 s64, s64, 1
    s_and_b32 s64, s64, 15
    s_add_u32 m0, s62, 0
    s_nop 0
    buffer_load_dwordx4 v6, s[12:15], s91 offen offset:0 lds
    buffer_load_dwordx4 v7, s[12:15], s91 offen offset:1024 lds
    s_add_u32 m0, s62, 8192
    s_nop 0
    buffer_load_dwordx4 v8, s[12:15], s91 offen offset:0 lds
    buffer_load_dwordx4 v9, s[12:15], s91 offen offset:1024 lds
    s_add_u32 m0, s62, 16384
    s_nop 0
    buffer_load_dwordx4 v10, s[12:15], s91 offen offset:0 lds
    buffer_load_dwordx4 v11, s[12:15], s91 offen offset:1024 lds
    s_waitcnt vmcnt(20)
    s_barrier
    v_mov_b32 v118, 0
    buffer_atomic_or v118, v117, s[16:19], 0 offen sc0 sc1
    s_add_u32 m0, s89, 40960
    s_mov_b32 s90, 655360
    buffer_load_dwordx4 v12, s[20:23], s90 offen lds
    s_add_u32 m0, s89, 45056
    s_mov_b32 s90, 720896
    buffer_load_dwordx4 v12, s[20:23], s90 offen lds
    s_add_u32 m0, s89, 49152
    s_mov_b32 s90, 786432
    buffer_load_dwordx4 v12, s[20:23], s90 offen lds
    s_add_u32 m0, s89, 53248
    s_mov_b32 s90, 851968
    buffer_load_dwordx4 v12, s[20:23], s90 offen lds
    s_mov_b32 s90, 0
    buffer_load_dwordx4 v[164:167], v30, s[32:35], s90 offen
    s_mov_b32 s90, 7168
    buffer_load_dwordx4 v[168:171], v30, s[32:35], s90 offen
    s_mov_b32 s90, 14336
    buffer_load_dwordx4 v[172:175], v30, s[32:35], s90 offen
    s_mov_b32 s90, 21504
    buffer_load_dwordx4 v[176:179], v30, s[32:35], s90 offen
    s_waitcnt vmcnt(19)
    s_barrier
    s_waitcnt vmcnt(8)
    s_branch L_h0_chk0
L_h0_spin:
    v_mov_b32 v118, 0
    buffer_atomic_or v118, v117, s[16:19], 0 offen sc0 sc1
    s_waitcnt vmcnt(0)
L_h0_chk0:
    v_cmp_ne_u32 vcc, s68, v118
    s_nop 0
    s_and_b64 vcc, vcc, s[76:77]
    s_cbranch_vccz L_ok_1
    s_sub_u32 s56, s56, 1
    s_cbranch_scc0 L_h0_spin
    s_mov_b32 s56, 0
L_ok_1:
    s_mov_b32 s90, 0
    buffer_load_dwordx4 v[40:43], v32, s[16:19], s90 offen sc1
    s_mov_b32 s90, 3072
    buffer_load_dwordx4 v[44:47], v32, s[16:19], s90 offen sc1
    s_mov_b32 s90, 6144
    buffer_load_dwordx4 v[48:51], v32, s[16:19], s90 offen sc1
    s_mov_b32 s90, 9216
    buffer_load_dwordx4 v[52:55], v32, s[16:19], s90 offen sc1
    buffer_load_dwordx4 v[56:59], v33, s[16:19], 0 offen sc1
    buffer_load_dwordx4 v[60:63], v33, s[16:19], s92 offen sc1
    buffer_load_dwordx4 v[64:67], v33, s[16:19], s93 offen sc1
    buffer_load_dwordx4 v[68:71], v33, s[16:19], s94 offen sc1
    s_mov_b32 s90, 28672
    buffer_load_dwordx4 v[180:183], v30, s[32:35], s90 offen
    s_mov_b32 s90, 35840
    buffer_load_dwordx4 v[184:187], v30, s[32:35], s90 offen
    s_mov_b32 s90, 43008
    buffer_load_dwordx4 v[188:191], v30, s[32:35], s90 offen
    s_waitcnt vmcnt(20)
    s_barrier
    v_mov_b32 v24, 135168
    v_lshl_add_u32 v24, v21, 2, v24
    v_mov_b32 v25, 0
    ds_write_b32 v24, v25
    s_add_u32 m0, s89, 57344
    s_mov_b32 s90, 917504
    buffer_load_dwordx4 v12, s[20:23], s90 offen lds
    s_add_u32 m0, s89, 61440
    s_mov_b32 s90, 983040
    buffer_load_dwordx4 v12, s[20:23], s90 offen lds
    s_add_u32 m0, s89, 65536
    s_mov_b32 s90, 1048576
    buffer_load_dwordx4 v12, s[20:23], s90 offen lds
    s_add_u32 m0, s89, 69632
    s_mov_b32 s90, 1114112
    buffer_load_dwordx4 v12, s[20:23], s90 offen lds
    s_add_u32 m0, s89, 73728
    s_mov_b32 s90, 1179648
    buffer_load_dwordx4 v12, s[20:23], s90 offen lds
    s_add_u32 m0, s89, 77824
    s_mov_b32 s90, 1245184
    buffer_load_dwordx4 v12, s[20:23], s90 offen lds
    s_waitcnt vmcnt(9)
    v_add_f32 v40, v40, v44
    v_add_f32 v41, v41, v45
    v_add_f32 v42, v42, v46
    v_add_f32 v43, v43, v47
    v_add_f32 v40, v40, v48
    v_add_f32 v41, v41, v49
    v_add_f32 v42, v42, v50
    v_add_f32 v43, v43, v51
    v_add_f32 v40, v40, v52
    v_add_f32 v41, v41, v53
    v_add_f32 v42, v42, v54
    v_add_f32 v43, v43, v55
    v_add_f32 v56, v56, v60
    v_add_f32 v57, v57, v61
    v_add_f32 v58, v58, v62
    v_add_f32 v59, v59, v63
    v_add_f32 v56, v56, v64
    v_add_f32 v57, v57, v65
    v_add_f32 v58, v58, v66
    v_add_f32 v59, v59, v67
    v_add_f32 v56, v56, v68
    v_add_f32 v57, v57, v69
    v_add_f32 v58, v58, v70
    v_add_f32 v59, v59, v71
    s_nop 0
    v_permlane32_swap_b32 v56, v58
    v_permlane32_swap_b32 v57, v59
    v_permlane32_swap_b32 v40, v42
    v_permlane32_swap_b32 v41, v43
    v_add_f32 v56, v56, v58
    v_add_f32 v57, v57, v59
    v_add_f32 v40, v40, v42
    v_add_f32 v41, v41, v43
    v_mov_b32 v58, v56
    v_mov_b32 v59, v57
    v_permlane16_swap_b32 v40, v41
    v_permlane16_swap_b32 v56, v58
    v_permlane16_swap_b32 v57, v59
    v_add_f32 v40, v40, v41
    v_add_f32 v56, v56, v58
    v_add_f32 v57, v57, v59
    ds_write_b32 v17, v40
    v_mul_f32 v56, 0x3a800000, v56
    v_mul_f32 v57, 0x3a800000, v57
    v_fma_f32 v57, -v56, v56, v57
    v_max_f32 v57, 0, v57
    v_cvt_pk_bf16_f32 v48, v56, v57
    v_lshlrev_b32 v44, 16, v48
    v_and_b32 v48, 0xffff0000, v48
    v_add_f32 v48, 0x3727c5ac, v48
    v_cvt_pk_bf16_f32 v48, v48, v48
    v_lshlrev_b32 v48, 16, v48
    v_sqrt_f32 v48, v48
    s_nop 0
    v_cvt_pk_bf16_f32 v48, v48, v48
    v_lshlrev_b32 v48, 16, v48
    v_rcp_f32 v46, v48
    v_sub_f32 v44, 0, v44
    v_mul_f32 v48, 0x3fb8aa3b, v46
    ds_write_b32 v16, v44
    ds_write_b32 v16, v46 offset:512
    ds_write_b32 v16, v48 offset:1024
    s_waitcnt lgkmcnt(0)
    s_barrier
    s_setprio 0
    s_add_u32 m0, s89, 81920
    s_mov_b32 s90, 1310720
    buffer_load_dwordx4 v12, s[20:23], s90 offen lds
    s_add_u32 m0, s89, 86016
    s_mov_b32 s90, 1376256
    buffer_load_dwordx4 v12, s[20:23], s90 offen lds
    s_add_u32 m0, s89, 90112
    s_mov_b32 s90, 1441792
    buffer_load_dwordx4 v12, s[20:23], s90 offen lds
    s_add_u32 m0, s89, 94208
    s_mov_b32 s90, 1507328
    buffer_load_dwordx4 v12, s[20:23], s90 offen lds
    s_add_u32 m0, s89, 98304
    s_mov_b32 s90, 1572864
    buffer_load_dwordx4 v12, s[20:23], s90 offen lds
    s_add_u32 m0, s89, 102400
    s_mov_b32 s90, 1638400
    buffer_load_dwordx4 v12, s[20:23], s90 offen lds
    s_add_u32 m0, s89, 106496
    s_mov_b32 s90, 1703936
    buffer_load_dwordx4 v12, s[20:23], s90 offen lds
    s_add_u32 m0, s89, 110592
    s_mov_b32 s90, 1769472
    buffer_load_dwordx4 v12, s[20:23], s90 offen lds
    s_add_u32 m0, s89, 114688
    s_mov_b32 s90, 1835008
    buffer_load_dwordx4 v12, s[20:23], s90 offen lds
    s_add_u32 m0, s89, 118784
    s_mov_b32 s90, 1900544
    buffer_load_dwordx4 v12, s[20:23], s90 offen lds
    s_add_u32 m0, s89, 122880
    s_mov_b32 s90, 1966080
    buffer_load_dwordx4 v12, s[20:23], s90 offen lds
    s_add_u32 m0, s89, 126976
    s_mov_b32 s90, 2031616
    buffer_load_dwordx4 v12, s[20:23], s90 offen lds
    s_add_u32 m0, s89, 0
    s_mov_b32 s90, 0
    buffer_load_dwordx4 v12, s[20:23], s90 offen lds
    s_add_u32 m0, s89, 4096
    s_mov_b32 s90, 65536
    buffer_load_dwordx4 v12, s[20:23], s90 offen lds
    s_add_u32 m0, s89, 8192
    s_mov_b32 s90, 131072
    buffer_load_dwordx4 v12, s[20:23], s90 offen lds
    s_add_u32 m0, s89, 12288
    s_mov_b32 s90, 196608
    buffer_load_dwordx4 v12, s[20:23], s90 offen lds
    s_add_u32 m0, s89, 16384
    s_mov_b32 s90, 262144
    buffer_load_dwordx4 v12, s[20:23], s90 offen lds
    s_add_u32 m0, s89, 20480
    s_mov_b32 s90, 327680
    buffer_load_dwordx4 v12, s[20:23], s90 offen lds
    s_add_u32 m0, s89, 24576
    s_mov_b32 s90, 393216
    buffer_load_dwordx4 v12, s[20:23], s90 offen lds
    s_add_u32 m0, s89, 28672
    s_mov_b32 s90, 458752
    buffer_load_dwordx4 v12, s[20:23], s90 offen lds
    s_add_u32 m0, s89, 32768
    s_mov_b32 s90, 524288
    buffer_load_dwordx4 v12, s[20:23], s90 offen lds
    s_add_u32 m0, s89, 36864
    s_mov_b32 s90, 589824
    buffer_load_dwordx4 v12, s[20:23], s90 offen lds
    s_lshl_b32 s86, s47, 2
    s_add_u32 s86, s86, s48
    s_lshl_b32 s87, s86, 7
    s_add_u32 s87, s87, 671744
    v_lshl_add_u32 v6, v0, 2, s87
    v_mov_b32 v4, 2147483648
    v_cmp_gt_u32 vcc, 16, v0
    s_nop 1
    v_cndmask_b32 v6, v4, v6, vcc
    s_lshl_b32 s86, s86, 14
    s_add_u32 s86, s86, 5242880
    v_lshl_add_u32 v2, v0, 4, s86
    s_lshl_b32 s86, s47, 1
    s_add_u32 s86, s86, s50
    s_lshl_b32 s86, s86, 11
    s_lshl_b32 s87, s49, 6
    s_add_u32 s86, s86, s87
    s_add_u32 s86, s86, 6881280
    v_lshl_add_u32 v3, v23, 7, s86
    v_lshl_add_u32 v3, v22, 4, v3
    v_mov_b32 v112, 0
    v_mov_b32 v113, 0
    v_mov_b32 v114, 0
    v_mov_b32 v115, 0
    v_mov_b32 v116, 0
    v_mov_b32 v117, 0
    v_mov_b32 v118, 0
    v_mov_b32 v119, 0
    s_lshr_b32 s62, s3, 2
    s_lshl_b32 s53, s51, 3
    s_lshl_b32 s86, s48, 1
    s_add_u32 s53, s53, s86
    s_add_u32 s53, s53, s62
    v_lshrrev_b32 v36, 4, v0
    v_and_b32 v37, 15, v0
    s_lshl_b32 s87, s53, 15
    s_lshl_b32 s86, s62, 14
    s_add_u32 s86, s86, s87
    s_add_u32 s86, s86, 1048576
    v_lshl_add_u32 v157, v0, 4, s86
    v_xor_b32 v158, 0x8000, v157
    s_lshl_b32 s86, s51, 1
    s_lshr_b32 s87, s48, 1
    s_add_u32 s86, s86, s87
    s_lshl_b32 s86, s86, 1
    s_add_u32 s86, s86, s62
    s_lshl_b32 s86, s86, 1
    s_and_b32 s87, s48, 1
    s_add_u32 s86, s86, s87
    s_lshl_b32 s86, s86, 7
    s_add_u32 s86, s86, 688128
    v_lshl_add_u32 v159, v0, 2, s86
    v_mov_b32 v38, 2147483648
    v_cmp_gt_u32 vcc, 16, v0
    s_nop 1
    v_cndmask_b32 v159, v38, v159, vcc
    v_bfe_u32 v38, v0, 2, 2
    v_lshl_add_u32 v38, v36, 2, v38
    v_bfe_u32 v39, v38, 1, 2
    v_lshlrev_b32 v38, 7, v38
    v_lshl_add_u32 v38, v39, 5, v38
    v_and_b32 v39, 3, v0
    v_lshl_add_u32 v38, v39, 3, v38
    s_lshl_b32 s86, s62, 16
    s_add_u32 s86, s86, 0
    v_add_u32 v144, s86, v38
    v_xor_b32 v145, 32, v144
    v_xor_b32 v146, 64, v144
    v_xor_b32 v147, 96, v144
    v_cmp_eq_u32 s[4:5], 1, v39
    v_cmp_eq_u32 s[6:7], 2, v39
    v_cmp_eq_u32 s[98:99], 3, v39
    s_lshl_b32 s86, s53, 10
    s_add_u32 s86, s86, 786432
    v_lshl_add_u32 v160, v0, 2, s86
    v_mul_u32_u24 v161, 192, v36
    v_add_u32 v160, v160, v161
    s_mov_b32 s72, 0x00f0000f
    s_mov_b32 s73, 0xf0000f00
    s_mov_b32 s74, 0x0f00f000
    s_mov_b32 s75, 0x0f00f000
    v_lshrrev_b32 v38, 2, v37
    v_lshl_add_u32 v161, v38, 4, v37
    v_lshlrev_b32 v161, 2, v161
    s_lshl_b32 s86, s3, 12
    s_add_u32 s86, s86, 131072
    v_lshl_add_u32 v162, v0, 4, s86
    v_xor_b32 v163, 0x4000, v162
    s_lshl_b32 s86, s52, 7
    v_lshl_add_u32 v36, v36, 3, s86
    s_lshl_b32 s87, s53, 15
    s_add_u32 s87, s87, s86
    s_lshl_b32 s86, s62, 6
    s_add_u32 s87, s87, s86
    v_lshl_add_u32 v39, v37, 11, s87
    v_and_b32 v38, 48, v0
    v_add_u32 v39, v39, v38
    v_xor_b32 v37, 0x8000, v39
    v_lshlrev_b32 v38, 4, v0
    buffer_load_dwordx2 v[148:149], v36, s[40:43], 0 offen offset:0
    buffer_load_dwordx2 v[150:151], v36, s[40:43], 0 offen offset:32
    buffer_load_dwordx2 v[152:153], v36, s[40:43], 0 offen offset:64
    buffer_load_dwordx2 v[154:155], v36, s[40:43], 0 offen offset:96
    buffer_load_dwordx4 v[128:131], v38, s[40:43], 0 offen
    buffer_load_dwordx4 v[132:135], v38, s[40:43], 0 offen offset:1024
    buffer_load_dwordx4 v[136:139], v39, s[8:11], 0 offen
    buffer_load_dwordx4 v[140:143], v37, s[8:11], 0 offen
    s_mov_b32 s90, 50176
    buffer_load_dwordx4 v[192:195], v30, s[32:35], s90 offen
    s_mov_b32 s90, 57344
    buffer_load_dwordx4 v[196:199], v30, s[32:35], s90 offen
    s_mov_b32 s90, 64512
    buffer_load_dwordx4 v[200:203], v30, s[32:35], s90 offen
    s_waitcnt vmcnt(5)
    v_mov_b32 v4, 0
    buffer_atomic_or v4, v6, s[16:19], 0 offen sc0 sc1
    v_bfe_u32 v36, v0, 2, 1
    v_cmp_eq_u32 vcc, 1, v36
    v_mov_b32 v36, s95
    v_mov_b32 v38, 0
    v_dot2c_f32_bf16 v38, s95, v128
    v_dot2c_f32_bf16 v38, s95, v129
    v_dot2c_f32_bf16 v38, s95, v130
    v_dot2c_f32_bf16 v38, s95, v131
    v_dot2c_f32_bf16 v38, s95, v132
    v_dot2c_f32_bf16 v38, s95, v133
    v_dot2c_f32_bf16 v38, s95, v134
    v_dot2c_f32_bf16 v38, s95, v135
    v_cndmask_b32 v148, v36, v148, vcc
    v_cndmask_b32 v149, v36, v149, vcc
    v_cndmask_b32 v150, v36, v150, vcc
    v_cndmask_b32 v151, v36, v151, vcc
    v_cndmask_b32 v152, v36, v152, vcc
    v_cndmask_b32 v153, v36, v153, vcc
    v_cndmask_b32 v154, v36, v154, vcc
    v_cndmask_b32 v155, v36, v155, vcc
    v_add_f32_dpp v38, v38, v38 row_ror:8 row_mask:0xf bank_mask:0xf
    s_nop 1
    v_add_f32_dpp v38, v38, v38 row_ror:4 row_mask:0xf bank_mask:0xf
    s_nop 1
    v_add_f32_dpp v38, v38, v38 row_ror:2 row_mask:0xf bank_mask:0xf
    s_nop 1
    v_add_f32_dpp v38, v38, v38 row_ror:1 row_mask:0xf bank_mask:0xf
    v_mov_b32 v36, v38
    s_nop 1
    v_permlane32_swap_b32 v38, v36
    v_add_f32 v38, v38, v36
    v_mov_b32 v36, v38
    s_nop 1
    v_permlane16_swap_b32 v38, v36
    v_add_f32 v38, v38, v36
    v_mov_b32 v36, 135200
    v_readfirstlane_b32 s57, v38
    ds_write_b32 v36, v38
    s_mul_i32 s86, s50, 3072
    s_add_u32 s86, s86, 151552
    v_lshl_add_u32 v7, v0, 4, s86
    s_lshl_b32 s86, s49, 10
    v_add_u32 v5, s86, v7
    s_lshl_b32 s86, s49, 3
    v_add_u32 v7, s86, v7
    s_mov_b32 s88, 0xffff0000
    s_mov_b32 s86, 0x00003f80
    s_mov_b32 s87, 0x3f800000
    s_branch L_h1_w0
L_h1_r0:
    s_ff1_i32_b32 s66, s65
    s_bitset0_b32 s65, s66
    s_lshl_b32 s66, s66, 10
    buffer_load_dwordx4 v[40:43], v2, s[16:19], s66 offen sc1
    s_cmp_eq_u32 s65, 0
    s_cbranch_scc1 L_h1_p1
L_h1_r1:
    s_ff1_i32_b32 s66, s65
    s_bitset0_b32 s65, s66
    s_lshl_b32 s66, s66, 10
    buffer_load_dwordx4 v[44:47], v2, s[16:19], s66 offen sc1
    s_cmp_eq_u32 s65, 0
    s_cbranch_scc1 L_h1_p2
L_h1_r2:
    s_ff1_i32_b32 s66, s65
    s_bitset0_b32 s65, s66
    s_lshl_b32 s66, s66, 10
    buffer_load_dwordx4 v[48:51], v2, s[16:19], s66 offen sc1
    s_cmp_eq_u32 s65, 0
    s_cbranch_scc1 L_h1_p3
L_h1_r3:
    s_ff1_i32_b32 s66, s65
    s_bitset0_b32 s65, s66
    s_lshl_b32 s66, s66, 10
    buffer_load_dwordx4 v[52:55], v2, s[16:19], s66 offen sc1
    s_cmp_eq_u32 s65, 0
    s_cbranch_scc1 L_h1_p4
L_h1_r4:
    s_ff1_i32_b32 s66, s65
    s_bitset0_b32 s65, s66
    s_lshl_b32 s66, s66, 10
    buffer_load_dwordx4 v[56:59], v2, s[16:19], s66 offen sc1
    s_cmp_eq_u32 s65, 0
    s_cbranch_scc1 L_h1_p5
L_h1_r5:
    s_ff1_i32_b32 s66, s65
    s_bitset0_b32 s65, s66
    s_lshl_b32 s66, s66, 10
    buffer_load_dwordx4 v[60:63], v2, s[16:19], s66 offen sc1
    s_cmp_eq_u32 s65, 0
    s_cbranch_scc1 L_h1_p6
L_h1_r6:
    s_ff1_i32_b32 s66, s65
    s_bitset0_b32 s65, s66
    s_lshl_b32 s66, s66, 10
    buffer_load_dwordx4 v[64:67], v2, s[16:19], s66 offen sc1
    s_cmp_eq_u32 s65, 0
    s_cbranch_scc1 L_h1_p7
L_h1_r7:
    s_ff1_i32_b32 s66, s65
    s_bitset0_b32 s65, s66
    s_lshl_b32 s66, s66, 10
    buffer_load_dwordx4 v[68:71], v2, s[16:19], s66 offen sc1
    s_cmp_eq_u32 s65, 0
    s_cbranch_scc1 L_h1_p8
L_h1_r8:
    s_ff1_i32_b32 s66, s65
    s_bitset0_b32 s65, s66
    s_lshl_b32 s66, s66, 10
    buffer_load_dwordx4 v[72:75], v2, s[16:19], s66 offen sc1
    s_cmp_eq_u32 s65, 0
    s_cbranch_scc1 L_h1_p9
L_h1_r9:
    s_ff1_i32_b32 s66, s65
    s_bitset0_b32 s65, s66
    s_lshl_b32 s66, s66, 10
    buffer_load_dwordx4 v[76:79], v2, s[16:19], s66 offen sc1
    s_cmp_eq_u32 s65, 0
    s_cbranch_scc1 L_h1_p10
L_h1_r10:
    s_ff1_i32_b32 s66, s65
    s_bitset0_b32 s65, s66
    s_lshl_b32 s66, s66, 10
    buffer_load_dwordx4 v[80:83], v2, s[16:19], s66 offen sc1
    s_cmp_eq_u32 s65, 0
    s_cbranch_scc1 L_h1_p11
L_h1_r11:
    s_ff1_i32_b32 s66, s65
    s_bitset0_b32 s65, s66
    s_lshl_b32 s66, s66, 10
    buffer_load_dwordx4 v[84:87], v2, s[16:19], s66 offen sc1
    s_cmp_eq_u32 s65, 0
    s_cbranch_scc1 L_h1_p12
L_h1_r12:
    s_ff1_i32_b32 s66, s65
    s_bitset0_b32 s65, s66
    s_lshl_b32 s66, s66, 10
    buffer_load_dwordx4 v[88:91], v2, s[16:19], s66 offen sc1
    s_cmp_eq_u32 s65, 0
    s_cbranch_scc1 L_h1_p13
L_h1_r13:
    s_ff1_i32_b32 s66, s65
    s_bitset0_b32 s65, s66
    s_lshl_b32 s66, s66, 10
    buffer_load_dwordx4 v[92:95], v2, s[16:19], s66 offen sc1
    s_cmp_eq_u32 s65, 0
    s_cbranch_scc1 L_h1_p14
L_h1_r14:
    s_ff1_i32_b32 s66, s65
    s_bitset0_b32 s65, s66
    s_lshl_b32 s66, s66, 10
    buffer_load_dwordx4 v[96:99], v2, s[16:19], s66 offen sc1
    s_cmp_eq_u32 s65, 0
    s_cbranch_scc1 L_h1_p15
L_h1_r15:
    s_ff1_i32_b32 s66, s65
    s_bitset0_b32 s65, s66
    s_lshl_b32 s66, s66, 10
    buffer_load_dwordx4 v[100:103], v2, s[16:19], s66 offen sc1
    buffer_load_dwordx4 v[104:107], v3, s[16:19], 0 offen sc1
L_h1_acc:
    s_waitcnt vmcnt(16)
    v_dot2c_f32_bf16 v112, s86, v40
    v_dot2c_f32_bf16 v113, s87, v40
    v_dot2c_f32_bf16 v114, s86, v41
    v_dot2c_f32_bf16 v115, s87, v41
    v_dot2c_f32_bf16 v116, s86, v42
    v_dot2c_f32_bf16 v117, s87, v42
    v_dot2c_f32_bf16 v118, s86, v43
    v_dot2c_f32_bf16 v119, s87, v43
    s_waitcnt vmcnt(15)
    v_dot2c_f32_bf16 v112, s86, v44
    v_dot2c_f32_bf16 v113, s87, v44
    v_dot2c_f32_bf16 v114, s86, v45
    v_dot2c_f32_bf16 v115, s87, v45
    v_dot2c_f32_bf16 v116, s86, v46
    v_dot2c_f32_bf16 v117, s87, v46
    v_dot2c_f32_bf16 v118, s86, v47
    v_dot2c_f32_bf16 v119, s87, v47
    s_waitcnt vmcnt(14)
    v_dot2c_f32_bf16 v112, s86, v48
    v_dot2c_f32_bf16 v113, s87, v48
    v_dot2c_f32_bf16 v114, s86, v49
    v_dot2c_f32_bf16 v115, s87, v49
    v_dot2c_f32_bf16 v116, s86, v50
    v_dot2c_f32_bf16 v117, s87, v50
    v_dot2c_f32_bf16 v118, s86, v51
    v_dot2c_f32_bf16 v119, s87, v51
    v_max3_u32 v4, v43, v47, v51
    s_waitcnt vmcnt(13)
    v_dot2c_f32_bf16 v112, s86, v52
    v_dot2c_f32_bf16 v113, s87, v52
    v_dot2c_f32_bf16 v114, s86, v53
    v_dot2c_f32_bf16 v115, s87, v53
    v_dot2c_f32_bf16 v116, s86, v54
    v_dot2c_f32_bf16 v117, s87, v54
    v_dot2c_f32_bf16 v118, s86, v55
    v_dot2c_f32_bf16 v119, s87, v55
    s_waitcnt vmcnt(12)
    v_dot2c_f32_bf16 v112, s86, v56
    v_dot2c_f32_bf16 v113, s87, v56
    v_dot2c_f32_bf16 v114, s86, v57
    v_dot2c_f32_bf16 v115, s87, v57
    v_dot2c_f32_bf16 v116, s86, v58
    v_dot2c_f32_bf16 v117, s87, v58
    v_dot2c_f32_bf16 v118, s86, v59
    v_dot2c_f32_bf16 v119, s87, v59
    v_max3_u32 v4, v4, v55, v59
    s_waitcnt vmcnt(11)
    v_dot2c_f32_bf16 v112, s86, v60
    v_dot2c_f32_bf16 v113, s87, v60
    v_dot2c_f32_bf16 v114, s86, v61
    v_dot2c_f32_bf16 v115, s87, v61
    v_dot2c_f32_bf16 v116, s86, v62
    v_dot2c_f32_bf16 v117, s87, v62
    v_dot2c_f32_bf16 v118, s86, v63
    v_dot2c_f32_bf16 v119, s87, v63
    s_waitcnt vmcnt(10)
    v_dot2c_f32_bf16 v112, s86, v64
    v_dot2c_f32_bf16 v113, s87, v64
    v_dot2c_f32_bf16 v114, s86, v65
    v_dot2c_f32_bf16 v115, s87, v65
    v_dot2c_f32_bf16 v116, s86, v66
    v_dot2c_f32_bf16 v117, s87, v66
    v_dot2c_f32_bf16 v118, s86, v67
    v_dot2c_f32_bf16 v119, s87, v67
    v_max3_u32 v4, v4, v63, v67
    s_waitcnt vmcnt(9)
    v_dot2c_f32_bf16 v112, s86, v68
    v_dot2c_f32_bf16 v113, s87, v68
    v_dot2c_f32_bf16 v114, s86, v69
    v_dot2c_f32_bf16 v115, s87, v69
    v_dot2c_f32_bf16 v116, s86, v70
    v_dot2c_f32_bf16 v117, s87, v70
    v_dot2c_f32_bf16 v118, s86, v71
    v_dot2c_f32_bf16 v119, s87, v71
    s_waitcnt vmcnt(8)
    v_dot2c_f32_bf16 v112, s86, v72
    v_dot2c_f32_bf16 v113, s87, v72
    v_dot2c_f32_bf16 v114, s86, v73
    v_dot2c_f32_bf16 v115, s87, v73
    v_dot2c_f32_bf16 v116, s86, v74
    v_dot2c_f32_bf16 v117, s87, v74
    v_dot2c_f32_bf16 v118, s86, v75
    v_dot2c_f32_bf16 v119, s87, v75
    v_max3_u32 v4, v4, v71, v75
    s_waitcnt vmcnt(7)
    v_dot2c_f32_bf16 v112, s86, v76
    v_dot2c_f32_bf16 v113, s87, v76
    v_dot2c_f32_bf16 v114, s86, v77
    v_dot2c_f32_bf16 v115, s87, v77
    v_dot2c_f32_bf16 v116, s86, v78
    v_dot2c_f32_bf16 v117, s87, v78
    v_dot2c_f32_bf16 v118, s86, v79
    v_dot2c_f32_bf16 v119, s87, v79
    s_waitcnt vmcnt(6)
    v_dot2c_f32_bf16 v112, s86, v80
    v_dot2c_f32_bf16 v113, s87, v80
    v_dot2c_f32_bf16 v114, s86, v81
    v_dot2c_f32_bf16 v115, s87, v81
    v_dot2c_f32_bf16 v116, s86, v82
    v_dot2c_f32_bf16 v117, s87, v82
    v_dot2c_f32_bf16 v118, s86, v83
    v_dot2c_f32_bf16 v119, s87, v83
    v_max3_u32 v4, v4, v79, v83
    s_waitcnt vmcnt(5)
    v_dot2c_f32_bf16 v112, s86, v84
    v_dot2c_f32_bf16 v113, s87, v84
    v_dot2c_f32_bf16 v114, s86, v85
    v_dot2c_f32_bf16 v115, s87, v85
    v_dot2c_f32_bf16 v116, s86, v86
    v_dot2c_f32_bf16 v117, s87, v86
    v_dot2c_f32_bf16 v118, s86, v87
    v_dot2c_f32_bf16 v119, s87, v87
    s_waitcnt vmcnt(4)
    v_dot2c_f32_bf16 v112, s86, v88
    v_dot2c_f32_bf16 v113, s87, v88
    v_dot2c_f32_bf16 v114, s86, v89
    v_dot2c_f32_bf16 v115, s87, v89
    v_dot2c_f32_bf16 v116, s86, v90
    v_dot2c_f32_bf16 v117, s87, v90
    v_dot2c_f32_bf16 v118, s86, v91
    v_dot2c_f32_bf16 v119, s87, v91
    v_max3_u32 v4, v4, v87, v91
    s_waitcnt vmcnt(3)
    v_dot2c_f32_bf16 v112, s86, v92
    v_dot2c_f32_bf16 v113, s87, v92
    v_dot2c_f32_bf16 v114, s86, v93
    v_dot2c_f32_bf16 v115, s87, v93
    v_dot2c_f32_bf16 v116, s86, v94
    v_dot2c_f32_bf16 v117, s87, v94
    v_dot2c_f32_bf16 v118, s86, v95
    v_dot2c_f32_bf16 v119, s87, v95
    s_waitcnt vmcnt(2)
    v_dot2c_f32_bf16 v112, s86, v96
    v_dot2c_f32_bf16 v113, s87, v96
    v_dot2c_f32_bf16 v114, s86, v97
    v_dot2c_f32_bf16 v115, s87, v97
    v_dot2c_f32_bf16 v116, s86, v98
    v_dot2c_f32_bf16 v117, s87, v98
    v_dot2c_f32_bf16 v118, s86, v99
    v_dot2c_f32_bf16 v119, s87, v99
    v_max3_u32 v4, v4, v95, v99
    s_waitcnt vmcnt(1)
    v_dot2c_f32_bf16 v112, s86, v100
    v_dot2c_f32_bf16 v113, s87, v100
    v_dot2c_f32_bf16 v114, s86, v101
    v_dot2c_f32_bf16 v115, s87, v101
    v_dot2c_f32_bf16 v116, s86, v102
    v_dot2c_f32_bf16 v117, s87, v102
    v_dot2c_f32_bf16 v118, s86, v103
    v_dot2c_f32_bf16 v119, s87, v103
    s_waitcnt vmcnt(0)
    v_max3_u32 v4, v4, v103, v107
    v_add_f32_dpp v104, v104, v104 row_ror:8 row_mask:0xf bank_mask:0xf
    v_add_f32_dpp v105, v105, v105 row_ror:8 row_mask:0xf bank_mask:0xf
    v_add_f32_dpp v106, v106, v106 row_ror:8 row_mask:0xf bank_mask:0xf
    v_add_f32_dpp v107, v107, v107 row_ror:8 row_mask:0xf bank_mask:0xf
    v_cvt_pk_bf16_f32 v120, v112, v113
    v_cvt_pk_bf16_f32 v121, v114, v115
    v_cvt_pk_bf16_f32 v122, v116, v117
    v_cvt_pk_bf16_f32 v123, v118, v119
    ds_write_b128 v5, v[120:123]
    v_add_f32_dpp v104, v104, v104 row_ror:4 row_mask:0xf bank_mask:0xf
    v_add_f32_dpp v105, v105, v105 row_ror:4 row_mask:0xf bank_mask:0xf
    v_add_f32_dpp v106, v106, v106 row_ror:4 row_mask:0xf bank_mask:0xf
    v_add_f32_dpp v107, v107, v107 row_ror:4 row_mask:0xf bank_mask:0xf
    v_add_f32_dpp v104, v104, v104 row_ror:2 row_mask:0xf bank_mask:0xf
    v_add_f32_dpp v105, v105, v105 row_ror:2 row_mask:0xf bank_mask:0xf
    v_add_f32_dpp v106, v106, v106 row_ror:2 row_mask:0xf bank_mask:0xf
    v_add_f32_dpp v107, v107, v107 row_ror:2 row_mask:0xf bank_mask:0xf
    v_add_f32_dpp v104, v104, v104 row_ror:1 row_mask:0xf bank_mask:0xf
    v_add_f32_dpp v105, v105, v105 row_ror:1 row_mask:0xf bank_mask:0xf
    v_add_f32_dpp v106, v106, v106 row_ror:1 row_mask:0xf bank_mask:0xf
    v_add_f32_dpp v107, v107, v107 row_ror:1 row_mask:0xf bank_mask:0xf
    v_cmp_eq_u32 vcc, -1, v4
    v_cvt_pk_bf16_f32 v124, v104, v105
    v_cvt_pk_bf16_f32 v125, v106, v107
    ds_write_b64 v7, v[124:125] offset:2048
    s_cbranch_vccnz L_h1_again
L_h1_done:
    s_waitcnt lgkmcnt(0)
    s_barrier
    s_or_b32 s86, s2, s48
    s_cmp_eq_u32 s86, 0
    s_cselect_b32 s86, 0, 2147483648
    s_add_u32 s86, s86, 524288
    v_mov_b32 v6, s86
    buffer_store_dword v35, v6, s[16:19], 0 offen sc1
    v_mov_b32 v11, v30
    v_mov_b32 v14, v31
    v_mov_b32 v8, 0
    buffer_atomic_or v8, v159, s[16:19], 0 offen sc0 sc1
    s_branch L_phaseB
L_h1_p0:
    v_mov_b32 v4, 0
    buffer_atomic_or v4, v6, s[16:19], 0 offen sc0 sc1
L_h1_w0:
    s_waitcnt vmcnt(0)
    v_cmp_eq_u32 vcc, s68, v4
    s_nop 0
    s_andn2_b32 s65, vcc_lo, s88
    s_or_b32 s88, s88, s65
    s_cmp_lg_u32 s65, 0
    s_cbranch_scc1 L_h1_r0
    s_sub_u32 s56, s56, 1
    s_cbranch_scc0 L_h1_p0
    s_mov_b32 s56, 0
    s_not_b32 s65, s88
    s_branch L_h1_r0
L_h1_p1:
    v_mov_b32 v4, 0
    buffer_atomic_or v4, v6, s[16:19], 0 offen sc0 sc1
    s_waitcnt vmcnt(0)
    v_cmp_eq_u32 vcc, s68, v4
    s_nop 0
    s_andn2_b32 s65, vcc_lo, s88
    s_or_b32 s88, s88, s65
    s_cmp_lg_u32 s65, 0
    s_cbranch_scc1 L_h1_r1
    s_sub_u32 s56, s56, 1
    s_cbranch_scc0 L_h1_p1
    s_mov_b32 s56, 0
    s_not_b32 s65, s88
    s_branch L_h1_r1
L_h1_p2:
    v_mov_b32 v4, 0
    buffer_atomic_or v4, v6, s[16:19], 0 offen sc0 sc1
    s_waitcnt vmcnt(0)
    v_cmp_eq_u32 vcc, s68, v4
    s_nop 0
    s_andn2_b32 s65, vcc_lo, s88
    s_or_b32 s88, s88, s65
    s_cmp_lg_u32 s65, 0
    s_cbranch_scc1 L_h1_r2
    s_sub_u32 s56, s56, 1
    s_cbranch_scc0 L_h1_p2
    s_mov_b32 s56, 0
    s_not_b32 s65, s88
    s_branch L_h1_r2
L_h1_p3:
    v_mov_b32 v4, 0
    buffer_atomic_or v4, v6, s[16:19], 0 offen sc0 sc1
    s_waitcnt vmcnt(0)
    v_cmp_eq_u32 vcc, s68, v4
    s_nop 0
    s_andn2_b32 s65, vcc_lo, s88
    s_or_b32 s88, s88, s65
    s_cmp_lg_u32 s65, 0
    s_cbranch_scc1 L_h1_r3
    s_sub_u32 s56, s56, 1
    s_cbranch_scc0 L_h1_p3
    s_mov_b32 s56, 0
    s_not_b32 s65, s88
    s_branch L_h1_r3
L_h1_p4:
    v_mov_b32 v4, 0
    buffer_atomic_or v4, v6, s[16:19], 0 offen sc0 sc1
    s_waitcnt vmcnt(0)
    v_cmp_eq_u32 vcc, s68, v4
    s_nop 0
    s_andn2_b32 s65, vcc_lo, s88
    s_or_b32 s88, s88, s65
    s_cmp_lg_u32 s65, 0
    s_cbranch_scc1 L_h1_r4
    s_sub_u32 s56, s56, 1
    s_cbranch_scc0 L_h1_p4
    s_mov_b32 s56, 0
    s_not_b32 s65, s88
    s_branch L_h1_r4
L_h1_p5:
    v_mov_b32 v4, 0
    buffer_atomic_or v4, v6, s[16:19], 0 offen sc0 sc1
    s_waitcnt vmcnt(0)
    v_cmp_eq_u32 vcc, s68, v4
    s_nop 0
    s_andn2_b32 s65, vcc_lo, s88
    s_or_b32 s88, s88, s65
    s_cmp_lg_u32 s65, 0
    s_cbranch_scc1 L_h1_r5
    s_sub_u32 s56, s56, 1
    s_cbranch_scc0 L_h1_p5
    s_mov_b32 s56, 0
    s_not_b32 s65, s88
    s_branch L_h1_r5
L_h1_p6:
    v_mov_b32 v4, 0
    buffer_atomic_or v4, v6, s[16:19], 0 offen sc0 sc1
    s_waitcnt vmcnt(0)
    v_cmp_eq_u32 vcc, s68, v4
    s_nop 0
    s_andn2_b32 s65, vcc_lo, s88
    s_or_b32 s88, s88, s65
    s_cmp_lg_u32 s65, 0
    s_cbranch_scc1 L_h1_r6
    s_sub_u32 s56, s56, 1
    s_cbranch_scc0 L_h1_p6
    s_mov_b32 s56, 0
    s_not_b32 s65, s88
    s_branch L_h1_r6
L_h1_p7:
    v_mov_b32 v4, 0
    buffer_atomic_or v4, v6, s[16:19], 0 offen sc0 sc1
    s_waitcnt vmcnt(0)
    v_cmp_eq_u32 vcc, s68, v4
    s_nop 0
    s_andn2_b32 s65, vcc_lo, s88
    s_or_b32 s88, s88, s65
    s_cmp_lg_u32 s65, 0
    s_cbranch_scc1 L_h1_r7
    s_sub_u32 s56, s56, 1
    s_cbranch_scc0 L_h1_p7
    s_mov_b32 s56, 0
    s_not_b32 s65, s88
    s_branch L_h1_r7
L_h1_p8:
    v_mov_b32 v4, 0
    buffer_atomic_or v4, v6, s[16:19], 0 offen sc0 sc1
    s_waitcnt vmcnt(0)
    v_cmp_eq_u32 vcc, s68, v4
    s_nop 0
    s_andn2_b32 s65, vcc_lo, s88
    s_or_b32 s88, s88, s65
    s_cmp_lg_u32 s65, 0
    s_cbranch_scc1 L_h1_r8
    s_sub_u32 s56, s56, 1
    s_cbranch_scc0 L_h1_p8
    s_mov_b32 s56, 0
    s_not_b32 s65, s88
    s_branch L_h1_r8
L_h1_p9:
    v_mov_b32 v4, 0
    buffer_atomic_or v4, v6, s[16:19], 0 offen sc0 sc1
    s_waitcnt vmcnt(0)
    v_cmp_eq_u32 vcc, s68, v4
    s_nop 0
    s_andn2_b32 s65, vcc_lo, s88
    s_or_b32 s88, s88, s65
    s_cmp_lg_u32 s65, 0
    s_cbranch_scc1 L_h1_r9
    s_sub_u32 s56, s56, 1
    s_cbranch_scc0 L_h1_p9
    s_mov_b32 s56, 0
    s_not_b32 s65, s88
    s_branch L_h1_r9
L_h1_p10:
    v_mov_b32 v4, 0
    buffer_atomic_or v4, v6, s[16:19], 0 offen sc0 sc1
    s_waitcnt vmcnt(0)
    v_cmp_eq_u32 vcc, s68, v4
    s_nop 0
    s_andn2_b32 s65, vcc_lo, s88
    s_or_b32 s88, s88, s65
    s_cmp_lg_u32 s65, 0
    s_cbranch_scc1 L_h1_r10
    s_sub_u32 s56, s56, 1
    s_cbranch_scc0 L_h1_p10
    s_mov_b32 s56, 0
    s_not_b32 s65, s88
    s_branch L_h1_r10
L_h1_p11:
    v_mov_b32 v4, 0
    buffer_atomic_or v4, v6, s[16:19], 0 offen sc0 sc1
    s_waitcnt vmcnt(0)
    v_cmp_eq_u32 vcc, s68, v4
    s_nop 0
    s_andn2_b32 s65, vcc_lo, s88
    s_or_b32 s88, s88, s65
    s_cmp_lg_u32 s65, 0
    s_cbranch_scc1 L_h1_r11
    s_sub_u32 s56, s56, 1
    s_cbranch_scc0 L_h1_p11
    s_mov_b32 s56, 0
    s_not_b32 s65, s88
    s_branch L_h1_r11
L_h1_p12:
    v_mov_b32 v4, 0
    buffer_atomic_or v4, v6, s[16:19], 0 offen sc0 sc1
    s_waitcnt vmcnt(0)
    v_cmp_eq_u32 vcc, s68, v4
    s_nop 0
    s_andn2_b32 s65, vcc_lo, s88
    s_or_b32 s88, s88, s65
    s_cmp_lg_u32 s65, 0
    s_cbranch_scc1 L_h1_r12
    s_sub_u32 s56, s56, 1
    s_cbranch_scc0 L_h1_p12
    s_mov_b32 s56, 0
    s_not_b32 s65, s88
    s_branch L_h1_r12
L_h1_p13:
    v_mov_b32 v4, 0
    buffer_atomic_or v4, v6, s[16:19], 0 offen sc0 sc1
    s_waitcnt vmcnt(0)
    v_cmp_eq_u32 vcc, s68, v4
    s_nop 0
    s_andn2_b32 s65, vcc_lo, s88
    s_or_b32 s88, s88, s65
    s_cmp_lg_u32 s65, 0
    s_cbranch_scc1 L_h1_r13
    s_sub_u32 s56, s56, 1
    s_cbranch_scc0 L_h1_p13
    s_mov_b32 s56, 0
    s_not_b32 s65, s88
    s_branch L_h1_r13
L_h1_p14:
    v_mov_b32 v4, 0
    buffer_atomic_or v4, v6, s[16:19], 0 offen sc0 sc1
    s_waitcnt vmcnt(0)
    v_cmp_eq_u32 vcc, s68, v4
    s_nop 0
    s_andn2_b32 s65, vcc_lo, s88
    s_or_b32 s88, s88, s65
    s_cmp_lg_u32 s65, 0
    s_cbranch_scc1 L_h1_r14
    s_sub_u32 s56, s56, 1
    s_cbranch_scc0 L_h1_p14
    s_mov_b32 s56, 0
    s_not_b32 s65, s88
    s_branch L_h1_r14
L_h1_p15:
    v_mov_b32 v4, 0
    buffer_atomic_or v4, v6, s[16:19], 0 offen sc0 sc1
    s_waitcnt vmcnt(0)
    v_cmp_eq_u32 vcc, s68, v4
    s_nop 0
    s_andn2_b32 s65, vcc_lo, s88
    s_or_b32 s88, s88, s65
    s_cmp_lg_u32 s65, 0
    s_cbranch_scc1 L_h1_r15
    s_sub_u32 s56, s56, 1
    s_cbranch_scc0 L_h1_p15
    s_mov_b32 s56, 0
    s_not_b32 s65, s88
    s_branch L_h1_r15
L_h1_again:
    s_sub_u32 s56, s56, 1
    s_cbranch_scc0 L_h1_re
    s_mov_b32 s56, 0
    s_branch L_h1_done
L_h1_re:
    buffer_load_dwordx4 v[40:43], v2, s[16:19], 0 offen offset:0 sc1
    buffer_load_dwordx4 v[44:47], v2, s[16:19], 0 offen offset:1024 sc1
    buffer_load_dwordx4 v[48:51], v2, s[16:19], 0 offen offset:2048 sc1
    buffer_load_dwordx4 v[52:55], v2, s[16:19], 0 offen offset:3072 sc1
    buffer_load_dwordx4 v[56:59], v2, s[16:19], s92 offen offset:0 sc1
    buffer_load_dwordx4 v[60:63], v2, s[16:19], s92 offen offset:1024 sc1
    buffer_load_dwordx4 v[64:67], v2, s[16:19], s92 offen offset:2048 sc1
    buffer_load_dwordx4 v[68:71], v2, s[16:19], s92 offen offset:3072 sc1
    buffer_load_dwordx4 v[72:75], v2, s[16:19], s93 offen offset:0 sc1
    buffer_load_dwordx4 v[76:79], v2, s[16:19], s93 offen offset:1024 sc1
    buffer_load_dwordx4 v[80:83], v2, s[16:19], s93 offen offset:2048 sc1
    buffer_load_dwordx4 v[84:87], v2, s[16:19], s93 offen offset:3072 sc1
    buffer_load_dwordx4 v[88:91], v2, s[16:19], s94 offen offset:0 sc1
    buffer_load_dwordx4 v[92:95], v2, s[16:19], s94 offen offset:1024 sc1
    buffer_load_dwordx4 v[96:99], v2, s[16:19], s94 offen offset:2048 sc1
    buffer_load_dwordx4 v[100:103], v2, s[16:19], s94 offen offset:3072 sc1
    buffer_load_dwordx4 v[104:107], v3, s[16:19], 0 offen sc1
    v_mov_b32 v112, 0
    v_mov_b32 v113, 0
    v_mov_b32 v114, 0
    v_mov_b32 v115, 0
    v_mov_b32 v116, 0
    v_mov_b32 v117, 0
    v_mov_b32 v118, 0
    v_mov_b32 v119, 0
    s_branch L_h1_acc
L_comp:
    v_and_b32 v20, 15, v0
    v_lshrrev_b32 v21, 4, v0
    v_bfe_u32 v22, v0, 1, 3
    s_lshl_b32 s86, s49, 13
    v_lshl_add_u32 v20, v20, 7, s86
    v_or_b32 v23, 0, v21
    v_xor_b32 v23, v23, v22
    v_lshl_add_u32 v2, v23, 4, v20
    v_or_b32 v23, 4, v21
    v_xor_b32 v23, v23, v22
    v_lshl_add_u32 v3, v23, 4, v20
    v_bfe_u32 v22, v0, 2, 2
    v_lshl_add_u32 v22, v21, 3, v22
    v_lshlrev_b32 v22, 7, v22
    v_bfe_u32 v23, v0, 3, 2
    s_lshl_b32 s86, s50, 1
    v_xor_b32 v23, s86, v23
    v_lshl_add_u32 v22, v23, 5, v22
    v_and_b32 v23, 3, v0
    v_lshl_add_u32 v22, v23, 3, v22
    v_add_u32 v4, 16384, v22
    v_xor_b32 v5, 32, v4
    s_lshl_b32 s53, s2, 2
    s_add_u32 s53, s53, s3
    s_lshl_b32 s86, s53, 12
    s_add_u32 s86, s86, 1048576
    v_lshl_add_u32 v6, v0, 4, s86
    s_mul_i32 s53, s53, 560
    s_add_u32 s53, s53, 6291456
    v_lshl_add_u32 v17, v0, 4, s53
    v_mov_b32 v16, 2147483648
    v_cmp_gt_u32 vcc, 35, v0
    s_nop 1
    v_cndmask_b32 v17, v16, v17, vcc
    s_lshl_b32 s86, s47, 1
    s_add_u32 s86, s86, s50
    s_lshl_b32 s87, s86, 4
    s_add_u32 s87, s87, s46
    s_lshl_b32 s87, s87, 1
    s_add_u32 s87, s87, s49
    s_lshl_b32 s87, s87, 6
    s_add_u32 s87, s87, 6880320
    v_lshl_add_u32 v16, v0, 4, s87
    v_cmp_le_u32 vcc, 60, v0
    s_nop 1
    v_cndmask_b32 v17, v17, v16, vcc
    s_lshl_b32 s87, s86, 1
    s_add_u32 s87, s87, s49
    s_lshl_b32 s87, s87, 4
    s_add_u32 s87, s87, s46
    s_lshl_b32 s87, s87, 10
    s_add_u32 s87, s87, 5242880
    v_lshl_add_u32 v16, v0, 4, s87
    v_mov_b32 v8, -1
    v_mov_b32 v9, -1
    v_mov_b32 v10, -1
    v_mov_b32 v11, -1
    s_waitcnt lgkmcnt(0)
    s_load_dword s61, s[84:85], 524288
    s_mov_b32 s16, s84
    s_and_b32 s17, s85, 0xffff
    s_mov_b32 s18, 268435456
    s_mov_b32 s19, 0x20000
    s_mov_b32 s8, s64
    s_and_b32 s9, s65, 0xffff
    s_mov_b32 s10, 4194304
    s_mov_b32 s11, 0x20000
    s_mov_b32 s20, s68
    s_and_b32 s21, s69, 0xffff
    s_mov_b32 s22, 2097152
    s_mov_b32 s23, 0x20000
    s_mov_b32 s24, s80
    s_and_b32 s25, s81, 0xffff
    s_mov_b32 s26, 4194304
    s_mov_b32 s27, 0x20000
    s_mov_b32 s28, s82
    s_and_b32 s29, s83, 0xffff
    s_mov_b32 s30, 256
    s_mov_b32 s31, 0x20000
    s_bitcmp1_b32 s2, 0
    s_cselect_b32 s32, s76, s74
    s_cselect_b32 s33, s77, s75
    s_and_b32 s33, s33, 0xffff
    s_mov_b32 s34, 7340032
    s_mov_b32 s35, 0x20000
    s_mov_b32 s36, s78
    s_and_b32 s37, s79, 0xffff
    s_mov_b32 s38, 7340032
    s_mov_b32 s39, 0x20000
    s_mov_b32 s40, s72
    s_and_b32 s41, s73, 0xffff
    s_mov_b32 s42, 2048
    s_mov_b32 s43, 0x20000
    s_lshl_b32 s86, s2, 9
    s_add_u32 s86, s86, 786432
    s_cmp_eq_u32 s3, 0
    s_cselect_b32 s86, s86, 2147483648
    v_lshl_add_u32 v7, v0, 2, s86
    v_mul_u32_u24 v12, 192, v21
    v_add_u32 v7, v7, v12
    s_lshl_b32 s86, s2, 8
    s_add_u32 s86, s86, 917376
    s_cmp_eq_u32 s3, 0
    s_cselect_b32 s86, s86, 2147483648
    v_lshl_add_u32 v12, v0, 2, s86
    v_cmp_gt_u32 vcc, 32, v0
    s_nop 1
    v_cndmask_b32 v7, v12, v7, vcc
    v_mov_b32 v12, 2147483648
    v_cmp_gt_u32 vcc, 48, v0
    s_nop 1
    v_cndmask_b32 v7, v12, v7, vcc
    v_mov_b32 v12, 0
    buffer_store_dword v12, v7, s[16:19], 0 offen sc1
    v_mov_b32 v128, 0
    v_mov_b32 v129, 0
    v_mov_b32 v130, 0
    v_mov_b32 v131, 0
    v_mov_b32 v132, 0
    v_mov_b32 v133, 0
    v_mov_b32 v134, 0
    v_mov_b32 v135, 0
    v_mov_b32 v136, 0
    v_mov_b32 v137, 0
    v_mov_b32 v138, 0
    v_mov_b32 v139, 0
    v_mov_b32 v140, 0
    v_mov_b32 v141, 0
    v_mov_b32 v142, 0
    v_mov_b32 v143, 0
    v_mov_b32 v144, 0
    v_mov_b32 v145, 0
    v_mov_b32 v146, 0
    v_mov_b32 v147, 0
    v_mov_b32 v148, 0
    v_mov_b32 v149, 0
    v_mov_b32 v150, 0
    v_mov_b32 v151, 0
    v_mov_b32 v152, 0
    v_mov_b32 v153, 0
    v_mov_b32 v154, 0
    v_mov_b32 v155, 0
    v_mov_b32 v156, 0
    v_mov_b32 v157, 0
    v_mov_b32 v158, 0
    v_mov_b32 v159, 0
    v_mov_b32 v160, 0
    v_mov_b32 v161, 0
    v_mov_b32 v162, 0
    v_mov_b32 v163, 0
    v_mov_b32 v164, 0
    v_mov_b32 v165, 0
    v_mov_b32 v166, 0
    v_mov_b32 v167, 0
    v_mov_b32 v168, 0
    v_mov_b32 v169, 0
    v_mov_b32 v170, 0
    v_mov_b32 v171, 0
    v_mov_b32 v172, 0
    v_mov_b32 v173, 0
    v_mov_b32 v174, 0
    v_mov_b32 v175, 0
    v_mov_b32 v176, 0
    v_mov_b32 v177, 0
    v_mov_b32 v178, 0
    v_mov_b32 v179, 0
    v_mov_b32 v180, 0
    v_mov_b32 v181, 0
    v_mov_b32 v182, 0
    v_mov_b32 v183, 0
    v_mov_b32 v184, 0
    v_mov_b32 v185, 0
    v_mov_b32 v186, 0
    v_mov_b32 v187, 0
    v_mov_b32 v188, 0
    v_mov_b32 v189, 0
    v_mov_b32 v190, 0
    v_mov_b32 v191, 0
    v_mov_b32 v192, 0
    v_mov_b32 v193, 0
    v_mov_b32 v194, 0
    v_mov_b32 v195, 0
    v_mov_b32 v196, 0
    v_mov_b32 v197, 0
    v_mov_b32 v198, 0
    v_mov_b32 v199, 0
    v_mov_b32 v200, 0
    v_mov_b32 v201, 0
    v_mov_b32 v202, 0
    v_mov_b32 v203, 0
    v_mov_b32 v204, 0
    v_mov_b32 v205, 0
    v_mov_b32 v206, 0
    v_mov_b32 v207, 0
    v_mov_b32 v208, 0
    v_mov_b32 v209, 0
    v_mov_b32 v210, 0
    v_mov_b32 v211, 0
    v_mov_b32 v212, 0
    v_mov_b32 v213, 0
    v_mov_b32 v214, 0
    v_mov_b32 v215, 0
    v_mov_b32 v216, 0
    v_mov_b32 v217, 0
    v_mov_b32 v218, 0
    v_mov_b32 v219, 0
    v_mov_b32 v220, 0
    v_mov_b32 v221, 0
    v_mov_b32 v222, 0
    v_mov_b32 v223, 0
    s_mov_b32 s54, 0x358637bd
    s_mov_b32 s55, 0x358637bd
    s_mov_b32 s62, 0
    s_mov_b32 s63, 1
    v_add_u32 v2, 40960, v2
    v_add_u32 v3, 40960, v3
    v_add_u32 v4, 40960, v4
    v_add_u32 v5, 40960, v5
    s_waitcnt lgkmcnt(0)
    s_add_u32 s68, s61, 0x9e3779b9
    s_barrier
    ds_read_b128 v[40:43], v2 offset:0
    ds_read_b128 v[44:47], v2 offset:2048
    ds_read_b128 v[48:51], v2 offset:4096
    ds_read_b128 v[52:55], v2 offset:6144
    ds_read_b64_tr_b16 v[56:57], v4 offset:0
    ds_read_b64_tr_b16 v[58:59], v4 offset:512
    ds_read_b64_tr_b16 v[60:61], v5 offset:0
    ds_read_b64_tr_b16 v[62:63], v5 offset:512
    ds_read_b64_tr_b16 v[64:65], v4 offset:8192
    ds_read_b64_tr_b16 v[66:67], v4 offset:8704
    ds_read_b64_tr_b16 v[68:69], v5 offset:8192
    ds_read_b64_tr_b16 v[70:71], v5 offset:8704
    ds_read_b64_tr_b16 v[72:73], v4 offset:16384
    ds_read_b64_tr_b16 v[74:75], v4 offset:16896
    ds_read_b64_tr_b16 v[76:77], v5 offset:16384
    ds_read_b64_tr_b16 v[78:79], v5 offset:16896
L_cloop:
    s_waitcnt lgkmcnt(0)
    v_mfma_f32_16x16x32_bf16 v[128:131], v[56:59], v[40:43], v[128:131]
    ds_read_b128 v[80:83], v3 offset:0
    v_mfma_f32_16x16x32_bf16 v[132:135], v[56:59], v[44:47], v[132:135]
    ds_read_b128 v[84:87], v3 offset:2048
    v_mfma_f32_16x16x32_bf16 v[136:139], v[56:59], v[48:51], v[136:139]
    ds_read_b128 v[88:91], v3 offset:4096
    v_mfma_f32_16x16x32_bf16 v[140:143], v[56:59], v[52:55], v[140:143]
    ds_read_b128 v[92:95], v3 offset:6144
    v_mfma_f32_16x16x32_bf16 v[144:147], v[60:63], v[40:43], v[144:147]
    ds_read_b64_tr_b16 v[96:97], v4 offset:4096
    v_mfma_f32_16x16x32_bf16 v[148:151], v[60:63], v[44:47], v[148:151]
    ds_read_b64_tr_b16 v[98:99], v4 offset:4608
    v_mfma_f32_16x16x32_bf16 v[152:155], v[60:63], v[48:51], v[152:155]
    ds_read_b64_tr_b16 v[100:101], v5 offset:4096
    v_mfma_f32_16x16x32_bf16 v[156:159], v[60:63], v[52:55], v[156:159]
    ds_read_b64_tr_b16 v[102:103], v5 offset:4608
    v_mfma_f32_16x16x32_bf16 v[160:163], v[40:43], v[64:67], v[160:163]
    ds_read_b64_tr_b16 v[104:105], v4 offset:12288
    v_mfma_f32_16x16x32_bf16 v[164:167], v[44:47], v[64:67], v[164:167]
    ds_read_b64_tr_b16 v[106:107], v4 offset:12800
    v_mfma_f32_16x16x32_bf16 v[168:171], v[48:51], v[64:67], v[168:171]
    ds_read_b64_tr_b16 v[108:109], v5 offset:12288
    v_mfma_f32_16x16x32_bf16 v[172:175], v[52:55], v[64:67], v[172:175]
    ds_read_b64_tr_b16 v[110:111], v5 offset:12800
    v_mfma_f32_16x16x32_bf16 v[176:179], v[40:43], v[68:71], v[176:179]
    ds_read_b64_tr_b16 v[112:113], v4 offset:20480
    v_mfma_f32_16x16x32_bf16 v[180:183], v[44:47], v[68:71], v[180:183]
    ds_read_b64_tr_b16 v[114:115], v4 offset:20992
    v_mfma_f32_16x16x32_bf16 v[184:187], v[48:51], v[68:71], v[184:187]
    ds_read_b64_tr_b16 v[116:117], v5 offset:20480
    v_mfma_f32_16x16x32_bf16 v[188:191], v[52:55], v[68:71], v[188:191]
    ds_read_b64_tr_b16 v[118:119], v5 offset:20992
    v_mfma_f32_16x16x32_bf16 v[192:195], v[40:43], v[72:75], v[192:195]
    s_add_u32 s63, s63, 1
    s_cmp_eq_u32 s63, 4
    s_cselect_b32 s53, 4294803456, 0
    s_cselect_b32 s63, 0, s63
    s_add_u32 s53, s53, 40960
    v_mfma_f32_16x16x32_bf16 v[196:199], v[44:47], v[72:75], v[196:199]
    v_add_u32 v2, s53, v2
    v_mfma_f32_16x16x32_bf16 v[200:203], v[48:51], v[72:75], v[200:203]
    v_add_u32 v4, s53, v4
    v_mfma_f32_16x16x32_bf16 v[204:207], v[52:55], v[72:75], v[204:207]
    v_add_u32 v5, s53, v5
    v_mfma_f32_16x16x32_bf16 v[208:211], v[40:43], v[76:79], v[208:211]
    v_add_u32 v3, s53, v3
    v_mfma_f32_16x16x32_bf16 v[212:215], v[44:47], v[76:79], v[212:215]
    s_cmp_ge_u32 s62, 6
    s_cbranch_scc1 L_cl_none
    buffer_store_dwordx4 v[8:11], v6, s[16:19], 0 offen sc1
    v_add_u32 v6, 1024, v6
    s_cmp_lt_u32 s62, 3
    s_cbranch_scc1 L_cl_none
    v_mov_b32 v6, v16
    v_mov_b32 v16, v17
L_cl_none:
    v_mfma_f32_16x16x32_bf16 v[216:219], v[48:51], v[76:79], v[216:219]
    v_mfma_f32_16x16x32_bf16 v[220:223], v[52:55], v[76:79], v[220:223]
    s_waitcnt lgkmcnt(0)
    v_mfma_f32_16x16x32_bf16 v[128:131], v[96:99], v[80:83], v[128:131]
    s_barrier
    ds_read_b128 v[40:43], v2 offset:0
    v_mfma_f32_16x16x32_bf16 v[132:135], v[96:99], v[84:87], v[132:135]
    ds_read_b128 v[44:47], v2 offset:2048
    v_mfma_f32_16x16x32_bf16 v[136:139], v[96:99], v[88:91], v[136:139]
    ds_read_b128 v[48:51], v2 offset:4096
    v_mfma_f32_16x16x32_bf16 v[140:143], v[96:99], v[92:95], v[140:143]
    ds_read_b128 v[52:55], v2 offset:6144
    v_mfma_f32_16x16x32_bf16 v[144:147], v[100:103], v[80:83], v[144:147]
    ds_read_b64_tr_b16 v[56:57], v4 offset:0
    v_mfma_f32_16x16x32_bf16 v[148:151], v[100:103], v[84:87], v[148:151]
    ds_read_b64_tr_b16 v[58:59], v4 offset:512
    v_mfma_f32_16x16x32_bf16 v[152:155], v[100:103], v[88:91], v[152:155]
    ds_read_b64_tr_b16 v[60:61], v5 offset:0
    v_mfma_f32_16x16x32_bf16 v[156:159], v[100:103], v[92:95], v[156:159]
    ds_read_b64_tr_b16 v[62:63], v5 offset:512
    v_mfma_f32_16x16x32_bf16 v[160:163], v[80:83], v[104:107], v[160:163]
    ds_read_b64_tr_b16 v[64:65], v4 offset:8192
    v_mfma_f32_16x16x32_bf16 v[164:167], v[84:87], v[104:107], v[164:167]
    ds_read_b64_tr_b16 v[66:67], v4 offset:8704
    v_mfma_f32_16x16x32_bf16 v[168:171], v[88:91], v[104:107], v[168:171]
    ds_read_b64_tr_b16 v[68:69], v5 offset:8192
    v_mfma_f32_16x16x32_bf16 v[172:175], v[92:95], v[104:107], v[172:175]
    ds_read_b64_tr_b16 v[70:71], v5 offset:8704
    v_mfma_f32_16x16x32_bf16 v[176:179], v[80:83], v[108:111], v[176:179]
    ds_read_b64_tr_b16 v[72:73], v4 offset:16384
    v_mfma_f32_16x16x32_bf16 v[180:183], v[84:87], v[108:111], v[180:183]
    ds_read_b64_tr_b16 v[74:75], v4 offset:16896
    v_mfma_f32_16x16x32_bf16 v[184:187], v[88:91], v[108:111], v[184:187]
    ds_read_b64_tr_b16 v[76:77], v5 offset:16384
    v_mfma_f32_16x16x32_bf16 v[188:191], v[92:95], v[108:111], v[188:191]
    ds_read_b64_tr_b16 v[78:79], v5 offset:16896
    v_mfma_f32_16x16x32_bf16 v[192:195], v[80:83], v[112:115], v[192:195]
    v_mfma_f32_16x16x32_bf16 v[196:199], v[84:87], v[112:115], v[196:199]
    s_cmp_lg_u32 s62, 8
    s_cbranch_scc1 L_cl_nw
    s_waitcnt vmcnt(0)
L_cl_nw:
    v_mfma_f32_16x16x32_bf16 v[200:203], v[88:91], v[112:115], v[200:203]
    v_mfma_f32_16x16x32_bf16 v[204:207], v[92:95], v[112:115], v[204:207]
    v_mfma_f32_16x16x32_bf16 v[208:211], v[80:83], v[116:119], v[208:211]
    s_add_u32 s62, s62, 1
    v_mfma_f32_16x16x32_bf16 v[212:215], v[84:87], v[116:119], v[212:215]
    v_mfma_f32_16x16x32_bf16 v[216:219], v[88:91], v[116:119], v[216:219]
    v_mfma_f32_16x16x32_bf16 v[220:223], v[92:95], v[116:119], v[220:223]
    s_cmp_lt_u32 s62, 15
    s_cbranch_scc1 L_cloop
    s_waitcnt lgkmcnt(0)
    v_mfma_f32_16x16x32_bf16 v[128:131], v[56:59], v[40:43], v[128:131]
    ds_read_b128 v[80:83], v3 offset:0
    v_mfma_f32_16x16x32_bf16 v[132:135], v[56:59], v[44:47], v[132:135]
    ds_read_b128 v[84:87], v3 offset:2048
    v_mfma_f32_16x16x32_bf16 v[136:139], v[56:59], v[48:51], v[136:139]
    ds_read_b128 v[88:91], v3 offset:4096
    v_mfma_f32_16x16x32_bf16 v[140:143], v[56:59], v[52:55], v[140:143]
    ds_read_b128 v[92:95], v3 offset:6144
    v_mfma_f32_16x16x32_bf16 v[144:147], v[60:63], v[40:43], v[144:147]
    ds_read_b64_tr_b16 v[96:97], v4 offset:4096
    v_mfma_f32_16x16x32_bf16 v[148:151], v[60:63], v[44:47], v[148:151]
    ds_read_b64_tr_b16 v[98:99], v4 offset:4608
    v_mfma_f32_16x16x32_bf16 v[152:155], v[60:63], v[48:51], v[152:155]
    ds_read_b64_tr_b16 v[100:101], v5 offset:4096
    v_mfma_f32_16x16x32_bf16 v[156:159], v[60:63], v[52:55], v[156:159]
    ds_read_b64_tr_b16 v[102:103], v5 offset:4608
    v_mfma_f32_16x16x32_bf16 v[160:163], v[40:43], v[64:67], v[160:163]
    ds_read_b64_tr_b16 v[104:105], v4 offset:12288
    v_mfma_f32_16x16x32_bf16 v[164:167], v[44:47], v[64:67], v[164:167]
    ds_read_b64_tr_b16 v[106:107], v4 offset:12800
    v_mfma_f32_16x16x32_bf16 v[168:171], v[48:51], v[64:67], v[168:171]
    ds_read_b64_tr_b16 v[108:109], v5 offset:12288
    v_mfma_f32_16x16x32_bf16 v[172:175], v[52:55], v[64:67], v[172:175]
    ds_read_b64_tr_b16 v[110:111], v5 offset:12800
    v_mfma_f32_16x16x32_bf16 v[176:179], v[40:43], v[68:71], v[176:179]
    ds_read_b64_tr_b16 v[112:113], v4 offset:20480
    v_mfma_f32_16x16x32_bf16 v[180:183], v[44:47], v[68:71], v[180:183]
    ds_read_b64_tr_b16 v[114:115], v4 offset:20992
    v_mfma_f32_16x16x32_bf16 v[184:187], v[48:51], v[68:71], v[184:187]
    ds_read_b64_tr_b16 v[116:117], v5 offset:20480
    v_mfma_f32_16x16x32_bf16 v[188:191], v[52:55], v[68:71], v[188:191]
    ds_read_b64_tr_b16 v[118:119], v5 offset:20992
    v_mfma_f32_16x16x32_bf16 v[192:195], v[40:43], v[72:75], v[192:195]
    v_lshrrev_b32 v21, 4, v0
    v_and_b32 v22, 15, v0
    v_mfma_f32_16x16x32_bf16 v[196:199], v[44:47], v[72:75], v[196:199]
    s_lshl_b32 s86, s49, 8
    s_add_u32 s86, s86, 131072
    v_lshl_add_u32 v6, v21, 4, s86
    v_mfma_f32_16x16x32_bf16 v[200:203], v[48:51], v[72:75], v[200:203]
    v_lshl_add_u32 v7, v22, 2, s86
    v_mfma_f32_16x16x32_bf16 v[204:207], v[52:55], v[72:75], v[204:207]
    s_lshl_b32 s86, s50, 7
    s_add_u32 s86, s86, 132608
    v_lshl_add_u32 v8, v22, 2, s86
    v_mfma_f32_16x16x32_bf16 v[208:211], v[40:43], v[76:79], v[208:211]
    v_lshl_add_u32 v9, v21, 4, s86
    v_mfma_f32_16x16x32_bf16 v[212:215], v[44:47], v[76:79], v[212:215]
    s_lshl_b32 s86, s3, 2
    s_add_u32 s86, s86, 135168
    v_mov_b32 v12, s86
    v_mfma_f32_16x16x32_bf16 v[216:219], v[48:51], v[76:79], v[216:219]
    v_xor_b32 v13, 4, v12
    v_mfma_f32_16x16x32_bf16 v[220:223], v[52:55], v[76:79], v[220:223]
    s_waitcnt lgkmcnt(0)
    v_mfma_f32_16x16x32_bf16 v[160:163], v[80:83], v[104:107], v[160:163]
    v_mfma_f32_16x16x32_bf16 v[164:167], v[84:87], v[104:107], v[164:167]
    v_mfma_f32_16x16x32_bf16 v[168:171], v[88:91], v[104:107], v[168:171]
    v_mfma_f32_16x16x32_bf16 v[172:175], v[92:95], v[104:107], v[172:175]
    v_mfma_f32_16x16x32_bf16 v[176:179], v[80:83], v[108:111], v[176:179]
    v_mfma_f32_16x16x32_bf16 v[180:183], v[84:87], v[108:111], v[180:183]
    v_mfma_f32_16x16x32_bf16 v[184:187], v[88:91], v[108:111], v[184:187]
    v_mfma_f32_16x16x32_bf16 v[188:191], v[92:95], v[108:111], v[188:191]
    v_mfma_f32_16x16x32_bf16 v[192:195], v[80:83], v[112:115], v[192:195]
    v_mfma_f32_16x16x32_bf16 v[196:199], v[84:87], v[112:115], v[196:199]
    v_mfma_f32_16x16x32_bf16 v[200:203], v[88:91], v[112:115], v[200:203]
    v_mfma_f32_16x16x32_bf16 v[204:207], v[92:95], v[112:115], v[204:207]
    v_mfma_f32_16x16x32_bf16 v[208:211], v[80:83], v[116:119], v[208:211]
    s_barrier
    ds_read_b128 v[40:43], v6 offset:0
    ds_read_b128 v[44:47], v6 offset:64
    v_mfma_f32_16x16x32_bf16 v[212:215], v[84:87], v[116:119], v[212:215]
    ds_read_b128 v[48:51], v6 offset:128
    ds_read_b128 v[52:55], v6 offset:192
    v_mfma_f32_16x16x32_bf16 v[216:219], v[88:91], v[116:119], v[216:219]
    ds_read_b32 v72, v8 offset:256
    ds_read_b32 v73, v8 offset:320
    v_mfma_f32_16x16x32_bf16 v[220:223], v[92:95], v[116:119], v[220:223]
    ds_read_b32 v74, v8 offset:512
    ds_read_b32 v75, v8 offset:576
    v_mfma_f32_16x16x32_bf16 v[128:131], v[96:99], v[80:83], v[128:131]
    ds_read_b128 v[56:59], v6 offset:512
    ds_read_b128 v[60:63], v6 offset:576
    v_mfma_f32_16x16x32_bf16 v[132:135], v[96:99], v[84:87], v[132:135]
    ds_read_b128 v[64:67], v6 offset:640
    ds_read_b128 v[68:71], v6 offset:704
    v_mfma_f32_16x16x32_bf16 v[136:139], v[96:99], v[88:91], v[136:139]
    ds_read_b128 v[224:227], v6 offset:1024
    ds_read_b128 v[228:231], v6 offset:1088
    v_mfma_f32_16x16x32_bf16 v[140:143], v[96:99], v[92:95], v[140:143]
    ds_read_b128 v[232:235], v6 offset:1152
    ds_read_b128 v[236:239], v6 offset:1216
    v_mfma_f32_16x16x32_bf16 v[144:147], v[100:103], v[80:83], v[144:147]
    ds_read_b128 v[28:31], v9 offset:0
    ds_read_b128 v[32:35], v9 offset:64
    v_mfma_f32_16x16x32_bf16 v[148:151], v[100:103], v[84:87], v[148:151]
    v_mfma_f32_16x16x32_bf16 v[152:155], v[100:103], v[88:91], v[152:155]
    v_mfma_f32_16x16x32_bf16 v[156:159], v[100:103], v[92:95], v[156:159]
    ds_read_b32 v240, v7 offset:0
    ds_read_b32 v244, v7 offset:512
    ds_read_b32 v248, v7 offset:1024
    ds_read_b32 v241, v7 offset:64
    ds_read_b32 v245, v7 offset:576
    ds_read_b32 v249, v7 offset:1088
    ds_read_b32 v242, v7 offset:128
    ds_read_b32 v246, v7 offset:640
    ds_read_b32 v250, v7 offset:1152
    ds_read_b32 v243, v7 offset:192
    ds_read_b32 v247, v7 offset:704
    ds_read_b32 v251, v7 offset:1216
    s_waitcnt lgkmcnt(12)
    v_pk_fma_f32 v[160:161], v[40:41], v[72:73], v[160:161] op_sel_hi:[1,0,1]
    v_pk_mul_f32 v[112:113], v[160:161], v[224:225]
    v_pk_fma_f32 v[160:161], v[160:161], v[56:57], s[54:55]
    v_exp_f32 v112, v112 clamp
    v_exp_f32 v113, v113 clamp
    v_max_f32 v160, s54, v160
    v_max_f32 v161, s54, v161
    v_pk_add_f32 v[160:161], v[160:161], v[112:113]
    v_cvt_pk_bf16_f32 v80, v160, v161
    v_pk_fma_f32 v[162:163], v[42:43], v[72:73], v[162:163] op_sel_hi:[1,0,1]
    v_pk_mul_f32 v[114:115], v[162:163], v[226:227]
    v_pk_fma_f32 v[162:163], v[162:163], v[58:59], s[54:55]
    v_exp_f32 v114, v114 clamp
    v_exp_f32 v115, v115 clamp
    v_max_f32 v162, s54, v162
    v_max_f32 v163, s54, v163
    v_pk_add_f32 v[162:163], v[162:163], v[114:115]
    v_cvt_pk_bf16_f32 v81, v162, v163
    v_pk_fma_f32 v[164:165], v[44:45], v[72:73], v[164:165] op_sel_hi:[1,0,1]
    v_pk_mul_f32 v[116:117], v[164:165], v[228:229]
    v_pk_fma_f32 v[164:165], v[164:165], v[60:61], s[54:55]
    v_exp_f32 v116, v116 clamp
    v_exp_f32 v117, v117 clamp
    v_max_f32 v164, s54, v164
    v_max_f32 v165, s54, v165
    v_pk_add_f32 v[164:165], v[164:165], v[116:117]
    v_cvt_pk_bf16_f32 v82, v164, v165
    v_pk_fma_f32 v[166:167], v[46:47], v[72:73], v[166:167] op_sel_hi:[1,0,1]
    v_pk_mul_f32 v[118:119], v[166:167], v[230:231]
    v_pk_fma_f32 v[166:167], v[166:167], v[62:63], s[54:55]
    v_exp_f32 v118, v118 clamp
    v_exp_f32 v119, v119 clamp
    v_max_f32 v166, s54, v166
    v_max_f32 v167, s54, v167
    v_pk_add_f32 v[166:167], v[166:167], v[118:119]
    v_cvt_pk_bf16_f32 v83, v166, v167
    v_pk_fma_f32 v[168:169], v[48:49], v[72:73], v[168:169] op_sel_hi:[1,0,1]
    v_pk_mul_f32 v[112:113], v[168:169], v[232:233]
    v_pk_fma_f32 v[168:169], v[168:169], v[64:65], s[54:55]
    v_exp_f32 v112, v112 clamp
    v_exp_f32 v113, v113 clamp
    v_max_f32 v168, s54, v168
    v_max_f32 v169, s54, v169
    v_pk_add_f32 v[168:169], v[168:169], v[112:113]
    v_cvt_pk_bf16_f32 v84, v168, v169
    v_pk_fma_f32 v[170:171], v[50:51], v[72:73], v[170:171] op_sel_hi:[1,0,1]
    v_pk_mul_f32 v[114:115], v[170:171], v[234:235]
    v_pk_fma_f32 v[170:171], v[170:171], v[66:67], s[54:55]
    v_exp_f32 v114, v114 clamp
    v_exp_f32 v115, v115 clamp
    v_max_f32 v170, s54, v170
    v_max_f32 v171, s54, v171
    v_pk_add_f32 v[170:171], v[170:171], v[114:115]
    v_cvt_pk_bf16_f32 v85, v170, v171
    v_pk_fma_f32 v[172:173], v[52:53], v[72:73], v[172:173] op_sel_hi:[1,0,1]
    v_pk_mul_f32 v[116:117], v[172:173], v[236:237]
    v_pk_fma_f32 v[172:173], v[172:173], v[68:69], s[54:55]
    v_exp_f32 v116, v116 clamp
    v_exp_f32 v117, v117 clamp
    v_max_f32 v172, s54, v172
    v_max_f32 v173, s54, v173
    v_pk_add_f32 v[172:173], v[172:173], v[116:117]
    v_cvt_pk_bf16_f32 v86, v172, v173
    v_pk_fma_f32 v[174:175], v[54:55], v[72:73], v[174:175] op_sel_hi:[1,0,1]
    v_pk_mul_f32 v[118:119], v[174:175], v[238:239]
    v_pk_fma_f32 v[174:175], v[174:175], v[70:71], s[54:55]
    v_exp_f32 v118, v118 clamp
    v_exp_f32 v119, v119 clamp
    v_max_f32 v174, s54, v174
    v_max_f32 v175, s54, v175
    v_pk_add_f32 v[174:175], v[174:175], v[118:119]
    v_cvt_pk_bf16_f32 v87, v174, v175
    v_pk_fma_f32 v[176:177], v[40:41], v[72:73], v[176:177] op_sel:[0,1,0] op_sel_hi:[1,1,1]
    v_pk_mul_f32 v[112:113], v[176:177], v[224:225]
    v_pk_fma_f32 v[176:177], v[176:177], v[56:57], s[54:55]
    v_exp_f32 v112, v112 clamp
    v_exp_f32 v113, v113 clamp
    v_max_f32 v176, s54, v176
    v_max_f32 v177, s54, v177
    v_pk_add_f32 v[176:177], v[176:177], v[112:113]
    v_cvt_pk_bf16_f32 v88, v176, v177
    v_pk_fma_f32 v[178:179], v[42:43], v[72:73], v[178:179] op_sel:[0,1,0] op_sel_hi:[1,1,1]
    v_pk_mul_f32 v[114:115], v[178:179], v[226:227]
    v_pk_fma_f32 v[178:179], v[178:179], v[58:59], s[54:55]
    v_exp_f32 v114, v114 clamp
    v_exp_f32 v115, v115 clamp
    v_max_f32 v178, s54, v178
    v_max_f32 v179, s54, v179
    v_pk_add_f32 v[178:179], v[178:179], v[114:115]
    v_cvt_pk_bf16_f32 v89, v178, v179
    v_pk_fma_f32 v[180:181], v[44:45], v[72:73], v[180:181] op_sel:[0,1,0] op_sel_hi:[1,1,1]
    v_pk_mul_f32 v[116:117], v[180:181], v[228:229]
    v_pk_fma_f32 v[180:181], v[180:181], v[60:61], s[54:55]
    v_exp_f32 v116, v116 clamp
    v_exp_f32 v117, v117 clamp
    v_max_f32 v180, s54, v180
    v_max_f32 v181, s54, v181
    v_pk_add_f32 v[180:181], v[180:181], v[116:117]
    v_cvt_pk_bf16_f32 v90, v180, v181
    v_pk_fma_f32 v[182:183], v[46:47], v[72:73], v[182:183] op_sel:[0,1,0] op_sel_hi:[1,1,1]
    v_pk_mul_f32 v[118:119], v[182:183], v[230:231]
    v_pk_fma_f32 v[182:183], v[182:183], v[62:63], s[54:55]
    v_exp_f32 v118, v118 clamp
    v_exp_f32 v119, v119 clamp
    v_max_f32 v182, s54, v182
    v_max_f32 v183, s54, v183
    v_pk_add_f32 v[182:183], v[182:183], v[118:119]
    v_cvt_pk_bf16_f32 v91, v182, v183
    v_pk_fma_f32 v[184:185], v[48:49], v[72:73], v[184:185] op_sel:[0,1,0] op_sel_hi:[1,1,1]
    v_pk_mul_f32 v[112:113], v[184:185], v[232:233]
    v_pk_fma_f32 v[184:185], v[184:185], v[64:65], s[54:55]
    v_exp_f32 v112, v112 clamp
    v_exp_f32 v113, v113 clamp
    v_max_f32 v184, s54, v184
    v_max_f32 v185, s54, v185
    v_pk_add_f32 v[184:185], v[184:185], v[112:113]
    v_cvt_pk_bf16_f32 v92, v184, v185
    v_pk_fma_f32 v[186:187], v[50:51], v[72:73], v[186:187] op_sel:[0,1,0] op_sel_hi:[1,1,1]
    v_pk_mul_f32 v[114:115], v[186:187], v[234:235]
    v_pk_fma_f32 v[186:187], v[186:187], v[66:67], s[54:55]
    v_exp_f32 v114, v114 clamp
    v_exp_f32 v115, v115 clamp
    v_max_f32 v186, s54, v186
    v_max_f32 v187, s54, v187
    v_pk_add_f32 v[186:187], v[186:187], v[114:115]
    v_cvt_pk_bf16_f32 v93, v186, v187
    v_pk_fma_f32 v[188:189], v[52:53], v[72:73], v[188:189] op_sel:[0,1,0] op_sel_hi:[1,1,1]
    v_pk_mul_f32 v[116:117], v[188:189], v[236:237]
    v_pk_fma_f32 v[188:189], v[188:189], v[68:69], s[54:55]
    v_exp_f32 v116, v116 clamp
    v_exp_f32 v117, v117 clamp
    v_max_f32 v188, s54, v188
    v_max_f32 v189, s54, v189
    v_pk_add_f32 v[188:189], v[188:189], v[116:117]
    v_cvt_pk_bf16_f32 v94, v188, v189
    v_pk_fma_f32 v[190:191], v[54:55], v[72:73], v[190:191] op_sel:[0,1,0] op_sel_hi:[1,1,1]
    v_pk_mul_f32 v[118:119], v[190:191], v[238:239]
    v_pk_fma_f32 v[190:191], v[190:191], v[70:71], s[54:55]
    v_exp_f32 v118, v118 clamp
    v_exp_f32 v119, v119 clamp
    v_max_f32 v190, s54, v190
    v_max_f32 v191, s54, v191
    v_pk_add_f32 v[190:191], v[190:191], v[118:119]
    v_cvt_pk_bf16_f32 v95, v190, v191
    v_mov_b32 v120, s95
    v_mov_b32 v121, s95
    v_mov_b32 v122, s95
    v_mov_b32 v123, s95
    v_pk_fma_f32 v[192:193], v[40:41], v[74:75], v[192:193] op_sel_hi:[1,0,1]
    v_pk_mul_f32 v[192:193], v[192:193], v[56:57]
    v_cvt_pk_bf16_f32 v96, v192, v193
    v_pk_fma_f32 v[194:195], v[42:43], v[74:75], v[194:195] op_sel_hi:[1,0,1]
    v_pk_mul_f32 v[194:195], v[194:195], v[58:59]
    v_cvt_pk_bf16_f32 v97, v194, v195
    v_pk_fma_f32 v[196:197], v[44:45], v[74:75], v[196:197] op_sel_hi:[1,0,1]
    v_pk_mul_f32 v[196:197], v[196:197], v[60:61]
    v_cvt_pk_bf16_f32 v98, v196, v197
    v_pk_fma_f32 v[198:199], v[46:47], v[74:75], v[198:199] op_sel_hi:[1,0,1]
    v_pk_mul_f32 v[198:199], v[198:199], v[62:63]
    v_cvt_pk_bf16_f32 v99, v198, v199
    v_pk_fma_f32 v[200:201], v[48:49], v[74:75], v[200:201] op_sel_hi:[1,0,1]
    v_pk_mul_f32 v[200:201], v[200:201], v[64:65]
    v_cvt_pk_bf16_f32 v100, v200, v201
    v_pk_fma_f32 v[202:203], v[50:51], v[74:75], v[202:203] op_sel_hi:[1,0,1]
    v_pk_mul_f32 v[202:203], v[202:203], v[66:67]
    v_cvt_pk_bf16_f32 v101, v202, v203
    v_pk_fma_f32 v[204:205], v[52:53], v[74:75], v[204:205] op_sel_hi:[1,0,1]
    v_pk_mul_f32 v[204:205], v[204:205], v[68:69]
    v_cvt_pk_bf16_f32 v102, v204, v205
    v_pk_fma_f32 v[206:207], v[54:55], v[74:75], v[206:207] op_sel_hi:[1,0,1]
    v_pk_mul_f32 v[206:207], v[206:207], v[70:71]
    v_cvt_pk_bf16_f32 v103, v206, v207
    v_pk_fma_f32 v[208:209], v[40:41], v[74:75], v[208:209] op_sel:[0,1,0] op_sel_hi:[1,1,1]
    v_pk_mul_f32 v[208:209], v[208:209], v[56:57]
    v_cvt_pk_bf16_f32 v104, v208, v209
    v_pk_fma_f32 v[210:211], v[42:43], v[74:75], v[210:211] op_sel:[0,1,0] op_sel_hi:[1,1,1]
    v_pk_mul_f32 v[210:211], v[210:211], v[58:59]
    v_cvt_pk_bf16_f32 v105, v210, v211
    v_pk_fma_f32 v[212:213], v[44:45], v[74:75], v[212:213] op_sel:[0,1,0] op_sel_hi:[1,1,1]
    v_pk_mul_f32 v[212:213], v[212:213], v[60:61]
    v_cvt_pk_bf16_f32 v106, v212, v213
    v_pk_fma_f32 v[214:215], v[46:47], v[74:75], v[214:215] op_sel:[0,1,0] op_sel_hi:[1,1,1]
    v_pk_mul_f32 v[214:215], v[214:215], v[62:63]
    v_cvt_pk_bf16_f32 v107, v214, v215
    v_pk_fma_f32 v[216:217], v[48:49], v[74:75], v[216:217] op_sel:[0,1,0] op_sel_hi:[1,1,1]
    v_pk_mul_f32 v[216:217], v[216:217], v[64:65]
    v_cvt_pk_bf16_f32 v108, v216, v217
    v_pk_fma_f32 v[218:219], v[50:51], v[74:75], v[218:219] op_sel:[0,1,0] op_sel_hi:[1,1,1]
    v_pk_mul_f32 v[218:219], v[218:219], v[66:67]
    v_cvt_pk_bf16_f32 v109, v218, v219
    v_pk_fma_f32 v[220:221], v[52:53], v[74:75], v[220:221] op_sel:[0,1,0] op_sel_hi:[1,1,1]
    v_pk_mul_f32 v[220:221], v[220:221], v[68:69]
    v_cvt_pk_bf16_f32 v110, v220, v221
    v_pk_fma_f32 v[222:223], v[54:55], v[74:75], v[222:223] op_sel:[0,1,0] op_sel_hi:[1,1,1]
    v_pk_mul_f32 v[222:223], v[222:223], v[70:71]
    v_cvt_pk_bf16_f32 v111, v222, v223
    s_mul_i32 s86, s3, 3072
    s_add_u32 s86, s86, 139264
    v_lshl_add_u32 v6, v0, 4, s86
    s_xor_b32 s86, s3, 1
    s_mul_i32 s86, s86, 3072
    s_add_u32 s86, s86, 139264
    v_lshl_add_u32 v7, v0, 4, s86
    s_cmp_eq_u32 s49, 1
    s_cbranch_scc1 L_kv1
    v_mfma_f32_16x16x32_bf16 v[172:175], v[80:83], v[104:107], 0
    v_mfma_f32_16x16x32_bf16 v[176:179], v[88:91], v[104:107], 0
    v_mfma_f32_16x16x32_bf16 v[180:183], v[88:91], v[120:123], 0
    v_mfma_f32_16x16x32_bf16 v[160:163], v[80:83], v[96:99], 0
    v_mfma_f32_16x16x32_bf16 v[164:167], v[88:91], v[96:99], 0
    v_mfma_f32_16x16x32_bf16 v[168:171], v[80:83], v[120:123], 0
    v_mfma_f32_16x16x32_bf16 v[172:175], v[84:87], v[108:111], v[172:175]
    v_mfma_f32_16x16x32_bf16 v[176:179], v[92:95], v[108:111], v[176:179]
    v_mfma_f32_16x16x32_bf16 v[180:183], v[92:95], v[120:123], v[180:183]
    v_mfma_f32_16x16x32_bf16 v[160:163], v[84:87], v[100:103], v[160:163]
    v_mfma_f32_16x16x32_bf16 v[164:167], v[92:95], v[100:103], v[164:167]
    v_mfma_f32_16x16x32_bf16 v[168:171], v[84:87], v[120:123], v[168:171]
    s_branch L_kvd
L_kv1:
    v_mfma_f32_16x16x32_bf16 v[172:175], v[80:83], v[96:99], 0
    v_mfma_f32_16x16x32_bf16 v[176:179], v[88:91], v[96:99], 0
    v_mfma_f32_16x16x32_bf16 v[180:183], v[80:83], v[120:123], 0
    v_mfma_f32_16x16x32_bf16 v[160:163], v[80:83], v[104:107], 0
    v_mfma_f32_16x16x32_bf16 v[164:167], v[88:91], v[104:107], 0
    v_mfma_f32_16x16x32_bf16 v[168:171], v[88:91], v[120:123], 0
    v_mfma_f32_16x16x32_bf16 v[172:175], v[84:87], v[100:103], v[172:175]
    v_mfma_f32_16x16x32_bf16 v[176:179], v[92:95], v[100:103], v[176:179]
    v_mfma_f32_16x16x32_bf16 v[180:183], v[84:87], v[120:123], v[180:183]
    v_mfma_f32_16x16x32_bf16 v[160:163], v[84:87], v[108:111], v[160:163]
    v_mfma_f32_16x16x32_bf16 v[164:167], v[92:95], v[108:111], v[164:167]
    v_mfma_f32_16x16x32_bf16 v[168:171], v[92:95], v[120:123], v[168:171]
L_kvd:
    s_lshl_b32 s86, s47, 1
    s_add_u32 s86, s86, s50
    s_lshl_b32 s87, s86, 1
    s_add_u32 s87, s87, s49
    s_lshl_b32 s87, s87, 4
    s_add_u32 s87, s87, s46
    s_lshl_b32 s87, s87, 10
    s_add_u32 s87, s87, 5242880
    v_lshl_add_u32 v8, v0, 4, s87
    s_lshl_b32 s87, s86, 4
    s_add_u32 s87, s87, s46
    s_lshl_b32 s87, s87, 7
    s_lshl_b32 s88, s49, 6
    s_add_u32 s87, s87, s88
    s_add_u32 s87, s87, 6881280
    v_lshl_add_u32 v9, v21, 4, s87
    v_cmp_eq_u32 vcc, 0, v22
    v_mov_b32 v10, 2147483648
    s_nop 0
    v_cndmask_b32 v9, v10, v9, vcc
    ds_write_b128 v6, v[172:175] offset:0
    ds_write_b128 v6, v[176:179] offset:1024
    ds_write_b128 v6, v[180:183] offset:2048
    ds_write_b32 v12, v12
    s_lshl_b32 s87, s46, 3
    s_lshl_b32 s88, s49, 2
    s_add_u32 s87, s87, s88
    s_lshl_b32 s87, s87, 5
    s_add_u32 s87, s87, s86
    s_lshl_b32 s87, s87, 10
    s_add_u32 s87, s87, 1048576
    v_lshl_add_u32 v10, v0, 4, s87
    s_mul_i32 s87, s50, 3072
    s_add_u32 s87, s87, 151552
    v_lshl_add_u32 v11, v0, 4, s87
    s_lshl_b32 s87, s86, 1
    s_add_u32 s87, s87, s49
    s_lshl_b32 s87, s87, 5
    s_add_u32 s87, s87, s46
    s_lshl2_add_u32 s87, s87, 671744
    v_mov_b32 v16, 2147483648
    v_mov_b32 v18, 2147483648
    v_writelane_b32 v16, s87, 0
    s_lshl_b32 s87, s46, 1
    s_add_u32 s87, s87, s49
    s_lshl_b32 s87, s87, 1
    s_lshr_b32 s88, s86, 4
    s_add_u32 s87, s87, s88
    s_lshl_b32 s87, s87, 6
    s_and_b32 s88, s86, 15
    s_add_u32 s87, s87, s88
    s_lshl2_add_u32 s87, s87, 688128
    v_writelane_b32 v18, s87, 0
    s_add_u32 s87, s87, 128
    v_writelane_b32 v18, s87, 1
    v_mov_b32 v17, s68
L_xkv:
    ds_read_b32 v14, v13
    ds_read_b128 v[172:175], v7 offset:0
    ds_read_b128 v[176:179], v7 offset:1024
    ds_read_b128 v[180:183], v7 offset:2048
    s_waitcnt lgkmcnt(0)
    v_cmp_eq_u32 vcc, 0, v14
    s_cbranch_vccz L_ok_2
    s_sub_u32 s56, s56, 1
    s_cbranch_scc0 L_xkv
    s_mov_b32 s56, 0
L_ok_2:
    v_pk_add_f32 v[160:161], v[160:161], v[172:173]
    v_pk_add_f32 v[162:163], v[162:163], v[174:175]
    v_pk_add_f32 v[164:165], v[164:165], v[176:177]
    v_pk_add_f32 v[166:167], v[166:167], v[178:179]
    v_pk_add_f32 v[168:169], v[168:169], v[180:181]
    v_pk_add_f32 v[170:171], v[170:171], v[182:183]
    v_cvt_pk_bf16_f32 v184, v160, v161
    v_cvt_pk_bf16_f32 v185, v162, v163
    v_cvt_pk_bf16_f32 v186, v164, v165
    v_cvt_pk_bf16_f32 v187, v166, v167
    buffer_store_dwordx4 v[184:187], v8, s[16:19], 0 offen sc1
    buffer_store_dwordx4 v[168:171], v9, s[16:19], 0 offen sc1
    buffer_atomic_swap v17, v16, s[16:19], 0 offen sc1
    v_pk_fma_f32 v[128:129], v[28:29], v[240:241], v[128:129] op_sel_hi:[1,0,1]
    v_pk_mul_f32 v[112:113], v[128:129], v[248:249] op_sel_hi:[1,0]
    v_pk_fma_f32 v[128:129], v[128:129], v[244:245], s[54:55] op_sel_hi:[1,0,1]
    v_exp_f32 v112, v112 clamp
    v_exp_f32 v113, v113 clamp
    v_max_f32 v128, s54, v128
    v_max_f32 v129, s54, v129
    v_pk_add_f32 v[128:129], v[128:129], v[112:113]
    v_cvt_pk_bf16_f32 v192, v128, v129
    v_pk_fma_f32 v[130:131], v[30:31], v[240:241], v[130:131] op_sel_hi:[1,0,1]
    v_pk_mul_f32 v[114:115], v[130:131], v[248:249] op_sel_hi:[1,0]
    v_pk_fma_f32 v[130:131], v[130:131], v[244:245], s[54:55] op_sel_hi:[1,0,1]
    v_exp_f32 v114, v114 clamp
    v_exp_f32 v115, v115 clamp
    v_max_f32 v130, s54, v130
    v_max_f32 v131, s54, v131
    v_pk_add_f32 v[130:131], v[130:131], v[114:115]
    v_cvt_pk_bf16_f32 v193, v130, v131
    v_pk_fma_f32 v[144:145], v[32:33], v[240:241], v[144:145] op_sel_hi:[1,0,1]
    v_pk_mul_f32 v[116:117], v[144:145], v[248:249] op_sel_hi:[1,0]
    v_pk_fma_f32 v[144:145], v[144:145], v[244:245], s[54:55] op_sel_hi:[1,0,1]
    v_exp_f32 v116, v116 clamp
    v_exp_f32 v117, v117 clamp
    v_max_f32 v144, s54, v144
    v_max_f32 v145, s54, v145
    v_pk_add_f32 v[144:145], v[144:145], v[116:117]
    v_cvt_pk_bf16_f32 v194, v144, v145
    v_pk_fma_f32 v[146:147], v[34:35], v[240:241], v[146:147] op_sel_hi:[1,0,1]
    v_pk_mul_f32 v[118:119], v[146:147], v[248:249] op_sel_hi:[1,0]
    v_pk_fma_f32 v[146:147], v[146:147], v[244:245], s[54:55] op_sel_hi:[1,0,1]
    v_exp_f32 v118, v118 clamp
    v_exp_f32 v119, v119 clamp
    v_max_f32 v146, s54, v146
    v_max_f32 v147, s54, v147
    v_pk_add_f32 v[146:147], v[146:147], v[118:119]
    v_cvt_pk_bf16_f32 v195, v146, v147
    v_pk_fma_f32 v[132:133], v[28:29], v[240:241], v[132:133] op_sel:[0,1,0] op_sel_hi:[1,1,1]
    v_pk_mul_f32 v[112:113], v[132:133], v[248:249] op_sel:[0,1] op_sel_hi:[1,1]
    v_pk_fma_f32 v[132:133], v[132:133], v[244:245], s[54:55] op_sel:[0,1,0] op_sel_hi:[1,1,1]
    v_exp_f32 v112, v112 clamp
    v_exp_f32 v113, v113 clamp
    v_max_f32 v132, s54, v132
    v_max_f32 v133, s54, v133
    v_pk_add_f32 v[132:133], v[132:133], v[112:113]
    v_cvt_pk_bf16_f32 v196, v132, v133
    v_pk_fma_f32 v[134:135], v[30:31], v[240:241], v[134:135] op_sel:[0,1,0] op_sel_hi:[1,1,1]
    v_pk_mul_f32 v[114:115], v[134:135], v[248:249] op_sel:[0,1] op_sel_hi:[1,1]
    v_pk_fma_f32 v[134:135], v[134:135], v[244:245], s[54:55] op_sel:[0,1,0] op_sel_hi:[1,1,1]
    v_exp_f32 v114, v114 clamp
    v_exp_f32 v115, v115 clamp
    v_max_f32 v134, s54, v134
    v_max_f32 v135, s54, v135
    v_pk_add_f32 v[134:135], v[134:135], v[114:115]
    v_cvt_pk_bf16_f32 v197, v134, v135
    v_pk_fma_f32 v[148:149], v[32:33], v[240:241], v[148:149] op_sel:[0,1,0] op_sel_hi:[1,1,1]
    v_pk_mul_f32 v[116:117], v[148:149], v[248:249] op_sel:[0,1] op_sel_hi:[1,1]
    v_pk_fma_f32 v[148:149], v[148:149], v[244:245], s[54:55] op_sel:[0,1,0] op_sel_hi:[1,1,1]
    v_exp_f32 v116, v116 clamp
    v_exp_f32 v117, v117 clamp
    v_max_f32 v148, s54, v148
    v_max_f32 v149, s54, v149
    v_pk_add_f32 v[148:149], v[148:149], v[116:117]
    v_cvt_pk_bf16_f32 v198, v148, v149
    v_pk_fma_f32 v[150:151], v[34:35], v[240:241], v[150:151] op_sel:[0,1,0] op_sel_hi:[1,1,1]
    v_pk_mul_f32 v[118:119], v[150:151], v[248:249] op_sel:[0,1] op_sel_hi:[1,1]
    v_pk_fma_f32 v[150:151], v[150:151], v[244:245], s[54:55] op_sel:[0,1,0] op_sel_hi:[1,1,1]
    v_exp_f32 v118, v118 clamp
    v_exp_f32 v119, v119 clamp
    v_max_f32 v150, s54, v150
    v_max_f32 v151, s54, v151
    v_pk_add_f32 v[150:151], v[150:151], v[118:119]
    v_cvt_pk_bf16_f32 v199, v150, v151
    v_pk_fma_f32 v[136:137], v[28:29], v[242:243], v[136:137] op_sel_hi:[1,0,1]
    v_pk_mul_f32 v[112:113], v[136:137], v[250:251] op_sel_hi:[1,0]
    v_pk_fma_f32 v[136:137], v[136:137], v[246:247], s[54:55] op_sel_hi:[1,0,1]
    v_exp_f32 v112, v112 clamp
    v_exp_f32 v113, v113 clamp
    v_max_f32 v136, s54, v136
    v_max_f32 v137, s54, v137
    v_pk_add_f32 v[136:137], v[136:137], v[112:113]
    v_cvt_pk_bf16_f32 v200, v136, v137
    v_pk_fma_f32 v[138:139], v[30:31], v[242:243], v[138:139] op_sel_hi:[1,0,1]
    v_pk_mul_f32 v[114:115], v[138:139], v[250:251] op_sel_hi:[1,0]
    v_pk_fma_f32 v[138:139], v[138:139], v[246:247], s[54:55] op_sel_hi:[1,0,1]
    v_exp_f32 v114, v114 clamp
    v_exp_f32 v115, v115 clamp
    v_max_f32 v138, s54, v138
    v_max_f32 v139, s54, v139
    v_pk_add_f32 v[138:139], v[138:139], v[114:115]
    v_cvt_pk_bf16_f32 v201, v138, v139
    v_pk_fma_f32 v[152:153], v[32:33], v[242:243], v[152:153] op_sel_hi:[1,0,1]
    v_pk_mul_f32 v[116:117], v[152:153], v[250:251] op_sel_hi:[1,0]
    v_pk_fma_f32 v[152:153], v[152:153], v[246:247], s[54:55] op_sel_hi:[1,0,1]
    v_exp_f32 v116, v116 clamp
    v_exp_f32 v117, v117 clamp
    v_max_f32 v152, s54, v152
    v_max_f32 v153, s54, v153
    v_pk_add_f32 v[152:153], v[152:153], v[116:117]
    v_cvt_pk_bf16_f32 v202, v152, v153
    v_pk_fma_f32 v[154:155], v[34:35], v[242:243], v[154:155] op_sel_hi:[1,0,1]
    v_pk_mul_f32 v[118:119], v[154:155], v[250:251] op_sel_hi:[1,0]
    v_pk_fma_f32 v[154:155], v[154:155], v[246:247], s[54:55] op_sel_hi:[1,0,1]
    v_exp_f32 v118, v118 clamp
    v_exp_f32 v119, v119 clamp
    v_max_f32 v154, s54, v154
    v_max_f32 v155, s54, v155
    v_pk_add_f32 v[154:155], v[154:155], v[118:119]
    v_cvt_pk_bf16_f32 v203, v154, v155
    v_pk_fma_f32 v[140:141], v[28:29], v[242:243], v[140:141] op_sel:[0,1,0] op_sel_hi:[1,1,1]
    v_pk_mul_f32 v[112:113], v[140:141], v[250:251] op_sel:[0,1] op_sel_hi:[1,1]
    v_pk_fma_f32 v[140:141], v[140:141], v[246:247], s[54:55] op_sel:[0,1,0] op_sel_hi:[1,1,1]
    v_exp_f32 v112, v112 clamp
    v_exp_f32 v113, v113 clamp
    v_max_f32 v140, s54, v140
    v_max_f32 v141, s54, v141
    v_pk_add_f32 v[140:141], v[140:141], v[112:113]
    v_cvt_pk_bf16_f32 v204, v140, v141
    v_pk_fma_f32 v[142:143], v[30:31], v[242:243], v[142:143] op_sel:[0,1,0] op_sel_hi:[1,1,1]
    v_pk_mul_f32 v[114:115], v[142:143], v[250:251] op_sel:[0,1] op_sel_hi:[1,1]
    v_pk_fma_f32 v[142:143], v[142:143], v[246:247], s[54:55] op_sel:[0,1,0] op_sel_hi:[1,1,1]
    v_exp_f32 v114, v114 clamp
    v_exp_f32 v115, v115 clamp
    v_max_f32 v142, s54, v142
    v_max_f32 v143, s54, v143
    v_pk_add_f32 v[142:143], v[142:143], v[114:115]
    v_cvt_pk_bf16_f32 v205, v142, v143
    v_pk_fma_f32 v[156:157], v[32:33], v[242:243], v[156:157] op_sel:[0,1,0] op_sel_hi:[1,1,1]
    v_pk_mul_f32 v[116:117], v[156:157], v[250:251] op_sel:[0,1] op_sel_hi:[1,1]
    v_pk_fma_f32 v[156:157], v[156:157], v[246:247], s[54:55] op_sel:[0,1,0] op_sel_hi:[1,1,1]
    v_exp_f32 v116, v116 clamp
    v_exp_f32 v117, v117 clamp
    v_max_f32 v156, s54, v156
    v_max_f32 v157, s54, v157
    v_pk_add_f32 v[156:157], v[156:157], v[116:117]
    v_cvt_pk_bf16_f32 v206, v156, v157
    v_pk_fma_f32 v[158:159], v[34:35], v[242:243], v[158:159] op_sel:[0,1,0] op_sel_hi:[1,1,1]
    v_pk_mul_f32 v[118:119], v[158:159], v[250:251] op_sel:[0,1] op_sel_hi:[1,1]
    v_pk_fma_f32 v[158:159], v[158:159], v[246:247], s[54:55] op_sel:[0,1,0] op_sel_hi:[1,1,1]
    v_exp_f32 v118, v118 clamp
    v_exp_f32 v119, v119 clamp
    v_max_f32 v158, s54, v158
    v_max_f32 v159, s54, v159
    v_pk_add_f32 v[158:159], v[158:159], v[118:119]
    v_cvt_pk_bf16_f32 v207, v158, v159
    s_lshr_b32 s62, s3, 2
    s_lshl_b32 s53, s51, 3
    s_lshl_b32 s86, s48, 1
    s_add_u32 s53, s53, s86
    s_add_u32 s53, s53, s62
    v_lshrrev_b32 v36, 4, v0
    v_and_b32 v37, 15, v0
    s_lshl_b32 s87, s53, 15
    s_lshl_b32 s86, s62, 14
    s_add_u32 s86, s86, s87
    s_add_u32 s86, s86, 1048576
    v_lshl_add_u32 v157, v0, 4, s86
    v_xor_b32 v158, 0x8000, v157
    s_lshl_b32 s86, s51, 1
    s_lshr_b32 s87, s48, 1
    s_add_u32 s86, s86, s87
    s_lshl_b32 s86, s86, 1
    s_add_u32 s86, s86, s62
    s_lshl_b32 s86, s86, 1
    s_and_b32 s87, s48, 1
    s_add_u32 s86, s86, s87
    s_lshl_b32 s86, s86, 7
    s_add_u32 s86, s86, 688128
    v_lshl_add_u32 v159, v0, 2, s86
    v_mov_b32 v38, 2147483648
    v_cmp_gt_u32 vcc, 16, v0
    s_nop 1
    v_cndmask_b32 v159, v38, v159, vcc
    v_bfe_u32 v38, v0, 2, 2
    v_lshl_add_u32 v38, v36, 2, v38
    v_bfe_u32 v39, v38, 1, 2
    v_lshlrev_b32 v38, 7, v38
    v_lshl_add_u32 v38, v39, 5, v38
    v_and_b32 v39, 3, v0
    v_lshl_add_u32 v38, v39, 3, v38
    s_lshl_b32 s86, s62, 16
    s_add_u32 s86, s86, 0
    v_add_u32 v144, s86, v38
    v_xor_b32 v145, 32, v144
    v_xor_b32 v146, 64, v144
    v_xor_b32 v147, 96, v144
    v_cmp_eq_u32 s[4:5], 1, v39
    v_cmp_eq_u32 s[6:7], 2, v39
    v_cmp_eq_u32 s[98:99], 3, v39
    s_lshl_b32 s86, s53, 10
    s_add_u32 s86, s86, 786432
    v_lshl_add_u32 v160, v0, 2, s86
    v_mul_u32_u24 v161, 192, v36
    v_add_u32 v160, v160, v161
    s_mov_b32 s72, 0x00f0000f
    s_mov_b32 s73, 0xf0000f00
    s_mov_b32 s74, 0x0f00f000
    s_mov_b32 s75, 0x0f00f000
    v_lshrrev_b32 v38, 2, v37
    v_lshl_add_u32 v161, v38, 4, v37
    v_lshlrev_b32 v161, 2, v161
    s_lshl_b32 s86, s3, 12
    s_add_u32 s86, s86, 131072
    v_lshl_add_u32 v162, v0, 4, s86
    v_xor_b32 v163, 0x4000, v162
    s_lshl_b32 s86, s52, 7
    v_lshl_add_u32 v36, v36, 3, s86
    s_lshl_b32 s87, s53, 15
    s_add_u32 s87, s87, s86
    s_lshl_b32 s86, s62, 6
    s_add_u32 s87, s87, s86
    v_lshl_add_u32 v39, v37, 11, s87
    v_and_b32 v38, 48, v0
    v_add_u32 v39, v39, v38
    v_xor_b32 v37, 0x8000, v39
    buffer_load_dwordx4 v[136:139], v39, s[8:11], 0 offen
    buffer_load_dwordx4 v[140:143], v37, s[8:11], 0 offen
    buffer_load_dwordx2 v[148:149], v36, s[40:43], 0 offen offset:0
    buffer_load_dwordx2 v[150:151], v36, s[40:43], 0 offen offset:32
    buffer_load_dwordx2 v[152:153], v36, s[40:43], 0 offen offset:64
    buffer_load_dwordx2 v[154:155], v36, s[40:43], 0 offen offset:96
    s_barrier
    ds_read_b128 v[40:43], v11 offset:0
    ds_read_b128 v[44:47], v11 offset:1024
    ds_read_b128 v[48:51], v11 offset:2048
    v_mov_b32 v38, 135200
    ds_read_b32 v38, v38
    s_mov_b32 s86, 0x8000
    s_mov_b32 s87, 0x10000
    s_mov_b32 s88, 0x18000
    s_waitcnt lgkmcnt(0)
    v_mfma_f32_16x16x32_bf16 v[216:219], v[48:51], v[192:195], 0
    v_mfma_f32_16x16x32_bf16 v[208:211], v[40:43], v[192:195], 0
    v_mfma_f32_16x16x32_bf16 v[212:215], v[44:47], v[192:195], 0
    v_mfma_f32_16x16x32_bf16 v[228:231], v[48:51], v[196:199], 0
    v_mfma_f32_16x16x32_bf16 v[220:223], v[40:43], v[196:199], 0
    v_mfma_f32_16x16x32_bf16 v[224:227], v[44:47], v[196:199], 0
    v_mfma_f32_16x16x32_bf16 v[240:243], v[48:51], v[200:203], 0
    v_mfma_f32_16x16x32_bf16 v[232:235], v[40:43], v[200:203], 0
    v_mfma_f32_16x16x32_bf16 v[236:239], v[44:47], v[200:203], 0
    v_mfma_f32_16x16x32_bf16 v[252:255], v[48:51], v[204:207], 0
    v_mfma_f32_16x16x32_bf16 v[244:247], v[40:43], v[204:207], 0
    v_mfma_f32_16x16x32_bf16 v[248:251], v[44:47], v[204:207], 0
    v_add_f32 v216, s54, v216
    v_rcp_f32 v216, v216
    s_nop 0
    v_pk_mul_f32 v[208:209], v[208:209], v[216:217] op_sel_hi:[1,0]
    v_pk_mul_f32 v[210:211], v[210:211], v[216:217] op_sel_hi:[1,0]
    v_pk_mul_f32 v[212:213], v[212:213], v[216:217] op_sel_hi:[1,0]
    v_pk_mul_f32 v[214:215], v[214:215], v[216:217] op_sel_hi:[1,0]
    v_cvt_pk_bf16_f32 v60, v208, v209
    v_cvt_pk_bf16_f32 v61, v210, v211
    v_cvt_pk_bf16_f32 v62, v212, v213
    v_cvt_pk_bf16_f32 v63, v214, v215
    buffer_store_dwordx4 v[60:63], v10, s[16:19], 0 offen sc1
    v_add_f32 v228, s54, v228
    v_rcp_f32 v228, v228
    s_nop 0
    v_pk_mul_f32 v[220:221], v[220:221], v[228:229] op_sel_hi:[1,0]
    v_pk_mul_f32 v[222:223], v[222:223], v[228:229] op_sel_hi:[1,0]
    v_pk_mul_f32 v[224:225], v[224:225], v[228:229] op_sel_hi:[1,0]
    v_pk_mul_f32 v[226:227], v[226:227], v[228:229] op_sel_hi:[1,0]
    v_cvt_pk_bf16_f32 v64, v220, v221
    v_cvt_pk_bf16_f32 v65, v222, v223
    v_cvt_pk_bf16_f32 v66, v224, v225
    v_cvt_pk_bf16_f32 v67, v226, v227
    buffer_store_dwordx4 v[64:67], v10, s[16:19], s86 offen sc1
    v_add_f32 v240, s54, v240
    v_rcp_f32 v240, v240
    s_nop 0
    v_pk_mul_f32 v[232:233], v[232:233], v[240:241] op_sel_hi:[1,0]
    v_pk_mul_f32 v[234:235], v[234:235], v[240:241] op_sel_hi:[1,0]
    v_pk_mul_f32 v[236:237], v[236:237], v[240:241] op_sel_hi:[1,0]
    v_pk_mul_f32 v[238:239], v[238:239], v[240:241] op_sel_hi:[1,0]
    v_cvt_pk_bf16_f32 v68, v232, v233
    v_cvt_pk_bf16_f32 v69, v234, v235
    v_cvt_pk_bf16_f32 v70, v236, v237
    v_cvt_pk_bf16_f32 v71, v238, v239
    buffer_store_dwordx4 v[68:71], v10, s[16:19], s87 offen sc1
    v_add_f32 v252, s54, v252
    v_rcp_f32 v252, v252
    s_nop 0
    v_pk_mul_f32 v[244:245], v[244:245], v[252:253] op_sel_hi:[1,0]
    v_pk_mul_f32 v[246:247], v[246:247], v[252:253] op_sel_hi:[1,0]
    v_pk_mul_f32 v[248:249], v[248:249], v[252:253] op_sel_hi:[1,0]
    v_pk_mul_f32 v[250:251], v[250:251], v[252:253] op_sel_hi:[1,0]
    v_cvt_pk_bf16_f32 v72, v244, v245
    v_cvt_pk_bf16_f32 v73, v246, v247
    v_cvt_pk_bf16_f32 v74, v248, v249
    v_cvt_pk_bf16_f32 v75, v250, v251
    buffer_store_dwordx4 v[72:75], v10, s[16:19], s88 offen sc1
    buffer_atomic_swap v17, v18, s[16:19], 0 offen sc1
    v_mov_b32 v8, 0
    buffer_atomic_or v8, v159, s[16:19], 0 offen sc0 sc1
    v_mov_b32 v14, 2147483648
    v_mov_b32 v11, 2147483648
    s_waitcnt vmcnt(6)
    v_bfe_u32 v36, v0, 2, 1
    v_cmp_eq_u32 vcc, 1, v36
    v_mov_b32 v36, s95
    s_nop 0
    v_cndmask_b32 v148, v36, v148, vcc
    v_cndmask_b32 v149, v36, v149, vcc
    v_cndmask_b32 v150, v36, v150, vcc
    v_cndmask_b32 v151, v36, v151, vcc
    v_cndmask_b32 v152, v36, v152, vcc
    v_cndmask_b32 v153, v36, v153, vcc
    v_cndmask_b32 v154, v36, v154, vcc
    v_cndmask_b32 v155, v36, v155, vcc
    v_readfirstlane_b32 s57, v38
L_phaseB:
    v_lshrrev_b32 v1, 4, v0
    v_and_b32 v2, 15, v0
    v_mov_b32 v3, 0x3f80
    s_lshl_b32 s87, s53, 4
    v_add_u32 v6, s87, v2
    s_lshl_b32 s86, s52, 7
    v_lshl_add_u32 v5, v6, 11, s86
    v_sub_u32 v6, 2047, v6
    v_mov_b32 v7, v39
    v_lshrrev_b32 v9, 1, v1
    v_lshl_add_u32 v5, v9, 4, v5
    v_and_b32 v9, 1, v1
    v_lshl_add_u32 v5, v9, 5, v5
    s_mov_b32 s67, 0
    s_mov_b32 s66, 0xffffaaaa
    s_mov_b32 s63, 0
L_b_init:
    v_bfe_u32 v9, v0, 3, 1
    v_bfe_u32 v10, v0, 4, 1
    v_xor_b32 v9, v9, v10
    v_bfe_u32 v10, v0, 1, 2
    v_lshl_add_u32 v9, v9, 3, v10
    v_lshrrev_b32 v10, 5, v0
    v_lshl_add_u32 v9, v10, 2, v9
    v_and_b32 v10, 1, v0
    v_lshlrev_b32 v10, 4, v10
    v_lshlrev_b32 v10, v10, v3
    v_cmp_eq_u32 vcc, 0, v9
    s_nop 1
    v_cndmask_b32 v128, 0, v10, vcc
    v_cmp_eq_u32 vcc, 1, v9
    s_nop 1
    v_cndmask_b32 v129, 0, v10, vcc
    v_cmp_eq_u32 vcc, 2, v9
    s_nop 1
    v_cndmask_b32 v130, 0, v10, vcc
    v_cmp_eq_u32 vcc, 3, v9
    s_nop 1
    v_cndmask_b32 v131, 0, v10, vcc
    v_cmp_eq_u32 vcc, 4, v9
    s_nop 1
    v_cndmask_b32 v132, 0, v10, vcc
    v_cmp_eq_u32 vcc, 5, v9
    s_nop 1
    v_cndmask_b32 v133, 0, v10, vcc
    v_cmp_eq_u32 vcc, 6, v9
    s_nop 1
    v_cndmask_b32 v134, 0, v10, vcc
    v_cmp_eq_u32 vcc, 7, v9
    s_nop 1
    v_cndmask_b32 v135, 0, v10, vcc
    v_mov_b32 v80, 0
    v_mov_b32 v81, 0
    v_mov_b32 v82, 0
    v_mov_b32 v83, 0
    v_mov_b32 v84, 0
    v_mov_b32 v85, 0
    v_mov_b32 v86, 0
    v_mov_b32 v87, 0
    v_mov_b32 v88, 0
    v_mov_b32 v89, 0
    v_mov_b32 v90, 0
    v_mov_b32 v91, 0
    v_mov_b32 v92, 0
    v_mov_b32 v93, 0
    v_mov_b32 v94, 0
    v_mov_b32 v95, 0
    v_mov_b32 v96, 0
    v_mov_b32 v97, 0
    v_mov_b32 v98, 0
    v_mov_b32 v99, 0
    v_mov_b32 v100, 0
    v_mov_b32 v101, 0
    v_mov_b32 v102, 0
    v_mov_b32 v103, 0
    v_mov_b32 v104, 0
    v_mov_b32 v105, 0
    v_mov_b32 v106, 0
    v_mov_b32 v107, 0
    v_mov_b32 v108, 0
    v_mov_b32 v109, 0
    v_mov_b32 v110, 0
    v_mov_b32 v111, 0
    v_mov_b32 v156, 0
    s_branch L_b_w0
L_b_r0:
    s_ff1_i32_b32 s91, s65
    s_bitset0_b32 s65, s91
    s_lshl_b32 s76, s91, 12
    s_lshl_b32 s91, s91, 10
    buffer_load_dwordx4 v[16:19], v157, s[16:19], s91 offen offset:0 sc1
    buffer_load_dwordx4 v[20:23], v158, s[16:19], s91 offen offset:0 sc1
    buffer_load_dwordx4 v[24:27], v157, s[16:19], s91 offen offset:1024 sc1
    buffer_load_dwordx4 v[28:31], v158, s[16:19], s91 offen offset:1024 sc1
    s_cmp_eq_u32 s65, 0
    s_cbranch_scc1 L_b_p1
L_b_r1:
    s_ff1_i32_b32 s91, s65
    s_bitset0_b32 s65, s91
    s_lshl_b32 s77, s91, 12
    s_lshl_b32 s91, s91, 10
    buffer_load_dwordx4 v[32:35], v157, s[16:19], s91 offen offset:0 sc1
    buffer_load_dwordx4 v[36:39], v158, s[16:19], s91 offen offset:0 sc1
    buffer_load_dwordx4 v[40:43], v157, s[16:19], s91 offen offset:1024 sc1
    buffer_load_dwordx4 v[44:47], v158, s[16:19], s91 offen offset:1024 sc1
    s_xor_b32 s89, s67, s76
    s_mov_b32 s67, s76
    v_xor_b32 v144, s89, v144
    ds_read_b64_tr_b16 v[112:113], v144 offset:0
    ds_read_b64_tr_b16 v[114:115], v144 offset:2048
    v_xor_b32 v145, s89, v145
    ds_read_b64_tr_b16 v[116:117], v145 offset:0
    ds_read_b64_tr_b16 v[118:119], v145 offset:2048
    v_xor_b32 v146, s89, v146
    ds_read_b64_tr_b16 v[120:121], v146 offset:0
    ds_read_b64_tr_b16 v[122:123], v146 offset:2048
    v_xor_b32 v147, s89, v147
    ds_read_b64_tr_b16 v[124:125], v147 offset:0
    ds_read_b64_tr_b16 v[126:127], v147 offset:2048
    s_cmp_eq_u32 s62, 0
    s_cbranch_scc0 L_b_x1
    v_mfma_f32_16x16x32_bf16 v[80:83], v[128:131], v[136:139], 0
    v_mfma_f32_16x16x32_bf16 v[96:99], v[128:131], v[140:143], 0
    v_mfma_f32_16x16x32_bf16 v[84:87], v[132:135], v[136:139], 0
    v_mfma_f32_16x16x32_bf16 v[100:103], v[132:135], v[140:143], 0
    s_branch L_b_xd
L_b_x1:
    v_mfma_f32_16x16x32_bf16 v[88:91], v[128:131], v[136:139], 0
    v_mfma_f32_16x16x32_bf16 v[104:107], v[128:131], v[140:143], 0
    v_mfma_f32_16x16x32_bf16 v[92:95], v[132:135], v[136:139], 0
    v_mfma_f32_16x16x32_bf16 v[108:111], v[132:135], v[140:143], 0
L_b_xd:
    s_waitcnt vmcnt(6) lgkmcnt(6)
    v_max3_u32 v156, v156, v19, v23
    v_mfma_f32_16x16x32_bf16 v[80:83], v[112:115], v[16:19], v[80:83]
    ds_read_b64_tr_b16 v[128:129], v144 offset:4096
    v_mfma_f32_16x16x32_bf16 v[96:99], v[112:115], v[20:23], v[96:99]
    ds_read_b64_tr_b16 v[130:131], v144 offset:6144
    s_waitcnt lgkmcnt(6)
    v_mfma_f32_16x16x32_bf16 v[84:87], v[116:119], v[16:19], v[84:87]
    ds_read_b64_tr_b16 v[132:133], v145 offset:4096
    v_mfma_f32_16x16x32_bf16 v[100:103], v[116:119], v[20:23], v[100:103]
    ds_read_b64_tr_b16 v[134:135], v145 offset:6144
    s_waitcnt lgkmcnt(6)
    v_mfma_f32_16x16x32_bf16 v[88:91], v[120:123], v[16:19], v[88:91]
    ds_read_b64_tr_b16 v[136:137], v146 offset:4096
    v_mfma_f32_16x16x32_bf16 v[104:107], v[120:123], v[20:23], v[104:107]
    ds_read_b64_tr_b16 v[138:139], v146 offset:6144
    s_waitcnt lgkmcnt(6)
    v_mfma_f32_16x16x32_bf16 v[92:95], v[124:127], v[16:19], v[92:95]
    ds_read_b64_tr_b16 v[140:141], v147 offset:4096
    v_mfma_f32_16x16x32_bf16 v[108:111], v[124:127], v[20:23], v[108:111]
    ds_read_b64_tr_b16 v[142:143], v147 offset:6144
    s_cmp_eq_u32 s65, 0
    s_cbranch_scc1 L_b_p2
L_b_r2:
    s_ff1_i32_b32 s91, s65
    s_bitset0_b32 s65, s91
    s_lshl_b32 s78, s91, 12
    s_lshl_b32 s91, s91, 10
    buffer_load_dwordx4 v[48:51], v157, s[16:19], s91 offen offset:0 sc1
    buffer_load_dwordx4 v[52:55], v158, s[16:19], s91 offen offset:0 sc1
    s_waitcnt vmcnt(6) lgkmcnt(6)
    v_max3_u32 v156, v156, v27, v31
    v_mfma_f32_16x16x32_bf16 v[80:83], v[128:131], v[24:27], v[80:83]
    s_xor_b32 s89, s67, s77
    s_mov_b32 s67, s77
    v_xor_b32 v144, s89, v144
    ds_read_b64_tr_b16 v[112:113], v144 offset:0
    v_mfma_f32_16x16x32_bf16 v[96:99], v[128:131], v[28:31], v[96:99]
    ds_read_b64_tr_b16 v[114:115], v144 offset:2048
    s_waitcnt lgkmcnt(6)
    v_mfma_f32_16x16x32_bf16 v[84:87], v[132:135], v[24:27], v[84:87]
    v_xor_b32 v145, s89, v145
    ds_read_b64_tr_b16 v[116:117], v145 offset:0
    v_mfma_f32_16x16x32_bf16 v[100:103], v[132:135], v[28:31], v[100:103]
    ds_read_b64_tr_b16 v[118:119], v145 offset:2048
    s_waitcnt lgkmcnt(6)
    v_mfma_f32_16x16x32_bf16 v[88:91], v[136:139], v[24:27], v[88:91]
    v_xor_b32 v146, s89, v146
    ds_read_b64_tr_b16 v[120:121], v146 offset:0
    v_mfma_f32_16x16x32_bf16 v[104:107], v[136:139], v[28:31], v[104:107]
    ds_read_b64_tr_b16 v[122:123], v146 offset:2048
    s_waitcnt lgkmcnt(6)
    v_mfma_f32_16x16x32_bf16 v[92:95], v[140:143], v[24:27], v[92:95]
    v_xor_b32 v147, s89, v147
    ds_read_b64_tr_b16 v[124:125], v147 offset:0
    v_mfma_f32_16x16x32_bf16 v[108:111], v[140:143], v[28:31], v[108:111]
    ds_read_b64_tr_b16 v[126:127], v147 offset:2048
    buffer_load_dwordx4 v[56:59], v157, s[16:19], s91 offen offset:1024 sc1
    buffer_load_dwordx4 v[60:63], v158, s[16:19], s91 offen offset:1024 sc1
    s_waitcnt vmcnt(6) lgkmcnt(6)
    v_max3_u32 v156, v156, v35, v39
    v_mfma_f32_16x16x32_bf16 v[80:83], v[112:115], v[32:35], v[80:83]
    ds_read_b64_tr_b16 v[128:129], v144 offset:4096
    v_mfma_f32_16x16x32_bf16 v[96:99], v[112:115], v[36:39], v[96:99]
    ds_read_b64_tr_b16 v[130:131], v144 offset:6144
    s_waitcnt lgkmcnt(6)
    v_mfma_f32_16x16x32_bf16 v[84:87], v[116:119], v[32:35], v[84:87]
    ds_read_b64_tr_b16 v[132:133], v145 offset:4096
    v_mfma_f32_16x16x32_bf16 v[100:103], v[116:119], v[36:39], v[100:103]
    ds_read_b64_tr_b16 v[134:135], v145 offset:6144
    s_waitcnt lgkmcnt(6)
    v_mfma_f32_16x16x32_bf16 v[88:91], v[120:123], v[32:35], v[88:91]
    ds_read_b64_tr_b16 v[136:137], v146 offset:4096
    v_mfma_f32_16x16x32_bf16 v[104:107], v[120:123], v[36:39], v[104:107]
    ds_read_b64_tr_b16 v[138:139], v146 offset:6144
    s_waitcnt lgkmcnt(6)
    v_mfma_f32_16x16x32_bf16 v[92:95], v[124:127], v[32:35], v[92:95]
    ds_read_b64_tr_b16 v[140:141], v147 offset:4096
    v_mfma_f32_16x16x32_bf16 v[108:111], v[124:127], v[36:39], v[108:111]
    ds_read_b64_tr_b16 v[142:143], v147 offset:6144
    s_cmp_eq_u32 s65, 0
    s_cbranch_scc1 L_b_p3
L_b_r3:
    s_ff1_i32_b32 s91, s65
    s_bitset0_b32 s65, s91
    s_lshl_b32 s79, s91, 12
    s_lshl_b32 s91, s91, 10
    buffer_load_dwordx4 v[64:67], v157, s[16:19], s91 offen offset:0 sc1
    buffer_load_dwordx4 v[68:71], v158, s[16:19], s91 offen offset:0 sc1
    s_waitcnt vmcnt(6) lgkmcnt(6)
    v_max3_u32 v156, v156, v43, v47
    v_mfma_f32_16x16x32_bf16 v[80:83], v[128:131], v[40:43], v[80:83]
    s_xor_b32 s89, s67, s78
    s_mov_b32 s67, s78
    v_xor_b32 v144, s89, v144
    ds_read_b64_tr_b16 v[112:113], v144 offset:0
    v_mfma_f32_16x16x32_bf16 v[96:99], v[128:131], v[44:47], v[96:99]
    ds_read_b64_tr_b16 v[114:115], v144 offset:2048
    s_waitcnt lgkmcnt(6)
    v_mfma_f32_16x16x32_bf16 v[84:87], v[132:135], v[40:43], v[84:87]
    v_xor_b32 v145, s89, v145
    ds_read_b64_tr_b16 v[116:117], v145 offset:0
    v_mfma_f32_16x16x32_bf16 v[100:103], v[132:135], v[44:47], v[100:103]
    ds_read_b64_tr_b16 v[118:119], v145 offset:2048
    s_waitcnt lgkmcnt(6)
    v_mfma_f32_16x16x32_bf16 v[88:91], v[136:139], v[40:43], v[88:91]
    v_xor_b32 v146, s89, v146
    ds_read_b64_tr_b16 v[120:121], v146 offset:0
    v_mfma_f32_16x16x32_bf16 v[104:107], v[136:139], v[44:47], v[104:107]
    ds_read_b64_tr_b16 v[122:123], v146 offset:2048
    s_waitcnt lgkmcnt(6)
    v_mfma_f32_16x16x32_bf16 v[92:95], v[140:143], v[40:43], v[92:95]
    v_xor_b32 v147, s89, v147
    ds_read_b64_tr_b16 v[124:125], v147 offset:0
    v_mfma_f32_16x16x32_bf16 v[108:111], v[140:143], v[44:47], v[108:111]
    ds_read_b64_tr_b16 v[126:127], v147 offset:2048
    buffer_load_dwordx4 v[72:75], v157, s[16:19], s91 offen offset:1024 sc1
    buffer_load_dwordx4 v[76:79], v158, s[16:19], s91 offen offset:1024 sc1
    s_waitcnt vmcnt(6) lgkmcnt(6)
    v_max3_u32 v156, v156, v51, v55
    v_mfma_f32_16x16x32_bf16 v[80:83], v[112:115], v[48:51], v[80:83]
    ds_read_b64_tr_b16 v[128:129], v144 offset:4096
    v_mfma_f32_16x16x32_bf16 v[96:99], v[112:115], v[52:55], v[96:99]
    ds_read_b64_tr_b16 v[130:131], v144 offset:6144
    s_waitcnt lgkmcnt(6)
    v_mfma_f32_16x16x32_bf16 v[84:87], v[116:119], v[48:51], v[84:87]
    ds_read_b64_tr_b16 v[132:133], v145 offset:4096
    v_mfma_f32_16x16x32_bf16 v[100:103], v[116:119], v[52:55], v[100:103]
    ds_read_b64_tr_b16 v[134:135], v145 offset:6144
    s_waitcnt lgkmcnt(6)
    v_mfma_f32_16x16x32_bf16 v[88:91], v[120:123], v[48:51], v[88:91]
    ds_read_b64_tr_b16 v[136:137], v146 offset:4096
    v_mfma_f32_16x16x32_bf16 v[104:107], v[120:123], v[52:55], v[104:107]
    ds_read_b64_tr_b16 v[138:139], v146 offset:6144
    s_waitcnt lgkmcnt(6)
    v_mfma_f32_16x16x32_bf16 v[92:95], v[124:127], v[48:51], v[92:95]
    ds_read_b64_tr_b16 v[140:141], v147 offset:4096
    v_mfma_f32_16x16x32_bf16 v[108:111], v[124:127], v[52:55], v[108:111]
    ds_read_b64_tr_b16 v[142:143], v147 offset:6144
    s_cmp_eq_u32 s65, 0
    s_cbranch_scc1 L_b_p4
L_b_r4:
    s_ff1_i32_b32 s91, s65
    s_bitset0_b32 s65, s91
    s_lshl_b32 s76, s91, 12
    s_lshl_b32 s91, s91, 10
    buffer_load_dwordx4 v[16:19], v157, s[16:19], s91 offen offset:0 sc1
    buffer_load_dwordx4 v[20:23], v158, s[16:19], s91 offen offset:0 sc1
    s_waitcnt vmcnt(6) lgkmcnt(6)
    v_max3_u32 v156, v156, v59, v63
    v_mfma_f32_16x16x32_bf16 v[80:83], v[128:131], v[56:59], v[80:83]
    s_xor_b32 s89, s67, s79
    s_mov_b32 s67, s79
    v_xor_b32 v144, s89, v144
    ds_read_b64_tr_b16 v[112:113], v144 offset:0
    v_mfma_f32_16x16x32_bf16 v[96:99], v[128:131], v[60:63], v[96:99]
    ds_read_b64_tr_b16 v[114:115], v144 offset:2048
    s_waitcnt lgkmcnt(6)
    v_mfma_f32_16x16x32_bf16 v[84:87], v[132:135], v[56:59], v[84:87]
    v_xor_b32 v145, s89, v145
    ds_read_b64_tr_b16 v[116:117], v145 offset:0
    v_mfma_f32_16x16x32_bf16 v[100:103], v[132:135], v[60:63], v[100:103]
    ds_read_b64_tr_b16 v[118:119], v145 offset:2048
    s_waitcnt lgkmcnt(6)
    v_mfma_f32_16x16x32_bf16 v[88:91], v[136:139], v[56:59], v[88:91]
    v_xor_b32 v146, s89, v146
    ds_read_b64_tr_b16 v[120:121], v146 offset:0
    v_mfma_f32_16x16x32_bf16 v[104:107], v[136:139], v[60:63], v[104:107]
    ds_read_b64_tr_b16 v[122:123], v146 offset:2048
    s_waitcnt lgkmcnt(6)
    v_mfma_f32_16x16x32_bf16 v[92:95], v[140:143], v[56:59], v[92:95]
    v_xor_b32 v147, s89, v147
    ds_read_b64_tr_b16 v[124:125], v147 offset:0
    v_mfma_f32_16x16x32_bf16 v[108:111], v[140:143], v[60:63], v[108:111]
    ds_read_b64_tr_b16 v[126:127], v147 offset:2048
    buffer_load_dwordx4 v[24:27], v157, s[16:19], s91 offen offset:1024 sc1
    buffer_load_dwordx4 v[28:31], v158, s[16:19], s91 offen offset:1024 sc1
    s_waitcnt vmcnt(6) lgkmcnt(6)
    v_max3_u32 v156, v156, v67, v71
    v_mfma_f32_16x16x32_bf16 v[80:83], v[112:115], v[64:67], v[80:83]
    ds_read_b64_tr_b16 v[128:129], v144 offset:4096
    v_mfma_f32_16x16x32_bf16 v[96:99], v[112:115], v[68:71], v[96:99]
    ds_read_b64_tr_b16 v[130:131], v144 offset:6144
    s_waitcnt lgkmcnt(6)
    v_mfma_f32_16x16x32_bf16 v[84:87], v[116:119], v[64:67], v[84:87]
    ds_read_b64_tr_b16 v[132:133], v145 offset:4096
    v_mfma_f32_16x16x32_bf16 v[100:103], v[116:119], v[68:71], v[100:103]
    ds_read_b64_tr_b16 v[134:135], v145 offset:6144
    s_waitcnt lgkmcnt(6)
    v_mfma_f32_16x16x32_bf16 v[88:91], v[120:123], v[64:67], v[88:91]
    ds_read_b64_tr_b16 v[136:137], v146 offset:4096
    v_mfma_f32_16x16x32_bf16 v[104:107], v[120:123], v[68:71], v[104:107]
    ds_read_b64_tr_b16 v[138:139], v146 offset:6144
    s_waitcnt lgkmcnt(6)
    v_mfma_f32_16x16x32_bf16 v[92:95], v[124:127], v[64:67], v[92:95]
    ds_read_b64_tr_b16 v[140:141], v147 offset:4096
    v_mfma_f32_16x16x32_bf16 v[108:111], v[124:127], v[68:71], v[108:111]
    ds_read_b64_tr_b16 v[142:143], v147 offset:6144
    s_cmp_eq_u32 s65, 0
    s_cbranch_scc1 L_b_p5
L_b_r5:
    s_ff1_i32_b32 s91, s65
    s_bitset0_b32 s65, s91
    s_lshl_b32 s77, s91, 12
    s_lshl_b32 s91, s91, 10
    buffer_load_dwordx4 v[32:35], v157, s[16:19], s91 offen offset:0 sc1
    buffer_load_dwordx4 v[36:39], v158, s[16:19], s91 offen offset:0 sc1
    s_waitcnt vmcnt(6) lgkmcnt(6)
    v_max3_u32 v156, v156, v75, v79
    v_mfma_f32_16x16x32_bf16 v[80:83], v[128:131], v[72:75], v[80:83]
    s_xor_b32 s89, s67, s76
    s_mov_b32 s67, s76
    v_xor_b32 v144, s89, v144
    ds_read_b64_tr_b16 v[112:113], v144 offset:0
    v_mfma_f32_16x16x32_bf16 v[96:99], v[128:131], v[76:79], v[96:99]
    ds_read_b64_tr_b16 v[114:115], v144 offset:2048
    s_waitcnt lgkmcnt(6)
    v_mfma_f32_16x16x32_bf16 v[84:87], v[132:135], v[72:75], v[84:87]
    v_xor_b32 v145, s89, v145
    ds_read_b64_tr_b16 v[116:117], v145 offset:0
    v_mfma_f32_16x16x32_bf16 v[100:103], v[132:135], v[76:79], v[100:103]
    ds_read_b64_tr_b16 v[118:119], v145 offset:2048
    s_waitcnt lgkmcnt(6)
    v_mfma_f32_16x16x32_bf16 v[88:91], v[136:139], v[72:75], v[88:91]
    v_xor_b32 v146, s89, v146
    ds_read_b64_tr_b16 v[120:121], v146 offset:0
    v_mfma_f32_16x16x32_bf16 v[104:107], v[136:139], v[76:79], v[104:107]
    ds_read_b64_tr_b16 v[122:123], v146 offset:2048
    s_waitcnt lgkmcnt(6)
    v_mfma_f32_16x16x32_bf16 v[92:95], v[140:143], v[72:75], v[92:95]
    v_xor_b32 v147, s89, v147
    ds_read_b64_tr_b16 v[124:125], v147 offset:0
    v_mfma_f32_16x16x32_bf16 v[108:111], v[140:143], v[76:79], v[108:111]
    ds_read_b64_tr_b16 v[126:127], v147 offset:2048
    buffer_load_dwordx4 v[40:43], v157, s[16:19], s91 offen offset:1024 sc1
    buffer_load_dwordx4 v[44:47], v158, s[16:19], s91 offen offset:1024 sc1
    s_waitcnt vmcnt(6) lgkmcnt(6)
    v_max3_u32 v156, v156, v19, v23
    v_mfma_f32_16x16x32_bf16 v[80:83], v[112:115], v[16:19], v[80:83]
    ds_read_b64_tr_b16 v[128:129], v144 offset:4096
    v_mfma_f32_16x16x32_bf16 v[96:99], v[112:115], v[20:23], v[96:99]
    ds_read_b64_tr_b16 v[130:131], v144 offset:6144
    s_waitcnt lgkmcnt(6)
    v_mfma_f32_16x16x32_bf16 v[84:87], v[116:119], v[16:19], v[84:87]
    ds_read_b64_tr_b16 v[132:133], v145 offset:4096
    v_mfma_f32_16x16x32_bf16 v[100:103], v[116:119], v[20:23], v[100:103]
    ds_read_b64_tr_b16 v[134:135], v145 offset:6144
    s_waitcnt lgkmcnt(6)
    v_mfma_f32_16x16x32_bf16 v[88:91], v[120:123], v[16:19], v[88:91]
    ds_read_b64_tr_b16 v[136:137], v146 offset:4096
    v_mfma_f32_16x16x32_bf16 v[104:107], v[120:123], v[20:23], v[104:107]
    ds_read_b64_tr_b16 v[138:139], v146 offset:6144
    s_waitcnt lgkmcnt(6)
    v_mfma_f32_16x16x32_bf16 v[92:95], v[124:127], v[16:19], v[92:95]
    ds_read_b64_tr_b16 v[140:141], v147 offset:4096
    v_mfma_f32_16x16x32_bf16 v[108:111], v[124:127], v[20:23], v[108:111]
    ds_read_b64_tr_b16 v[142:143], v147 offset:6144
    s_cmp_eq_u32 s65, 0
    s_cbranch_scc1 L_b_p6
L_b_r6:
    s_ff1_i32_b32 s91, s65
    s_bitset0_b32 s65, s91
    s_lshl_b32 s78, s91, 12
    s_lshl_b32 s91, s91, 10
    buffer_load_dwordx4 v[48:51], v157, s[16:19], s91 offen offset:0 sc1
    buffer_load_dwordx4 v[52:55], v158, s[16:19], s91 offen offset:0 sc1
    s_waitcnt vmcnt(6) lgkmcnt(6)
    v_max3_u32 v156, v156, v27, v31
    v_mfma_f32_16x16x32_bf16 v[80:83], v[128:131], v[24:27], v[80:83]
    s_xor_b32 s89, s67, s77
    s_mov_b32 s67, s77
    v_xor_b32 v144, s89, v144
    ds_read_b64_tr_b16 v[112:113], v144 offset:0
    v_mfma_f32_16x16x32_bf16 v[96:99], v[128:131], v[28:31], v[96:99]
    ds_read_b64_tr_b16 v[114:115], v144 offset:2048
    s_waitcnt lgkmcnt(6)
    v_mfma_f32_16x16x32_bf16 v[84:87], v[132:135], v[24:27], v[84:87]
    v_xor_b32 v145, s89, v145
    ds_read_b64_tr_b16 v[116:117], v145 offset:0
    v_mfma_f32_16x16x32_bf16 v[100:103], v[132:135], v[28:31], v[100:103]
    ds_read_b64_tr_b16 v[118:119], v145 offset:2048
    s_waitcnt lgkmcnt(6)
    v_mfma_f32_16x16x32_bf16 v[88:91], v[136:139], v[24:27], v[88:91]
    v_xor_b32 v146, s89, v146
    ds_read_b64_tr_b16 v[120:121], v146 offset:0
    v_mfma_f32_16x16x32_bf16 v[104:107], v[136:139], v[28:31], v[104:107]
    ds_read_b64_tr_b16 v[122:123], v146 offset:2048
    s_waitcnt lgkmcnt(6)
    v_mfma_f32_16x16x32_bf16 v[92:95], v[140:143], v[24:27], v[92:95]
    v_xor_b32 v147, s89, v147
    ds_read_b64_tr_b16 v[124:125], v147 offset:0
    v_mfma_f32_16x16x32_bf16 v[108:111], v[140:143], v[28:31], v[108:111]
    ds_read_b64_tr_b16 v[126:127], v147 offset:2048
    buffer_load_dwordx4 v[56:59], v157, s[16:19], s91 offen offset:1024 sc1
    buffer_load_dwordx4 v[60:63], v158, s[16:19], s91 offen offset:1024 sc1
    s_waitcnt vmcnt(6) lgkmcnt(6)
    v_max3_u32 v156, v156, v35, v39
    v_mfma_f32_16x16x32_bf16 v[80:83], v[112:115], v[32:35], v[80:83]
    ds_read_b64_tr_b16 v[128:129], v144 offset:4096
    v_mfma_f32_16x16x32_bf16 v[96:99], v[112:115], v[36:39], v[96:99]
    ds_read_b64_tr_b16 v[130:131], v144 offset:6144
    s_waitcnt lgkmcnt(6)
    v_mfma_f32_16x16x32_bf16 v[84:87], v[116:119], v[32:35], v[84:87]
    ds_read_b64_tr_b16 v[132:133], v145 offset:4096
    v_mfma_f32_16x16x32_bf16 v[100:103], v[116:119], v[36:39], v[100:103]
    ds_read_b64_tr_b16 v[134:135], v145 offset:6144
    s_waitcnt lgkmcnt(6)
    v_mfma_f32_16x16x32_bf16 v[88:91], v[120:123], v[32:35], v[88:91]
    ds_read_b64_tr_b16 v[136:137], v146 offset:4096
    v_mfma_f32_16x16x32_bf16 v[104:107], v[120:123], v[36:39], v[104:107]
    ds_read_b64_tr_b16 v[138:139], v146 offset:6144
    s_waitcnt lgkmcnt(6)
    v_mfma_f32_16x16x32_bf16 v[92:95], v[124:127], v[32:35], v[92:95]
    ds_read_b64_tr_b16 v[140:141], v147 offset:4096
    v_mfma_f32_16x16x32_bf16 v[108:111], v[124:127], v[36:39], v[108:111]
    ds_read_b64_tr_b16 v[142:143], v147 offset:6144
    s_cmp_eq_u32 s65, 0
    s_cbranch_scc1 L_b_p7
L_b_r7:
    s_ff1_i32_b32 s91, s65
    s_bitset0_b32 s65, s91
    s_lshl_b32 s79, s91, 12
    s_lshl_b32 s91, s91, 10
    buffer_load_dwordx4 v[64:67], v157, s[16:19], s91 offen offset:0 sc1
    buffer_load_dwordx4 v[68:71], v158, s[16:19], s91 offen offset:0 sc1
    s_waitcnt vmcnt(6) lgkmcnt(6)
    v_max3_u32 v156, v156, v43, v47
    v_mfma_f32_16x16x32_bf16 v[80:83], v[128:131], v[40:43], v[80:83]
    s_xor_b32 s89, s67, s78
    s_mov_b32 s67, s78
    v_xor_b32 v144, s89, v144
    ds_read_b64_tr_b16 v[112:113], v144 offset:0
    v_mfma_f32_16x16x32_bf16 v[96:99], v[128:131], v[44:47], v[96:99]
    ds_read_b64_tr_b16 v[114:115], v144 offset:2048
    s_waitcnt lgkmcnt(6)
    v_mfma_f32_16x16x32_bf16 v[84:87], v[132:135], v[40:43], v[84:87]
    v_xor_b32 v145, s89, v145
    ds_read_b64_tr_b16 v[116:117], v145 offset:0
    v_mfma_f32_16x16x32_bf16 v[100:103], v[132:135], v[44:47], v[100:103]
    ds_read_b64_tr_b16 v[118:119], v145 offset:2048
    s_waitcnt lgkmcnt(6)
    v_mfma_f32_16x16x32_bf16 v[88:91], v[136:139], v[40:43], v[88:91]
    v_xor_b32 v146, s89, v146
    ds_read_b64_tr_b16 v[120:121], v146 offset:0
    v_mfma_f32_16x16x32_bf16 v[104:107], v[136:139], v[44:47], v[104:107]
    ds_read_b64_tr_b16 v[122:123], v146 offset:2048
    s_waitcnt lgkmcnt(6)
    v_mfma_f32_16x16x32_bf16 v[92:95], v[140:143], v[40:43], v[92:95]
    v_xor_b32 v147, s89, v147
    ds_read_b64_tr_b16 v[124:125], v147 offset:0
    v_mfma_f32_16x16x32_bf16 v[108:111], v[140:143], v[44:47], v[108:111]
    ds_read_b64_tr_b16 v[126:127], v147 offset:2048
    buffer_load_dwordx4 v[72:75], v157, s[16:19], s91 offen offset:1024 sc1
    buffer_load_dwordx4 v[76:79], v158, s[16:19], s91 offen offset:1024 sc1
    s_waitcnt vmcnt(6) lgkmcnt(6)
    v_max3_u32 v156, v156, v51, v55
    v_mfma_f32_16x16x32_bf16 v[80:83], v[112:115], v[48:51], v[80:83]
    ds_read_b64_tr_b16 v[128:129], v144 offset:4096
    v_mfma_f32_16x16x32_bf16 v[96:99], v[112:115], v[52:55], v[96:99]
    ds_read_b64_tr_b16 v[130:131], v144 offset:6144
    s_mov_b32 s90, 71680
    buffer_load_dwordx4 v[204:207], v11, s[32:35], s90 offen
    s_waitcnt lgkmcnt(6)
    v_mfma_f32_16x16x32_bf16 v[84:87], v[116:119], v[48:51], v[84:87]
    ds_read_b64_tr_b16 v[132:133], v145 offset:4096
    v_mfma_f32_16x16x32_bf16 v[100:103], v[116:119], v[52:55], v[100:103]
    ds_read_b64_tr_b16 v[134:135], v145 offset:6144
    s_waitcnt lgkmcnt(6)
    v_mfma_f32_16x16x32_bf16 v[88:91], v[120:123], v[48:51], v[88:91]
    ds_read_b64_tr_b16 v[136:137], v146 offset:4096
    v_mfma_f32_16x16x32_bf16 v[104:107], v[120:123], v[52:55], v[104:107]
    ds_read_b64_tr_b16 v[138:139], v146 offset:6144
    s_mov_b32 s90, 78848
    buffer_load_dwordx4 v[208:211], v11, s[32:35], s90 offen
    s_waitcnt lgkmcnt(6)
    v_mfma_f32_16x16x32_bf16 v[92:95], v[124:127], v[48:51], v[92:95]
    ds_read_b64_tr_b16 v[140:141], v147 offset:4096
    v_mfma_f32_16x16x32_bf16 v[108:111], v[124:127], v[52:55], v[108:111]
    ds_read_b64_tr_b16 v[142:143], v147 offset:6144
    s_waitcnt vmcnt(6) lgkmcnt(6)
    v_max3_u32 v156, v156, v59, v63
    v_mfma_f32_16x16x32_bf16 v[80:83], v[128:131], v[56:59], v[80:83]
    s_xor_b32 s89, s67, s79
    s_mov_b32 s67, s79
    v_xor_b32 v144, s89, v144
    ds_read_b64_tr_b16 v[112:113], v144 offset:0
    v_mfma_f32_16x16x32_bf16 v[96:99], v[128:131], v[60:63], v[96:99]
    ds_read_b64_tr_b16 v[114:115], v144 offset:2048
    s_mov_b32 s90, 86016
    buffer_load_dwordx4 v[212:215], v11, s[32:35], s90 offen
    s_waitcnt lgkmcnt(6)
    v_mfma_f32_16x16x32_bf16 v[84:87], v[132:135], v[56:59], v[84:87]
    v_xor_b32 v145, s89, v145
    ds_read_b64_tr_b16 v[116:117], v145 offset:0
    v_mfma_f32_16x16x32_bf16 v[100:103], v[132:135], v[60:63], v[100:103]
    ds_read_b64_tr_b16 v[118:119], v145 offset:2048
    s_waitcnt lgkmcnt(6)
    v_mfma_f32_16x16x32_bf16 v[88:91], v[136:139], v[56:59], v[88:91]
    v_xor_b32 v146, s89, v146
    ds_read_b64_tr_b16 v[120:121], v146 offset:0
    v_mfma_f32_16x16x32_bf16 v[104:107], v[136:139], v[60:63], v[104:107]
    ds_read_b64_tr_b16 v[122:123], v146 offset:2048
    s_mov_b32 s90, 93184
    buffer_load_dwordx4 v[216:219], v11, s[32:35], s90 offen
    s_waitcnt lgkmcnt(6)
    v_mfma_f32_16x16x32_bf16 v[92:95], v[140:143], v[56:59], v[92:95]
    v_xor_b32 v147, s89, v147
    ds_read_b64_tr_b16 v[124:125], v147 offset:0
    v_mfma_f32_16x16x32_bf16 v[108:111], v[140:143], v[60:63], v[108:111]
    ds_read_b64_tr_b16 v[126:127], v147 offset:2048
    s_waitcnt vmcnt(6) lgkmcnt(6)
    v_max3_u32 v156, v156, v67, v71
    v_mfma_f32_16x16x32_bf16 v[80:83], v[112:115], v[64:67], v[80:83]
    ds_read_b64_tr_b16 v[128:129], v144 offset:4096
    v_mfma_f32_16x16x32_bf16 v[96:99], v[112:115], v[68:71], v[96:99]
    ds_read_b64_tr_b16 v[130:131], v144 offset:6144
    s_mov_b32 s90, 100352
    buffer_load_dwordx4 v[220:223], v11, s[32:35], s90 offen
    s_waitcnt lgkmcnt(6)
    v_mfma_f32_16x16x32_bf16 v[84:87], v[116:119], v[64:67], v[84:87]
    ds_read_b64_tr_b16 v[132:133], v145 offset:4096
    v_mfma_f32_16x16x32_bf16 v[100:103], v[116:119], v[68:71], v[100:103]
    ds_read_b64_tr_b16 v[134:135], v145 offset:6144
    s_waitcnt lgkmcnt(6)
    v_mfma_f32_16x16x32_bf16 v[88:91], v[120:123], v[64:67], v[88:91]
    ds_read_b64_tr_b16 v[136:137], v146 offset:4096
    v_mfma_f32_16x16x32_bf16 v[104:107], v[120:123], v[68:71], v[104:107]
    ds_read_b64_tr_b16 v[138:139], v146 offset:6144
    s_waitcnt lgkmcnt(6)
    v_mfma_f32_16x16x32_bf16 v[92:95], v[124:127], v[64:67], v[92:95]
    ds_read_b64_tr_b16 v[140:141], v147 offset:4096
    v_mfma_f32_16x16x32_bf16 v[108:111], v[124:127], v[68:71], v[108:111]
    ds_read_b64_tr_b16 v[142:143], v147 offset:6144
    s_waitcnt vmcnt(5) lgkmcnt(6)
    v_max3_u32 v156, v156, v75, v79
    v_cmp_eq_u32 vcc, -1, v156
    s_cbranch_vccz L_ok_3
    s_sub_u32 s56, s56, 1
    s_cbranch_scc0 L_b_restart
    s_mov_b32 s56, 0
L_ok_3:
    v_mfma_f32_16x16x32_bf16 v[80:83], v[128:131], v[72:75], v[80:83]
    v_mfma_f32_16x16x32_bf16 v[96:99], v[128:131], v[76:79], v[96:99]
    s_mov_b32 s90, 107520
    buffer_load_dwordx4 v[224:227], v11, s[32:35], s90 offen
    s_waitcnt lgkmcnt(4)
    v_mfma_f32_16x16x32_bf16 v[84:87], v[132:135], v[72:75], v[84:87]
    v_mfma_f32_16x16x32_bf16 v[100:103], v[132:135], v[76:79], v[100:103]
    s_waitcnt lgkmcnt(2)
    v_mfma_f32_16x16x32_bf16 v[88:91], v[136:139], v[72:75], v[88:91]
    v_mfma_f32_16x16x32_bf16 v[104:107], v[136:139], v[76:79], v[104:107]
    s_waitcnt lgkmcnt(0)
    v_mfma_f32_16x16x32_bf16 v[92:95], v[140:143], v[72:75], v[92:95]
    v_mfma_f32_16x16x32_bf16 v[108:111], v[140:143], v[76:79], v[108:111]
    ds_write_b128 v162, v[96:99] offset:0
    s_nop 0
    ds_write_b128 v162, v[100:103] offset:1024
    s_nop 1
    ds_write_b128 v162, v[104:107] offset:2048
    s_nop 1
    ds_write_b128 v162, v[108:111] offset:3072
    s_waitcnt lgkmcnt(0)
    s_barrier
    ds_read_b128 v[16:19], v163 offset:0
    ds_read_b128 v[20:23], v163 offset:1024
    ds_read_b128 v[24:27], v163 offset:2048
    ds_read_b128 v[28:31], v163 offset:3072
    s_waitcnt lgkmcnt(3)
    v_pk_add_f32 v[80:81], v[80:81], v[16:17]
    v_pk_add_f32 v[82:83], v[82:83], v[18:19]
    v_cvt_pk_bf16_f32 v32, v80, v81
    v_cvt_pk_bf16_f32 v33, v82, v83
    s_waitcnt lgkmcnt(2)
    v_pk_add_f32 v[84:85], v[84:85], v[20:21]
    v_pk_add_f32 v[86:87], v[86:87], v[22:23]
    v_cvt_pk_bf16_f32 v34, v84, v85
    v_cvt_pk_bf16_f32 v35, v86, v87
    s_waitcnt lgkmcnt(1)
    v_pk_add_f32 v[88:89], v[88:89], v[24:25]
    v_pk_add_f32 v[90:91], v[90:91], v[26:27]
    v_cvt_pk_bf16_f32 v36, v88, v89
    v_cvt_pk_bf16_f32 v37, v90, v91
    s_waitcnt lgkmcnt(0)
    v_pk_add_f32 v[92:93], v[92:93], v[28:29]
    v_pk_add_f32 v[94:95], v[94:95], v[30:31]
    v_cvt_pk_bf16_f32 v38, v92, v93
    v_cvt_pk_bf16_f32 v39, v94, v95
    v_mfma_f32_16x16x32_bf16 v[60:63], v[32:35], v[32:35], 0
    v_mfma_f32_16x16x32_bf16 v[56:59], v[32:35], v[148:151], 0
    v_mfma_f32_16x16x32_bf16 v[60:63], v[36:39], v[36:39], v[60:63]
    v_mfma_f32_16x16x32_bf16 v[56:59], v[36:39], v[152:155], v[56:59]
    v_lshlrev_b32 v40, 16, v32
    v_and_b32 v41, 0xffff0000, v32
    v_lshlrev_b32 v42, 16, v33
    v_and_b32 v43, 0xffff0000, v33
    v_lshlrev_b32 v44, 16, v34
    v_and_b32 v45, 0xffff0000, v34
    s_nop 1
    v_cndmask_b32 v56, v56, v60, s[72:73]
    v_cndmask_b32 v57, v57, v61, s[72:73]
    v_cndmask_b32 v58, v58, v62, s[72:73]
    v_cndmask_b32 v59, v59, v63, s[72:73]
    v_cndmask_b32 v56, v56, v57, s[4:5]
    v_cndmask_b32 v58, v58, v59, s[98:99]
    s_or_b64 vcc, s[6:7], s[98:99]
    v_cndmask_b32 v56, v56, v58, vcc
    v_cndmask_b32 v56, v56, 1.0, s[74:75]
    v_mov_b32 v67, v56
    buffer_atomic_add_f32 v67, v160, s[16:19], 0 offen sc0 sc1
    s_mov_b32 s90, 0
    buffer_load_dwordx4 v[228:231], v14, s[36:39], s90 offen
    s_mov_b32 s90, 2048
    buffer_load_dwordx4 v[232:235], v14, s[36:39], s90 offen
    s_mov_b32 s90, 4096
    buffer_load_dwordx4 v[236:239], v14, s[36:39], s90 offen
    v_lshlrev_b32 v46, 16, v35
    v_and_b32 v47, 0xffff0000, v35
    v_lshlrev_b32 v48, 16, v36
    v_and_b32 v49, 0xffff0000, v36
    v_lshlrev_b32 v50, 16, v37
    v_and_b32 v51, 0xffff0000, v37
    v_lshlrev_b32 v52, 16, v38
    v_and_b32 v53, 0xffff0000, v38
    v_lshlrev_b32 v54, 16, v39
    v_and_b32 v55, 0xffff0000, v39
    v_lshrrev_b32 v8, 2, v2
    v_lshlrev_b32 v9, 4, v8
    v_sub_u32 v9, v161, v9
    v_cmp_eq_u32 vcc, 0, v8
    s_nop 1
    v_cndmask_b32 v10, 0, 32, vcc
    v_add_u32 v10, v9, v10
    v_cmp_eq_u32 vcc, 1, v8
    s_nop 1
    v_cndmask_b32 v8, 16, 48, vcc
    v_add_u32 v9, v9, v8
    s_waitcnt vmcnt(3)
    v_add_f32 v67, v67, v56
    s_branch L_h3_chk
L_h3:
    v_mov_b32 v67, 0
    buffer_atomic_or v67, v160, s[16:19], 0 offen sc0 sc1
    s_waitcnt vmcnt(0)
L_h3_chk:
    v_cmp_ne_u32 vcc, 0x41800000, v67
    s_nop 0
    s_and_b64 vcc, vcc, s[74:75]
    s_cbranch_vccz L_ok_4
    s_sub_u32 s56, s56, 1
    s_cbranch_scc0 L_h3
    s_mov_b32 s56, 0
L_ok_4:
    ds_bpermute_b32 v64, v10, v67
    ds_bpermute_b32 v66, v161, v67
    ds_bpermute_b32 v65, v9, v67
    s_waitcnt lgkmcnt(0)
    v_mul_f32 v64, 0x3a800000, v64
    v_mul_f32 v66, 0x3a800000, v66
    v_fma_f32 v66, -v64, v64, v66
    v_max_f32 v66, 0, v66
    v_cvt_pk_bf16_f32 v69, v64, v66
    v_lshlrev_b32 v68, 16, v69
    v_and_b32 v69, 0xffff0000, v69
    v_add_f32 v69, 0x3727c5ac, v69
    v_cvt_pk_bf16_f32 v69, v69, v69
    v_lshlrev_b32 v69, 16, v69
    v_sqrt_f32 v69, v69
    s_nop 0
    v_cvt_pk_bf16_f32 v69, v69, v69
    v_lshlrev_b32 v69, 16, v69
    v_rcp_f32 v70, v69
    v_fma_f32 v12, -v68, s57, v65
    v_mul_f32 v12, v12, v70
    v_mul_f32 v72, -v68, v70
    v_ashrrev_i32 v8, 31, v12
    v_or_b32 v8, 0x80000000, v8
    v_xor_b32 v8, v8, v12
    v_and_b32 v8, 0xfffff800, v8
    v_or_b32 v13, v8, v6
    s_lshl_b32 s86, s3, 6
    s_add_u32 s86, s86, 65536
    v_lshl_add_u32 v8, v2, 2, s86
    ds_write_b32 v8, v13
    v_pk_fma_f32 v[16:17], v[40:41], v[70:71], v[72:73] op_sel_hi:[1,0,0]
    v_pk_fma_f32 v[18:19], v[42:43], v[70:71], v[72:73] op_sel_hi:[1,0,0]
    v_pk_fma_f32 v[20:21], v[44:45], v[70:71], v[72:73] op_sel_hi:[1,0,0]
    v_pk_fma_f32 v[22:23], v[46:47], v[70:71], v[72:73] op_sel_hi:[1,0,0]
    v_pk_fma_f32 v[24:25], v[48:49], v[70:71], v[72:73] op_sel_hi:[1,0,0]
    v_pk_fma_f32 v[26:27], v[50:51], v[70:71], v[72:73] op_sel_hi:[1,0,0]
    v_pk_fma_f32 v[28:29], v[52:53], v[70:71], v[72:73] op_sel_hi:[1,0,0]
    v_pk_fma_f32 v[30:31], v[54:55], v[70:71], v[72:73] op_sel_hi:[1,0,0]
    v_lshlrev_b32 v8, 3, v0
    v_add_u32 v8, 65536, v8
    s_waitcnt lgkmcnt(0)
    s_barrier
    ds_read_b64 v[64:65], v8
    v_cvt_pk_bf16_f32 v96, v16, v17
    v_cvt_pk_bf16_f32 v97, v18, v19
    v_cvt_pk_bf16_f32 v98, v20, v21
    v_cvt_pk_bf16_f32 v99, v22, v23
    v_cvt_pk_bf16_f32 v100, v24, v25
    v_cvt_pk_bf16_f32 v101, v26, v27
    v_cvt_pk_bf16_f32 v102, v28, v29
    v_cvt_pk_bf16_f32 v103, v30, v31
    s_waitcnt lgkmcnt(0)
    v_max_u32 v66, v64, v65
    v_min_u32 v67, v64, v65
    s_nop 0
    v_mov_b32_dpp v64, v66 row_ror:8 row_mask:0xf bank_mask:0xf
    v_max_u32_dpp v65, v67, v67 row_ror:8 row_mask:0xf bank_mask:0xf
    v_med3_u32 v67, v66, v64, v65
    v_max_u32 v66, v66, v64
    s_nop 1
    v_mov_b32_dpp v64, v66 row_ror:4 row_mask:0xf bank_mask:0xf
    v_max_u32_dpp v65, v67, v67 row_ror:4 row_mask:0xf bank_mask:0xf
    v_med3_u32 v67, v66, v64, v65
    v_max_u32 v66, v66, v64
    s_nop 1
    v_mov_b32_dpp v64, v66 row_ror:2 row_mask:0xf bank_mask:0xf
    v_max_u32_dpp v65, v67, v67 row_ror:2 row_mask:0xf bank_mask:0xf
    v_med3_u32 v67, v66, v64, v65
    v_max_u32 v66, v66, v64
    s_nop 1
    v_mov_b32_dpp v64, v66 row_ror:1 row_mask:0xf bank_mask:0xf
    v_max_u32_dpp v65, v67, v67 row_ror:1 row_mask:0xf bank_mask:0xf
    v_med3_u32 v67, v66, v64, v65
    v_max_u32 v66, v66, v64
    s_nop 0
    v_readlane_b32 s58, v66, 0
    v_readlane_b32 s59, v67, 0
    v_readlane_b32 s86, v66, 16
    v_readlane_b32 s87, v67, 16
    s_nop 0
    s_max_u32 s59, s59, s87
    s_min_u32 s87, s58, s86
    s_max_u32 s58, s58, s86
    s_max_u32 s59, s59, s87
    v_readlane_b32 s86, v66, 32
    v_readlane_b32 s87, v67, 32
    s_nop 0
    s_max_u32 s59, s59, s87
    s_min_u32 s87, s58, s86
    s_max_u32 s58, s58, s86
    s_max_u32 s59, s59, s87
    v_readlane_b32 s86, v66, 48
    v_readlane_b32 s87, v67, 48
    s_nop 0
    s_max_u32 s59, s59, s87
    s_min_u32 s87, s58, s86
    s_max_u32 s58, s58, s86
    s_max_u32 s59, s59, s87
    v_cmp_eq_u32 s[4:5], s58, v13
    v_cmp_eq_u32 s[6:7], s59, v13
    s_nop 0
    s_or_b64 s[96:97], s[4:5], s[6:7]
    s_cbranch_scc0 L_nocand
    s_lshl_b32 s86, s51, 12
    s_lshl_b32 s87, s52, 7
    s_add_u32 s86, s86, s87
    s_add_u32 s86, s86, 6782976
    v_lshl_add_u32 v8, v1, 3, s86
    v_add_u32 v9, 2048, v8
    v_cndmask_b32 v8, v8, v9, s[6:7]
    v_mov_b32 v9, 2147483648
    v_cndmask_b32 v8, v9, v8, s[96:97]
    buffer_store_dwordx2 v[96:97], v8, s[16:19], 0 offen offset:0 sc1
    buffer_store_dwordx2 v[98:99], v8, s[16:19], 0 offen offset:32 sc1
    buffer_store_dwordx2 v[100:101], v8, s[16:19], 0 offen offset:64 sc1
    buffer_store_dwordx2 v[102:103], v8, s[16:19], 0 offen offset:96 sc1
L_nocand:
    s_cmp_lg_u32 s3, 0
    s_cbranch_scc1 L_nokey
    s_lshl_b32 s86, s52, 10
    s_lshl_b32 s87, s51, 3
    s_add_u32 s86, s86, s87
    s_add_u32 s86, s86, 6848512
    v_lshl_add_u32 v8, v0, 7, s86
    v_mov_b32 v9, 2147483648
    v_cmp_gt_u32 vcc, 8, v0
    s_nop 1
    v_cndmask_b32 v8, v9, v8, vcc
    v_mov_b32 v10, s58
    v_mov_b32 v11, s59
    buffer_atomic_swap_x2 v[10:11], v8, s[16:19], 0 offen sc1
L_nokey:
    s_bfe_u32 s89, s2, 0x20001
    s_lshl_b32 s89, s89, 2
    s_add_u32 s89, s89, s48
    s_lshl_b32 s86, s89, 3
    s_and_b32 s87, s45, 7
    s_add_u32 s86, s86, s87
    s_lshl_b32 s86, s86, 7
    s_add_u32 s86, s86, 6848512
    v_lshl_add_u32 v129, v0, 2, s86
    v_mov_b32 v8, 2147483648
    v_cmp_gt_u32 vcc, 32, v0
    s_nop 1
    v_cndmask_b32 v129, v8, v129, vcc
    s_cmp_lg_u64 s[96:97], 0
    s_cselect_b32 s63, 1, s62
    s_cmp_eq_u32 s63, 0
    s_cbranch_scc1 L_h4_skip1
    v_mov_b32 v128, 0
    buffer_atomic_or v128, v129, s[16:19], 0 offen sc0 sc1
L_h4_skip1:
    v_lshlrev_b32 v16, 16, v96
    v_and_b32 v17, 0xffff0000, v96
    v_lshlrev_b32 v18, 16, v97
    v_and_b32 v19, 0xffff0000, v97
    v_lshlrev_b32 v20, 16, v98
    v_and_b32 v21, 0xffff0000, v98
    v_lshlrev_b32 v22, 16, v99
    v_and_b32 v23, 0xffff0000, v99
    v_lshlrev_b32 v24, 16, v100
    v_and_b32 v25, 0xffff0000, v100
    v_lshlrev_b32 v26, 16, v101
    v_and_b32 v27, 0xffff0000, v101
    v_lshlrev_b32 v28, 16, v102
    v_and_b32 v29, 0xffff0000, v102
    v_lshlrev_b32 v30, 16, v103
    v_and_b32 v31, 0xffff0000, v103
    v_pk_add_f32 v[16:17], v[16:17], v[40:41]
    v_pk_add_f32 v[18:19], v[18:19], v[42:43]
    v_pk_add_f32 v[20:21], v[20:21], v[44:45]
    v_pk_add_f32 v[22:23], v[22:23], v[46:47]
    v_pk_add_f32 v[24:25], v[24:25], v[48:49]
    v_pk_add_f32 v[26:27], v[26:27], v[50:51]
    v_pk_add_f32 v[28:29], v[28:29], v[52:53]
    v_pk_add_f32 v[30:31], v[30:31], v[54:55]
    v_cvt_pk_bf16_f32 v104, v16, v17
    v_cvt_pk_bf16_f32 v105, v18, v19
    v_cvt_pk_bf16_f32 v106, v20, v21
    v_cvt_pk_bf16_f32 v107, v22, v23
    v_cvt_pk_bf16_f32 v108, v24, v25
    v_cvt_pk_bf16_f32 v109, v26, v27
    v_cvt_pk_bf16_f32 v110, v28, v29
    v_cvt_pk_bf16_f32 v111, v30, v31
    v_permlane16_swap_b32 v104, v106
    v_permlane16_swap_b32 v105, v107
    v_permlane16_swap_b32 v108, v110
    v_permlane16_swap_b32 v109, v111
    v_mov_b32 v9, 2147483648
    v_cndmask_b32 v8, v5, v9, s[96:97]
    buffer_store_dwordx4 v[104:107], v8, s[24:27], 0 offen sc1
    buffer_store_dwordx4 v[108:111], v8, s[24:27], 0 offen offset:64 sc1
    s_cmp_eq_u32 s63, 0
    s_cbranch_scc1 L_fin
    s_cmp_eq_u64 s[96:97], 0
    s_cbranch_scc1 L_nostash
    v_lshlrev_b32 v8, 3, v1
    v_add_u32 v8, 98304, v8
    v_add_u32 v9, 512, v8
    v_cndmask_b32 v8, v8, v9, s[6:7]
    v_cvt_pk_bf16_f32 v9, v12, v12
    v_lshlrev_b32 v9, 16, v9
    s_mov_b64 exec, s[96:97]
    ds_write_b64 v8, v[32:33] offset:0
    ds_write_b64 v8, v[96:97] offset:128
    ds_write_b64 v8, v[34:35] offset:32
    ds_write_b64 v8, v[98:99] offset:160
    ds_write_b64 v8, v[36:37] offset:64
    ds_write_b64 v8, v[100:101] offset:192
    ds_write_b64 v8, v[38:39] offset:96
    ds_write_b64 v8, v[102:103] offset:224
    ds_write_b32 v8, v9 offset:256
    s_mov_b64 exec, -1
L_nostash:
    s_waitcnt vmcnt(2)
    s_branch L_h4_chk
L_h4:
    v_mov_b32 v128, 0
    buffer_atomic_or v128, v129, s[16:19], 0 offen sc0 sc1
    s_waitcnt vmcnt(0)
L_h4_chk:
    v_cmp_eq_u32 vcc, -1, v128
    s_cbranch_vccz L_ok_5
    s_sub_u32 s56, s56, 1
    s_cbranch_scc0 L_h4
    s_mov_b32 s56, 0
L_ok_5:
    v_mov_b32 v64, v128
    v_mov_b32 v65, 0
    s_nop 0
    v_mov_b32_dpp v66, v64 row_ror:8 row_mask:0xf bank_mask:0xf
    v_max_u32_dpp v67, v65, v65 row_ror:8 row_mask:0xf bank_mask:0xf
    v_med3_u32 v65, v64, v66, v67
    v_max_u32 v64, v64, v66
    s_nop 1
    v_mov_b32_dpp v66, v64 row_ror:4 row_mask:0xf bank_mask:0xf
    v_max_u32_dpp v67, v65, v65 row_ror:4 row_mask:0xf bank_mask:0xf
    v_med3_u32 v65, v64, v66, v67
    v_max_u32 v64, v64, v66
    s_nop 1
    v_mov_b32_dpp v66, v64 row_ror:2 row_mask:0xf bank_mask:0xf
    v_max_u32_dpp v67, v65, v65 row_ror:2 row_mask:0xf bank_mask:0xf
    v_med3_u32 v65, v64, v66, v67
    v_max_u32 v64, v64, v66
    s_nop 1
    v_mov_b32_dpp v66, v64 row_ror:1 row_mask:0xf bank_mask:0xf
    v_max_u32_dpp v67, v65, v65 row_ror:1 row_mask:0xf bank_mask:0xf
    v_med3_u32 v65, v64, v66, v67
    v_max_u32 v64, v64, v66
    s_nop 0
    v_readlane_b32 s60, v64, 0
    v_readlane_b32 s61, v65, 0
    v_readlane_b32 s86, v64, 16
    v_readlane_b32 s87, v65, 16
    s_nop 0
    s_max_u32 s61, s61, s87
    s_min_u32 s87, s60, s86
    s_max_u32 s60, s60, s86
    s_max_u32 s61, s61, s87
    s_cmp_lg_u32 s62, 0
    s_cbranch_scc1 L_moe
    s_barrier
    s_barrier
    s_branch L_final
L_moe:
    v_cmp_eq_u32 vcc, s60, v128
    s_nop 0
    s_ff1_i32_b32 s86, vcc_lo
    v_cmp_eq_u32 vcc, s61, v128
    s_nop 0
    s_ff1_i32_b32 s87, vcc_lo
    s_and_b32 s86, s86, 31
    s_and_b32 s87, s87, 31
    v_bfe_u32 v8, v0, 3, 1
    v_cmp_eq_u32 vcc, 1, v8
    v_mov_b32 v9, s86
    v_mov_b32 v10, s87
    v_cndmask_b32 v9, v9, v10, vcc
    s_lshl_b32 s89, s89, 7
    s_add_u32 s89, s89, 6782976
    v_lshl_add_u32 v10, v1, 5, s89
    v_lshl_add_u32 v130, v9, 11, v10
    buffer_load_dwordx4 v[64:67], v130, s[16:19], 0 offen sc1
    buffer_load_dwordx4 v[68:71], v130, s[16:19], 0 offen offset:16 sc1
    s_mov_b32 s90, 6144
    buffer_load_dwordx4 v[240:243], v14, s[36:39], s90 offen
    s_mov_b32 s90, 8192
    buffer_load_dwordx4 v[244:247], v14, s[36:39], s90 offen
    s_mov_b32 s90, 10240
    buffer_load_dwordx4 v[248:251], v14, s[36:39], s90 offen
    s_mov_b32 s90, 12288
    buffer_load_dwordx4 v[252:255], v14, s[36:39], s90 offen
    v_and_b32 v10, 1, v0
    v_cmp_eq_u32 vcc, 1, v10
    v_mov_b32 v10, 0x0c0c0100
    v_mov_b32 v11, 0x01000c0c
    v_cndmask_b32 v16, v10, v11, vcc
    v_mov_b32 v10, 0x0c0c0302
    v_mov_b32 v11, 0x03020c0c
    v_cndmask_b32 v17, v10, v11, vcc
    v_bfe_u32 v10, v0, 1, 2
    v_mov_b32 v11, 0x0c0c0c0c
    v_cmp_eq_u32 vcc, 0, v10
    s_nop 1
    v_cndmask_b32 v72, v11, v16, vcc
    v_cndmask_b32 v76, v11, v17, vcc
    v_cmp_eq_u32 vcc, 1, v10
    s_nop 1
    v_cndmask_b32 v73, v11, v16, vcc
    v_cndmask_b32 v77, v11, v17, vcc
    v_cmp_eq_u32 vcc, 2, v10
    s_nop 1
    v_cndmask_b32 v74, v11, v16, vcc
    v_cndmask_b32 v78, v11, v17, vcc
    v_cmp_eq_u32 vcc, 3, v10
    s_nop 1
    v_cndmask_b32 v75, v11, v16, vcc
    v_cndmask_b32 v79, v11, v17, vcc
    s_lshl_b32 s86, s48, 10
    s_add_u32 s86, s86, 90112
    v_lshl_add_u32 v18, v0, 4, s86
    s_and_b32 s86, s2, 1
    s_lshl_b32 s86, s86, 2
    s_bfe_u32 s87, s2, 0x20001
    s_add_u32 s88, s86, s87
    s_mul_i32 s86, s88, 28672
    s_add_u32 s86, s86, 6553600
    v_mov_b32 v16, s80
    v_mov_b32 v17, s81
    s_mov_b32 vcc_lo, 4278255360
    s_mov_b32 vcc_hi, vcc_lo
    v_cndmask_b32 v16, v16, v17, vcc
    v_cmp_gt_u32 vcc, 56, v16
    v_lshl_add_u32 v19, v16, 8, s86
    v_and_b32 v16, 7, v0
    v_lshl_add_u32 v19, v16, 5, v19
    v_and_b32 v10, 1, v1
    v_lshl_add_u32 v19, v10, 4, v19
    v_lshrrev_b32 v11, 1, v1
    v_mul_u32_u24 v16, 14336, v11
    v_add_u32 v19, v19, v16
    v_mov_b32 v133, 2147483648
    v_cndmask_b32 v19, v133, v19, vcc
    v_mov_b32 v131, s68
    s_lshl2_add_u32 s86, s88, 704512
    v_mov_b32 v16, s80
    v_mov_b32 v17, s81
    s_mov_b32 vcc_lo, 4042322160
    s_mov_b32 vcc_hi, vcc_lo
    v_cndmask_b32 v16, v16, v17, vcc
    v_cmp_gt_u32 vcc, 56, v16
    v_lshl_add_u32 v132, v16, 9, s86
    v_and_b32 v16, 3, v0
    v_lshl_add_u32 v132, v16, 7, v132
    s_and_b64 vcc, vcc, 0xff
    v_cndmask_b32 v132, v133, v132, vcc
    s_lshl_b32 s86, s44, 5
    s_add_u32 s86, s86, s45
    s_lshl2_add_u32 s86, s86, 737280
    v_writelane_b32 v133, s86, 0
    s_mul_i32 s86, s45, 112
    s_mul_i32 s87, s48, 28
    s_add_u32 s86, s86, s87
    v_mul_u32_u24 v16, 27, v8
    v_add_u32 v16, s86, v16
    v_lshrrev_b32 v16, 6, v16
    s_lshl_b32 s87, s48, 7
    s_add_u32 s87, s87, 704512
    v_lshl_add_u32 v134, v16, 9, s87
    v_and_b32 v16, 7, v0
    v_lshl_add_u32 v134, v16, 2, v134
    v_mov_b32 v16, 2147483648
    v_cmp_gt_u32 vcc, 16, v0
    s_nop 1
    v_cndmask_b32 v134, v16, v134, vcc
    s_waitcnt vmcnt(4)
    s_branch L_seg_chk
L_seg:
    buffer_load_dwordx4 v[64:67], v130, s[16:19], 0 offen sc1
    buffer_load_dwordx4 v[68:71], v130, s[16:19], 0 offen offset:16 sc1
    s_waitcnt vmcnt(0)
L_seg_chk:
    v_max3_u32 v16, v65, v67, v69
    v_max_u32 v16, v16, v71
    v_cmp_eq_u32 vcc, -1, v16
    s_cbranch_vccz L_ok_6
    s_sub_u32 s56, s56, 1
    s_cbranch_scc0 L_seg
    s_mov_b32 s56, 0
L_ok_6:
    v_perm_b32 v80, v64, v64, v72
    v_perm_b32 v81, v64, v64, v73
    v_perm_b32 v82, v64, v64, v74
    v_perm_b32 v83, v64, v64, v75
    s_nop 1
    v_mfma_f32_16x16x32_bf16 v[88:91], v[80:83], v[164:167], 0
    v_perm_b32 v84, v64, v64, v76
    v_perm_b32 v85, v64, v64, v77
    v_perm_b32 v86, v64, v64, v78
    v_perm_b32 v87, v64, v64, v79
    s_nop 1
    v_mfma_f32_16x16x32_bf16 v[88:91], v[84:87], v[168:171], v[88:91]
    v_perm_b32 v80, v65, v65, v72
    v_perm_b32 v81, v65, v65, v73
    v_perm_b32 v82, v65, v65, v74
    v_perm_b32 v83, v65, v65, v75
    s_nop 1
    v_mfma_f32_16x16x32_bf16 v[88:91], v[80:83], v[172:175], v[88:91]
    v_perm_b32 v84, v65, v65, v76
    v_perm_b32 v85, v65, v65, v77
    v_perm_b32 v86, v65, v65, v78
    v_perm_b32 v87, v65, v65, v79
    s_nop 1
    v_mfma_f32_16x16x32_bf16 v[88:91], v[84:87], v[176:179], v[88:91]
    v_perm_b32 v80, v66, v66, v72
    v_perm_b32 v81, v66, v66, v73
    v_perm_b32 v82, v66, v66, v74
    v_perm_b32 v83, v66, v66, v75
    s_nop 1
    v_mfma_f32_16x16x32_bf16 v[88:91], v[80:83], v[180:183], v[88:91]
    v_perm_b32 v84, v66, v66, v76
    v_perm_b32 v85, v66, v66, v77
    v_perm_b32 v86, v66, v66, v78
    v_perm_b32 v87, v66, v66, v79
    s_nop 1
    v_mfma_f32_16x16x32_bf16 v[88:91], v[84:87], v[184:187], v[88:91]
    v_perm_b32 v80, v67, v67, v72
    v_perm_b32 v81, v67, v67, v73
    v_perm_b32 v82, v67, v67, v74
    v_perm_b32 v83, v67, v67, v75
    s_nop 1
    v_mfma_f32_16x16x32_bf16 v[88:91], v[80:83], v[188:191], v[88:91]
    v_perm_b32 v84, v67, v67, v76
    v_perm_b32 v85, v67, v67, v77
    v_perm_b32 v86, v67, v67, v78
    v_perm_b32 v87, v67, v67, v79
    s_nop 1
    v_mfma_f32_16x16x32_bf16 v[88:91], v[84:87], v[192:195], v[88:91]
    v_perm_b32 v80, v68, v68, v72
    v_perm_b32 v81, v68, v68, v73
    v_perm_b32 v82, v68, v68, v74
    v_perm_b32 v83, v68, v68, v75
    s_nop 1
    v_mfma_f32_16x16x32_bf16 v[88:91], v[80:83], v[196:199], v[88:91]
    v_perm_b32 v84, v68, v68, v76
    v_perm_b32 v85, v68, v68, v77
    v_perm_b32 v86, v68, v68, v78
    v_perm_b32 v87, v68, v68, v79
    s_nop 1
    v_mfma_f32_16x16x32_bf16 v[88:91], v[84:87], v[200:203], v[88:91]
    v_perm_b32 v80, v69, v69, v72
    v_perm_b32 v81, v69, v69, v73
    v_perm_b32 v82, v69, v69, v74
    v_perm_b32 v83, v69, v69, v75
    s_nop 1
    v_mfma_f32_16x16x32_bf16 v[88:91], v[80:83], v[204:207], v[88:91]
    v_perm_b32 v84, v69, v69, v76
    v_perm_b32 v85, v69, v69, v77
    v_perm_b32 v86, v69, v69, v78
    v_perm_b32 v87, v69, v69, v79
    s_nop 1
    v_mfma_f32_16x16x32_bf16 v[88:91], v[84:87], v[208:211], v[88:91]
    v_perm_b32 v80, v70, v70, v72
    v_perm_b32 v81, v70, v70, v73
    v_perm_b32 v82, v70, v70, v74
    v_perm_b32 v83, v70, v70, v75
    s_nop 1
    v_mfma_f32_16x16x32_bf16 v[88:91], v[80:83], v[212:215], v[88:91]
    v_perm_b32 v84, v70, v70, v76
    v_perm_b32 v85, v70, v70, v77
    v_perm_b32 v86, v70, v70, v78
    v_perm_b32 v87, v70, v70, v79
    s_nop 1
    v_mfma_f32_16x16x32_bf16 v[88:91], v[84:87], v[216:219], v[88:91]
    v_perm_b32 v80, v71, v71, v72
    v_perm_b32 v81, v71, v71, v73
    v_perm_b32 v82, v71, v71, v74
    v_perm_b32 v83, v71, v71, v75
    s_nop 1
    v_mfma_f32_16x16x32_bf16 v[88:91], v[80:83], v[220:223], v[88:91]
    v_perm_b32 v84, v71, v71, v76
    v_perm_b32 v85, v71, v71, v77
    v_perm_b32 v86, v71, v71, v78
    v_perm_b32 v87, v71, v71, v79
    s_nop 1
    v_mfma_f32_16x16x32_bf16 v[88:91], v[84:87], v[224:227], v[88:91]
    s_nop 7
    ds_write_b128 v18, v[88:91] offset:0
    s_waitcnt lgkmcnt(0)
    s_barrier
    s_cmp_lg_u32 s48, 0
    s_cbranch_scc1 L_gu_done
    ds_read_b128 v[20:23], v18 offset:1024
    ds_read_b128 v[24:27], v18 offset:2048
    ds_read_b128 v[28:31], v18 offset:3072
    s_waitcnt lgkmcnt(0)
    v_pk_add_f32 v[88:89], v[88:89], v[20:21]
    v_pk_add_f32 v[24:25], v[24:25], v[28:29]
    v_pk_add_f32 v[88:89], v[88:89], v[24:25]
    v_pk_add_f32 v[90:91], v[90:91], v[22:23]
    v_pk_add_f32 v[26:27], v[26:27], v[30:31]
    v_pk_add_f32 v[90:91], v[90:91], v[26:27]
    buffer_store_dwordx4 v[88:91], v19, s[16:19], 0 offen sc1
    buffer_atomic_swap v131, v132, s[16:19], 0 offen sc1
L_gu_done:
    v_mov_b32 v135, 0
    buffer_atomic_or v135, v134, s[16:19], 0 offen sc0 sc1
    s_mul_i32 s86, s45, 112
    s_mul_i32 s87, s48, 28
    s_add_u32 s86, s86, s87
    v_bfe_u32 v16, v0, 3, 2
    v_mul_u32_u24 v16, 7, v16
    v_and_b32 v17, 7, v0
    v_min_u32 v17, 6, v17
    v_add3_u32 v16, v16, v17, s86
    v_lshrrev_b32 v17, 5, v0
    v_mul_u32_u24 v17, 14336, v17
    v_lshl_add_u32 v16, v16, 2, v17
    v_add_u32 v16, 6553600, v16
    s_lshr_b32 s86, s48, 1
    s_and_b32 s87, s48, 1
    s_lshl_b32 s88, s86, 9
    s_lshl_b32 s89, s87, 7
    s_add_u32 s88, s88, s89
    s_add_u32 s88, s88, 94208
    v_lshrrev_b32 v17, 3, v0
    v_lshl_add_u32 v20, v17, 4, s88
    v_bfe_u32 v9, v0, 2, 1
    v_lshl_add_u32 v20, v9, 8, v20
    v_and_b32 v9, 3, v0
    v_lshl_add_u32 v20, v9, 2, v20
    s_lshl3_add_u32 s86, s86, s44
    s_lshl1_add_u32 s86, s86, s87
    s_lshl_b32 s86, s86, 11
    s_add_u32 s86, s86, 917504
    v_lshl_add_u32 v9, v17, 8, s86
    v_and_b32 v17, 7, v0
    v_lshl_add_u32 v9, v17, 3, v9
    s_mov_b32 s76, 0
    s_mov_b32 s77, 0x41900000
    s_lshl_b32 s86, s48, 7
    s_add_u32 s86, s86, 100352
    v_lshl_add_u32 v10, v0, 1, s86
    v_lshl_add_u32 v11, v8, 6, s86
    v_lshl_add_u32 v11, v1, 4, v11
    s_branch L_h5f_chk
L_h5f:
    v_mov_b32 v135, 0
    buffer_atomic_or v135, v134, s[16:19], 0 offen sc0 sc1
L_h5f_chk:
    s_waitcnt vmcnt(0)
    v_cmp_ne_u32 vcc, s68, v135
    s_nop 0
    s_and_b64 vcc, vcc, 0xffff
    s_cbranch_vccz L_ok_7
    s_sub_u32 s56, s56, 1
    s_cbranch_scc0 L_h5f
    s_mov_b32 s56, 0
L_ok_7:
L_h5:
    s_mov_b32 s90, 0
    buffer_load_dword v24, v16, s[16:19], s90 offen sc1
    s_mov_b32 s90, 28672
    buffer_load_dword v25, v16, s[16:19], s90 offen sc1
    s_mov_b32 s90, 57344
    buffer_load_dword v26, v16, s[16:19], s90 offen sc1
    s_mov_b32 s90, 86016
    buffer_load_dword v27, v16, s[16:19], s90 offen sc1
    s_mov_b32 s90, 114688
    buffer_load_dword v28, v16, s[16:19], s90 offen sc1
    s_mov_b32 s90, 143360
    buffer_load_dword v29, v16, s[16:19], s90 offen sc1
    s_mov_b32 s90, 172032
    buffer_load_dword v30, v16, s[16:19], s90 offen sc1
    s_mov_b32 s90, 200704
    buffer_load_dword v31, v16, s[16:19], s90 offen sc1
    s_waitcnt vmcnt(0)
    v_max3_u32 v17, v24, v25, v26
    v_max3_u32 v17, v17, v27, v28
    v_max3_u32 v17, v17, v29, v30
    v_max_u32 v17, v17, v31
    v_cmp_eq_u32 vcc, -1, v17
    s_cbranch_vccz L_ok_8
    s_sub_u32 s56, s56, 1
    s_cbranch_scc0 L_h5
    s_mov_b32 s56, 0
L_ok_8:
    v_mov_b32 v19, v9
    v_add_f32 v24, v24, v25
    v_add_f32 v26, v26, v27
    v_add_f32 v28, v28, v29
    v_add_f32 v30, v30, v31
    v_add_f32 v24, v24, v26
    v_add_f32 v28, v28, v30
    v_cvt_pk_bf16_f32 v25, v24, v28
    v_lshlrev_b32 v24, 16, v25
    v_and_b32 v28, 0xffff0000, v25
    v_mul_f32 v25, 0xbfb8aa3b, v24
    v_exp_f32 v25, v25
    s_nop 0
    v_add_f32 v25, 1.0, v25
    v_rcp_f32 v25, v25
    s_nop 0
    v_mul_f32 v24, v24, v25
    v_cvt_pk_bf16_f32 v24, v24, v24
    v_lshlrev_b32 v24, 16, v24
    v_mul_f32 v24, v24, v28
    v_cvt_pk_bf16_f32 v24, v24, v24
    ds_write_b16 v10, v24
    s_waitcnt lgkmcnt(0)
    ds_read_b128 v[64:67], v11
    s_waitcnt lgkmcnt(0)
    v_perm_b32 v80, v64, v64, v72
    v_perm_b32 v81, v64, v64, v73
    v_perm_b32 v82, v64, v64, v74
    v_perm_b32 v83, v64, v64, v75
    s_nop 1
    v_mfma_f32_16x16x32_bf16 v[88:91], v[80:83], v[228:231], 0
    v_perm_b32 v84, v64, v64, v76
    v_perm_b32 v85, v64, v64, v77
    v_perm_b32 v86, v64, v64, v78
    v_perm_b32 v87, v64, v64, v79
    s_nop 1
    v_mfma_f32_16x16x32_bf16 v[88:91], v[84:87], v[232:235], v[88:91]
    v_perm_b32 v80, v65, v65, v72
    v_perm_b32 v81, v65, v65, v73
    v_perm_b32 v82, v65, v65, v74
    v_perm_b32 v83, v65, v65, v75
    s_nop 1
    v_mfma_f32_16x16x32_bf16 v[88:91], v[80:83], v[236:239], v[88:91]
    v_perm_b32 v84, v65, v65, v76
    v_perm_b32 v85, v65, v65, v77
    v_perm_b32 v86, v65, v65, v78
    v_perm_b32 v87, v65, v65, v79
    s_nop 1
    v_mfma_f32_16x16x32_bf16 v[88:91], v[84:87], v[240:243], v[88:91]
    v_perm_b32 v80, v66, v66, v72
    v_perm_b32 v81, v66, v66, v73
    v_perm_b32 v82, v66, v66, v74
    v_perm_b32 v83, v66, v66, v75
    s_nop 1
    v_mfma_f32_16x16x32_bf16 v[88:91], v[80:83], v[244:247], v[88:91]
    v_perm_b32 v84, v66, v66, v76
    v_perm_b32 v85, v66, v66, v77
    v_perm_b32 v86, v66, v66, v78
    v_perm_b32 v87, v66, v66, v79
    s_nop 1
    v_mfma_f32_16x16x32_bf16 v[88:91], v[84:87], v[248:251], v[88:91]
    v_perm_b32 v80, v67, v67, v72
    v_perm_b32 v81, v67, v67, v73
    v_perm_b32 v82, v67, v67, v74
    v_perm_b32 v83, v67, v67, v75
    s_nop 1
    v_mfma_f32_16x16x32_bf16 v[88:91], v[80:83], v[252:255], v[88:91]
    s_nop 7
    ds_write_b128 v18, v[88:91] offset:4096
    s_waitcnt lgkmcnt(0)
    s_barrier
    ds_read2st64_b32 v[24:25], v20 offset0:0 offset1:4
    ds_read2st64_b32 v[26:27], v20 offset0:8 offset1:12
    s_waitcnt lgkmcnt(0)
    v_pk_add_f32 v[24:25], v[24:25], v[26:27]
    v_add_f32 v24, v24, v25
    v_cvt_f64_f32 v[24:25], v24
    v_add_f64 v[24:25], v[24:25], s[76:77]
    buffer_atomic_add_f64 v[24:25], v19, s[16:19], 0 offen sc1
L_final:
    s_cmp_eq_u64 s[96:97], 0
    s_cbranch_scc1 L_fin
    v_cmp_ne_u32 s[4:5], s60, v13
    v_cmp_ne_u32 s[6:7], s61, v13
    s_nop 0
    s_and_b64 s[4:5], s[4:5], s[6:7]
    s_and_b64 s[4:5], s[4:5], s[96:97]
    s_cbranch_scc0 L_nolost
    v_mov_b32 v9, 2147483648
    v_cndmask_b32 v8, v9, v5, s[4:5]
    buffer_store_dwordx4 v[104:107], v8, s[24:27], 0 offen sc1
    buffer_store_dwordx4 v[108:111], v8, s[24:27], 0 offen offset:64 sc1
L_nolost:
    s_mov_b32 s63, 0
L_fin_loop:
    v_cmp_eq_u32 vcc, s60, v13
    s_cbranch_vccz L_fin_next
    s_cmp_eq_u32 s60, s58
    s_cselect_b32 s86, 0, 512
    s_add_u32 s86, s86, 98304
    v_lshl_add_u32 v8, v0, 1, s86
    v_mov_b32 v9, s86
    ds_read_u16_d16_hi v56, v8
    ds_read_u16_d16_hi v57, v8 offset:128
    ds_read_b32 v60, v9 offset:256
    s_lshl4_add_u32 s86, s63, s52
    s_lshl_b32 s86, s86, 11
    s_add_u32 s86, s86, 917504
    v_lshrrev_b32 v9, 3, v0
    v_lshl_add_u32 v10, v9, 8, s86
    v_and_b32 v9, 7, v0
    v_lshl_add_u32 v10, v9, 3, v10
    v_mov_b32 v62, 0
    v_mov_b32 v63, 0
    buffer_atomic_or_x2 v[62:63], v10, s[16:19], 0 offen sc0 sc1
    s_and_b32 s86, s60, 0x7ff
    s_sub_u32 s86, 2047, s86
    s_lshl_b32 s86, s86, 11
    s_lshl_b32 s87, s52, 7
    s_add_u32 s86, s86, s87
    v_lshl_add_u32 v11, v0, 1, s86
    s_mov_b32 s76, 0
    s_mov_b32 s77, 0xc1e00000
    s_mov_b32 s88, 0x4c000000
    s_waitcnt lgkmcnt(0)
    v_mul_f32 v60, 0xbfb8aa3b, v60
    v_exp_f32 v60, v60
    v_and_b32 v56, 0xffff0000, v56
    v_and_b32 v57, 0xffff0000, v57
    v_add_f32 v60, 1.0, v60
    v_rcp_f32 v60, v60
    s_nop 0
    v_cvt_pk_bf16_f32 v60, v60, v60
    v_lshlrev_b32 v60, 16, v60
    s_branch L_h6_chk
L_h6:
    v_mov_b32 v62, 0
    v_mov_b32 v63, 0
    buffer_atomic_or_x2 v[62:63], v10, s[16:19], 0 offen sc0 sc1
L_h6_chk:
    s_waitcnt vmcnt(0)
    v_add_f64 v[62:63], v[62:63], s[76:77]
    v_cvt_f32_f64 v62, v[62:63]
    v_cmp_nlt_f32 vcc, |v62|, s88
    s_cbranch_vccz L_ok_9
    s_sub_u32 s56, s56, 1
    s_cbranch_scc0 L_h6
    s_mov_b32 s56, 0
L_ok_9:
    v_cvt_pk_bf16_f32 v62, v62, v62
    v_lshlrev_b32 v62, 16, v62
    v_mul_f32 v62, v62, v60
    v_cvt_pk_bf16_f32 v62, v62, v62
    v_lshlrev_b32 v62, 16, v62
    v_add_f32 v62, v62, v57
    v_cvt_pk_bf16_f32 v62, v62, v62
    v_lshlrev_b32 v62, 16, v62
    v_add_f32 v62, v62, v56
    v_cvt_pk_bf16_f32 v62, v62, v62
    buffer_store_short v62, v11, s[24:27], 0 offen
L_fin_next:
    s_mov_b32 s60, s61
    s_add_u32 s63, s63, 1
    s_cmp_lt_u32 s63, 2
    s_cbranch_scc1 L_fin_loop
L_fin:
L_end:
    s_endpgm
L_b_restart:
    s_waitcnt vmcnt(0)
    v_xor_b32 v9, 0x8000, v7
    buffer_load_dwordx4 v[136:139], v7, s[8:11], 0 offen
    buffer_load_dwordx4 v[140:143], v9, s[8:11], 0 offen
    v_mov_b32 v8, s68
    s_mov_b32 s66, 0xffffaaaa
    s_mov_b32 s63, 1
    s_branch L_b_init
L_b_p0:
    v_mov_b32 v8, 0
    buffer_atomic_or v8, v159, s[16:19], 0 offen sc0 sc1
L_b_w0:
    s_waitcnt vmcnt(0)
    v_cmp_eq_u32 vcc, s68, v8
    s_nop 0
    s_lshr_b32 s65, vcc_lo, 1
    s_and_b32 s65, s65, vcc_lo
    s_andn2_b32 s65, s65, s66
    s_cbranch_scc0 L_b_q0
    s_or_b32 s66, s66, s65
    s_branch L_b_r0
L_b_q0:
    s_sub_u32 s56, s56, 1
    s_cbranch_scc0 L_b_p0
    s_mov_b32 s56, 0
    s_not_b32 s65, s66
    s_branch L_b_r0
L_b_p1:
    v_mov_b32 v8, 0
    buffer_atomic_or v8, v159, s[16:19], 0 offen sc0 sc1
    s_waitcnt vmcnt(0)
    v_cmp_eq_u32 vcc, s68, v8
    s_nop 0
    s_lshr_b32 s65, vcc_lo, 1
    s_and_b32 s65, s65, vcc_lo
    s_andn2_b32 s65, s65, s66
    s_cbranch_scc0 L_b_q1
    s_or_b32 s66, s66, s65
    s_branch L_b_r1
L_b_q1:
    s_sub_u32 s56, s56, 1
    s_cbranch_scc0 L_b_p1
    s_mov_b32 s56, 0
    s_not_b32 s65, s66
    s_branch L_b_r1
L_b_p2:
    v_mov_b32 v8, 0
    buffer_atomic_or v8, v159, s[16:19], 0 offen sc0 sc1
    s_waitcnt vmcnt(0)
    v_cmp_eq_u32 vcc, s68, v8
    s_nop 0
    s_lshr_b32 s65, vcc_lo, 1
    s_and_b32 s65, s65, vcc_lo
    s_andn2_b32 s65, s65, s66
    s_cbranch_scc0 L_b_q2
    s_or_b32 s66, s66, s65
    s_branch L_b_r2
L_b_q2:
    s_sub_u32 s56, s56, 1
    s_cbranch_scc0 L_b_p2
    s_mov_b32 s56, 0
    s_not_b32 s65, s66
    s_branch L_b_r2
L_b_p3:
    v_mov_b32 v8, 0
    buffer_atomic_or v8, v159, s[16:19], 0 offen sc0 sc1
    s_waitcnt vmcnt(0)
    v_cmp_eq_u32 vcc, s68, v8
    s_nop 0
    s_lshr_b32 s65, vcc_lo, 1
    s_and_b32 s65, s65, vcc_lo
    s_andn2_b32 s65, s65, s66
    s_cbranch_scc0 L_b_q3
    s_or_b32 s66, s66, s65
    s_branch L_b_r3
L_b_q3:
    s_sub_u32 s56, s56, 1
    s_cbranch_scc0 L_b_p3
    s_mov_b32 s56, 0
    s_not_b32 s65, s66
    s_branch L_b_r3
L_b_p4:
    v_mov_b32 v8, 0
    buffer_atomic_or v8, v159, s[16:19], 0 offen sc0 sc1
    s_waitcnt vmcnt(0)
    v_cmp_eq_u32 vcc, s68, v8
    s_nop 0
    s_lshr_b32 s65, vcc_lo, 1
    s_and_b32 s65, s65, vcc_lo
    s_andn2_b32 s65, s65, s66
    s_cbranch_scc0 L_b_q4
    s_or_b32 s66, s66, s65
    s_branch L_b_r4
L_b_q4:
    s_sub_u32 s56, s56, 1
    s_cbranch_scc0 L_b_p4
    s_mov_b32 s56, 0
    s_not_b32 s65, s66
    s_branch L_b_r4
L_b_p5:
    v_mov_b32 v8, 0
    buffer_atomic_or v8, v159, s[16:19], 0 offen sc0 sc1
    s_waitcnt vmcnt(0)
    v_cmp_eq_u32 vcc, s68, v8
    s_nop 0
    s_lshr_b32 s65, vcc_lo, 1
    s_and_b32 s65, s65, vcc_lo
    s_andn2_b32 s65, s65, s66
    s_cbranch_scc0 L_b_q5
    s_or_b32 s66, s66, s65
    s_branch L_b_r5
L_b_q5:
    s_sub_u32 s56, s56, 1
    s_cbranch_scc0 L_b_p5
    s_mov_b32 s56, 0
    s_not_b32 s65, s66
    s_branch L_b_r5
L_b_p6:
    v_mov_b32 v8, 0
    buffer_atomic_or v8, v159, s[16:19], 0 offen sc0 sc1
    s_waitcnt vmcnt(0)
    v_cmp_eq_u32 vcc, s68, v8
    s_nop 0
    s_lshr_b32 s65, vcc_lo, 1
    s_and_b32 s65, s65, vcc_lo
    s_andn2_b32 s65, s65, s66
    s_cbranch_scc0 L_b_q6
    s_or_b32 s66, s66, s65
    s_branch L_b_r6
L_b_q6:
    s_sub_u32 s56, s56, 1
    s_cbranch_scc0 L_b_p6
    s_mov_b32 s56, 0
    s_not_b32 s65, s66
    s_branch L_b_r6
L_b_p7:
    v_mov_b32 v8, 0
    buffer_atomic_or v8, v159, s[16:19], 0 offen sc0 sc1
    s_waitcnt vmcnt(0)
    v_cmp_eq_u32 vcc, s68, v8
    s_nop 0
    s_lshr_b32 s65, vcc_lo, 1
    s_and_b32 s65, s65, vcc_lo
    s_andn2_b32 s65, s65, s66
    s_cbranch_scc0 L_b_q7
    s_or_b32 s66, s66, s65
    s_branch L_b_r7
L_b_q7:
    s_sub_u32 s56, s56, 1
    s_cbranch_scc0 L_b_p7
    s_mov_b32 s56, 0
    s_not_b32 s65, s66
    s_branch L_b_r7
    s_endpgm
.section .rodata,"a"
.p2align 6
.amdhsa_kernel sequential_preLN__linear_attn_block__moe_arch_mod__prompt_kernel
  .amdhsa_next_free_vgpr 256
  .amdhsa_next_free_sgpr 102
  .amdhsa_accum_offset 256
  .amdhsa_group_segment_fixed_size 0
  .amdhsa_kernarg_size 88
  .amdhsa_user_sgpr_count 2
  .amdhsa_user_sgpr_kernarg_segment_ptr 1
  .amdhsa_system_sgpr_workgroup_id_x 1
.end_amdhsa_kernel
```

```asm
; @launch grid=(256,1,1) block=(512,1,1) lds=163840
.amdgcn_target "amdgcn-amd-amdhsa--gfx950"
.text
.globl sequential_preLN__linear_attn_block__moe_arch_mod__prompt_kernel
.p2align 8
.type sequential_preLN__linear_attn_block__moe_arch_mod__prompt_kernel,@function
sequential_preLN__linear_attn_block__moe_arch_mod__prompt_kernel:
    s_cmp_ge_u32 s2, 256
    s_cbranch_scc1 L_end
    s_load_dwordx16 s[64:79], s[0:1], 0
    s_load_dwordx4 s[80:83], s[0:1], 64
    s_load_dwordx2 s[84:85], s[0:1], 80
    v_lshrrev_b32 v1, 6, v0
    v_and_b32 v0, 63, v0
    v_readfirstlane_b32 s3, v1
    s_and_b32 s44, s2, 7
    s_lshr_b32 s45, s2, 3
    s_and_b32 s46, s44, 1
    s_lshl_b32 s46, s46, 3
    s_and_b32 s86, s45, 7
    s_add_u32 s46, s46, s86
    s_lshr_b32 s47, s44, 1
    s_lshl_b32 s47, s47, 2
    s_lshr_b32 s86, s45, 3
    s_add_u32 s47, s47, s86
    s_mov_b32 s51, s47
    s_mov_b32 s52, s46
    s_and_b32 s48, s3, 3
    s_and_b32 s49, s3, 1
    s_bfe_u32 s50, s3, 0x10001
    s_mov_b32 s56, 65536
    s_mov_b32 s95, 0x3f803f80
    s_movk_i32 s92, 0x1000
    s_movk_i32 s93, 0x2000
    s_movk_i32 s94, 0x3000
    s_cmp_lt_u32 s3, 4
    s_cbranch_scc1 L_comp0
    v_lshrrev_b32 v20, 3, v0
    v_and_b32 v21, 7, v0
    v_lshrrev_b32 v22, 4, v0
    v_xor_b32 v23, v21, v22
    v_xor_b32 v24, 4, v23
    s_lshl_b32 s86, s48, 5
    v_add_u32 v25, s86, v20
    v_lshlrev_b32 v25, 11, v25
    v_lshl_add_u32 v2, v23, 4, v25
    v_lshl_add_u32 v3, v24, 4, v25
    v_add_u32 v3, 15360, v3
    v_lshl_add_u32 v4, v23, 4, v25
    v_add_u32 v4, 30720, v4
    v_lshl_add_u32 v5, v24, 4, v25
    v_add_u32 v5, 46080, v5
    s_lshl_b32 s86, s48, 4
    v_add_u32 v25, s86, v20
    v_mul_u32_u24 v25, 6144, v25
    s_lshl_b32 s86, s47, 7
    v_add_u32 v25, s86, v25
    v_bfe_u32 v26, v0, 4, 1
    v_lshlrev_b32 v26, 1, v26
    v_xor_b32 v26, v26, v21
    v_xor_b32 v27, 4, v26
    v_lshl_add_u32 v6, v26, 4, v25
    v_lshl_add_u32 v7, v27, 4, v25
    v_add_u32 v7, 48128, v7
    v_lshl_add_u32 v8, v26, 4, v25
    v_add_u32 v8, 2048, v8
    v_lshl_add_u32 v9, v27, 4, v25
    v_add_u32 v9, 50176, v9
    v_lshl_add_u32 v10, v26, 4, v25
    v_add_u32 v10, 4096, v10
    v_lshl_add_u32 v11, v27, 4, v25
    v_add_u32 v11, 52224, v11
    s_lshl_b32 s63, s46, 18
    s_lshl_b32 s53, s48, 12
    s_lshl_b32 s62, s48, 11
    s_add_u32 s62, s62, 16384
    s_setprio 1
    s_lshl_b32 s86, s45, 2
    s_add_u32 s86, s86, s48
    s_mul_i32 s87, s86, 12288
    s_and_b32 s88, s47, 12
    s_lshl_b32 s88, s88, 7
    s_add_u32 s87, s87, s88
    s_add_u32 s87, s87, 384
    s_bitcmp1_b32 s47, 2
    s_cselect_b32 s87, 2147483648, s87
    v_lshl_add_u32 v37, v0, 11, s87
    v_mov_b32 v24, 2147483648
    v_cmp_gt_u32 vcc, 6, v0
    s_nop 1
    v_cndmask_b32 v37, v24, v37, vcc
    s_lshl_b32 s86, s86, 14
    s_and_b32 s88, s46, 8
    s_lshl_b32 s88, s88, 7
    s_add_u32 s86, s86, s88
    s_add_u32 s86, s86, 384
    v_lshl_add_u32 v38, v0, 11, s86
    v_cmp_gt_u32 vcc, 8, v0
    s_nop 1
    v_cndmask_b32 v38, v24, v38, vcc
    s_waitcnt lgkmcnt(0)
    s_mov_b32 s8, s64
    s_and_b32 s9, s65, 0xffff
    s_mov_b32 s10, 4194304
    s_mov_b32 s11, 0x20000
    s_mov_b32 s12, s66
    s_and_b32 s13, s67, 0xffff
    s_mov_b32 s14, 6291456
    s_mov_b32 s15, 0x20000
    s_and_b32 s86, s47, 12
    s_and_b32 s87, s46, 8
    s_add_u32 s64, s86, s87
    s_and_b32 s64, s64, 15
    s_mov_b32 s67, s64
    s_load_dword s61, s[84:85], 524288
    s_lshr_b32 s90, s67, 2
    s_mul_i32 s90, s90, 1572864
    buffer_load_dword v39, v37, s[12:15], s90 offen
    s_add_u32 m0, s53, 40960
    s_lshl_b32 s70, s64, 7
    s_add_u32 s70, s70, s63
    buffer_load_dwordx4 v2, s[8:11], s70 offen offset:0 lds
    buffer_load_dwordx4 v3, s[8:11], s70 offen offset:1024 lds
    buffer_load_dwordx4 v4, s[8:11], s70 offen offset:2048 lds
    buffer_load_dwordx4 v5, s[8:11], s70 offen offset:3072 lds
    s_mul_i32 s91, s64, 393216
    s_add_u32 s64, s64, 1
    s_and_b32 s64, s64, 15
    s_add_u32 m0, s62, 40960
    s_nop 0
    buffer_load_dwordx4 v6, s[12:15], s91 offen offset:0 lds
    buffer_load_dwordx4 v7, s[12:15], s91 offen offset:1024 lds
    s_add_u32 m0, s62, 49152
    s_nop 0
    buffer_load_dwordx4 v8, s[12:15], s91 offen offset:0 lds
    buffer_load_dwordx4 v9, s[12:15], s91 offen offset:1024 lds
    s_add_u32 m0, s62, 57344
    s_nop 0
    buffer_load_dwordx4 v10, s[12:15], s91 offen offset:0 lds
    buffer_load_dwordx4 v11, s[12:15], s91 offen offset:1024 lds
    s_branch L_ld1
L_comp0:
    s_lshl2_add_u32 s86, s45, s3
    s_cmp_ge_u32 s86, 4
    s_cbranch_scc1 L_noipf
    s_getpc_b64 s[4:5]
L_ipf:
    s_sub_u32 s4, s4, L_ipf-sequential_preLN__linear_attn_block__moe_arch_mod__prompt_kernel
    s_subb_u32 s5, s5, 0
    s_lshl_b32 s86, s86, 13
    v_lshl_add_u32 v31, v0, 7, s86
    v_min_u32 v31, L_last-sequential_preLN__linear_attn_block__moe_arch_mod__prompt_kernel, v31
    global_load_dword v30, v31, s[4:5]
L_noipf:
    s_cmp_eq_u32 s3, 3
    s_cbranch_scc1 L_comp
    s_mov_b64 exec, 0
    s_cmp_eq_u32 s3, 2
    s_cbranch_scc1 L_walkA2
    s_cmp_eq_u32 s3, 1
    s_cbranch_scc1 L_walkA1
    s_branch L_walkA0
L_ld1:
    s_mov_b32 s16, s84
    s_and_b32 s17, s85, 0xffff
    s_mov_b32 s18, 268435456
    s_mov_b32 s19, 0x20000
    s_mov_b32 s20, s68
    s_and_b32 s21, s69, 0xffff
    s_mov_b32 s22, 2097152
    s_mov_b32 s23, 0x20000
    s_mov_b32 s24, s80
    s_and_b32 s25, s81, 0xffff
    s_mov_b32 s26, 4194304
    s_mov_b32 s27, 0x20000
    s_mov_b32 s28, s82
    s_and_b32 s29, s83, 0xffff
    s_mov_b32 s30, 256
    s_mov_b32 s31, 0x20000
    s_bitcmp1_b32 s2, 0
    s_cselect_b32 s32, s76, s74
    s_cselect_b32 s33, s77, s75
    s_and_b32 s33, s33, 0xffff
    s_mov_b32 s34, 7340032
    s_mov_b32 s35, 0x20000
    s_mov_b32 s36, s78
    s_and_b32 s37, s79, 0xffff
    s_mov_b32 s38, 7340032
    s_mov_b32 s39, 0x20000
    s_mov_b32 s40, s72
    s_and_b32 s41, s73, 0xffff
    s_mov_b32 s42, 2048
    s_mov_b32 s43, 0x20000
    v_lshrrev_b32 v22, 4, v0
    v_and_b32 v23, 15, v0
    s_lshl_b32 s86, s45, 2
    s_add_u32 s86, s86, s48
    s_mul_i32 s87, s86, 6
    v_mul_u32_u24 v24, 43, v0
L_walkA0:
    s_cbranch_execz L_comp
    v_lshrrev_b32 v24, 8, v24
    v_mul_u32_u24 v25, 6, v24
    v_sub_u32 v25, v0, v25
    v_add_u32 v25, s87, v25
    s_add_u32 s87, s67, 2
    v_add_u32 v24, s87, v24
    v_and_b32 v24, 15, v24
    v_mul_u32_u24 v124, 393216, v24
    v_lshrrev_b32 v24, 2, v25
    v_lshl_add_u32 v124, v24, 11, v124
    v_and_b32 v25, 3, v25
    s_and_b32 s88, s47, 12
    v_add_u32 v25, s88, v25
    v_lshl_add_u32 v124, v25, 7, v124
    v_mov_b32 v24, 2147483648
    v_cmp_gt_u32 vcc, 36, v0
    s_nop 1
    v_cndmask_b32 v124, v24, v124, vcc
    v_add_u32 v24, s87, v20
    v_and_b32 v24, 15, v24
    s_and_b32 s88, s46, 8
    s_lshl4_add_u32 s86, s88, s86
    s_lshl_b32 s86, s86, 14
    v_lshl_add_u32 v123, v21, 11, s86
    v_lshl_add_u32 v123, v24, 7, v123
    v_mov_b32 v24, 2147483648
    v_cmp_gt_u32 vcc, 16, v0
    s_nop 1
    v_cndmask_b32 v123, v24, v123, vcc
    s_add_u32 m0, s53, 81920
    s_lshl_b32 s70, s64, 7
    s_add_u32 s70, s70, s63
    buffer_load_dwordx4 v2, s[8:11], s70 offen offset:0 lds
    buffer_load_dwordx4 v3, s[8:11], s70 offen offset:1024 lds
    buffer_load_dwordx4 v4, s[8:11], s70 offen offset:2048 lds
    buffer_load_dwordx4 v5, s[8:11], s70 offen offset:3072 lds
    s_mul_i32 s91, s64, 393216
    s_add_u32 s64, s64, 1
    s_and_b32 s64, s64, 15
    s_add_u32 m0, s62, 81920
    s_nop 0
    buffer_load_dwordx4 v6, s[12:15], s91 offen offset:0 lds
    buffer_load_dwordx4 v7, s[12:15], s91 offen offset:1024 lds
    s_add_u32 m0, s62, 90112
    s_nop 0
    buffer_load_dwordx4 v8, s[12:15], s91 offen offset:0 lds
    buffer_load_dwordx4 v9, s[12:15], s91 offen offset:1024 lds
    s_add_u32 m0, s62, 98304
    s_nop 0
    buffer_load_dwordx4 v10, s[12:15], s91 offen offset:0 lds
    buffer_load_dwordx4 v11, s[12:15], s91 offen offset:1024 lds
    buffer_load_dword v122, v123, s[8:11], 0 offen
    buffer_load_dword v122, v124, s[12:15], 0 offen
    s_and_b32 s65, s45, 7
    s_lshr_b32 s66, s45, 3
    s_add_u32 s86, s65, 1
    s_and_b32 s86, s86, 3
    s_mul_i32 s86, s86, 40960
    s_lshl_b32 s87, s48, 13
    s_cmp_eq_u32 s48, 3
    s_cselect_b32 s87, 0, s87
    s_add_u32 s86, s86, s87
    s_add_u32 s86, s86, 16384
    v_lshl_add_u32 v25, v20, 7, s86
    v_lshl_add_u32 v28, v26, 4, v25
    v_lshl_add_u32 v29, v27, 4, v25
    s_add_u32 s86, s66, 1
    s_and_b32 s86, s86, 3
    s_mul_i32 s86, s86, 40960
    s_add_u32 s86, s86, s53
    v_lshl_add_u32 v16, v0, 6, s86
    v_bfe_u32 v25, v0, 2, 2
    v_lshl_add_u32 v16, v25, 4, v16
    v_xor_b32 v17, 16, v16
    v_xor_b32 v18, 32, v16
    v_xor_b32 v19, 48, v16
    s_lshl_b32 s86, s46, 14
    s_lshl_b32 s87, s48, 8
    s_add_u32 s86, s86, s87
    s_add_u32 s86, s86, 262144
    v_lshl_add_u32 v33, v23, 4, s86
    v_lshl_add_u32 v33, v22, 10, v33
    s_lshl_b32 s87, s47, 10
    s_add_u32 s86, s86, s87
    v_lshl_add_u32 v13, v0, 2, s86
    v_and_b32 v25, 3, v0
    v_cmp_eq_u32 vcc, 0, v25
    v_mov_b32 v24, 2147483648
    s_nop 0
    v_cndmask_b32 v13, v24, v13, vcc
    s_mul_i32 s86, s47, 12288
    s_add_u32 s86, s86, 65536
    s_lshl_b32 s87, s48, 8
    s_cmp_eq_u32 s48, 3
    s_cselect_b32 s87, 2147483648, s87
    s_mov_b32 s88, 0
    s_add_u32 s86, s86, s87
    v_lshl_add_u32 v32, v23, 4, s86
    v_mul_u32_u24 v25, 768, v22
    v_add_u32 v32, v32, v25
    s_mul_i32 s87, s46, 768
    s_add_u32 s86, s86, s87
    s_add_u32 s86, s86, s88
    v_lshl_add_u32 v34, v23, 5, s86
    v_lshl_add_u32 v34, v22, 4, v34
    v_and_b32 v25, 0x28, v0
    v_cmp_eq_u32 vcc, 0, v25
    s_nop 1
    v_cndmask_b32 v34, v24, v34, vcc
    s_bfe_u32 s86, s2, 0x20001
    s_lshl_b32 s86, s86, 2
    s_add_u32 s86, s86, s48
    s_lshl_b32 s86, s86, 6
    v_lshl_add_u32 v30, v22, 4, s86
    v_mul_u32_u24 v30, 7168, v30
    s_lshl_b32 s86, s45, 1
    s_sub_u32 s86, s86, 14
    s_mul_i32 s87, s86, 37
    s_lshr_b32 s87, s87, 8
    s_add_u32 s80, s86, s87
    s_and_b32 s87, s80, 7
    s_cmp_ge_u32 s87, 3
    s_addc_u32 s80, s80, 0
    s_lshl_b32 s86, s45, 1
    s_sub_u32 s86, s86, 13
    s_mul_i32 s87, s86, 37
    s_lshr_b32 s87, s87, 8
    s_add_u32 s81, s86, s87
    s_and_b32 s87, s81, 7
    s_cmp_ge_u32 s87, 3
    s_addc_u32 s81, s81, 0
    s_lshl_b32 s86, s45, 3
    s_add_u32 s86, s86, 3
    s_cmp_lt_u32 s45, 7
    s_cselect_b32 s80, s86, s80
    s_cselect_b32 s81, 56, s81
    v_mov_b32 v24, s80
    v_mov_b32 v25, s81
    s_mov_b32 vcc_lo, 4278255360
    s_mov_b32 vcc_hi, vcc_lo
    v_cndmask_b32 v24, v24, v25, vcc
    v_cmp_gt_u32 vcc, 56, v24
    v_and_b32 v25, 7, v0
    v_lshlrev_b32 v24, 7, v24
    v_lshl_add_u32 v24, v25, 4, v24
    v_add_u32 v30, v30, v24
    v_mov_b32 v24, 2147483648
    v_cndmask_b32 v30, v24, v30, vcc
    s_mul_i32 s86, s45, 112
    s_mul_i32 s87, s48, 28
    s_add_u32 s86, s86, s87
    v_mul_u32_u24 v31, 7, v22
    v_add_u32 v31, s86, v31
    v_lshlrev_b32 v31, 11, v31
    s_lshl_b32 s86, s44, 8
    v_lshl_add_u32 v24, v23, 4, s86
    v_add_u32 v31, v31, v24
    v_lshlrev_b32 v24, 1, v22
    v_xor_b32 v24, v24, v21
    s_lshl_b32 s86, s48, 3
    v_add_u32 v12, s86, v20
    v_lshlrev_b32 v12, 11, v12
    s_lshl_b32 s86, s52, 7
    v_lshl_add_u32 v24, v24, 4, s86
    v_add_u32 v12, v12, v24
    s_lshl_b32 s89, s48, 10
    v_and_b32 v24, 1, v0
    v_lshlrev_b32 v24, 4, v24
    v_mov_b32 v25, 0x3f80
    v_lshlrev_b32 v24, v24, v25
    v_bfe_u32 v25, v0, 1, 2
    v_cmp_eq_u32 vcc, 0, v25
    s_nop 1
    v_cndmask_b32 v104, 0, v24, vcc
    v_cmp_eq_u32 vcc, 1, v25
    s_nop 1
    v_cndmask_b32 v105, 0, v24, vcc
    v_cmp_eq_u32 vcc, 2, v25
    s_nop 1
    v_cndmask_b32 v106, 0, v24, vcc
    v_cmp_eq_u32 vcc, 3, v25
    s_nop 1
    v_cndmask_b32 v107, 0, v24, vcc
    s_waitcnt lgkmcnt(0)
    s_add_u32 s68, s61, 0x9e3779b9
    v_mov_b32 v35, s68
    s_lshl_b32 s86, s46, 2
    s_add_u32 s86, s86, s48
    s_lshl_b32 s86, s86, 7
    s_add_u32 s86, s86, 655360
    s_lshl_b32 s87, s47, 2
    s_add_u32 s87, s87, s48
    s_lshl_b32 s87, s87, 7
    s_add_u32 s87, s87, 663552
    s_cmp_eq_u32 s48, 3
    s_cselect_b32 s87, 2147483648, s87
    s_cselect_b32 s76, 0xffff, -1
    s_mov_b32 s77, 0
    v_mov_b32 v24, s86
    v_mov_b32 v25, s87
    v_cmp_gt_u32 vcc, 16, v0
    s_nop 1
    v_cndmask_b32 v117, v25, v24, vcc
    v_lshl_add_u32 v117, v23, 2, v117
    v_mov_b32 v116, 2147483648
    v_cmp_gt_u32 vcc, 32, v0
    s_nop 1
    v_cndmask_b32 v117, v116, v117, vcc
    s_lshl2_add_u32 s86, s47, s86
    s_lshl2_add_u32 s87, s46, s87
    v_writelane_b32 v116, s86, 0
    v_writelane_b32 v116, s87, 1
L_walkA1:
    s_cbranch_execz L_comp
    s_waitcnt vmcnt(12)
    s_barrier
    s_add_u32 m0, s53, 122880
    s_lshl_b32 s70, s64, 7
    s_add_u32 s70, s70, s63
    buffer_load_dwordx4 v2, s[8:11], s70 offen offset:0 lds
    buffer_load_dwordx4 v3, s[8:11], s70 offen offset:1024 lds
    buffer_load_dwordx4 v4, s[8:11], s70 offen offset:2048 lds
    buffer_load_dwordx4 v5, s[8:11], s70 offen offset:3072 lds
    s_mul_i32 s91, s64, 393216
    s_add_u32 s64, s64, 1
    s_and_b32 s64, s64, 15
    s_add_u32 m0, s62, 122880
    s_nop 0
    buffer_load_dwordx4 v6, s[12:15], s91 offen offset:0 lds
    buffer_load_dwordx4 v7, s[12:15], s91 offen offset:1024 lds
    s_add_u32 m0, s62, 131072
    s_nop 0
    buffer_load_dwordx4 v8, s[12:15], s91 offen offset:0 lds
    buffer_load_dwordx4 v9, s[12:15], s91 offen offset:1024 lds
    s_add_u32 m0, s62, 139264
    s_nop 0
    buffer_load_dwordx4 v10, s[12:15], s91 offen offset:0 lds
    buffer_load_dwordx4 v11, s[12:15], s91 offen offset:1024 lds
    s_cmp_lg_u32 s65, 0
    s_cbranch_scc1 L_h0c0
    ds_read_b128 v[40:43], v28 offset:0
    ds_read_b128 v[44:47], v29 offset:1024
    ds_read_b128 v[48:51], v28 offset:2048
    ds_read_b128 v[52:55], v29 offset:3072
    ds_read_b128 v[56:59], v28 offset:4096
    ds_read_b128 v[60:63], v29 offset:5120
    ds_read_b128 v[64:67], v28 offset:6144
    ds_read_b128 v[68:71], v29 offset:7168
L_h0c0:
    s_cmp_lg_u32 s66, 0
    s_cbranch_scc1 L_h0r0
    ds_read_b128 v[72:75], v16
    ds_read_b128 v[76:79], v17
    ds_read_b128 v[80:83], v18
    ds_read_b128 v[84:87], v19
L_h0r0:
    s_waitcnt lgkmcnt(0)
    s_waitcnt vmcnt(12)
    s_barrier
    s_add_u32 m0, s53, 0
    s_lshl_b32 s70, s64, 7
    s_add_u32 s70, s70, s63
    buffer_load_dwordx4 v2, s[8:11], s70 offen offset:0 lds
    buffer_load_dwordx4 v3, s[8:11], s70 offen offset:1024 lds
    buffer_load_dwordx4 v4, s[8:11], s70 offen offset:2048 lds
    buffer_load_dwordx4 v5, s[8:11], s70 offen offset:3072 lds
    s_mul_i32 s91, s64, 393216
    s_add_u32 s64, s64, 1
    s_and_b32 s64, s64, 15
    s_add_u32 m0, s62, 0
    s_nop 0
    buffer_load_dwordx4 v6, s[12:15], s91 offen offset:0 lds
    buffer_load_dwordx4 v7, s[12:15], s91 offen offset:1024 lds
    s_add_u32 m0, s62, 8192
    s_nop 0
    buffer_load_dwordx4 v8, s[12:15], s91 offen offset:0 lds
    buffer_load_dwordx4 v9, s[12:15], s91 offen offset:1024 lds
    s_add_u32 m0, s62, 16384
    s_nop 0
    buffer_load_dwordx4 v10, s[12:15], s91 offen offset:0 lds
    buffer_load_dwordx4 v11, s[12:15], s91 offen offset:1024 lds
    s_cmp_lg_u32 s65, 1
    s_cbranch_scc1 L_h0c1
    ds_read_b128 v[40:43], v28 offset:0
    ds_read_b128 v[44:47], v29 offset:1024
    ds_read_b128 v[48:51], v28 offset:2048
    ds_read_b128 v[52:55], v29 offset:3072
    ds_read_b128 v[56:59], v28 offset:4096
    ds_read_b128 v[60:63], v29 offset:5120
    ds_read_b128 v[64:67], v28 offset:6144
    ds_read_b128 v[68:71], v29 offset:7168
L_h0c1:
    s_cmp_lg_u32 s66, 1
    s_cbranch_scc1 L_h0r1
    ds_read_b128 v[72:75], v16
    ds_read_b128 v[76:79], v17
    ds_read_b128 v[80:83], v18
    ds_read_b128 v[84:87], v19
L_h0r1:
    s_waitcnt lgkmcnt(0)
    s_waitcnt vmcnt(10)
    s_barrier
    s_add_u32 m0, s53, 40960
    s_lshl_b32 s70, s64, 7
    s_add_u32 s70, s70, s63
    buffer_load_dwordx4 v2, s[8:11], s70 offen offset:0 lds
    buffer_load_dwordx4 v3, s[8:11], s70 offen offset:1024 lds
    buffer_load_dwordx4 v4, s[8:11], s70 offen offset:2048 lds
    buffer_load_dwordx4 v5, s[8:11], s70 offen offset:3072 lds
    s_mul_i32 s91, s64, 393216
    s_add_u32 s64, s64, 1
    s_and_b32 s64, s64, 15
    s_add_u32 m0, s62, 40960
    s_nop 0
    buffer_load_dwordx4 v6, s[12:15], s91 offen offset:0 lds
    buffer_load_dwordx4 v7, s[12:15], s91 offen offset:1024 lds
    s_add_u32 m0, s62, 49152
    s_nop 0
    buffer_load_dwordx4 v8, s[12:15], s91 offen offset:0 lds
    buffer_load_dwordx4 v9, s[12:15], s91 offen offset:1024 lds
    s_add_u32 m0, s62, 57344
    s_nop 0
    buffer_load_dwordx4 v10, s[12:15], s91 offen offset:0 lds
    buffer_load_dwordx4 v11, s[12:15], s91 offen offset:1024 lds
    s_cmp_lg_u32 s65, 2
    s_cbranch_scc1 L_h0c2
    ds_read_b128 v[40:43], v28 offset:0
    ds_read_b128 v[44:47], v29 offset:1024
    ds_read_b128 v[48:51], v28 offset:2048
    ds_read_b128 v[52:55], v29 offset:3072
    ds_read_b128 v[56:59], v28 offset:4096
    ds_read_b128 v[60:63], v29 offset:5120
    ds_read_b128 v[64:67], v28 offset:6144
    ds_read_b128 v[68:71], v29 offset:7168
L_h0c2:
    s_cmp_lg_u32 s66, 2
    s_cbranch_scc1 L_h0r2
    ds_read_b128 v[72:75], v16
    ds_read_b128 v[76:79], v17
    ds_read_b128 v[80:83], v18
    ds_read_b128 v[84:87], v19
L_h0r2:
    s_waitcnt lgkmcnt(0)
    s_waitcnt vmcnt(10)
    s_barrier
    s_add_u32 m0, s53, 81920
    s_lshl_b32 s70, s64, 7
    s_add_u32 s70, s70, s63
    buffer_load_dwordx4 v2, s[8:11], s70 offen offset:0 lds
    buffer_load_dwordx4 v3, s[8:11], s70 offen offset:1024 lds
    buffer_load_dwordx4 v4, s[8:11], s70 offen offset:2048 lds
    buffer_load_dwordx4 v5, s[8:11], s70 offen offset:3072 lds
    s_mul_i32 s91, s64, 393216
    s_add_u32 s64, s64, 1
    s_and_b32 s64, s64, 15
    s_add_u32 m0, s62, 81920
    s_nop 0
    buffer_load_dwordx4 v6, s[12:15], s91 offen offset:0 lds
    buffer_load_dwordx4 v7, s[12:15], s91 offen offset:1024 lds
    s_add_u32 m0, s62, 90112
    s_nop 0
    buffer_load_dwordx4 v8, s[12:15], s91 offen offset:0 lds
    buffer_load_dwordx4 v9, s[12:15], s91 offen offset:1024 lds
    s_add_u32 m0, s62, 98304
    s_nop 0
    buffer_load_dwordx4 v10, s[12:15], s91 offen offset:0 lds
    buffer_load_dwordx4 v11, s[12:15], s91 offen offset:1024 lds
    s_lshr_b32 s90, s67, 2
    s_add_u32 s90, s90, 2
    s_and_b32 s90, s90, 3
    s_mul_i32 s90, s90, 1572864
    buffer_load_dword v39, v37, s[12:15], s90 offen
    s_cmp_lg_u32 s65, 3
    s_cbranch_scc1 L_h0c3
    ds_read_b128 v[40:43], v28 offset:0
    ds_read_b128 v[44:47], v29 offset:1024
    ds_read_b128 v[48:51], v28 offset:2048
    ds_read_b128 v[52:55], v29 offset:3072
    ds_read_b128 v[56:59], v28 offset:4096
    ds_read_b128 v[60:63], v29 offset:5120
    ds_read_b128 v[64:67], v28 offset:6144
    ds_read_b128 v[68:71], v29 offset:7168
L_h0c3:
    s_cmp_lg_u32 s66, 3
    s_cbranch_scc1 L_h0r3
    ds_read_b128 v[72:75], v16
    ds_read_b128 v[76:79], v17
    ds_read_b128 v[80:83], v18
    ds_read_b128 v[84:87], v19
L_h0r3:
    s_waitcnt lgkmcnt(0)
L_walkB0:
    s_cbranch_execz L_walk_4
    s_waitcnt vmcnt(11)
    s_barrier
    s_add_u32 m0, s53, 122880
    s_lshl_b32 s70, s64, 7
    s_add_u32 s70, s70, s63
    buffer_load_dwordx4 v2, s[8:11], s70 offen offset:0 lds
    buffer_load_dwordx4 v3, s[8:11], s70 offen offset:1024 lds
    buffer_load_dwordx4 v4, s[8:11], s70 offen offset:2048 lds
    buffer_load_dwordx4 v5, s[8:11], s70 offen offset:3072 lds
    s_mul_i32 s91, s64, 393216
    s_add_u32 s64, s64, 1
    s_and_b32 s64, s64, 15
    s_add_u32 m0, s62, 122880
    s_nop 0
    buffer_load_dwordx4 v6, s[12:15], s91 offen offset:0 lds
    buffer_load_dwordx4 v7, s[12:15], s91 offen offset:1024 lds
    s_add_u32 m0, s62, 131072
    s_nop 0
    buffer_load_dwordx4 v8, s[12:15], s91 offen offset:0 lds
    buffer_load_dwordx4 v9, s[12:15], s91 offen offset:1024 lds
    s_add_u32 m0, s62, 139264
    s_nop 0
    buffer_load_dwordx4 v10, s[12:15], s91 offen offset:0 lds
    buffer_load_dwordx4 v11, s[12:15], s91 offen offset:1024 lds
    s_cmp_lg_u32 s65, 4
    s_cbranch_scc1 L_h0c4
    ds_read_b128 v[40:43], v28 offset:0
    ds_read_b128 v[44:47], v29 offset:1024
    ds_read_b128 v[48:51], v28 offset:2048
    ds_read_b128 v[52:55], v29 offset:3072
    ds_read_b128 v[56:59], v28 offset:4096
    ds_read_b128 v[60:63], v29 offset:5120
    ds_read_b128 v[64:67], v28 offset:6144
    ds_read_b128 v[68:71], v29 offset:7168
L_h0c4:
    s_waitcnt lgkmcnt(0)
    v_mov_b32 v88, 0
    v_mov_b32 v89, 0
    v_mov_b32 v90, 0
    v_mov_b32 v91, 0
    v_mov_b32 v92, 0
    v_mov_b32 v93, 0
    v_mov_b32 v94, 0
    v_mov_b32 v95, 0
    v_dot2c_f32_bf16 v88, s95, v72
    v_dot2c_f32_bf16 v89, s95, v73
    v_dot2c_f32_bf16 v90, s95, v74
    v_dot2c_f32_bf16 v91, s95, v75
    v_dot2c_f32_bf16 v92, v72, v72
    v_dot2c_f32_bf16 v93, v73, v73
    v_dot2c_f32_bf16 v94, v74, v74
    v_dot2c_f32_bf16 v95, v75, v75
    v_dot2c_f32_bf16 v88, s95, v76
    v_dot2c_f32_bf16 v89, s95, v77
    v_dot2c_f32_bf16 v90, s95, v78
    v_dot2c_f32_bf16 v91, s95, v79
    v_dot2c_f32_bf16 v92, v76, v76
    v_dot2c_f32_bf16 v93, v77, v77
    v_dot2c_f32_bf16 v94, v78, v78
    v_dot2c_f32_bf16 v95, v79, v79
    v_dot2c_f32_bf16 v88, s95, v80
    v_dot2c_f32_bf16 v89, s95, v81
    v_dot2c_f32_bf16 v90, s95, v82
    v_dot2c_f32_bf16 v91, s95, v83
    v_dot2c_f32_bf16 v92, v80, v80
    v_dot2c_f32_bf16 v93, v81, v81
    v_dot2c_f32_bf16 v94, v82, v82
    v_dot2c_f32_bf16 v95, v83, v83
    v_dot2c_f32_bf16 v88, s95, v84
    v_dot2c_f32_bf16 v89, s95, v85
    v_dot2c_f32_bf16 v90, s95, v86
    v_dot2c_f32_bf16 v91, s95, v87
    v_dot2c_f32_bf16 v92, v84, v84
    v_dot2c_f32_bf16 v93, v85, v85
    v_dot2c_f32_bf16 v94, v86, v86
    v_dot2c_f32_bf16 v95, v87, v87
    s_waitcnt vmcnt(11)
    s_barrier
    s_add_u32 m0, s53, 0
    s_lshl_b32 s70, s64, 7
    s_add_u32 s70, s70, s63
    buffer_load_dwordx4 v2, s[8:11], s70 offen offset:0 lds
    buffer_load_dwordx4 v3, s[8:11], s70 offen offset:1024 lds
    buffer_load_dwordx4 v4, s[8:11], s70 offen offset:2048 lds
    buffer_load_dwordx4 v5, s[8:11], s70 offen offset:3072 lds
    s_mul_i32 s91, s64, 393216
    s_add_u32 s64, s64, 1
    s_and_b32 s64, s64, 15
    s_add_u32 m0, s62, 0
    s_nop 0
    buffer_load_dwordx4 v6, s[12:15], s91 offen offset:0 lds
    buffer_load_dwordx4 v7, s[12:15], s91 offen offset:1024 lds
    s_add_u32 m0, s62, 8192
    s_nop 0
    buffer_load_dwordx4 v8, s[12:15], s91 offen offset:0 lds
    buffer_load_dwordx4 v9, s[12:15], s91 offen offset:1024 lds
    s_add_u32 m0, s62, 16384
    s_nop 0
    buffer_load_dwordx4 v10, s[12:15], s91 offen offset:0 lds
    buffer_load_dwordx4 v11, s[12:15], s91 offen offset:1024 lds
    buffer_load_dword v39, v38, s[20:23], 0 offen
    s_cmp_lg_u32 s65, 5
    s_cbranch_scc1 L_h0c5
    ds_read_b128 v[40:43], v28 offset:0
    ds_read_b128 v[44:47], v29 offset:1024
    ds_read_b128 v[48:51], v28 offset:2048
    ds_read_b128 v[52:55], v29 offset:3072
    ds_read_b128 v[56:59], v28 offset:4096
    ds_read_b128 v[60:63], v29 offset:5120
    ds_read_b128 v[64:67], v28 offset:6144
    ds_read_b128 v[68:71], v29 offset:7168
L_h0c5:
    s_waitcnt lgkmcnt(0)
    v_pk_add_f32 v[88:89], v[88:89], v[90:91]
    v_pk_add_f32 v[92:93], v[92:93], v[94:95]
    v_add_f32 v88, v88, v89
    v_add_f32 v89, v92, v93
    s_nop 0
    v_add_f32_dpp v88, v88, v88 quad_perm:[1,0,3,2] row_mask:0xf bank_mask:0xf
    v_add_f32_dpp v89, v89, v89 quad_perm:[1,0,3,2] row_mask:0xf bank_mask:0xf
    s_nop 0
    v_mov_b32_dpp v90, v88 quad_perm:[2,2,2,2] row_mask:0xf bank_mask:0xf
    v_mov_b32_dpp v91, v89 quad_perm:[2,2,2,2] row_mask:0xf bank_mask:0xf
    buffer_store_dwordx4 v[88:91], v13, s[16:19], 0 offen sc1
    s_lshl_b32 s86, s48, 7
    s_add_u32 s86, s86, 131072
    v_lshl_add_u32 v16, v23, 3, s86
    v_lshrrev_b32 v17, 5, v0
    v_lshl_add_u32 v16, v17, 2, v16
    s_lshl_b32 s86, s48, 8
    s_add_u32 s86, s86, 132608
    v_lshl_add_u32 v17, v23, 4, s86
    v_lshl_add_u32 v17, v22, 2, v17
    s_waitcnt vmcnt(12)
    s_barrier
    s_add_u32 m0, s53, 40960
    s_lshl_b32 s70, s64, 7
    s_add_u32 s70, s70, s63
    buffer_load_dwordx4 v2, s[8:11], s70 offen offset:0 lds
    buffer_load_dwordx4 v3, s[8:11], s70 offen offset:1024 lds
    buffer_load_dwordx4 v4, s[8:11], s70 offen offset:2048 lds
    buffer_load_dwordx4 v5, s[8:11], s70 offen offset:3072 lds
    s_mul_i32 s91, s64, 393216
    s_add_u32 s64, s64, 1
    s_and_b32 s64, s64, 15
    s_add_u32 m0, s62, 40960
    s_nop 0
    buffer_load_dwordx4 v6, s[12:15], s91 offen offset:0 lds
    buffer_load_dwordx4 v7, s[12:15], s91 offen offset:1024 lds
    s_add_u32 m0, s62, 49152
    s_nop 0
    buffer_load_dwordx4 v8, s[12:15], s91 offen offset:0 lds
    buffer_load_dwordx4 v9, s[12:15], s91 offen offset:1024 lds
    s_add_u32 m0, s62, 57344
    s_nop 0
    buffer_load_dwordx4 v10, s[12:15], s91 offen offset:0 lds
    buffer_load_dwordx4 v11, s[12:15], s91 offen offset:1024 lds
    s_lshr_b32 s90, s67, 2
    s_add_u32 s90, s90, 3
    s_and_b32 s90, s90, 3
    s_mul_i32 s90, s90, 1572864
    buffer_load_dword v39, v37, s[12:15], s90 offen
    s_cmp_lg_u32 s65, 6
    s_cbranch_scc1 L_h0c6
    ds_read_b128 v[40:43], v28 offset:0
    ds_read_b128 v[44:47], v29 offset:1024
    ds_read_b128 v[48:51], v28 offset:2048
    ds_read_b128 v[52:55], v29 offset:3072
    ds_read_b128 v[56:59], v28 offset:4096
    ds_read_b128 v[60:63], v29 offset:5120
    ds_read_b128 v[64:67], v28 offset:6144
    ds_read_b128 v[68:71], v29 offset:7168
L_h0c6:
    s_waitcnt lgkmcnt(0)
    s_waitcnt vmcnt(13)
    s_barrier
    s_add_u32 m0, s53, 81920
L_walkB1:
    s_cbranch_execz L_walk_5
    s_lshl_b32 s70, s64, 7
    s_add_u32 s70, s70, s63
    buffer_load_dwordx4 v2, s[8:11], s70 offen offset:0 lds
    buffer_load_dwordx4 v3, s[8:11], s70 offen offset:1024 lds
    buffer_load_dwordx4 v4, s[8:11], s70 offen offset:2048 lds
    buffer_load_dwordx4 v5, s[8:11], s70 offen offset:3072 lds
    s_mul_i32 s91, s64, 393216
    s_add_u32 s64, s64, 1
    s_and_b32 s64, s64, 15
    s_add_u32 m0, s62, 81920
    s_nop 0
    buffer_load_dwordx4 v6, s[12:15], s91 offen offset:0 lds
    buffer_load_dwordx4 v7, s[12:15], s91 offen offset:1024 lds
    s_add_u32 m0, s62, 90112
    s_nop 0
    buffer_load_dwordx4 v8, s[12:15], s91 offen offset:0 lds
    buffer_load_dwordx4 v9, s[12:15], s91 offen offset:1024 lds
    s_add_u32 m0, s62, 98304
    s_nop 0
    buffer_load_dwordx4 v10, s[12:15], s91 offen offset:0 lds
    buffer_load_dwordx4 v11, s[12:15], s91 offen offset:1024 lds
    s_add_u32 m0, s53, 122880
    s_lshl_b32 s70, s64, 7
    s_add_u32 s70, s70, s63
    buffer_load_dwordx4 v2, s[8:11], s70 offen offset:0 lds
    buffer_load_dwordx4 v3, s[8:11], s70 offen offset:1024 lds
    s_cmp_lg_u32 s65, 7
    s_cbranch_scc1 L_h0c7
    ds_read_b128 v[40:43], v28 offset:0
    ds_read_b128 v[44:47], v29 offset:1024
    ds_read_b128 v[48:51], v28 offset:2048
    ds_read_b128 v[52:55], v29 offset:3072
    ds_read_b128 v[56:59], v28 offset:4096
    ds_read_b128 v[60:63], v29 offset:5120
    ds_read_b128 v[64:67], v28 offset:6144
    ds_read_b128 v[68:71], v29 offset:7168
L_h0c7:
    s_waitcnt lgkmcnt(0)
    s_waitcnt vmcnt(13)
    s_barrier
    s_add_u32 m0, s53, 122880
    s_nop 0
    buffer_load_dwordx4 v4, s[8:11], s70 offen offset:2048 lds
    buffer_load_dwordx4 v5, s[8:11], s70 offen offset:3072 lds
    s_mul_i32 s91, s64, 393216
    s_add_u32 s64, s64, 1
    s_and_b32 s64, s64, 15
    s_add_u32 m0, s62, 122880
    s_nop 0
    buffer_load_dwordx4 v6, s[12:15], s91 offen offset:0 lds
    buffer_load_dwordx4 v7, s[12:15], s91 offen offset:1024 lds
    s_add_u32 m0, s62, 131072
    s_nop 0
    buffer_load_dwordx4 v8, s[12:15], s91 offen offset:0 lds
    buffer_load_dwordx4 v9, s[12:15], s91 offen offset:1024 lds
    s_add_u32 m0, s62, 139264
    s_nop 0
    buffer_load_dwordx4 v10, s[12:15], s91 offen offset:0 lds
    buffer_load_dwordx4 v11, s[12:15], s91 offen offset:1024 lds
    s_add_u32 m0, s53, 0
    s_lshl_b32 s70, s64, 7
    s_add_u32 s70, s70, s63
    buffer_load_dwordx4 v2, s[8:11], s70 offen offset:0 lds
    buffer_load_dwordx4 v3, s[8:11], s70 offen offset:1024 lds
    v_mfma_f32_16x16x32_bf16 v[108:111], v[104:107], v[40:43], 0
    v_mfma_f32_16x16x32_bf16 v[108:111], v[104:107], v[44:47], v[108:111]
    v_mfma_f32_16x16x32_bf16 v[108:111], v[104:107], v[48:51], v[108:111]
    v_mfma_f32_16x16x32_bf16 v[108:111], v[104:107], v[52:55], v[108:111]
    v_mfma_f32_16x16x32_bf16 v[108:111], v[104:107], v[56:59], v[108:111]
    v_mfma_f32_16x16x32_bf16 v[108:111], v[104:107], v[60:63], v[108:111]
    v_mfma_f32_16x16x32_bf16 v[108:111], v[104:107], v[64:67], v[108:111]
    v_mfma_f32_16x16x32_bf16 v[108:111], v[104:107], v[68:71], v[108:111]
    s_nop 7
    v_add_f32_dpp v108, v108, v108 row_ror:8 row_mask:0xf bank_mask:0xf
    v_add_f32_dpp v109, v109, v109 row_ror:8 row_mask:0xf bank_mask:0xf
    v_add_f32_dpp v110, v110, v110 row_ror:8 row_mask:0xf bank_mask:0xf
    v_add_f32_dpp v111, v111, v111 row_ror:8 row_mask:0xf bank_mask:0xf
    buffer_store_dwordx4 v[108:111], v34, s[16:19], 0 offen sc1
    s_waitcnt vmcnt(13)
    s_barrier
    s_add_u32 m0, s53, 0
    s_nop 0
    buffer_load_dwordx4 v4, s[8:11], s70 offen offset:2048 lds
    buffer_load_dwordx4 v5, s[8:11], s70 offen offset:3072 lds
    s_mul_i32 s91, s64, 393216
    s_add_u32 s64, s64, 1
    s_and_b32 s64, s64, 15
    s_add_u32 m0, s62, 0
    s_nop 0
    buffer_load_dwordx4 v6, s[12:15], s91 offen offset:0 lds
    buffer_load_dwordx4 v7, s[12:15], s91 offen offset:1024 lds
    s_add_u32 m0, s62, 8192
    s_nop 0
    buffer_load_dwordx4 v8, s[12:15], s91 offen offset:0 lds
    buffer_load_dwordx4 v9, s[12:15], s91 offen offset:1024 lds
    s_add_u32 m0, s62, 16384
    s_nop 0
    buffer_load_dwordx4 v10, s[12:15], s91 offen offset:0 lds
    buffer_load_dwordx4 v11, s[12:15], s91 offen offset:1024 lds
    s_add_u32 m0, s53, 40960
    s_lshl_b32 s70, s64, 7
    s_add_u32 s70, s70, s63
    buffer_load_dwordx4 v2, s[8:11], s70 offen offset:0 lds
    buffer_load_dwordx4 v3, s[8:11], s70 offen offset:1024 lds
    buffer_load_dwordx4 v4, s[8:11], s70 offen offset:2048 lds
    buffer_load_dwordx4 v5, s[8:11], s70 offen offset:3072 lds
    s_mul_i32 s91, s64, 393216
    s_add_u32 s64, s64, 1
    s_and_b32 s64, s64, 15
    s_waitcnt vmcnt(12)
    s_barrier
    buffer_atomic_swap v35, v116, s[16:19], 0 offen sc1
    s_add_u32 m0, s62, 40960
    s_nop 0
    buffer_load_dwordx4 v6, s[12:15], s91 offen offset:0 lds
    buffer_load_dwordx4 v7, s[12:15], s91 offen offset:1024 lds
    s_add_u32 m0, s62, 49152
    s_nop 0
    buffer_load_dwordx4 v8, s[12:15], s91 offen offset:0 lds
    buffer_load_dwordx4 v9, s[12:15], s91 offen offset:1024 lds
    s_add_u32 m0, s62, 57344
    s_nop 0
    buffer_load_dwordx4 v10, s[12:15], s91 offen offset:0 lds
    buffer_load_dwordx4 v11, s[12:15], s91 offen offset:1024 lds
    s_add_u32 m0, s53, 81920
    s_lshl_b32 s70, s64, 7
    s_add_u32 s70, s70, s63
    buffer_load_dwordx4 v2, s[8:11], s70 offen offset:0 lds
    buffer_load_dwordx4 v3, s[8:11], s70 offen offset:1024 lds
    buffer_load_dwordx4 v4, s[8:11], s70 offen offset:2048 lds
    buffer_load_dwordx4 v5, s[8:11], s70 offen offset:3072 lds
    s_mul_i32 s91, s64, 393216
    s_add_u32 s64, s64, 1
    s_and_b32 s64, s64, 15
    s_add_u32 m0, s62, 81920
    s_nop 0
    buffer_load_dwordx4 v6, s[12:15], s91 offen offset:0 lds
    buffer_load_dwordx4 v7, s[12:15], s91 offen offset:1024 lds
    s_waitcnt vmcnt(17)
    s_barrier
    s_add_u32 m0, s62, 90112
    s_nop 0
    buffer_load_dwordx4 v8, s[12:15], s91 offen offset:0 lds
    buffer_load_dwordx4 v9, s[12:15], s91 offen offset:1024 lds
    s_add_u32 m0, s62, 98304
    s_nop 0
    buffer_load_dwordx4 v10, s[12:15], s91 offen offset:0 lds
    buffer_load_dwordx4 v11, s[12:15], s91 offen offset:1024 lds
    s_add_u32 m0, s53, 122880
    s_lshl_b32 s70, s64, 7
    s_add_u32 s70, s70, s63
    buffer_load_dwordx4 v2, s[8:11], s70 offen offset:0 lds
    buffer_load_dwordx4 v3, s[8:11], s70 offen offset:1024 lds
    buffer_load_dwordx4 v4, s[8:11], s70 offen offset:2048 lds
    buffer_load_dwordx4 v5, s[8:11], s70 offen offset:3072 lds
    s_mul_i32 s91, s64, 393216
    s_add_u32 s64, s64, 1
    s_and_b32 s64, s64, 15
    s_add_u32 m0, s62, 122880
    s_nop 0
    buffer_load_dwordx4 v6, s[12:15], s91 offen offset:0 lds
    buffer_load_dwordx4 v7, s[12:15], s91 offen offset:1024 lds
    s_add_u32 m0, s62, 131072
    s_nop 0
    buffer_load_dwordx4 v8, s[12:15], s91 offen offset:0 lds
    buffer_load_dwordx4 v9, s[12:15], s91 offen offset:1024 lds
L_walk_4:
    s_cbranch_execz L_walk_8
    s_waitcnt vmcnt(18)
    s_barrier
    s_add_u32 m0, s62, 139264
    s_nop 0
    buffer_load_dwordx4 v10, s[12:15], s91 offen offset:0 lds
    buffer_load_dwordx4 v11, s[12:15], s91 offen offset:1024 lds
    s_add_u32 m0, s53, 0
    s_lshl_b32 s70, s64, 7
    s_add_u32 s70, s70, s63
    buffer_load_dwordx4 v2, s[8:11], s70 offen offset:0 lds
    buffer_load_dwordx4 v3, s[8:11], s70 offen offset:1024 lds
    buffer_load_dwordx4 v4, s[8:11], s70 offen offset:2048 lds
    buffer_load_dwordx4 v5, s[8:11], s70 offen offset:3072 lds
    s_mul_i32 s91, s64, 393216
    s_add_u32 s64, s64, 1
    s_and_b32 s64, s64, 15
    s_add_u32 m0, s62, 0
    s_nop 0
    buffer_load_dwordx4 v6, s[12:15], s91 offen offset:0 lds
    buffer_load_dwordx4 v7, s[12:15], s91 offen offset:1024 lds
    s_add_u32 m0, s62, 8192
    s_nop 0
    buffer_load_dwordx4 v8, s[12:15], s91 offen offset:0 lds
    buffer_load_dwordx4 v9, s[12:15], s91 offen offset:1024 lds
    s_add_u32 m0, s62, 16384
    s_nop 0
    buffer_load_dwordx4 v10, s[12:15], s91 offen offset:0 lds
    buffer_load_dwordx4 v11, s[12:15], s91 offen offset:1024 lds
    s_waitcnt vmcnt(20)
    s_barrier
    v_mov_b32 v118, 0
    buffer_atomic_or v118, v117, s[16:19], 0 offen sc0 sc1
    s_add_u32 m0, s89, 40960
    s_mov_b32 s90, 655360
    buffer_load_dwordx4 v12, s[20:23], s90 offen lds
    s_add_u32 m0, s89, 45056
    s_mov_b32 s90, 720896
    buffer_load_dwordx4 v12, s[20:23], s90 offen lds
    s_add_u32 m0, s89, 49152
    s_mov_b32 s90, 786432
    buffer_load_dwordx4 v12, s[20:23], s90 offen lds
    s_add_u32 m0, s89, 53248
    s_mov_b32 s90, 851968
    buffer_load_dwordx4 v12, s[20:23], s90 offen lds
    s_mov_b32 s90, 0
    buffer_load_dwordx4 v[164:167], v30, s[32:35], s90 offen
    s_mov_b32 s90, 7168
    buffer_load_dwordx4 v[168:171], v30, s[32:35], s90 offen
    s_mov_b32 s90, 14336
    buffer_load_dwordx4 v[172:175], v30, s[32:35], s90 offen
    s_mov_b32 s90, 21504
    buffer_load_dwordx4 v[176:179], v30, s[32:35], s90 offen
    s_waitcnt vmcnt(19)
    s_barrier
    s_waitcnt vmcnt(8)
    s_branch L_h0_chk0
L_h0_spin:
    v_mov_b32 v118, 0
    buffer_atomic_or v118, v117, s[16:19], 0 offen sc0 sc1
    s_waitcnt vmcnt(0)
L_h0_chk0:
    v_cmp_ne_u32 vcc, s68, v118
    s_nop 0
    s_and_b64 vcc, vcc, s[76:77]
    s_cbranch_vccz L_ok_1
    s_sub_u32 s56, s56, 1
    s_cbranch_scc0 L_h0_spin
    s_mov_b32 s56, 0
L_ok_1:
    s_mov_b32 s90, 0
    buffer_load_dwordx4 v[40:43], v32, s[16:19], s90 offen sc1
    s_mov_b32 s90, 3072
    buffer_load_dwordx4 v[44:47], v32, s[16:19], s90 offen sc1
    s_mov_b32 s90, 6144
    buffer_load_dwordx4 v[48:51], v32, s[16:19], s90 offen sc1
    s_mov_b32 s90, 9216
    buffer_load_dwordx4 v[52:55], v32, s[16:19], s90 offen sc1
    buffer_load_dwordx4 v[56:59], v33, s[16:19], 0 offen sc1
    buffer_load_dwordx4 v[60:63], v33, s[16:19], s92 offen sc1
    buffer_load_dwordx4 v[64:67], v33, s[16:19], s93 offen sc1
    buffer_load_dwordx4 v[68:71], v33, s[16:19], s94 offen sc1
    s_mov_b32 s90, 28672
    buffer_load_dwordx4 v[180:183], v30, s[32:35], s90 offen
    s_mov_b32 s90, 35840
    buffer_load_dwordx4 v[184:187], v30, s[32:35], s90 offen
    s_mov_b32 s90, 43008
    buffer_load_dwordx4 v[188:191], v30, s[32:35], s90 offen
    s_waitcnt vmcnt(20)
    s_barrier
    v_mov_b32 v24, 135168
    v_lshl_add_u32 v24, v21, 2, v24
    v_mov_b32 v25, 0
    ds_write_b32 v24, v25
    s_add_u32 m0, s89, 57344
    s_mov_b32 s90, 917504
    buffer_load_dwordx4 v12, s[20:23], s90 offen lds
    s_add_u32 m0, s89, 61440
    s_mov_b32 s90, 983040
    buffer_load_dwordx4 v12, s[20:23], s90 offen lds
    s_add_u32 m0, s89, 65536
    s_mov_b32 s90, 1048576
    buffer_load_dwordx4 v12, s[20:23], s90 offen lds
    s_add_u32 m0, s89, 69632
    s_mov_b32 s90, 1114112
    buffer_load_dwordx4 v12, s[20:23], s90 offen lds
    s_add_u32 m0, s89, 73728
    s_mov_b32 s90, 1179648
    buffer_load_dwordx4 v12, s[20:23], s90 offen lds
    s_add_u32 m0, s89, 77824
    s_mov_b32 s90, 1245184
    buffer_load_dwordx4 v12, s[20:23], s90 offen lds
    s_waitcnt vmcnt(9)
    v_add_f32 v40, v40, v44
    v_add_f32 v41, v41, v45
    v_add_f32 v42, v42, v46
    v_add_f32 v43, v43, v47
    v_add_f32 v40, v40, v48
    v_add_f32 v41, v41, v49
    v_add_f32 v42, v42, v50
    v_add_f32 v43, v43, v51
    v_add_f32 v40, v40, v52
    v_add_f32 v41, v41, v53
    v_add_f32 v42, v42, v54
    v_add_f32 v43, v43, v55
    v_add_f32 v56, v56, v60
    v_add_f32 v57, v57, v61
    v_add_f32 v58, v58, v62
    v_add_f32 v59, v59, v63
    v_add_f32 v56, v56, v64
    v_add_f32 v57, v57, v65
    v_add_f32 v58, v58, v66
    v_add_f32 v59, v59, v67
    v_add_f32 v56, v56, v68
    v_add_f32 v57, v57, v69
    v_add_f32 v58, v58, v70
    v_add_f32 v59, v59, v71
    s_nop 0
    v_permlane32_swap_b32 v56, v58
    v_permlane32_swap_b32 v57, v59
    v_permlane32_swap_b32 v40, v42
    v_permlane32_swap_b32 v41, v43
    v_add_f32 v56, v56, v58
    v_add_f32 v57, v57, v59
    v_add_f32 v40, v40, v42
    v_add_f32 v41, v41, v43
    v_mov_b32 v58, v56
    v_mov_b32 v59, v57
    v_permlane16_swap_b32 v40, v41
    v_permlane16_swap_b32 v56, v58
    v_permlane16_swap_b32 v57, v59
    v_add_f32 v40, v40, v41
    v_add_f32 v56, v56, v58
    v_add_f32 v57, v57, v59
    ds_write_b32 v17, v40
    v_mul_f32 v56, 0x3a800000, v56
    v_mul_f32 v57, 0x3a800000, v57
    v_fma_f32 v57, -v56, v56, v57
    v_max_f32 v57, 0, v57
    v_cvt_pk_bf16_f32 v48, v56, v57
    v_lshlrev_b32 v44, 16, v48
    v_and_b32 v48, 0xffff0000, v48
    v_add_f32 v48, 0x3727c5ac, v48
    v_cvt_pk_bf16_f32 v48, v48, v48
    v_lshlrev_b32 v48, 16, v48
    v_sqrt_f32 v48, v48
    s_nop 0
    v_cvt_pk_bf16_f32 v48, v48, v48
    v_lshlrev_b32 v48, 16, v48
    v_rcp_f32 v46, v48
    v_sub_f32 v44, 0, v44
    v_mul_f32 v48, 0x3fb8aa3b, v46
    ds_write_b32 v16, v44
    ds_write_b32 v16, v46 offset:512
    ds_write_b32 v16, v48 offset:1024
    s_waitcnt lgkmcnt(0)
    s_barrier
    s_setprio 0
    s_add_u32 m0, s89, 81920
    s_mov_b32 s90, 1310720
    buffer_load_dwordx4 v12, s[20:23], s90 offen lds
    s_add_u32 m0, s89, 86016
L_walk_5:
    s_cbranch_execz L_walk_12
    s_mov_b32 s90, 1376256
    buffer_load_dwordx4 v12, s[20:23], s90 offen lds
    s_add_u32 m0, s89, 90112
    s_mov_b32 s90, 1441792
    buffer_load_dwordx4 v12, s[20:23], s90 offen lds
    s_add_u32 m0, s89, 94208
    s_mov_b32 s90, 1507328
    buffer_load_dwordx4 v12, s[20:23], s90 offen lds
    s_add_u32 m0, s89, 98304
    s_mov_b32 s90, 1572864
    buffer_load_dwordx4 v12, s[20:23], s90 offen lds
    s_add_u32 m0, s89, 102400
    s_mov_b32 s90, 1638400
    buffer_load_dwordx4 v12, s[20:23], s90 offen lds
    s_add_u32 m0, s89, 106496
    s_mov_b32 s90, 1703936
    buffer_load_dwordx4 v12, s[20:23], s90 offen lds
    s_add_u32 m0, s89, 110592
    s_mov_b32 s90, 1769472
    buffer_load_dwordx4 v12, s[20:23], s90 offen lds
    s_add_u32 m0, s89, 114688
    s_mov_b32 s90, 1835008
    buffer_load_dwordx4 v12, s[20:23], s90 offen lds
    s_add_u32 m0, s89, 118784
    s_mov_b32 s90, 1900544
    buffer_load_dwordx4 v12, s[20:23], s90 offen lds
    s_add_u32 m0, s89, 122880
    s_mov_b32 s90, 1966080
    buffer_load_dwordx4 v12, s[20:23], s90 offen lds
    s_add_u32 m0, s89, 126976
    s_mov_b32 s90, 2031616
    buffer_load_dwordx4 v12, s[20:23], s90 offen lds
    s_add_u32 m0, s89, 0
    s_mov_b32 s90, 0
    buffer_load_dwordx4 v12, s[20:23], s90 offen lds
    s_add_u32 m0, s89, 4096
    s_mov_b32 s90, 65536
    buffer_load_dwordx4 v12, s[20:23], s90 offen lds
    s_add_u32 m0, s89, 8192
    s_mov_b32 s90, 131072
    buffer_load_dwordx4 v12, s[20:23], s90 offen lds
    s_add_u32 m0, s89, 12288
    s_mov_b32 s90, 196608
    buffer_load_dwordx4 v12, s[20:23], s90 offen lds
    s_add_u32 m0, s89, 16384
    s_mov_b32 s90, 262144
    buffer_load_dwordx4 v12, s[20:23], s90 offen lds
    s_add_u32 m0, s89, 20480
    s_mov_b32 s90, 327680
    buffer_load_dwordx4 v12, s[20:23], s90 offen lds
    s_add_u32 m0, s89, 24576
    s_mov_b32 s90, 393216
    buffer_load_dwordx4 v12, s[20:23], s90 offen lds
    s_add_u32 m0, s89, 28672
    s_mov_b32 s90, 458752
    buffer_load_dwordx4 v12, s[20:23], s90 offen lds
    s_add_u32 m0, s89, 32768
    s_mov_b32 s90, 524288
    buffer_load_dwordx4 v12, s[20:23], s90 offen lds
    s_add_u32 m0, s89, 36864
    s_mov_b32 s90, 589824
    buffer_load_dwordx4 v12, s[20:23], s90 offen lds
    s_lshl_b32 s86, s47, 2
    s_add_u32 s86, s86, s48
    s_lshl_b32 s87, s86, 7
    s_add_u32 s87, s87, 671744
    v_lshl_add_u32 v6, v0, 2, s87
    v_mov_b32 v4, 2147483648
    v_cmp_gt_u32 vcc, 16, v0
    s_nop 1
    v_cndmask_b32 v6, v4, v6, vcc
    s_lshl_b32 s86, s86, 14
    s_add_u32 s86, s86, 5242880
    v_lshl_add_u32 v2, v0, 4, s86
    s_lshl_b32 s86, s47, 1
    s_add_u32 s86, s86, s50
    s_lshl_b32 s86, s86, 11
    s_lshl_b32 s87, s49, 6
    s_add_u32 s86, s86, s87
    s_add_u32 s86, s86, 6881280
    v_lshl_add_u32 v3, v23, 7, s86
    v_lshl_add_u32 v3, v22, 4, v3
    v_mov_b32 v112, 0
    v_mov_b32 v113, 0
    v_mov_b32 v114, 0
    v_mov_b32 v115, 0
    v_mov_b32 v116, 0
    v_mov_b32 v117, 0
    v_mov_b32 v118, 0
    v_mov_b32 v119, 0
    s_lshr_b32 s62, s3, 2
    s_lshl_b32 s53, s51, 3
    s_lshl_b32 s86, s48, 1
    s_add_u32 s53, s53, s86
    s_add_u32 s53, s53, s62
    v_lshrrev_b32 v36, 4, v0
    v_and_b32 v37, 15, v0
    s_lshl_b32 s87, s53, 15
    s_lshl_b32 s86, s62, 14
    s_add_u32 s86, s86, s87
    s_add_u32 s86, s86, 1048576
    v_lshl_add_u32 v157, v0, 4, s86
    v_xor_b32 v158, 0x8000, v157
    s_lshl_b32 s86, s51, 1
    s_lshr_b32 s87, s48, 1
    s_add_u32 s86, s86, s87
    s_lshl_b32 s86, s86, 1
    s_add_u32 s86, s86, s62
    s_lshl_b32 s86, s86, 1
    s_and_b32 s87, s48, 1
    s_add_u32 s86, s86, s87
    s_lshl_b32 s86, s86, 7
    s_add_u32 s86, s86, 688128
    v_lshl_add_u32 v159, v0, 2, s86
    v_mov_b32 v38, 2147483648
    v_cmp_gt_u32 vcc, 16, v0
    s_nop 1
    v_cndmask_b32 v159, v38, v159, vcc
    v_bfe_u32 v38, v0, 2, 2
    v_lshl_add_u32 v38, v36, 2, v38
    v_bfe_u32 v39, v38, 1, 2
    v_lshlrev_b32 v38, 7, v38
    v_lshl_add_u32 v38, v39, 5, v38
    v_and_b32 v39, 3, v0
    v_lshl_add_u32 v38, v39, 3, v38
    s_lshl_b32 s86, s62, 16
    s_add_u32 s86, s86, 0
    v_add_u32 v144, s86, v38
    v_xor_b32 v145, 32, v144
    v_xor_b32 v146, 64, v144
    v_xor_b32 v147, 96, v144
    v_cmp_eq_u32 s[4:5], 1, v39
    v_cmp_eq_u32 s[6:7], 2, v39
    v_cmp_eq_u32 s[98:99], 3, v39
    s_lshl_b32 s86, s53, 10
    s_add_u32 s86, s86, 786432
    v_lshl_add_u32 v160, v0, 2, s86
    v_mul_u32_u24 v161, 192, v36
    v_add_u32 v160, v160, v161
    s_mov_b32 s72, 0x00f0000f
    s_mov_b32 s73, 0xf0000f00
    s_mov_b32 s74, 0x0f00f000
    s_mov_b32 s75, 0x0f00f000
    v_lshrrev_b32 v38, 2, v37
    v_lshl_add_u32 v161, v38, 4, v37
    v_lshlrev_b32 v161, 2, v161
    s_lshl_b32 s86, s3, 12
    s_add_u32 s86, s86, 131072
    v_lshl_add_u32 v162, v0, 4, s86
    v_xor_b32 v163, 0x4000, v162
    s_lshl_b32 s86, s52, 7
    v_lshl_add_u32 v36, v36, 3, s86
    s_lshl_b32 s87, s53, 15
    s_add_u32 s87, s87, s86
    s_lshl_b32 s86, s62, 6
    s_add_u32 s87, s87, s86
    v_lshl_add_u32 v39, v37, 11, s87
    v_and_b32 v38, 48, v0
    v_add_u32 v39, v39, v38
    v_xor_b32 v37, 0x8000, v39
    v_lshlrev_b32 v38, 4, v0
    buffer_load_dwordx2 v[148:149], v36, s[40:43], 0 offen offset:0
    buffer_load_dwordx2 v[150:151], v36, s[40:43], 0 offen offset:32
    buffer_load_dwordx2 v[152:153], v36, s[40:43], 0 offen offset:64
    buffer_load_dwordx2 v[154:155], v36, s[40:43], 0 offen offset:96
    buffer_load_dwordx4 v[128:131], v38, s[40:43], 0 offen
    buffer_load_dwordx4 v[132:135], v38, s[40:43], 0 offen offset:1024
    buffer_load_dwordx4 v[136:139], v39, s[8:11], 0 offen
    buffer_load_dwordx4 v[140:143], v37, s[8:11], 0 offen
    s_mov_b32 s90, 50176
    buffer_load_dwordx4 v[192:195], v30, s[32:35], s90 offen
    s_mov_b32 s90, 57344
    buffer_load_dwordx4 v[196:199], v30, s[32:35], s90 offen
    s_mov_b32 s90, 64512
    buffer_load_dwordx4 v[200:203], v30, s[32:35], s90 offen
L_walk_6:
    s_cbranch_execz L_walk_13
    s_waitcnt vmcnt(5)
    v_mov_b32 v4, 0
    buffer_atomic_or v4, v6, s[16:19], 0 offen sc0 sc1
    v_bfe_u32 v36, v0, 2, 1
    v_cmp_eq_u32 vcc, 1, v36
    v_mov_b32 v36, s95
    v_mov_b32 v38, 0
    v_dot2c_f32_bf16 v38, s95, v128
    v_dot2c_f32_bf16 v38, s95, v129
    v_dot2c_f32_bf16 v38, s95, v130
    v_dot2c_f32_bf16 v38, s95, v131
    v_dot2c_f32_bf16 v38, s95, v132
    v_dot2c_f32_bf16 v38, s95, v133
    v_dot2c_f32_bf16 v38, s95, v134
    v_dot2c_f32_bf16 v38, s95, v135
    v_cndmask_b32 v148, v36, v148, vcc
    v_cndmask_b32 v149, v36, v149, vcc
    v_cndmask_b32 v150, v36, v150, vcc
    v_cndmask_b32 v151, v36, v151, vcc
    v_cndmask_b32 v152, v36, v152, vcc
    v_cndmask_b32 v153, v36, v153, vcc
    v_cndmask_b32 v154, v36, v154, vcc
    v_cndmask_b32 v155, v36, v155, vcc
    v_add_f32_dpp v38, v38, v38 row_ror:8 row_mask:0xf bank_mask:0xf
    s_nop 1
    v_add_f32_dpp v38, v38, v38 row_ror:4 row_mask:0xf bank_mask:0xf
    s_nop 1
    v_add_f32_dpp v38, v38, v38 row_ror:2 row_mask:0xf bank_mask:0xf
    s_nop 1
    v_add_f32_dpp v38, v38, v38 row_ror:1 row_mask:0xf bank_mask:0xf
    v_mov_b32 v36, v38
    s_nop 1
    v_permlane32_swap_b32 v38, v36
    v_add_f32 v38, v38, v36
    v_mov_b32 v36, v38
    s_nop 1
    v_permlane16_swap_b32 v38, v36
    v_add_f32 v38, v38, v36
    v_mov_b32 v36, 135200
    v_readfirstlane_b32 s57, v38
    ds_write_b32 v36, v38
    s_mul_i32 s86, s50, 3072
    s_add_u32 s86, s86, 151552
    v_lshl_add_u32 v7, v0, 4, s86
    s_lshl_b32 s86, s49, 10
    v_add_u32 v5, s86, v7
    s_lshl_b32 s86, s49, 3
    v_add_u32 v7, s86, v7
    s_mov_b32 s88, 0xffff0000
    s_mov_b32 s86, 0x00003f80
    s_mov_b32 s87, 0x3f800000
    s_branch L_h1_w0
L_h1_r0:
    s_ff1_i32_b32 s66, s65
    s_bitset0_b32 s65, s66
    s_lshl_b32 s66, s66, 10
    buffer_load_dwordx4 v[40:43], v2, s[16:19], s66 offen sc1
    s_cmp_eq_u32 s65, 0
    s_cbranch_scc1 L_h1_p1
L_h1_r1:
    s_ff1_i32_b32 s66, s65
    s_bitset0_b32 s65, s66
    s_lshl_b32 s66, s66, 10
    buffer_load_dwordx4 v[44:47], v2, s[16:19], s66 offen sc1
    s_cmp_eq_u32 s65, 0
    s_cbranch_scc1 L_h1_p2
L_h1_r2:
    s_ff1_i32_b32 s66, s65
    s_bitset0_b32 s65, s66
    s_lshl_b32 s66, s66, 10
    buffer_load_dwordx4 v[48:51], v2, s[16:19], s66 offen sc1
    s_cmp_eq_u32 s65, 0
    s_cbranch_scc1 L_h1_p3
L_h1_r3:
    s_ff1_i32_b32 s66, s65
    s_bitset0_b32 s65, s66
    s_lshl_b32 s66, s66, 10
    buffer_load_dwordx4 v[52:55], v2, s[16:19], s66 offen sc1
    s_cmp_eq_u32 s65, 0
    s_cbranch_scc1 L_h1_p4
L_h1_r4:
    s_ff1_i32_b32 s66, s65
    s_bitset0_b32 s65, s66
    s_lshl_b32 s66, s66, 10
    buffer_load_dwordx4 v[56:59], v2, s[16:19], s66 offen sc1
    s_cmp_eq_u32 s65, 0
    s_cbranch_scc1 L_h1_p5
L_h1_r5:
    s_ff1_i32_b32 s66, s65
    s_bitset0_b32 s65, s66
    s_lshl_b32 s66, s66, 10
    buffer_load_dwordx4 v[60:63], v2, s[16:19], s66 offen sc1
    s_cmp_eq_u32 s65, 0
    s_cbranch_scc1 L_h1_p6
L_h1_r6:
    s_ff1_i32_b32 s66, s65
    s_bitset0_b32 s65, s66
    s_lshl_b32 s66, s66, 10
    buffer_load_dwordx4 v[64:67], v2, s[16:19], s66 offen sc1
    s_cmp_eq_u32 s65, 0
    s_cbranch_scc1 L_h1_p7
L_h1_r7:
    s_ff1_i32_b32 s66, s65
    s_bitset0_b32 s65, s66
    s_lshl_b32 s66, s66, 10
    buffer_load_dwordx4 v[68:71], v2, s[16:19], s66 offen sc1
    s_cmp_eq_u32 s65, 0
    s_cbranch_scc1 L_h1_p8
L_h1_r8:
    s_ff1_i32_b32 s66, s65
    s_bitset0_b32 s65, s66
    s_lshl_b32 s66, s66, 10
    buffer_load_dwordx4 v[72:75], v2, s[16:19], s66 offen sc1
    s_cmp_eq_u32 s65, 0
    s_cbranch_scc1 L_h1_p9
L_h1_r9:
    s_ff1_i32_b32 s66, s65
    s_bitset0_b32 s65, s66
    s_lshl_b32 s66, s66, 10
    buffer_load_dwordx4 v[76:79], v2, s[16:19], s66 offen sc1
    s_cmp_eq_u32 s65, 0
    s_cbranch_scc1 L_h1_p10
L_h1_r10:
    s_ff1_i32_b32 s66, s65
    s_bitset0_b32 s65, s66
    s_lshl_b32 s66, s66, 10
    buffer_load_dwordx4 v[80:83], v2, s[16:19], s66 offen sc1
    s_cmp_eq_u32 s65, 0
    s_cbranch_scc1 L_h1_p11
L_h1_r11:
    s_ff1_i32_b32 s66, s65
    s_bitset0_b32 s65, s66
    s_lshl_b32 s66, s66, 10
    buffer_load_dwordx4 v[84:87], v2, s[16:19], s66 offen sc1
    s_cmp_eq_u32 s65, 0
    s_cbranch_scc1 L_h1_p12
L_h1_r12:
    s_ff1_i32_b32 s66, s65
    s_bitset0_b32 s65, s66
    s_lshl_b32 s66, s66, 10
    buffer_load_dwordx4 v[88:91], v2, s[16:19], s66 offen sc1
    s_cmp_eq_u32 s65, 0
    s_cbranch_scc1 L_h1_p13
L_h1_r13:
    s_ff1_i32_b32 s66, s65
    s_bitset0_b32 s65, s66
    s_lshl_b32 s66, s66, 10
    buffer_load_dwordx4 v[92:95], v2, s[16:19], s66 offen sc1
    s_cmp_eq_u32 s65, 0
    s_cbranch_scc1 L_h1_p14
L_h1_r14:
    s_ff1_i32_b32 s66, s65
    s_bitset0_b32 s65, s66
    s_lshl_b32 s66, s66, 10
    buffer_load_dwordx4 v[96:99], v2, s[16:19], s66 offen sc1
    s_cmp_eq_u32 s65, 0
    s_cbranch_scc1 L_h1_p15
L_h1_r15:
    s_ff1_i32_b32 s66, s65
    s_bitset0_b32 s65, s66
    s_lshl_b32 s66, s66, 10
    buffer_load_dwordx4 v[100:103], v2, s[16:19], s66 offen sc1
    buffer_load_dwordx4 v[104:107], v3, s[16:19], 0 offen sc1
L_h1_acc:
    s_waitcnt vmcnt(16)
    v_dot2c_f32_bf16 v112, s86, v40
    v_dot2c_f32_bf16 v113, s87, v40
    v_dot2c_f32_bf16 v114, s86, v41
    v_dot2c_f32_bf16 v115, s87, v41
    v_dot2c_f32_bf16 v116, s86, v42
    v_dot2c_f32_bf16 v117, s87, v42
    v_dot2c_f32_bf16 v118, s86, v43
    v_dot2c_f32_bf16 v119, s87, v43
    s_waitcnt vmcnt(15)
    v_dot2c_f32_bf16 v112, s86, v44
    v_dot2c_f32_bf16 v113, s87, v44
    v_dot2c_f32_bf16 v114, s86, v45
    v_dot2c_f32_bf16 v115, s87, v45
    v_dot2c_f32_bf16 v116, s86, v46
    v_dot2c_f32_bf16 v117, s87, v46
    v_dot2c_f32_bf16 v118, s86, v47
    v_dot2c_f32_bf16 v119, s87, v47
    s_waitcnt vmcnt(14)
    v_dot2c_f32_bf16 v112, s86, v48
    v_dot2c_f32_bf16 v113, s87, v48
    v_dot2c_f32_bf16 v114, s86, v49
    v_dot2c_f32_bf16 v115, s87, v49
    v_dot2c_f32_bf16 v116, s86, v50
    v_dot2c_f32_bf16 v117, s87, v50
    v_dot2c_f32_bf16 v118, s86, v51
    v_dot2c_f32_bf16 v119, s87, v51
    v_max3_u32 v4, v43, v47, v51
    s_waitcnt vmcnt(13)
    v_dot2c_f32_bf16 v112, s86, v52
    v_dot2c_f32_bf16 v113, s87, v52
    v_dot2c_f32_bf16 v114, s86, v53
    v_dot2c_f32_bf16 v115, s87, v53
    v_dot2c_f32_bf16 v116, s86, v54
    v_dot2c_f32_bf16 v117, s87, v54
    v_dot2c_f32_bf16 v118, s86, v55
    v_dot2c_f32_bf16 v119, s87, v55
    s_waitcnt vmcnt(12)
    v_dot2c_f32_bf16 v112, s86, v56
    v_dot2c_f32_bf16 v113, s87, v56
    v_dot2c_f32_bf16 v114, s86, v57
    v_dot2c_f32_bf16 v115, s87, v57
    v_dot2c_f32_bf16 v116, s86, v58
    v_dot2c_f32_bf16 v117, s87, v58
    v_dot2c_f32_bf16 v118, s86, v59
    v_dot2c_f32_bf16 v119, s87, v59
    v_max3_u32 v4, v4, v55, v59
    s_waitcnt vmcnt(11)
    v_dot2c_f32_bf16 v112, s86, v60
    v_dot2c_f32_bf16 v113, s87, v60
    v_dot2c_f32_bf16 v114, s86, v61
    v_dot2c_f32_bf16 v115, s87, v61
    v_dot2c_f32_bf16 v116, s86, v62
    v_dot2c_f32_bf16 v117, s87, v62
    v_dot2c_f32_bf16 v118, s86, v63
    v_dot2c_f32_bf16 v119, s87, v63
    s_waitcnt vmcnt(10)
    v_dot2c_f32_bf16 v112, s86, v64
    v_dot2c_f32_bf16 v113, s87, v64
    v_dot2c_f32_bf16 v114, s86, v65
    v_dot2c_f32_bf16 v115, s87, v65
    v_dot2c_f32_bf16 v116, s86, v66
    v_dot2c_f32_bf16 v117, s87, v66
    v_dot2c_f32_bf16 v118, s86, v67
    v_dot2c_f32_bf16 v119, s87, v67
    v_max3_u32 v4, v4, v63, v67
    s_waitcnt vmcnt(9)
    v_dot2c_f32_bf16 v112, s86, v68
    v_dot2c_f32_bf16 v113, s87, v68
    v_dot2c_f32_bf16 v114, s86, v69
    v_dot2c_f32_bf16 v115, s87, v69
    v_dot2c_f32_bf16 v116, s86, v70
    v_dot2c_f32_bf16 v117, s87, v70
    v_dot2c_f32_bf16 v118, s86, v71
    v_dot2c_f32_bf16 v119, s87, v71
    s_waitcnt vmcnt(8)
    v_dot2c_f32_bf16 v112, s86, v72
    v_dot2c_f32_bf16 v113, s87, v72
    v_dot2c_f32_bf16 v114, s86, v73
    v_dot2c_f32_bf16 v115, s87, v73
    v_dot2c_f32_bf16 v116, s86, v74
    v_dot2c_f32_bf16 v117, s87, v74
    v_dot2c_f32_bf16 v118, s86, v75
    v_dot2c_f32_bf16 v119, s87, v75
    v_max3_u32 v4, v4, v71, v75
L_walk_7:
    s_cbranch_execz L_walk_14
    s_waitcnt vmcnt(7)
    v_dot2c_f32_bf16 v112, s86, v76
    v_dot2c_f32_bf16 v113, s87, v76
    v_dot2c_f32_bf16 v114, s86, v77
    v_dot2c_f32_bf16 v115, s87, v77
    v_dot2c_f32_bf16 v116, s86, v78
    v_dot2c_f32_bf16 v117, s87, v78
    v_dot2c_f32_bf16 v118, s86, v79
    v_dot2c_f32_bf16 v119, s87, v79
    s_waitcnt vmcnt(6)
    v_dot2c_f32_bf16 v112, s86, v80
    v_dot2c_f32_bf16 v113, s87, v80
    v_dot2c_f32_bf16 v114, s86, v81
    v_dot2c_f32_bf16 v115, s87, v81
    v_dot2c_f32_bf16 v116, s86, v82
    v_dot2c_f32_bf16 v117, s87, v82
    v_dot2c_f32_bf16 v118, s86, v83
    v_dot2c_f32_bf16 v119, s87, v83
    v_max3_u32 v4, v4, v79, v83
    s_waitcnt vmcnt(5)
    v_dot2c_f32_bf16 v112, s86, v84
    v_dot2c_f32_bf16 v113, s87, v84
    v_dot2c_f32_bf16 v114, s86, v85
    v_dot2c_f32_bf16 v115, s87, v85
    v_dot2c_f32_bf16 v116, s86, v86
    v_dot2c_f32_bf16 v117, s87, v86
    v_dot2c_f32_bf16 v118, s86, v87
    v_dot2c_f32_bf16 v119, s87, v87
    s_waitcnt vmcnt(4)
    v_dot2c_f32_bf16 v112, s86, v88
    v_dot2c_f32_bf16 v113, s87, v88
    v_dot2c_f32_bf16 v114, s86, v89
    v_dot2c_f32_bf16 v115, s87, v89
    v_dot2c_f32_bf16 v116, s86, v90
    v_dot2c_f32_bf16 v117, s87, v90
    v_dot2c_f32_bf16 v118, s86, v91
    v_dot2c_f32_bf16 v119, s87, v91
    v_max3_u32 v4, v4, v87, v91
    s_waitcnt vmcnt(3)
    v_dot2c_f32_bf16 v112, s86, v92
    v_dot2c_f32_bf16 v113, s87, v92
    v_dot2c_f32_bf16 v114, s86, v93
    v_dot2c_f32_bf16 v115, s87, v93
    v_dot2c_f32_bf16 v116, s86, v94
    v_dot2c_f32_bf16 v117, s87, v94
    v_dot2c_f32_bf16 v118, s86, v95
    v_dot2c_f32_bf16 v119, s87, v95
    s_waitcnt vmcnt(2)
    v_dot2c_f32_bf16 v112, s86, v96
    v_dot2c_f32_bf16 v113, s87, v96
    v_dot2c_f32_bf16 v114, s86, v97
    v_dot2c_f32_bf16 v115, s87, v97
    v_dot2c_f32_bf16 v116, s86, v98
    v_dot2c_f32_bf16 v117, s87, v98
    v_dot2c_f32_bf16 v118, s86, v99
    v_dot2c_f32_bf16 v119, s87, v99
    v_max3_u32 v4, v4, v95, v99
    s_waitcnt vmcnt(1)
    v_dot2c_f32_bf16 v112, s86, v100
    v_dot2c_f32_bf16 v113, s87, v100
    v_dot2c_f32_bf16 v114, s86, v101
    v_dot2c_f32_bf16 v115, s87, v101
    v_dot2c_f32_bf16 v116, s86, v102
    v_dot2c_f32_bf16 v117, s87, v102
    v_dot2c_f32_bf16 v118, s86, v103
    v_dot2c_f32_bf16 v119, s87, v103
    s_waitcnt vmcnt(0)
    v_max3_u32 v4, v4, v103, v107
    v_add_f32_dpp v104, v104, v104 row_ror:8 row_mask:0xf bank_mask:0xf
    v_add_f32_dpp v105, v105, v105 row_ror:8 row_mask:0xf bank_mask:0xf
    v_add_f32_dpp v106, v106, v106 row_ror:8 row_mask:0xf bank_mask:0xf
    v_add_f32_dpp v107, v107, v107 row_ror:8 row_mask:0xf bank_mask:0xf
    v_cvt_pk_bf16_f32 v120, v112, v113
    v_cvt_pk_bf16_f32 v121, v114, v115
    v_cvt_pk_bf16_f32 v122, v116, v117
    v_cvt_pk_bf16_f32 v123, v118, v119
    ds_write_b128 v5, v[120:123]
    v_add_f32_dpp v104, v104, v104 row_ror:4 row_mask:0xf bank_mask:0xf
    v_add_f32_dpp v105, v105, v105 row_ror:4 row_mask:0xf bank_mask:0xf
    v_add_f32_dpp v106, v106, v106 row_ror:4 row_mask:0xf bank_mask:0xf
    v_add_f32_dpp v107, v107, v107 row_ror:4 row_mask:0xf bank_mask:0xf
    v_add_f32_dpp v104, v104, v104 row_ror:2 row_mask:0xf bank_mask:0xf
    v_add_f32_dpp v105, v105, v105 row_ror:2 row_mask:0xf bank_mask:0xf
    v_add_f32_dpp v106, v106, v106 row_ror:2 row_mask:0xf bank_mask:0xf
    v_add_f32_dpp v107, v107, v107 row_ror:2 row_mask:0xf bank_mask:0xf
    v_add_f32_dpp v104, v104, v104 row_ror:1 row_mask:0xf bank_mask:0xf
    v_add_f32_dpp v105, v105, v105 row_ror:1 row_mask:0xf bank_mask:0xf
    v_add_f32_dpp v106, v106, v106 row_ror:1 row_mask:0xf bank_mask:0xf
    v_add_f32_dpp v107, v107, v107 row_ror:1 row_mask:0xf bank_mask:0xf
    v_cmp_eq_u32 vcc, -1, v4
    v_cvt_pk_bf16_f32 v124, v104, v105
    v_cvt_pk_bf16_f32 v125, v106, v107
    ds_write_b64 v7, v[124:125] offset:2048
    s_cbranch_vccnz L_h1_again
L_h1_done:
    s_waitcnt lgkmcnt(0)
    s_barrier
    s_or_b32 s86, s2, s48
    s_cmp_eq_u32 s86, 0
    s_cselect_b32 s86, 0, 2147483648
    s_add_u32 s86, s86, 524288
    v_mov_b32 v6, s86
    buffer_store_dword v35, v6, s[16:19], 0 offen sc1
    v_mov_b32 v11, v30
    v_mov_b32 v14, v31
    v_mov_b32 v8, 0
    buffer_atomic_or v8, v159, s[16:19], 0 offen sc0 sc1
    s_branch L_phaseB
L_h1_p0:
    v_mov_b32 v4, 0
    buffer_atomic_or v4, v6, s[16:19], 0 offen sc0 sc1
L_h1_w0:
    s_waitcnt vmcnt(0)
    v_cmp_eq_u32 vcc, s68, v4
    s_nop 0
    s_andn2_b32 s65, vcc_lo, s88
    s_or_b32 s88, s88, s65
    s_cmp_lg_u32 s65, 0
    s_cbranch_scc1 L_h1_r0
    s_sub_u32 s56, s56, 1
    s_cbranch_scc0 L_h1_p0
    s_mov_b32 s56, 0
    s_not_b32 s65, s88
    s_branch L_h1_r0
L_h1_p1:
    v_mov_b32 v4, 0
    buffer_atomic_or v4, v6, s[16:19], 0 offen sc0 sc1
    s_waitcnt vmcnt(0)
    v_cmp_eq_u32 vcc, s68, v4
    s_nop 0
    s_andn2_b32 s65, vcc_lo, s88
    s_or_b32 s88, s88, s65
    s_cmp_lg_u32 s65, 0
    s_cbranch_scc1 L_h1_r1
    s_sub_u32 s56, s56, 1
    s_cbranch_scc0 L_h1_p1
    s_mov_b32 s56, 0
    s_not_b32 s65, s88
    s_branch L_h1_r1
L_h1_p2:
    v_mov_b32 v4, 0
    buffer_atomic_or v4, v6, s[16:19], 0 offen sc0 sc1
    s_waitcnt vmcnt(0)
    v_cmp_eq_u32 vcc, s68, v4
    s_nop 0
    s_andn2_b32 s65, vcc_lo, s88
    s_or_b32 s88, s88, s65
    s_cmp_lg_u32 s65, 0
    s_cbranch_scc1 L_h1_r2
    s_sub_u32 s56, s56, 1
    s_cbranch_scc0 L_h1_p2
    s_mov_b32 s56, 0
    s_not_b32 s65, s88
    s_branch L_h1_r2
L_h1_p3:
    v_mov_b32 v4, 0
    buffer_atomic_or v4, v6, s[16:19], 0 offen sc0 sc1
    s_waitcnt vmcnt(0)
    v_cmp_eq_u32 vcc, s68, v4
    s_nop 0
    s_andn2_b32 s65, vcc_lo, s88
    s_or_b32 s88, s88, s65
    s_cmp_lg_u32 s65, 0
    s_cbranch_scc1 L_h1_r3
    s_sub_u32 s56, s56, 1
    s_cbranch_scc0 L_h1_p3
    s_mov_b32 s56, 0
    s_not_b32 s65, s88
    s_branch L_h1_r3
L_h1_p4:
    v_mov_b32 v4, 0
    buffer_atomic_or v4, v6, s[16:19], 0 offen sc0 sc1
    s_waitcnt vmcnt(0)
    v_cmp_eq_u32 vcc, s68, v4
    s_nop 0
    s_andn2_b32 s65, vcc_lo, s88
    s_or_b32 s88, s88, s65
    s_cmp_lg_u32 s65, 0
    s_cbranch_scc1 L_h1_r4
    s_sub_u32 s56, s56, 1
    s_cbranch_scc0 L_h1_p4
    s_mov_b32 s56, 0
    s_not_b32 s65, s88
    s_branch L_h1_r4
L_h1_p5:
    v_mov_b32 v4, 0
    buffer_atomic_or v4, v6, s[16:19], 0 offen sc0 sc1
    s_waitcnt vmcnt(0)
    v_cmp_eq_u32 vcc, s68, v4
    s_nop 0
    s_andn2_b32 s65, vcc_lo, s88
    s_or_b32 s88, s88, s65
    s_cmp_lg_u32 s65, 0
    s_cbranch_scc1 L_h1_r5
    s_sub_u32 s56, s56, 1
    s_cbranch_scc0 L_h1_p5
    s_mov_b32 s56, 0
    s_not_b32 s65, s88
    s_branch L_h1_r5
L_h1_p6:
    v_mov_b32 v4, 0
    buffer_atomic_or v4, v6, s[16:19], 0 offen sc0 sc1
    s_waitcnt vmcnt(0)
    v_cmp_eq_u32 vcc, s68, v4
    s_nop 0
    s_andn2_b32 s65, vcc_lo, s88
    s_or_b32 s88, s88, s65
    s_cmp_lg_u32 s65, 0
    s_cbranch_scc1 L_h1_r6
    s_sub_u32 s56, s56, 1
    s_cbranch_scc0 L_h1_p6
    s_mov_b32 s56, 0
    s_not_b32 s65, s88
    s_branch L_h1_r6
L_h1_p7:
    v_mov_b32 v4, 0
    buffer_atomic_or v4, v6, s[16:19], 0 offen sc0 sc1
    s_waitcnt vmcnt(0)
    v_cmp_eq_u32 vcc, s68, v4
    s_nop 0
    s_andn2_b32 s65, vcc_lo, s88
    s_or_b32 s88, s88, s65
    s_cmp_lg_u32 s65, 0
    s_cbranch_scc1 L_h1_r7
    s_sub_u32 s56, s56, 1
    s_cbranch_scc0 L_h1_p7
    s_mov_b32 s56, 0
    s_not_b32 s65, s88
    s_branch L_h1_r7
L_h1_p8:
    v_mov_b32 v4, 0
    buffer_atomic_or v4, v6, s[16:19], 0 offen sc0 sc1
    s_waitcnt vmcnt(0)
    v_cmp_eq_u32 vcc, s68, v4
    s_nop 0
    s_andn2_b32 s65, vcc_lo, s88
    s_or_b32 s88, s88, s65
    s_cmp_lg_u32 s65, 0
    s_cbranch_scc1 L_h1_r8
    s_sub_u32 s56, s56, 1
    s_cbranch_scc0 L_h1_p8
    s_mov_b32 s56, 0
    s_not_b32 s65, s88
    s_branch L_h1_r8
L_walk_8:
    s_cbranch_execz L_walk_15
L_h1_p9:
    v_mov_b32 v4, 0
    buffer_atomic_or v4, v6, s[16:19], 0 offen sc0 sc1
    s_waitcnt vmcnt(0)
    v_cmp_eq_u32 vcc, s68, v4
    s_nop 0
    s_andn2_b32 s65, vcc_lo, s88
    s_or_b32 s88, s88, s65
    s_cmp_lg_u32 s65, 0
    s_cbranch_scc1 L_h1_r9
    s_sub_u32 s56, s56, 1
    s_cbranch_scc0 L_h1_p9
    s_mov_b32 s56, 0
    s_not_b32 s65, s88
    s_branch L_h1_r9
L_h1_p10:
    v_mov_b32 v4, 0
    buffer_atomic_or v4, v6, s[16:19], 0 offen sc0 sc1
    s_waitcnt vmcnt(0)
    v_cmp_eq_u32 vcc, s68, v4
    s_nop 0
    s_andn2_b32 s65, vcc_lo, s88
    s_or_b32 s88, s88, s65
    s_cmp_lg_u32 s65, 0
    s_cbranch_scc1 L_h1_r10
    s_sub_u32 s56, s56, 1
    s_cbranch_scc0 L_h1_p10
    s_mov_b32 s56, 0
    s_not_b32 s65, s88
    s_branch L_h1_r10
L_h1_p11:
    v_mov_b32 v4, 0
    buffer_atomic_or v4, v6, s[16:19], 0 offen sc0 sc1
    s_waitcnt vmcnt(0)
    v_cmp_eq_u32 vcc, s68, v4
    s_nop 0
    s_andn2_b32 s65, vcc_lo, s88
    s_or_b32 s88, s88, s65
    s_cmp_lg_u32 s65, 0
    s_cbranch_scc1 L_h1_r11
    s_sub_u32 s56, s56, 1
    s_cbranch_scc0 L_h1_p11
    s_mov_b32 s56, 0
    s_not_b32 s65, s88
    s_branch L_h1_r11
L_h1_p12:
    v_mov_b32 v4, 0
    buffer_atomic_or v4, v6, s[16:19], 0 offen sc0 sc1
    s_waitcnt vmcnt(0)
    v_cmp_eq_u32 vcc, s68, v4
    s_nop 0
    s_andn2_b32 s65, vcc_lo, s88
    s_or_b32 s88, s88, s65
    s_cmp_lg_u32 s65, 0
    s_cbranch_scc1 L_h1_r12
    s_sub_u32 s56, s56, 1
    s_cbranch_scc0 L_h1_p12
    s_mov_b32 s56, 0
    s_not_b32 s65, s88
    s_branch L_h1_r12
L_h1_p13:
    v_mov_b32 v4, 0
    buffer_atomic_or v4, v6, s[16:19], 0 offen sc0 sc1
    s_waitcnt vmcnt(0)
    v_cmp_eq_u32 vcc, s68, v4
    s_nop 0
    s_andn2_b32 s65, vcc_lo, s88
    s_or_b32 s88, s88, s65
    s_cmp_lg_u32 s65, 0
    s_cbranch_scc1 L_h1_r13
    s_sub_u32 s56, s56, 1
    s_cbranch_scc0 L_h1_p13
    s_mov_b32 s56, 0
    s_not_b32 s65, s88
    s_branch L_h1_r13
L_h1_p14:
    v_mov_b32 v4, 0
    buffer_atomic_or v4, v6, s[16:19], 0 offen sc0 sc1
    s_waitcnt vmcnt(0)
    v_cmp_eq_u32 vcc, s68, v4
    s_nop 0
    s_andn2_b32 s65, vcc_lo, s88
    s_or_b32 s88, s88, s65
    s_cmp_lg_u32 s65, 0
    s_cbranch_scc1 L_h1_r14
    s_sub_u32 s56, s56, 1
    s_cbranch_scc0 L_h1_p14
    s_mov_b32 s56, 0
    s_not_b32 s65, s88
    s_branch L_h1_r14
L_h1_p15:
    v_mov_b32 v4, 0
    buffer_atomic_or v4, v6, s[16:19], 0 offen sc0 sc1
    s_waitcnt vmcnt(0)
    v_cmp_eq_u32 vcc, s68, v4
    s_nop 0
    s_andn2_b32 s65, vcc_lo, s88
    s_or_b32 s88, s88, s65
    s_cmp_lg_u32 s65, 0
    s_cbranch_scc1 L_h1_r15
    s_sub_u32 s56, s56, 1
    s_cbranch_scc0 L_h1_p15
    s_mov_b32 s56, 0
    s_not_b32 s65, s88
    s_branch L_h1_r15
L_h1_again:
    s_sub_u32 s56, s56, 1
    s_cbranch_scc0 L_h1_re
    s_mov_b32 s56, 0
    s_branch L_h1_done
L_h1_re:
    buffer_load_dwordx4 v[40:43], v2, s[16:19], 0 offen offset:0 sc1
    buffer_load_dwordx4 v[44:47], v2, s[16:19], 0 offen offset:1024 sc1
    buffer_load_dwordx4 v[48:51], v2, s[16:19], 0 offen offset:2048 sc1
    buffer_load_dwordx4 v[52:55], v2, s[16:19], 0 offen offset:3072 sc1
    buffer_load_dwordx4 v[56:59], v2, s[16:19], s92 offen offset:0 sc1
    buffer_load_dwordx4 v[60:63], v2, s[16:19], s92 offen offset:1024 sc1
    buffer_load_dwordx4 v[64:67], v2, s[16:19], s92 offen offset:2048 sc1
    buffer_load_dwordx4 v[68:71], v2, s[16:19], s92 offen offset:3072 sc1
    buffer_load_dwordx4 v[72:75], v2, s[16:19], s93 offen offset:0 sc1
    buffer_load_dwordx4 v[76:79], v2, s[16:19], s93 offen offset:1024 sc1
    buffer_load_dwordx4 v[80:83], v2, s[16:19], s93 offen offset:2048 sc1
    buffer_load_dwordx4 v[84:87], v2, s[16:19], s93 offen offset:3072 sc1
    buffer_load_dwordx4 v[88:91], v2, s[16:19], s94 offen offset:0 sc1
    buffer_load_dwordx4 v[92:95], v2, s[16:19], s94 offen offset:1024 sc1
    buffer_load_dwordx4 v[96:99], v2, s[16:19], s94 offen offset:2048 sc1
    buffer_load_dwordx4 v[100:103], v2, s[16:19], s94 offen offset:3072 sc1
    buffer_load_dwordx4 v[104:107], v3, s[16:19], 0 offen sc1
    v_mov_b32 v112, 0
    v_mov_b32 v113, 0
    v_mov_b32 v114, 0
    v_mov_b32 v115, 0
    v_mov_b32 v116, 0
    v_mov_b32 v117, 0
    v_mov_b32 v118, 0
    v_mov_b32 v119, 0
    s_branch L_h1_acc
L_comp:
    s_mov_b64 exec, -1
    v_and_b32 v20, 15, v0
    v_lshrrev_b32 v21, 4, v0
    v_bfe_u32 v22, v0, 1, 3
    s_lshl_b32 s86, s49, 13
    v_lshl_add_u32 v20, v20, 7, s86
    v_or_b32 v23, 0, v21
    v_xor_b32 v23, v23, v22
    v_lshl_add_u32 v2, v23, 4, v20
    v_or_b32 v23, 4, v21
    v_xor_b32 v23, v23, v22
    v_lshl_add_u32 v3, v23, 4, v20
    v_bfe_u32 v22, v0, 2, 2
    v_lshl_add_u32 v22, v21, 3, v22
    v_lshlrev_b32 v22, 7, v22
    v_bfe_u32 v23, v0, 3, 2
    s_lshl_b32 s86, s50, 1
    v_xor_b32 v23, s86, v23
    v_lshl_add_u32 v22, v23, 5, v22
    v_and_b32 v23, 3, v0
    v_lshl_add_u32 v22, v23, 3, v22
    v_add_u32 v4, 16384, v22
    v_xor_b32 v5, 32, v4
    s_lshl_b32 s53, s2, 2
    s_add_u32 s53, s53, s3
    s_lshl_b32 s86, s53, 12
    s_add_u32 s86, s86, 1048576
    v_lshl_add_u32 v6, v0, 4, s86
    s_mul_i32 s53, s53, 144
    s_add_u32 s53, s53, 6553600
    v_lshl_add_u32 v17, v0, 4, s53
    v_mov_b32 v16, 2147483648
    v_cmp_gt_u32 vcc, 9, v0
    s_nop 1
    v_cndmask_b32 v17, v16, v17, vcc
    s_lshl_b32 s86, s47, 1
    s_add_u32 s86, s86, s50
    s_lshl_b32 s87, s86, 4
    s_add_u32 s87, s87, s46
    s_lshl_b32 s87, s87, 1
    s_add_u32 s87, s87, s49
    s_lshl_b32 s87, s87, 6
    s_add_u32 s87, s87, 6880320
    v_lshl_add_u32 v16, v0, 4, s87
    v_cmp_le_u32 vcc, 60, v0
    s_nop 1
    v_cndmask_b32 v17, v17, v16, vcc
    s_lshl_b32 s87, s86, 1
    s_add_u32 s87, s87, s49
    s_lshl_b32 s87, s87, 4
    s_add_u32 s87, s87, s46
    s_lshl_b32 s87, s87, 10
    s_add_u32 s87, s87, 5242880
    v_lshl_add_u32 v16, v0, 4, s87
    v_mov_b32 v8, -1
    v_mov_b32 v9, -1
    v_mov_b32 v10, -1
    v_mov_b32 v11, -1
    s_waitcnt lgkmcnt(0)
    s_load_dword s61, s[84:85], 524288
    s_mov_b32 s16, s84
    s_and_b32 s17, s85, 0xffff
    s_mov_b32 s18, 268435456
    s_mov_b32 s19, 0x20000
    s_mov_b32 s8, s64
    s_and_b32 s9, s65, 0xffff
    s_mov_b32 s10, 4194304
    s_mov_b32 s11, 0x20000
    s_mov_b32 s20, s68
    s_and_b32 s21, s69, 0xffff
    s_mov_b32 s22, 2097152
    s_mov_b32 s23, 0x20000
    s_mov_b32 s24, s80
    s_and_b32 s25, s81, 0xffff
    s_mov_b32 s26, 4194304
    s_mov_b32 s27, 0x20000
    s_mov_b32 s28, s82
    s_and_b32 s29, s83, 0xffff
    s_mov_b32 s30, 256
    s_mov_b32 s31, 0x20000
    s_bitcmp1_b32 s2, 0
    s_cselect_b32 s32, s76, s74
    s_cselect_b32 s33, s77, s75
    s_and_b32 s33, s33, 0xffff
    s_mov_b32 s34, 7340032
    s_mov_b32 s35, 0x20000
    s_mov_b32 s36, s78
    s_and_b32 s37, s79, 0xffff
    s_mov_b32 s38, 7340032
    s_mov_b32 s39, 0x20000
    s_mov_b32 s40, s72
    s_and_b32 s41, s73, 0xffff
    s_mov_b32 s42, 2048
    s_mov_b32 s43, 0x20000
    s_lshl_b32 s86, s2, 9
    s_add_u32 s86, s86, 786432
    s_cmp_eq_u32 s3, 0
    s_cselect_b32 s86, s86, 2147483648
    v_lshl_add_u32 v7, v0, 2, s86
    v_mul_u32_u24 v12, 192, v21
    v_add_u32 v7, v7, v12
    s_lshl_b32 s86, s2, 8
    s_add_u32 s86, s86, 917376
    s_cmp_eq_u32 s3, 0
    s_cselect_b32 s86, s86, 2147483648
    v_lshl_add_u32 v12, v0, 2, s86
    v_cmp_gt_u32 vcc, 32, v0
    s_nop 1
    v_cndmask_b32 v7, v12, v7, vcc
    v_mov_b32 v12, 2147483648
    v_cmp_gt_u32 vcc, 48, v0
    s_nop 1
    v_cndmask_b32 v7, v12, v7, vcc
    s_lshl_b32 s86, s2, 9
    s_add_u32 s86, s86, 6291456
    v_lshl_add_u32 v13, v0, 2, s86
    v_mul_u32_u24 v12, 64, v21
    v_add_u32 v13, v13, v12
    s_cmp_eq_u32 s3, 1
    s_cselect_b64 vcc, -1, 0
    v_cndmask_b32 v7, v7, v13, vcc
    v_mov_b32 v12, 0
    buffer_store_dword v12, v7, s[16:19], 0 offen sc1
    v_mov_b32 v128, 0
    v_mov_b32 v129, 0
    v_mov_b32 v130, 0
    v_mov_b32 v131, 0
    v_mov_b32 v132, 0
    v_mov_b32 v133, 0
    v_mov_b32 v134, 0
    v_mov_b32 v135, 0
    v_mov_b32 v136, 0
    v_mov_b32 v137, 0
    v_mov_b32 v138, 0
    v_mov_b32 v139, 0
    v_mov_b32 v140, 0
    v_mov_b32 v141, 0
    v_mov_b32 v142, 0
    v_mov_b32 v143, 0
    v_mov_b32 v144, 0
    v_mov_b32 v145, 0
    v_mov_b32 v146, 0
    v_mov_b32 v147, 0
    v_mov_b32 v148, 0
    v_mov_b32 v149, 0
    v_mov_b32 v150, 0
    v_mov_b32 v151, 0
    v_mov_b32 v152, 0
    v_mov_b32 v153, 0
    v_mov_b32 v154, 0
    v_mov_b32 v155, 0
    v_mov_b32 v156, 0
    v_mov_b32 v157, 0
    v_mov_b32 v158, 0
    v_mov_b32 v159, 0
    v_mov_b32 v160, 0
    v_mov_b32 v161, 0
    v_mov_b32 v162, 0
    v_mov_b32 v163, 0
    v_mov_b32 v164, 0
    v_mov_b32 v165, 0
    v_mov_b32 v166, 0
    v_mov_b32 v167, 0
    v_mov_b32 v168, 0
    v_mov_b32 v169, 0
    v_mov_b32 v170, 0
    v_mov_b32 v171, 0
    v_mov_b32 v172, 0
    v_mov_b32 v173, 0
    v_mov_b32 v174, 0
    v_mov_b32 v175, 0
    v_mov_b32 v176, 0
    v_mov_b32 v177, 0
    v_mov_b32 v178, 0
    v_mov_b32 v179, 0
    v_mov_b32 v180, 0
    v_mov_b32 v181, 0
    v_mov_b32 v182, 0
    v_mov_b32 v183, 0
    v_mov_b32 v184, 0
    v_mov_b32 v185, 0
    v_mov_b32 v186, 0
    v_mov_b32 v187, 0
    v_mov_b32 v188, 0
    v_mov_b32 v189, 0
    v_mov_b32 v190, 0
    v_mov_b32 v191, 0
    v_mov_b32 v192, 0
    v_mov_b32 v193, 0
    v_mov_b32 v194, 0
    v_mov_b32 v195, 0
    v_mov_b32 v196, 0
    v_mov_b32 v197, 0
    v_mov_b32 v198, 0
    v_mov_b32 v199, 0
    v_mov_b32 v200, 0
    v_mov_b32 v201, 0
    v_mov_b32 v202, 0
    v_mov_b32 v203, 0
    v_mov_b32 v204, 0
    v_mov_b32 v205, 0
    v_mov_b32 v206, 0
    v_mov_b32 v207, 0
    v_mov_b32 v208, 0
    v_mov_b32 v209, 0
    v_mov_b32 v210, 0
    v_mov_b32 v211, 0
    v_mov_b32 v212, 0
    v_mov_b32 v213, 0
    v_mov_b32 v214, 0
L_walkA2:
    s_cbranch_execz L_comp
    v_mov_b32 v215, 0
    v_mov_b32 v216, 0
    v_mov_b32 v217, 0
    v_mov_b32 v218, 0
    v_mov_b32 v219, 0
    v_mov_b32 v220, 0
    v_mov_b32 v221, 0
    v_mov_b32 v222, 0
    v_mov_b32 v223, 0
    s_mov_b32 s54, 0x358637bd
    s_mov_b32 s55, 0x358637bd
    s_mov_b32 s62, 0
    s_mov_b32 s63, 1
    v_add_u32 v2, 40960, v2
    v_add_u32 v3, 40960, v3
    v_add_u32 v4, 40960, v4
    v_add_u32 v5, 40960, v5
    s_mov_b64 exec, 0
    s_cmp_eq_u32 s3, 0
    s_cbranch_scc1 L_walkB0
    s_cmp_eq_u32 s3, 1
    s_cbranch_scc1 L_walkB1
    s_cmp_eq_u32 s3, 2
    s_cbranch_scc1 L_walkB2
    s_branch L_walkB3
L_walked:
    s_mov_b64 exec, -1
    s_waitcnt lgkmcnt(0)
    s_add_u32 s68, s61, 0x9e3779b9
    s_barrier
    ds_read_b128 v[40:43], v2 offset:0
    ds_read_b128 v[44:47], v2 offset:2048
    ds_read_b128 v[48:51], v2 offset:4096
    ds_read_b128 v[52:55], v2 offset:6144
    ds_read_b64_tr_b16 v[56:57], v4 offset:0
    ds_read_b64_tr_b16 v[58:59], v4 offset:512
    ds_read_b64_tr_b16 v[60:61], v5 offset:0
    ds_read_b64_tr_b16 v[62:63], v5 offset:512
    ds_read_b64_tr_b16 v[64:65], v4 offset:8192
    ds_read_b64_tr_b16 v[66:67], v4 offset:8704
    ds_read_b64_tr_b16 v[68:69], v5 offset:8192
    ds_read_b64_tr_b16 v[70:71], v5 offset:8704
    ds_read_b64_tr_b16 v[72:73], v4 offset:16384
    ds_read_b64_tr_b16 v[74:75], v4 offset:16896
    ds_read_b64_tr_b16 v[76:77], v5 offset:16384
    ds_read_b64_tr_b16 v[78:79], v5 offset:16896
L_cloop:
    s_waitcnt lgkmcnt(0)
    v_mfma_f32_16x16x32_bf16 v[128:131], v[56:59], v[40:43], v[128:131]
    ds_read_b128 v[80:83], v3 offset:0
    v_mfma_f32_16x16x32_bf16 v[132:135], v[56:59], v[44:47], v[132:135]
    ds_read_b128 v[84:87], v3 offset:2048
    v_mfma_f32_16x16x32_bf16 v[136:139], v[56:59], v[48:51], v[136:139]
    ds_read_b128 v[88:91], v3 offset:4096
    v_mfma_f32_16x16x32_bf16 v[140:143], v[56:59], v[52:55], v[140:143]
    ds_read_b128 v[92:95], v3 offset:6144
    v_mfma_f32_16x16x32_bf16 v[144:147], v[60:63], v[40:43], v[144:147]
    ds_read_b64_tr_b16 v[96:97], v4 offset:4096
    v_mfma_f32_16x16x32_bf16 v[148:151], v[60:63], v[44:47], v[148:151]
    ds_read_b64_tr_b16 v[98:99], v4 offset:4608
    v_mfma_f32_16x16x32_bf16 v[152:155], v[60:63], v[48:51], v[152:155]
    ds_read_b64_tr_b16 v[100:101], v5 offset:4096
    v_mfma_f32_16x16x32_bf16 v[156:159], v[60:63], v[52:55], v[156:159]
    ds_read_b64_tr_b16 v[102:103], v5 offset:4608
    v_mfma_f32_16x16x32_bf16 v[160:163], v[40:43], v[64:67], v[160:163]
    ds_read_b64_tr_b16 v[104:105], v4 offset:12288
    v_mfma_f32_16x16x32_bf16 v[164:167], v[44:47], v[64:67], v[164:167]
    ds_read_b64_tr_b16 v[106:107], v4 offset:12800
    v_mfma_f32_16x16x32_bf16 v[168:171], v[48:51], v[64:67], v[168:171]
    ds_read_b64_tr_b16 v[108:109], v5 offset:12288
    v_mfma_f32_16x16x32_bf16 v[172:175], v[52:55], v[64:67], v[172:175]
    ds_read_b64_tr_b16 v[110:111], v5 offset:12800
    v_mfma_f32_16x16x32_bf16 v[176:179], v[40:43], v[68:71], v[176:179]
    ds_read_b64_tr_b16 v[112:113], v4 offset:20480
    v_mfma_f32_16x16x32_bf16 v[180:183], v[44:47], v[68:71], v[180:183]
    ds_read_b64_tr_b16 v[114:115], v4 offset:20992
    v_mfma_f32_16x16x32_bf16 v[184:187], v[48:51], v[68:71], v[184:187]
    ds_read_b64_tr_b16 v[116:117], v5 offset:20480
    v_mfma_f32_16x16x32_bf16 v[188:191], v[52:55], v[68:71], v[188:191]
    ds_read_b64_tr_b16 v[118:119], v5 offset:20992
    v_mfma_f32_16x16x32_bf16 v[192:195], v[40:43], v[72:75], v[192:195]
    s_add_u32 s63, s63, 1
    s_cmp_eq_u32 s63, 4
    s_cselect_b32 s53, 4294803456, 0
    s_cselect_b32 s63, 0, s63
    s_add_u32 s53, s53, 40960
    v_mfma_f32_16x16x32_bf16 v[196:199], v[44:47], v[72:75], v[196:199]
    v_add_u32 v2, s53, v2
    v_mfma_f32_16x16x32_bf16 v[200:203], v[48:51], v[72:75], v[200:203]
    v_add_u32 v4, s53, v4
    v_mfma_f32_16x16x32_bf16 v[204:207], v[52:55], v[72:75], v[204:207]
    v_add_u32 v5, s53, v5
    v_mfma_f32_16x16x32_bf16 v[208:211], v[40:43], v[76:79], v[208:211]
    v_add_u32 v3, s53, v3
    v_mfma_f32_16x16x32_bf16 v[212:215], v[44:47], v[76:79], v[212:215]
    s_cmp_ge_u32 s62, 6
    s_cbranch_scc1 L_cl_none
    buffer_store_dwordx4 v[8:11], v6, s[16:19], 0 offen sc1
    v_add_u32 v6, 1024, v6
    s_cmp_lt_u32 s62, 3
    s_cbranch_scc1 L_cl_none
    v_mov_b32 v6, v16
    v_mov_b32 v16, v17
L_cl_none:
    v_mfma_f32_16x16x32_bf16 v[216:219], v[48:51], v[76:79], v[216:219]
    v_mfma_f32_16x16x32_bf16 v[220:223], v[52:55], v[76:79], v[220:223]
    s_waitcnt lgkmcnt(0)
    v_mfma_f32_16x16x32_bf16 v[128:131], v[96:99], v[80:83], v[128:131]
    s_barrier
    ds_read_b128 v[40:43], v2 offset:0
    v_mfma_f32_16x16x32_bf16 v[132:135], v[96:99], v[84:87], v[132:135]
    ds_read_b128 v[44:47], v2 offset:2048
    v_mfma_f32_16x16x32_bf16 v[136:139], v[96:99], v[88:91], v[136:139]
    ds_read_b128 v[48:51], v2 offset:4096
    v_mfma_f32_16x16x32_bf16 v[140:143], v[96:99], v[92:95], v[140:143]
    ds_read_b128 v[52:55], v2 offset:6144
    v_mfma_f32_16x16x32_bf16 v[144:147], v[100:103], v[80:83], v[144:147]
    ds_read_b64_tr_b16 v[56:57], v4 offset:0
    v_mfma_f32_16x16x32_bf16 v[148:151], v[100:103], v[84:87], v[148:151]
    ds_read_b64_tr_b16 v[58:59], v4 offset:512
    v_mfma_f32_16x16x32_bf16 v[152:155], v[100:103], v[88:91], v[152:155]
    ds_read_b64_tr_b16 v[60:61], v5 offset:0
    v_mfma_f32_16x16x32_bf16 v[156:159], v[100:103], v[92:95], v[156:159]
    ds_read_b64_tr_b16 v[62:63], v5 offset:512
    v_mfma_f32_16x16x32_bf16 v[160:163], v[80:83], v[104:107], v[160:163]
    ds_read_b64_tr_b16 v[64:65], v4 offset:8192
    v_mfma_f32_16x16x32_bf16 v[164:167], v[84:87], v[104:107], v[164:167]
    ds_read_b64_tr_b16 v[66:67], v4 offset:8704
    v_mfma_f32_16x16x32_bf16 v[168:171], v[88:91], v[104:107], v[168:171]
    ds_read_b64_tr_b16 v[68:69], v5 offset:8192
    v_mfma_f32_16x16x32_bf16 v[172:175], v[92:95], v[104:107], v[172:175]
    ds_read_b64_tr_b16 v[70:71], v5 offset:8704
    v_mfma_f32_16x16x32_bf16 v[176:179], v[80:83], v[108:111], v[176:179]
    ds_read_b64_tr_b16 v[72:73], v4 offset:16384
    v_mfma_f32_16x16x32_bf16 v[180:183], v[84:87], v[108:111], v[180:183]
    ds_read_b64_tr_b16 v[74:75], v4 offset:16896
    v_mfma_f32_16x16x32_bf16 v[184:187], v[88:91], v[108:111], v[184:187]
    ds_read_b64_tr_b16 v[76:77], v5 offset:16384
    v_mfma_f32_16x16x32_bf16 v[188:191], v[92:95], v[108:111], v[188:191]
    ds_read_b64_tr_b16 v[78:79], v5 offset:16896
    v_mfma_f32_16x16x32_bf16 v[192:195], v[80:83], v[112:115], v[192:195]
    v_mfma_f32_16x16x32_bf16 v[196:199], v[84:87], v[112:115], v[196:199]
    s_cmp_lg_u32 s62, 8
    s_cbranch_scc1 L_cl_nw
    s_waitcnt vmcnt(0)
L_cl_nw:
    v_mfma_f32_16x16x32_bf16 v[200:203], v[88:91], v[112:115], v[200:203]
    v_mfma_f32_16x16x32_bf16 v[204:207], v[92:95], v[112:115], v[204:207]
    v_mfma_f32_16x16x32_bf16 v[208:211], v[80:83], v[116:119], v[208:211]
    s_add_u32 s62, s62, 1
    v_mfma_f32_16x16x32_bf16 v[212:215], v[84:87], v[116:119], v[212:215]
    v_mfma_f32_16x16x32_bf16 v[216:219], v[88:91], v[116:119], v[216:219]
    v_mfma_f32_16x16x32_bf16 v[220:223], v[92:95], v[116:119], v[220:223]
    s_cmp_lt_u32 s62, 15
    s_cbranch_scc1 L_cloop
    s_waitcnt lgkmcnt(0)
    v_mfma_f32_16x16x32_bf16 v[128:131], v[56:59], v[40:43], v[128:131]
    ds_read_b128 v[80:83], v3 offset:0
    v_mfma_f32_16x16x32_bf16 v[132:135], v[56:59], v[44:47], v[132:135]
    ds_read_b128 v[84:87], v3 offset:2048
    v_mfma_f32_16x16x32_bf16 v[136:139], v[56:59], v[48:51], v[136:139]
    ds_read_b128 v[88:91], v3 offset:4096
L_walkB2:
    s_cbranch_execz L_walk_6
    v_mfma_f32_16x16x32_bf16 v[140:143], v[56:59], v[52:55], v[140:143]
    ds_read_b128 v[92:95], v3 offset:6144
    v_mfma_f32_16x16x32_bf16 v[144:147], v[60:63], v[40:43], v[144:147]
    ds_read_b64_tr_b16 v[96:97], v4 offset:4096
    v_mfma_f32_16x16x32_bf16 v[148:151], v[60:63], v[44:47], v[148:151]
    ds_read_b64_tr_b16 v[98:99], v4 offset:4608
    v_mfma_f32_16x16x32_bf16 v[152:155], v[60:63], v[48:51], v[152:155]
    ds_read_b64_tr_b16 v[100:101], v5 offset:4096
    v_mfma_f32_16x16x32_bf16 v[156:159], v[60:63], v[52:55], v[156:159]
    ds_read_b64_tr_b16 v[102:103], v5 offset:4608
    v_mfma_f32_16x16x32_bf16 v[160:163], v[40:43], v[64:67], v[160:163]
    ds_read_b64_tr_b16 v[104:105], v4 offset:12288
    v_mfma_f32_16x16x32_bf16 v[164:167], v[44:47], v[64:67], v[164:167]
    ds_read_b64_tr_b16 v[106:107], v4 offset:12800
    v_mfma_f32_16x16x32_bf16 v[168:171], v[48:51], v[64:67], v[168:171]
    ds_read_b64_tr_b16 v[108:109], v5 offset:12288
    v_mfma_f32_16x16x32_bf16 v[172:175], v[52:55], v[64:67], v[172:175]
    ds_read_b64_tr_b16 v[110:111], v5 offset:12800
    v_mfma_f32_16x16x32_bf16 v[176:179], v[40:43], v[68:71], v[176:179]
    ds_read_b64_tr_b16 v[112:113], v4 offset:20480
    v_mfma_f32_16x16x32_bf16 v[180:183], v[44:47], v[68:71], v[180:183]
    ds_read_b64_tr_b16 v[114:115], v4 offset:20992
    v_mfma_f32_16x16x32_bf16 v[184:187], v[48:51], v[68:71], v[184:187]
    ds_read_b64_tr_b16 v[116:117], v5 offset:20480
    v_mfma_f32_16x16x32_bf16 v[188:191], v[52:55], v[68:71], v[188:191]
    ds_read_b64_tr_b16 v[118:119], v5 offset:20992
    v_mfma_f32_16x16x32_bf16 v[192:195], v[40:43], v[72:75], v[192:195]
    v_lshrrev_b32 v21, 4, v0
    v_and_b32 v22, 15, v0
    v_mfma_f32_16x16x32_bf16 v[196:199], v[44:47], v[72:75], v[196:199]
    s_lshl_b32 s86, s49, 8
    s_add_u32 s86, s86, 131072
    v_lshl_add_u32 v6, v21, 4, s86
    v_mfma_f32_16x16x32_bf16 v[200:203], v[48:51], v[72:75], v[200:203]
    v_lshl_add_u32 v7, v22, 2, s86
    v_mfma_f32_16x16x32_bf16 v[204:207], v[52:55], v[72:75], v[204:207]
    s_lshl_b32 s86, s50, 7
    s_add_u32 s86, s86, 132608
    v_lshl_add_u32 v8, v22, 2, s86
    v_mfma_f32_16x16x32_bf16 v[208:211], v[40:43], v[76:79], v[208:211]
    v_lshl_add_u32 v9, v21, 4, s86
    v_mfma_f32_16x16x32_bf16 v[212:215], v[44:47], v[76:79], v[212:215]
    s_lshl_b32 s86, s3, 2
    s_add_u32 s86, s86, 135168
    v_mov_b32 v12, s86
    v_mfma_f32_16x16x32_bf16 v[216:219], v[48:51], v[76:79], v[216:219]
    v_xor_b32 v13, 4, v12
    v_mfma_f32_16x16x32_bf16 v[220:223], v[52:55], v[76:79], v[220:223]
    s_waitcnt lgkmcnt(0)
    v_mfma_f32_16x16x32_bf16 v[160:163], v[80:83], v[104:107], v[160:163]
    v_mfma_f32_16x16x32_bf16 v[164:167], v[84:87], v[104:107], v[164:167]
    v_mfma_f32_16x16x32_bf16 v[168:171], v[88:91], v[104:107], v[168:171]
    v_mfma_f32_16x16x32_bf16 v[172:175], v[92:95], v[104:107], v[172:175]
    v_mfma_f32_16x16x32_bf16 v[176:179], v[80:83], v[108:111], v[176:179]
    v_mfma_f32_16x16x32_bf16 v[180:183], v[84:87], v[108:111], v[180:183]
    v_mfma_f32_16x16x32_bf16 v[184:187], v[88:91], v[108:111], v[184:187]
    v_mfma_f32_16x16x32_bf16 v[188:191], v[92:95], v[108:111], v[188:191]
    v_mfma_f32_16x16x32_bf16 v[192:195], v[80:83], v[112:115], v[192:195]
    v_mfma_f32_16x16x32_bf16 v[196:199], v[84:87], v[112:115], v[196:199]
    v_mfma_f32_16x16x32_bf16 v[200:203], v[88:91], v[112:115], v[200:203]
    v_mfma_f32_16x16x32_bf16 v[204:207], v[92:95], v[112:115], v[204:207]
    v_mfma_f32_16x16x32_bf16 v[208:211], v[80:83], v[116:119], v[208:211]
    s_barrier
    ds_read_b128 v[40:43], v6 offset:0
    ds_read_b128 v[44:47], v6 offset:64
    v_mfma_f32_16x16x32_bf16 v[212:215], v[84:87], v[116:119], v[212:215]
    ds_read_b128 v[48:51], v6 offset:128
    ds_read_b128 v[52:55], v6 offset:192
    v_mfma_f32_16x16x32_bf16 v[216:219], v[88:91], v[116:119], v[216:219]
    ds_read_b32 v72, v8 offset:256
    ds_read_b32 v73, v8 offset:320
    v_mfma_f32_16x16x32_bf16 v[220:223], v[92:95], v[116:119], v[220:223]
    ds_read_b32 v74, v8 offset:512
    ds_read_b32 v75, v8 offset:576
    v_mfma_f32_16x16x32_bf16 v[128:131], v[96:99], v[80:83], v[128:131]
    ds_read_b128 v[56:59], v6 offset:512
    ds_read_b128 v[60:63], v6 offset:576
    v_mfma_f32_16x16x32_bf16 v[132:135], v[96:99], v[84:87], v[132:135]
    ds_read_b128 v[64:67], v6 offset:640
    ds_read_b128 v[68:71], v6 offset:704
    v_mfma_f32_16x16x32_bf16 v[136:139], v[96:99], v[88:91], v[136:139]
    ds_read_b128 v[224:227], v6 offset:1024
    ds_read_b128 v[228:231], v6 offset:1088
    v_mfma_f32_16x16x32_bf16 v[140:143], v[96:99], v[92:95], v[140:143]
    ds_read_b128 v[232:235], v6 offset:1152
    ds_read_b128 v[236:239], v6 offset:1216
    v_mfma_f32_16x16x32_bf16 v[144:147], v[100:103], v[80:83], v[144:147]
    ds_read_b128 v[28:31], v9 offset:0
    ds_read_b128 v[32:35], v9 offset:64
    v_mfma_f32_16x16x32_bf16 v[148:151], v[100:103], v[84:87], v[148:151]
    v_mfma_f32_16x16x32_bf16 v[152:155], v[100:103], v[88:91], v[152:155]
    v_mfma_f32_16x16x32_bf16 v[156:159], v[100:103], v[92:95], v[156:159]
    ds_read_b32 v240, v7 offset:0
    ds_read_b32 v244, v7 offset:512
    ds_read_b32 v248, v7 offset:1024
    ds_read_b32 v241, v7 offset:64
    ds_read_b32 v245, v7 offset:576
    ds_read_b32 v249, v7 offset:1088
    ds_read_b32 v242, v7 offset:128
    ds_read_b32 v246, v7 offset:640
    ds_read_b32 v250, v7 offset:1152
    ds_read_b32 v243, v7 offset:192
    ds_read_b32 v247, v7 offset:704
    ds_read_b32 v251, v7 offset:1216
    s_waitcnt lgkmcnt(12)
    v_pk_fma_f32 v[160:161], v[40:41], v[72:73], v[160:161] op_sel_hi:[1,0,1]
    v_pk_mul_f32 v[112:113], v[160:161], v[224:225]
    v_pk_fma_f32 v[160:161], v[160:161], v[56:57], s[54:55]
    v_exp_f32 v112, v112 clamp
    v_exp_f32 v113, v113 clamp
    v_max_f32 v160, s54, v160
    v_max_f32 v161, s54, v161
    v_pk_add_f32 v[160:161], v[160:161], v[112:113]
    v_cvt_pk_bf16_f32 v80, v160, v161
    v_pk_fma_f32 v[162:163], v[42:43], v[72:73], v[162:163] op_sel_hi:[1,0,1]
    v_pk_mul_f32 v[114:115], v[162:163], v[226:227]
    v_pk_fma_f32 v[162:163], v[162:163], v[58:59], s[54:55]
    v_exp_f32 v114, v114 clamp
    v_exp_f32 v115, v115 clamp
    v_max_f32 v162, s54, v162
    v_max_f32 v163, s54, v163
    v_pk_add_f32 v[162:163], v[162:163], v[114:115]
    v_cvt_pk_bf16_f32 v81, v162, v163
    v_pk_fma_f32 v[164:165], v[44:45], v[72:73], v[164:165] op_sel_hi:[1,0,1]
    v_pk_mul_f32 v[116:117], v[164:165], v[228:229]
    v_pk_fma_f32 v[164:165], v[164:165], v[60:61], s[54:55]
    v_exp_f32 v116, v116 clamp
    v_exp_f32 v117, v117 clamp
    v_max_f32 v164, s54, v164
    v_max_f32 v165, s54, v165
    v_pk_add_f32 v[164:165], v[164:165], v[116:117]
    v_cvt_pk_bf16_f32 v82, v164, v165
    v_pk_fma_f32 v[166:167], v[46:47], v[72:73], v[166:167] op_sel_hi:[1,0,1]
    v_pk_mul_f32 v[118:119], v[166:167], v[230:231]
    v_pk_fma_f32 v[166:167], v[166:167], v[62:63], s[54:55]
    v_exp_f32 v118, v118 clamp
    v_exp_f32 v119, v119 clamp
    v_max_f32 v166, s54, v166
    v_max_f32 v167, s54, v167
    v_pk_add_f32 v[166:167], v[166:167], v[118:119]
    v_cvt_pk_bf16_f32 v83, v166, v167
    v_pk_fma_f32 v[168:169], v[48:49], v[72:73], v[168:169] op_sel_hi:[1,0,1]
    v_pk_mul_f32 v[112:113], v[168:169], v[232:233]
    v_pk_fma_f32 v[168:169], v[168:169], v[64:65], s[54:55]
    v_exp_f32 v112, v112 clamp
L_walkB3:
    s_cbranch_execz L_walk_7
    v_exp_f32 v113, v113 clamp
    v_max_f32 v168, s54, v168
    v_max_f32 v169, s54, v169
    v_pk_add_f32 v[168:169], v[168:169], v[112:113]
    v_cvt_pk_bf16_f32 v84, v168, v169
    v_pk_fma_f32 v[170:171], v[50:51], v[72:73], v[170:171] op_sel_hi:[1,0,1]
    v_pk_mul_f32 v[114:115], v[170:171], v[234:235]
    v_pk_fma_f32 v[170:171], v[170:171], v[66:67], s[54:55]
    v_exp_f32 v114, v114 clamp
    v_exp_f32 v115, v115 clamp
    v_max_f32 v170, s54, v170
    v_max_f32 v171, s54, v171
    v_pk_add_f32 v[170:171], v[170:171], v[114:115]
    v_cvt_pk_bf16_f32 v85, v170, v171
    v_pk_fma_f32 v[172:173], v[52:53], v[72:73], v[172:173] op_sel_hi:[1,0,1]
    v_pk_mul_f32 v[116:117], v[172:173], v[236:237]
    v_pk_fma_f32 v[172:173], v[172:173], v[68:69], s[54:55]
    v_exp_f32 v116, v116 clamp
    v_exp_f32 v117, v117 clamp
    v_max_f32 v172, s54, v172
    v_max_f32 v173, s54, v173
    v_pk_add_f32 v[172:173], v[172:173], v[116:117]
    v_cvt_pk_bf16_f32 v86, v172, v173
    v_pk_fma_f32 v[174:175], v[54:55], v[72:73], v[174:175] op_sel_hi:[1,0,1]
    v_pk_mul_f32 v[118:119], v[174:175], v[238:239]
    v_pk_fma_f32 v[174:175], v[174:175], v[70:71], s[54:55]
    v_exp_f32 v118, v118 clamp
    v_exp_f32 v119, v119 clamp
    v_max_f32 v174, s54, v174
    v_max_f32 v175, s54, v175
    v_pk_add_f32 v[174:175], v[174:175], v[118:119]
    v_cvt_pk_bf16_f32 v87, v174, v175
    v_pk_fma_f32 v[176:177], v[40:41], v[72:73], v[176:177] op_sel:[0,1,0] op_sel_hi:[1,1,1]
    v_pk_mul_f32 v[112:113], v[176:177], v[224:225]
    v_pk_fma_f32 v[176:177], v[176:177], v[56:57], s[54:55]
    v_exp_f32 v112, v112 clamp
    v_exp_f32 v113, v113 clamp
    v_max_f32 v176, s54, v176
    v_max_f32 v177, s54, v177
    v_pk_add_f32 v[176:177], v[176:177], v[112:113]
    v_cvt_pk_bf16_f32 v88, v176, v177
    v_pk_fma_f32 v[178:179], v[42:43], v[72:73], v[178:179] op_sel:[0,1,0] op_sel_hi:[1,1,1]
    v_pk_mul_f32 v[114:115], v[178:179], v[226:227]
    v_pk_fma_f32 v[178:179], v[178:179], v[58:59], s[54:55]
    v_exp_f32 v114, v114 clamp
    v_exp_f32 v115, v115 clamp
    v_max_f32 v178, s54, v178
    v_max_f32 v179, s54, v179
    v_pk_add_f32 v[178:179], v[178:179], v[114:115]
    v_cvt_pk_bf16_f32 v89, v178, v179
    v_pk_fma_f32 v[180:181], v[44:45], v[72:73], v[180:181] op_sel:[0,1,0] op_sel_hi:[1,1,1]
    v_pk_mul_f32 v[116:117], v[180:181], v[228:229]
    v_pk_fma_f32 v[180:181], v[180:181], v[60:61], s[54:55]
    v_exp_f32 v116, v116 clamp
    v_exp_f32 v117, v117 clamp
    v_max_f32 v180, s54, v180
    v_max_f32 v181, s54, v181
    v_pk_add_f32 v[180:181], v[180:181], v[116:117]
    v_cvt_pk_bf16_f32 v90, v180, v181
    v_pk_fma_f32 v[182:183], v[46:47], v[72:73], v[182:183] op_sel:[0,1,0] op_sel_hi:[1,1,1]
    v_pk_mul_f32 v[118:119], v[182:183], v[230:231]
    v_pk_fma_f32 v[182:183], v[182:183], v[62:63], s[54:55]
    v_exp_f32 v118, v118 clamp
    v_exp_f32 v119, v119 clamp
    v_max_f32 v182, s54, v182
    v_max_f32 v183, s54, v183
    v_pk_add_f32 v[182:183], v[182:183], v[118:119]
    v_cvt_pk_bf16_f32 v91, v182, v183
    v_pk_fma_f32 v[184:185], v[48:49], v[72:73], v[184:185] op_sel:[0,1,0] op_sel_hi:[1,1,1]
    v_pk_mul_f32 v[112:113], v[184:185], v[232:233]
    v_pk_fma_f32 v[184:185], v[184:185], v[64:65], s[54:55]
    v_exp_f32 v112, v112 clamp
    v_exp_f32 v113, v113 clamp
    v_max_f32 v184, s54, v184
    v_max_f32 v185, s54, v185
    v_pk_add_f32 v[184:185], v[184:185], v[112:113]
    v_cvt_pk_bf16_f32 v92, v184, v185
    v_pk_fma_f32 v[186:187], v[50:51], v[72:73], v[186:187] op_sel:[0,1,0] op_sel_hi:[1,1,1]
    v_pk_mul_f32 v[114:115], v[186:187], v[234:235]
    v_pk_fma_f32 v[186:187], v[186:187], v[66:67], s[54:55]
    v_exp_f32 v114, v114 clamp
    v_exp_f32 v115, v115 clamp
    v_max_f32 v186, s54, v186
    v_max_f32 v187, s54, v187
    v_pk_add_f32 v[186:187], v[186:187], v[114:115]
    v_cvt_pk_bf16_f32 v93, v186, v187
    v_pk_fma_f32 v[188:189], v[52:53], v[72:73], v[188:189] op_sel:[0,1,0] op_sel_hi:[1,1,1]
    v_pk_mul_f32 v[116:117], v[188:189], v[236:237]
    v_pk_fma_f32 v[188:189], v[188:189], v[68:69], s[54:55]
    v_exp_f32 v116, v116 clamp
    v_exp_f32 v117, v117 clamp
    v_max_f32 v188, s54, v188
    v_max_f32 v189, s54, v189
    v_pk_add_f32 v[188:189], v[188:189], v[116:117]
    v_cvt_pk_bf16_f32 v94, v188, v189
    v_pk_fma_f32 v[190:191], v[54:55], v[72:73], v[190:191] op_sel:[0,1,0] op_sel_hi:[1,1,1]
    v_pk_mul_f32 v[118:119], v[190:191], v[238:239]
    v_pk_fma_f32 v[190:191], v[190:191], v[70:71], s[54:55]
    v_exp_f32 v118, v118 clamp
    v_exp_f32 v119, v119 clamp
    v_max_f32 v190, s54, v190
    v_max_f32 v191, s54, v191
    v_pk_add_f32 v[190:191], v[190:191], v[118:119]
    v_cvt_pk_bf16_f32 v95, v190, v191
    v_mov_b32 v120, s95
    v_mov_b32 v121, s95
    v_mov_b32 v122, s95
    v_mov_b32 v123, s95
    v_pk_fma_f32 v[192:193], v[40:41], v[74:75], v[192:193] op_sel_hi:[1,0,1]
    v_pk_mul_f32 v[192:193], v[192:193], v[56:57]
    v_cvt_pk_bf16_f32 v96, v192, v193
    v_pk_fma_f32 v[194:195], v[42:43], v[74:75], v[194:195] op_sel_hi:[1,0,1]
    v_pk_mul_f32 v[194:195], v[194:195], v[58:59]
    v_cvt_pk_bf16_f32 v97, v194, v195
    v_pk_fma_f32 v[196:197], v[44:45], v[74:75], v[196:197] op_sel_hi:[1,0,1]
    v_pk_mul_f32 v[196:197], v[196:197], v[60:61]
    v_cvt_pk_bf16_f32 v98, v196, v197
    v_pk_fma_f32 v[198:199], v[46:47], v[74:75], v[198:199] op_sel_hi:[1,0,1]
    v_pk_mul_f32 v[198:199], v[198:199], v[62:63]
    v_cvt_pk_bf16_f32 v99, v198, v199
    v_pk_fma_f32 v[200:201], v[48:49], v[74:75], v[200:201] op_sel_hi:[1,0,1]
    v_pk_mul_f32 v[200:201], v[200:201], v[64:65]
    v_cvt_pk_bf16_f32 v100, v200, v201
    v_pk_fma_f32 v[202:203], v[50:51], v[74:75], v[202:203] op_sel_hi:[1,0,1]
    v_pk_mul_f32 v[202:203], v[202:203], v[66:67]
    v_cvt_pk_bf16_f32 v101, v202, v203
    v_pk_fma_f32 v[204:205], v[52:53], v[74:75], v[204:205] op_sel_hi:[1,0,1]
    v_pk_mul_f32 v[204:205], v[204:205], v[68:69]
    v_cvt_pk_bf16_f32 v102, v204, v205
    v_pk_fma_f32 v[206:207], v[54:55], v[74:75], v[206:207] op_sel_hi:[1,0,1]
    v_pk_mul_f32 v[206:207], v[206:207], v[70:71]
    v_cvt_pk_bf16_f32 v103, v206, v207
    v_pk_fma_f32 v[208:209], v[40:41], v[74:75], v[208:209] op_sel:[0,1,0] op_sel_hi:[1,1,1]
    v_pk_mul_f32 v[208:209], v[208:209], v[56:57]
    v_cvt_pk_bf16_f32 v104, v208, v209
    v_pk_fma_f32 v[210:211], v[42:43], v[74:75], v[210:211] op_sel:[0,1,0] op_sel_hi:[1,1,1]
    v_pk_mul_f32 v[210:211], v[210:211], v[58:59]
    v_cvt_pk_bf16_f32 v105, v210, v211
    v_pk_fma_f32 v[212:213], v[44:45], v[74:75], v[212:213] op_sel:[0,1,0] op_sel_hi:[1,1,1]
    v_pk_mul_f32 v[212:213], v[212:213], v[60:61]
    v_cvt_pk_bf16_f32 v106, v212, v213
    v_pk_fma_f32 v[214:215], v[46:47], v[74:75], v[214:215] op_sel:[0,1,0] op_sel_hi:[1,1,1]
    v_pk_mul_f32 v[214:215], v[214:215], v[62:63]
    v_cvt_pk_bf16_f32 v107, v214, v215
    v_pk_fma_f32 v[216:217], v[48:49], v[74:75], v[216:217] op_sel:[0,1,0] op_sel_hi:[1,1,1]
    v_pk_mul_f32 v[216:217], v[216:217], v[64:65]
    v_cvt_pk_bf16_f32 v108, v216, v217
    v_pk_fma_f32 v[218:219], v[50:51], v[74:75], v[218:219] op_sel:[0,1,0] op_sel_hi:[1,1,1]
    v_pk_mul_f32 v[218:219], v[218:219], v[66:67]
L_walk_12:
    s_cbranch_execz L_walk_16
    v_cvt_pk_bf16_f32 v109, v218, v219
    v_pk_fma_f32 v[220:221], v[52:53], v[74:75], v[220:221] op_sel:[0,1,0] op_sel_hi:[1,1,1]
    v_pk_mul_f32 v[220:221], v[220:221], v[68:69]
    v_cvt_pk_bf16_f32 v110, v220, v221
    v_pk_fma_f32 v[222:223], v[54:55], v[74:75], v[222:223] op_sel:[0,1,0] op_sel_hi:[1,1,1]
    v_pk_mul_f32 v[222:223], v[222:223], v[70:71]
    v_cvt_pk_bf16_f32 v111, v222, v223
    s_mul_i32 s86, s3, 3072
    s_add_u32 s86, s86, 139264
    v_lshl_add_u32 v6, v0, 4, s86
    s_xor_b32 s86, s3, 1
    s_mul_i32 s86, s86, 3072
    s_add_u32 s86, s86, 139264
    v_lshl_add_u32 v7, v0, 4, s86
    s_cmp_eq_u32 s49, 1
    s_cbranch_scc1 L_kv1
    v_mfma_f32_16x16x32_bf16 v[172:175], v[80:83], v[104:107], 0
    v_mfma_f32_16x16x32_bf16 v[176:179], v[88:91], v[104:107], 0
    v_mfma_f32_16x16x32_bf16 v[180:183], v[88:91], v[120:123], 0
    v_mfma_f32_16x16x32_bf16 v[160:163], v[80:83], v[96:99], 0
    v_mfma_f32_16x16x32_bf16 v[164:167], v[88:91], v[96:99], 0
    v_mfma_f32_16x16x32_bf16 v[168:171], v[80:83], v[120:123], 0
    v_mfma_f32_16x16x32_bf16 v[172:175], v[84:87], v[108:111], v[172:175]
    v_mfma_f32_16x16x32_bf16 v[176:179], v[92:95], v[108:111], v[176:179]
    v_mfma_f32_16x16x32_bf16 v[180:183], v[92:95], v[120:123], v[180:183]
    v_mfma_f32_16x16x32_bf16 v[160:163], v[84:87], v[100:103], v[160:163]
    v_mfma_f32_16x16x32_bf16 v[164:167], v[92:95], v[100:103], v[164:167]
    v_mfma_f32_16x16x32_bf16 v[168:171], v[84:87], v[120:123], v[168:171]
    s_branch L_kvd
L_kv1:
    v_mfma_f32_16x16x32_bf16 v[172:175], v[80:83], v[96:99], 0
    v_mfma_f32_16x16x32_bf16 v[176:179], v[88:91], v[96:99], 0
    v_mfma_f32_16x16x32_bf16 v[180:183], v[80:83], v[120:123], 0
    v_mfma_f32_16x16x32_bf16 v[160:163], v[80:83], v[104:107], 0
    v_mfma_f32_16x16x32_bf16 v[164:167], v[88:91], v[104:107], 0
    v_mfma_f32_16x16x32_bf16 v[168:171], v[88:91], v[120:123], 0
    v_mfma_f32_16x16x32_bf16 v[172:175], v[84:87], v[100:103], v[172:175]
    v_mfma_f32_16x16x32_bf16 v[176:179], v[92:95], v[100:103], v[176:179]
    v_mfma_f32_16x16x32_bf16 v[180:183], v[84:87], v[120:123], v[180:183]
    v_mfma_f32_16x16x32_bf16 v[160:163], v[84:87], v[108:111], v[160:163]
    v_mfma_f32_16x16x32_bf16 v[164:167], v[92:95], v[108:111], v[164:167]
    v_mfma_f32_16x16x32_bf16 v[168:171], v[92:95], v[120:123], v[168:171]
L_kvd:
    s_lshl_b32 s86, s47, 1
    s_add_u32 s86, s86, s50
    s_lshl_b32 s87, s86, 1
    s_add_u32 s87, s87, s49
    s_lshl_b32 s87, s87, 4
    s_add_u32 s87, s87, s46
    s_lshl_b32 s87, s87, 10
    s_add_u32 s87, s87, 5242880
    v_lshl_add_u32 v8, v0, 4, s87
    s_lshl_b32 s87, s86, 4
    s_add_u32 s87, s87, s46
    s_lshl_b32 s87, s87, 7
    s_lshl_b32 s88, s49, 6
    s_add_u32 s87, s87, s88
    s_add_u32 s87, s87, 6881280
    v_lshl_add_u32 v9, v21, 4, s87
    v_cmp_eq_u32 vcc, 0, v22
    v_mov_b32 v10, 2147483648
    s_nop 0
    v_cndmask_b32 v9, v10, v9, vcc
    ds_write_b128 v6, v[172:175] offset:0
    ds_write_b128 v6, v[176:179] offset:1024
    ds_write_b128 v6, v[180:183] offset:2048
    ds_write_b32 v12, v12
    s_lshl_b32 s87, s46, 3
    s_lshl_b32 s88, s49, 2
    s_add_u32 s87, s87, s88
    s_lshl_b32 s87, s87, 5
    s_add_u32 s87, s87, s86
    s_lshl_b32 s87, s87, 10
    s_add_u32 s87, s87, 1048576
    v_lshl_add_u32 v10, v0, 4, s87
    s_mul_i32 s87, s50, 3072
    s_add_u32 s87, s87, 151552
    v_lshl_add_u32 v11, v0, 4, s87
    s_lshl_b32 s87, s86, 1
    s_add_u32 s87, s87, s49
    s_lshl_b32 s87, s87, 5
    s_add_u32 s87, s87, s46
    s_lshl2_add_u32 s87, s87, 671744
    v_mov_b32 v16, 2147483648
    v_mov_b32 v18, 2147483648
    v_writelane_b32 v16, s87, 0
    s_lshl_b32 s87, s46, 1
    s_add_u32 s87, s87, s49
    s_lshl_b32 s87, s87, 1
    s_lshr_b32 s88, s86, 4
    s_add_u32 s87, s87, s88
    s_lshl_b32 s87, s87, 6
    s_and_b32 s88, s86, 15
    s_add_u32 s87, s87, s88
    s_lshl2_add_u32 s87, s87, 688128
    v_writelane_b32 v18, s87, 0
    s_add_u32 s87, s87, 128
    v_writelane_b32 v18, s87, 1
    v_mov_b32 v17, s68
L_xkv:
    ds_read_b32 v14, v13
    ds_read_b128 v[172:175], v7 offset:0
    ds_read_b128 v[176:179], v7 offset:1024
    ds_read_b128 v[180:183], v7 offset:2048
    s_waitcnt lgkmcnt(0)
    v_cmp_eq_u32 vcc, 0, v14
    s_cbranch_vccz L_ok_2
    s_sub_u32 s56, s56, 1
    s_cbranch_scc0 L_xkv
    s_mov_b32 s56, 0
L_ok_2:
    v_pk_add_f32 v[160:161], v[160:161], v[172:173]
    v_pk_add_f32 v[162:163], v[162:163], v[174:175]
    v_pk_add_f32 v[164:165], v[164:165], v[176:177]
    v_pk_add_f32 v[166:167], v[166:167], v[178:179]
    v_pk_add_f32 v[168:169], v[168:169], v[180:181]
    v_pk_add_f32 v[170:171], v[170:171], v[182:183]
    v_cvt_pk_bf16_f32 v184, v160, v161
    v_cvt_pk_bf16_f32 v185, v162, v163
    v_cvt_pk_bf16_f32 v186, v164, v165
    v_cvt_pk_bf16_f32 v187, v166, v167
    buffer_store_dwordx4 v[184:187], v8, s[16:19], 0 offen sc1
    buffer_store_dwordx4 v[168:171], v9, s[16:19], 0 offen sc1
    buffer_atomic_swap v17, v16, s[16:19], 0 offen sc1
    v_pk_fma_f32 v[128:129], v[28:29], v[240:241], v[128:129] op_sel_hi:[1,0,1]
    v_pk_mul_f32 v[112:113], v[128:129], v[248:249] op_sel_hi:[1,0]
    v_pk_fma_f32 v[128:129], v[128:129], v[244:245], s[54:55] op_sel_hi:[1,0,1]
    v_exp_f32 v112, v112 clamp
    v_exp_f32 v113, v113 clamp
    v_max_f32 v128, s54, v128
    v_max_f32 v129, s54, v129
    v_pk_add_f32 v[128:129], v[128:129], v[112:113]
    v_cvt_pk_bf16_f32 v192, v128, v129
    v_pk_fma_f32 v[130:131], v[30:31], v[240:241], v[130:131] op_sel_hi:[1,0,1]
    v_pk_mul_f32 v[114:115], v[130:131], v[248:249] op_sel_hi:[1,0]
    v_pk_fma_f32 v[130:131], v[130:131], v[244:245], s[54:55] op_sel_hi:[1,0,1]
    v_exp_f32 v114, v114 clamp
    v_exp_f32 v115, v115 clamp
    v_max_f32 v130, s54, v130
    v_max_f32 v131, s54, v131
    v_pk_add_f32 v[130:131], v[130:131], v[114:115]
    v_cvt_pk_bf16_f32 v193, v130, v131
    v_pk_fma_f32 v[144:145], v[32:33], v[240:241], v[144:145] op_sel_hi:[1,0,1]
    v_pk_mul_f32 v[116:117], v[144:145], v[248:249] op_sel_hi:[1,0]
    v_pk_fma_f32 v[144:145], v[144:145], v[244:245], s[54:55] op_sel_hi:[1,0,1]
    v_exp_f32 v116, v116 clamp
    v_exp_f32 v117, v117 clamp
    v_max_f32 v144, s54, v144
    v_max_f32 v145, s54, v145
    v_pk_add_f32 v[144:145], v[144:145], v[116:117]
    v_cvt_pk_bf16_f32 v194, v144, v145
    v_pk_fma_f32 v[146:147], v[34:35], v[240:241], v[146:147] op_sel_hi:[1,0,1]
    v_pk_mul_f32 v[118:119], v[146:147], v[248:249] op_sel_hi:[1,0]
    v_pk_fma_f32 v[146:147], v[146:147], v[244:245], s[54:55] op_sel_hi:[1,0,1]
    v_exp_f32 v118, v118 clamp
    v_exp_f32 v119, v119 clamp
    v_max_f32 v146, s54, v146
    v_max_f32 v147, s54, v147
    v_pk_add_f32 v[146:147], v[146:147], v[118:119]
    v_cvt_pk_bf16_f32 v195, v146, v147
    v_pk_fma_f32 v[132:133], v[28:29], v[240:241], v[132:133] op_sel:[0,1,0] op_sel_hi:[1,1,1]
    v_pk_mul_f32 v[112:113], v[132:133], v[248:249] op_sel:[0,1] op_sel_hi:[1,1]
    v_pk_fma_f32 v[132:133], v[132:133], v[244:245], s[54:55] op_sel:[0,1,0] op_sel_hi:[1,1,1]
    v_exp_f32 v112, v112 clamp
    v_exp_f32 v113, v113 clamp
    v_max_f32 v132, s54, v132
L_walk_13:
    s_cbranch_execz L_walk_17
    v_max_f32 v133, s54, v133
    v_pk_add_f32 v[132:133], v[132:133], v[112:113]
    v_cvt_pk_bf16_f32 v196, v132, v133
    v_pk_fma_f32 v[134:135], v[30:31], v[240:241], v[134:135] op_sel:[0,1,0] op_sel_hi:[1,1,1]
    v_pk_mul_f32 v[114:115], v[134:135], v[248:249] op_sel:[0,1] op_sel_hi:[1,1]
    v_pk_fma_f32 v[134:135], v[134:135], v[244:245], s[54:55] op_sel:[0,1,0] op_sel_hi:[1,1,1]
    v_exp_f32 v114, v114 clamp
    v_exp_f32 v115, v115 clamp
    v_max_f32 v134, s54, v134
    v_max_f32 v135, s54, v135
    v_pk_add_f32 v[134:135], v[134:135], v[114:115]
    v_cvt_pk_bf16_f32 v197, v134, v135
    v_pk_fma_f32 v[148:149], v[32:33], v[240:241], v[148:149] op_sel:[0,1,0] op_sel_hi:[1,1,1]
    v_pk_mul_f32 v[116:117], v[148:149], v[248:249] op_sel:[0,1] op_sel_hi:[1,1]
    v_pk_fma_f32 v[148:149], v[148:149], v[244:245], s[54:55] op_sel:[0,1,0] op_sel_hi:[1,1,1]
    v_exp_f32 v116, v116 clamp
    v_exp_f32 v117, v117 clamp
    v_max_f32 v148, s54, v148
    v_max_f32 v149, s54, v149
    v_pk_add_f32 v[148:149], v[148:149], v[116:117]
    v_cvt_pk_bf16_f32 v198, v148, v149
    v_pk_fma_f32 v[150:151], v[34:35], v[240:241], v[150:151] op_sel:[0,1,0] op_sel_hi:[1,1,1]
    v_pk_mul_f32 v[118:119], v[150:151], v[248:249] op_sel:[0,1] op_sel_hi:[1,1]
    v_pk_fma_f32 v[150:151], v[150:151], v[244:245], s[54:55] op_sel:[0,1,0] op_sel_hi:[1,1,1]
    v_exp_f32 v118, v118 clamp
    v_exp_f32 v119, v119 clamp
    v_max_f32 v150, s54, v150
    v_max_f32 v151, s54, v151
    v_pk_add_f32 v[150:151], v[150:151], v[118:119]
    v_cvt_pk_bf16_f32 v199, v150, v151
    v_pk_fma_f32 v[136:137], v[28:29], v[242:243], v[136:137] op_sel_hi:[1,0,1]
    v_pk_mul_f32 v[112:113], v[136:137], v[250:251] op_sel_hi:[1,0]
    v_pk_fma_f32 v[136:137], v[136:137], v[246:247], s[54:55] op_sel_hi:[1,0,1]
    v_exp_f32 v112, v112 clamp
    v_exp_f32 v113, v113 clamp
    v_max_f32 v136, s54, v136
    v_max_f32 v137, s54, v137
    v_pk_add_f32 v[136:137], v[136:137], v[112:113]
    v_cvt_pk_bf16_f32 v200, v136, v137
    v_pk_fma_f32 v[138:139], v[30:31], v[242:243], v[138:139] op_sel_hi:[1,0,1]
    v_pk_mul_f32 v[114:115], v[138:139], v[250:251] op_sel_hi:[1,0]
    v_pk_fma_f32 v[138:139], v[138:139], v[246:247], s[54:55] op_sel_hi:[1,0,1]
    v_exp_f32 v114, v114 clamp
    v_exp_f32 v115, v115 clamp
    v_max_f32 v138, s54, v138
    v_max_f32 v139, s54, v139
    v_pk_add_f32 v[138:139], v[138:139], v[114:115]
    v_cvt_pk_bf16_f32 v201, v138, v139
    v_pk_fma_f32 v[152:153], v[32:33], v[242:243], v[152:153] op_sel_hi:[1,0,1]
    v_pk_mul_f32 v[116:117], v[152:153], v[250:251] op_sel_hi:[1,0]
    v_pk_fma_f32 v[152:153], v[152:153], v[246:247], s[54:55] op_sel_hi:[1,0,1]
    v_exp_f32 v116, v116 clamp
    v_exp_f32 v117, v117 clamp
    v_max_f32 v152, s54, v152
    v_max_f32 v153, s54, v153
    v_pk_add_f32 v[152:153], v[152:153], v[116:117]
    v_cvt_pk_bf16_f32 v202, v152, v153
    v_pk_fma_f32 v[154:155], v[34:35], v[242:243], v[154:155] op_sel_hi:[1,0,1]
    v_pk_mul_f32 v[118:119], v[154:155], v[250:251] op_sel_hi:[1,0]
    v_pk_fma_f32 v[154:155], v[154:155], v[246:247], s[54:55] op_sel_hi:[1,0,1]
    v_exp_f32 v118, v118 clamp
    v_exp_f32 v119, v119 clamp
    v_max_f32 v154, s54, v154
    v_max_f32 v155, s54, v155
    v_pk_add_f32 v[154:155], v[154:155], v[118:119]
    v_cvt_pk_bf16_f32 v203, v154, v155
    v_pk_fma_f32 v[140:141], v[28:29], v[242:243], v[140:141] op_sel:[0,1,0] op_sel_hi:[1,1,1]
    v_pk_mul_f32 v[112:113], v[140:141], v[250:251] op_sel:[0,1] op_sel_hi:[1,1]
    v_pk_fma_f32 v[140:141], v[140:141], v[246:247], s[54:55] op_sel:[0,1,0] op_sel_hi:[1,1,1]
    v_exp_f32 v112, v112 clamp
    v_exp_f32 v113, v113 clamp
    v_max_f32 v140, s54, v140
    v_max_f32 v141, s54, v141
    v_pk_add_f32 v[140:141], v[140:141], v[112:113]
    v_cvt_pk_bf16_f32 v204, v140, v141
    v_pk_fma_f32 v[142:143], v[30:31], v[242:243], v[142:143] op_sel:[0,1,0] op_sel_hi:[1,1,1]
    v_pk_mul_f32 v[114:115], v[142:143], v[250:251] op_sel:[0,1] op_sel_hi:[1,1]
    v_pk_fma_f32 v[142:143], v[142:143], v[246:247], s[54:55] op_sel:[0,1,0] op_sel_hi:[1,1,1]
    v_exp_f32 v114, v114 clamp
    v_exp_f32 v115, v115 clamp
    v_max_f32 v142, s54, v142
    v_max_f32 v143, s54, v143
    v_pk_add_f32 v[142:143], v[142:143], v[114:115]
    v_cvt_pk_bf16_f32 v205, v142, v143
    v_pk_fma_f32 v[156:157], v[32:33], v[242:243], v[156:157] op_sel:[0,1,0] op_sel_hi:[1,1,1]
    v_pk_mul_f32 v[116:117], v[156:157], v[250:251] op_sel:[0,1] op_sel_hi:[1,1]
    v_pk_fma_f32 v[156:157], v[156:157], v[246:247], s[54:55] op_sel:[0,1,0] op_sel_hi:[1,1,1]
    v_exp_f32 v116, v116 clamp
    v_exp_f32 v117, v117 clamp
    v_max_f32 v156, s54, v156
    v_max_f32 v157, s54, v157
    v_pk_add_f32 v[156:157], v[156:157], v[116:117]
    v_cvt_pk_bf16_f32 v206, v156, v157
    v_pk_fma_f32 v[158:159], v[34:35], v[242:243], v[158:159] op_sel:[0,1,0] op_sel_hi:[1,1,1]
    v_pk_mul_f32 v[118:119], v[158:159], v[250:251] op_sel:[0,1] op_sel_hi:[1,1]
    v_pk_fma_f32 v[158:159], v[158:159], v[246:247], s[54:55] op_sel:[0,1,0] op_sel_hi:[1,1,1]
    v_exp_f32 v118, v118 clamp
    v_exp_f32 v119, v119 clamp
    v_max_f32 v158, s54, v158
    v_max_f32 v159, s54, v159
    v_pk_add_f32 v[158:159], v[158:159], v[118:119]
    v_cvt_pk_bf16_f32 v207, v158, v159
    s_lshr_b32 s62, s3, 2
    s_lshl_b32 s53, s51, 3
    s_lshl_b32 s86, s48, 1
    s_add_u32 s53, s53, s86
    s_add_u32 s53, s53, s62
    v_lshrrev_b32 v36, 4, v0
    v_and_b32 v37, 15, v0
    s_lshl_b32 s87, s53, 15
    s_lshl_b32 s86, s62, 14
    s_add_u32 s86, s86, s87
    s_add_u32 s86, s86, 1048576
    v_lshl_add_u32 v157, v0, 4, s86
    v_xor_b32 v158, 0x8000, v157
    s_lshl_b32 s86, s51, 1
    s_lshr_b32 s87, s48, 1
    s_add_u32 s86, s86, s87
    s_lshl_b32 s86, s86, 1
    s_add_u32 s86, s86, s62
    s_lshl_b32 s86, s86, 1
    s_and_b32 s87, s48, 1
    s_add_u32 s86, s86, s87
    s_lshl_b32 s86, s86, 7
    s_add_u32 s86, s86, 688128
    v_lshl_add_u32 v159, v0, 2, s86
    v_mov_b32 v38, 2147483648
    v_cmp_gt_u32 vcc, 16, v0
    s_nop 1
    v_cndmask_b32 v159, v38, v159, vcc
    v_bfe_u32 v38, v0, 2, 2
    v_lshl_add_u32 v38, v36, 2, v38
    v_bfe_u32 v39, v38, 1, 2
    v_lshlrev_b32 v38, 7, v38
    v_lshl_add_u32 v38, v39, 5, v38
    v_and_b32 v39, 3, v0
    v_lshl_add_u32 v38, v39, 3, v38
    s_lshl_b32 s86, s62, 16
    s_add_u32 s86, s86, 0
    v_add_u32 v144, s86, v38
    v_xor_b32 v145, 32, v144
    v_xor_b32 v146, 64, v144
    v_xor_b32 v147, 96, v144
    v_cmp_eq_u32 s[4:5], 1, v39
    v_cmp_eq_u32 s[6:7], 2, v39
    v_cmp_eq_u32 s[98:99], 3, v39
    s_lshl_b32 s86, s53, 10
    s_add_u32 s86, s86, 786432
    v_lshl_add_u32 v160, v0, 2, s86
    v_mul_u32_u24 v161, 192, v36
    v_add_u32 v160, v160, v161
    s_mov_b32 s72, 0x00f0000f
    s_mov_b32 s73, 0xf0000f00
    s_mov_b32 s74, 0x0f00f000
    s_mov_b32 s75, 0x0f00f000
    v_lshrrev_b32 v38, 2, v37
    v_lshl_add_u32 v161, v38, 4, v37
    v_lshlrev_b32 v161, 2, v161
    s_lshl_b32 s86, s3, 12
    s_add_u32 s86, s86, 131072
    v_lshl_add_u32 v162, v0, 4, s86
    v_xor_b32 v163, 0x4000, v162
    s_lshl_b32 s86, s52, 7
    v_lshl_add_u32 v36, v36, 3, s86
    s_lshl_b32 s87, s53, 15
L_walk_14:
    s_cbranch_execz L_walk_18
    s_add_u32 s87, s87, s86
    s_lshl_b32 s86, s62, 6
    s_add_u32 s87, s87, s86
    v_lshl_add_u32 v39, v37, 11, s87
    v_and_b32 v38, 48, v0
    v_add_u32 v39, v39, v38
    v_xor_b32 v37, 0x8000, v39
    buffer_load_dwordx4 v[136:139], v39, s[8:11], 0 offen
    buffer_load_dwordx4 v[140:143], v37, s[8:11], 0 offen
    buffer_load_dwordx2 v[148:149], v36, s[40:43], 0 offen offset:0
    buffer_load_dwordx2 v[150:151], v36, s[40:43], 0 offen offset:32
    buffer_load_dwordx2 v[152:153], v36, s[40:43], 0 offen offset:64
    buffer_load_dwordx2 v[154:155], v36, s[40:43], 0 offen offset:96
    s_barrier
    ds_read_b128 v[40:43], v11 offset:0
    ds_read_b128 v[44:47], v11 offset:1024
    ds_read_b128 v[48:51], v11 offset:2048
    v_mov_b32 v38, 135200
    ds_read_b32 v38, v38
    s_mov_b32 s86, 0x8000
    s_mov_b32 s87, 0x10000
    s_mov_b32 s88, 0x18000
    s_waitcnt lgkmcnt(0)
    v_mfma_f32_16x16x32_bf16 v[216:219], v[48:51], v[192:195], 0
    v_mfma_f32_16x16x32_bf16 v[208:211], v[40:43], v[192:195], 0
    v_mfma_f32_16x16x32_bf16 v[212:215], v[44:47], v[192:195], 0
    v_mfma_f32_16x16x32_bf16 v[228:231], v[48:51], v[196:199], 0
    v_mfma_f32_16x16x32_bf16 v[220:223], v[40:43], v[196:199], 0
    v_mfma_f32_16x16x32_bf16 v[224:227], v[44:47], v[196:199], 0
    v_mfma_f32_16x16x32_bf16 v[240:243], v[48:51], v[200:203], 0
    v_mfma_f32_16x16x32_bf16 v[232:235], v[40:43], v[200:203], 0
    v_mfma_f32_16x16x32_bf16 v[236:239], v[44:47], v[200:203], 0
    v_mfma_f32_16x16x32_bf16 v[252:255], v[48:51], v[204:207], 0
    v_mfma_f32_16x16x32_bf16 v[244:247], v[40:43], v[204:207], 0
    v_mfma_f32_16x16x32_bf16 v[248:251], v[44:47], v[204:207], 0
    v_add_f32 v216, s54, v216
    v_rcp_f32 v216, v216
    s_nop 0
    v_pk_mul_f32 v[208:209], v[208:209], v[216:217] op_sel_hi:[1,0]
    v_pk_mul_f32 v[210:211], v[210:211], v[216:217] op_sel_hi:[1,0]
    v_pk_mul_f32 v[212:213], v[212:213], v[216:217] op_sel_hi:[1,0]
    v_pk_mul_f32 v[214:215], v[214:215], v[216:217] op_sel_hi:[1,0]
    v_cvt_pk_bf16_f32 v60, v208, v209
    v_cvt_pk_bf16_f32 v61, v210, v211
    v_cvt_pk_bf16_f32 v62, v212, v213
    v_cvt_pk_bf16_f32 v63, v214, v215
    buffer_store_dwordx4 v[60:63], v10, s[16:19], 0 offen sc1
    v_add_f32 v228, s54, v228
    v_rcp_f32 v228, v228
    s_nop 0
    v_pk_mul_f32 v[220:221], v[220:221], v[228:229] op_sel_hi:[1,0]
    v_pk_mul_f32 v[222:223], v[222:223], v[228:229] op_sel_hi:[1,0]
    v_pk_mul_f32 v[224:225], v[224:225], v[228:229] op_sel_hi:[1,0]
    v_pk_mul_f32 v[226:227], v[226:227], v[228:229] op_sel_hi:[1,0]
    v_cvt_pk_bf16_f32 v64, v220, v221
    v_cvt_pk_bf16_f32 v65, v222, v223
    v_cvt_pk_bf16_f32 v66, v224, v225
    v_cvt_pk_bf16_f32 v67, v226, v227
    buffer_store_dwordx4 v[64:67], v10, s[16:19], s86 offen sc1
    v_add_f32 v240, s54, v240
    v_rcp_f32 v240, v240
    s_nop 0
    v_pk_mul_f32 v[232:233], v[232:233], v[240:241] op_sel_hi:[1,0]
    v_pk_mul_f32 v[234:235], v[234:235], v[240:241] op_sel_hi:[1,0]
    v_pk_mul_f32 v[236:237], v[236:237], v[240:241] op_sel_hi:[1,0]
    v_pk_mul_f32 v[238:239], v[238:239], v[240:241] op_sel_hi:[1,0]
    v_cvt_pk_bf16_f32 v68, v232, v233
    v_cvt_pk_bf16_f32 v69, v234, v235
    v_cvt_pk_bf16_f32 v70, v236, v237
    v_cvt_pk_bf16_f32 v71, v238, v239
    buffer_store_dwordx4 v[68:71], v10, s[16:19], s87 offen sc1
    v_add_f32 v252, s54, v252
    v_rcp_f32 v252, v252
    s_nop 0
    v_pk_mul_f32 v[244:245], v[244:245], v[252:253] op_sel_hi:[1,0]
    v_pk_mul_f32 v[246:247], v[246:247], v[252:253] op_sel_hi:[1,0]
    v_pk_mul_f32 v[248:249], v[248:249], v[252:253] op_sel_hi:[1,0]
    v_pk_mul_f32 v[250:251], v[250:251], v[252:253] op_sel_hi:[1,0]
    v_cvt_pk_bf16_f32 v72, v244, v245
    v_cvt_pk_bf16_f32 v73, v246, v247
    v_cvt_pk_bf16_f32 v74, v248, v249
    v_cvt_pk_bf16_f32 v75, v250, v251
    buffer_store_dwordx4 v[72:75], v10, s[16:19], s88 offen sc1
    buffer_atomic_swap v17, v18, s[16:19], 0 offen sc1
    v_mov_b32 v8, 0
    buffer_atomic_or v8, v159, s[16:19], 0 offen sc0 sc1
    v_mov_b32 v14, 2147483648
    v_mov_b32 v11, 2147483648
    s_waitcnt vmcnt(6)
    v_bfe_u32 v36, v0, 2, 1
    v_cmp_eq_u32 vcc, 1, v36
    v_mov_b32 v36, s95
    s_nop 0
    v_cndmask_b32 v148, v36, v148, vcc
    v_cndmask_b32 v149, v36, v149, vcc
    v_cndmask_b32 v150, v36, v150, vcc
    v_cndmask_b32 v151, v36, v151, vcc
    v_cndmask_b32 v152, v36, v152, vcc
    v_cndmask_b32 v153, v36, v153, vcc
    v_cndmask_b32 v154, v36, v154, vcc
    v_cndmask_b32 v155, v36, v155, vcc
    v_readfirstlane_b32 s57, v38
L_phaseB:
    v_lshrrev_b32 v1, 4, v0
    v_and_b32 v2, 15, v0
    v_mov_b32 v3, 0x3f80
    s_lshl_b32 s87, s53, 4
    v_add_u32 v6, s87, v2
    s_lshl_b32 s86, s52, 7
    v_lshl_add_u32 v5, v6, 11, s86
    v_sub_u32 v6, 2047, v6
    v_mov_b32 v7, v39
    v_lshrrev_b32 v9, 1, v1
    v_lshl_add_u32 v5, v9, 4, v5
    v_and_b32 v9, 1, v1
    v_lshl_add_u32 v5, v9, 5, v5
    s_mov_b32 s67, 0
    s_mov_b32 s66, 0xffffaaaa
    s_mov_b32 s63, 0
L_b_init:
    v_bfe_u32 v9, v0, 3, 1
    v_bfe_u32 v10, v0, 4, 1
    v_xor_b32 v9, v9, v10
    v_bfe_u32 v10, v0, 1, 2
    v_lshl_add_u32 v9, v9, 3, v10
    v_lshrrev_b32 v10, 5, v0
    v_lshl_add_u32 v9, v10, 2, v9
    v_and_b32 v10, 1, v0
    v_lshlrev_b32 v10, 4, v10
    v_lshlrev_b32 v10, v10, v3
    v_cmp_eq_u32 vcc, 0, v9
    s_nop 1
    v_cndmask_b32 v128, 0, v10, vcc
    v_cmp_eq_u32 vcc, 1, v9
    s_nop 1
    v_cndmask_b32 v129, 0, v10, vcc
    v_cmp_eq_u32 vcc, 2, v9
    s_nop 1
    v_cndmask_b32 v130, 0, v10, vcc
    v_cmp_eq_u32 vcc, 3, v9
    s_nop 1
    v_cndmask_b32 v131, 0, v10, vcc
    v_cmp_eq_u32 vcc, 4, v9
    s_nop 1
    v_cndmask_b32 v132, 0, v10, vcc
    v_cmp_eq_u32 vcc, 5, v9
    s_nop 1
    v_cndmask_b32 v133, 0, v10, vcc
    v_cmp_eq_u32 vcc, 6, v9
    s_nop 1
    v_cndmask_b32 v134, 0, v10, vcc
    v_cmp_eq_u32 vcc, 7, v9
    s_nop 1
    v_cndmask_b32 v135, 0, v10, vcc
    v_mov_b32 v80, 0
    v_mov_b32 v81, 0
    v_mov_b32 v82, 0
    v_mov_b32 v83, 0
    v_mov_b32 v84, 0
    v_mov_b32 v85, 0
    v_mov_b32 v86, 0
    v_mov_b32 v87, 0
    v_mov_b32 v88, 0
    v_mov_b32 v89, 0
    v_mov_b32 v90, 0
    v_mov_b32 v91, 0
    v_mov_b32 v92, 0
    v_mov_b32 v93, 0
    v_mov_b32 v94, 0
    v_mov_b32 v95, 0
    v_mov_b32 v96, 0
    v_mov_b32 v97, 0
    v_mov_b32 v98, 0
    v_mov_b32 v99, 0
    v_mov_b32 v100, 0
    v_mov_b32 v101, 0
    v_mov_b32 v102, 0
    v_mov_b32 v103, 0
    v_mov_b32 v104, 0
    v_mov_b32 v105, 0
    v_mov_b32 v106, 0
    v_mov_b32 v107, 0
    v_mov_b32 v108, 0
    v_mov_b32 v109, 0
    v_mov_b32 v110, 0
    v_mov_b32 v111, 0
    v_mov_b32 v156, 0
    s_branch L_b_w0
L_b_r0:
    s_ff1_i32_b32 s91, s65
    s_bitset0_b32 s65, s91
    s_lshl_b32 s76, s91, 12
    s_lshl_b32 s91, s91, 10
    buffer_load_dwordx4 v[16:19], v157, s[16:19], s91 offen offset:0 sc1
L_walk_15:
    s_cbranch_execz L_walk_19
    buffer_load_dwordx4 v[20:23], v158, s[16:19], s91 offen offset:0 sc1
    buffer_load_dwordx4 v[24:27], v157, s[16:19], s91 offen offset:1024 sc1
    buffer_load_dwordx4 v[28:31], v158, s[16:19], s91 offen offset:1024 sc1
    s_cmp_eq_u32 s65, 0
    s_cbranch_scc1 L_b_p1
L_b_r1:
    s_ff1_i32_b32 s91, s65
    s_bitset0_b32 s65, s91
    s_lshl_b32 s77, s91, 12
    s_lshl_b32 s91, s91, 10
    buffer_load_dwordx4 v[32:35], v157, s[16:19], s91 offen offset:0 sc1
    buffer_load_dwordx4 v[36:39], v158, s[16:19], s91 offen offset:0 sc1
    buffer_load_dwordx4 v[40:43], v157, s[16:19], s91 offen offset:1024 sc1
    buffer_load_dwordx4 v[44:47], v158, s[16:19], s91 offen offset:1024 sc1
    s_xor_b32 s89, s67, s76
    s_mov_b32 s67, s76
    v_xor_b32 v144, s89, v144
    ds_read_b64_tr_b16 v[112:113], v144 offset:0
    ds_read_b64_tr_b16 v[114:115], v144 offset:2048
    v_xor_b32 v145, s89, v145
    ds_read_b64_tr_b16 v[116:117], v145 offset:0
    ds_read_b64_tr_b16 v[118:119], v145 offset:2048
    v_xor_b32 v146, s89, v146
    ds_read_b64_tr_b16 v[120:121], v146 offset:0
    ds_read_b64_tr_b16 v[122:123], v146 offset:2048
    v_xor_b32 v147, s89, v147
    ds_read_b64_tr_b16 v[124:125], v147 offset:0
    ds_read_b64_tr_b16 v[126:127], v147 offset:2048
    s_cmp_eq_u32 s62, 0
    s_cbranch_scc0 L_b_x1
    v_mfma_f32_16x16x32_bf16 v[80:83], v[128:131], v[136:139], 0
    v_mfma_f32_16x16x32_bf16 v[96:99], v[128:131], v[140:143], 0
    v_mfma_f32_16x16x32_bf16 v[84:87], v[132:135], v[136:139], 0
    v_mfma_f32_16x16x32_bf16 v[100:103], v[132:135], v[140:143], 0
    s_branch L_b_xd
L_b_x1:
    v_mfma_f32_16x16x32_bf16 v[88:91], v[128:131], v[136:139], 0
    v_mfma_f32_16x16x32_bf16 v[104:107], v[128:131], v[140:143], 0
    v_mfma_f32_16x16x32_bf16 v[92:95], v[132:135], v[136:139], 0
    v_mfma_f32_16x16x32_bf16 v[108:111], v[132:135], v[140:143], 0
L_b_xd:
    s_waitcnt vmcnt(6) lgkmcnt(6)
    v_max3_u32 v156, v156, v19, v23
    v_mfma_f32_16x16x32_bf16 v[80:83], v[112:115], v[16:19], v[80:83]
    ds_read_b64_tr_b16 v[128:129], v144 offset:4096
    v_mfma_f32_16x16x32_bf16 v[96:99], v[112:115], v[20:23], v[96:99]
    ds_read_b64_tr_b16 v[130:131], v144 offset:6144
    s_waitcnt lgkmcnt(6)
    v_mfma_f32_16x16x32_bf16 v[84:87], v[116:119], v[16:19], v[84:87]
    ds_read_b64_tr_b16 v[132:133], v145 offset:4096
    v_mfma_f32_16x16x32_bf16 v[100:103], v[116:119], v[20:23], v[100:103]
    ds_read_b64_tr_b16 v[134:135], v145 offset:6144
    s_waitcnt lgkmcnt(6)
    v_mfma_f32_16x16x32_bf16 v[88:91], v[120:123], v[16:19], v[88:91]
    ds_read_b64_tr_b16 v[136:137], v146 offset:4096
    v_mfma_f32_16x16x32_bf16 v[104:107], v[120:123], v[20:23], v[104:107]
    ds_read_b64_tr_b16 v[138:139], v146 offset:6144
    s_waitcnt lgkmcnt(6)
    v_mfma_f32_16x16x32_bf16 v[92:95], v[124:127], v[16:19], v[92:95]
    ds_read_b64_tr_b16 v[140:141], v147 offset:4096
    v_mfma_f32_16x16x32_bf16 v[108:111], v[124:127], v[20:23], v[108:111]
    ds_read_b64_tr_b16 v[142:143], v147 offset:6144
    s_cmp_eq_u32 s65, 0
    s_cbranch_scc1 L_b_p2
L_b_r2:
    s_ff1_i32_b32 s91, s65
    s_bitset0_b32 s65, s91
    s_lshl_b32 s78, s91, 12
    s_lshl_b32 s91, s91, 10
    buffer_load_dwordx4 v[48:51], v157, s[16:19], s91 offen offset:0 sc1
    buffer_load_dwordx4 v[52:55], v158, s[16:19], s91 offen offset:0 sc1
    s_waitcnt vmcnt(6) lgkmcnt(6)
    v_max3_u32 v156, v156, v27, v31
    v_mfma_f32_16x16x32_bf16 v[80:83], v[128:131], v[24:27], v[80:83]
    s_xor_b32 s89, s67, s77
    s_mov_b32 s67, s77
    v_xor_b32 v144, s89, v144
    ds_read_b64_tr_b16 v[112:113], v144 offset:0
    v_mfma_f32_16x16x32_bf16 v[96:99], v[128:131], v[28:31], v[96:99]
    ds_read_b64_tr_b16 v[114:115], v144 offset:2048
    s_waitcnt lgkmcnt(6)
    v_mfma_f32_16x16x32_bf16 v[84:87], v[132:135], v[24:27], v[84:87]
    v_xor_b32 v145, s89, v145
    ds_read_b64_tr_b16 v[116:117], v145 offset:0
    v_mfma_f32_16x16x32_bf16 v[100:103], v[132:135], v[28:31], v[100:103]
    ds_read_b64_tr_b16 v[118:119], v145 offset:2048
    s_waitcnt lgkmcnt(6)
    v_mfma_f32_16x16x32_bf16 v[88:91], v[136:139], v[24:27], v[88:91]
    v_xor_b32 v146, s89, v146
    ds_read_b64_tr_b16 v[120:121], v146 offset:0
    v_mfma_f32_16x16x32_bf16 v[104:107], v[136:139], v[28:31], v[104:107]
    ds_read_b64_tr_b16 v[122:123], v146 offset:2048
    s_waitcnt lgkmcnt(6)
    v_mfma_f32_16x16x32_bf16 v[92:95], v[140:143], v[24:27], v[92:95]
    v_xor_b32 v147, s89, v147
    ds_read_b64_tr_b16 v[124:125], v147 offset:0
    v_mfma_f32_16x16x32_bf16 v[108:111], v[140:143], v[28:31], v[108:111]
    ds_read_b64_tr_b16 v[126:127], v147 offset:2048
    buffer_load_dwordx4 v[56:59], v157, s[16:19], s91 offen offset:1024 sc1
    buffer_load_dwordx4 v[60:63], v158, s[16:19], s91 offen offset:1024 sc1
    s_waitcnt vmcnt(6) lgkmcnt(6)
    v_max3_u32 v156, v156, v35, v39
    v_mfma_f32_16x16x32_bf16 v[80:83], v[112:115], v[32:35], v[80:83]
    ds_read_b64_tr_b16 v[128:129], v144 offset:4096
    v_mfma_f32_16x16x32_bf16 v[96:99], v[112:115], v[36:39], v[96:99]
    ds_read_b64_tr_b16 v[130:131], v144 offset:6144
    s_waitcnt lgkmcnt(6)
    v_mfma_f32_16x16x32_bf16 v[84:87], v[116:119], v[32:35], v[84:87]
    ds_read_b64_tr_b16 v[132:133], v145 offset:4096
    v_mfma_f32_16x16x32_bf16 v[100:103], v[116:119], v[36:39], v[100:103]
    ds_read_b64_tr_b16 v[134:135], v145 offset:6144
    s_waitcnt lgkmcnt(6)
    v_mfma_f32_16x16x32_bf16 v[88:91], v[120:123], v[32:35], v[88:91]
    ds_read_b64_tr_b16 v[136:137], v146 offset:4096
    v_mfma_f32_16x16x32_bf16 v[104:107], v[120:123], v[36:39], v[104:107]
    ds_read_b64_tr_b16 v[138:139], v146 offset:6144
    s_waitcnt lgkmcnt(6)
    v_mfma_f32_16x16x32_bf16 v[92:95], v[124:127], v[32:35], v[92:95]
    ds_read_b64_tr_b16 v[140:141], v147 offset:4096
    v_mfma_f32_16x16x32_bf16 v[108:111], v[124:127], v[36:39], v[108:111]
    ds_read_b64_tr_b16 v[142:143], v147 offset:6144
    s_cmp_eq_u32 s65, 0
    s_cbranch_scc1 L_b_p3
L_b_r3:
    s_ff1_i32_b32 s91, s65
    s_bitset0_b32 s65, s91
    s_lshl_b32 s79, s91, 12
    s_lshl_b32 s91, s91, 10
    buffer_load_dwordx4 v[64:67], v157, s[16:19], s91 offen offset:0 sc1
    buffer_load_dwordx4 v[68:71], v158, s[16:19], s91 offen offset:0 sc1
    s_waitcnt vmcnt(6) lgkmcnt(6)
    v_max3_u32 v156, v156, v43, v47
    v_mfma_f32_16x16x32_bf16 v[80:83], v[128:131], v[40:43], v[80:83]
    s_xor_b32 s89, s67, s78
    s_mov_b32 s67, s78
    v_xor_b32 v144, s89, v144
    ds_read_b64_tr_b16 v[112:113], v144 offset:0
    v_mfma_f32_16x16x32_bf16 v[96:99], v[128:131], v[44:47], v[96:99]
    ds_read_b64_tr_b16 v[114:115], v144 offset:2048
    s_waitcnt lgkmcnt(6)
    v_mfma_f32_16x16x32_bf16 v[84:87], v[132:135], v[40:43], v[84:87]
    v_xor_b32 v145, s89, v145
    ds_read_b64_tr_b16 v[116:117], v145 offset:0
    v_mfma_f32_16x16x32_bf16 v[100:103], v[132:135], v[44:47], v[100:103]
    ds_read_b64_tr_b16 v[118:119], v145 offset:2048
    s_waitcnt lgkmcnt(6)
    v_mfma_f32_16x16x32_bf16 v[88:91], v[136:139], v[40:43], v[88:91]
    v_xor_b32 v146, s89, v146
    ds_read_b64_tr_b16 v[120:121], v146 offset:0
    v_mfma_f32_16x16x32_bf16 v[104:107], v[136:139], v[44:47], v[104:107]
    ds_read_b64_tr_b16 v[122:123], v146 offset:2048
    s_waitcnt lgkmcnt(6)
    v_mfma_f32_16x16x32_bf16 v[92:95], v[140:143], v[40:43], v[92:95]
    v_xor_b32 v147, s89, v147
    ds_read_b64_tr_b16 v[124:125], v147 offset:0
    v_mfma_f32_16x16x32_bf16 v[108:111], v[140:143], v[44:47], v[108:111]
    ds_read_b64_tr_b16 v[126:127], v147 offset:2048
    buffer_load_dwordx4 v[72:75], v157, s[16:19], s91 offen offset:1024 sc1
    buffer_load_dwordx4 v[76:79], v158, s[16:19], s91 offen offset:1024 sc1
    s_waitcnt vmcnt(6) lgkmcnt(6)
    v_max3_u32 v156, v156, v51, v55
    v_mfma_f32_16x16x32_bf16 v[80:83], v[112:115], v[48:51], v[80:83]
    ds_read_b64_tr_b16 v[128:129], v144 offset:4096
    v_mfma_f32_16x16x32_bf16 v[96:99], v[112:115], v[52:55], v[96:99]
    ds_read_b64_tr_b16 v[130:131], v144 offset:6144
    s_waitcnt lgkmcnt(6)
    v_mfma_f32_16x16x32_bf16 v[84:87], v[116:119], v[48:51], v[84:87]
    ds_read_b64_tr_b16 v[132:133], v145 offset:4096
    v_mfma_f32_16x16x32_bf16 v[100:103], v[116:119], v[52:55], v[100:103]
L_walk_16:
    s_cbranch_execz L_walk_20
    ds_read_b64_tr_b16 v[134:135], v145 offset:6144
    s_waitcnt lgkmcnt(6)
    v_mfma_f32_16x16x32_bf16 v[88:91], v[120:123], v[48:51], v[88:91]
    ds_read_b64_tr_b16 v[136:137], v146 offset:4096
    v_mfma_f32_16x16x32_bf16 v[104:107], v[120:123], v[52:55], v[104:107]
    ds_read_b64_tr_b16 v[138:139], v146 offset:6144
    s_waitcnt lgkmcnt(6)
    v_mfma_f32_16x16x32_bf16 v[92:95], v[124:127], v[48:51], v[92:95]
    ds_read_b64_tr_b16 v[140:141], v147 offset:4096
    v_mfma_f32_16x16x32_bf16 v[108:111], v[124:127], v[52:55], v[108:111]
    ds_read_b64_tr_b16 v[142:143], v147 offset:6144
    s_cmp_eq_u32 s65, 0
    s_cbranch_scc1 L_b_p4
L_b_r4:
    s_ff1_i32_b32 s91, s65
    s_bitset0_b32 s65, s91
    s_lshl_b32 s76, s91, 12
    s_lshl_b32 s91, s91, 10
    buffer_load_dwordx4 v[16:19], v157, s[16:19], s91 offen offset:0 sc1
    buffer_load_dwordx4 v[20:23], v158, s[16:19], s91 offen offset:0 sc1
    s_waitcnt vmcnt(6) lgkmcnt(6)
    v_max3_u32 v156, v156, v59, v63
    v_mfma_f32_16x16x32_bf16 v[80:83], v[128:131], v[56:59], v[80:83]
    s_xor_b32 s89, s67, s79
    s_mov_b32 s67, s79
    v_xor_b32 v144, s89, v144
    ds_read_b64_tr_b16 v[112:113], v144 offset:0
    v_mfma_f32_16x16x32_bf16 v[96:99], v[128:131], v[60:63], v[96:99]
    ds_read_b64_tr_b16 v[114:115], v144 offset:2048
    s_waitcnt lgkmcnt(6)
    v_mfma_f32_16x16x32_bf16 v[84:87], v[132:135], v[56:59], v[84:87]
    v_xor_b32 v145, s89, v145
    ds_read_b64_tr_b16 v[116:117], v145 offset:0
    v_mfma_f32_16x16x32_bf16 v[100:103], v[132:135], v[60:63], v[100:103]
    ds_read_b64_tr_b16 v[118:119], v145 offset:2048
    s_waitcnt lgkmcnt(6)
    v_mfma_f32_16x16x32_bf16 v[88:91], v[136:139], v[56:59], v[88:91]
    v_xor_b32 v146, s89, v146
    ds_read_b64_tr_b16 v[120:121], v146 offset:0
    v_mfma_f32_16x16x32_bf16 v[104:107], v[136:139], v[60:63], v[104:107]
    ds_read_b64_tr_b16 v[122:123], v146 offset:2048
    s_waitcnt lgkmcnt(6)
    v_mfma_f32_16x16x32_bf16 v[92:95], v[140:143], v[56:59], v[92:95]
    v_xor_b32 v147, s89, v147
    ds_read_b64_tr_b16 v[124:125], v147 offset:0
    v_mfma_f32_16x16x32_bf16 v[108:111], v[140:143], v[60:63], v[108:111]
    ds_read_b64_tr_b16 v[126:127], v147 offset:2048
    buffer_load_dwordx4 v[24:27], v157, s[16:19], s91 offen offset:1024 sc1
    buffer_load_dwordx4 v[28:31], v158, s[16:19], s91 offen offset:1024 sc1
    s_waitcnt vmcnt(6) lgkmcnt(6)
    v_max3_u32 v156, v156, v67, v71
    v_mfma_f32_16x16x32_bf16 v[80:83], v[112:115], v[64:67], v[80:83]
    ds_read_b64_tr_b16 v[128:129], v144 offset:4096
    v_mfma_f32_16x16x32_bf16 v[96:99], v[112:115], v[68:71], v[96:99]
    ds_read_b64_tr_b16 v[130:131], v144 offset:6144
    s_waitcnt lgkmcnt(6)
    v_mfma_f32_16x16x32_bf16 v[84:87], v[116:119], v[64:67], v[84:87]
    ds_read_b64_tr_b16 v[132:133], v145 offset:4096
    v_mfma_f32_16x16x32_bf16 v[100:103], v[116:119], v[68:71], v[100:103]
    ds_read_b64_tr_b16 v[134:135], v145 offset:6144
    s_waitcnt lgkmcnt(6)
    v_mfma_f32_16x16x32_bf16 v[88:91], v[120:123], v[64:67], v[88:91]
    ds_read_b64_tr_b16 v[136:137], v146 offset:4096
    v_mfma_f32_16x16x32_bf16 v[104:107], v[120:123], v[68:71], v[104:107]
    ds_read_b64_tr_b16 v[138:139], v146 offset:6144
    s_waitcnt lgkmcnt(6)
    v_mfma_f32_16x16x32_bf16 v[92:95], v[124:127], v[64:67], v[92:95]
    ds_read_b64_tr_b16 v[140:141], v147 offset:4096
    v_mfma_f32_16x16x32_bf16 v[108:111], v[124:127], v[68:71], v[108:111]
    ds_read_b64_tr_b16 v[142:143], v147 offset:6144
    s_cmp_eq_u32 s65, 0
    s_cbranch_scc1 L_b_p5
L_b_r5:
    s_ff1_i32_b32 s91, s65
    s_bitset0_b32 s65, s91
    s_lshl_b32 s77, s91, 12
    s_lshl_b32 s91, s91, 10
    buffer_load_dwordx4 v[32:35], v157, s[16:19], s91 offen offset:0 sc1
    buffer_load_dwordx4 v[36:39], v158, s[16:19], s91 offen offset:0 sc1
    s_waitcnt vmcnt(6) lgkmcnt(6)
    v_max3_u32 v156, v156, v75, v79
    v_mfma_f32_16x16x32_bf16 v[80:83], v[128:131], v[72:75], v[80:83]
    s_xor_b32 s89, s67, s76
    s_mov_b32 s67, s76
    v_xor_b32 v144, s89, v144
    ds_read_b64_tr_b16 v[112:113], v144 offset:0
    v_mfma_f32_16x16x32_bf16 v[96:99], v[128:131], v[76:79], v[96:99]
    ds_read_b64_tr_b16 v[114:115], v144 offset:2048
    s_waitcnt lgkmcnt(6)
    v_mfma_f32_16x16x32_bf16 v[84:87], v[132:135], v[72:75], v[84:87]
    v_xor_b32 v145, s89, v145
    ds_read_b64_tr_b16 v[116:117], v145 offset:0
    v_mfma_f32_16x16x32_bf16 v[100:103], v[132:135], v[76:79], v[100:103]
    ds_read_b64_tr_b16 v[118:119], v145 offset:2048
    s_waitcnt lgkmcnt(6)
    v_mfma_f32_16x16x32_bf16 v[88:91], v[136:139], v[72:75], v[88:91]
    v_xor_b32 v146, s89, v146
    ds_read_b64_tr_b16 v[120:121], v146 offset:0
    v_mfma_f32_16x16x32_bf16 v[104:107], v[136:139], v[76:79], v[104:107]
    ds_read_b64_tr_b16 v[122:123], v146 offset:2048
    s_waitcnt lgkmcnt(6)
    v_mfma_f32_16x16x32_bf16 v[92:95], v[140:143], v[72:75], v[92:95]
    v_xor_b32 v147, s89, v147
    ds_read_b64_tr_b16 v[124:125], v147 offset:0
    v_mfma_f32_16x16x32_bf16 v[108:111], v[140:143], v[76:79], v[108:111]
    ds_read_b64_tr_b16 v[126:127], v147 offset:2048
    buffer_load_dwordx4 v[40:43], v157, s[16:19], s91 offen offset:1024 sc1
    buffer_load_dwordx4 v[44:47], v158, s[16:19], s91 offen offset:1024 sc1
    s_waitcnt vmcnt(6) lgkmcnt(6)
    v_max3_u32 v156, v156, v19, v23
    v_mfma_f32_16x16x32_bf16 v[80:83], v[112:115], v[16:19], v[80:83]
    ds_read_b64_tr_b16 v[128:129], v144 offset:4096
    v_mfma_f32_16x16x32_bf16 v[96:99], v[112:115], v[20:23], v[96:99]
    ds_read_b64_tr_b16 v[130:131], v144 offset:6144
    s_waitcnt lgkmcnt(6)
    v_mfma_f32_16x16x32_bf16 v[84:87], v[116:119], v[16:19], v[84:87]
    ds_read_b64_tr_b16 v[132:133], v145 offset:4096
    v_mfma_f32_16x16x32_bf16 v[100:103], v[116:119], v[20:23], v[100:103]
    ds_read_b64_tr_b16 v[134:135], v145 offset:6144
    s_waitcnt lgkmcnt(6)
    v_mfma_f32_16x16x32_bf16 v[88:91], v[120:123], v[16:19], v[88:91]
    ds_read_b64_tr_b16 v[136:137], v146 offset:4096
    v_mfma_f32_16x16x32_bf16 v[104:107], v[120:123], v[20:23], v[104:107]
    ds_read_b64_tr_b16 v[138:139], v146 offset:6144
    s_waitcnt lgkmcnt(6)
    v_mfma_f32_16x16x32_bf16 v[92:95], v[124:127], v[16:19], v[92:95]
    ds_read_b64_tr_b16 v[140:141], v147 offset:4096
    v_mfma_f32_16x16x32_bf16 v[108:111], v[124:127], v[20:23], v[108:111]
    ds_read_b64_tr_b16 v[142:143], v147 offset:6144
    s_cmp_eq_u32 s65, 0
    s_cbranch_scc1 L_b_p6
L_b_r6:
    s_ff1_i32_b32 s91, s65
    s_bitset0_b32 s65, s91
    s_lshl_b32 s78, s91, 12
    s_lshl_b32 s91, s91, 10
    buffer_load_dwordx4 v[48:51], v157, s[16:19], s91 offen offset:0 sc1
    buffer_load_dwordx4 v[52:55], v158, s[16:19], s91 offen offset:0 sc1
    s_waitcnt vmcnt(6) lgkmcnt(6)
    v_max3_u32 v156, v156, v27, v31
    v_mfma_f32_16x16x32_bf16 v[80:83], v[128:131], v[24:27], v[80:83]
    s_xor_b32 s89, s67, s77
    s_mov_b32 s67, s77
    v_xor_b32 v144, s89, v144
    ds_read_b64_tr_b16 v[112:113], v144 offset:0
    v_mfma_f32_16x16x32_bf16 v[96:99], v[128:131], v[28:31], v[96:99]
    ds_read_b64_tr_b16 v[114:115], v144 offset:2048
    s_waitcnt lgkmcnt(6)
    v_mfma_f32_16x16x32_bf16 v[84:87], v[132:135], v[24:27], v[84:87]
    v_xor_b32 v145, s89, v145
    ds_read_b64_tr_b16 v[116:117], v145 offset:0
    v_mfma_f32_16x16x32_bf16 v[100:103], v[132:135], v[28:31], v[100:103]
    ds_read_b64_tr_b16 v[118:119], v145 offset:2048
    s_waitcnt lgkmcnt(6)
    v_mfma_f32_16x16x32_bf16 v[88:91], v[136:139], v[24:27], v[88:91]
    v_xor_b32 v146, s89, v146
    ds_read_b64_tr_b16 v[120:121], v146 offset:0
    v_mfma_f32_16x16x32_bf16 v[104:107], v[136:139], v[28:31], v[104:107]
    ds_read_b64_tr_b16 v[122:123], v146 offset:2048
    s_waitcnt lgkmcnt(6)
    v_mfma_f32_16x16x32_bf16 v[92:95], v[140:143], v[24:27], v[92:95]
    v_xor_b32 v147, s89, v147
    ds_read_b64_tr_b16 v[124:125], v147 offset:0
    v_mfma_f32_16x16x32_bf16 v[108:111], v[140:143], v[28:31], v[108:111]
    ds_read_b64_tr_b16 v[126:127], v147 offset:2048
    buffer_load_dwordx4 v[56:59], v157, s[16:19], s91 offen offset:1024 sc1
    buffer_load_dwordx4 v[60:63], v158, s[16:19], s91 offen offset:1024 sc1
L_walk_17:
    s_cbranch_execz L_walk_21
    s_waitcnt vmcnt(6) lgkmcnt(6)
    v_max3_u32 v156, v156, v35, v39
    v_mfma_f32_16x16x32_bf16 v[80:83], v[112:115], v[32:35], v[80:83]
    ds_read_b64_tr_b16 v[128:129], v144 offset:4096
    v_mfma_f32_16x16x32_bf16 v[96:99], v[112:115], v[36:39], v[96:99]
    ds_read_b64_tr_b16 v[130:131], v144 offset:6144
    s_waitcnt lgkmcnt(6)
    v_mfma_f32_16x16x32_bf16 v[84:87], v[116:119], v[32:35], v[84:87]
    ds_read_b64_tr_b16 v[132:133], v145 offset:4096
    v_mfma_f32_16x16x32_bf16 v[100:103], v[116:119], v[36:39], v[100:103]
    ds_read_b64_tr_b16 v[134:135], v145 offset:6144
    s_waitcnt lgkmcnt(6)
    v_mfma_f32_16x16x32_bf16 v[88:91], v[120:123], v[32:35], v[88:91]
    ds_read_b64_tr_b16 v[136:137], v146 offset:4096
    v_mfma_f32_16x16x32_bf16 v[104:107], v[120:123], v[36:39], v[104:107]
    ds_read_b64_tr_b16 v[138:139], v146 offset:6144
    s_waitcnt lgkmcnt(6)
    v_mfma_f32_16x16x32_bf16 v[92:95], v[124:127], v[32:35], v[92:95]
    ds_read_b64_tr_b16 v[140:141], v147 offset:4096
    v_mfma_f32_16x16x32_bf16 v[108:111], v[124:127], v[36:39], v[108:111]
    ds_read_b64_tr_b16 v[142:143], v147 offset:6144
    s_cmp_eq_u32 s65, 0
    s_cbranch_scc1 L_b_p7
L_b_r7:
    s_ff1_i32_b32 s91, s65
    s_bitset0_b32 s65, s91
    s_lshl_b32 s79, s91, 12
    s_lshl_b32 s91, s91, 10
    buffer_load_dwordx4 v[64:67], v157, s[16:19], s91 offen offset:0 sc1
    buffer_load_dwordx4 v[68:71], v158, s[16:19], s91 offen offset:0 sc1
    s_waitcnt vmcnt(6) lgkmcnt(6)
    v_max3_u32 v156, v156, v43, v47
    v_mfma_f32_16x16x32_bf16 v[80:83], v[128:131], v[40:43], v[80:83]
    s_xor_b32 s89, s67, s78
    s_mov_b32 s67, s78
    v_xor_b32 v144, s89, v144
    ds_read_b64_tr_b16 v[112:113], v144 offset:0
    v_mfma_f32_16x16x32_bf16 v[96:99], v[128:131], v[44:47], v[96:99]
    ds_read_b64_tr_b16 v[114:115], v144 offset:2048
    s_waitcnt lgkmcnt(6)
    v_mfma_f32_16x16x32_bf16 v[84:87], v[132:135], v[40:43], v[84:87]
    v_xor_b32 v145, s89, v145
    ds_read_b64_tr_b16 v[116:117], v145 offset:0
    v_mfma_f32_16x16x32_bf16 v[100:103], v[132:135], v[44:47], v[100:103]
    ds_read_b64_tr_b16 v[118:119], v145 offset:2048
    s_waitcnt lgkmcnt(6)
    v_mfma_f32_16x16x32_bf16 v[88:91], v[136:139], v[40:43], v[88:91]
    v_xor_b32 v146, s89, v146
    ds_read_b64_tr_b16 v[120:121], v146 offset:0
    v_mfma_f32_16x16x32_bf16 v[104:107], v[136:139], v[44:47], v[104:107]
    ds_read_b64_tr_b16 v[122:123], v146 offset:2048
    s_waitcnt lgkmcnt(6)
    v_mfma_f32_16x16x32_bf16 v[92:95], v[140:143], v[40:43], v[92:95]
    v_xor_b32 v147, s89, v147
    ds_read_b64_tr_b16 v[124:125], v147 offset:0
    v_mfma_f32_16x16x32_bf16 v[108:111], v[140:143], v[44:47], v[108:111]
    ds_read_b64_tr_b16 v[126:127], v147 offset:2048
    buffer_load_dwordx4 v[72:75], v157, s[16:19], s91 offen offset:1024 sc1
    buffer_load_dwordx4 v[76:79], v158, s[16:19], s91 offen offset:1024 sc1
    s_waitcnt vmcnt(6) lgkmcnt(6)
    v_max3_u32 v156, v156, v51, v55
    v_mfma_f32_16x16x32_bf16 v[80:83], v[112:115], v[48:51], v[80:83]
    ds_read_b64_tr_b16 v[128:129], v144 offset:4096
    v_mfma_f32_16x16x32_bf16 v[96:99], v[112:115], v[52:55], v[96:99]
    ds_read_b64_tr_b16 v[130:131], v144 offset:6144
    s_mov_b32 s90, 71680
    buffer_load_dwordx4 v[204:207], v11, s[32:35], s90 offen
    s_waitcnt lgkmcnt(6)
    v_mfma_f32_16x16x32_bf16 v[84:87], v[116:119], v[48:51], v[84:87]
    ds_read_b64_tr_b16 v[132:133], v145 offset:4096
    v_mfma_f32_16x16x32_bf16 v[100:103], v[116:119], v[52:55], v[100:103]
    ds_read_b64_tr_b16 v[134:135], v145 offset:6144
    s_waitcnt lgkmcnt(6)
    v_mfma_f32_16x16x32_bf16 v[88:91], v[120:123], v[48:51], v[88:91]
    ds_read_b64_tr_b16 v[136:137], v146 offset:4096
    v_mfma_f32_16x16x32_bf16 v[104:107], v[120:123], v[52:55], v[104:107]
    ds_read_b64_tr_b16 v[138:139], v146 offset:6144
    s_mov_b32 s90, 78848
    buffer_load_dwordx4 v[208:211], v11, s[32:35], s90 offen
    s_waitcnt lgkmcnt(6)
    v_mfma_f32_16x16x32_bf16 v[92:95], v[124:127], v[48:51], v[92:95]
    ds_read_b64_tr_b16 v[140:141], v147 offset:4096
    v_mfma_f32_16x16x32_bf16 v[108:111], v[124:127], v[52:55], v[108:111]
    ds_read_b64_tr_b16 v[142:143], v147 offset:6144
    s_waitcnt vmcnt(6) lgkmcnt(6)
    v_max3_u32 v156, v156, v59, v63
    v_mfma_f32_16x16x32_bf16 v[80:83], v[128:131], v[56:59], v[80:83]
    s_xor_b32 s89, s67, s79
    s_mov_b32 s67, s79
    v_xor_b32 v144, s89, v144
    ds_read_b64_tr_b16 v[112:113], v144 offset:0
    v_mfma_f32_16x16x32_bf16 v[96:99], v[128:131], v[60:63], v[96:99]
    ds_read_b64_tr_b16 v[114:115], v144 offset:2048
    s_mov_b32 s90, 86016
    buffer_load_dwordx4 v[212:215], v11, s[32:35], s90 offen
    s_waitcnt lgkmcnt(6)
    v_mfma_f32_16x16x32_bf16 v[84:87], v[132:135], v[56:59], v[84:87]
    v_xor_b32 v145, s89, v145
    ds_read_b64_tr_b16 v[116:117], v145 offset:0
    v_mfma_f32_16x16x32_bf16 v[100:103], v[132:135], v[60:63], v[100:103]
    ds_read_b64_tr_b16 v[118:119], v145 offset:2048
    s_waitcnt lgkmcnt(6)
    v_mfma_f32_16x16x32_bf16 v[88:91], v[136:139], v[56:59], v[88:91]
    v_xor_b32 v146, s89, v146
    ds_read_b64_tr_b16 v[120:121], v146 offset:0
    v_mfma_f32_16x16x32_bf16 v[104:107], v[136:139], v[60:63], v[104:107]
    ds_read_b64_tr_b16 v[122:123], v146 offset:2048
    s_mov_b32 s90, 93184
    buffer_load_dwordx4 v[216:219], v11, s[32:35], s90 offen
    s_waitcnt lgkmcnt(6)
    v_mfma_f32_16x16x32_bf16 v[92:95], v[140:143], v[56:59], v[92:95]
    v_xor_b32 v147, s89, v147
    ds_read_b64_tr_b16 v[124:125], v147 offset:0
    v_mfma_f32_16x16x32_bf16 v[108:111], v[140:143], v[60:63], v[108:111]
    ds_read_b64_tr_b16 v[126:127], v147 offset:2048
    s_waitcnt vmcnt(6) lgkmcnt(6)
    v_max3_u32 v156, v156, v67, v71
    v_mfma_f32_16x16x32_bf16 v[80:83], v[112:115], v[64:67], v[80:83]
    ds_read_b64_tr_b16 v[128:129], v144 offset:4096
    v_mfma_f32_16x16x32_bf16 v[96:99], v[112:115], v[68:71], v[96:99]
    ds_read_b64_tr_b16 v[130:131], v144 offset:6144
    s_mov_b32 s90, 100352
    buffer_load_dwordx4 v[220:223], v11, s[32:35], s90 offen
    s_waitcnt lgkmcnt(6)
    v_mfma_f32_16x16x32_bf16 v[84:87], v[116:119], v[64:67], v[84:87]
    ds_read_b64_tr_b16 v[132:133], v145 offset:4096
    v_mfma_f32_16x16x32_bf16 v[100:103], v[116:119], v[68:71], v[100:103]
    ds_read_b64_tr_b16 v[134:135], v145 offset:6144
    s_waitcnt lgkmcnt(6)
    v_mfma_f32_16x16x32_bf16 v[88:91], v[120:123], v[64:67], v[88:91]
    ds_read_b64_tr_b16 v[136:137], v146 offset:4096
    v_mfma_f32_16x16x32_bf16 v[104:107], v[120:123], v[68:71], v[104:107]
    ds_read_b64_tr_b16 v[138:139], v146 offset:6144
    s_waitcnt lgkmcnt(6)
    v_mfma_f32_16x16x32_bf16 v[92:95], v[124:127], v[64:67], v[92:95]
    ds_read_b64_tr_b16 v[140:141], v147 offset:4096
    v_mfma_f32_16x16x32_bf16 v[108:111], v[124:127], v[68:71], v[108:111]
    ds_read_b64_tr_b16 v[142:143], v147 offset:6144
    s_waitcnt vmcnt(5) lgkmcnt(6)
    v_max3_u32 v156, v156, v75, v79
    v_cmp_eq_u32 vcc, -1, v156
    s_cbranch_vccz L_ok_3
    s_sub_u32 s56, s56, 1
    s_cbranch_scc0 L_b_restart
    s_mov_b32 s56, 0
L_ok_3:
    v_mfma_f32_16x16x32_bf16 v[80:83], v[128:131], v[72:75], v[80:83]
    v_mfma_f32_16x16x32_bf16 v[96:99], v[128:131], v[76:79], v[96:99]
    s_mov_b32 s90, 107520
    buffer_load_dwordx4 v[224:227], v11, s[32:35], s90 offen
    s_waitcnt lgkmcnt(4)
    v_mfma_f32_16x16x32_bf16 v[84:87], v[132:135], v[72:75], v[84:87]
    v_mfma_f32_16x16x32_bf16 v[100:103], v[132:135], v[76:79], v[100:103]
    s_waitcnt lgkmcnt(2)
    v_mfma_f32_16x16x32_bf16 v[88:91], v[136:139], v[72:75], v[88:91]
    v_mfma_f32_16x16x32_bf16 v[104:107], v[136:139], v[76:79], v[104:107]
    s_waitcnt lgkmcnt(0)
    v_mfma_f32_16x16x32_bf16 v[92:95], v[140:143], v[72:75], v[92:95]
    v_mfma_f32_16x16x32_bf16 v[108:111], v[140:143], v[76:79], v[108:111]
    ds_write_b128 v162, v[96:99] offset:0
    s_nop 0
    ds_write_b128 v162, v[100:103] offset:1024
    s_nop 1
    ds_write_b128 v162, v[104:107] offset:2048
    s_nop 1
    ds_write_b128 v162, v[108:111] offset:3072
    s_waitcnt lgkmcnt(0)
L_walk_18:
    s_cbranch_execz L_walk_22
    s_barrier
    ds_read_b128 v[16:19], v163 offset:0
    ds_read_b128 v[20:23], v163 offset:1024
    ds_read_b128 v[24:27], v163 offset:2048
    ds_read_b128 v[28:31], v163 offset:3072
    s_waitcnt lgkmcnt(3)
    v_pk_add_f32 v[80:81], v[80:81], v[16:17]
    v_pk_add_f32 v[82:83], v[82:83], v[18:19]
    v_cvt_pk_bf16_f32 v32, v80, v81
    v_cvt_pk_bf16_f32 v33, v82, v83
    s_waitcnt lgkmcnt(2)
    v_pk_add_f32 v[84:85], v[84:85], v[20:21]
    v_pk_add_f32 v[86:87], v[86:87], v[22:23]
    v_cvt_pk_bf16_f32 v34, v84, v85
    v_cvt_pk_bf16_f32 v35, v86, v87
    s_waitcnt lgkmcnt(1)
    v_pk_add_f32 v[88:89], v[88:89], v[24:25]
    v_pk_add_f32 v[90:91], v[90:91], v[26:27]
    v_cvt_pk_bf16_f32 v36, v88, v89
    v_cvt_pk_bf16_f32 v37, v90, v91
    s_waitcnt lgkmcnt(0)
    v_pk_add_f32 v[92:93], v[92:93], v[28:29]
    v_pk_add_f32 v[94:95], v[94:95], v[30:31]
    v_cvt_pk_bf16_f32 v38, v92, v93
    v_cvt_pk_bf16_f32 v39, v94, v95
    v_mfma_f32_16x16x32_bf16 v[60:63], v[32:35], v[32:35], 0
    v_mfma_f32_16x16x32_bf16 v[56:59], v[32:35], v[148:151], 0
    v_mfma_f32_16x16x32_bf16 v[60:63], v[36:39], v[36:39], v[60:63]
    v_mfma_f32_16x16x32_bf16 v[56:59], v[36:39], v[152:155], v[56:59]
    v_lshlrev_b32 v40, 16, v32
    v_and_b32 v41, 0xffff0000, v32
    v_lshlrev_b32 v42, 16, v33
    v_and_b32 v43, 0xffff0000, v33
    v_lshlrev_b32 v44, 16, v34
    v_and_b32 v45, 0xffff0000, v34
    s_nop 1
    v_cndmask_b32 v56, v56, v60, s[72:73]
    v_cndmask_b32 v57, v57, v61, s[72:73]
    v_cndmask_b32 v58, v58, v62, s[72:73]
    v_cndmask_b32 v59, v59, v63, s[72:73]
    v_cndmask_b32 v56, v56, v57, s[4:5]
    v_cndmask_b32 v58, v58, v59, s[98:99]
    s_or_b64 vcc, s[6:7], s[98:99]
    v_cndmask_b32 v56, v56, v58, vcc
    v_cndmask_b32 v56, v56, 1.0, s[74:75]
    v_mov_b32 v67, v56
    buffer_atomic_add_f32 v67, v160, s[16:19], 0 offen sc0 sc1
    s_mov_b32 s90, 0
    buffer_load_dwordx4 v[228:231], v14, s[36:39], s90 offen
    s_mov_b32 s90, 2048
    buffer_load_dwordx4 v[232:235], v14, s[36:39], s90 offen
    s_mov_b32 s90, 4096
    buffer_load_dwordx4 v[236:239], v14, s[36:39], s90 offen
    v_lshlrev_b32 v46, 16, v35
    v_and_b32 v47, 0xffff0000, v35
    v_lshlrev_b32 v48, 16, v36
    v_and_b32 v49, 0xffff0000, v36
    v_lshlrev_b32 v50, 16, v37
    v_and_b32 v51, 0xffff0000, v37
    v_lshlrev_b32 v52, 16, v38
    v_and_b32 v53, 0xffff0000, v38
    v_lshlrev_b32 v54, 16, v39
    v_and_b32 v55, 0xffff0000, v39
    v_lshrrev_b32 v8, 2, v2
    v_lshlrev_b32 v9, 4, v8
    v_sub_u32 v9, v161, v9
    v_cmp_eq_u32 vcc, 0, v8
    s_nop 1
    v_cndmask_b32 v10, 0, 32, vcc
    v_add_u32 v10, v9, v10
    v_cmp_eq_u32 vcc, 1, v8
    s_nop 1
    v_cndmask_b32 v8, 16, 48, vcc
    v_add_u32 v9, v9, v8
    s_lshl_b32 s86, s52, 10
    s_lshr_b32 s87, s51, 3
    s_lshl_b32 s87, s87, 6
    s_add_u32 s86, s86, s87
    s_and_b32 s87, s51, 7
    s_lshl3_add_u32 s86, s87, s86
    s_add_u32 s86, s86, 6684672
    v_lshl_add_u32 v149, v0, 7, s86
    v_mov_b32 v8, 2147483648
    v_cmp_gt_u32 vcc, 8, v0
    s_nop 1
    v_cndmask_b32 v149, v8, v149, vcc
    s_bfe_u32 s67, s2, 0x20001
    s_lshl2_add_u32 s67, s67, s48
    s_and_b32 s86, s2, 1
    s_lshl1_add_u32 s87, s45, s86
    s_and_b32 s87, s87, 7
    s_lshl_b32 s86, s67, 3
    s_add_u32 s86, s86, s87
    s_lshl_b32 s86, s86, 7
    s_add_u32 s86, s86, 6684672
    v_lshl_add_u32 v148, v0, 3, s86
    v_mov_b32 v8, 2147483648
    v_cmp_gt_u32 vcc, 16, v0
    s_nop 1
    v_cndmask_b32 v148, v8, v148, vcc
    s_lshl_b32 s67, s67, 7
    s_add_u32 s67, s67, 6619136
    s_waitcnt vmcnt(3)
    v_add_f32 v67, v67, v56
    s_branch L_h3_chk
L_h3:
    v_mov_b32 v67, 0
    buffer_atomic_or v67, v160, s[16:19], 0 offen sc0 sc1
    s_waitcnt vmcnt(0)
L_h3_chk:
    v_cmp_ne_u32 vcc, 0x41800000, v67
    s_nop 0
    s_and_b64 vcc, vcc, s[74:75]
    s_cbranch_vccz L_ok_4
    s_sub_u32 s56, s56, 1
    s_cbranch_scc0 L_h3
    s_mov_b32 s56, 0
L_ok_4:
    ds_bpermute_b32 v64, v10, v67
    ds_bpermute_b32 v66, v161, v67
    ds_bpermute_b32 v65, v9, v67
    s_waitcnt lgkmcnt(0)
    v_mul_f32 v64, 0x3a800000, v64
    v_mul_f32 v66, 0x3a800000, v66
    v_fma_f32 v66, -v64, v64, v66
    v_max_f32 v66, 0, v66
    v_cvt_pk_bf16_f32 v69, v64, v66
    v_lshlrev_b32 v68, 16, v69
    v_and_b32 v69, 0xffff0000, v69
    v_add_f32 v69, 0x3727c5ac, v69
    v_cvt_pk_bf16_f32 v69, v69, v69
    v_lshlrev_b32 v69, 16, v69
    v_sqrt_f32 v69, v69
    s_nop 0
    v_cvt_pk_bf16_f32 v69, v69, v69
    v_lshlrev_b32 v69, 16, v69
    v_rcp_f32 v70, v69
    v_fma_f32 v12, -v68, s57, v65
    v_mul_f32 v12, v12, v70
    v_mul_f32 v72, -v68, v70
    v_cvt_pk_bf16_f32 v12, v12, v12
    v_ashrrev_i32 v8, 31, v12
    v_or_b32 v8, 0x80000000, v8
    v_xor_b32 v8, v8, v12
    v_and_b32 v8, 4294901760, v8
    v_or_b32 v13, v8, v6
    s_lshl_b32 s86, s3, 6
    s_add_u32 s86, s86, 65536
    v_lshl_add_u32 v8, v2, 2, s86
    ds_write_b32 v8, v13
    v_pk_fma_f32 v[16:17], v[40:41], v[70:71], v[72:73] op_sel_hi:[1,0,0]
    v_pk_fma_f32 v[18:19], v[42:43], v[70:71], v[72:73] op_sel_hi:[1,0,0]
    v_pk_fma_f32 v[20:21], v[44:45], v[70:71], v[72:73] op_sel_hi:[1,0,0]
    v_pk_fma_f32 v[22:23], v[46:47], v[70:71], v[72:73] op_sel_hi:[1,0,0]
    v_pk_fma_f32 v[24:25], v[48:49], v[70:71], v[72:73] op_sel_hi:[1,0,0]
    v_pk_fma_f32 v[26:27], v[50:51], v[70:71], v[72:73] op_sel_hi:[1,0,0]
    v_pk_fma_f32 v[28:29], v[52:53], v[70:71], v[72:73] op_sel_hi:[1,0,0]
    v_pk_fma_f32 v[30:31], v[54:55], v[70:71], v[72:73] op_sel_hi:[1,0,0]
    v_lshlrev_b32 v8, 3, v0
    v_add_u32 v8, 65536, v8
    s_waitcnt lgkmcnt(0)
    s_barrier
    ds_read_b64 v[64:65], v8
    v_cvt_pk_bf16_f32 v96, v16, v17
    v_cvt_pk_bf16_f32 v97, v18, v19
    v_cvt_pk_bf16_f32 v98, v20, v21
    v_cvt_pk_bf16_f32 v99, v22, v23
    v_cvt_pk_bf16_f32 v100, v24, v25
    v_cvt_pk_bf16_f32 v101, v26, v27
    v_cvt_pk_bf16_f32 v102, v28, v29
    v_cvt_pk_bf16_f32 v103, v30, v31
    s_waitcnt lgkmcnt(0)
L_walk_19:
    s_cbranch_execz L_walked
    v_max_u32 v66, v64, v65
    v_min_u32 v67, v64, v65
    s_nop 0
    v_min_u32_dpp v64, v66, v66 row_ror:8 row_mask:0xf bank_mask:0xf
    v_max_u32_dpp v66, v66, v66 row_ror:8 row_mask:0xf bank_mask:0xf
    v_max_u32_dpp v65, v67, v67 row_ror:8 row_mask:0xf bank_mask:0xf
    v_max_u32 v67, v64, v65
    v_min_u32_dpp v64, v66, v66 row_ror:4 row_mask:0xf bank_mask:0xf
    v_max_u32_dpp v66, v66, v66 row_ror:4 row_mask:0xf bank_mask:0xf
    v_max_u32_dpp v65, v67, v67 row_ror:4 row_mask:0xf bank_mask:0xf
    v_max_u32 v67, v64, v65
    v_min_u32_dpp v64, v66, v66 row_ror:2 row_mask:0xf bank_mask:0xf
    v_max_u32_dpp v66, v66, v66 row_ror:2 row_mask:0xf bank_mask:0xf
    v_max_u32_dpp v65, v67, v67 row_ror:2 row_mask:0xf bank_mask:0xf
    v_max_u32 v67, v64, v65
    v_min_u32_dpp v64, v66, v66 row_ror:1 row_mask:0xf bank_mask:0xf
    v_max_u32_dpp v66, v66, v66 row_ror:1 row_mask:0xf bank_mask:0xf
    v_max_u32_dpp v65, v67, v67 row_ror:1 row_mask:0xf bank_mask:0xf
    v_max_u32 v67, v64, v65
    v_readlane_b32 s58, v66, 0
    v_readlane_b32 s59, v67, 0
    v_readlane_b32 s86, v66, 16
    v_readlane_b32 s87, v67, 16
    s_nop 0
    s_max_u32 s59, s59, s87
    s_min_u32 s87, s58, s86
    s_max_u32 s58, s58, s86
    s_max_u32 s59, s59, s87
    v_readlane_b32 s86, v66, 32
    v_readlane_b32 s87, v67, 32
    s_nop 0
    s_max_u32 s59, s59, s87
    s_min_u32 s87, s58, s86
    s_max_u32 s58, s58, s86
    s_max_u32 s59, s59, s87
    v_readlane_b32 s86, v66, 48
    v_readlane_b32 s87, v67, 48
    s_nop 0
    s_max_u32 s59, s59, s87
    s_min_u32 s87, s58, s86
    s_max_u32 s58, s58, s86
    s_max_u32 s59, s59, s87
    s_cmp_lg_u32 s3, 0
    s_cbranch_scc1 L_nokey
    v_mov_b32 v8, s58
    v_mov_b32 v9, s59
    buffer_atomic_swap_x2 v[8:9], v149, s[16:19], 0 offen sc1
L_nokey:
    s_cmp_eq_u32 s62, 0
    s_cbranch_scc1 L_h4_skip1
    v_mov_b32 v128, 0
    v_mov_b32 v129, 0
    buffer_atomic_or_x2 v[128:129], v148, s[16:19], 0 offen sc0 sc1
L_h4_skip1:
    v_cmp_eq_u32 s[4:5], s58, v13
    v_cmp_eq_u32 s[6:7], s59, v13
    s_nop 0
    s_or_b64 s[96:97], s[4:5], s[6:7]
    s_cbranch_scc0 L_nocand
    s_lshl_b32 s86, s51, 12
    s_lshl_b32 s87, s52, 7
    s_add_u32 s86, s86, s87
    s_add_u32 s86, s86, 6619136
    v_lshl_add_u32 v8, v1, 3, s86
    v_add_u32 v9, 2048, v8
    v_cndmask_b32 v8, v8, v9, s[6:7]
    v_mov_b32 v9, 2147483648
    v_cndmask_b32 v8, v9, v8, s[96:97]
    buffer_store_dwordx2 v[96:97], v8, s[16:19], 0 offen offset:0 sc1
    buffer_store_dwordx2 v[98:99], v8, s[16:19], 0 offen offset:32 sc1
    buffer_store_dwordx2 v[100:101], v8, s[16:19], 0 offen offset:64 sc1
    buffer_store_dwordx2 v[102:103], v8, s[16:19], 0 offen offset:96 sc1
    v_subrev_u32 v131, 65536, v8
L_nocand:
    v_lshlrev_b32 v16, 16, v96
    v_and_b32 v17, 0xffff0000, v96
    v_lshlrev_b32 v18, 16, v97
    v_and_b32 v19, 0xffff0000, v97
    v_lshlrev_b32 v20, 16, v98
    v_and_b32 v21, 0xffff0000, v98
    v_lshlrev_b32 v22, 16, v99
    v_and_b32 v23, 0xffff0000, v99
    v_lshlrev_b32 v24, 16, v100
    v_and_b32 v25, 0xffff0000, v100
    v_lshlrev_b32 v26, 16, v101
    v_and_b32 v27, 0xffff0000, v101
    v_lshlrev_b32 v28, 16, v102
    v_and_b32 v29, 0xffff0000, v102
    v_lshlrev_b32 v30, 16, v103
    v_and_b32 v31, 0xffff0000, v103
    v_pk_add_f32 v[16:17], v[16:17], v[40:41]
    v_pk_add_f32 v[18:19], v[18:19], v[42:43]
    v_pk_add_f32 v[20:21], v[20:21], v[44:45]
    v_pk_add_f32 v[22:23], v[22:23], v[46:47]
    v_pk_add_f32 v[24:25], v[24:25], v[48:49]
    v_pk_add_f32 v[26:27], v[26:27], v[50:51]
    v_pk_add_f32 v[28:29], v[28:29], v[52:53]
    v_pk_add_f32 v[30:31], v[30:31], v[54:55]
    v_cvt_pk_bf16_f32 v104, v16, v17
    v_cvt_pk_bf16_f32 v105, v18, v19
    v_cvt_pk_bf16_f32 v106, v20, v21
    v_cvt_pk_bf16_f32 v107, v22, v23
    v_cvt_pk_bf16_f32 v108, v24, v25
    v_cvt_pk_bf16_f32 v109, v26, v27
    v_cvt_pk_bf16_f32 v110, v28, v29
    v_cvt_pk_bf16_f32 v111, v30, v31
    v_permlane16_swap_b32 v104, v106
    v_permlane16_swap_b32 v105, v107
    v_permlane16_swap_b32 v108, v110
    v_permlane16_swap_b32 v109, v111
    buffer_store_dwordx4 v[104:107], v5, s[24:27], 0 offen sc1
    buffer_store_dwordx4 v[108:111], v5, s[24:27], 0 offen offset:64 sc1
    s_cmp_eq_u64 s[96:97], 0
    s_cbranch_scc1 L_noh
    s_cmp_lg_u32 s62, 0
    s_cbranch_scc1 L_h4_wh
    buffer_store_dwordx2 v[32:33], v131, s[16:19], 0 offen offset:0 sc1
    buffer_store_dwordx2 v[34:35], v131, s[16:19], 0 offen offset:32 sc1
    buffer_store_dwordx2 v[36:37], v131, s[16:19], 0 offen offset:64 sc1
    buffer_store_dwordx2 v[38:39], v131, s[16:19], 0 offen offset:96 sc1
L_noh:
    s_cmp_lg_u32 s62, 0
    s_cbranch_scc1 L_h4_w
    s_waitcnt vmcnt(0)
    s_branch L_fin
L_h4_wh:
    v_bfe_u32 v8, v0, 3, 1
    v_lshl_add_u32 v10, v1, 5, s67
    s_waitcnt vmcnt(6)
    s_branch L_h4_chk
L_h4_w:
    v_bfe_u32 v8, v0, 3, 1
    v_lshl_add_u32 v10, v1, 5, s67
    s_waitcnt vmcnt(2)
    s_branch L_h4_chk
L_h4:
    v_mov_b32 v128, 0
    v_mov_b32 v129, 0
    buffer_atomic_or_x2 v[128:129], v148, s[16:19], 0 offen sc0 sc1
    s_waitcnt vmcnt(0)
L_h4_chk:
    v_cmp_eq_u32 vcc, -1, v128
    s_cbranch_vccz L_ok_5
    s_sub_u32 s56, s56, 1
    s_cbranch_scc0 L_h4
    s_mov_b32 s56, 0
L_ok_5:
    v_min_u32_dpp v66, v128, v128 row_ror:8 row_mask:0xf bank_mask:0xf
    v_max_u32_dpp v128, v128, v128 row_ror:8 row_mask:0xf bank_mask:0xf
    v_max_u32_dpp v67, v129, v129 row_ror:8 row_mask:0xf bank_mask:0xf
    v_max_u32 v129, v66, v67
    v_min_u32_dpp v66, v128, v128 row_ror:4 row_mask:0xf bank_mask:0xf
    v_max_u32_dpp v128, v128, v128 row_ror:4 row_mask:0xf bank_mask:0xf
    v_max_u32_dpp v67, v129, v129 row_ror:4 row_mask:0xf bank_mask:0xf
    v_max_u32 v129, v66, v67
    v_min_u32_dpp v66, v128, v128 row_ror:2 row_mask:0xf bank_mask:0xf
    v_max_u32_dpp v128, v128, v128 row_ror:2 row_mask:0xf bank_mask:0xf
    v_max_u32_dpp v67, v129, v129 row_ror:2 row_mask:0xf bank_mask:0xf
    v_max_u32 v129, v66, v67
    v_min_u32_dpp v66, v128, v128 row_ror:1 row_mask:0xf bank_mask:0xf
    v_max_u32_dpp v128, v128, v128 row_ror:1 row_mask:0xf bank_mask:0xf
    v_max_u32_dpp v67, v129, v129 row_ror:1 row_mask:0xf bank_mask:0xf
    v_max_u32 v129, v66, v67
    v_readlane_b32 s60, v128, 0
    v_readlane_b32 s61, v129, 0
L_moe:
    s_bfe_u32 s86, s60, 0x40007
    s_bfe_u32 s87, s61, 0x40007
    s_sub_u32 s87, s86, s87
    s_lshl_b32 s87, s87, 12
    s_cselect_b32 s87, s87, 2048
    v_mad_i32_i24 v130, v8, s87, v10
    s_xor_b32 s86, s86, 15
    s_lshl_b32 s66, s86, 12
    buffer_load_dwordx4 v[64:67], v130, s[16:19], s66 offen sc1
    buffer_load_dwordx4 v[68:71], v130, s[16:19], s66 offen offset:16 sc1
    s_mov_b32 s90, 6144
    buffer_load_dwordx4 v[240:243], v14, s[36:39], s90 offen
    s_mov_b32 s90, 8192
    buffer_load_dwordx4 v[244:247], v14, s[36:39], s90 offen
    s_mov_b32 s90, 10240
    buffer_load_dwordx4 v[248:251], v14, s[36:39], s90 offen
    s_mov_b32 s90, 12288
    buffer_load_dwordx4 v[252:255], v14, s[36:39], s90 offen
L_walk_20:
    s_cbranch_execz L_walked
    s_lshr_b32 s88, s48, 1
    s_cselect_b32 s86, s87, 0
    s_cselect_b32 s63, s61, s60
    s_and_b32 s87, s48, 1
    s_lshl1_add_u32 s87, s44, s87
    s_lshl_b32 s87, s87, 7
    s_add_u32 s86, s86, s66
    s_add_u32 s86, s86, s87
    s_add_u32 s86, s86, 6553600
    v_lshl_add_u32 v142, v0, 1, s86
    v_mov_b32 v140, 0
    v_mov_b32 v141, 0
    s_mov_b32 s65, 65536
    s_cmp_eq_u64 s[96:97], 0
    s_cbranch_scc1 L_noh2
    buffer_store_dwordx2 v[32:33], v131, s[16:19], 0 offen offset:0 sc1
    buffer_store_dwordx2 v[34:35], v131, s[16:19], 0 offen offset:32 sc1
    buffer_store_dwordx2 v[36:37], v131, s[16:19], 0 offen offset:64 sc1
    buffer_store_dwordx2 v[38:39], v131, s[16:19], 0 offen offset:96 sc1
L_noh2:
    s_and_b32 s86, s63, 0x7ff
    s_sub_u32 s86, 2047, s86
    s_lshl_b32 s86, s86, 11
    s_add_u32 s86, s86, s87
    v_lshl_add_u32 v143, v0, 1, s86
    s_ashr_i32 s86, s63, 31
    s_orn2_b32 s86, 0x80000000, s86
    s_xor_b32 s63, s63, s86
    s_and_b32 s63, s63, 0xffff0000
    v_and_b32 v10, 1, v0
    v_cmp_eq_u32 vcc, 1, v10
    v_mov_b32 v10, 0x0c0c0100
    v_mov_b32 v11, 0x01000c0c
    v_cndmask_b32 v16, v10, v11, vcc
    v_mov_b32 v10, 0x0c0c0302
    v_mov_b32 v11, 0x03020c0c
    v_cndmask_b32 v17, v10, v11, vcc
    v_bfe_u32 v10, v0, 1, 2
    v_mov_b32 v11, 0x0c0c0c0c
    v_cmp_eq_u32 vcc, 0, v10
    s_nop 1
    v_cndmask_b32 v72, v11, v16, vcc
    v_cndmask_b32 v76, v11, v17, vcc
    v_cmp_eq_u32 vcc, 1, v10
    s_nop 1
    v_cndmask_b32 v73, v11, v16, vcc
    v_cndmask_b32 v77, v11, v17, vcc
    v_cmp_eq_u32 vcc, 2, v10
    s_nop 1
    v_cndmask_b32 v74, v11, v16, vcc
    v_cndmask_b32 v78, v11, v17, vcc
    v_cmp_eq_u32 vcc, 3, v10
    s_nop 1
    v_cndmask_b32 v75, v11, v16, vcc
    v_cndmask_b32 v79, v11, v17, vcc
    s_lshl_b32 s86, s48, 10
    s_add_u32 s86, s86, 90112
    v_lshl_add_u32 v18, v0, 4, s86
    s_and_b32 s86, s48, 1
    s_cselect_b32 s87, s81, s80
    s_mul_i32 s88, s87, 299616
    s_lshr_b32 s88, s88, 16
    s_mul_i32 s89, s88, 14
    s_lshl_b32 s90, s87, 6
    s_sub_u32 s89, s89, s90
    s_lshr_b32 s90, s48, 1
    s_lshl1_add_u32 s88, s88, s90
    s_and_b32 s91, s2, 1
    s_lshl1_add_u32 s88, s88, s91
    s_lshl_b32 s88, s88, 7
    s_add_u32 s88, s88, 6291456
    s_cmp_lt_u32 s87, 56
    s_cselect_b32 s88, s88, 2147483648
    s_lshl_b32 s90, s90, 9
    s_lshl_b32 s86, s86, 7
    s_add_u32 s86, s86, s90
    s_add_u32 s86, s86, 90112
    v_mul_u32_u24 v16, 14, v1
    v_add3_u32 v16, v16, v2, s89
    v_cmp_eq_u32 s[4:5], 14, v2
    v_cmp_gt_u32 vcc, 14, v2
    s_nop 1
    v_cndmask_b32 v21, 0, 64, vcc
    v_mov_b32 v17, 78
    v_cndmask_b32 v21, v21, v17, s[4:5]
    v_lshl_add_u32 v22, v1, 9, s88
    v_lshl_add_u32 v22, v2, 2, v22
    v_mov_b32 v23, 2147483648
    v_cmp_lt_u32 vcc, v16, v21
    s_nop 1
    v_cndmask_b32 v131, v23, v22, vcc
    v_sub_u32 v17, 78, v16
    v_min3_i32 v17, v17, v16, 14
    v_cvt_f32_i32 v135, v17
    v_bfe_u32 v17, v16, 3, 3
    v_lshl_add_u32 v133, v17, 4, s86
    v_bfe_u32 v17, v16, 2, 1
    v_lshl_add_u32 v133, v17, 8, v133
    v_and_b32 v17, 3, v16
    v_lshl_add_u32 v133, v17, 2, v133
    v_add_u32 v16, 56, v16
    v_add_u32 v22, 2048, v22
    v_cmp_lt_u32 vcc, v16, v21
    s_nop 1
    v_cndmask_b32 v132, v23, v22, vcc
    v_sub_u32 v17, 78, v16
    v_min3_i32 v17, v17, v16, 14
    v_cvt_f32_i32 v136, v17
    v_bfe_u32 v17, v16, 3, 3
    v_lshl_add_u32 v134, v17, 4, s86
    v_bfe_u32 v17, v16, 2, 1
    v_lshl_add_u32 v134, v17, 8, v134
    v_and_b32 v17, 3, v16
    v_lshl_add_u32 v134, v17, 2, v134
    s_lshl2_add_u32 s86, s45, s48
    s_lshl_b32 s86, s86, 10
    s_add_u32 s86, s86, 6291456
    v_lshrrev_b32 v16, 3, v0
    v_lshl_add_u32 v137, v16, 7, s86
    v_and_b32 v16, 7, v0
    v_lshl_add_u32 v137, v16, 3, v137
    v_mov_b32 v138, 0
    v_mov_b32 v139, 0
    s_cmp_eq_u64 s[96:97], 0
    s_cbranch_scc1 L_xw
    s_waitcnt vmcnt(8)
    s_branch L_seg_chk
L_xw:
    s_waitcnt vmcnt(4)
    s_branch L_seg_chk
L_seg:
    buffer_load_dwordx4 v[64:67], v130, s[16:19], s66 offen sc1
    buffer_load_dwordx4 v[68:71], v130, s[16:19], s66 offen offset:16 sc1
    s_waitcnt vmcnt(0)
L_seg_chk:
    v_max3_u32 v16, v65, v67, v69
    v_max_u32 v16, v16, v71
    v_cmp_eq_u32 vcc, -1, v16
    s_cbranch_vccz L_ok_6
    s_sub_u32 s56, s56, 1
    s_cbranch_scc0 L_seg
    s_mov_b32 s56, 0
L_ok_6:
    v_perm_b32 v80, v64, v64, v72
    v_perm_b32 v81, v64, v64, v73
    v_perm_b32 v82, v64, v64, v74
    v_perm_b32 v83, v64, v64, v75
    v_perm_b32 v84, v64, v64, v76
    v_perm_b32 v85, v64, v64, v77
    v_perm_b32 v86, v64, v64, v78
    v_perm_b32 v87, v64, v64, v79
    v_mfma_f32_16x16x32_bf16 v[88:91], v[80:83], v[164:167], 0
    v_perm_b32 v92, v65, v65, v72
    v_perm_b32 v93, v65, v65, v73
    v_perm_b32 v94, v65, v65, v74
    v_perm_b32 v95, v65, v65, v75
    v_mfma_f32_16x16x32_bf16 v[88:91], v[84:87], v[168:171], v[88:91]
    v_perm_b32 v80, v65, v65, v76
    v_perm_b32 v81, v65, v65, v77
    v_perm_b32 v82, v65, v65, v78
    v_perm_b32 v83, v65, v65, v79
    v_mfma_f32_16x16x32_bf16 v[88:91], v[92:95], v[172:175], v[88:91]
    v_perm_b32 v84, v66, v66, v72
    v_perm_b32 v85, v66, v66, v73
    v_perm_b32 v86, v66, v66, v74
    v_perm_b32 v87, v66, v66, v75
    v_mfma_f32_16x16x32_bf16 v[88:91], v[80:83], v[176:179], v[88:91]
    v_perm_b32 v92, v66, v66, v76
    v_perm_b32 v93, v66, v66, v77
    v_perm_b32 v94, v66, v66, v78
    v_perm_b32 v95, v66, v66, v79
    v_mfma_f32_16x16x32_bf16 v[88:91], v[84:87], v[180:183], v[88:91]
    v_perm_b32 v80, v67, v67, v72
    v_perm_b32 v81, v67, v67, v73
    v_perm_b32 v82, v67, v67, v74
    v_perm_b32 v83, v67, v67, v75
    v_mfma_f32_16x16x32_bf16 v[88:91], v[92:95], v[184:187], v[88:91]
    v_perm_b32 v84, v67, v67, v76
    v_perm_b32 v85, v67, v67, v77
    v_perm_b32 v86, v67, v67, v78
    v_perm_b32 v87, v67, v67, v79
    v_mfma_f32_16x16x32_bf16 v[88:91], v[80:83], v[188:191], v[88:91]
    v_perm_b32 v92, v68, v68, v72
L_walk_21:
    s_cbranch_execz L_walked
    v_perm_b32 v93, v68, v68, v73
    v_perm_b32 v94, v68, v68, v74
    v_perm_b32 v95, v68, v68, v75
    v_mfma_f32_16x16x32_bf16 v[88:91], v[84:87], v[192:195], v[88:91]
    v_perm_b32 v80, v68, v68, v76
    v_perm_b32 v81, v68, v68, v77
    v_perm_b32 v82, v68, v68, v78
    v_perm_b32 v83, v68, v68, v79
    v_mfma_f32_16x16x32_bf16 v[88:91], v[92:95], v[196:199], v[88:91]
    v_perm_b32 v84, v69, v69, v72
    v_perm_b32 v85, v69, v69, v73
    v_perm_b32 v86, v69, v69, v74
    v_perm_b32 v87, v69, v69, v75
    v_mfma_f32_16x16x32_bf16 v[88:91], v[80:83], v[200:203], v[88:91]
    v_perm_b32 v92, v69, v69, v76
    v_perm_b32 v93, v69, v69, v77
    v_perm_b32 v94, v69, v69, v78
    v_perm_b32 v95, v69, v69, v79
    v_mfma_f32_16x16x32_bf16 v[88:91], v[84:87], v[204:207], v[88:91]
    v_perm_b32 v80, v70, v70, v72
    v_perm_b32 v81, v70, v70, v73
    v_perm_b32 v82, v70, v70, v74
    v_perm_b32 v83, v70, v70, v75
    v_mfma_f32_16x16x32_bf16 v[88:91], v[92:95], v[208:211], v[88:91]
    v_perm_b32 v84, v70, v70, v76
    v_perm_b32 v85, v70, v70, v77
    v_perm_b32 v86, v70, v70, v78
    v_perm_b32 v87, v70, v70, v79
    v_mfma_f32_16x16x32_bf16 v[88:91], v[80:83], v[212:215], v[88:91]
    v_perm_b32 v92, v71, v71, v72
    v_perm_b32 v93, v71, v71, v73
    v_perm_b32 v94, v71, v71, v74
    v_perm_b32 v95, v71, v71, v75
    v_mfma_f32_16x16x32_bf16 v[88:91], v[84:87], v[216:219], v[88:91]
    v_perm_b32 v80, v71, v71, v76
    v_perm_b32 v81, v71, v71, v77
    v_perm_b32 v82, v71, v71, v78
    v_perm_b32 v83, v71, v71, v79
    v_mfma_f32_16x16x32_bf16 v[88:91], v[92:95], v[220:223], v[88:91]
    s_nop 0
    v_mfma_f32_16x16x32_bf16 v[88:91], v[80:83], v[224:227], v[88:91]
    s_nop 7
    ds_write_b128 v18, v[88:91]
    s_waitcnt lgkmcnt(0)
    s_barrier
    ds_read2st64_b32 v[24:25], v133 offset0:0 offset1:4
    ds_read2st64_b32 v[26:27], v133 offset0:8 offset1:12
    ds_read2st64_b32 v[28:29], v134 offset0:0 offset1:4
    ds_read2st64_b32 v[30:31], v134 offset0:8 offset1:12
    s_waitcnt lgkmcnt(2)
    v_pk_add_f32 v[24:25], v[24:25], v[26:27]
    v_add_f32 v24, v24, v25
    v_cndmask_b32 v24, v24, v135, s[4:5]
    buffer_atomic_add_f32 v24, v131, s[16:19], 0 offen sc1
    s_waitcnt lgkmcnt(0)
    v_pk_add_f32 v[28:29], v[28:29], v[30:31]
    v_add_f32 v28, v28, v29
    v_cndmask_b32 v28, v28, v136, s[4:5]
    buffer_atomic_add_f32 v28, v132, s[16:19], 0 offen sc1
    buffer_atomic_or_x2 v[138:139], v137, s[16:19], 0 offen sc0 sc1
    buffer_load_short_d16_hi v140, v142, s[16:19], 0 offen sc1
    buffer_load_short_d16_hi v141, v142, s[16:19], s65 offen sc1
    s_lshr_b32 s86, s48, 1
    s_and_b32 s87, s48, 1
    s_lshl_b32 s88, s86, 9
    s_lshl_b32 s89, s87, 7
    s_add_u32 s88, s88, s89
    s_add_u32 s88, s88, 94208
    v_lshrrev_b32 v17, 3, v0
    v_lshl_add_u32 v20, v17, 4, s88
    v_bfe_u32 v9, v0, 2, 1
    v_lshl_add_u32 v20, v9, 8, v20
    v_and_b32 v9, 3, v0
    v_lshl_add_u32 v20, v9, 2, v20
    s_lshl3_add_u32 s86, s86, s44
    s_lshl1_add_u32 s86, s86, s87
    s_lshl_b32 s86, s86, 11
    s_add_u32 s86, s86, 917504
    v_lshl_add_u32 v9, v17, 8, s86
    v_and_b32 v17, 7, v0
    v_lshl_add_u32 v9, v17, 3, v9
    s_mov_b32 s76, 0
    s_mov_b32 s77, 0x41900000
    s_lshl_b32 s86, s48, 7
    s_add_u32 s86, s86, 100352
    v_lshl_add_u32 v11, v8, 6, s86
    v_lshl_add_u32 v11, v1, 4, v11
    v_and_b32 v16, 7, v0
    v_lshl_or_b32 v16, v16, 1, v8
    v_cmp_le_u32 vcc, 7, v16
    v_add_u32 v17, 1, v16
    s_nop 0
    v_cndmask_b32 v16, v16, v17, vcc
    v_min_u32 v16, 15, v16
    v_lshrrev_b32 v17, 5, v0
    v_lshl_add_u32 v16, v17, 4, v16
    v_bfe_u32 v17, v0, 4, 1
    v_lshl_add_u32 v16, v17, 5, v16
    v_lshl_add_u32 v10, v16, 1, s86
    v_cmp_eq_u32 vcc, 1, v8
    v_mov_b32 v16, 0x01000c0c
    v_mov_b32 v17, 0x07060c0c
    v_cndmask_b32 v21, v16, v17, vcc
    v_mov_b32 v16, 0x05040c0c
    v_mov_b32 v17, 0x03020c0c
    v_cndmask_b32 v22, v16, v17, vcc
    v_mov_b32 v144, s63
    v_mul_f32 v144, 0xbfb8aa3b, v144
    v_exp_f32 v144, v144
    s_nop 0
    v_add_f32 v144, 1.0, v144
    v_rcp_f32 v144, v144
    s_nop 0
    v_cvt_pk_bf16_f32 v144, v144, v144
    v_lshlrev_b32 v144, 16, v144
    s_mov_b32 s6, 0x80808080
    s_mov_b32 s7, 0x80808080
    v_mov_b32 v19, v9
    s_waitcnt vmcnt(2)
    s_branch L_h5_chk
L_h5:
    v_mov_b32 v138, 0
    v_mov_b32 v139, 0
    buffer_atomic_or_x2 v[138:139], v137, s[16:19], 0 offen sc0 sc1
    s_waitcnt vmcnt(0)
L_h5_chk:
    v_cmp_neq_f32 vcc, 0x42600000, v138
    v_cvt_pk_bf16_f32 v25, v138, v139
    s_and_b64 vcc, vcc, s[6:7]
    s_cbranch_vccz L_ok_7
    s_sub_u32 s56, s56, 1
    s_cbranch_scc0 L_h5
    s_mov_b32 s56, 0
L_ok_7:
    v_mov_b32_dpp v26, v25 row_ror:8 row_mask:0xf bank_mask:0xf
    v_perm_b32 v24, v26, v25, v21
    v_perm_b32 v28, v26, v25, v22
    v_mul_f32 v25, 0xbfb8aa3b, v24
    v_exp_f32 v25, v25
    s_nop 0
    v_add_f32 v25, 1.0, v25
    v_rcp_f32 v25, v25
    s_nop 0
    v_mul_f32 v24, v24, v25
    v_cvt_pk_bf16_f32 v24, v24, v24
    v_lshlrev_b32 v24, 16, v24
    v_mul_f32 v24, v24, v28
    v_cvt_pk_bf16_f32 v24, v24, v24
    ds_write_b16 v10, v24
    s_waitcnt lgkmcnt(0)
    ds_read_b128 v[64:67], v11
    s_waitcnt lgkmcnt(0)
    v_perm_b32 v80, v64, v64, v72
    v_perm_b32 v81, v64, v64, v73
    v_perm_b32 v82, v64, v64, v74
    v_perm_b32 v83, v64, v64, v75
    v_perm_b32 v84, v64, v64, v76
    v_perm_b32 v85, v64, v64, v77
    v_perm_b32 v86, v64, v64, v78
    v_perm_b32 v87, v64, v64, v79
    v_mfma_f32_16x16x32_bf16 v[88:91], v[80:83], v[228:231], 0
    v_perm_b32 v92, v65, v65, v72
    v_perm_b32 v93, v65, v65, v73
    v_perm_b32 v94, v65, v65, v74
    v_perm_b32 v95, v65, v65, v75
    v_mfma_f32_16x16x32_bf16 v[88:91], v[84:87], v[232:235], v[88:91]
    v_perm_b32 v80, v65, v65, v76
    v_perm_b32 v81, v65, v65, v77
L_walk_22:
    s_cbranch_execz L_walked
    v_perm_b32 v82, v65, v65, v78
    v_perm_b32 v83, v65, v65, v79
    v_mfma_f32_16x16x32_bf16 v[88:91], v[92:95], v[236:239], v[88:91]
    v_perm_b32 v84, v66, v66, v72
    v_perm_b32 v85, v66, v66, v73
    v_perm_b32 v86, v66, v66, v74
    v_perm_b32 v87, v66, v66, v75
    v_mfma_f32_16x16x32_bf16 v[88:91], v[80:83], v[240:243], v[88:91]
    v_perm_b32 v92, v66, v66, v76
    v_perm_b32 v93, v66, v66, v77
    v_perm_b32 v94, v66, v66, v78
    v_perm_b32 v95, v66, v66, v79
    v_mfma_f32_16x16x32_bf16 v[88:91], v[84:87], v[244:247], v[88:91]
    v_perm_b32 v80, v67, v67, v72
    v_perm_b32 v81, v67, v67, v73
    v_perm_b32 v82, v67, v67, v74
    v_perm_b32 v83, v67, v67, v75
    v_mfma_f32_16x16x32_bf16 v[88:91], v[92:95], v[248:251], v[88:91]
    s_nop 0
    v_mfma_f32_16x16x32_bf16 v[88:91], v[80:83], v[252:255], v[88:91]
    s_nop 7
    ds_write_b128 v18, v[88:91] offset:4096
    s_waitcnt lgkmcnt(0)
    s_barrier
    ds_read2st64_b32 v[24:25], v20 offset0:0 offset1:4
    ds_read2st64_b32 v[26:27], v20 offset0:8 offset1:12
    s_waitcnt lgkmcnt(0)
    v_pk_add_f32 v[24:25], v[24:25], v[26:27]
    v_add_f32 v24, v24, v25
    v_cvt_f64_f32 v[26:27], v24
    v_add_f64 v[24:25], v[26:27], s[76:77]
    buffer_atomic_add_f64 v[24:25], v19, s[16:19], 0 offen sc0 sc1
    s_mov_b32 s77, 0xc1df0000
    v_add_f64 v[26:27], v[26:27], s[76:77]
    s_waitcnt vmcnt(1)
    v_max_u32 v16, v140, v141
    v_cmp_eq_u32 vcc, 0xffff0000, v16
    s_cbranch_vccnz L_fin_ld
L_fin_go:
    s_mov_b32 s88, 0x4c000000
    v_mov_b32 v17, 2147483648
    s_waitcnt vmcnt(0)
    v_add_f64 v[24:25], v[24:25], v[26:27]
    v_cvt_f32_f64 v24, v[24:25]
    v_cmp_lt_f32 vcc, |v24|, s88
    v_cvt_pk_bf16_f32 v24, v24, v24
    v_lshlrev_b32 v24, 16, v24
    v_mul_f32 v24, v24, v144
    v_cndmask_b32 v17, v17, v143, vcc
    v_cvt_pk_bf16_f32 v24, v24, v24
    v_lshlrev_b32 v24, 16, v24
    v_add_f32 v24, v24, v141
    v_cvt_pk_bf16_f32 v24, v24, v24
    v_lshlrev_b32 v24, 16, v24
    v_add_f32 v24, v24, v140
    v_cvt_pk_bf16_f32 v24, v24, v24
    buffer_store_short v24, v17, s[24:27], 0 offen
L_fin:
L_end:
    s_endpgm
L_b_restart:
    s_waitcnt vmcnt(0)
    v_xor_b32 v9, 0x8000, v7
    buffer_load_dwordx4 v[136:139], v7, s[8:11], 0 offen
    buffer_load_dwordx4 v[140:143], v9, s[8:11], 0 offen
    v_mov_b32 v8, s68
    s_mov_b32 s66, 0xffffaaaa
    s_mov_b32 s63, 1
    s_branch L_b_init
L_b_p0:
    v_mov_b32 v8, 0
    buffer_atomic_or v8, v159, s[16:19], 0 offen sc0 sc1
L_b_w0:
    s_waitcnt vmcnt(0)
    v_cmp_eq_u32 vcc, s68, v8
    s_nop 0
    s_lshr_b32 s65, vcc_lo, 1
    s_and_b32 s65, s65, vcc_lo
    s_andn2_b32 s65, s65, s66
    s_cbranch_scc0 L_b_q0
    s_or_b32 s66, s66, s65
    s_branch L_b_r0
L_b_q0:
    s_sub_u32 s56, s56, 1
    s_cbranch_scc0 L_b_p0
    s_mov_b32 s56, 0
    s_not_b32 s65, s66
    s_branch L_b_r0
L_b_p1:
    v_mov_b32 v8, 0
    buffer_atomic_or v8, v159, s[16:19], 0 offen sc0 sc1
    s_waitcnt vmcnt(0)
    v_cmp_eq_u32 vcc, s68, v8
    s_nop 0
    s_lshr_b32 s65, vcc_lo, 1
    s_and_b32 s65, s65, vcc_lo
    s_andn2_b32 s65, s65, s66
    s_cbranch_scc0 L_b_q1
    s_or_b32 s66, s66, s65
    s_branch L_b_r1
L_b_q1:
    s_sub_u32 s56, s56, 1
    s_cbranch_scc0 L_b_p1
    s_mov_b32 s56, 0
    s_not_b32 s65, s66
    s_branch L_b_r1
L_b_p2:
    v_mov_b32 v8, 0
    buffer_atomic_or v8, v159, s[16:19], 0 offen sc0 sc1
    s_waitcnt vmcnt(0)
    v_cmp_eq_u32 vcc, s68, v8
    s_nop 0
    s_lshr_b32 s65, vcc_lo, 1
    s_and_b32 s65, s65, vcc_lo
    s_andn2_b32 s65, s65, s66
    s_cbranch_scc0 L_b_q2
    s_or_b32 s66, s66, s65
    s_branch L_b_r2
L_b_q2:
    s_sub_u32 s56, s56, 1
    s_cbranch_scc0 L_b_p2
    s_mov_b32 s56, 0
    s_not_b32 s65, s66
    s_branch L_b_r2
L_b_p3:
    v_mov_b32 v8, 0
    buffer_atomic_or v8, v159, s[16:19], 0 offen sc0 sc1
    s_waitcnt vmcnt(0)
    v_cmp_eq_u32 vcc, s68, v8
    s_nop 0
    s_lshr_b32 s65, vcc_lo, 1
    s_and_b32 s65, s65, vcc_lo
    s_andn2_b32 s65, s65, s66
    s_cbranch_scc0 L_b_q3
    s_or_b32 s66, s66, s65
    s_branch L_b_r3
L_b_q3:
    s_sub_u32 s56, s56, 1
    s_cbranch_scc0 L_b_p3
    s_mov_b32 s56, 0
    s_not_b32 s65, s66
    s_branch L_b_r3
L_b_p4:
    v_mov_b32 v8, 0
    buffer_atomic_or v8, v159, s[16:19], 0 offen sc0 sc1
    s_waitcnt vmcnt(0)
    v_cmp_eq_u32 vcc, s68, v8
    s_nop 0
    s_lshr_b32 s65, vcc_lo, 1
    s_and_b32 s65, s65, vcc_lo
    s_andn2_b32 s65, s65, s66
    s_cbranch_scc0 L_b_q4
    s_or_b32 s66, s66, s65
    s_branch L_b_r4
L_b_q4:
    s_sub_u32 s56, s56, 1
    s_cbranch_scc0 L_b_p4
    s_mov_b32 s56, 0
    s_not_b32 s65, s66
    s_branch L_b_r4
L_b_p5:
    v_mov_b32 v8, 0
    buffer_atomic_or v8, v159, s[16:19], 0 offen sc0 sc1
    s_waitcnt vmcnt(0)
    v_cmp_eq_u32 vcc, s68, v8
    s_nop 0
    s_lshr_b32 s65, vcc_lo, 1
    s_and_b32 s65, s65, vcc_lo
    s_andn2_b32 s65, s65, s66
    s_cbranch_scc0 L_b_q5
    s_or_b32 s66, s66, s65
    s_branch L_b_r5
L_b_q5:
    s_sub_u32 s56, s56, 1
    s_cbranch_scc0 L_b_p5
    s_mov_b32 s56, 0
    s_not_b32 s65, s66
    s_branch L_b_r5
L_b_p6:
    v_mov_b32 v8, 0
    buffer_atomic_or v8, v159, s[16:19], 0 offen sc0 sc1
    s_waitcnt vmcnt(0)
    v_cmp_eq_u32 vcc, s68, v8
    s_nop 0
    s_lshr_b32 s65, vcc_lo, 1
    s_and_b32 s65, s65, vcc_lo
    s_andn2_b32 s65, s65, s66
    s_cbranch_scc0 L_b_q6
    s_or_b32 s66, s66, s65
    s_branch L_b_r6
L_b_q6:
    s_sub_u32 s56, s56, 1
    s_cbranch_scc0 L_b_p6
    s_mov_b32 s56, 0
    s_not_b32 s65, s66
    s_branch L_b_r6
L_b_p7:
    v_mov_b32 v8, 0
    buffer_atomic_or v8, v159, s[16:19], 0 offen sc0 sc1
    s_waitcnt vmcnt(0)
    v_cmp_eq_u32 vcc, s68, v8
    s_nop 0
    s_lshr_b32 s65, vcc_lo, 1
    s_and_b32 s65, s65, vcc_lo
    s_andn2_b32 s65, s65, s66
    s_cbranch_scc0 L_b_q7
    s_or_b32 s66, s66, s65
    s_branch L_b_r7
L_b_q7:
    s_sub_u32 s56, s56, 1
    s_cbranch_scc0 L_b_p7
    s_mov_b32 s56, 0
    s_not_b32 s65, s66
    s_branch L_b_r7
L_fin_ld:
    buffer_load_short_d16_hi v140, v142, s[16:19], 0 offen sc1
    buffer_load_short_d16_hi v141, v142, s[16:19], s65 offen sc1
    s_waitcnt vmcnt(0)
    v_max_u32 v16, v140, v141
    v_cmp_eq_u32 vcc, 0xffff0000, v16
    s_cbranch_vccz L_fin_go
    s_sub_u32 s56, s56, 1
    s_cbranch_scc0 L_fin_ld
    s_branch L_fin_go
L_last:
    s_endpgm
.section .rodata,"a"
.p2align 6
.amdhsa_kernel sequential_preLN__linear_attn_block__moe_arch_mod__prompt_kernel
  .amdhsa_next_free_vgpr 256
  .amdhsa_next_free_sgpr 102
  .amdhsa_accum_offset 256
  .amdhsa_group_segment_fixed_size 0
  .amdhsa_kernarg_size 88
  .amdhsa_user_sgpr_count 2
  .amdhsa_user_sgpr_kernarg_segment_ptr 1
  .amdhsa_system_sgpr_workgroup_id_x 1
.end_amdhsa_kernel
```

```asm
; @launch grid=(256,1,1) block=(512,1,1) lds=163840
.amdgcn_target "amdgcn-amd-amdhsa--gfx950"
.text
.globl sequential_preLN__linear_attn_block__moe_arch_mod__prompt_kernel
.p2align 8
.type sequential_preLN__linear_attn_block__moe_arch_mod__prompt_kernel,@function
sequential_preLN__linear_attn_block__moe_arch_mod__prompt_kernel:
    s_cmp_ge_u32 s2, 256
    s_cbranch_scc1 L_end
    s_load_dwordx16 s[64:79], s[0:1], 0
    s_load_dwordx4 s[80:83], s[0:1], 64
    s_load_dwordx2 s[84:85], s[0:1], 80
    v_lshrrev_b32 v1, 6, v0
    v_and_b32 v0, 63, v0
    v_readfirstlane_b32 s3, v1
    s_and_b32 s44, s2, 7
    s_lshr_b32 s45, s2, 3
    s_and_b32 s46, s44, 1
    s_lshl_b32 s46, s46, 3
    s_and_b32 s86, s45, 7
    s_add_u32 s46, s46, s86
    s_lshr_b32 s47, s44, 1
    s_lshl_b32 s47, s47, 2
    s_lshr_b32 s86, s45, 3
    s_add_u32 s47, s47, s86
    s_mov_b32 s51, s47
    s_mov_b32 s52, s46
    s_and_b32 s48, s3, 3
    s_and_b32 s49, s3, 1
    s_bfe_u32 s50, s3, 0x10001
    s_mov_b32 s56, 65536
    s_mov_b32 s95, 0x3f803f80
    s_movk_i32 s92, 0x1000
    s_movk_i32 s93, 0x2000
    s_movk_i32 s94, 0x3000
    s_cmp_lt_u32 s3, 4
    s_cbranch_scc1 L_comp0
    v_lshrrev_b32 v20, 3, v0
    v_and_b32 v21, 7, v0
    v_lshrrev_b32 v22, 4, v0
    v_xor_b32 v23, v21, v22
    v_xor_b32 v24, 4, v23
    s_lshl_b32 s86, s48, 5
    v_add_u32 v25, s86, v20
    v_lshlrev_b32 v25, 11, v25
    v_lshl_add_u32 v2, v23, 4, v25
    v_lshl_add_u32 v3, v24, 4, v25
    v_add_u32 v3, 15360, v3
    v_lshl_add_u32 v4, v23, 4, v25
    v_add_u32 v4, 30720, v4
    v_lshl_add_u32 v5, v24, 4, v25
    v_add_u32 v5, 46080, v5
    s_lshl_b32 s86, s48, 4
    v_add_u32 v25, s86, v20
    v_mul_u32_u24 v25, 6144, v25
    s_lshl_b32 s86, s47, 7
    v_add_u32 v25, s86, v25
    v_bfe_u32 v26, v0, 4, 1
    v_lshlrev_b32 v26, 1, v26
    v_xor_b32 v26, v26, v21
    v_xor_b32 v27, 4, v26
    v_lshl_add_u32 v6, v26, 4, v25
    v_lshl_add_u32 v7, v27, 4, v25
    v_add_u32 v7, 48128, v7
    v_lshl_add_u32 v8, v26, 4, v25
    v_add_u32 v8, 2048, v8
    v_lshl_add_u32 v9, v27, 4, v25
    v_add_u32 v9, 50176, v9
    v_lshl_add_u32 v10, v26, 4, v25
    v_add_u32 v10, 4096, v10
    v_lshl_add_u32 v11, v27, 4, v25
    v_add_u32 v11, 52224, v11
    s_lshl_b32 s63, s46, 18
    s_lshl_b32 s53, s48, 12
    s_lshl_b32 s62, s48, 11
    s_add_u32 s62, s62, 16384
    s_setprio 1
    s_lshl_b32 s86, s45, 2
    s_add_u32 s86, s86, s48
    s_mul_i32 s87, s86, 12288
    s_and_b32 s88, s47, 12
    s_lshl_b32 s88, s88, 7
    s_add_u32 s87, s87, s88
    s_add_u32 s87, s87, 384
    s_bitcmp1_b32 s47, 2
    s_cselect_b32 s87, 2147483648, s87
    v_lshl_add_u32 v37, v0, 11, s87
    v_mov_b32 v24, 2147483648
    v_cmp_gt_u32 vcc, 6, v0
    s_nop 1
    v_cndmask_b32 v37, v24, v37, vcc
    s_lshl_b32 s86, s86, 14
    s_and_b32 s88, s46, 8
    s_lshl_b32 s88, s88, 7
    s_add_u32 s86, s86, s88
    s_add_u32 s86, s86, 384
    v_lshl_add_u32 v38, v0, 11, s86
    v_cmp_gt_u32 vcc, 8, v0
    s_nop 1
    v_cndmask_b32 v38, v24, v38, vcc
    s_waitcnt lgkmcnt(0)
    s_mov_b32 s8, s64
    s_and_b32 s9, s65, 0xffff
    s_mov_b32 s10, 4194304
    s_mov_b32 s11, 0x20000
    s_mov_b32 s12, s66
    s_and_b32 s13, s67, 0xffff
    s_mov_b32 s14, 6291456
    s_mov_b32 s15, 0x20000
    s_and_b32 s86, s47, 12
    s_and_b32 s87, s46, 8
    s_add_u32 s64, s86, s87
    s_and_b32 s64, s64, 15
    s_mov_b32 s67, s64
    s_load_dword s61, s[84:85], 524288
    s_lshr_b32 s90, s67, 2
    s_mul_i32 s90, s90, 1572864
    buffer_load_dword v39, v37, s[12:15], s90 offen
    s_add_u32 m0, s53, 40960
    s_lshl_b32 s70, s64, 7
    s_add_u32 s70, s70, s63
    buffer_load_dwordx4 v2, s[8:11], s70 offen offset:0 lds
    buffer_load_dwordx4 v3, s[8:11], s70 offen offset:1024 lds
    buffer_load_dwordx4 v4, s[8:11], s70 offen offset:2048 lds
    buffer_load_dwordx4 v5, s[8:11], s70 offen offset:3072 lds
    s_mul_i32 s91, s64, 393216
    s_add_u32 s64, s64, 1
    s_and_b32 s64, s64, 15
    s_add_u32 m0, s62, 40960
    s_nop 0
    buffer_load_dwordx4 v6, s[12:15], s91 offen offset:0 lds
    buffer_load_dwordx4 v7, s[12:15], s91 offen offset:1024 lds
    s_add_u32 m0, s62, 49152
    s_nop 0
    buffer_load_dwordx4 v8, s[12:15], s91 offen offset:0 lds
    buffer_load_dwordx4 v9, s[12:15], s91 offen offset:1024 lds
    s_add_u32 m0, s62, 57344
    s_nop 0
    buffer_load_dwordx4 v10, s[12:15], s91 offen offset:0 lds
    buffer_load_dwordx4 v11, s[12:15], s91 offen offset:1024 lds
    s_branch L_ld1
L_comp0:
    s_lshl2_add_u32 s86, s45, s3
    s_cmp_ge_u32 s86, 4
    s_cbranch_scc1 L_noipf
    s_getpc_b64 s[4:5]
L_ipf:
    s_sub_u32 s4, s4, L_ipf-sequential_preLN__linear_attn_block__moe_arch_mod__prompt_kernel
    s_subb_u32 s5, s5, 0
    s_lshl_b32 s86, s86, 13
    v_lshl_add_u32 v31, v0, 7, s86
    v_min_u32 v31, L_last-sequential_preLN__linear_attn_block__moe_arch_mod__prompt_kernel, v31
    global_load_dword v30, v31, s[4:5]
L_noipf:
    s_cmp_eq_u32 s3, 3
    s_cbranch_scc1 L_comp
    s_mov_b64 exec, 0
    s_cmp_eq_u32 s3, 2
    s_cbranch_scc1 L_walkA2
    s_cmp_eq_u32 s3, 1
    s_cbranch_scc1 L_walkA1
    s_branch L_walkA0
L_ld1:
    s_mov_b32 s16, s84
    s_and_b32 s17, s85, 0xffff
    s_mov_b32 s18, 268435456
    s_mov_b32 s19, 0x20000
    s_mov_b32 s20, s68
    s_and_b32 s21, s69, 0xffff
    s_mov_b32 s22, 2097152
    s_mov_b32 s23, 0x20000
    s_mov_b32 s24, s80
    s_and_b32 s25, s81, 0xffff
    s_mov_b32 s26, 4194304
    s_mov_b32 s27, 0x20000
    s_mov_b32 s28, s82
    s_and_b32 s29, s83, 0xffff
    s_mov_b32 s30, 256
    s_mov_b32 s31, 0x20000
    s_bitcmp1_b32 s2, 0
    s_cselect_b32 s32, s76, s74
    s_cselect_b32 s33, s77, s75
    s_and_b32 s33, s33, 0xffff
    s_mov_b32 s34, 7340032
    s_mov_b32 s35, 0x20000
    s_mov_b32 s36, s78
    s_and_b32 s37, s79, 0xffff
    s_mov_b32 s38, 7340032
    s_mov_b32 s39, 0x20000
    s_mov_b32 s40, s72
    s_and_b32 s41, s73, 0xffff
    s_mov_b32 s42, 2048
    s_mov_b32 s43, 0x20000
    v_lshrrev_b32 v22, 4, v0
    v_and_b32 v23, 15, v0
    s_lshl_b32 s86, s45, 2
    s_add_u32 s86, s86, s48
    s_mul_i32 s87, s86, 6
    v_mul_u32_u24 v24, 43, v0
L_walkA0:
    s_cbranch_execz L_comp
    v_lshrrev_b32 v24, 8, v24
    v_mul_u32_u24 v25, 6, v24
    v_sub_u32 v25, v0, v25
    v_add_u32 v25, s87, v25
    s_add_u32 s87, s67, 2
    v_add_u32 v24, s87, v24
    v_and_b32 v24, 15, v24
    v_mul_u32_u24 v124, 393216, v24
    v_lshrrev_b32 v24, 2, v25
    v_lshl_add_u32 v124, v24, 11, v124
    v_and_b32 v25, 3, v25
    s_and_b32 s88, s47, 12
    v_add_u32 v25, s88, v25
    v_lshl_add_u32 v124, v25, 7, v124
    v_mov_b32 v24, 2147483648
    v_cmp_gt_u32 vcc, 36, v0
    s_nop 1
    v_cndmask_b32 v124, v24, v124, vcc
    v_add_u32 v24, s87, v20
    v_and_b32 v24, 15, v24
    s_and_b32 s88, s46, 8
    s_lshl4_add_u32 s86, s88, s86
    s_lshl_b32 s86, s86, 14
    v_lshl_add_u32 v123, v21, 11, s86
    v_mov_b32 v125, v123
    v_lshl_add_u32 v123, v24, 7, v123
    v_mov_b32 v24, 2147483648
    v_cmp_gt_u32 vcc, 16, v0
    s_nop 1
    v_cndmask_b32 v123, v24, v123, vcc
    s_add_u32 m0, s53, 81920
    s_lshl_b32 s70, s64, 7
    s_add_u32 s70, s70, s63
    buffer_load_dwordx4 v2, s[8:11], s70 offen offset:0 lds
    buffer_load_dwordx4 v3, s[8:11], s70 offen offset:1024 lds
    buffer_load_dwordx4 v4, s[8:11], s70 offen offset:2048 lds
    buffer_load_dwordx4 v5, s[8:11], s70 offen offset:3072 lds
    s_mul_i32 s91, s64, 393216
    s_add_u32 s64, s64, 1
    s_and_b32 s64, s64, 15
    s_add_u32 m0, s62, 81920
    s_nop 0
    buffer_load_dwordx4 v6, s[12:15], s91 offen offset:0 lds
    buffer_load_dwordx4 v7, s[12:15], s91 offen offset:1024 lds
    s_add_u32 m0, s62, 90112
    s_nop 0
    buffer_load_dwordx4 v8, s[12:15], s91 offen offset:0 lds
    buffer_load_dwordx4 v9, s[12:15], s91 offen offset:1024 lds
    s_add_u32 m0, s62, 98304
    s_nop 0
    buffer_load_dwordx4 v10, s[12:15], s91 offen offset:0 lds
    buffer_load_dwordx4 v11, s[12:15], s91 offen offset:1024 lds
    buffer_load_dword v122, v123, s[8:11], 0 offen
    buffer_load_dword v122, v124, s[12:15], 0 offen
    s_and_b32 s65, s45, 7
    s_lshr_b32 s66, s45, 3
    s_add_u32 s86, s65, 1
    s_and_b32 s86, s86, 3
    s_mul_i32 s86, s86, 40960
    s_lshl_b32 s87, s48, 13
    s_cmp_eq_u32 s48, 3
    s_cselect_b32 s87, 0, s87
    s_add_u32 s86, s86, s87
    s_add_u32 s86, s86, 16384
    v_lshl_add_u32 v25, v20, 7, s86
    v_lshl_add_u32 v28, v26, 4, v25
    v_lshl_add_u32 v29, v27, 4, v25
    s_add_u32 s86, s66, 1
    s_and_b32 s86, s86, 3
    s_mul_i32 s86, s86, 40960
    s_add_u32 s86, s86, s53
    v_lshl_add_u32 v16, v0, 6, s86
    v_bfe_u32 v25, v0, 2, 2
    v_lshl_add_u32 v16, v25, 4, v16
    v_xor_b32 v17, 16, v16
    v_xor_b32 v18, 32, v16
    v_xor_b32 v19, 48, v16
    s_lshl_b32 s86, s46, 14
    s_lshl_b32 s87, s48, 8
    s_add_u32 s86, s86, s87
    s_add_u32 s86, s86, 262144
    v_lshl_add_u32 v33, v23, 4, s86
    v_lshl_add_u32 v33, v22, 10, v33
    s_lshl_b32 s87, s47, 10
    s_add_u32 s86, s86, s87
    v_lshl_add_u32 v13, v0, 2, s86
    v_and_b32 v25, 3, v0
    v_cmp_eq_u32 vcc, 0, v25
    v_mov_b32 v24, 2147483648
    s_nop 0
    v_cndmask_b32 v13, v24, v13, vcc
    s_mul_i32 s86, s47, 12288
    s_add_u32 s86, s86, 65536
    s_lshl_b32 s87, s48, 8
    s_cmp_eq_u32 s48, 3
    s_cselect_b32 s87, 2147483648, s87
    s_mov_b32 s88, 0
    s_add_u32 s86, s86, s87
    v_lshl_add_u32 v32, v23, 4, s86
    v_mul_u32_u24 v25, 768, v22
    v_add_u32 v32, v32, v25
    s_mul_i32 s87, s46, 768
    s_add_u32 s86, s86, s87
    s_add_u32 s86, s86, s88
    v_lshl_add_u32 v34, v23, 5, s86
    v_lshl_add_u32 v34, v22, 4, v34
    v_and_b32 v25, 0x28, v0
    v_cmp_eq_u32 vcc, 0, v25
    s_nop 1
    v_cndmask_b32 v34, v24, v34, vcc
    s_bfe_u32 s86, s2, 0x20001
    s_lshl_b32 s86, s86, 2
    s_add_u32 s86, s86, s48
    s_lshl_b32 s86, s86, 6
    v_lshl_add_u32 v30, v22, 4, s86
    v_mul_u32_u24 v30, 7168, v30
    s_lshl_b32 s86, s45, 1
    s_sub_u32 s86, s86, 14
    s_mul_i32 s87, s86, 37
    s_lshr_b32 s87, s87, 8
    s_add_u32 s80, s86, s87
    s_and_b32 s87, s80, 7
    s_cmp_ge_u32 s87, 3
    s_addc_u32 s80, s80, 0
    s_lshl_b32 s86, s45, 1
    s_sub_u32 s86, s86, 13
    s_mul_i32 s87, s86, 37
    s_lshr_b32 s87, s87, 8
    s_add_u32 s81, s86, s87
    s_and_b32 s87, s81, 7
    s_cmp_ge_u32 s87, 3
    s_addc_u32 s81, s81, 0
    s_lshl_b32 s86, s45, 3
    s_add_u32 s86, s86, 3
    s_cmp_lt_u32 s45, 7
    s_cselect_b32 s80, s86, s80
    s_cselect_b32 s81, 56, s81
    v_mov_b32 v24, s80
    v_mov_b32 v25, s81
    s_mov_b32 vcc_lo, 4278255360
    s_mov_b32 vcc_hi, vcc_lo
    v_cndmask_b32 v24, v24, v25, vcc
    v_cmp_gt_u32 vcc, 56, v24
    v_and_b32 v25, 7, v0
    v_lshlrev_b32 v24, 7, v24
    v_lshl_add_u32 v24, v25, 4, v24
    v_add_u32 v30, v30, v24
    v_mov_b32 v24, 2147483648
    v_cndmask_b32 v30, v24, v30, vcc
    s_mul_i32 s86, s45, 112
    s_mul_i32 s87, s48, 28
    s_add_u32 s86, s86, s87
    v_mul_u32_u24 v31, 7, v22
    v_add_u32 v31, s86, v31
    v_lshlrev_b32 v31, 11, v31
    s_lshl_b32 s86, s44, 8
    v_lshl_add_u32 v24, v23, 4, s86
    v_add_u32 v31, v31, v24
    v_lshlrev_b32 v24, 1, v22
    v_xor_b32 v24, v24, v21
    s_lshl_b32 s86, s48, 3
    v_add_u32 v12, s86, v20
    v_lshlrev_b32 v12, 11, v12
    s_lshl_b32 s86, s52, 7
    v_lshl_add_u32 v24, v24, 4, s86
    v_add_u32 v12, v12, v24
    s_lshl_b32 s89, s48, 10
    v_and_b32 v24, 1, v0
    v_lshlrev_b32 v24, 4, v24
    v_mov_b32 v25, 0x3f80
    v_lshlrev_b32 v24, v24, v25
    v_bfe_u32 v25, v0, 1, 2
    v_cmp_eq_u32 vcc, 0, v25
    s_nop 1
    v_cndmask_b32 v104, 0, v24, vcc
    v_cmp_eq_u32 vcc, 1, v25
    s_nop 1
    v_cndmask_b32 v105, 0, v24, vcc
    v_cmp_eq_u32 vcc, 2, v25
    s_nop 1
    v_cndmask_b32 v106, 0, v24, vcc
    v_cmp_eq_u32 vcc, 3, v25
    s_nop 1
    v_cndmask_b32 v107, 0, v24, vcc
    s_waitcnt lgkmcnt(0)
    s_add_u32 s68, s61, 0x9e3779b9
    v_mov_b32 v35, s68
    s_lshl_b32 s86, s46, 2
    s_add_u32 s86, s86, s48
    s_lshl_b32 s86, s86, 7
    s_add_u32 s86, s86, 655360
    s_lshl_b32 s87, s47, 2
    s_add_u32 s87, s87, s48
    s_lshl_b32 s87, s87, 7
    s_add_u32 s87, s87, 663552
    s_cmp_eq_u32 s48, 3
    s_cselect_b32 s87, 2147483648, s87
    s_cselect_b32 s76, 0xffff, -1
    s_mov_b32 s77, 0
    v_mov_b32 v24, s86
    v_mov_b32 v25, s87
    v_cmp_gt_u32 vcc, 16, v0
    s_nop 1
    v_cndmask_b32 v117, v25, v24, vcc
    v_lshl_add_u32 v117, v23, 2, v117
    v_mov_b32 v116, 2147483648
    v_cmp_gt_u32 vcc, 32, v0
    s_nop 1
    v_cndmask_b32 v117, v116, v117, vcc
    s_lshl2_add_u32 s86, s47, s86
    s_lshl2_add_u32 s87, s46, s87
    v_writelane_b32 v116, s86, 0
    v_writelane_b32 v116, s87, 1
L_walkA1:
    s_cbranch_execz L_comp
    s_waitcnt vmcnt(12)
    s_barrier
    s_add_u32 m0, s53, 122880
    s_lshl_b32 s70, s64, 7
    s_add_u32 s70, s70, s63
    buffer_load_dwordx4 v2, s[8:11], s70 offen offset:0 lds
    buffer_load_dwordx4 v3, s[8:11], s70 offen offset:1024 lds
    buffer_load_dwordx4 v4, s[8:11], s70 offen offset:2048 lds
    buffer_load_dwordx4 v5, s[8:11], s70 offen offset:3072 lds
    s_mul_i32 s91, s64, 393216
    s_add_u32 s64, s64, 1
    s_and_b32 s64, s64, 15
    s_add_u32 m0, s62, 122880
    s_nop 0
    buffer_load_dwordx4 v6, s[12:15], s91 offen offset:0 lds
    buffer_load_dwordx4 v7, s[12:15], s91 offen offset:1024 lds
    s_add_u32 m0, s62, 131072
    s_nop 0
    buffer_load_dwordx4 v8, s[12:15], s91 offen offset:0 lds
    buffer_load_dwordx4 v9, s[12:15], s91 offen offset:1024 lds
    s_add_u32 m0, s62, 139264
    s_nop 0
    buffer_load_dwordx4 v10, s[12:15], s91 offen offset:0 lds
    buffer_load_dwordx4 v11, s[12:15], s91 offen offset:1024 lds
    s_add_u32 s87, s67, 4
    v_add_u32 v24, s87, v20
    v_and_b32 v24, 15, v24
    v_lshl_add_u32 v123, v24, 7, v125
    v_mov_b32 v24, 2147483648
    v_cmp_gt_u32 vcc, 32, v0
    s_nop 1
    v_cndmask_b32 v123, v24, v123, vcc
    buffer_load_dword v122, v123, s[8:11], 0 offen
    s_cmp_lg_u32 s65, 0
    s_cbranch_scc1 L_h0c0
    ds_read_b128 v[40:43], v28 offset:0
    ds_read_b128 v[44:47], v29 offset:1024
    ds_read_b128 v[48:51], v28 offset:2048
    ds_read_b128 v[52:55], v29 offset:3072
    ds_read_b128 v[56:59], v28 offset:4096
    ds_read_b128 v[60:63], v29 offset:5120
    ds_read_b128 v[64:67], v28 offset:6144
    ds_read_b128 v[68:71], v29 offset:7168
L_h0c0:
    s_cmp_lg_u32 s66, 0
    s_cbranch_scc1 L_h0r0
    ds_read_b128 v[72:75], v16
    ds_read_b128 v[76:79], v17
    ds_read_b128 v[80:83], v18
    ds_read_b128 v[84:87], v19
L_h0r0:
    s_waitcnt lgkmcnt(0)
    s_waitcnt vmcnt(13)
    s_barrier
    s_add_u32 m0, s53, 0
    s_lshl_b32 s70, s64, 7
    s_add_u32 s70, s70, s63
    buffer_load_dwordx4 v2, s[8:11], s70 offen offset:0 lds
    buffer_load_dwordx4 v3, s[8:11], s70 offen offset:1024 lds
    buffer_load_dwordx4 v4, s[8:11], s70 offen offset:2048 lds
    buffer_load_dwordx4 v5, s[8:11], s70 offen offset:3072 lds
    s_mul_i32 s91, s64, 393216
    s_add_u32 s64, s64, 1
    s_and_b32 s64, s64, 15
    s_add_u32 m0, s62, 0
    s_nop 0
    buffer_load_dwordx4 v6, s[12:15], s91 offen offset:0 lds
    buffer_load_dwordx4 v7, s[12:15], s91 offen offset:1024 lds
    s_add_u32 m0, s62, 8192
    s_nop 0
    buffer_load_dwordx4 v8, s[12:15], s91 offen offset:0 lds
    buffer_load_dwordx4 v9, s[12:15], s91 offen offset:1024 lds
    s_add_u32 m0, s62, 16384
    s_nop 0
    buffer_load_dwordx4 v10, s[12:15], s91 offen offset:0 lds
    buffer_load_dwordx4 v11, s[12:15], s91 offen offset:1024 lds
    s_cmp_lg_u32 s65, 1
    s_cbranch_scc1 L_h0c1
    ds_read_b128 v[40:43], v28 offset:0
    ds_read_b128 v[44:47], v29 offset:1024
    ds_read_b128 v[48:51], v28 offset:2048
    ds_read_b128 v[52:55], v29 offset:3072
    ds_read_b128 v[56:59], v28 offset:4096
    ds_read_b128 v[60:63], v29 offset:5120
    ds_read_b128 v[64:67], v28 offset:6144
    ds_read_b128 v[68:71], v29 offset:7168
L_h0c1:
    s_cmp_lg_u32 s66, 1
    s_cbranch_scc1 L_h0r1
    ds_read_b128 v[72:75], v16
    ds_read_b128 v[76:79], v17
    ds_read_b128 v[80:83], v18
    ds_read_b128 v[84:87], v19
L_h0r1:
    s_waitcnt lgkmcnt(0)
    s_waitcnt vmcnt(11)
    s_barrier
    s_add_u32 m0, s53, 40960
    s_lshl_b32 s70, s64, 7
    s_add_u32 s70, s70, s63
    buffer_load_dwordx4 v2, s[8:11], s70 offen offset:0 lds
    buffer_load_dwordx4 v3, s[8:11], s70 offen offset:1024 lds
    buffer_load_dwordx4 v4, s[8:11], s70 offen offset:2048 lds
    buffer_load_dwordx4 v5, s[8:11], s70 offen offset:3072 lds
    s_mul_i32 s91, s64, 393216
    s_add_u32 s64, s64, 1
    s_and_b32 s64, s64, 15
    s_add_u32 m0, s62, 40960
    s_nop 0
    buffer_load_dwordx4 v6, s[12:15], s91 offen offset:0 lds
    buffer_load_dwordx4 v7, s[12:15], s91 offen offset:1024 lds
    s_add_u32 m0, s62, 49152
    s_nop 0
    buffer_load_dwordx4 v8, s[12:15], s91 offen offset:0 lds
    buffer_load_dwordx4 v9, s[12:15], s91 offen offset:1024 lds
    s_add_u32 m0, s62, 57344
    s_nop 0
    buffer_load_dwordx4 v10, s[12:15], s91 offen offset:0 lds
    buffer_load_dwordx4 v11, s[12:15], s91 offen offset:1024 lds
    s_cmp_lg_u32 s65, 2
    s_cbranch_scc1 L_h0c2
    ds_read_b128 v[40:43], v28 offset:0
    ds_read_b128 v[44:47], v29 offset:1024
    ds_read_b128 v[48:51], v28 offset:2048
    ds_read_b128 v[52:55], v29 offset:3072
    ds_read_b128 v[56:59], v28 offset:4096
    ds_read_b128 v[60:63], v29 offset:5120
    ds_read_b128 v[64:67], v28 offset:6144
    ds_read_b128 v[68:71], v29 offset:7168
L_h0c2:
    s_cmp_lg_u32 s66, 2
    s_cbranch_scc1 L_h0r2
    ds_read_b128 v[72:75], v16
    ds_read_b128 v[76:79], v17
    ds_read_b128 v[80:83], v18
    ds_read_b128 v[84:87], v19
L_h0r2:
    s_waitcnt lgkmcnt(0)
    s_waitcnt vmcnt(10)
    s_barrier
    s_add_u32 m0, s53, 81920
    s_lshl_b32 s70, s64, 7
    s_add_u32 s70, s70, s63
    buffer_load_dwordx4 v2, s[8:11], s70 offen offset:0 lds
    buffer_load_dwordx4 v3, s[8:11], s70 offen offset:1024 lds
    buffer_load_dwordx4 v4, s[8:11], s70 offen offset:2048 lds
    buffer_load_dwordx4 v5, s[8:11], s70 offen offset:3072 lds
    s_mul_i32 s91, s64, 393216
    s_add_u32 s64, s64, 1
    s_and_b32 s64, s64, 15
    s_add_u32 m0, s62, 81920
    s_nop 0
    buffer_load_dwordx4 v6, s[12:15], s91 offen offset:0 lds
    buffer_load_dwordx4 v7, s[12:15], s91 offen offset:1024 lds
    s_add_u32 m0, s62, 90112
    s_nop 0
    buffer_load_dwordx4 v8, s[12:15], s91 offen offset:0 lds
    buffer_load_dwordx4 v9, s[12:15], s91 offen offset:1024 lds
    s_add_u32 m0, s62, 98304
    s_nop 0
    buffer_load_dwordx4 v10, s[12:15], s91 offen offset:0 lds
    buffer_load_dwordx4 v11, s[12:15], s91 offen offset:1024 lds
    s_lshr_b32 s90, s67, 2
    s_add_u32 s90, s90, 2
    s_and_b32 s90, s90, 3
    s_mul_i32 s90, s90, 1572864
    buffer_load_dword v39, v37, s[12:15], s90 offen
    s_cmp_lg_u32 s65, 3
    s_cbranch_scc1 L_h0c3
    ds_read_b128 v[40:43], v28 offset:0
L_walkB0:
    s_cbranch_execz L_walk_4
    ds_read_b128 v[44:47], v29 offset:1024
    ds_read_b128 v[48:51], v28 offset:2048
    ds_read_b128 v[52:55], v29 offset:3072
    ds_read_b128 v[56:59], v28 offset:4096
    ds_read_b128 v[60:63], v29 offset:5120
    ds_read_b128 v[64:67], v28 offset:6144
    ds_read_b128 v[68:71], v29 offset:7168
L_h0c3:
    s_cmp_lg_u32 s66, 3
    s_cbranch_scc1 L_h0r3
    ds_read_b128 v[72:75], v16
    ds_read_b128 v[76:79], v17
    ds_read_b128 v[80:83], v18
    ds_read_b128 v[84:87], v19
L_h0r3:
    s_waitcnt lgkmcnt(0)
    s_waitcnt vmcnt(11)
    s_barrier
    s_add_u32 m0, s53, 122880
    s_lshl_b32 s70, s64, 7
    s_add_u32 s70, s70, s63
    buffer_load_dwordx4 v2, s[8:11], s70 offen offset:0 lds
    buffer_load_dwordx4 v3, s[8:11], s70 offen offset:1024 lds
    buffer_load_dwordx4 v4, s[8:11], s70 offen offset:2048 lds
    buffer_load_dwordx4 v5, s[8:11], s70 offen offset:3072 lds
    s_mul_i32 s91, s64, 393216
    s_add_u32 s64, s64, 1
    s_and_b32 s64, s64, 15
    s_add_u32 m0, s62, 122880
    s_nop 0
    buffer_load_dwordx4 v6, s[12:15], s91 offen offset:0 lds
    buffer_load_dwordx4 v7, s[12:15], s91 offen offset:1024 lds
    s_add_u32 m0, s62, 131072
    s_nop 0
    buffer_load_dwordx4 v8, s[12:15], s91 offen offset:0 lds
    buffer_load_dwordx4 v9, s[12:15], s91 offen offset:1024 lds
    s_add_u32 m0, s62, 139264
    s_nop 0
    buffer_load_dwordx4 v10, s[12:15], s91 offen offset:0 lds
    buffer_load_dwordx4 v11, s[12:15], s91 offen offset:1024 lds
    s_cmp_lg_u32 s65, 4
    s_cbranch_scc1 L_h0c4
    ds_read_b128 v[40:43], v28 offset:0
    ds_read_b128 v[44:47], v29 offset:1024
    ds_read_b128 v[48:51], v28 offset:2048
    ds_read_b128 v[52:55], v29 offset:3072
    ds_read_b128 v[56:59], v28 offset:4096
    ds_read_b128 v[60:63], v29 offset:5120
    ds_read_b128 v[64:67], v28 offset:6144
    ds_read_b128 v[68:71], v29 offset:7168
L_h0c4:
    s_waitcnt lgkmcnt(0)
    v_mov_b32 v88, 0
    v_mov_b32 v89, 0
    v_mov_b32 v90, 0
    v_mov_b32 v91, 0
    v_mov_b32 v92, 0
    v_mov_b32 v93, 0
    v_mov_b32 v94, 0
    v_mov_b32 v95, 0
    v_dot2c_f32_bf16 v88, s95, v72
    v_dot2c_f32_bf16 v89, s95, v73
    v_dot2c_f32_bf16 v90, s95, v74
    v_dot2c_f32_bf16 v91, s95, v75
    v_dot2c_f32_bf16 v92, v72, v72
    v_dot2c_f32_bf16 v93, v73, v73
    v_dot2c_f32_bf16 v94, v74, v74
    v_dot2c_f32_bf16 v95, v75, v75
    v_dot2c_f32_bf16 v88, s95, v76
    v_dot2c_f32_bf16 v89, s95, v77
    v_dot2c_f32_bf16 v90, s95, v78
    v_dot2c_f32_bf16 v91, s95, v79
    v_dot2c_f32_bf16 v92, v76, v76
    v_dot2c_f32_bf16 v93, v77, v77
    v_dot2c_f32_bf16 v94, v78, v78
    v_dot2c_f32_bf16 v95, v79, v79
    v_dot2c_f32_bf16 v88, s95, v80
    v_dot2c_f32_bf16 v89, s95, v81
    v_dot2c_f32_bf16 v90, s95, v82
    v_dot2c_f32_bf16 v91, s95, v83
    v_dot2c_f32_bf16 v92, v80, v80
    v_dot2c_f32_bf16 v93, v81, v81
    v_dot2c_f32_bf16 v94, v82, v82
    v_dot2c_f32_bf16 v95, v83, v83
    v_dot2c_f32_bf16 v88, s95, v84
    v_dot2c_f32_bf16 v89, s95, v85
    v_dot2c_f32_bf16 v90, s95, v86
    v_dot2c_f32_bf16 v91, s95, v87
    v_dot2c_f32_bf16 v92, v84, v84
    v_dot2c_f32_bf16 v93, v85, v85
    v_dot2c_f32_bf16 v94, v86, v86
    v_dot2c_f32_bf16 v95, v87, v87
    s_waitcnt vmcnt(11)
    s_barrier
    s_add_u32 m0, s53, 0
    s_lshl_b32 s70, s64, 7
    s_add_u32 s70, s70, s63
    buffer_load_dwordx4 v2, s[8:11], s70 offen offset:0 lds
    buffer_load_dwordx4 v3, s[8:11], s70 offen offset:1024 lds
    buffer_load_dwordx4 v4, s[8:11], s70 offen offset:2048 lds
    buffer_load_dwordx4 v5, s[8:11], s70 offen offset:3072 lds
    s_mul_i32 s91, s64, 393216
    s_add_u32 s64, s64, 1
    s_and_b32 s64, s64, 15
    s_add_u32 m0, s62, 0
    s_nop 0
    buffer_load_dwordx4 v6, s[12:15], s91 offen offset:0 lds
    buffer_load_dwordx4 v7, s[12:15], s91 offen offset:1024 lds
    s_add_u32 m0, s62, 8192
    s_nop 0
    buffer_load_dwordx4 v8, s[12:15], s91 offen offset:0 lds
    buffer_load_dwordx4 v9, s[12:15], s91 offen offset:1024 lds
    s_add_u32 m0, s62, 16384
    s_nop 0
    buffer_load_dwordx4 v10, s[12:15], s91 offen offset:0 lds
    buffer_load_dwordx4 v11, s[12:15], s91 offen offset:1024 lds
    buffer_load_dword v39, v38, s[20:23], 0 offen
    s_cmp_lg_u32 s65, 5
    s_cbranch_scc1 L_h0c5
    ds_read_b128 v[40:43], v28 offset:0
    ds_read_b128 v[44:47], v29 offset:1024
    ds_read_b128 v[48:51], v28 offset:2048
    ds_read_b128 v[52:55], v29 offset:3072
    ds_read_b128 v[56:59], v28 offset:4096
    ds_read_b128 v[60:63], v29 offset:5120
    ds_read_b128 v[64:67], v28 offset:6144
    ds_read_b128 v[68:71], v29 offset:7168
L_h0c5:
    s_waitcnt lgkmcnt(0)
    v_pk_add_f32 v[88:89], v[88:89], v[90:91]
    v_pk_add_f32 v[92:93], v[92:93], v[94:95]
    v_add_f32 v88, v88, v89
    v_add_f32 v89, v92, v93
    s_nop 0
    v_add_f32_dpp v88, v88, v88 quad_perm:[1,0,3,2] row_mask:0xf bank_mask:0xf
    v_add_f32_dpp v89, v89, v89 quad_perm:[1,0,3,2] row_mask:0xf bank_mask:0xf
    s_nop 0
    v_mov_b32_dpp v90, v88 quad_perm:[2,2,2,2] row_mask:0xf bank_mask:0xf
    v_mov_b32_dpp v91, v89 quad_perm:[2,2,2,2] row_mask:0xf bank_mask:0xf
    buffer_store_dwordx4 v[88:91], v13, s[16:19], 0 offen sc1
    s_lshl_b32 s86, s48, 7
    s_add_u32 s86, s86, 131072
    v_lshl_add_u32 v16, v23, 3, s86
    v_lshrrev_b32 v17, 5, v0
    v_lshl_add_u32 v16, v17, 2, v16
    s_lshl_b32 s86, s48, 8
    s_add_u32 s86, s86, 132608
    v_lshl_add_u32 v17, v23, 4, s86
    v_lshl_add_u32 v17, v22, 2, v17
    s_waitcnt vmcnt(12)
    s_barrier
    s_add_u32 m0, s53, 40960
    s_lshl_b32 s70, s64, 7
    s_add_u32 s70, s70, s63
    buffer_load_dwordx4 v2, s[8:11], s70 offen offset:0 lds
    buffer_load_dwordx4 v3, s[8:11], s70 offen offset:1024 lds
    buffer_load_dwordx4 v4, s[8:11], s70 offen offset:2048 lds
    buffer_load_dwordx4 v5, s[8:11], s70 offen offset:3072 lds
    s_mul_i32 s91, s64, 393216
    s_add_u32 s64, s64, 1
    s_and_b32 s64, s64, 15
    s_add_u32 m0, s62, 40960
    s_nop 0
    buffer_load_dwordx4 v6, s[12:15], s91 offen offset:0 lds
    buffer_load_dwordx4 v7, s[12:15], s91 offen offset:1024 lds
    s_add_u32 m0, s62, 49152
    s_nop 0
    buffer_load_dwordx4 v8, s[12:15], s91 offen offset:0 lds
    buffer_load_dwordx4 v9, s[12:15], s91 offen offset:1024 lds
    s_add_u32 m0, s62, 57344
    s_nop 0
    buffer_load_dwordx4 v10, s[12:15], s91 offen offset:0 lds
    buffer_load_dwordx4 v11, s[12:15], s91 offen offset:1024 lds
    s_lshr_b32 s90, s67, 2
    s_add_u32 s90, s90, 3
    s_and_b32 s90, s90, 3
    s_mul_i32 s90, s90, 1572864
    buffer_load_dword v39, v37, s[12:15], s90 offen
    s_cmp_lg_u32 s65, 6
    s_cbranch_scc1 L_h0c6
    ds_read_b128 v[40:43], v28 offset:0
    ds_read_b128 v[44:47], v29 offset:1024
    ds_read_b128 v[48:51], v28 offset:2048
    ds_read_b128 v[52:55], v29 offset:3072
    ds_read_b128 v[56:59], v28 offset:4096
    ds_read_b128 v[60:63], v29 offset:5120
    ds_read_b128 v[64:67], v28 offset:6144
    ds_read_b128 v[68:71], v29 offset:7168
L_h0c6:
    s_waitcnt lgkmcnt(0)
L_walkB1:
    s_cbranch_execz L_walk_5
    s_waitcnt vmcnt(13)
    s_barrier
    s_add_u32 m0, s53, 81920
    s_lshl_b32 s70, s64, 7
    s_add_u32 s70, s70, s63
    buffer_load_dwordx4 v2, s[8:11], s70 offen offset:0 lds
    buffer_load_dwordx4 v3, s[8:11], s70 offen offset:1024 lds
    buffer_load_dwordx4 v4, s[8:11], s70 offen offset:2048 lds
    buffer_load_dwordx4 v5, s[8:11], s70 offen offset:3072 lds
    s_mul_i32 s91, s64, 393216
    s_add_u32 s64, s64, 1
    s_and_b32 s64, s64, 15
    s_add_u32 m0, s62, 81920
    s_nop 0
    buffer_load_dwordx4 v6, s[12:15], s91 offen offset:0 lds
    buffer_load_dwordx4 v7, s[12:15], s91 offen offset:1024 lds
    s_add_u32 m0, s62, 90112
    s_nop 0
    buffer_load_dwordx4 v8, s[12:15], s91 offen offset:0 lds
    buffer_load_dwordx4 v9, s[12:15], s91 offen offset:1024 lds
    s_add_u32 m0, s62, 98304
    s_nop 0
    buffer_load_dwordx4 v10, s[12:15], s91 offen offset:0 lds
    buffer_load_dwordx4 v11, s[12:15], s91 offen offset:1024 lds
    s_add_u32 m0, s53, 122880
    s_lshl_b32 s70, s64, 7
    s_add_u32 s70, s70, s63
    buffer_load_dwordx4 v2, s[8:11], s70 offen offset:0 lds
    buffer_load_dwordx4 v3, s[8:11], s70 offen offset:1024 lds
    s_cmp_lg_u32 s65, 7
    s_cbranch_scc1 L_h0c7
    ds_read_b128 v[40:43], v28 offset:0
    ds_read_b128 v[44:47], v29 offset:1024
    ds_read_b128 v[48:51], v28 offset:2048
    ds_read_b128 v[52:55], v29 offset:3072
    ds_read_b128 v[56:59], v28 offset:4096
    ds_read_b128 v[60:63], v29 offset:5120
    ds_read_b128 v[64:67], v28 offset:6144
    ds_read_b128 v[68:71], v29 offset:7168
L_h0c7:
    s_waitcnt lgkmcnt(0)
    s_waitcnt vmcnt(13)
    s_barrier
    s_add_u32 m0, s53, 122880
    s_nop 0
    buffer_load_dwordx4 v4, s[8:11], s70 offen offset:2048 lds
    buffer_load_dwordx4 v5, s[8:11], s70 offen offset:3072 lds
    s_mul_i32 s91, s64, 393216
    s_add_u32 s64, s64, 1
    s_and_b32 s64, s64, 15
    s_add_u32 m0, s62, 122880
    s_nop 0
    buffer_load_dwordx4 v6, s[12:15], s91 offen offset:0 lds
    buffer_load_dwordx4 v7, s[12:15], s91 offen offset:1024 lds
    s_add_u32 m0, s62, 131072
    s_nop 0
    buffer_load_dwordx4 v8, s[12:15], s91 offen offset:0 lds
    buffer_load_dwordx4 v9, s[12:15], s91 offen offset:1024 lds
    s_add_u32 m0, s62, 139264
    s_nop 0
    buffer_load_dwordx4 v10, s[12:15], s91 offen offset:0 lds
    buffer_load_dwordx4 v11, s[12:15], s91 offen offset:1024 lds
    s_add_u32 m0, s53, 0
    s_lshl_b32 s70, s64, 7
    s_add_u32 s70, s70, s63
    buffer_load_dwordx4 v2, s[8:11], s70 offen offset:0 lds
    buffer_load_dwordx4 v3, s[8:11], s70 offen offset:1024 lds
    v_mfma_f32_16x16x32_bf16 v[108:111], v[104:107], v[40:43], 0
    v_mfma_f32_16x16x32_bf16 v[108:111], v[104:107], v[44:47], v[108:111]
    v_mfma_f32_16x16x32_bf16 v[108:111], v[104:107], v[48:51], v[108:111]
    v_mfma_f32_16x16x32_bf16 v[108:111], v[104:107], v[52:55], v[108:111]
    v_mfma_f32_16x16x32_bf16 v[108:111], v[104:107], v[56:59], v[108:111]
    v_mfma_f32_16x16x32_bf16 v[108:111], v[104:107], v[60:63], v[108:111]
    v_mfma_f32_16x16x32_bf16 v[108:111], v[104:107], v[64:67], v[108:111]
    v_mfma_f32_16x16x32_bf16 v[108:111], v[104:107], v[68:71], v[108:111]
    s_nop 7
    v_add_f32_dpp v108, v108, v108 row_ror:8 row_mask:0xf bank_mask:0xf
    v_add_f32_dpp v109, v109, v109 row_ror:8 row_mask:0xf bank_mask:0xf
    v_add_f32_dpp v110, v110, v110 row_ror:8 row_mask:0xf bank_mask:0xf
    v_add_f32_dpp v111, v111, v111 row_ror:8 row_mask:0xf bank_mask:0xf
    buffer_store_dwordx4 v[108:111], v34, s[16:19], 0 offen sc1
    s_waitcnt vmcnt(13)
    s_barrier
    s_add_u32 m0, s53, 0
    s_nop 0
    buffer_load_dwordx4 v4, s[8:11], s70 offen offset:2048 lds
    buffer_load_dwordx4 v5, s[8:11], s70 offen offset:3072 lds
    s_mul_i32 s91, s64, 393216
    s_add_u32 s64, s64, 1
    s_and_b32 s64, s64, 15
    s_add_u32 m0, s62, 0
    s_nop 0
    buffer_load_dwordx4 v6, s[12:15], s91 offen offset:0 lds
    buffer_load_dwordx4 v7, s[12:15], s91 offen offset:1024 lds
    s_add_u32 m0, s62, 8192
    s_nop 0
    buffer_load_dwordx4 v8, s[12:15], s91 offen offset:0 lds
    buffer_load_dwordx4 v9, s[12:15], s91 offen offset:1024 lds
    s_add_u32 m0, s62, 16384
    s_nop 0
    buffer_load_dwordx4 v10, s[12:15], s91 offen offset:0 lds
    buffer_load_dwordx4 v11, s[12:15], s91 offen offset:1024 lds
    s_add_u32 m0, s53, 40960
    s_lshl_b32 s70, s64, 7
    s_add_u32 s70, s70, s63
    buffer_load_dwordx4 v2, s[8:11], s70 offen offset:0 lds
    buffer_load_dwordx4 v3, s[8:11], s70 offen offset:1024 lds
    buffer_load_dwordx4 v4, s[8:11], s70 offen offset:2048 lds
    buffer_load_dwordx4 v5, s[8:11], s70 offen offset:3072 lds
    s_mul_i32 s91, s64, 393216
    s_add_u32 s64, s64, 1
    s_and_b32 s64, s64, 15
    s_waitcnt vmcnt(12)
    s_barrier
    buffer_atomic_swap v35, v116, s[16:19], 0 offen sc1
    s_add_u32 m0, s62, 40960
    s_nop 0
    buffer_load_dwordx4 v6, s[12:15], s91 offen offset:0 lds
    buffer_load_dwordx4 v7, s[12:15], s91 offen offset:1024 lds
    s_add_u32 m0, s62, 49152
    s_nop 0
    buffer_load_dwordx4 v8, s[12:15], s91 offen offset:0 lds
    buffer_load_dwordx4 v9, s[12:15], s91 offen offset:1024 lds
    s_add_u32 m0, s62, 57344
    s_nop 0
    buffer_load_dwordx4 v10, s[12:15], s91 offen offset:0 lds
    buffer_load_dwordx4 v11, s[12:15], s91 offen offset:1024 lds
    s_add_u32 m0, s53, 81920
    s_lshl_b32 s70, s64, 7
    s_add_u32 s70, s70, s63
    buffer_load_dwordx4 v2, s[8:11], s70 offen offset:0 lds
    buffer_load_dwordx4 v3, s[8:11], s70 offen offset:1024 lds
    buffer_load_dwordx4 v4, s[8:11], s70 offen offset:2048 lds
    buffer_load_dwordx4 v5, s[8:11], s70 offen offset:3072 lds
    s_mul_i32 s91, s64, 393216
    s_add_u32 s64, s64, 1
    s_and_b32 s64, s64, 15
    s_add_u32 m0, s62, 81920
    s_nop 0
    buffer_load_dwordx4 v6, s[12:15], s91 offen offset:0 lds
    buffer_load_dwordx4 v7, s[12:15], s91 offen offset:1024 lds
    s_waitcnt vmcnt(17)
    s_barrier
    s_add_u32 m0, s62, 90112
    s_nop 0
    buffer_load_dwordx4 v8, s[12:15], s91 offen offset:0 lds
    buffer_load_dwordx4 v9, s[12:15], s91 offen offset:1024 lds
    s_add_u32 m0, s62, 98304
    s_nop 0
    buffer_load_dwordx4 v10, s[12:15], s91 offen offset:0 lds
    buffer_load_dwordx4 v11, s[12:15], s91 offen offset:1024 lds
    s_add_u32 m0, s53, 122880
    s_lshl_b32 s70, s64, 7
    s_add_u32 s70, s70, s63
    buffer_load_dwordx4 v2, s[8:11], s70 offen offset:0 lds
    buffer_load_dwordx4 v3, s[8:11], s70 offen offset:1024 lds
    buffer_load_dwordx4 v4, s[8:11], s70 offen offset:2048 lds
    buffer_load_dwordx4 v5, s[8:11], s70 offen offset:3072 lds
    s_mul_i32 s91, s64, 393216
    s_add_u32 s64, s64, 1
    s_and_b32 s64, s64, 15
    s_add_u32 m0, s62, 122880
    s_nop 0
    buffer_load_dwordx4 v6, s[12:15], s91 offen offset:0 lds
    buffer_load_dwordx4 v7, s[12:15], s91 offen offset:1024 lds
    s_add_u32 m0, s62, 131072
    s_nop 0
    buffer_load_dwordx4 v8, s[12:15], s91 offen offset:0 lds
    buffer_load_dwordx4 v9, s[12:15], s91 offen offset:1024 lds
L_walk_4:
    s_cbranch_execz L_walk_8
    s_waitcnt vmcnt(18)
    s_barrier
    s_add_u32 m0, s62, 139264
    s_nop 0
    buffer_load_dwordx4 v10, s[12:15], s91 offen offset:0 lds
    buffer_load_dwordx4 v11, s[12:15], s91 offen offset:1024 lds
    s_add_u32 m0, s53, 0
    s_lshl_b32 s70, s64, 7
    s_add_u32 s70, s70, s63
    buffer_load_dwordx4 v2, s[8:11], s70 offen offset:0 lds
    buffer_load_dwordx4 v3, s[8:11], s70 offen offset:1024 lds
    buffer_load_dwordx4 v4, s[8:11], s70 offen offset:2048 lds
    buffer_load_dwordx4 v5, s[8:11], s70 offen offset:3072 lds
    s_mul_i32 s91, s64, 393216
    s_add_u32 s64, s64, 1
    s_and_b32 s64, s64, 15
    s_add_u32 m0, s62, 0
    s_nop 0
    buffer_load_dwordx4 v6, s[12:15], s91 offen offset:0 lds
    buffer_load_dwordx4 v7, s[12:15], s91 offen offset:1024 lds
    s_add_u32 m0, s62, 8192
    s_nop 0
    buffer_load_dwordx4 v8, s[12:15], s91 offen offset:0 lds
    buffer_load_dwordx4 v9, s[12:15], s91 offen offset:1024 lds
    s_add_u32 m0, s62, 16384
    s_nop 0
    buffer_load_dwordx4 v10, s[12:15], s91 offen offset:0 lds
    buffer_load_dwordx4 v11, s[12:15], s91 offen offset:1024 lds
    s_waitcnt vmcnt(20)
    s_barrier
    v_mov_b32 v118, 0
    buffer_atomic_or v118, v117, s[16:19], 0 offen sc0 sc1
    s_add_u32 m0, s89, 40960
    s_mov_b32 s90, 655360
    buffer_load_dwordx4 v12, s[20:23], s90 offen lds
    s_add_u32 m0, s89, 45056
    s_mov_b32 s90, 720896
    buffer_load_dwordx4 v12, s[20:23], s90 offen lds
    s_add_u32 m0, s89, 49152
    s_mov_b32 s90, 786432
    buffer_load_dwordx4 v12, s[20:23], s90 offen lds
    s_add_u32 m0, s89, 53248
    s_mov_b32 s90, 851968
    buffer_load_dwordx4 v12, s[20:23], s90 offen lds
    s_mov_b32 s90, 0
    buffer_load_dwordx4 v[164:167], v30, s[32:35], s90 offen
    s_mov_b32 s90, 7168
    buffer_load_dwordx4 v[168:171], v30, s[32:35], s90 offen
    s_mov_b32 s90, 14336
    buffer_load_dwordx4 v[172:175], v30, s[32:35], s90 offen
    s_mov_b32 s90, 21504
    buffer_load_dwordx4 v[176:179], v30, s[32:35], s90 offen
    s_waitcnt vmcnt(19)
    s_barrier
    s_waitcnt vmcnt(8)
    s_branch L_h0_chk0
L_h0_spin:
    v_mov_b32 v118, 0
    buffer_atomic_or v118, v117, s[16:19], 0 offen sc0 sc1
    s_waitcnt vmcnt(0)
L_h0_chk0:
    v_cmp_ne_u32 vcc, s68, v118
    s_nop 0
    s_and_b64 vcc, vcc, s[76:77]
    s_cbranch_vccz L_ok_1
    s_sub_u32 s56, s56, 1
    s_cbranch_scc0 L_h0_spin
    s_mov_b32 s56, 0
L_ok_1:
    s_mov_b32 s90, 0
    buffer_load_dwordx4 v[40:43], v32, s[16:19], s90 offen sc1
    s_mov_b32 s90, 3072
    buffer_load_dwordx4 v[44:47], v32, s[16:19], s90 offen sc1
    s_mov_b32 s90, 6144
    buffer_load_dwordx4 v[48:51], v32, s[16:19], s90 offen sc1
    s_mov_b32 s90, 9216
    buffer_load_dwordx4 v[52:55], v32, s[16:19], s90 offen sc1
    buffer_load_dwordx4 v[56:59], v33, s[16:19], 0 offen sc1
    buffer_load_dwordx4 v[60:63], v33, s[16:19], s92 offen sc1
    buffer_load_dwordx4 v[64:67], v33, s[16:19], s93 offen sc1
    buffer_load_dwordx4 v[68:71], v33, s[16:19], s94 offen sc1
    s_mov_b32 s90, 28672
    buffer_load_dwordx4 v[180:183], v30, s[32:35], s90 offen
    s_mov_b32 s90, 35840
    buffer_load_dwordx4 v[184:187], v30, s[32:35], s90 offen
    s_mov_b32 s90, 43008
    buffer_load_dwordx4 v[188:191], v30, s[32:35], s90 offen
    s_waitcnt vmcnt(20)
    s_barrier
    v_mov_b32 v24, 135168
    v_lshl_add_u32 v24, v21, 2, v24
    v_mov_b32 v25, 0
    ds_write_b32 v24, v25
    s_add_u32 m0, s89, 57344
    s_mov_b32 s90, 917504
    buffer_load_dwordx4 v12, s[20:23], s90 offen lds
    s_add_u32 m0, s89, 61440
    s_mov_b32 s90, 983040
    buffer_load_dwordx4 v12, s[20:23], s90 offen lds
    s_add_u32 m0, s89, 65536
    s_mov_b32 s90, 1048576
    buffer_load_dwordx4 v12, s[20:23], s90 offen lds
    s_add_u32 m0, s89, 69632
    s_mov_b32 s90, 1114112
    buffer_load_dwordx4 v12, s[20:23], s90 offen lds
    s_add_u32 m0, s89, 73728
    s_mov_b32 s90, 1179648
    buffer_load_dwordx4 v12, s[20:23], s90 offen lds
    s_add_u32 m0, s89, 77824
    s_mov_b32 s90, 1245184
    buffer_load_dwordx4 v12, s[20:23], s90 offen lds
    s_waitcnt vmcnt(9)
    v_add_f32 v40, v40, v44
    v_add_f32 v41, v41, v45
    v_add_f32 v42, v42, v46
    v_add_f32 v43, v43, v47
    v_add_f32 v40, v40, v48
    v_add_f32 v41, v41, v49
    v_add_f32 v42, v42, v50
    v_add_f32 v43, v43, v51
    v_add_f32 v40, v40, v52
    v_add_f32 v41, v41, v53
    v_add_f32 v42, v42, v54
    v_add_f32 v43, v43, v55
    v_add_f32 v56, v56, v60
    v_add_f32 v57, v57, v61
    v_add_f32 v58, v58, v62
    v_add_f32 v59, v59, v63
    v_add_f32 v56, v56, v64
    v_add_f32 v57, v57, v65
    v_add_f32 v58, v58, v66
    v_add_f32 v59, v59, v67
    v_add_f32 v56, v56, v68
    v_add_f32 v57, v57, v69
    v_add_f32 v58, v58, v70
    v_add_f32 v59, v59, v71
    s_nop 0
    v_permlane32_swap_b32 v56, v58
    v_permlane32_swap_b32 v57, v59
    v_permlane32_swap_b32 v40, v42
    v_permlane32_swap_b32 v41, v43
    v_add_f32 v56, v56, v58
    v_add_f32 v57, v57, v59
    v_add_f32 v40, v40, v42
    v_add_f32 v41, v41, v43
    v_mov_b32 v58, v56
    v_mov_b32 v59, v57
    v_permlane16_swap_b32 v40, v41
    v_permlane16_swap_b32 v56, v58
    v_permlane16_swap_b32 v57, v59
    v_add_f32 v40, v40, v41
    v_add_f32 v56, v56, v58
    v_add_f32 v57, v57, v59
    ds_write_b32 v17, v40
    v_mul_f32 v56, 0x3a800000, v56
    v_mul_f32 v57, 0x3a800000, v57
    v_fma_f32 v57, -v56, v56, v57
    v_max_f32 v57, 0, v57
    v_cvt_pk_bf16_f32 v48, v56, v57
    v_lshlrev_b32 v44, 16, v48
    v_and_b32 v48, 0xffff0000, v48
    v_add_f32 v48, 0x3727c5ac, v48
    v_cvt_pk_bf16_f32 v48, v48, v48
    v_lshlrev_b32 v48, 16, v48
    v_sqrt_f32 v48, v48
    s_nop 0
    v_cvt_pk_bf16_f32 v48, v48, v48
    v_lshlrev_b32 v48, 16, v48
    v_rcp_f32 v46, v48
    v_sub_f32 v44, 0, v44
    v_mul_f32 v48, 0x3fb8aa3b, v46
    ds_write_b32 v16, v44
    ds_write_b32 v16, v46 offset:512
    ds_write_b32 v16, v48 offset:1024
    s_waitcnt lgkmcnt(0)
L_walk_5:
    s_cbranch_execz L_walk_12
    s_barrier
    s_setprio 0
    s_add_u32 m0, s89, 81920
    s_mov_b32 s90, 1310720
    buffer_load_dwordx4 v12, s[20:23], s90 offen lds
    s_add_u32 m0, s89, 86016
    s_mov_b32 s90, 1376256
    buffer_load_dwordx4 v12, s[20:23], s90 offen lds
    s_add_u32 m0, s89, 90112
    s_mov_b32 s90, 1441792
    buffer_load_dwordx4 v12, s[20:23], s90 offen lds
    s_add_u32 m0, s89, 94208
    s_mov_b32 s90, 1507328
    buffer_load_dwordx4 v12, s[20:23], s90 offen lds
    s_add_u32 m0, s89, 98304
    s_mov_b32 s90, 1572864
    buffer_load_dwordx4 v12, s[20:23], s90 offen lds
    s_add_u32 m0, s89, 102400
    s_mov_b32 s90, 1638400
    buffer_load_dwordx4 v12, s[20:23], s90 offen lds
    s_add_u32 m0, s89, 106496
    s_mov_b32 s90, 1703936
    buffer_load_dwordx4 v12, s[20:23], s90 offen lds
    s_add_u32 m0, s89, 110592
    s_mov_b32 s90, 1769472
    buffer_load_dwordx4 v12, s[20:23], s90 offen lds
    s_add_u32 m0, s89, 114688
    s_mov_b32 s90, 1835008
    buffer_load_dwordx4 v12, s[20:23], s90 offen lds
    s_add_u32 m0, s89, 118784
    s_mov_b32 s90, 1900544
    buffer_load_dwordx4 v12, s[20:23], s90 offen lds
    s_add_u32 m0, s89, 122880
    s_mov_b32 s90, 1966080
    buffer_load_dwordx4 v12, s[20:23], s90 offen lds
    s_add_u32 m0, s89, 126976
    s_mov_b32 s90, 2031616
    buffer_load_dwordx4 v12, s[20:23], s90 offen lds
    s_add_u32 m0, s89, 0
    s_mov_b32 s90, 0
    buffer_load_dwordx4 v12, s[20:23], s90 offen lds
    s_add_u32 m0, s89, 4096
    s_mov_b32 s90, 65536
    buffer_load_dwordx4 v12, s[20:23], s90 offen lds
    s_add_u32 m0, s89, 8192
    s_mov_b32 s90, 131072
    buffer_load_dwordx4 v12, s[20:23], s90 offen lds
    s_add_u32 m0, s89, 12288
    s_mov_b32 s90, 196608
    buffer_load_dwordx4 v12, s[20:23], s90 offen lds
    s_add_u32 m0, s89, 16384
    s_mov_b32 s90, 262144
    buffer_load_dwordx4 v12, s[20:23], s90 offen lds
    s_add_u32 m0, s89, 20480
    s_mov_b32 s90, 327680
    buffer_load_dwordx4 v12, s[20:23], s90 offen lds
    s_add_u32 m0, s89, 24576
    s_mov_b32 s90, 393216
    buffer_load_dwordx4 v12, s[20:23], s90 offen lds
    s_add_u32 m0, s89, 28672
    s_mov_b32 s90, 458752
    buffer_load_dwordx4 v12, s[20:23], s90 offen lds
    s_add_u32 m0, s89, 32768
    s_mov_b32 s90, 524288
    buffer_load_dwordx4 v12, s[20:23], s90 offen lds
    s_add_u32 m0, s89, 36864
    s_mov_b32 s90, 589824
    buffer_load_dwordx4 v12, s[20:23], s90 offen lds
    s_lshl_b32 s86, s47, 2
    s_add_u32 s86, s86, s48
    s_lshl_b32 s87, s86, 7
    s_add_u32 s87, s87, 671744
    v_lshl_add_u32 v6, v0, 2, s87
    v_mov_b32 v4, 2147483648
    v_cmp_gt_u32 vcc, 16, v0
    s_nop 1
    v_cndmask_b32 v6, v4, v6, vcc
    s_lshl_b32 s86, s86, 14
    s_add_u32 s86, s86, 5242880
    v_lshl_add_u32 v2, v0, 4, s86
    s_lshl_b32 s86, s47, 1
    s_add_u32 s86, s86, s50
    s_lshl_b32 s86, s86, 11
    s_lshl_b32 s87, s49, 6
    s_add_u32 s86, s86, s87
    s_add_u32 s86, s86, 6881280
    v_lshl_add_u32 v3, v23, 7, s86
    v_lshl_add_u32 v3, v22, 4, v3
    v_mov_b32 v112, 0
    v_mov_b32 v113, 0
    v_mov_b32 v114, 0
    v_mov_b32 v115, 0
    v_mov_b32 v116, 0
    v_mov_b32 v117, 0
    v_mov_b32 v118, 0
    v_mov_b32 v119, 0
    s_lshr_b32 s62, s3, 2
    s_lshl_b32 s53, s51, 3
    s_lshl_b32 s86, s48, 1
    s_add_u32 s53, s53, s86
    s_add_u32 s53, s53, s62
    v_lshrrev_b32 v36, 4, v0
    v_and_b32 v37, 15, v0
    s_lshl_b32 s87, s53, 15
    s_lshl_b32 s86, s62, 14
    s_add_u32 s86, s86, s87
    s_add_u32 s86, s86, 1048576
    v_lshl_add_u32 v157, v0, 4, s86
    v_xor_b32 v158, 0x8000, v157
    s_lshl_b32 s86, s51, 1
    s_lshr_b32 s87, s48, 1
    s_add_u32 s86, s86, s87
    s_lshl_b32 s86, s86, 1
    s_add_u32 s86, s86, s62
    s_lshl_b32 s86, s86, 1
    s_and_b32 s87, s48, 1
    s_add_u32 s86, s86, s87
    s_lshl_b32 s86, s86, 7
    s_add_u32 s86, s86, 688128
    v_lshl_add_u32 v159, v0, 2, s86
    v_mov_b32 v38, 2147483648
    v_cmp_gt_u32 vcc, 16, v0
    s_nop 1
    v_cndmask_b32 v159, v38, v159, vcc
    v_bfe_u32 v38, v0, 2, 2
    v_lshl_add_u32 v38, v36, 2, v38
    v_bfe_u32 v39, v38, 1, 2
    v_lshlrev_b32 v38, 7, v38
    v_lshl_add_u32 v38, v39, 5, v38
    v_and_b32 v39, 3, v0
    v_lshl_add_u32 v38, v39, 3, v38
    s_lshl_b32 s86, s62, 16
    s_add_u32 s86, s86, 0
    v_add_u32 v144, s86, v38
    v_xor_b32 v145, 32, v144
    v_xor_b32 v146, 64, v144
    v_xor_b32 v147, 96, v144
    v_cmp_eq_u32 s[4:5], 1, v39
    v_cmp_eq_u32 s[6:7], 2, v39
    v_cmp_eq_u32 s[98:99], 3, v39
    s_lshl_b32 s86, s53, 10
    s_add_u32 s86, s86, 786432
    v_lshl_add_u32 v160, v0, 2, s86
    v_mul_u32_u24 v161, 192, v36
    v_add_u32 v160, v160, v161
    s_mov_b32 s72, 0x00f0000f
    s_mov_b32 s73, 0xf0000f00
    s_mov_b32 s74, 0x0f00f000
    s_mov_b32 s75, 0x0f00f000
    v_lshrrev_b32 v38, 2, v37
    v_lshl_add_u32 v161, v38, 4, v37
    v_lshlrev_b32 v161, 2, v161
    s_lshl_b32 s86, s3, 12
    s_add_u32 s86, s86, 131072
    v_lshl_add_u32 v162, v0, 4, s86
    v_xor_b32 v163, 0x4000, v162
    s_lshl_b32 s86, s52, 7
    v_lshl_add_u32 v36, v36, 3, s86
    s_lshl_b32 s87, s53, 15
    s_add_u32 s87, s87, s86
    s_lshl_b32 s86, s62, 6
    s_add_u32 s87, s87, s86
    v_lshl_add_u32 v39, v37, 11, s87
    v_and_b32 v38, 48, v0
    v_add_u32 v39, v39, v38
    v_xor_b32 v37, 0x8000, v39
    v_lshlrev_b32 v38, 4, v0
L_walk_6:
    s_cbranch_execz L_walk_13
    buffer_load_dwordx2 v[148:149], v36, s[40:43], 0 offen offset:0
    buffer_load_dwordx2 v[150:151], v36, s[40:43], 0 offen offset:32
    buffer_load_dwordx2 v[152:153], v36, s[40:43], 0 offen offset:64
    buffer_load_dwordx2 v[154:155], v36, s[40:43], 0 offen offset:96
    buffer_load_dwordx4 v[128:131], v38, s[40:43], 0 offen
    buffer_load_dwordx4 v[132:135], v38, s[40:43], 0 offen offset:1024
    buffer_load_dwordx4 v[136:139], v39, s[8:11], 0 offen
    buffer_load_dwordx4 v[140:143], v37, s[8:11], 0 offen
    s_mov_b32 s90, 50176
    buffer_load_dwordx4 v[192:195], v30, s[32:35], s90 offen
    s_mov_b32 s90, 57344
    buffer_load_dwordx4 v[196:199], v30, s[32:35], s90 offen
    s_mov_b32 s90, 64512
    buffer_load_dwordx4 v[200:203], v30, s[32:35], s90 offen
    s_waitcnt vmcnt(5)
    v_mov_b32 v4, 0
    buffer_atomic_or v4, v6, s[16:19], 0 offen sc0 sc1
    v_bfe_u32 v36, v0, 2, 1
    v_cmp_eq_u32 vcc, 1, v36
    v_mov_b32 v36, s95
    v_mov_b32 v38, 0
    v_dot2c_f32_bf16 v38, s95, v128
    v_dot2c_f32_bf16 v38, s95, v129
    v_dot2c_f32_bf16 v38, s95, v130
    v_dot2c_f32_bf16 v38, s95, v131
    v_dot2c_f32_bf16 v38, s95, v132
    v_dot2c_f32_bf16 v38, s95, v133
    v_dot2c_f32_bf16 v38, s95, v134
    v_dot2c_f32_bf16 v38, s95, v135
    v_cndmask_b32 v148, v36, v148, vcc
    v_cndmask_b32 v149, v36, v149, vcc
    v_cndmask_b32 v150, v36, v150, vcc
    v_cndmask_b32 v151, v36, v151, vcc
    v_cndmask_b32 v152, v36, v152, vcc
    v_cndmask_b32 v153, v36, v153, vcc
    v_cndmask_b32 v154, v36, v154, vcc
    v_cndmask_b32 v155, v36, v155, vcc
    v_add_f32_dpp v38, v38, v38 row_ror:8 row_mask:0xf bank_mask:0xf
    s_nop 1
    v_add_f32_dpp v38, v38, v38 row_ror:4 row_mask:0xf bank_mask:0xf
    s_nop 1
    v_add_f32_dpp v38, v38, v38 row_ror:2 row_mask:0xf bank_mask:0xf
    s_nop 1
    v_add_f32_dpp v38, v38, v38 row_ror:1 row_mask:0xf bank_mask:0xf
    v_mov_b32 v36, v38
    s_nop 1
    v_permlane32_swap_b32 v38, v36
    v_add_f32 v38, v38, v36
    v_mov_b32 v36, v38
    s_nop 1
    v_permlane16_swap_b32 v38, v36
    v_add_f32 v38, v38, v36
    v_mov_b32 v36, 135200
    v_readfirstlane_b32 s57, v38
    ds_write_b32 v36, v38
    s_mul_i32 s86, s50, 3072
    s_add_u32 s86, s86, 151552
    v_lshl_add_u32 v7, v0, 4, s86
    s_lshl_b32 s86, s49, 10
    v_add_u32 v5, s86, v7
    s_lshl_b32 s86, s49, 3
    v_add_u32 v7, s86, v7
    s_mov_b32 s88, 0xffff0000
    s_mov_b32 s86, 0x00003f80
    s_mov_b32 s87, 0x3f800000
    s_branch L_h1_w0
L_h1_r0:
    s_ff1_i32_b32 s66, s65
    s_bitset0_b32 s65, s66
    s_lshl_b32 s66, s66, 10
    buffer_load_dwordx4 v[40:43], v2, s[16:19], s66 offen sc1
    s_cmp_eq_u32 s65, 0
    s_cbranch_scc1 L_h1_p1
L_h1_r1:
    s_ff1_i32_b32 s66, s65
    s_bitset0_b32 s65, s66
    s_lshl_b32 s66, s66, 10
    buffer_load_dwordx4 v[44:47], v2, s[16:19], s66 offen sc1
    s_cmp_eq_u32 s65, 0
    s_cbranch_scc1 L_h1_p2
L_h1_r2:
    s_ff1_i32_b32 s66, s65
    s_bitset0_b32 s65, s66
    s_lshl_b32 s66, s66, 10
    buffer_load_dwordx4 v[48:51], v2, s[16:19], s66 offen sc1
    s_cmp_eq_u32 s65, 0
    s_cbranch_scc1 L_h1_p3
L_h1_r3:
    s_ff1_i32_b32 s66, s65
    s_bitset0_b32 s65, s66
    s_lshl_b32 s66, s66, 10
    buffer_load_dwordx4 v[52:55], v2, s[16:19], s66 offen sc1
    s_cmp_eq_u32 s65, 0
    s_cbranch_scc1 L_h1_p4
L_h1_r4:
    s_ff1_i32_b32 s66, s65
    s_bitset0_b32 s65, s66
    s_lshl_b32 s66, s66, 10
    buffer_load_dwordx4 v[56:59], v2, s[16:19], s66 offen sc1
    s_cmp_eq_u32 s65, 0
    s_cbranch_scc1 L_h1_p5
L_h1_r5:
    s_ff1_i32_b32 s66, s65
    s_bitset0_b32 s65, s66
    s_lshl_b32 s66, s66, 10
    buffer_load_dwordx4 v[60:63], v2, s[16:19], s66 offen sc1
    s_cmp_eq_u32 s65, 0
    s_cbranch_scc1 L_h1_p6
L_h1_r6:
    s_ff1_i32_b32 s66, s65
    s_bitset0_b32 s65, s66
    s_lshl_b32 s66, s66, 10
    buffer_load_dwordx4 v[64:67], v2, s[16:19], s66 offen sc1
    s_cmp_eq_u32 s65, 0
    s_cbranch_scc1 L_h1_p7
L_h1_r7:
    s_ff1_i32_b32 s66, s65
    s_bitset0_b32 s65, s66
    s_lshl_b32 s66, s66, 10
    buffer_load_dwordx4 v[68:71], v2, s[16:19], s66 offen sc1
    s_cmp_eq_u32 s65, 0
    s_cbranch_scc1 L_h1_p8
L_h1_r8:
    s_ff1_i32_b32 s66, s65
    s_bitset0_b32 s65, s66
    s_lshl_b32 s66, s66, 10
    buffer_load_dwordx4 v[72:75], v2, s[16:19], s66 offen sc1
    s_cmp_eq_u32 s65, 0
    s_cbranch_scc1 L_h1_p9
L_h1_r9:
    s_ff1_i32_b32 s66, s65
    s_bitset0_b32 s65, s66
    s_lshl_b32 s66, s66, 10
    buffer_load_dwordx4 v[76:79], v2, s[16:19], s66 offen sc1
    s_cmp_eq_u32 s65, 0
    s_cbranch_scc1 L_h1_p10
L_h1_r10:
    s_ff1_i32_b32 s66, s65
    s_bitset0_b32 s65, s66
    s_lshl_b32 s66, s66, 10
    buffer_load_dwordx4 v[80:83], v2, s[16:19], s66 offen sc1
    s_cmp_eq_u32 s65, 0
    s_cbranch_scc1 L_h1_p11
L_h1_r11:
    s_ff1_i32_b32 s66, s65
    s_bitset0_b32 s65, s66
    s_lshl_b32 s66, s66, 10
    buffer_load_dwordx4 v[84:87], v2, s[16:19], s66 offen sc1
    s_cmp_eq_u32 s65, 0
    s_cbranch_scc1 L_h1_p12
L_h1_r12:
    s_ff1_i32_b32 s66, s65
    s_bitset0_b32 s65, s66
    s_lshl_b32 s66, s66, 10
    buffer_load_dwordx4 v[88:91], v2, s[16:19], s66 offen sc1
    s_cmp_eq_u32 s65, 0
    s_cbranch_scc1 L_h1_p13
L_h1_r13:
    s_ff1_i32_b32 s66, s65
    s_bitset0_b32 s65, s66
    s_lshl_b32 s66, s66, 10
    buffer_load_dwordx4 v[92:95], v2, s[16:19], s66 offen sc1
    s_cmp_eq_u32 s65, 0
    s_cbranch_scc1 L_h1_p14
L_h1_r14:
    s_ff1_i32_b32 s66, s65
    s_bitset0_b32 s65, s66
    s_lshl_b32 s66, s66, 10
    buffer_load_dwordx4 v[96:99], v2, s[16:19], s66 offen sc1
    s_cmp_eq_u32 s65, 0
    s_cbranch_scc1 L_h1_p15
L_h1_r15:
    s_ff1_i32_b32 s66, s65
    s_bitset0_b32 s65, s66
    s_lshl_b32 s66, s66, 10
    buffer_load_dwordx4 v[100:103], v2, s[16:19], s66 offen sc1
    buffer_load_dwordx4 v[104:107], v3, s[16:19], 0 offen sc1
L_h1_acc:
    s_waitcnt vmcnt(16)
    v_dot2c_f32_bf16 v112, s86, v40
    v_dot2c_f32_bf16 v113, s87, v40
    v_dot2c_f32_bf16 v114, s86, v41
    v_dot2c_f32_bf16 v115, s87, v41
    v_dot2c_f32_bf16 v116, s86, v42
    v_dot2c_f32_bf16 v117, s87, v42
    v_dot2c_f32_bf16 v118, s86, v43
    v_dot2c_f32_bf16 v119, s87, v43
    s_waitcnt vmcnt(15)
    v_dot2c_f32_bf16 v112, s86, v44
    v_dot2c_f32_bf16 v113, s87, v44
    v_dot2c_f32_bf16 v114, s86, v45
    v_dot2c_f32_bf16 v115, s87, v45
    v_dot2c_f32_bf16 v116, s86, v46
    v_dot2c_f32_bf16 v117, s87, v46
    v_dot2c_f32_bf16 v118, s86, v47
    v_dot2c_f32_bf16 v119, s87, v47
    s_waitcnt vmcnt(14)
    v_dot2c_f32_bf16 v112, s86, v48
    v_dot2c_f32_bf16 v113, s87, v48
    v_dot2c_f32_bf16 v114, s86, v49
    v_dot2c_f32_bf16 v115, s87, v49
    v_dot2c_f32_bf16 v116, s86, v50
    v_dot2c_f32_bf16 v117, s87, v50
    v_dot2c_f32_bf16 v118, s86, v51
    v_dot2c_f32_bf16 v119, s87, v51
    v_max3_u32 v4, v43, v47, v51
    s_waitcnt vmcnt(13)
    v_dot2c_f32_bf16 v112, s86, v52
    v_dot2c_f32_bf16 v113, s87, v52
    v_dot2c_f32_bf16 v114, s86, v53
    v_dot2c_f32_bf16 v115, s87, v53
    v_dot2c_f32_bf16 v116, s86, v54
    v_dot2c_f32_bf16 v117, s87, v54
    v_dot2c_f32_bf16 v118, s86, v55
    v_dot2c_f32_bf16 v119, s87, v55
    s_waitcnt vmcnt(12)
    v_dot2c_f32_bf16 v112, s86, v56
    v_dot2c_f32_bf16 v113, s87, v56
    v_dot2c_f32_bf16 v114, s86, v57
    v_dot2c_f32_bf16 v115, s87, v57
    v_dot2c_f32_bf16 v116, s86, v58
    v_dot2c_f32_bf16 v117, s87, v58
    v_dot2c_f32_bf16 v118, s86, v59
    v_dot2c_f32_bf16 v119, s87, v59
    v_max3_u32 v4, v4, v55, v59
    s_waitcnt vmcnt(11)
    v_dot2c_f32_bf16 v112, s86, v60
    v_dot2c_f32_bf16 v113, s87, v60
    v_dot2c_f32_bf16 v114, s86, v61
    v_dot2c_f32_bf16 v115, s87, v61
    v_dot2c_f32_bf16 v116, s86, v62
    v_dot2c_f32_bf16 v117, s87, v62
    v_dot2c_f32_bf16 v118, s86, v63
    v_dot2c_f32_bf16 v119, s87, v63
    s_waitcnt vmcnt(10)
    v_dot2c_f32_bf16 v112, s86, v64
    v_dot2c_f32_bf16 v113, s87, v64
    v_dot2c_f32_bf16 v114, s86, v65
    v_dot2c_f32_bf16 v115, s87, v65
    v_dot2c_f32_bf16 v116, s86, v66
    v_dot2c_f32_bf16 v117, s87, v66
    v_dot2c_f32_bf16 v118, s86, v67
    v_dot2c_f32_bf16 v119, s87, v67
    v_max3_u32 v4, v4, v63, v67
L_walk_7:
    s_cbranch_execz L_walk_14
    s_waitcnt vmcnt(9)
    v_dot2c_f32_bf16 v112, s86, v68
    v_dot2c_f32_bf16 v113, s87, v68
    v_dot2c_f32_bf16 v114, s86, v69
    v_dot2c_f32_bf16 v115, s87, v69
    v_dot2c_f32_bf16 v116, s86, v70
    v_dot2c_f32_bf16 v117, s87, v70
    v_dot2c_f32_bf16 v118, s86, v71
    v_dot2c_f32_bf16 v119, s87, v71
    s_waitcnt vmcnt(8)
    v_dot2c_f32_bf16 v112, s86, v72
    v_dot2c_f32_bf16 v113, s87, v72
    v_dot2c_f32_bf16 v114, s86, v73
    v_dot2c_f32_bf16 v115, s87, v73
    v_dot2c_f32_bf16 v116, s86, v74
    v_dot2c_f32_bf16 v117, s87, v74
    v_dot2c_f32_bf16 v118, s86, v75
    v_dot2c_f32_bf16 v119, s87, v75
    v_max3_u32 v4, v4, v71, v75
    s_waitcnt vmcnt(7)
    v_dot2c_f32_bf16 v112, s86, v76
    v_dot2c_f32_bf16 v113, s87, v76
    v_dot2c_f32_bf16 v114, s86, v77
    v_dot2c_f32_bf16 v115, s87, v77
    v_dot2c_f32_bf16 v116, s86, v78
    v_dot2c_f32_bf16 v117, s87, v78
    v_dot2c_f32_bf16 v118, s86, v79
    v_dot2c_f32_bf16 v119, s87, v79
    s_waitcnt vmcnt(6)
    v_dot2c_f32_bf16 v112, s86, v80
    v_dot2c_f32_bf16 v113, s87, v80
    v_dot2c_f32_bf16 v114, s86, v81
    v_dot2c_f32_bf16 v115, s87, v81
    v_dot2c_f32_bf16 v116, s86, v82
    v_dot2c_f32_bf16 v117, s87, v82
    v_dot2c_f32_bf16 v118, s86, v83
    v_dot2c_f32_bf16 v119, s87, v83
    v_max3_u32 v4, v4, v79, v83
    s_waitcnt vmcnt(5)
    v_dot2c_f32_bf16 v112, s86, v84
    v_dot2c_f32_bf16 v113, s87, v84
    v_dot2c_f32_bf16 v114, s86, v85
    v_dot2c_f32_bf16 v115, s87, v85
    v_dot2c_f32_bf16 v116, s86, v86
    v_dot2c_f32_bf16 v117, s87, v86
    v_dot2c_f32_bf16 v118, s86, v87
    v_dot2c_f32_bf16 v119, s87, v87
    s_waitcnt vmcnt(4)
    v_dot2c_f32_bf16 v112, s86, v88
    v_dot2c_f32_bf16 v113, s87, v88
    v_dot2c_f32_bf16 v114, s86, v89
    v_dot2c_f32_bf16 v115, s87, v89
    v_dot2c_f32_bf16 v116, s86, v90
    v_dot2c_f32_bf16 v117, s87, v90
    v_dot2c_f32_bf16 v118, s86, v91
    v_dot2c_f32_bf16 v119, s87, v91
    v_max3_u32 v4, v4, v87, v91
    s_waitcnt vmcnt(3)
    v_dot2c_f32_bf16 v112, s86, v92
    v_dot2c_f32_bf16 v113, s87, v92
    v_dot2c_f32_bf16 v114, s86, v93
    v_dot2c_f32_bf16 v115, s87, v93
    v_dot2c_f32_bf16 v116, s86, v94
    v_dot2c_f32_bf16 v117, s87, v94
    v_dot2c_f32_bf16 v118, s86, v95
    v_dot2c_f32_bf16 v119, s87, v95
    s_waitcnt vmcnt(2)
    v_dot2c_f32_bf16 v112, s86, v96
    v_dot2c_f32_bf16 v113, s87, v96
    v_dot2c_f32_bf16 v114, s86, v97
    v_dot2c_f32_bf16 v115, s87, v97
    v_dot2c_f32_bf16 v116, s86, v98
    v_dot2c_f32_bf16 v117, s87, v98
    v_dot2c_f32_bf16 v118, s86, v99
    v_dot2c_f32_bf16 v119, s87, v99
    v_max3_u32 v4, v4, v95, v99
    s_waitcnt vmcnt(1)
    v_dot2c_f32_bf16 v112, s86, v100
    v_dot2c_f32_bf16 v113, s87, v100
    v_dot2c_f32_bf16 v114, s86, v101
    v_dot2c_f32_bf16 v115, s87, v101
    v_dot2c_f32_bf16 v116, s86, v102
    v_dot2c_f32_bf16 v117, s87, v102
    v_dot2c_f32_bf16 v118, s86, v103
    v_dot2c_f32_bf16 v119, s87, v103
    s_waitcnt vmcnt(0)
    v_max3_u32 v4, v4, v103, v107
    v_add_f32_dpp v104, v104, v104 row_ror:8 row_mask:0xf bank_mask:0xf
    v_add_f32_dpp v105, v105, v105 row_ror:8 row_mask:0xf bank_mask:0xf
    v_add_f32_dpp v106, v106, v106 row_ror:8 row_mask:0xf bank_mask:0xf
    v_add_f32_dpp v107, v107, v107 row_ror:8 row_mask:0xf bank_mask:0xf
    v_cvt_pk_bf16_f32 v120, v112, v113
    v_cvt_pk_bf16_f32 v121, v114, v115
    v_cvt_pk_bf16_f32 v122, v116, v117
    v_cvt_pk_bf16_f32 v123, v118, v119
    ds_write_b128 v5, v[120:123]
    v_add_f32_dpp v104, v104, v104 row_ror:4 row_mask:0xf bank_mask:0xf
    v_add_f32_dpp v105, v105, v105 row_ror:4 row_mask:0xf bank_mask:0xf
    v_add_f32_dpp v106, v106, v106 row_ror:4 row_mask:0xf bank_mask:0xf
    v_add_f32_dpp v107, v107, v107 row_ror:4 row_mask:0xf bank_mask:0xf
    v_add_f32_dpp v104, v104, v104 row_ror:2 row_mask:0xf bank_mask:0xf
    v_add_f32_dpp v105, v105, v105 row_ror:2 row_mask:0xf bank_mask:0xf
    v_add_f32_dpp v106, v106, v106 row_ror:2 row_mask:0xf bank_mask:0xf
    v_add_f32_dpp v107, v107, v107 row_ror:2 row_mask:0xf bank_mask:0xf
    v_add_f32_dpp v104, v104, v104 row_ror:1 row_mask:0xf bank_mask:0xf
    v_add_f32_dpp v105, v105, v105 row_ror:1 row_mask:0xf bank_mask:0xf
    v_add_f32_dpp v106, v106, v106 row_ror:1 row_mask:0xf bank_mask:0xf
    v_add_f32_dpp v107, v107, v107 row_ror:1 row_mask:0xf bank_mask:0xf
    v_cmp_eq_u32 vcc, -1, v4
    v_cvt_pk_bf16_f32 v124, v104, v105
    v_cvt_pk_bf16_f32 v125, v106, v107
    ds_write_b64 v7, v[124:125] offset:2048
    s_cbranch_vccnz L_h1_again
L_h1_done:
    s_waitcnt lgkmcnt(0)
    s_barrier
    s_or_b32 s86, s2, s48
    s_cmp_eq_u32 s86, 0
    s_cselect_b32 s86, 0, 2147483648
    s_add_u32 s86, s86, 524288
    v_mov_b32 v6, s86
    buffer_store_dword v35, v6, s[16:19], 0 offen sc1
    v_mov_b32 v11, v30
    v_mov_b32 v14, v31
    v_mov_b32 v8, 0
    buffer_atomic_or v8, v159, s[16:19], 0 offen sc0 sc1
    s_branch L_phaseB
L_h1_p0:
    v_mov_b32 v4, 0
    buffer_atomic_or v4, v6, s[16:19], 0 offen sc0 sc1
L_h1_w0:
    s_waitcnt vmcnt(0)
    v_cmp_eq_u32 vcc, s68, v4
    s_nop 0
    s_andn2_b32 s65, vcc_lo, s88
    s_or_b32 s88, s88, s65
    s_cmp_lg_u32 s65, 0
    s_cbranch_scc1 L_h1_r0
    s_sub_u32 s56, s56, 1
    s_cbranch_scc0 L_h1_p0
    s_mov_b32 s56, 0
    s_not_b32 s65, s88
    s_branch L_h1_r0
L_h1_p1:
    v_mov_b32 v4, 0
    buffer_atomic_or v4, v6, s[16:19], 0 offen sc0 sc1
    s_waitcnt vmcnt(0)
    v_cmp_eq_u32 vcc, s68, v4
    s_nop 0
    s_andn2_b32 s65, vcc_lo, s88
    s_or_b32 s88, s88, s65
    s_cmp_lg_u32 s65, 0
    s_cbranch_scc1 L_h1_r1
    s_sub_u32 s56, s56, 1
    s_cbranch_scc0 L_h1_p1
    s_mov_b32 s56, 0
    s_not_b32 s65, s88
    s_branch L_h1_r1
L_h1_p2:
    v_mov_b32 v4, 0
    buffer_atomic_or v4, v6, s[16:19], 0 offen sc0 sc1
    s_waitcnt vmcnt(0)
    v_cmp_eq_u32 vcc, s68, v4
    s_nop 0
    s_andn2_b32 s65, vcc_lo, s88
    s_or_b32 s88, s88, s65
    s_cmp_lg_u32 s65, 0
    s_cbranch_scc1 L_h1_r2
    s_sub_u32 s56, s56, 1
    s_cbranch_scc0 L_h1_p2
    s_mov_b32 s56, 0
    s_not_b32 s65, s88
    s_branch L_h1_r2
L_h1_p3:
    v_mov_b32 v4, 0
    buffer_atomic_or v4, v6, s[16:19], 0 offen sc0 sc1
    s_waitcnt vmcnt(0)
    v_cmp_eq_u32 vcc, s68, v4
    s_nop 0
    s_andn2_b32 s65, vcc_lo, s88
    s_or_b32 s88, s88, s65
    s_cmp_lg_u32 s65, 0
    s_cbranch_scc1 L_h1_r3
    s_sub_u32 s56, s56, 1
    s_cbranch_scc0 L_h1_p3
    s_mov_b32 s56, 0
    s_not_b32 s65, s88
    s_branch L_h1_r3
L_h1_p4:
    v_mov_b32 v4, 0
    buffer_atomic_or v4, v6, s[16:19], 0 offen sc0 sc1
    s_waitcnt vmcnt(0)
    v_cmp_eq_u32 vcc, s68, v4
    s_nop 0
    s_andn2_b32 s65, vcc_lo, s88
    s_or_b32 s88, s88, s65
    s_cmp_lg_u32 s65, 0
    s_cbranch_scc1 L_h1_r4
    s_sub_u32 s56, s56, 1
    s_cbranch_scc0 L_h1_p4
    s_mov_b32 s56, 0
    s_not_b32 s65, s88
    s_branch L_h1_r4
L_h1_p5:
    v_mov_b32 v4, 0
    buffer_atomic_or v4, v6, s[16:19], 0 offen sc0 sc1
    s_waitcnt vmcnt(0)
    v_cmp_eq_u32 vcc, s68, v4
    s_nop 0
    s_andn2_b32 s65, vcc_lo, s88
    s_or_b32 s88, s88, s65
    s_cmp_lg_u32 s65, 0
    s_cbranch_scc1 L_h1_r5
    s_sub_u32 s56, s56, 1
    s_cbranch_scc0 L_h1_p5
    s_mov_b32 s56, 0
    s_not_b32 s65, s88
    s_branch L_h1_r5
L_h1_p6:
    v_mov_b32 v4, 0
    buffer_atomic_or v4, v6, s[16:19], 0 offen sc0 sc1
    s_waitcnt vmcnt(0)
    v_cmp_eq_u32 vcc, s68, v4
    s_nop 0
    s_andn2_b32 s65, vcc_lo, s88
    s_or_b32 s88, s88, s65
    s_cmp_lg_u32 s65, 0
    s_cbranch_scc1 L_h1_r6
    s_sub_u32 s56, s56, 1
    s_cbranch_scc0 L_h1_p6
    s_mov_b32 s56, 0
    s_not_b32 s65, s88
    s_branch L_h1_r6
L_h1_p7:
    v_mov_b32 v4, 0
    buffer_atomic_or v4, v6, s[16:19], 0 offen sc0 sc1
    s_waitcnt vmcnt(0)
    v_cmp_eq_u32 vcc, s68, v4
    s_nop 0
    s_andn2_b32 s65, vcc_lo, s88
    s_or_b32 s88, s88, s65
    s_cmp_lg_u32 s65, 0
    s_cbranch_scc1 L_h1_r7
    s_sub_u32 s56, s56, 1
    s_cbranch_scc0 L_h1_p7
    s_mov_b32 s56, 0
    s_not_b32 s65, s88
    s_branch L_h1_r7
L_walk_8:
    s_cbranch_execz L_walk_15
L_h1_p8:
    v_mov_b32 v4, 0
    buffer_atomic_or v4, v6, s[16:19], 0 offen sc0 sc1
    s_waitcnt vmcnt(0)
    v_cmp_eq_u32 vcc, s68, v4
    s_nop 0
    s_andn2_b32 s65, vcc_lo, s88
    s_or_b32 s88, s88, s65
    s_cmp_lg_u32 s65, 0
    s_cbranch_scc1 L_h1_r8
    s_sub_u32 s56, s56, 1
    s_cbranch_scc0 L_h1_p8
    s_mov_b32 s56, 0
    s_not_b32 s65, s88
    s_branch L_h1_r8
L_h1_p9:
    v_mov_b32 v4, 0
    buffer_atomic_or v4, v6, s[16:19], 0 offen sc0 sc1
    s_waitcnt vmcnt(0)
    v_cmp_eq_u32 vcc, s68, v4
    s_nop 0
    s_andn2_b32 s65, vcc_lo, s88
    s_or_b32 s88, s88, s65
    s_cmp_lg_u32 s65, 0
    s_cbranch_scc1 L_h1_r9
    s_sub_u32 s56, s56, 1
    s_cbranch_scc0 L_h1_p9
    s_mov_b32 s56, 0
    s_not_b32 s65, s88
    s_branch L_h1_r9
L_h1_p10:
    v_mov_b32 v4, 0
    buffer_atomic_or v4, v6, s[16:19], 0 offen sc0 sc1
    s_waitcnt vmcnt(0)
    v_cmp_eq_u32 vcc, s68, v4
    s_nop 0
    s_andn2_b32 s65, vcc_lo, s88
    s_or_b32 s88, s88, s65
    s_cmp_lg_u32 s65, 0
    s_cbranch_scc1 L_h1_r10
    s_sub_u32 s56, s56, 1
    s_cbranch_scc0 L_h1_p10
    s_mov_b32 s56, 0
    s_not_b32 s65, s88
    s_branch L_h1_r10
L_h1_p11:
    v_mov_b32 v4, 0
    buffer_atomic_or v4, v6, s[16:19], 0 offen sc0 sc1
    s_waitcnt vmcnt(0)
    v_cmp_eq_u32 vcc, s68, v4
    s_nop 0
    s_andn2_b32 s65, vcc_lo, s88
    s_or_b32 s88, s88, s65
    s_cmp_lg_u32 s65, 0
    s_cbranch_scc1 L_h1_r11
    s_sub_u32 s56, s56, 1
    s_cbranch_scc0 L_h1_p11
    s_mov_b32 s56, 0
    s_not_b32 s65, s88
    s_branch L_h1_r11
L_h1_p12:
    v_mov_b32 v4, 0
    buffer_atomic_or v4, v6, s[16:19], 0 offen sc0 sc1
    s_waitcnt vmcnt(0)
    v_cmp_eq_u32 vcc, s68, v4
    s_nop 0
    s_andn2_b32 s65, vcc_lo, s88
    s_or_b32 s88, s88, s65
    s_cmp_lg_u32 s65, 0
    s_cbranch_scc1 L_h1_r12
    s_sub_u32 s56, s56, 1
    s_cbranch_scc0 L_h1_p12
    s_mov_b32 s56, 0
    s_not_b32 s65, s88
    s_branch L_h1_r12
L_h1_p13:
    v_mov_b32 v4, 0
    buffer_atomic_or v4, v6, s[16:19], 0 offen sc0 sc1
    s_waitcnt vmcnt(0)
    v_cmp_eq_u32 vcc, s68, v4
    s_nop 0
    s_andn2_b32 s65, vcc_lo, s88
    s_or_b32 s88, s88, s65
    s_cmp_lg_u32 s65, 0
    s_cbranch_scc1 L_h1_r13
    s_sub_u32 s56, s56, 1
    s_cbranch_scc0 L_h1_p13
    s_mov_b32 s56, 0
    s_not_b32 s65, s88
    s_branch L_h1_r13
L_h1_p14:
    v_mov_b32 v4, 0
    buffer_atomic_or v4, v6, s[16:19], 0 offen sc0 sc1
    s_waitcnt vmcnt(0)
    v_cmp_eq_u32 vcc, s68, v4
    s_nop 0
    s_andn2_b32 s65, vcc_lo, s88
    s_or_b32 s88, s88, s65
    s_cmp_lg_u32 s65, 0
    s_cbranch_scc1 L_h1_r14
    s_sub_u32 s56, s56, 1
    s_cbranch_scc0 L_h1_p14
    s_mov_b32 s56, 0
    s_not_b32 s65, s88
    s_branch L_h1_r14
L_h1_p15:
    v_mov_b32 v4, 0
    buffer_atomic_or v4, v6, s[16:19], 0 offen sc0 sc1
    s_waitcnt vmcnt(0)
    v_cmp_eq_u32 vcc, s68, v4
    s_nop 0
    s_andn2_b32 s65, vcc_lo, s88
    s_or_b32 s88, s88, s65
    s_cmp_lg_u32 s65, 0
    s_cbranch_scc1 L_h1_r15
    s_sub_u32 s56, s56, 1
    s_cbranch_scc0 L_h1_p15
    s_mov_b32 s56, 0
    s_not_b32 s65, s88
    s_branch L_h1_r15
L_h1_again:
    s_sub_u32 s56, s56, 1
    s_cbranch_scc0 L_h1_re
    s_mov_b32 s56, 0
    s_branch L_h1_done
L_h1_re:
    buffer_load_dwordx4 v[40:43], v2, s[16:19], 0 offen offset:0 sc1
    buffer_load_dwordx4 v[44:47], v2, s[16:19], 0 offen offset:1024 sc1
    buffer_load_dwordx4 v[48:51], v2, s[16:19], 0 offen offset:2048 sc1
    buffer_load_dwordx4 v[52:55], v2, s[16:19], 0 offen offset:3072 sc1
    buffer_load_dwordx4 v[56:59], v2, s[16:19], s92 offen offset:0 sc1
    buffer_load_dwordx4 v[60:63], v2, s[16:19], s92 offen offset:1024 sc1
    buffer_load_dwordx4 v[64:67], v2, s[16:19], s92 offen offset:2048 sc1
    buffer_load_dwordx4 v[68:71], v2, s[16:19], s92 offen offset:3072 sc1
    buffer_load_dwordx4 v[72:75], v2, s[16:19], s93 offen offset:0 sc1
    buffer_load_dwordx4 v[76:79], v2, s[16:19], s93 offen offset:1024 sc1
    buffer_load_dwordx4 v[80:83], v2, s[16:19], s93 offen offset:2048 sc1
    buffer_load_dwordx4 v[84:87], v2, s[16:19], s93 offen offset:3072 sc1
    buffer_load_dwordx4 v[88:91], v2, s[16:19], s94 offen offset:0 sc1
    buffer_load_dwordx4 v[92:95], v2, s[16:19], s94 offen offset:1024 sc1
    buffer_load_dwordx4 v[96:99], v2, s[16:19], s94 offen offset:2048 sc1
    buffer_load_dwordx4 v[100:103], v2, s[16:19], s94 offen offset:3072 sc1
    buffer_load_dwordx4 v[104:107], v3, s[16:19], 0 offen sc1
    v_mov_b32 v112, 0
    v_mov_b32 v113, 0
    v_mov_b32 v114, 0
    v_mov_b32 v115, 0
    v_mov_b32 v116, 0
    v_mov_b32 v117, 0
    v_mov_b32 v118, 0
    v_mov_b32 v119, 0
    s_branch L_h1_acc
L_comp:
    s_mov_b64 exec, -1
    v_and_b32 v20, 15, v0
    v_lshrrev_b32 v21, 4, v0
    v_bfe_u32 v22, v0, 1, 3
    s_lshl_b32 s86, s49, 13
    v_lshl_add_u32 v20, v20, 7, s86
    v_or_b32 v23, 0, v21
    v_xor_b32 v23, v23, v22
    v_lshl_add_u32 v2, v23, 4, v20
    v_or_b32 v23, 4, v21
    v_xor_b32 v23, v23, v22
    v_lshl_add_u32 v3, v23, 4, v20
    v_bfe_u32 v22, v0, 2, 2
    v_lshl_add_u32 v22, v21, 3, v22
    v_lshlrev_b32 v22, 7, v22
    v_bfe_u32 v23, v0, 3, 2
    s_lshl_b32 s86, s50, 1
    v_xor_b32 v23, s86, v23
    v_lshl_add_u32 v22, v23, 5, v22
    v_and_b32 v23, 3, v0
    v_lshl_add_u32 v22, v23, 3, v22
    v_add_u32 v4, 16384, v22
    v_xor_b32 v5, 32, v4
    s_lshl_b32 s53, s2, 2
    s_add_u32 s53, s53, s3
    s_lshl_b32 s86, s53, 12
    s_add_u32 s86, s86, 1048576
    v_lshl_add_u32 v6, v0, 4, s86
    s_mul_i32 s53, s53, 160
    s_add_u32 s53, s53, 6553600
    v_lshl_add_u32 v17, v0, 4, s53
    v_mov_b32 v16, 2147483648
    v_cmp_gt_u32 vcc, 10, v0
    s_nop 1
    v_cndmask_b32 v17, v16, v17, vcc
    s_lshl_b32 s86, s47, 1
    s_add_u32 s86, s86, s50
    s_lshl_b32 s87, s86, 4
    s_add_u32 s87, s87, s46
    s_lshl_b32 s87, s87, 1
    s_add_u32 s87, s87, s49
    s_lshl_b32 s87, s87, 6
    s_add_u32 s87, s87, 6880320
    v_lshl_add_u32 v16, v0, 4, s87
    v_cmp_le_u32 vcc, 60, v0
    s_nop 1
    v_cndmask_b32 v17, v17, v16, vcc
    s_lshl_b32 s87, s86, 1
    s_add_u32 s87, s87, s49
    s_lshl_b32 s87, s87, 4
    s_add_u32 s87, s87, s46
    s_lshl_b32 s87, s87, 10
    s_add_u32 s87, s87, 5242880
    v_lshl_add_u32 v16, v0, 4, s87
    v_mov_b32 v8, -1
    v_mov_b32 v9, -1
    v_mov_b32 v10, -1
    v_mov_b32 v11, -1
    s_waitcnt lgkmcnt(0)
    s_load_dword s61, s[84:85], 524288
    s_mov_b32 s16, s84
    s_and_b32 s17, s85, 0xffff
    s_mov_b32 s18, 268435456
    s_mov_b32 s19, 0x20000
    s_mov_b32 s8, s64
    s_and_b32 s9, s65, 0xffff
    s_mov_b32 s10, 4194304
    s_mov_b32 s11, 0x20000
    s_mov_b32 s20, s68
    s_and_b32 s21, s69, 0xffff
    s_mov_b32 s22, 2097152
    s_mov_b32 s23, 0x20000
    s_mov_b32 s24, s80
    s_and_b32 s25, s81, 0xffff
    s_mov_b32 s26, 4194304
    s_mov_b32 s27, 0x20000
    s_mov_b32 s28, s82
    s_and_b32 s29, s83, 0xffff
    s_mov_b32 s30, 256
    s_mov_b32 s31, 0x20000
    s_bitcmp1_b32 s2, 0
    s_cselect_b32 s32, s76, s74
    s_cselect_b32 s33, s77, s75
    s_and_b32 s33, s33, 0xffff
    s_mov_b32 s34, 7340032
    s_mov_b32 s35, 0x20000
    s_mov_b32 s36, s78
    s_and_b32 s37, s79, 0xffff
    s_mov_b32 s38, 7340032
    s_mov_b32 s39, 0x20000
    s_mov_b32 s40, s72
    s_and_b32 s41, s73, 0xffff
    s_mov_b32 s42, 2048
    s_mov_b32 s43, 0x20000
    s_lshl_b32 s86, s2, 9
    s_add_u32 s86, s86, 786432
    s_cmp_eq_u32 s3, 0
    s_cselect_b32 s86, s86, 2147483648
    v_lshl_add_u32 v7, v0, 2, s86
    v_mul_u32_u24 v12, 192, v21
    v_add_u32 v7, v7, v12
    s_lshl_b32 s86, s2, 8
    s_add_u32 s86, s86, 917376
    s_cmp_eq_u32 s3, 0
    s_cselect_b32 s86, s86, 2147483648
    v_lshl_add_u32 v12, v0, 2, s86
    v_cmp_gt_u32 vcc, 32, v0
    s_nop 1
    v_cndmask_b32 v7, v12, v7, vcc
    v_mov_b32 v12, 2147483648
    v_cmp_gt_u32 vcc, 48, v0
    s_nop 1
    v_cndmask_b32 v7, v12, v7, vcc
    s_lshl_b32 s86, s2, 9
    s_add_u32 s86, s86, 6291456
    v_lshl_add_u32 v13, v0, 2, s86
    v_mul_u32_u24 v12, 64, v21
    v_add_u32 v13, v13, v12
    s_cmp_eq_u32 s3, 1
    s_cselect_b64 vcc, -1, 0
    v_cndmask_b32 v7, v7, v13, vcc
    v_mov_b32 v12, 0
    buffer_store_dword v12, v7, s[16:19], 0 offen sc1
    v_mov_b32 v128, 0
    v_mov_b32 v129, 0
    v_mov_b32 v130, 0
    v_mov_b32 v131, 0
    v_mov_b32 v132, 0
    v_mov_b32 v133, 0
    v_mov_b32 v134, 0
    v_mov_b32 v135, 0
    v_mov_b32 v136, 0
    v_mov_b32 v137, 0
    v_mov_b32 v138, 0
    v_mov_b32 v139, 0
    v_mov_b32 v140, 0
    v_mov_b32 v141, 0
    v_mov_b32 v142, 0
    v_mov_b32 v143, 0
    v_mov_b32 v144, 0
    v_mov_b32 v145, 0
    v_mov_b32 v146, 0
    v_mov_b32 v147, 0
    v_mov_b32 v148, 0
    v_mov_b32 v149, 0
    v_mov_b32 v150, 0
    v_mov_b32 v151, 0
    v_mov_b32 v152, 0
    v_mov_b32 v153, 0
    v_mov_b32 v154, 0
    v_mov_b32 v155, 0
    v_mov_b32 v156, 0
    v_mov_b32 v157, 0
    v_mov_b32 v158, 0
    v_mov_b32 v159, 0
    v_mov_b32 v160, 0
    v_mov_b32 v161, 0
    v_mov_b32 v162, 0
    v_mov_b32 v163, 0
    v_mov_b32 v164, 0
    v_mov_b32 v165, 0
    v_mov_b32 v166, 0
    v_mov_b32 v167, 0
    v_mov_b32 v168, 0
    v_mov_b32 v169, 0
    v_mov_b32 v170, 0
    v_mov_b32 v171, 0
    v_mov_b32 v172, 0
    v_mov_b32 v173, 0
    v_mov_b32 v174, 0
    v_mov_b32 v175, 0
    v_mov_b32 v176, 0
    v_mov_b32 v177, 0
    v_mov_b32 v178, 0
    v_mov_b32 v179, 0
    v_mov_b32 v180, 0
    v_mov_b32 v181, 0
    v_mov_b32 v182, 0
    v_mov_b32 v183, 0
    v_mov_b32 v184, 0
    v_mov_b32 v185, 0
    v_mov_b32 v186, 0
    v_mov_b32 v187, 0
    v_mov_b32 v188, 0
    v_mov_b32 v189, 0
    v_mov_b32 v190, 0
    v_mov_b32 v191, 0
    v_mov_b32 v192, 0
    v_mov_b32 v193, 0
    v_mov_b32 v194, 0
    v_mov_b32 v195, 0
    v_mov_b32 v196, 0
    v_mov_b32 v197, 0
    v_mov_b32 v198, 0
    v_mov_b32 v199, 0
    v_mov_b32 v200, 0
    v_mov_b32 v201, 0
    v_mov_b32 v202, 0
    v_mov_b32 v203, 0
    v_mov_b32 v204, 0
    v_mov_b32 v205, 0
    v_mov_b32 v206, 0
    v_mov_b32 v207, 0
    v_mov_b32 v208, 0
    v_mov_b32 v209, 0
    v_mov_b32 v210, 0
    v_mov_b32 v211, 0
    v_mov_b32 v212, 0
    v_mov_b32 v213, 0
    v_mov_b32 v214, 0
    v_mov_b32 v215, 0
    v_mov_b32 v216, 0
    v_mov_b32 v217, 0
L_walkA2:
    s_cbranch_execz L_comp
    v_mov_b32 v218, 0
    v_mov_b32 v219, 0
    v_mov_b32 v220, 0
    v_mov_b32 v221, 0
    v_mov_b32 v222, 0
    v_mov_b32 v223, 0
    s_mov_b32 s54, 0x358637bd
    s_mov_b32 s55, 0x358637bd
    s_mov_b32 s62, 0
    s_mov_b32 s63, 1
    v_add_u32 v2, 40960, v2
    v_add_u32 v3, 40960, v3
    v_add_u32 v4, 40960, v4
    v_add_u32 v5, 40960, v5
    s_mov_b64 exec, 0
    s_cmp_eq_u32 s3, 0
    s_cbranch_scc1 L_walkB0
    s_cmp_eq_u32 s3, 1
    s_cbranch_scc1 L_walkB1
    s_cmp_eq_u32 s3, 2
    s_cbranch_scc1 L_walkB2
    s_branch L_walkB3
L_walked:
    s_mov_b64 exec, -1
    s_waitcnt lgkmcnt(0)
    s_add_u32 s68, s61, 0x9e3779b9
    s_barrier
    ds_read_b128 v[40:43], v2 offset:0
    ds_read_b128 v[44:47], v2 offset:2048
    ds_read_b128 v[48:51], v2 offset:4096
    ds_read_b128 v[52:55], v2 offset:6144
    ds_read_b64_tr_b16 v[56:57], v4 offset:0
    ds_read_b64_tr_b16 v[58:59], v4 offset:512
    ds_read_b64_tr_b16 v[60:61], v5 offset:0
    ds_read_b64_tr_b16 v[62:63], v5 offset:512
    ds_read_b64_tr_b16 v[64:65], v4 offset:8192
    ds_read_b64_tr_b16 v[66:67], v4 offset:8704
    ds_read_b64_tr_b16 v[68:69], v5 offset:8192
    ds_read_b64_tr_b16 v[70:71], v5 offset:8704
    ds_read_b64_tr_b16 v[72:73], v4 offset:16384
    ds_read_b64_tr_b16 v[74:75], v4 offset:16896
    ds_read_b64_tr_b16 v[76:77], v5 offset:16384
    ds_read_b64_tr_b16 v[78:79], v5 offset:16896
L_cloop:
    s_waitcnt lgkmcnt(0)
    v_mfma_f32_16x16x32_bf16 v[128:131], v[56:59], v[40:43], v[128:131]
    ds_read_b128 v[80:83], v3 offset:0
    v_mfma_f32_16x16x32_bf16 v[132:135], v[56:59], v[44:47], v[132:135]
    ds_read_b128 v[84:87], v3 offset:2048
    v_mfma_f32_16x16x32_bf16 v[136:139], v[56:59], v[48:51], v[136:139]
    ds_read_b128 v[88:91], v3 offset:4096
    v_mfma_f32_16x16x32_bf16 v[140:143], v[56:59], v[52:55], v[140:143]
    ds_read_b128 v[92:95], v3 offset:6144
    v_mfma_f32_16x16x32_bf16 v[144:147], v[60:63], v[40:43], v[144:147]
    ds_read_b64_tr_b16 v[96:97], v4 offset:4096
    v_mfma_f32_16x16x32_bf16 v[148:151], v[60:63], v[44:47], v[148:151]
    ds_read_b64_tr_b16 v[98:99], v4 offset:4608
    v_mfma_f32_16x16x32_bf16 v[152:155], v[60:63], v[48:51], v[152:155]
    ds_read_b64_tr_b16 v[100:101], v5 offset:4096
    v_mfma_f32_16x16x32_bf16 v[156:159], v[60:63], v[52:55], v[156:159]
    ds_read_b64_tr_b16 v[102:103], v5 offset:4608
    v_mfma_f32_16x16x32_bf16 v[160:163], v[40:43], v[64:67], v[160:163]
    ds_read_b64_tr_b16 v[104:105], v4 offset:12288
    v_mfma_f32_16x16x32_bf16 v[164:167], v[44:47], v[64:67], v[164:167]
    ds_read_b64_tr_b16 v[106:107], v4 offset:12800
    v_mfma_f32_16x16x32_bf16 v[168:171], v[48:51], v[64:67], v[168:171]
    ds_read_b64_tr_b16 v[108:109], v5 offset:12288
    v_mfma_f32_16x16x32_bf16 v[172:175], v[52:55], v[64:67], v[172:175]
    ds_read_b64_tr_b16 v[110:111], v5 offset:12800
    v_mfma_f32_16x16x32_bf16 v[176:179], v[40:43], v[68:71], v[176:179]
    ds_read_b64_tr_b16 v[112:113], v4 offset:20480
    v_mfma_f32_16x16x32_bf16 v[180:183], v[44:47], v[68:71], v[180:183]
    ds_read_b64_tr_b16 v[114:115], v4 offset:20992
    v_mfma_f32_16x16x32_bf16 v[184:187], v[48:51], v[68:71], v[184:187]
    ds_read_b64_tr_b16 v[116:117], v5 offset:20480
    v_mfma_f32_16x16x32_bf16 v[188:191], v[52:55], v[68:71], v[188:191]
    ds_read_b64_tr_b16 v[118:119], v5 offset:20992
    v_mfma_f32_16x16x32_bf16 v[192:195], v[40:43], v[72:75], v[192:195]
    s_add_u32 s63, s63, 1
    s_cmp_eq_u32 s63, 4
    s_cselect_b32 s53, 4294803456, 0
    s_cselect_b32 s63, 0, s63
    s_add_u32 s53, s53, 40960
    v_mfma_f32_16x16x32_bf16 v[196:199], v[44:47], v[72:75], v[196:199]
    v_add_u32 v2, s53, v2
    v_mfma_f32_16x16x32_bf16 v[200:203], v[48:51], v[72:75], v[200:203]
    v_add_u32 v4, s53, v4
    v_mfma_f32_16x16x32_bf16 v[204:207], v[52:55], v[72:75], v[204:207]
    v_add_u32 v5, s53, v5
    v_mfma_f32_16x16x32_bf16 v[208:211], v[40:43], v[76:79], v[208:211]
    v_add_u32 v3, s53, v3
    v_mfma_f32_16x16x32_bf16 v[212:215], v[44:47], v[76:79], v[212:215]
    s_cmp_ge_u32 s62, 6
    s_cbranch_scc1 L_cl_none
    buffer_store_dwordx4 v[8:11], v6, s[16:19], 0 offen sc1
    v_add_u32 v6, 1024, v6
    s_cmp_lt_u32 s62, 3
    s_cbranch_scc1 L_cl_none
    v_mov_b32 v6, v16
    v_mov_b32 v16, v17
L_cl_none:
    v_mfma_f32_16x16x32_bf16 v[216:219], v[48:51], v[76:79], v[216:219]
    v_mfma_f32_16x16x32_bf16 v[220:223], v[52:55], v[76:79], v[220:223]
    s_waitcnt lgkmcnt(0)
    v_mfma_f32_16x16x32_bf16 v[128:131], v[96:99], v[80:83], v[128:131]
    s_barrier
    ds_read_b128 v[40:43], v2 offset:0
    v_mfma_f32_16x16x32_bf16 v[132:135], v[96:99], v[84:87], v[132:135]
    ds_read_b128 v[44:47], v2 offset:2048
    v_mfma_f32_16x16x32_bf16 v[136:139], v[96:99], v[88:91], v[136:139]
    ds_read_b128 v[48:51], v2 offset:4096
    v_mfma_f32_16x16x32_bf16 v[140:143], v[96:99], v[92:95], v[140:143]
    ds_read_b128 v[52:55], v2 offset:6144
    v_mfma_f32_16x16x32_bf16 v[144:147], v[100:103], v[80:83], v[144:147]
    ds_read_b64_tr_b16 v[56:57], v4 offset:0
    v_mfma_f32_16x16x32_bf16 v[148:151], v[100:103], v[84:87], v[148:151]
    ds_read_b64_tr_b16 v[58:59], v4 offset:512
    v_mfma_f32_16x16x32_bf16 v[152:155], v[100:103], v[88:91], v[152:155]
    ds_read_b64_tr_b16 v[60:61], v5 offset:0
    v_mfma_f32_16x16x32_bf16 v[156:159], v[100:103], v[92:95], v[156:159]
    ds_read_b64_tr_b16 v[62:63], v5 offset:512
    v_mfma_f32_16x16x32_bf16 v[160:163], v[80:83], v[104:107], v[160:163]
    ds_read_b64_tr_b16 v[64:65], v4 offset:8192
    v_mfma_f32_16x16x32_bf16 v[164:167], v[84:87], v[104:107], v[164:167]
    ds_read_b64_tr_b16 v[66:67], v4 offset:8704
    v_mfma_f32_16x16x32_bf16 v[168:171], v[88:91], v[104:107], v[168:171]
    ds_read_b64_tr_b16 v[68:69], v5 offset:8192
    v_mfma_f32_16x16x32_bf16 v[172:175], v[92:95], v[104:107], v[172:175]
    ds_read_b64_tr_b16 v[70:71], v5 offset:8704
    v_mfma_f32_16x16x32_bf16 v[176:179], v[80:83], v[108:111], v[176:179]
    ds_read_b64_tr_b16 v[72:73], v4 offset:16384
    v_mfma_f32_16x16x32_bf16 v[180:183], v[84:87], v[108:111], v[180:183]
    ds_read_b64_tr_b16 v[74:75], v4 offset:16896
    v_mfma_f32_16x16x32_bf16 v[184:187], v[88:91], v[108:111], v[184:187]
    ds_read_b64_tr_b16 v[76:77], v5 offset:16384
    v_mfma_f32_16x16x32_bf16 v[188:191], v[92:95], v[108:111], v[188:191]
    ds_read_b64_tr_b16 v[78:79], v5 offset:16896
    v_mfma_f32_16x16x32_bf16 v[192:195], v[80:83], v[112:115], v[192:195]
    v_mfma_f32_16x16x32_bf16 v[196:199], v[84:87], v[112:115], v[196:199]
    s_cmp_lg_u32 s62, 8
    s_cbranch_scc1 L_cl_nw
    s_waitcnt vmcnt(0)
L_cl_nw:
    v_mfma_f32_16x16x32_bf16 v[200:203], v[88:91], v[112:115], v[200:203]
    v_mfma_f32_16x16x32_bf16 v[204:207], v[92:95], v[112:115], v[204:207]
    v_mfma_f32_16x16x32_bf16 v[208:211], v[80:83], v[116:119], v[208:211]
    s_add_u32 s62, s62, 1
    v_mfma_f32_16x16x32_bf16 v[212:215], v[84:87], v[116:119], v[212:215]
    v_mfma_f32_16x16x32_bf16 v[216:219], v[88:91], v[116:119], v[216:219]
    v_mfma_f32_16x16x32_bf16 v[220:223], v[92:95], v[116:119], v[220:223]
    s_cmp_lt_u32 s62, 15
    s_cbranch_scc1 L_cloop
    s_waitcnt lgkmcnt(0)
    v_mfma_f32_16x16x32_bf16 v[128:131], v[56:59], v[40:43], v[128:131]
    ds_read_b128 v[80:83], v3 offset:0
    v_mfma_f32_16x16x32_bf16 v[132:135], v[56:59], v[44:47], v[132:135]
    ds_read_b128 v[84:87], v3 offset:2048
    v_mfma_f32_16x16x32_bf16 v[136:139], v[56:59], v[48:51], v[136:139]
    ds_read_b128 v[88:91], v3 offset:4096
    v_mfma_f32_16x16x32_bf16 v[140:143], v[56:59], v[52:55], v[140:143]
    ds_read_b128 v[92:95], v3 offset:6144
L_walkB2:
    s_cbranch_execz L_walk_6
    v_mfma_f32_16x16x32_bf16 v[144:147], v[60:63], v[40:43], v[144:147]
    ds_read_b64_tr_b16 v[96:97], v4 offset:4096
    v_mfma_f32_16x16x32_bf16 v[148:151], v[60:63], v[44:47], v[148:151]
    ds_read_b64_tr_b16 v[98:99], v4 offset:4608
    v_mfma_f32_16x16x32_bf16 v[152:155], v[60:63], v[48:51], v[152:155]
    ds_read_b64_tr_b16 v[100:101], v5 offset:4096
    v_mfma_f32_16x16x32_bf16 v[156:159], v[60:63], v[52:55], v[156:159]
    ds_read_b64_tr_b16 v[102:103], v5 offset:4608
    v_mfma_f32_16x16x32_bf16 v[160:163], v[40:43], v[64:67], v[160:163]
    ds_read_b64_tr_b16 v[104:105], v4 offset:12288
    v_mfma_f32_16x16x32_bf16 v[164:167], v[44:47], v[64:67], v[164:167]
    ds_read_b64_tr_b16 v[106:107], v4 offset:12800
    v_mfma_f32_16x16x32_bf16 v[168:171], v[48:51], v[64:67], v[168:171]
    ds_read_b64_tr_b16 v[108:109], v5 offset:12288
    v_mfma_f32_16x16x32_bf16 v[172:175], v[52:55], v[64:67], v[172:175]
    ds_read_b64_tr_b16 v[110:111], v5 offset:12800
    v_mfma_f32_16x16x32_bf16 v[176:179], v[40:43], v[68:71], v[176:179]
    ds_read_b64_tr_b16 v[112:113], v4 offset:20480
    v_mfma_f32_16x16x32_bf16 v[180:183], v[44:47], v[68:71], v[180:183]
    ds_read_b64_tr_b16 v[114:115], v4 offset:20992
    v_mfma_f32_16x16x32_bf16 v[184:187], v[48:51], v[68:71], v[184:187]
    ds_read_b64_tr_b16 v[116:117], v5 offset:20480
    v_mfma_f32_16x16x32_bf16 v[188:191], v[52:55], v[68:71], v[188:191]
    ds_read_b64_tr_b16 v[118:119], v5 offset:20992
    v_mfma_f32_16x16x32_bf16 v[192:195], v[40:43], v[72:75], v[192:195]
    v_lshrrev_b32 v21, 4, v0
    v_and_b32 v22, 15, v0
    v_mfma_f32_16x16x32_bf16 v[196:199], v[44:47], v[72:75], v[196:199]
    s_lshl_b32 s86, s49, 8
    s_add_u32 s86, s86, 131072
    v_lshl_add_u32 v6, v21, 4, s86
    v_mfma_f32_16x16x32_bf16 v[200:203], v[48:51], v[72:75], v[200:203]
    v_lshl_add_u32 v7, v22, 2, s86
    v_mfma_f32_16x16x32_bf16 v[204:207], v[52:55], v[72:75], v[204:207]
    s_lshl_b32 s86, s50, 7
    s_add_u32 s86, s86, 132608
    v_lshl_add_u32 v8, v22, 2, s86
    v_mfma_f32_16x16x32_bf16 v[208:211], v[40:43], v[76:79], v[208:211]
    v_lshl_add_u32 v9, v21, 4, s86
    v_mfma_f32_16x16x32_bf16 v[212:215], v[44:47], v[76:79], v[212:215]
    s_lshl_b32 s86, s3, 2
    s_add_u32 s86, s86, 135168
    v_mov_b32 v12, s86
    v_mfma_f32_16x16x32_bf16 v[216:219], v[48:51], v[76:79], v[216:219]
    v_xor_b32 v13, 4, v12
    v_mfma_f32_16x16x32_bf16 v[220:223], v[52:55], v[76:79], v[220:223]
    s_waitcnt lgkmcnt(0)
    v_mfma_f32_16x16x32_bf16 v[160:163], v[80:83], v[104:107], v[160:163]
    v_mfma_f32_16x16x32_bf16 v[164:167], v[84:87], v[104:107], v[164:167]
    v_mfma_f32_16x16x32_bf16 v[168:171], v[88:91], v[104:107], v[168:171]
    v_mfma_f32_16x16x32_bf16 v[172:175], v[92:95], v[104:107], v[172:175]
    v_mfma_f32_16x16x32_bf16 v[176:179], v[80:83], v[108:111], v[176:179]
    v_mfma_f32_16x16x32_bf16 v[180:183], v[84:87], v[108:111], v[180:183]
    v_mfma_f32_16x16x32_bf16 v[184:187], v[88:91], v[108:111], v[184:187]
    v_mfma_f32_16x16x32_bf16 v[188:191], v[92:95], v[108:111], v[188:191]
    v_mfma_f32_16x16x32_bf16 v[192:195], v[80:83], v[112:115], v[192:195]
    v_mfma_f32_16x16x32_bf16 v[196:199], v[84:87], v[112:115], v[196:199]
    v_mfma_f32_16x16x32_bf16 v[200:203], v[88:91], v[112:115], v[200:203]
    v_mfma_f32_16x16x32_bf16 v[204:207], v[92:95], v[112:115], v[204:207]
    v_mfma_f32_16x16x32_bf16 v[208:211], v[80:83], v[116:119], v[208:211]
    s_barrier
    ds_read_b128 v[40:43], v6 offset:0
    ds_read_b128 v[44:47], v6 offset:64
    v_mfma_f32_16x16x32_bf16 v[212:215], v[84:87], v[116:119], v[212:215]
    ds_read_b128 v[48:51], v6 offset:128
    ds_read_b128 v[52:55], v6 offset:192
    v_mfma_f32_16x16x32_bf16 v[216:219], v[88:91], v[116:119], v[216:219]
    ds_read_b32 v72, v8 offset:256
    ds_read_b32 v73, v8 offset:320
    v_mfma_f32_16x16x32_bf16 v[220:223], v[92:95], v[116:119], v[220:223]
    ds_read_b32 v74, v8 offset:512
    ds_read_b32 v75, v8 offset:576
    v_mfma_f32_16x16x32_bf16 v[128:131], v[96:99], v[80:83], v[128:131]
    ds_read_b128 v[56:59], v6 offset:512
    ds_read_b128 v[60:63], v6 offset:576
    v_mfma_f32_16x16x32_bf16 v[132:135], v[96:99], v[84:87], v[132:135]
    ds_read_b128 v[64:67], v6 offset:640
    ds_read_b128 v[68:71], v6 offset:704
    v_mfma_f32_16x16x32_bf16 v[136:139], v[96:99], v[88:91], v[136:139]
    ds_read_b128 v[224:227], v6 offset:1024
    ds_read_b128 v[228:231], v6 offset:1088
    v_mfma_f32_16x16x32_bf16 v[140:143], v[96:99], v[92:95], v[140:143]
    ds_read_b128 v[232:235], v6 offset:1152
    ds_read_b128 v[236:239], v6 offset:1216
    v_mfma_f32_16x16x32_bf16 v[144:147], v[100:103], v[80:83], v[144:147]
    ds_read_b128 v[28:31], v9 offset:0
    ds_read_b128 v[32:35], v9 offset:64
    v_mfma_f32_16x16x32_bf16 v[148:151], v[100:103], v[84:87], v[148:151]
    v_mfma_f32_16x16x32_bf16 v[152:155], v[100:103], v[88:91], v[152:155]
    v_mfma_f32_16x16x32_bf16 v[156:159], v[100:103], v[92:95], v[156:159]
    ds_read_b32 v240, v7 offset:0
    ds_read_b32 v244, v7 offset:512
    ds_read_b32 v248, v7 offset:1024
    ds_read_b32 v241, v7 offset:64
    ds_read_b32 v245, v7 offset:576
    ds_read_b32 v249, v7 offset:1088
    ds_read_b32 v242, v7 offset:128
    ds_read_b32 v246, v7 offset:640
    ds_read_b32 v250, v7 offset:1152
    ds_read_b32 v243, v7 offset:192
    ds_read_b32 v247, v7 offset:704
    ds_read_b32 v251, v7 offset:1216
    s_waitcnt lgkmcnt(12)
    v_pk_fma_f32 v[160:161], v[40:41], v[72:73], v[160:161] op_sel_hi:[1,0,1]
    v_pk_mul_f32 v[112:113], v[160:161], v[224:225]
    v_pk_fma_f32 v[160:161], v[160:161], v[56:57], s[54:55]
    v_exp_f32 v112, v112 clamp
    v_exp_f32 v113, v113 clamp
    v_max_f32 v160, s54, v160
    v_max_f32 v161, s54, v161
    v_pk_add_f32 v[160:161], v[160:161], v[112:113]
    v_cvt_pk_bf16_f32 v80, v160, v161
    v_pk_fma_f32 v[162:163], v[42:43], v[72:73], v[162:163] op_sel_hi:[1,0,1]
    v_pk_mul_f32 v[114:115], v[162:163], v[226:227]
    v_pk_fma_f32 v[162:163], v[162:163], v[58:59], s[54:55]
    v_exp_f32 v114, v114 clamp
    v_exp_f32 v115, v115 clamp
    v_max_f32 v162, s54, v162
    v_max_f32 v163, s54, v163
    v_pk_add_f32 v[162:163], v[162:163], v[114:115]
    v_cvt_pk_bf16_f32 v81, v162, v163
    v_pk_fma_f32 v[164:165], v[44:45], v[72:73], v[164:165] op_sel_hi:[1,0,1]
    v_pk_mul_f32 v[116:117], v[164:165], v[228:229]
    v_pk_fma_f32 v[164:165], v[164:165], v[60:61], s[54:55]
    v_exp_f32 v116, v116 clamp
    v_exp_f32 v117, v117 clamp
    v_max_f32 v164, s54, v164
    v_max_f32 v165, s54, v165
    v_pk_add_f32 v[164:165], v[164:165], v[116:117]
    v_cvt_pk_bf16_f32 v82, v164, v165
    v_pk_fma_f32 v[166:167], v[46:47], v[72:73], v[166:167] op_sel_hi:[1,0,1]
    v_pk_mul_f32 v[118:119], v[166:167], v[230:231]
    v_pk_fma_f32 v[166:167], v[166:167], v[62:63], s[54:55]
    v_exp_f32 v118, v118 clamp
    v_exp_f32 v119, v119 clamp
    v_max_f32 v166, s54, v166
    v_max_f32 v167, s54, v167
    v_pk_add_f32 v[166:167], v[166:167], v[118:119]
    v_cvt_pk_bf16_f32 v83, v166, v167
    v_pk_fma_f32 v[168:169], v[48:49], v[72:73], v[168:169] op_sel_hi:[1,0,1]
    v_pk_mul_f32 v[112:113], v[168:169], v[232:233]
    v_pk_fma_f32 v[168:169], v[168:169], v[64:65], s[54:55]
    v_exp_f32 v112, v112 clamp
    v_exp_f32 v113, v113 clamp
L_walkB3:
    s_cbranch_execz L_walk_7
    v_max_f32 v168, s54, v168
    v_max_f32 v169, s54, v169
    v_pk_add_f32 v[168:169], v[168:169], v[112:113]
    v_cvt_pk_bf16_f32 v84, v168, v169
    v_pk_fma_f32 v[170:171], v[50:51], v[72:73], v[170:171] op_sel_hi:[1,0,1]
    v_pk_mul_f32 v[114:115], v[170:171], v[234:235]
    v_pk_fma_f32 v[170:171], v[170:171], v[66:67], s[54:55]
    v_exp_f32 v114, v114 clamp
    v_exp_f32 v115, v115 clamp
    v_max_f32 v170, s54, v170
    v_max_f32 v171, s54, v171
    v_pk_add_f32 v[170:171], v[170:171], v[114:115]
    v_cvt_pk_bf16_f32 v85, v170, v171
    v_pk_fma_f32 v[172:173], v[52:53], v[72:73], v[172:173] op_sel_hi:[1,0,1]
    v_pk_mul_f32 v[116:117], v[172:173], v[236:237]
    v_pk_fma_f32 v[172:173], v[172:173], v[68:69], s[54:55]
    v_exp_f32 v116, v116 clamp
    v_exp_f32 v117, v117 clamp
    v_max_f32 v172, s54, v172
    v_max_f32 v173, s54, v173
    v_pk_add_f32 v[172:173], v[172:173], v[116:117]
    v_cvt_pk_bf16_f32 v86, v172, v173
    v_pk_fma_f32 v[174:175], v[54:55], v[72:73], v[174:175] op_sel_hi:[1,0,1]
    v_pk_mul_f32 v[118:119], v[174:175], v[238:239]
    v_pk_fma_f32 v[174:175], v[174:175], v[70:71], s[54:55]
    v_exp_f32 v118, v118 clamp
    v_exp_f32 v119, v119 clamp
    v_max_f32 v174, s54, v174
    v_max_f32 v175, s54, v175
    v_pk_add_f32 v[174:175], v[174:175], v[118:119]
    v_cvt_pk_bf16_f32 v87, v174, v175
    v_pk_fma_f32 v[176:177], v[40:41], v[72:73], v[176:177] op_sel:[0,1,0] op_sel_hi:[1,1,1]
    v_pk_mul_f32 v[112:113], v[176:177], v[224:225]
    v_pk_fma_f32 v[176:177], v[176:177], v[56:57], s[54:55]
    v_exp_f32 v112, v112 clamp
    v_exp_f32 v113, v113 clamp
    v_max_f32 v176, s54, v176
    v_max_f32 v177, s54, v177
    v_pk_add_f32 v[176:177], v[176:177], v[112:113]
    v_cvt_pk_bf16_f32 v88, v176, v177
    v_pk_fma_f32 v[178:179], v[42:43], v[72:73], v[178:179] op_sel:[0,1,0] op_sel_hi:[1,1,1]
    v_pk_mul_f32 v[114:115], v[178:179], v[226:227]
    v_pk_fma_f32 v[178:179], v[178:179], v[58:59], s[54:55]
    v_exp_f32 v114, v114 clamp
    v_exp_f32 v115, v115 clamp
    v_max_f32 v178, s54, v178
    v_max_f32 v179, s54, v179
    v_pk_add_f32 v[178:179], v[178:179], v[114:115]
    v_cvt_pk_bf16_f32 v89, v178, v179
    v_pk_fma_f32 v[180:181], v[44:45], v[72:73], v[180:181] op_sel:[0,1,0] op_sel_hi:[1,1,1]
    v_pk_mul_f32 v[116:117], v[180:181], v[228:229]
    v_pk_fma_f32 v[180:181], v[180:181], v[60:61], s[54:55]
    v_exp_f32 v116, v116 clamp
    v_exp_f32 v117, v117 clamp
    v_max_f32 v180, s54, v180
    v_max_f32 v181, s54, v181
    v_pk_add_f32 v[180:181], v[180:181], v[116:117]
    v_cvt_pk_bf16_f32 v90, v180, v181
    v_pk_fma_f32 v[182:183], v[46:47], v[72:73], v[182:183] op_sel:[0,1,0] op_sel_hi:[1,1,1]
    v_pk_mul_f32 v[118:119], v[182:183], v[230:231]
    v_pk_fma_f32 v[182:183], v[182:183], v[62:63], s[54:55]
    v_exp_f32 v118, v118 clamp
    v_exp_f32 v119, v119 clamp
    v_max_f32 v182, s54, v182
    v_max_f32 v183, s54, v183
    v_pk_add_f32 v[182:183], v[182:183], v[118:119]
    v_cvt_pk_bf16_f32 v91, v182, v183
    v_pk_fma_f32 v[184:185], v[48:49], v[72:73], v[184:185] op_sel:[0,1,0] op_sel_hi:[1,1,1]
    v_pk_mul_f32 v[112:113], v[184:185], v[232:233]
    v_pk_fma_f32 v[184:185], v[184:185], v[64:65], s[54:55]
    v_exp_f32 v112, v112 clamp
    v_exp_f32 v113, v113 clamp
    v_max_f32 v184, s54, v184
    v_max_f32 v185, s54, v185
    v_pk_add_f32 v[184:185], v[184:185], v[112:113]
    v_cvt_pk_bf16_f32 v92, v184, v185
    v_pk_fma_f32 v[186:187], v[50:51], v[72:73], v[186:187] op_sel:[0,1,0] op_sel_hi:[1,1,1]
    v_pk_mul_f32 v[114:115], v[186:187], v[234:235]
    v_pk_fma_f32 v[186:187], v[186:187], v[66:67], s[54:55]
    v_exp_f32 v114, v114 clamp
    v_exp_f32 v115, v115 clamp
    v_max_f32 v186, s54, v186
    v_max_f32 v187, s54, v187
    v_pk_add_f32 v[186:187], v[186:187], v[114:115]
    v_cvt_pk_bf16_f32 v93, v186, v187
    v_pk_fma_f32 v[188:189], v[52:53], v[72:73], v[188:189] op_sel:[0,1,0] op_sel_hi:[1,1,1]
    v_pk_mul_f32 v[116:117], v[188:189], v[236:237]
    v_pk_fma_f32 v[188:189], v[188:189], v[68:69], s[54:55]
    v_exp_f32 v116, v116 clamp
    v_exp_f32 v117, v117 clamp
    v_max_f32 v188, s54, v188
    v_max_f32 v189, s54, v189
    v_pk_add_f32 v[188:189], v[188:189], v[116:117]
    v_cvt_pk_bf16_f32 v94, v188, v189
    v_pk_fma_f32 v[190:191], v[54:55], v[72:73], v[190:191] op_sel:[0,1,0] op_sel_hi:[1,1,1]
    v_pk_mul_f32 v[118:119], v[190:191], v[238:239]
    v_pk_fma_f32 v[190:191], v[190:191], v[70:71], s[54:55]
    v_exp_f32 v118, v118 clamp
    v_exp_f32 v119, v119 clamp
    v_max_f32 v190, s54, v190
    v_max_f32 v191, s54, v191
    v_pk_add_f32 v[190:191], v[190:191], v[118:119]
    v_cvt_pk_bf16_f32 v95, v190, v191
    v_mov_b32 v120, s95
    v_mov_b32 v121, s95
    v_mov_b32 v122, s95
    v_mov_b32 v123, s95
    v_pk_fma_f32 v[192:193], v[40:41], v[74:75], v[192:193] op_sel_hi:[1,0,1]
    v_pk_mul_f32 v[192:193], v[192:193], v[56:57]
    v_cvt_pk_bf16_f32 v96, v192, v193
    v_pk_fma_f32 v[194:195], v[42:43], v[74:75], v[194:195] op_sel_hi:[1,0,1]
    v_pk_mul_f32 v[194:195], v[194:195], v[58:59]
    v_cvt_pk_bf16_f32 v97, v194, v195
    v_pk_fma_f32 v[196:197], v[44:45], v[74:75], v[196:197] op_sel_hi:[1,0,1]
    v_pk_mul_f32 v[196:197], v[196:197], v[60:61]
    v_cvt_pk_bf16_f32 v98, v196, v197
    v_pk_fma_f32 v[198:199], v[46:47], v[74:75], v[198:199] op_sel_hi:[1,0,1]
    v_pk_mul_f32 v[198:199], v[198:199], v[62:63]
    v_cvt_pk_bf16_f32 v99, v198, v199
    v_pk_fma_f32 v[200:201], v[48:49], v[74:75], v[200:201] op_sel_hi:[1,0,1]
    v_pk_mul_f32 v[200:201], v[200:201], v[64:65]
    v_cvt_pk_bf16_f32 v100, v200, v201
    v_pk_fma_f32 v[202:203], v[50:51], v[74:75], v[202:203] op_sel_hi:[1,0,1]
    v_pk_mul_f32 v[202:203], v[202:203], v[66:67]
    v_cvt_pk_bf16_f32 v101, v202, v203
    v_pk_fma_f32 v[204:205], v[52:53], v[74:75], v[204:205] op_sel_hi:[1,0,1]
    v_pk_mul_f32 v[204:205], v[204:205], v[68:69]
    v_cvt_pk_bf16_f32 v102, v204, v205
    v_pk_fma_f32 v[206:207], v[54:55], v[74:75], v[206:207] op_sel_hi:[1,0,1]
    v_pk_mul_f32 v[206:207], v[206:207], v[70:71]
    v_cvt_pk_bf16_f32 v103, v206, v207
    v_pk_fma_f32 v[208:209], v[40:41], v[74:75], v[208:209] op_sel:[0,1,0] op_sel_hi:[1,1,1]
    v_pk_mul_f32 v[208:209], v[208:209], v[56:57]
    v_cvt_pk_bf16_f32 v104, v208, v209
    v_pk_fma_f32 v[210:211], v[42:43], v[74:75], v[210:211] op_sel:[0,1,0] op_sel_hi:[1,1,1]
    v_pk_mul_f32 v[210:211], v[210:211], v[58:59]
    v_cvt_pk_bf16_f32 v105, v210, v211
    v_pk_fma_f32 v[212:213], v[44:45], v[74:75], v[212:213] op_sel:[0,1,0] op_sel_hi:[1,1,1]
    v_pk_mul_f32 v[212:213], v[212:213], v[60:61]
    v_cvt_pk_bf16_f32 v106, v212, v213
    v_pk_fma_f32 v[214:215], v[46:47], v[74:75], v[214:215] op_sel:[0,1,0] op_sel_hi:[1,1,1]
    v_pk_mul_f32 v[214:215], v[214:215], v[62:63]
    v_cvt_pk_bf16_f32 v107, v214, v215
    v_pk_fma_f32 v[216:217], v[48:49], v[74:75], v[216:217] op_sel:[0,1,0] op_sel_hi:[1,1,1]
    v_pk_mul_f32 v[216:217], v[216:217], v[64:65]
    v_cvt_pk_bf16_f32 v108, v216, v217
    v_pk_fma_f32 v[218:219], v[50:51], v[74:75], v[218:219] op_sel:[0,1,0] op_sel_hi:[1,1,1]
    v_pk_mul_f32 v[218:219], v[218:219], v[66:67]
    v_cvt_pk_bf16_f32 v109, v218, v219
    v_pk_fma_f32 v[220:221], v[52:53], v[74:75], v[220:221] op_sel:[0,1,0] op_sel_hi:[1,1,1]
L_walk_12:
    s_cbranch_execz L_walk_16
    v_pk_mul_f32 v[220:221], v[220:221], v[68:69]
    v_cvt_pk_bf16_f32 v110, v220, v221
    v_pk_fma_f32 v[222:223], v[54:55], v[74:75], v[222:223] op_sel:[0,1,0] op_sel_hi:[1,1,1]
    v_pk_mul_f32 v[222:223], v[222:223], v[70:71]
    v_cvt_pk_bf16_f32 v111, v222, v223
    s_mul_i32 s86, s3, 3072
    s_add_u32 s86, s86, 139264
    v_lshl_add_u32 v6, v0, 4, s86
    s_xor_b32 s86, s3, 1
    s_mul_i32 s86, s86, 3072
    s_add_u32 s86, s86, 139264
    v_lshl_add_u32 v7, v0, 4, s86
    s_cmp_eq_u32 s49, 1
    s_cbranch_scc1 L_kv1
    v_mfma_f32_16x16x32_bf16 v[172:175], v[80:83], v[104:107], 0
    v_mfma_f32_16x16x32_bf16 v[176:179], v[88:91], v[104:107], 0
    v_mfma_f32_16x16x32_bf16 v[180:183], v[88:91], v[120:123], 0
    v_mfma_f32_16x16x32_bf16 v[160:163], v[80:83], v[96:99], 0
    v_mfma_f32_16x16x32_bf16 v[164:167], v[88:91], v[96:99], 0
    v_mfma_f32_16x16x32_bf16 v[168:171], v[80:83], v[120:123], 0
    v_mfma_f32_16x16x32_bf16 v[172:175], v[84:87], v[108:111], v[172:175]
    v_mfma_f32_16x16x32_bf16 v[176:179], v[92:95], v[108:111], v[176:179]
    v_mfma_f32_16x16x32_bf16 v[180:183], v[92:95], v[120:123], v[180:183]
    v_mfma_f32_16x16x32_bf16 v[160:163], v[84:87], v[100:103], v[160:163]
    v_mfma_f32_16x16x32_bf16 v[164:167], v[92:95], v[100:103], v[164:167]
    v_mfma_f32_16x16x32_bf16 v[168:171], v[84:87], v[120:123], v[168:171]
    s_branch L_kvd
L_kv1:
    v_mfma_f32_16x16x32_bf16 v[172:175], v[80:83], v[96:99], 0
    v_mfma_f32_16x16x32_bf16 v[176:179], v[88:91], v[96:99], 0
    v_mfma_f32_16x16x32_bf16 v[180:183], v[80:83], v[120:123], 0
    v_mfma_f32_16x16x32_bf16 v[160:163], v[80:83], v[104:107], 0
    v_mfma_f32_16x16x32_bf16 v[164:167], v[88:91], v[104:107], 0
    v_mfma_f32_16x16x32_bf16 v[168:171], v[88:91], v[120:123], 0
    v_mfma_f32_16x16x32_bf16 v[172:175], v[84:87], v[100:103], v[172:175]
    v_mfma_f32_16x16x32_bf16 v[176:179], v[92:95], v[100:103], v[176:179]
    v_mfma_f32_16x16x32_bf16 v[180:183], v[84:87], v[120:123], v[180:183]
    v_mfma_f32_16x16x32_bf16 v[160:163], v[84:87], v[108:111], v[160:163]
    v_mfma_f32_16x16x32_bf16 v[164:167], v[92:95], v[108:111], v[164:167]
    v_mfma_f32_16x16x32_bf16 v[168:171], v[92:95], v[120:123], v[168:171]
L_kvd:
    s_lshl_b32 s86, s47, 1
    s_add_u32 s86, s86, s50
    s_lshl_b32 s87, s86, 1
    s_add_u32 s87, s87, s49
    s_lshl_b32 s87, s87, 4
    s_add_u32 s87, s87, s46
    s_lshl_b32 s87, s87, 10
    s_add_u32 s87, s87, 5242880
    v_lshl_add_u32 v8, v0, 4, s87
    s_lshl_b32 s87, s86, 4
    s_add_u32 s87, s87, s46
    s_lshl_b32 s87, s87, 7
    s_lshl_b32 s88, s49, 6
    s_add_u32 s87, s87, s88
    s_add_u32 s87, s87, 6881280
    v_add_u32 v9, s87, v0
    s_mov_b32 vcc_lo, 0x00010001
    s_mov_b32 vcc_hi, vcc_lo
    v_mov_b32 v14, 2147483648
    v_cndmask_b32 v9, v14, v9, vcc
    ds_write_b128 v6, v[172:175] offset:0
    ds_write_b128 v6, v[176:179] offset:1024
    ds_write_b128 v6, v[180:183] offset:2048
    ds_write_b32 v12, v12
    s_lshl_b32 s86, s47, 1
    s_add_u32 s86, s86, s50
    s_lshl_b32 s87, s46, 3
    s_lshl_b32 s88, s49, 2
    s_add_u32 s87, s87, s88
    s_lshl_b32 s87, s87, 5
    s_add_u32 s87, s87, s86
    s_lshl_b32 s87, s87, 10
    s_add_u32 s87, s87, 1048576
    v_lshl_add_u32 v10, v0, 4, s87
    s_mul_i32 s87, s50, 3072
    s_add_u32 s87, s87, 151552
    v_lshl_add_u32 v11, v0, 4, s87
    s_lshl_b32 s87, s86, 1
    s_add_u32 s87, s87, s49
    s_lshl_b32 s87, s87, 5
    s_add_u32 s87, s87, s46
    s_lshl2_add_u32 s87, s87, 671744
    v_mov_b32 v16, 2147483648
    v_mov_b32 v18, 2147483648
    v_writelane_b32 v16, s87, 0
    s_lshl_b32 s87, s46, 1
    s_add_u32 s87, s87, s49
    s_lshl_b32 s87, s87, 1
    s_lshr_b32 s88, s86, 4
    s_add_u32 s87, s87, s88
    s_lshl_b32 s87, s87, 6
    s_and_b32 s88, s86, 15
    s_add_u32 s87, s87, s88
    s_lshl2_add_u32 s87, s87, 688128
    v_writelane_b32 v18, s87, 0
    s_add_u32 s87, s87, 128
    v_writelane_b32 v18, s87, 1
    v_mov_b32 v17, s68
L_xkv:
    ds_read_b32 v14, v13
    ds_read_b128 v[172:175], v7 offset:0
    ds_read_b128 v[176:179], v7 offset:1024
    ds_read_b128 v[180:183], v7 offset:2048
    s_waitcnt lgkmcnt(0)
    v_cmp_eq_u32 vcc, 0, v14
    s_cbranch_vccz L_ok_2
    s_sub_u32 s56, s56, 1
    s_cbranch_scc0 L_xkv
    s_mov_b32 s56, 0
L_ok_2:
    v_pk_add_f32 v[160:161], v[160:161], v[172:173]
    v_pk_add_f32 v[162:163], v[162:163], v[174:175]
    v_pk_add_f32 v[164:165], v[164:165], v[176:177]
    v_pk_add_f32 v[166:167], v[166:167], v[178:179]
    v_pk_add_f32 v[168:169], v[168:169], v[180:181]
    v_pk_add_f32 v[170:171], v[170:171], v[182:183]
    v_cvt_pk_bf16_f32 v184, v160, v161
    v_cvt_pk_bf16_f32 v185, v162, v163
    v_cvt_pk_bf16_f32 v186, v164, v165
    v_cvt_pk_bf16_f32 v187, v166, v167
    buffer_store_dwordx4 v[184:187], v8, s[16:19], 0 offen sc1
    buffer_store_dwordx4 v[168:171], v9, s[16:19], 0 offen sc1
    buffer_atomic_swap v17, v16, s[16:19], 0 offen sc1
    v_pk_fma_f32 v[128:129], v[28:29], v[240:241], v[128:129] op_sel_hi:[1,0,1]
    v_pk_mul_f32 v[112:113], v[128:129], v[248:249] op_sel_hi:[1,0]
    v_pk_fma_f32 v[128:129], v[128:129], v[244:245], s[54:55] op_sel_hi:[1,0,1]
    v_exp_f32 v112, v112 clamp
    v_exp_f32 v113, v113 clamp
    v_max_f32 v128, s54, v128
    v_max_f32 v129, s54, v129
    v_pk_add_f32 v[128:129], v[128:129], v[112:113]
    v_cvt_pk_bf16_f32 v192, v128, v129
    v_pk_fma_f32 v[130:131], v[30:31], v[240:241], v[130:131] op_sel_hi:[1,0,1]
    v_pk_mul_f32 v[114:115], v[130:131], v[248:249] op_sel_hi:[1,0]
    v_pk_fma_f32 v[130:131], v[130:131], v[244:245], s[54:55] op_sel_hi:[1,0,1]
    v_exp_f32 v114, v114 clamp
    v_exp_f32 v115, v115 clamp
    v_max_f32 v130, s54, v130
    v_max_f32 v131, s54, v131
    v_pk_add_f32 v[130:131], v[130:131], v[114:115]
    v_cvt_pk_bf16_f32 v193, v130, v131
    v_pk_fma_f32 v[144:145], v[32:33], v[240:241], v[144:145] op_sel_hi:[1,0,1]
    v_pk_mul_f32 v[116:117], v[144:145], v[248:249] op_sel_hi:[1,0]
    v_pk_fma_f32 v[144:145], v[144:145], v[244:245], s[54:55] op_sel_hi:[1,0,1]
    v_exp_f32 v116, v116 clamp
    v_exp_f32 v117, v117 clamp
    v_max_f32 v144, s54, v144
    v_max_f32 v145, s54, v145
    v_pk_add_f32 v[144:145], v[144:145], v[116:117]
    v_cvt_pk_bf16_f32 v194, v144, v145
    v_pk_fma_f32 v[146:147], v[34:35], v[240:241], v[146:147] op_sel_hi:[1,0,1]
    v_pk_mul_f32 v[118:119], v[146:147], v[248:249] op_sel_hi:[1,0]
    v_pk_fma_f32 v[146:147], v[146:147], v[244:245], s[54:55] op_sel_hi:[1,0,1]
    v_exp_f32 v118, v118 clamp
    v_exp_f32 v119, v119 clamp
    v_max_f32 v146, s54, v146
    v_max_f32 v147, s54, v147
    v_pk_add_f32 v[146:147], v[146:147], v[118:119]
    v_cvt_pk_bf16_f32 v195, v146, v147
    v_pk_fma_f32 v[132:133], v[28:29], v[240:241], v[132:133] op_sel:[0,1,0] op_sel_hi:[1,1,1]
    v_pk_mul_f32 v[112:113], v[132:133], v[248:249] op_sel:[0,1] op_sel_hi:[1,1]
    v_pk_fma_f32 v[132:133], v[132:133], v[244:245], s[54:55] op_sel:[0,1,0] op_sel_hi:[1,1,1]
    v_exp_f32 v112, v112 clamp
    v_exp_f32 v113, v113 clamp
    v_max_f32 v132, s54, v132
    v_max_f32 v133, s54, v133
L_walk_13:
    s_cbranch_execz L_walk_17
    v_pk_add_f32 v[132:133], v[132:133], v[112:113]
    v_cvt_pk_bf16_f32 v196, v132, v133
    v_pk_fma_f32 v[134:135], v[30:31], v[240:241], v[134:135] op_sel:[0,1,0] op_sel_hi:[1,1,1]
    v_pk_mul_f32 v[114:115], v[134:135], v[248:249] op_sel:[0,1] op_sel_hi:[1,1]
    v_pk_fma_f32 v[134:135], v[134:135], v[244:245], s[54:55] op_sel:[0,1,0] op_sel_hi:[1,1,1]
    v_exp_f32 v114, v114 clamp
    v_exp_f32 v115, v115 clamp
    v_max_f32 v134, s54, v134
    v_max_f32 v135, s54, v135
    v_pk_add_f32 v[134:135], v[134:135], v[114:115]
    v_cvt_pk_bf16_f32 v197, v134, v135
    v_pk_fma_f32 v[148:149], v[32:33], v[240:241], v[148:149] op_sel:[0,1,0] op_sel_hi:[1,1,1]
    v_pk_mul_f32 v[116:117], v[148:149], v[248:249] op_sel:[0,1] op_sel_hi:[1,1]
    v_pk_fma_f32 v[148:149], v[148:149], v[244:245], s[54:55] op_sel:[0,1,0] op_sel_hi:[1,1,1]
    v_exp_f32 v116, v116 clamp
    v_exp_f32 v117, v117 clamp
    v_max_f32 v148, s54, v148
    v_max_f32 v149, s54, v149
    v_pk_add_f32 v[148:149], v[148:149], v[116:117]
    v_cvt_pk_bf16_f32 v198, v148, v149
    v_pk_fma_f32 v[150:151], v[34:35], v[240:241], v[150:151] op_sel:[0,1,0] op_sel_hi:[1,1,1]
    v_pk_mul_f32 v[118:119], v[150:151], v[248:249] op_sel:[0,1] op_sel_hi:[1,1]
    v_pk_fma_f32 v[150:151], v[150:151], v[244:245], s[54:55] op_sel:[0,1,0] op_sel_hi:[1,1,1]
    v_exp_f32 v118, v118 clamp
    v_exp_f32 v119, v119 clamp
    v_max_f32 v150, s54, v150
    v_max_f32 v151, s54, v151
    v_pk_add_f32 v[150:151], v[150:151], v[118:119]
    v_cvt_pk_bf16_f32 v199, v150, v151
    v_pk_fma_f32 v[136:137], v[28:29], v[242:243], v[136:137] op_sel_hi:[1,0,1]
    v_pk_mul_f32 v[112:113], v[136:137], v[250:251] op_sel_hi:[1,0]
    v_pk_fma_f32 v[136:137], v[136:137], v[246:247], s[54:55] op_sel_hi:[1,0,1]
    v_exp_f32 v112, v112 clamp
    v_exp_f32 v113, v113 clamp
    v_max_f32 v136, s54, v136
    v_max_f32 v137, s54, v137
    v_pk_add_f32 v[136:137], v[136:137], v[112:113]
    v_cvt_pk_bf16_f32 v200, v136, v137
    v_pk_fma_f32 v[138:139], v[30:31], v[242:243], v[138:139] op_sel_hi:[1,0,1]
    v_pk_mul_f32 v[114:115], v[138:139], v[250:251] op_sel_hi:[1,0]
    v_pk_fma_f32 v[138:139], v[138:139], v[246:247], s[54:55] op_sel_hi:[1,0,1]
    v_exp_f32 v114, v114 clamp
    v_exp_f32 v115, v115 clamp
    v_max_f32 v138, s54, v138
    v_max_f32 v139, s54, v139
    v_pk_add_f32 v[138:139], v[138:139], v[114:115]
    v_cvt_pk_bf16_f32 v201, v138, v139
    v_pk_fma_f32 v[152:153], v[32:33], v[242:243], v[152:153] op_sel_hi:[1,0,1]
    v_pk_mul_f32 v[116:117], v[152:153], v[250:251] op_sel_hi:[1,0]
    v_pk_fma_f32 v[152:153], v[152:153], v[246:247], s[54:55] op_sel_hi:[1,0,1]
    v_exp_f32 v116, v116 clamp
    v_exp_f32 v117, v117 clamp
    v_max_f32 v152, s54, v152
    v_max_f32 v153, s54, v153
    v_pk_add_f32 v[152:153], v[152:153], v[116:117]
    v_cvt_pk_bf16_f32 v202, v152, v153
    v_pk_fma_f32 v[154:155], v[34:35], v[242:243], v[154:155] op_sel_hi:[1,0,1]
    v_pk_mul_f32 v[118:119], v[154:155], v[250:251] op_sel_hi:[1,0]
    v_pk_fma_f32 v[154:155], v[154:155], v[246:247], s[54:55] op_sel_hi:[1,0,1]
    v_exp_f32 v118, v118 clamp
    v_exp_f32 v119, v119 clamp
    v_max_f32 v154, s54, v154
    v_max_f32 v155, s54, v155
    v_pk_add_f32 v[154:155], v[154:155], v[118:119]
    v_cvt_pk_bf16_f32 v203, v154, v155
    v_pk_fma_f32 v[140:141], v[28:29], v[242:243], v[140:141] op_sel:[0,1,0] op_sel_hi:[1,1,1]
    v_pk_mul_f32 v[112:113], v[140:141], v[250:251] op_sel:[0,1] op_sel_hi:[1,1]
    v_pk_fma_f32 v[140:141], v[140:141], v[246:247], s[54:55] op_sel:[0,1,0] op_sel_hi:[1,1,1]
    v_exp_f32 v112, v112 clamp
    v_exp_f32 v113, v113 clamp
    v_max_f32 v140, s54, v140
    v_max_f32 v141, s54, v141
    v_pk_add_f32 v[140:141], v[140:141], v[112:113]
    v_cvt_pk_bf16_f32 v204, v140, v141
    v_pk_fma_f32 v[142:143], v[30:31], v[242:243], v[142:143] op_sel:[0,1,0] op_sel_hi:[1,1,1]
    v_pk_mul_f32 v[114:115], v[142:143], v[250:251] op_sel:[0,1] op_sel_hi:[1,1]
    v_pk_fma_f32 v[142:143], v[142:143], v[246:247], s[54:55] op_sel:[0,1,0] op_sel_hi:[1,1,1]
    v_exp_f32 v114, v114 clamp
    v_exp_f32 v115, v115 clamp
    v_max_f32 v142, s54, v142
    v_max_f32 v143, s54, v143
    v_pk_add_f32 v[142:143], v[142:143], v[114:115]
    v_cvt_pk_bf16_f32 v205, v142, v143
    v_pk_fma_f32 v[156:157], v[32:33], v[242:243], v[156:157] op_sel:[0,1,0] op_sel_hi:[1,1,1]
    v_pk_mul_f32 v[116:117], v[156:157], v[250:251] op_sel:[0,1] op_sel_hi:[1,1]
    v_pk_fma_f32 v[156:157], v[156:157], v[246:247], s[54:55] op_sel:[0,1,0] op_sel_hi:[1,1,1]
    v_exp_f32 v116, v116 clamp
    v_exp_f32 v117, v117 clamp
    v_max_f32 v156, s54, v156
    v_max_f32 v157, s54, v157
    v_pk_add_f32 v[156:157], v[156:157], v[116:117]
    v_cvt_pk_bf16_f32 v206, v156, v157
    v_pk_fma_f32 v[158:159], v[34:35], v[242:243], v[158:159] op_sel:[0,1,0] op_sel_hi:[1,1,1]
    v_pk_mul_f32 v[118:119], v[158:159], v[250:251] op_sel:[0,1] op_sel_hi:[1,1]
    v_pk_fma_f32 v[158:159], v[158:159], v[246:247], s[54:55] op_sel:[0,1,0] op_sel_hi:[1,1,1]
    v_exp_f32 v118, v118 clamp
    v_exp_f32 v119, v119 clamp
    v_max_f32 v158, s54, v158
    v_max_f32 v159, s54, v159
    v_pk_add_f32 v[158:159], v[158:159], v[118:119]
    v_cvt_pk_bf16_f32 v207, v158, v159
    s_lshr_b32 s62, s3, 2
    s_lshl_b32 s53, s51, 3
    s_lshl_b32 s86, s48, 1
    s_add_u32 s53, s53, s86
    s_add_u32 s53, s53, s62
    v_lshrrev_b32 v36, 4, v0
    v_and_b32 v37, 15, v0
    s_lshl_b32 s87, s53, 15
    s_lshl_b32 s86, s62, 14
    s_add_u32 s86, s86, s87
    s_add_u32 s86, s86, 1048576
    v_lshl_add_u32 v157, v0, 4, s86
    v_xor_b32 v158, 0x8000, v157
    s_lshl_b32 s86, s51, 1
    s_lshr_b32 s87, s48, 1
    s_add_u32 s86, s86, s87
    s_lshl_b32 s86, s86, 1
    s_add_u32 s86, s86, s62
    s_lshl_b32 s86, s86, 1
    s_and_b32 s87, s48, 1
    s_add_u32 s86, s86, s87
    s_lshl_b32 s86, s86, 7
    s_add_u32 s86, s86, 688128
    v_lshl_add_u32 v159, v0, 2, s86
    v_mov_b32 v38, 2147483648
    v_cmp_gt_u32 vcc, 16, v0
    s_nop 1
    v_cndmask_b32 v159, v38, v159, vcc
    v_bfe_u32 v38, v0, 2, 2
    v_lshl_add_u32 v38, v36, 2, v38
    v_bfe_u32 v39, v38, 1, 2
    v_lshlrev_b32 v38, 7, v38
    v_lshl_add_u32 v38, v39, 5, v38
    v_and_b32 v39, 3, v0
    v_lshl_add_u32 v38, v39, 3, v38
    s_lshl_b32 s86, s62, 16
    s_add_u32 s86, s86, 0
    v_add_u32 v144, s86, v38
    v_xor_b32 v145, 32, v144
    v_xor_b32 v146, 64, v144
    v_xor_b32 v147, 96, v144
    v_cmp_eq_u32 s[4:5], 1, v39
    v_cmp_eq_u32 s[6:7], 2, v39
    v_cmp_eq_u32 s[98:99], 3, v39
    s_lshl_b32 s86, s53, 10
    s_add_u32 s86, s86, 786432
    v_lshl_add_u32 v160, v0, 2, s86
    v_mul_u32_u24 v161, 192, v36
    v_add_u32 v160, v160, v161
    s_mov_b32 s72, 0x00f0000f
    s_mov_b32 s73, 0xf0000f00
    s_mov_b32 s74, 0x0f00f000
    s_mov_b32 s75, 0x0f00f000
    v_lshrrev_b32 v38, 2, v37
    v_lshl_add_u32 v161, v38, 4, v37
    v_lshlrev_b32 v161, 2, v161
    s_lshl_b32 s86, s3, 12
    s_add_u32 s86, s86, 131072
    v_lshl_add_u32 v162, v0, 4, s86
    v_xor_b32 v163, 0x4000, v162
    s_lshl_b32 s86, s52, 7
    v_lshl_add_u32 v36, v36, 3, s86
    s_lshl_b32 s87, s53, 15
    s_add_u32 s87, s87, s86
L_walk_14:
    s_cbranch_execz L_walk_18
    s_lshl_b32 s86, s62, 6
    s_add_u32 s87, s87, s86
    v_lshl_add_u32 v39, v37, 11, s87
    v_and_b32 v38, 48, v0
    v_add_u32 v39, v39, v38
    v_xor_b32 v37, 0x8000, v39
    buffer_load_dwordx4 v[136:139], v39, s[8:11], 0 offen
    buffer_load_dwordx4 v[140:143], v37, s[8:11], 0 offen
    buffer_load_dwordx2 v[148:149], v36, s[40:43], 0 offen offset:0
    buffer_load_dwordx2 v[150:151], v36, s[40:43], 0 offen offset:32
    buffer_load_dwordx2 v[152:153], v36, s[40:43], 0 offen offset:64
    buffer_load_dwordx2 v[154:155], v36, s[40:43], 0 offen offset:96
    s_barrier
    ds_read_b128 v[40:43], v11 offset:0
    ds_read_b128 v[44:47], v11 offset:1024
    ds_read_b128 v[48:51], v11 offset:2048
    v_mov_b32 v38, 135200
    ds_read_b32 v38, v38
    s_mov_b32 s86, 0x8000
    s_mov_b32 s87, 0x10000
    s_mov_b32 s88, 0x18000
    s_waitcnt lgkmcnt(0)
    v_mfma_f32_16x16x32_bf16 v[216:219], v[48:51], v[192:195], 0
    v_mfma_f32_16x16x32_bf16 v[208:211], v[40:43], v[192:195], 0
    v_mfma_f32_16x16x32_bf16 v[212:215], v[44:47], v[192:195], 0
    v_mfma_f32_16x16x32_bf16 v[228:231], v[48:51], v[196:199], 0
    v_mfma_f32_16x16x32_bf16 v[220:223], v[40:43], v[196:199], 0
    v_mfma_f32_16x16x32_bf16 v[224:227], v[44:47], v[196:199], 0
    v_mfma_f32_16x16x32_bf16 v[240:243], v[48:51], v[200:203], 0
    v_mfma_f32_16x16x32_bf16 v[232:235], v[40:43], v[200:203], 0
    v_mfma_f32_16x16x32_bf16 v[236:239], v[44:47], v[200:203], 0
    v_mfma_f32_16x16x32_bf16 v[252:255], v[48:51], v[204:207], 0
    v_mfma_f32_16x16x32_bf16 v[244:247], v[40:43], v[204:207], 0
    v_mfma_f32_16x16x32_bf16 v[248:251], v[44:47], v[204:207], 0
    v_add_f32 v216, s54, v216
    v_rcp_f32 v216, v216
    s_nop 0
    v_pk_mul_f32 v[208:209], v[208:209], v[216:217] op_sel_hi:[1,0]
    v_pk_mul_f32 v[210:211], v[210:211], v[216:217] op_sel_hi:[1,0]
    v_pk_mul_f32 v[212:213], v[212:213], v[216:217] op_sel_hi:[1,0]
    v_pk_mul_f32 v[214:215], v[214:215], v[216:217] op_sel_hi:[1,0]
    v_cvt_pk_bf16_f32 v60, v208, v209
    v_cvt_pk_bf16_f32 v61, v210, v211
    v_cvt_pk_bf16_f32 v62, v212, v213
    v_cvt_pk_bf16_f32 v63, v214, v215
    buffer_store_dwordx4 v[60:63], v10, s[16:19], 0 offen sc1
    v_add_f32 v228, s54, v228
    v_rcp_f32 v228, v228
    s_nop 0
    v_pk_mul_f32 v[220:221], v[220:221], v[228:229] op_sel_hi:[1,0]
    v_pk_mul_f32 v[222:223], v[222:223], v[228:229] op_sel_hi:[1,0]
    v_pk_mul_f32 v[224:225], v[224:225], v[228:229] op_sel_hi:[1,0]
    v_pk_mul_f32 v[226:227], v[226:227], v[228:229] op_sel_hi:[1,0]
    v_cvt_pk_bf16_f32 v64, v220, v221
    v_cvt_pk_bf16_f32 v65, v222, v223
    v_cvt_pk_bf16_f32 v66, v224, v225
    v_cvt_pk_bf16_f32 v67, v226, v227
    buffer_store_dwordx4 v[64:67], v10, s[16:19], s86 offen sc1
    v_add_f32 v240, s54, v240
    v_rcp_f32 v240, v240
    s_nop 0
    v_pk_mul_f32 v[232:233], v[232:233], v[240:241] op_sel_hi:[1,0]
    v_pk_mul_f32 v[234:235], v[234:235], v[240:241] op_sel_hi:[1,0]
    v_pk_mul_f32 v[236:237], v[236:237], v[240:241] op_sel_hi:[1,0]
    v_pk_mul_f32 v[238:239], v[238:239], v[240:241] op_sel_hi:[1,0]
    v_cvt_pk_bf16_f32 v68, v232, v233
    v_cvt_pk_bf16_f32 v69, v234, v235
    v_cvt_pk_bf16_f32 v70, v236, v237
    v_cvt_pk_bf16_f32 v71, v238, v239
    buffer_store_dwordx4 v[68:71], v10, s[16:19], s87 offen sc1
    v_add_f32 v252, s54, v252
    v_rcp_f32 v252, v252
    s_nop 0
    v_pk_mul_f32 v[244:245], v[244:245], v[252:253] op_sel_hi:[1,0]
    v_pk_mul_f32 v[246:247], v[246:247], v[252:253] op_sel_hi:[1,0]
    v_pk_mul_f32 v[248:249], v[248:249], v[252:253] op_sel_hi:[1,0]
    v_pk_mul_f32 v[250:251], v[250:251], v[252:253] op_sel_hi:[1,0]
    v_cvt_pk_bf16_f32 v72, v244, v245
    v_cvt_pk_bf16_f32 v73, v246, v247
    v_cvt_pk_bf16_f32 v74, v248, v249
    v_cvt_pk_bf16_f32 v75, v250, v251
    buffer_store_dwordx4 v[72:75], v10, s[16:19], s88 offen sc1
    buffer_atomic_swap v17, v18, s[16:19], 0 offen sc1
    v_mov_b32 v8, 0
    buffer_atomic_or v8, v159, s[16:19], 0 offen sc0 sc1
    v_mov_b32 v14, 2147483648
    v_mov_b32 v11, 2147483648
    s_waitcnt vmcnt(6)
    v_bfe_u32 v36, v0, 2, 1
    v_cmp_eq_u32 vcc, 1, v36
    v_mov_b32 v36, s95
    s_nop 0
    v_cndmask_b32 v148, v36, v148, vcc
    v_cndmask_b32 v149, v36, v149, vcc
    v_cndmask_b32 v150, v36, v150, vcc
    v_cndmask_b32 v151, v36, v151, vcc
    v_cndmask_b32 v152, v36, v152, vcc
    v_cndmask_b32 v153, v36, v153, vcc
    v_cndmask_b32 v154, v36, v154, vcc
    v_cndmask_b32 v155, v36, v155, vcc
    v_readfirstlane_b32 s57, v38
L_phaseB:
    v_lshrrev_b32 v1, 4, v0
    v_and_b32 v2, 15, v0
    v_mov_b32 v3, 0x3f80
    s_lshl_b32 s87, s53, 4
    v_add_u32 v6, s87, v2
    s_lshl_b32 s86, s52, 7
    v_lshl_add_u32 v5, v6, 11, s86
    v_sub_u32 v6, 2047, v6
    v_mov_b32 v7, v39
    v_lshrrev_b32 v9, 1, v1
    v_lshl_add_u32 v5, v9, 4, v5
    v_and_b32 v9, 1, v1
    v_lshl_add_u32 v5, v9, 5, v5
    s_mov_b32 s67, 0
    s_mov_b32 s66, 0xffffaaaa
    s_mov_b32 s63, 0
L_b_init:
    v_bfe_u32 v9, v0, 3, 1
    v_bfe_u32 v10, v0, 4, 1
    v_xor_b32 v9, v9, v10
    v_bfe_u32 v10, v0, 1, 2
    v_lshl_add_u32 v9, v9, 3, v10
    v_lshrrev_b32 v10, 5, v0
    v_lshl_add_u32 v9, v10, 2, v9
    v_and_b32 v10, 1, v0
    v_lshlrev_b32 v10, 4, v10
    v_lshlrev_b32 v10, v10, v3
    v_cmp_eq_u32 vcc, 0, v9
    s_nop 1
    v_cndmask_b32 v128, 0, v10, vcc
    v_cmp_eq_u32 vcc, 1, v9
    s_nop 1
    v_cndmask_b32 v129, 0, v10, vcc
    v_cmp_eq_u32 vcc, 2, v9
    s_nop 1
    v_cndmask_b32 v130, 0, v10, vcc
    v_cmp_eq_u32 vcc, 3, v9
    s_nop 1
    v_cndmask_b32 v131, 0, v10, vcc
    v_cmp_eq_u32 vcc, 4, v9
    s_nop 1
    v_cndmask_b32 v132, 0, v10, vcc
    v_cmp_eq_u32 vcc, 5, v9
    s_nop 1
    v_cndmask_b32 v133, 0, v10, vcc
    v_cmp_eq_u32 vcc, 6, v9
    s_nop 1
    v_cndmask_b32 v134, 0, v10, vcc
    v_cmp_eq_u32 vcc, 7, v9
    s_nop 1
    v_cndmask_b32 v135, 0, v10, vcc
    v_mov_b32 v80, 0
    v_mov_b32 v81, 0
    v_mov_b32 v82, 0
    v_mov_b32 v83, 0
    v_mov_b32 v84, 0
    v_mov_b32 v85, 0
    v_mov_b32 v86, 0
    v_mov_b32 v87, 0
    v_mov_b32 v88, 0
    v_mov_b32 v89, 0
    v_mov_b32 v90, 0
    v_mov_b32 v91, 0
    v_mov_b32 v92, 0
    v_mov_b32 v93, 0
    v_mov_b32 v94, 0
    v_mov_b32 v95, 0
    v_mov_b32 v96, 0
    v_mov_b32 v97, 0
    v_mov_b32 v98, 0
    v_mov_b32 v99, 0
    v_mov_b32 v100, 0
    v_mov_b32 v101, 0
    v_mov_b32 v102, 0
    v_mov_b32 v103, 0
    v_mov_b32 v104, 0
    v_mov_b32 v105, 0
    v_mov_b32 v106, 0
    v_mov_b32 v107, 0
    v_mov_b32 v108, 0
    v_mov_b32 v109, 0
    v_mov_b32 v110, 0
    v_mov_b32 v111, 0
    v_mov_b32 v156, 0
    s_branch L_b_w0
L_b_r0:
    s_ff1_i32_b32 s91, s65
    s_bitset0_b32 s65, s91
    s_lshl_b32 s76, s91, 12
    s_lshl_b32 s91, s91, 10
    buffer_load_dwordx4 v[16:19], v157, s[16:19], s91 offen offset:0 sc1
L_walk_15:
    s_cbranch_execz L_walk_19
    buffer_load_dwordx4 v[20:23], v158, s[16:19], s91 offen offset:0 sc1
    buffer_load_dwordx4 v[24:27], v157, s[16:19], s91 offen offset:1024 sc1
    buffer_load_dwordx4 v[28:31], v158, s[16:19], s91 offen offset:1024 sc1
    s_cmp_eq_u32 s65, 0
    s_cbranch_scc1 L_b_p1
L_b_r1:
    s_ff1_i32_b32 s91, s65
    s_bitset0_b32 s65, s91
    s_lshl_b32 s77, s91, 12
    s_lshl_b32 s91, s91, 10
    buffer_load_dwordx4 v[32:35], v157, s[16:19], s91 offen offset:0 sc1
    buffer_load_dwordx4 v[36:39], v158, s[16:19], s91 offen offset:0 sc1
    buffer_load_dwordx4 v[40:43], v157, s[16:19], s91 offen offset:1024 sc1
    buffer_load_dwordx4 v[44:47], v158, s[16:19], s91 offen offset:1024 sc1
    s_xor_b32 s89, s67, s76
    s_mov_b32 s67, s76
    v_xor_b32 v144, s89, v144
    ds_read_b64_tr_b16 v[112:113], v144 offset:0
    ds_read_b64_tr_b16 v[114:115], v144 offset:2048
    v_xor_b32 v145, s89, v145
    ds_read_b64_tr_b16 v[116:117], v145 offset:0
    ds_read_b64_tr_b16 v[118:119], v145 offset:2048
    v_xor_b32 v146, s89, v146
    ds_read_b64_tr_b16 v[120:121], v146 offset:0
    ds_read_b64_tr_b16 v[122:123], v146 offset:2048
    v_xor_b32 v147, s89, v147
    ds_read_b64_tr_b16 v[124:125], v147 offset:0
    ds_read_b64_tr_b16 v[126:127], v147 offset:2048
    s_cmp_eq_u32 s62, 0
    s_cbranch_scc0 L_b_x1
    v_mfma_f32_16x16x32_bf16 v[80:83], v[128:131], v[136:139], 0
    v_mfma_f32_16x16x32_bf16 v[96:99], v[128:131], v[140:143], 0
    v_mfma_f32_16x16x32_bf16 v[84:87], v[132:135], v[136:139], 0
    v_mfma_f32_16x16x32_bf16 v[100:103], v[132:135], v[140:143], 0
    s_branch L_b_xd
L_b_x1:
    v_mfma_f32_16x16x32_bf16 v[88:91], v[128:131], v[136:139], 0
    v_mfma_f32_16x16x32_bf16 v[104:107], v[128:131], v[140:143], 0
    v_mfma_f32_16x16x32_bf16 v[92:95], v[132:135], v[136:139], 0
    v_mfma_f32_16x16x32_bf16 v[108:111], v[132:135], v[140:143], 0
L_b_xd:
    s_waitcnt vmcnt(6) lgkmcnt(6)
    v_max3_u32 v156, v156, v19, v23
    v_mfma_f32_16x16x32_bf16 v[80:83], v[112:115], v[16:19], v[80:83]
    ds_read_b64_tr_b16 v[128:129], v144 offset:4096
    v_mfma_f32_16x16x32_bf16 v[96:99], v[112:115], v[20:23], v[96:99]
    ds_read_b64_tr_b16 v[130:131], v144 offset:6144
    s_waitcnt lgkmcnt(6)
    v_mfma_f32_16x16x32_bf16 v[84:87], v[116:119], v[16:19], v[84:87]
    ds_read_b64_tr_b16 v[132:133], v145 offset:4096
    v_mfma_f32_16x16x32_bf16 v[100:103], v[116:119], v[20:23], v[100:103]
    ds_read_b64_tr_b16 v[134:135], v145 offset:6144
    s_waitcnt lgkmcnt(6)
    v_mfma_f32_16x16x32_bf16 v[88:91], v[120:123], v[16:19], v[88:91]
    ds_read_b64_tr_b16 v[136:137], v146 offset:4096
    v_mfma_f32_16x16x32_bf16 v[104:107], v[120:123], v[20:23], v[104:107]
    ds_read_b64_tr_b16 v[138:139], v146 offset:6144
    s_waitcnt lgkmcnt(6)
    v_mfma_f32_16x16x32_bf16 v[92:95], v[124:127], v[16:19], v[92:95]
    ds_read_b64_tr_b16 v[140:141], v147 offset:4096
    v_mfma_f32_16x16x32_bf16 v[108:111], v[124:127], v[20:23], v[108:111]
    ds_read_b64_tr_b16 v[142:143], v147 offset:6144
    s_cmp_eq_u32 s65, 0
    s_cbranch_scc1 L_b_p2
L_b_r2:
    s_ff1_i32_b32 s91, s65
    s_bitset0_b32 s65, s91
    s_lshl_b32 s78, s91, 12
    s_lshl_b32 s91, s91, 10
    buffer_load_dwordx4 v[48:51], v157, s[16:19], s91 offen offset:0 sc1
    buffer_load_dwordx4 v[52:55], v158, s[16:19], s91 offen offset:0 sc1
    s_waitcnt vmcnt(6) lgkmcnt(6)
    v_max3_u32 v156, v156, v27, v31
    v_mfma_f32_16x16x32_bf16 v[80:83], v[128:131], v[24:27], v[80:83]
    s_xor_b32 s89, s67, s77
    s_mov_b32 s67, s77
    v_xor_b32 v144, s89, v144
    ds_read_b64_tr_b16 v[112:113], v144 offset:0
    v_mfma_f32_16x16x32_bf16 v[96:99], v[128:131], v[28:31], v[96:99]
    ds_read_b64_tr_b16 v[114:115], v144 offset:2048
    s_waitcnt lgkmcnt(6)
    v_mfma_f32_16x16x32_bf16 v[84:87], v[132:135], v[24:27], v[84:87]
    v_xor_b32 v145, s89, v145
    ds_read_b64_tr_b16 v[116:117], v145 offset:0
    v_mfma_f32_16x16x32_bf16 v[100:103], v[132:135], v[28:31], v[100:103]
    ds_read_b64_tr_b16 v[118:119], v145 offset:2048
    s_waitcnt lgkmcnt(6)
    v_mfma_f32_16x16x32_bf16 v[88:91], v[136:139], v[24:27], v[88:91]
    v_xor_b32 v146, s89, v146
    ds_read_b64_tr_b16 v[120:121], v146 offset:0
    v_mfma_f32_16x16x32_bf16 v[104:107], v[136:139], v[28:31], v[104:107]
    ds_read_b64_tr_b16 v[122:123], v146 offset:2048
    s_waitcnt lgkmcnt(6)
    v_mfma_f32_16x16x32_bf16 v[92:95], v[140:143], v[24:27], v[92:95]
    v_xor_b32 v147, s89, v147
    ds_read_b64_tr_b16 v[124:125], v147 offset:0
    v_mfma_f32_16x16x32_bf16 v[108:111], v[140:143], v[28:31], v[108:111]
    ds_read_b64_tr_b16 v[126:127], v147 offset:2048
    buffer_load_dwordx4 v[56:59], v157, s[16:19], s91 offen offset:1024 sc1
    buffer_load_dwordx4 v[60:63], v158, s[16:19], s91 offen offset:1024 sc1
    s_waitcnt vmcnt(6) lgkmcnt(6)
    v_max3_u32 v156, v156, v35, v39
    v_mfma_f32_16x16x32_bf16 v[80:83], v[112:115], v[32:35], v[80:83]
    ds_read_b64_tr_b16 v[128:129], v144 offset:4096
    v_mfma_f32_16x16x32_bf16 v[96:99], v[112:115], v[36:39], v[96:99]
    ds_read_b64_tr_b16 v[130:131], v144 offset:6144
    s_waitcnt lgkmcnt(6)
    v_mfma_f32_16x16x32_bf16 v[84:87], v[116:119], v[32:35], v[84:87]
    ds_read_b64_tr_b16 v[132:133], v145 offset:4096
    v_mfma_f32_16x16x32_bf16 v[100:103], v[116:119], v[36:39], v[100:103]
    ds_read_b64_tr_b16 v[134:135], v145 offset:6144
    s_waitcnt lgkmcnt(6)
    v_mfma_f32_16x16x32_bf16 v[88:91], v[120:123], v[32:35], v[88:91]
    ds_read_b64_tr_b16 v[136:137], v146 offset:4096
    v_mfma_f32_16x16x32_bf16 v[104:107], v[120:123], v[36:39], v[104:107]
    ds_read_b64_tr_b16 v[138:139], v146 offset:6144
    s_waitcnt lgkmcnt(6)
    v_mfma_f32_16x16x32_bf16 v[92:95], v[124:127], v[32:35], v[92:95]
    ds_read_b64_tr_b16 v[140:141], v147 offset:4096
    v_mfma_f32_16x16x32_bf16 v[108:111], v[124:127], v[36:39], v[108:111]
    ds_read_b64_tr_b16 v[142:143], v147 offset:6144
    s_cmp_eq_u32 s65, 0
    s_cbranch_scc1 L_b_p3
L_b_r3:
    s_ff1_i32_b32 s91, s65
    s_bitset0_b32 s65, s91
    s_lshl_b32 s79, s91, 12
    s_lshl_b32 s91, s91, 10
    buffer_load_dwordx4 v[64:67], v157, s[16:19], s91 offen offset:0 sc1
    buffer_load_dwordx4 v[68:71], v158, s[16:19], s91 offen offset:0 sc1
    s_waitcnt vmcnt(6) lgkmcnt(6)
    v_max3_u32 v156, v156, v43, v47
    v_mfma_f32_16x16x32_bf16 v[80:83], v[128:131], v[40:43], v[80:83]
    s_xor_b32 s89, s67, s78
    s_mov_b32 s67, s78
    v_xor_b32 v144, s89, v144
    ds_read_b64_tr_b16 v[112:113], v144 offset:0
    v_mfma_f32_16x16x32_bf16 v[96:99], v[128:131], v[44:47], v[96:99]
    ds_read_b64_tr_b16 v[114:115], v144 offset:2048
    s_waitcnt lgkmcnt(6)
    v_mfma_f32_16x16x32_bf16 v[84:87], v[132:135], v[40:43], v[84:87]
    v_xor_b32 v145, s89, v145
    ds_read_b64_tr_b16 v[116:117], v145 offset:0
    v_mfma_f32_16x16x32_bf16 v[100:103], v[132:135], v[44:47], v[100:103]
    ds_read_b64_tr_b16 v[118:119], v145 offset:2048
    s_waitcnt lgkmcnt(6)
    v_mfma_f32_16x16x32_bf16 v[88:91], v[136:139], v[40:43], v[88:91]
    v_xor_b32 v146, s89, v146
    ds_read_b64_tr_b16 v[120:121], v146 offset:0
    v_mfma_f32_16x16x32_bf16 v[104:107], v[136:139], v[44:47], v[104:107]
    ds_read_b64_tr_b16 v[122:123], v146 offset:2048
    s_waitcnt lgkmcnt(6)
    v_mfma_f32_16x16x32_bf16 v[92:95], v[140:143], v[40:43], v[92:95]
    v_xor_b32 v147, s89, v147
    ds_read_b64_tr_b16 v[124:125], v147 offset:0
    v_mfma_f32_16x16x32_bf16 v[108:111], v[140:143], v[44:47], v[108:111]
    ds_read_b64_tr_b16 v[126:127], v147 offset:2048
    buffer_load_dwordx4 v[72:75], v157, s[16:19], s91 offen offset:1024 sc1
    buffer_load_dwordx4 v[76:79], v158, s[16:19], s91 offen offset:1024 sc1
    s_waitcnt vmcnt(6) lgkmcnt(6)
    v_max3_u32 v156, v156, v51, v55
    v_mfma_f32_16x16x32_bf16 v[80:83], v[112:115], v[48:51], v[80:83]
    ds_read_b64_tr_b16 v[128:129], v144 offset:4096
    v_mfma_f32_16x16x32_bf16 v[96:99], v[112:115], v[52:55], v[96:99]
    ds_read_b64_tr_b16 v[130:131], v144 offset:6144
    s_waitcnt lgkmcnt(6)
    v_mfma_f32_16x16x32_bf16 v[84:87], v[116:119], v[48:51], v[84:87]
    ds_read_b64_tr_b16 v[132:133], v145 offset:4096
    v_mfma_f32_16x16x32_bf16 v[100:103], v[116:119], v[52:55], v[100:103]
L_walk_16:
    s_cbranch_execz L_walk_20
    ds_read_b64_tr_b16 v[134:135], v145 offset:6144
    s_waitcnt lgkmcnt(6)
    v_mfma_f32_16x16x32_bf16 v[88:91], v[120:123], v[48:51], v[88:91]
    ds_read_b64_tr_b16 v[136:137], v146 offset:4096
    v_mfma_f32_16x16x32_bf16 v[104:107], v[120:123], v[52:55], v[104:107]
    ds_read_b64_tr_b16 v[138:139], v146 offset:6144
    s_waitcnt lgkmcnt(6)
    v_mfma_f32_16x16x32_bf16 v[92:95], v[124:127], v[48:51], v[92:95]
    ds_read_b64_tr_b16 v[140:141], v147 offset:4096
    v_mfma_f32_16x16x32_bf16 v[108:111], v[124:127], v[52:55], v[108:111]
    ds_read_b64_tr_b16 v[142:143], v147 offset:6144
    s_cmp_eq_u32 s65, 0
    s_cbranch_scc1 L_b_p4
L_b_r4:
    s_ff1_i32_b32 s91, s65
    s_bitset0_b32 s65, s91
    s_lshl_b32 s76, s91, 12
    s_lshl_b32 s91, s91, 10
    buffer_load_dwordx4 v[16:19], v157, s[16:19], s91 offen offset:0 sc1
    buffer_load_dwordx4 v[20:23], v158, s[16:19], s91 offen offset:0 sc1
    s_waitcnt vmcnt(6) lgkmcnt(6)
    v_max3_u32 v156, v156, v59, v63
    v_mfma_f32_16x16x32_bf16 v[80:83], v[128:131], v[56:59], v[80:83]
    s_xor_b32 s89, s67, s79
    s_mov_b32 s67, s79
    v_xor_b32 v144, s89, v144
    ds_read_b64_tr_b16 v[112:113], v144 offset:0
    v_mfma_f32_16x16x32_bf16 v[96:99], v[128:131], v[60:63], v[96:99]
    ds_read_b64_tr_b16 v[114:115], v144 offset:2048
    s_waitcnt lgkmcnt(6)
    v_mfma_f32_16x16x32_bf16 v[84:87], v[132:135], v[56:59], v[84:87]
    v_xor_b32 v145, s89, v145
    ds_read_b64_tr_b16 v[116:117], v145 offset:0
    v_mfma_f32_16x16x32_bf16 v[100:103], v[132:135], v[60:63], v[100:103]
    ds_read_b64_tr_b16 v[118:119], v145 offset:2048
    s_waitcnt lgkmcnt(6)
    v_mfma_f32_16x16x32_bf16 v[88:91], v[136:139], v[56:59], v[88:91]
    v_xor_b32 v146, s89, v146
    ds_read_b64_tr_b16 v[120:121], v146 offset:0
    v_mfma_f32_16x16x32_bf16 v[104:107], v[136:139], v[60:63], v[104:107]
    ds_read_b64_tr_b16 v[122:123], v146 offset:2048
    s_waitcnt lgkmcnt(6)
    v_mfma_f32_16x16x32_bf16 v[92:95], v[140:143], v[56:59], v[92:95]
    v_xor_b32 v147, s89, v147
    ds_read_b64_tr_b16 v[124:125], v147 offset:0
    v_mfma_f32_16x16x32_bf16 v[108:111], v[140:143], v[60:63], v[108:111]
    ds_read_b64_tr_b16 v[126:127], v147 offset:2048
    buffer_load_dwordx4 v[24:27], v157, s[16:19], s91 offen offset:1024 sc1
    buffer_load_dwordx4 v[28:31], v158, s[16:19], s91 offen offset:1024 sc1
    s_waitcnt vmcnt(6) lgkmcnt(6)
    v_max3_u32 v156, v156, v67, v71
    v_mfma_f32_16x16x32_bf16 v[80:83], v[112:115], v[64:67], v[80:83]
    ds_read_b64_tr_b16 v[128:129], v144 offset:4096
    v_mfma_f32_16x16x32_bf16 v[96:99], v[112:115], v[68:71], v[96:99]
    ds_read_b64_tr_b16 v[130:131], v144 offset:6144
    s_waitcnt lgkmcnt(6)
    v_mfma_f32_16x16x32_bf16 v[84:87], v[116:119], v[64:67], v[84:87]
    ds_read_b64_tr_b16 v[132:133], v145 offset:4096
    v_mfma_f32_16x16x32_bf16 v[100:103], v[116:119], v[68:71], v[100:103]
    ds_read_b64_tr_b16 v[134:135], v145 offset:6144
    s_waitcnt lgkmcnt(6)
    v_mfma_f32_16x16x32_bf16 v[88:91], v[120:123], v[64:67], v[88:91]
    ds_read_b64_tr_b16 v[136:137], v146 offset:4096
    v_mfma_f32_16x16x32_bf16 v[104:107], v[120:123], v[68:71], v[104:107]
    ds_read_b64_tr_b16 v[138:139], v146 offset:6144
    s_waitcnt lgkmcnt(6)
    v_mfma_f32_16x16x32_bf16 v[92:95], v[124:127], v[64:67], v[92:95]
    ds_read_b64_tr_b16 v[140:141], v147 offset:4096
    v_mfma_f32_16x16x32_bf16 v[108:111], v[124:127], v[68:71], v[108:111]
    ds_read_b64_tr_b16 v[142:143], v147 offset:6144
    s_cmp_eq_u32 s65, 0
    s_cbranch_scc1 L_b_p5
L_b_r5:
    s_ff1_i32_b32 s91, s65
    s_bitset0_b32 s65, s91
    s_lshl_b32 s77, s91, 12
    s_lshl_b32 s91, s91, 10
    buffer_load_dwordx4 v[32:35], v157, s[16:19], s91 offen offset:0 sc1
    buffer_load_dwordx4 v[36:39], v158, s[16:19], s91 offen offset:0 sc1
    s_waitcnt vmcnt(6) lgkmcnt(6)
    v_max3_u32 v156, v156, v75, v79
    v_mfma_f32_16x16x32_bf16 v[80:83], v[128:131], v[72:75], v[80:83]
    s_xor_b32 s89, s67, s76
    s_mov_b32 s67, s76
    v_xor_b32 v144, s89, v144
    ds_read_b64_tr_b16 v[112:113], v144 offset:0
    v_mfma_f32_16x16x32_bf16 v[96:99], v[128:131], v[76:79], v[96:99]
    ds_read_b64_tr_b16 v[114:115], v144 offset:2048
    s_waitcnt lgkmcnt(6)
    v_mfma_f32_16x16x32_bf16 v[84:87], v[132:135], v[72:75], v[84:87]
    v_xor_b32 v145, s89, v145
    ds_read_b64_tr_b16 v[116:117], v145 offset:0
    v_mfma_f32_16x16x32_bf16 v[100:103], v[132:135], v[76:79], v[100:103]
    ds_read_b64_tr_b16 v[118:119], v145 offset:2048
    s_waitcnt lgkmcnt(6)
    v_mfma_f32_16x16x32_bf16 v[88:91], v[136:139], v[72:75], v[88:91]
    v_xor_b32 v146, s89, v146
    ds_read_b64_tr_b16 v[120:121], v146 offset:0
    v_mfma_f32_16x16x32_bf16 v[104:107], v[136:139], v[76:79], v[104:107]
    ds_read_b64_tr_b16 v[122:123], v146 offset:2048
    s_waitcnt lgkmcnt(6)
    v_mfma_f32_16x16x32_bf16 v[92:95], v[140:143], v[72:75], v[92:95]
    v_xor_b32 v147, s89, v147
    ds_read_b64_tr_b16 v[124:125], v147 offset:0
    v_mfma_f32_16x16x32_bf16 v[108:111], v[140:143], v[76:79], v[108:111]
    ds_read_b64_tr_b16 v[126:127], v147 offset:2048
    buffer_load_dwordx4 v[40:43], v157, s[16:19], s91 offen offset:1024 sc1
    buffer_load_dwordx4 v[44:47], v158, s[16:19], s91 offen offset:1024 sc1
    s_waitcnt vmcnt(6) lgkmcnt(6)
    v_max3_u32 v156, v156, v19, v23
    v_mfma_f32_16x16x32_bf16 v[80:83], v[112:115], v[16:19], v[80:83]
    ds_read_b64_tr_b16 v[128:129], v144 offset:4096
    v_mfma_f32_16x16x32_bf16 v[96:99], v[112:115], v[20:23], v[96:99]
    ds_read_b64_tr_b16 v[130:131], v144 offset:6144
    s_waitcnt lgkmcnt(6)
    v_mfma_f32_16x16x32_bf16 v[84:87], v[116:119], v[16:19], v[84:87]
    ds_read_b64_tr_b16 v[132:133], v145 offset:4096
    v_mfma_f32_16x16x32_bf16 v[100:103], v[116:119], v[20:23], v[100:103]
    ds_read_b64_tr_b16 v[134:135], v145 offset:6144
    s_waitcnt lgkmcnt(6)
    v_mfma_f32_16x16x32_bf16 v[88:91], v[120:123], v[16:19], v[88:91]
    ds_read_b64_tr_b16 v[136:137], v146 offset:4096
    v_mfma_f32_16x16x32_bf16 v[104:107], v[120:123], v[20:23], v[104:107]
    ds_read_b64_tr_b16 v[138:139], v146 offset:6144
    s_waitcnt lgkmcnt(6)
    v_mfma_f32_16x16x32_bf16 v[92:95], v[124:127], v[16:19], v[92:95]
    ds_read_b64_tr_b16 v[140:141], v147 offset:4096
    v_mfma_f32_16x16x32_bf16 v[108:111], v[124:127], v[20:23], v[108:111]
    ds_read_b64_tr_b16 v[142:143], v147 offset:6144
    s_cmp_eq_u32 s65, 0
    s_cbranch_scc1 L_b_p6
L_b_r6:
    s_ff1_i32_b32 s91, s65
    s_bitset0_b32 s65, s91
    s_lshl_b32 s78, s91, 12
    s_lshl_b32 s91, s91, 10
    buffer_load_dwordx4 v[48:51], v157, s[16:19], s91 offen offset:0 sc1
    buffer_load_dwordx4 v[52:55], v158, s[16:19], s91 offen offset:0 sc1
    s_waitcnt vmcnt(6) lgkmcnt(6)
    v_max3_u32 v156, v156, v27, v31
    v_mfma_f32_16x16x32_bf16 v[80:83], v[128:131], v[24:27], v[80:83]
    s_xor_b32 s89, s67, s77
    s_mov_b32 s67, s77
    v_xor_b32 v144, s89, v144
    ds_read_b64_tr_b16 v[112:113], v144 offset:0
    v_mfma_f32_16x16x32_bf16 v[96:99], v[128:131], v[28:31], v[96:99]
    ds_read_b64_tr_b16 v[114:115], v144 offset:2048
    s_waitcnt lgkmcnt(6)
    v_mfma_f32_16x16x32_bf16 v[84:87], v[132:135], v[24:27], v[84:87]
    v_xor_b32 v145, s89, v145
    ds_read_b64_tr_b16 v[116:117], v145 offset:0
    v_mfma_f32_16x16x32_bf16 v[100:103], v[132:135], v[28:31], v[100:103]
    ds_read_b64_tr_b16 v[118:119], v145 offset:2048
    s_waitcnt lgkmcnt(6)
    v_mfma_f32_16x16x32_bf16 v[88:91], v[136:139], v[24:27], v[88:91]
    v_xor_b32 v146, s89, v146
    ds_read_b64_tr_b16 v[120:121], v146 offset:0
    v_mfma_f32_16x16x32_bf16 v[104:107], v[136:139], v[28:31], v[104:107]
    ds_read_b64_tr_b16 v[122:123], v146 offset:2048
    s_waitcnt lgkmcnt(6)
    v_mfma_f32_16x16x32_bf16 v[92:95], v[140:143], v[24:27], v[92:95]
    v_xor_b32 v147, s89, v147
    ds_read_b64_tr_b16 v[124:125], v147 offset:0
    v_mfma_f32_16x16x32_bf16 v[108:111], v[140:143], v[28:31], v[108:111]
    ds_read_b64_tr_b16 v[126:127], v147 offset:2048
    buffer_load_dwordx4 v[56:59], v157, s[16:19], s91 offen offset:1024 sc1
    buffer_load_dwordx4 v[60:63], v158, s[16:19], s91 offen offset:1024 sc1
    s_waitcnt vmcnt(6) lgkmcnt(6)
L_walk_17:
    s_cbranch_execz L_walk_21
    v_max3_u32 v156, v156, v35, v39
    v_mfma_f32_16x16x32_bf16 v[80:83], v[112:115], v[32:35], v[80:83]
    ds_read_b64_tr_b16 v[128:129], v144 offset:4096
    v_mfma_f32_16x16x32_bf16 v[96:99], v[112:115], v[36:39], v[96:99]
    ds_read_b64_tr_b16 v[130:131], v144 offset:6144
    s_waitcnt lgkmcnt(6)
    v_mfma_f32_16x16x32_bf16 v[84:87], v[116:119], v[32:35], v[84:87]
    ds_read_b64_tr_b16 v[132:133], v145 offset:4096
    v_mfma_f32_16x16x32_bf16 v[100:103], v[116:119], v[36:39], v[100:103]
    ds_read_b64_tr_b16 v[134:135], v145 offset:6144
    s_waitcnt lgkmcnt(6)
    v_mfma_f32_16x16x32_bf16 v[88:91], v[120:123], v[32:35], v[88:91]
    ds_read_b64_tr_b16 v[136:137], v146 offset:4096
    v_mfma_f32_16x16x32_bf16 v[104:107], v[120:123], v[36:39], v[104:107]
    ds_read_b64_tr_b16 v[138:139], v146 offset:6144
    s_waitcnt lgkmcnt(6)
    v_mfma_f32_16x16x32_bf16 v[92:95], v[124:127], v[32:35], v[92:95]
    ds_read_b64_tr_b16 v[140:141], v147 offset:4096
    v_mfma_f32_16x16x32_bf16 v[108:111], v[124:127], v[36:39], v[108:111]
    ds_read_b64_tr_b16 v[142:143], v147 offset:6144
    s_cmp_eq_u32 s65, 0
    s_cbranch_scc1 L_b_p7
L_b_r7:
    s_ff1_i32_b32 s91, s65
    s_bitset0_b32 s65, s91
    s_lshl_b32 s79, s91, 12
    s_lshl_b32 s91, s91, 10
    buffer_load_dwordx4 v[64:67], v157, s[16:19], s91 offen offset:0 sc1
    buffer_load_dwordx4 v[68:71], v158, s[16:19], s91 offen offset:0 sc1
    s_waitcnt vmcnt(6) lgkmcnt(6)
    v_max3_u32 v156, v156, v43, v47
    v_mfma_f32_16x16x32_bf16 v[80:83], v[128:131], v[40:43], v[80:83]
    s_xor_b32 s89, s67, s78
    s_mov_b32 s67, s78
    v_xor_b32 v144, s89, v144
    ds_read_b64_tr_b16 v[112:113], v144 offset:0
    v_mfma_f32_16x16x32_bf16 v[96:99], v[128:131], v[44:47], v[96:99]
    ds_read_b64_tr_b16 v[114:115], v144 offset:2048
    s_waitcnt lgkmcnt(6)
    v_mfma_f32_16x16x32_bf16 v[84:87], v[132:135], v[40:43], v[84:87]
    v_xor_b32 v145, s89, v145
    ds_read_b64_tr_b16 v[116:117], v145 offset:0
    v_mfma_f32_16x16x32_bf16 v[100:103], v[132:135], v[44:47], v[100:103]
    ds_read_b64_tr_b16 v[118:119], v145 offset:2048
    s_waitcnt lgkmcnt(6)
    v_mfma_f32_16x16x32_bf16 v[88:91], v[136:139], v[40:43], v[88:91]
    v_xor_b32 v146, s89, v146
    ds_read_b64_tr_b16 v[120:121], v146 offset:0
    v_mfma_f32_16x16x32_bf16 v[104:107], v[136:139], v[44:47], v[104:107]
    ds_read_b64_tr_b16 v[122:123], v146 offset:2048
    s_waitcnt lgkmcnt(6)
    v_mfma_f32_16x16x32_bf16 v[92:95], v[140:143], v[40:43], v[92:95]
    v_xor_b32 v147, s89, v147
    ds_read_b64_tr_b16 v[124:125], v147 offset:0
    v_mfma_f32_16x16x32_bf16 v[108:111], v[140:143], v[44:47], v[108:111]
    ds_read_b64_tr_b16 v[126:127], v147 offset:2048
    buffer_load_dwordx4 v[72:75], v157, s[16:19], s91 offen offset:1024 sc1
    buffer_load_dwordx4 v[76:79], v158, s[16:19], s91 offen offset:1024 sc1
    s_waitcnt vmcnt(6) lgkmcnt(6)
    v_max3_u32 v156, v156, v51, v55
    v_mfma_f32_16x16x32_bf16 v[80:83], v[112:115], v[48:51], v[80:83]
    ds_read_b64_tr_b16 v[128:129], v144 offset:4096
    v_mfma_f32_16x16x32_bf16 v[96:99], v[112:115], v[52:55], v[96:99]
    ds_read_b64_tr_b16 v[130:131], v144 offset:6144
    s_mov_b32 s90, 71680
    buffer_load_dwordx4 v[204:207], v11, s[32:35], s90 offen
    s_waitcnt lgkmcnt(6)
    v_mfma_f32_16x16x32_bf16 v[84:87], v[116:119], v[48:51], v[84:87]
    ds_read_b64_tr_b16 v[132:133], v145 offset:4096
    v_mfma_f32_16x16x32_bf16 v[100:103], v[116:119], v[52:55], v[100:103]
    ds_read_b64_tr_b16 v[134:135], v145 offset:6144
    s_waitcnt lgkmcnt(6)
    v_mfma_f32_16x16x32_bf16 v[88:91], v[120:123], v[48:51], v[88:91]
    ds_read_b64_tr_b16 v[136:137], v146 offset:4096
    v_mfma_f32_16x16x32_bf16 v[104:107], v[120:123], v[52:55], v[104:107]
    ds_read_b64_tr_b16 v[138:139], v146 offset:6144
    s_mov_b32 s90, 78848
    buffer_load_dwordx4 v[208:211], v11, s[32:35], s90 offen
    s_waitcnt lgkmcnt(6)
    v_mfma_f32_16x16x32_bf16 v[92:95], v[124:127], v[48:51], v[92:95]
    ds_read_b64_tr_b16 v[140:141], v147 offset:4096
    v_mfma_f32_16x16x32_bf16 v[108:111], v[124:127], v[52:55], v[108:111]
    ds_read_b64_tr_b16 v[142:143], v147 offset:6144
    s_waitcnt vmcnt(6) lgkmcnt(6)
    v_max3_u32 v156, v156, v59, v63
    v_mfma_f32_16x16x32_bf16 v[80:83], v[128:131], v[56:59], v[80:83]
    s_xor_b32 s89, s67, s79
    s_mov_b32 s67, s79
    v_xor_b32 v144, s89, v144
    ds_read_b64_tr_b16 v[112:113], v144 offset:0
    v_mfma_f32_16x16x32_bf16 v[96:99], v[128:131], v[60:63], v[96:99]
    ds_read_b64_tr_b16 v[114:115], v144 offset:2048
    s_mov_b32 s90, 86016
    buffer_load_dwordx4 v[212:215], v11, s[32:35], s90 offen
    s_waitcnt lgkmcnt(6)
    v_mfma_f32_16x16x32_bf16 v[84:87], v[132:135], v[56:59], v[84:87]
    v_xor_b32 v145, s89, v145
    ds_read_b64_tr_b16 v[116:117], v145 offset:0
    v_mfma_f32_16x16x32_bf16 v[100:103], v[132:135], v[60:63], v[100:103]
    ds_read_b64_tr_b16 v[118:119], v145 offset:2048
    s_waitcnt lgkmcnt(6)
    v_mfma_f32_16x16x32_bf16 v[88:91], v[136:139], v[56:59], v[88:91]
    v_xor_b32 v146, s89, v146
    ds_read_b64_tr_b16 v[120:121], v146 offset:0
    v_mfma_f32_16x16x32_bf16 v[104:107], v[136:139], v[60:63], v[104:107]
    ds_read_b64_tr_b16 v[122:123], v146 offset:2048
    s_mov_b32 s90, 93184
    buffer_load_dwordx4 v[216:219], v11, s[32:35], s90 offen
    s_waitcnt lgkmcnt(6)
    v_mfma_f32_16x16x32_bf16 v[92:95], v[140:143], v[56:59], v[92:95]
    v_xor_b32 v147, s89, v147
    ds_read_b64_tr_b16 v[124:125], v147 offset:0
    v_mfma_f32_16x16x32_bf16 v[108:111], v[140:143], v[60:63], v[108:111]
    ds_read_b64_tr_b16 v[126:127], v147 offset:2048
    s_waitcnt vmcnt(6) lgkmcnt(6)
    v_max3_u32 v156, v156, v67, v71
    v_mfma_f32_16x16x32_bf16 v[80:83], v[112:115], v[64:67], v[80:83]
    ds_read_b64_tr_b16 v[128:129], v144 offset:4096
    v_mfma_f32_16x16x32_bf16 v[96:99], v[112:115], v[68:71], v[96:99]
    ds_read_b64_tr_b16 v[130:131], v144 offset:6144
    s_mov_b32 s90, 100352
    buffer_load_dwordx4 v[220:223], v11, s[32:35], s90 offen
    s_waitcnt lgkmcnt(6)
    v_mfma_f32_16x16x32_bf16 v[84:87], v[116:119], v[64:67], v[84:87]
    ds_read_b64_tr_b16 v[132:133], v145 offset:4096
    v_mfma_f32_16x16x32_bf16 v[100:103], v[116:119], v[68:71], v[100:103]
    ds_read_b64_tr_b16 v[134:135], v145 offset:6144
    s_waitcnt lgkmcnt(6)
    v_mfma_f32_16x16x32_bf16 v[88:91], v[120:123], v[64:67], v[88:91]
    ds_read_b64_tr_b16 v[136:137], v146 offset:4096
    v_mfma_f32_16x16x32_bf16 v[104:107], v[120:123], v[68:71], v[104:107]
    ds_read_b64_tr_b16 v[138:139], v146 offset:6144
    s_waitcnt lgkmcnt(6)
    v_mfma_f32_16x16x32_bf16 v[92:95], v[124:127], v[64:67], v[92:95]
    ds_read_b64_tr_b16 v[140:141], v147 offset:4096
    v_mfma_f32_16x16x32_bf16 v[108:111], v[124:127], v[68:71], v[108:111]
    ds_read_b64_tr_b16 v[142:143], v147 offset:6144
    s_waitcnt vmcnt(5) lgkmcnt(6)
    v_max3_u32 v156, v156, v75, v79
    v_cmp_eq_u32 vcc, -1, v156
    s_cbranch_vccz L_ok_3
    s_sub_u32 s56, s56, 1
    s_cbranch_scc0 L_b_restart
    s_mov_b32 s56, 0
L_ok_3:
    v_mfma_f32_16x16x32_bf16 v[80:83], v[128:131], v[72:75], v[80:83]
    v_mfma_f32_16x16x32_bf16 v[96:99], v[128:131], v[76:79], v[96:99]
    s_mov_b32 s90, 107520
    buffer_load_dwordx4 v[224:227], v11, s[32:35], s90 offen
    s_waitcnt lgkmcnt(4)
    v_mfma_f32_16x16x32_bf16 v[84:87], v[132:135], v[72:75], v[84:87]
    v_mfma_f32_16x16x32_bf16 v[100:103], v[132:135], v[76:79], v[100:103]
    s_waitcnt lgkmcnt(2)
    v_mfma_f32_16x16x32_bf16 v[88:91], v[136:139], v[72:75], v[88:91]
    v_mfma_f32_16x16x32_bf16 v[104:107], v[136:139], v[76:79], v[104:107]
    s_waitcnt lgkmcnt(0)
    v_mfma_f32_16x16x32_bf16 v[92:95], v[140:143], v[72:75], v[92:95]
    v_mfma_f32_16x16x32_bf16 v[108:111], v[140:143], v[76:79], v[108:111]
    ds_write_b128 v162, v[96:99] offset:0
    s_nop 0
    ds_write_b128 v162, v[100:103] offset:1024
    s_nop 1
    ds_write_b128 v162, v[104:107] offset:2048
    s_nop 1
    ds_write_b128 v162, v[108:111] offset:3072
    s_waitcnt lgkmcnt(0)
L_walk_18:
    s_cbranch_execz L_walk_22
    s_barrier
    ds_read_b128 v[16:19], v163 offset:0
    ds_read_b128 v[20:23], v163 offset:1024
    ds_read_b128 v[24:27], v163 offset:2048
    ds_read_b128 v[28:31], v163 offset:3072
    s_waitcnt lgkmcnt(3)
    v_pk_add_f32 v[80:81], v[80:81], v[16:17]
    v_pk_add_f32 v[82:83], v[82:83], v[18:19]
    v_cvt_pk_bf16_f32 v32, v80, v81
    v_cvt_pk_bf16_f32 v33, v82, v83
    s_waitcnt lgkmcnt(2)
    v_pk_add_f32 v[84:85], v[84:85], v[20:21]
    v_pk_add_f32 v[86:87], v[86:87], v[22:23]
    v_cvt_pk_bf16_f32 v34, v84, v85
    v_cvt_pk_bf16_f32 v35, v86, v87
    s_waitcnt lgkmcnt(1)
    v_pk_add_f32 v[88:89], v[88:89], v[24:25]
    v_pk_add_f32 v[90:91], v[90:91], v[26:27]
    v_cvt_pk_bf16_f32 v36, v88, v89
    v_cvt_pk_bf16_f32 v37, v90, v91
    s_waitcnt lgkmcnt(0)
    v_pk_add_f32 v[92:93], v[92:93], v[28:29]
    v_pk_add_f32 v[94:95], v[94:95], v[30:31]
    v_cvt_pk_bf16_f32 v38, v92, v93
    v_cvt_pk_bf16_f32 v39, v94, v95
    v_mfma_f32_16x16x32_bf16 v[60:63], v[32:35], v[32:35], 0
    v_mfma_f32_16x16x32_bf16 v[56:59], v[32:35], v[148:151], 0
    v_mfma_f32_16x16x32_bf16 v[60:63], v[36:39], v[36:39], v[60:63]
    v_mfma_f32_16x16x32_bf16 v[56:59], v[36:39], v[152:155], v[56:59]
    v_lshlrev_b32 v40, 16, v32
    v_and_b32 v41, 0xffff0000, v32
    v_lshlrev_b32 v42, 16, v33
    v_and_b32 v43, 0xffff0000, v33
    v_lshlrev_b32 v44, 16, v34
    v_and_b32 v45, 0xffff0000, v34
    s_nop 1
    v_cndmask_b32 v56, v56, v60, s[72:73]
    v_cndmask_b32 v57, v57, v61, s[72:73]
    v_cndmask_b32 v58, v58, v62, s[72:73]
    v_cndmask_b32 v59, v59, v63, s[72:73]
    v_cndmask_b32 v56, v56, v57, s[4:5]
    v_cndmask_b32 v58, v58, v59, s[98:99]
    s_or_b64 vcc, s[6:7], s[98:99]
    v_cndmask_b32 v56, v56, v58, vcc
    v_cndmask_b32 v56, v56, 1.0, s[74:75]
    v_mov_b32 v67, v56
    buffer_atomic_add_f32 v67, v160, s[16:19], 0 offen sc0 sc1
    s_mov_b32 s90, 0
    buffer_load_dwordx4 v[228:231], v14, s[36:39], s90 offen
    s_mov_b32 s90, 2048
    buffer_load_dwordx4 v[232:235], v14, s[36:39], s90 offen
    s_mov_b32 s90, 4096
    buffer_load_dwordx4 v[236:239], v14, s[36:39], s90 offen
    s_lshl_b32 s86, s3, 11
    s_add_u32 s86, s86, 69632
    v_lshl_add_u32 v150, v0, 4, s86
    ds_write_b128 v150, v[32:35]
    ds_write_b128 v150, v[36:39] offset:1024
    s_lshl_b32 s86, s3, 7
    s_add_u32 s86, s86, 66560
    v_lshl_add_u32 v151, v2, 3, s86
    s_cmp_eq_u32 s62, 0
    s_cbranch_scc1 L_unp
    v_and_b32 v24, 1, v0
    v_cmp_eq_u32 vcc, 1, v24
    v_mov_b32 v24, 0x0c0c0100
    v_mov_b32 v25, 0x01000c0c
    v_cndmask_b32 v16, v24, v25, vcc
    v_mov_b32 v24, 0x0c0c0302
    v_mov_b32 v25, 0x03020c0c
    v_cndmask_b32 v17, v24, v25, vcc
    v_bfe_u32 v24, v0, 1, 2
    v_mov_b32 v25, 0x0c0c0c0c
    v_cmp_eq_u32 vcc, 0, v24
    s_nop 1
    v_cndmask_b32 v72, v25, v16, vcc
    v_cndmask_b32 v76, v25, v17, vcc
    v_cmp_eq_u32 vcc, 1, v24
    s_nop 1
    v_cndmask_b32 v73, v25, v16, vcc
    v_cndmask_b32 v77, v25, v17, vcc
    v_cmp_eq_u32 vcc, 2, v24
    s_nop 1
    v_cndmask_b32 v74, v25, v16, vcc
    v_cndmask_b32 v78, v25, v17, vcc
    v_cmp_eq_u32 vcc, 3, v24
    s_nop 1
    v_cndmask_b32 v75, v25, v16, vcc
    v_cndmask_b32 v79, v25, v17, vcc
    s_lshl_b32 s86, s48, 10
    s_add_u32 s86, s86, 90112
    v_lshl_add_u32 v18, v0, 4, s86
    s_and_b32 s86, s48, 1
    s_cselect_b32 s87, s81, s80
    s_mul_i32 s88, s87, 299616
    s_lshr_b32 s88, s88, 16
    s_mul_i32 s89, s88, 14
    s_lshl_b32 s90, s87, 6
    s_sub_u32 s89, s89, s90
    s_lshr_b32 s90, s48, 1
    s_lshl1_add_u32 s88, s88, s90
    s_and_b32 s91, s2, 1
    s_lshl1_add_u32 s88, s88, s91
    s_lshl_b32 s88, s88, 7
    s_add_u32 s88, s88, 6291456
    s_cmp_lt_u32 s87, 56
    s_cselect_b32 s88, s88, 2147483648
    s_lshl_b32 s90, s90, 9
    s_lshl_b32 s86, s86, 7
    s_add_u32 s86, s86, s90
    s_add_u32 s86, s86, 90112
    v_mul_u32_u24 v16, 14, v1
    v_add3_u32 v16, v16, v2, s89
    v_cmp_eq_u32 s[4:5], 14, v2
    v_cmp_gt_u32 vcc, 14, v2
    s_nop 1
    v_cndmask_b32 v21, 0, 64, vcc
    v_mov_b32 v17, 78
    v_cndmask_b32 v21, v21, v17, s[4:5]
    v_lshl_add_u32 v22, v1, 9, s88
    v_lshl_add_u32 v22, v2, 2, v22
    v_mov_b32 v23, 2147483648
    v_cmp_lt_u32 vcc, v16, v21
    s_nop 1
    v_cndmask_b32 v131, v23, v22, vcc
    v_sub_u32 v17, 78, v16
    v_min3_i32 v17, v17, v16, 14
    v_cvt_f32_i32 v135, v17
    v_bfe_u32 v17, v16, 3, 3
    v_lshl_add_u32 v133, v17, 4, s86
    v_bfe_u32 v17, v16, 2, 1
    v_lshl_add_u32 v133, v17, 8, v133
    v_and_b32 v17, 3, v16
    v_lshl_add_u32 v133, v17, 2, v133
    v_add_u32 v16, 56, v16
    v_add_u32 v22, 2048, v22
    v_cmp_lt_u32 vcc, v16, v21
    s_nop 1
    v_cndmask_b32 v132, v23, v22, vcc
    v_sub_u32 v17, 78, v16
    v_min3_i32 v17, v17, v16, 14
    v_cvt_f32_i32 v136, v17
    v_bfe_u32 v17, v16, 3, 3
    v_lshl_add_u32 v134, v17, 4, s86
    v_bfe_u32 v17, v16, 2, 1
    v_lshl_add_u32 v134, v17, 8, v134
    v_and_b32 v17, 3, v16
    v_lshl_add_u32 v134, v17, 2, v134
    s_lshl2_add_u32 s86, s45, s48
    s_lshl_b32 s86, s86, 10
    s_add_u32 s86, s86, 6291456
    v_lshrrev_b32 v16, 3, v0
    v_lshl_add_u32 v137, v16, 7, s86
    v_and_b32 v16, 7, v0
    v_lshl_add_u32 v137, v16, 3, v137
    v_mov_b32 v138, 0
    v_mov_b32 v139, 0
    s_branch L_unpd
L_unp:
    v_lshlrev_b32 v46, 16, v35
    v_and_b32 v47, 0xffff0000, v35
    v_lshlrev_b32 v48, 16, v36
    v_and_b32 v49, 0xffff0000, v36
    v_lshlrev_b32 v50, 16, v37
    v_and_b32 v51, 0xffff0000, v37
    v_lshlrev_b32 v52, 16, v38
    v_and_b32 v53, 0xffff0000, v38
    v_lshlrev_b32 v54, 16, v39
    v_and_b32 v55, 0xffff0000, v39
L_unpd:
    v_lshrrev_b32 v8, 2, v2
    v_lshlrev_b32 v9, 4, v8
    v_sub_u32 v9, v161, v9
    v_cmp_eq_u32 vcc, 0, v8
    s_nop 1
    v_cndmask_b32 v10, 0, 32, vcc
L_walk_19:
    s_cbranch_execz L_walk_23
    v_add_u32 v10, v9, v10
    v_cmp_eq_u32 vcc, 1, v8
    s_nop 1
    v_cndmask_b32 v8, 16, 48, vcc
    v_add_u32 v9, v9, v8
    s_lshl_b32 s86, s52, 11
    s_lshr_b32 s87, s51, 3
    s_lshl_b32 s87, s87, 6
    s_add_u32 s86, s86, s87
    s_and_b32 s87, s51, 7
    s_lshl3_add_u32 s86, s87, s86
    s_add_u32 s86, s86, 6684672
    v_lshl_add_u32 v149, v0, 7, s86
    v_mov_b32 v8, 2147483648
    v_cmp_gt_u32 vcc, 16, v0
    s_nop 1
    v_cndmask_b32 v149, v8, v149, vcc
    s_bfe_u32 s67, s2, 0x20001
    s_lshl2_add_u32 s67, s67, s48
    s_and_b32 s86, s2, 1
    s_lshl1_add_u32 s87, s45, s86
    s_and_b32 s87, s87, 15
    s_lshl_b32 s86, s67, 4
    s_add_u32 s86, s86, s87
    s_lshl_b32 s86, s86, 7
    s_add_u32 s86, s86, 6684672
    v_lshl_add_u32 v148, v0, 3, s86
    v_mov_b32 v8, 2147483648
    v_cmp_gt_u32 vcc, 16, v0
    s_nop 1
    v_cndmask_b32 v148, v8, v148, vcc
    s_lshl_b32 s67, s67, 7
    s_add_u32 s67, s67, 6619136
    s_waitcnt vmcnt(3)
    v_add_f32 v67, v67, v56
    s_branch L_h3_chk
L_h3:
    v_mov_b32 v67, 0
    buffer_atomic_or v67, v160, s[16:19], 0 offen sc0 sc1
    s_waitcnt vmcnt(0)
L_h3_chk:
    v_cmp_ne_u32 vcc, 0x41800000, v67
    s_nop 0
    s_and_b64 vcc, vcc, s[74:75]
    s_cbranch_vccz L_ok_4
    s_sub_u32 s56, s56, 1
    s_cbranch_scc0 L_h3
    s_mov_b32 s56, 0
L_ok_4:
    ds_bpermute_b32 v64, v10, v67
    ds_bpermute_b32 v66, v161, v67
    ds_bpermute_b32 v65, v9, v67
    s_cmp_eq_u32 s62, 0
    s_cbranch_scc1 L_nop0
    v_mov_b32 v128, 0
    v_mov_b32 v129, 0
    buffer_atomic_or_x2 v[128:129], v148, s[16:19], 0 offen sc0 sc1
L_nop0:
    s_waitcnt lgkmcnt(0)
    v_mul_f32 v64, 0x3a800000, v64
    v_mul_f32 v66, 0x3a800000, v66
    v_fma_f32 v66, -v64, v64, v66
    v_max_f32 v66, 0, v66
    v_cvt_pk_bf16_f32 v69, v64, v66
    v_lshlrev_b32 v68, 16, v69
    v_and_b32 v69, 0xffff0000, v69
    v_add_f32 v69, 0x3727c5ac, v69
    v_cvt_pk_bf16_f32 v69, v69, v69
    v_lshlrev_b32 v69, 16, v69
    v_sqrt_f32 v69, v69
    s_nop 0
    v_cvt_pk_bf16_f32 v69, v69, v69
    v_lshlrev_b32 v69, 16, v69
    v_rcp_f32 v70, v69
    v_fma_f32 v12, -v68, s57, v65
    v_mul_f32 v12, v12, v70
    v_mul_f32 v71, -v68, v70
    v_cvt_pk_bf16_f32 v12, v12, v12
    v_ashrrev_i32 v8, 31, v12
    v_or_b32 v8, 0x80000000, v8
    v_xor_b32 v8, v8, v12
    v_and_b32 v8, 4294901760, v8
    v_or_b32 v13, v8, v6
    s_lshl_b32 s86, s3, 6
    s_add_u32 s86, s86, 65536
    v_lshl_add_u32 v8, v2, 2, s86
    ds_write_b32 v8, v13
    ds_write_b64 v151, v[70:71]
    v_mov_b32 v152, v8
    s_cmp_lg_u32 s62, 0
    s_cbranch_scc1 L_nohn
    v_pk_fma_f32 v[16:17], v[40:41], v[70:71], v[70:71] op_sel:[0,0,1] op_sel_hi:[1,0,1]
    v_pk_fma_f32 v[18:19], v[42:43], v[70:71], v[70:71] op_sel:[0,0,1] op_sel_hi:[1,0,1]
    v_pk_fma_f32 v[20:21], v[44:45], v[70:71], v[70:71] op_sel:[0,0,1] op_sel_hi:[1,0,1]
    v_pk_fma_f32 v[22:23], v[46:47], v[70:71], v[70:71] op_sel:[0,0,1] op_sel_hi:[1,0,1]
    v_pk_fma_f32 v[24:25], v[48:49], v[70:71], v[70:71] op_sel:[0,0,1] op_sel_hi:[1,0,1]
    v_pk_fma_f32 v[26:27], v[50:51], v[70:71], v[70:71] op_sel:[0,0,1] op_sel_hi:[1,0,1]
    v_pk_fma_f32 v[28:29], v[52:53], v[70:71], v[70:71] op_sel:[0,0,1] op_sel_hi:[1,0,1]
    v_pk_fma_f32 v[30:31], v[54:55], v[70:71], v[70:71] op_sel:[0,0,1] op_sel_hi:[1,0,1]
L_nohn:
    v_lshlrev_b32 v8, 3, v0
    v_add_u32 v8, 65536, v8
    s_waitcnt lgkmcnt(0)
    s_barrier
    ds_read_b64 v[64:65], v8
    s_cmp_lg_u32 s62, 0
    s_cbranch_scc1 L_t3_ld
    ds_read_b32 v144, v152 offset:256
    ds_read_b64 v[142:143], v151 offset:512
    ds_read_b128 v[112:115], v150 offset:8192
    ds_read_b128 v[116:119], v150 offset:9216
    v_cvt_pk_bf16_f32 v96, v16, v17
    v_cvt_pk_bf16_f32 v97, v18, v19
    v_cvt_pk_bf16_f32 v98, v20, v21
    v_cvt_pk_bf16_f32 v99, v22, v23
    v_cvt_pk_bf16_f32 v100, v24, v25
    v_cvt_pk_bf16_f32 v101, v26, v27
    v_cvt_pk_bf16_f32 v102, v28, v29
    v_cvt_pk_bf16_f32 v103, v30, v31
    s_waitcnt lgkmcnt(4)
    v_max_u32 v66, v64, v65
    v_min_u32 v67, v64, v65
    s_nop 0
    v_min_u32_dpp v64, v66, v66 row_ror:8 row_mask:0xf bank_mask:0xf
    v_max_u32_dpp v66, v66, v66 row_ror:8 row_mask:0xf bank_mask:0xf
    v_max_u32_dpp v65, v67, v67 row_ror:8 row_mask:0xf bank_mask:0xf
    v_max_u32 v67, v64, v65
    v_min_u32_dpp v64, v66, v66 row_ror:4 row_mask:0xf bank_mask:0xf
    v_max_u32_dpp v66, v66, v66 row_ror:4 row_mask:0xf bank_mask:0xf
    v_max_u32_dpp v65, v67, v67 row_ror:4 row_mask:0xf bank_mask:0xf
    v_max_u32 v67, v64, v65
    v_min_u32_dpp v64, v66, v66 row_ror:2 row_mask:0xf bank_mask:0xf
    v_max_u32_dpp v66, v66, v66 row_ror:2 row_mask:0xf bank_mask:0xf
    v_max_u32_dpp v65, v67, v67 row_ror:2 row_mask:0xf bank_mask:0xf
    v_max_u32 v67, v64, v65
    v_min_u32_dpp v64, v66, v66 row_ror:1 row_mask:0xf bank_mask:0xf
    v_max_u32_dpp v66, v66, v66 row_ror:1 row_mask:0xf bank_mask:0xf
    v_max_u32_dpp v65, v67, v67 row_ror:1 row_mask:0xf bank_mask:0xf
    v_max_u32 v67, v64, v65
    v_readlane_b32 s58, v66, 0
    v_readlane_b32 s59, v67, 0
    v_readlane_b32 s86, v66, 16
    v_readlane_b32 s87, v67, 16
    s_nop 0
    s_max_u32 s59, s59, s87
    s_min_u32 s87, s58, s86
    s_max_u32 s58, s58, s86
    s_max_u32 s59, s59, s87
    v_readlane_b32 s86, v66, 32
    v_readlane_b32 s87, v67, 32
    s_nop 0
    s_max_u32 s59, s59, s87
    s_min_u32 s87, s58, s86
    s_max_u32 s58, s58, s86
    s_max_u32 s59, s59, s87
    v_readlane_b32 s86, v66, 48
    v_readlane_b32 s87, v67, 48
    s_nop 0
    s_max_u32 s59, s59, s87
    s_min_u32 s87, s58, s86
    s_max_u32 s58, s58, s86
    s_max_u32 s59, s59, s87
    s_cmp_lg_u32 s3, 0
    s_cbranch_scc1 L_nokey
    v_mov_b32 v8, s58
    v_mov_b32 v9, s59
    buffer_atomic_swap_x2 v[8:9], v149, s[16:19], 0 offen sc1
L_nokey:
    v_cmp_eq_u32 s[4:5], s58, v13
    v_cmp_eq_u32 s[6:7], s59, v13
    s_nop 0
    s_or_b64 s[96:97], s[4:5], s[6:7]
    s_cbranch_scc0 L_nocand
    s_lshl_b32 s86, s51, 12
    s_lshl_b32 s87, s52, 7
    s_add_u32 s86, s86, s87
    s_add_u32 s86, s86, 6619136
    v_lshl_add_u32 v8, v1, 3, s86
    v_add_u32 v9, 2048, v8
    v_cndmask_b32 v8, v8, v9, s[6:7]
    v_mov_b32 v9, 2147483648
    v_cndmask_b32 v8, v9, v8, s[96:97]
    buffer_store_dwordx2 v[96:97], v8, s[16:19], 0 offen offset:0 sc1
    buffer_store_dwordx2 v[98:99], v8, s[16:19], 0 offen offset:32 sc1
    buffer_store_dwordx2 v[100:101], v8, s[16:19], 0 offen offset:64 sc1
    buffer_store_dwordx2 v[102:103], v8, s[16:19], 0 offen offset:96 sc1
    v_subrev_u32 v131, 65536, v8
L_nocand:
    s_waitcnt lgkmcnt(0)
    v_lshlrev_b32 v80, 16, v112
L_walk_20:
    s_cbranch_execz L_walk_24
    v_and_b32 v81, 0xffff0000, v112
    v_lshlrev_b32 v82, 16, v113
    v_and_b32 v83, 0xffff0000, v113
    v_lshlrev_b32 v84, 16, v114
    v_and_b32 v85, 0xffff0000, v114
    v_lshlrev_b32 v86, 16, v115
    v_and_b32 v87, 0xffff0000, v115
    v_lshlrev_b32 v88, 16, v116
    v_and_b32 v89, 0xffff0000, v116
    v_lshlrev_b32 v90, 16, v117
    v_and_b32 v91, 0xffff0000, v117
    v_lshlrev_b32 v92, 16, v118
    v_and_b32 v93, 0xffff0000, v118
    v_lshlrev_b32 v94, 16, v119
    v_and_b32 v95, 0xffff0000, v119
    v_pk_fma_f32 v[16:17], v[80:81], v[142:143], v[142:143] op_sel:[0,0,1] op_sel_hi:[1,0,1]
    v_pk_fma_f32 v[18:19], v[82:83], v[142:143], v[142:143] op_sel:[0,0,1] op_sel_hi:[1,0,1]
    v_pk_fma_f32 v[20:21], v[84:85], v[142:143], v[142:143] op_sel:[0,0,1] op_sel_hi:[1,0,1]
    v_pk_fma_f32 v[22:23], v[86:87], v[142:143], v[142:143] op_sel:[0,0,1] op_sel_hi:[1,0,1]
    v_pk_fma_f32 v[24:25], v[88:89], v[142:143], v[142:143] op_sel:[0,0,1] op_sel_hi:[1,0,1]
    v_pk_fma_f32 v[26:27], v[90:91], v[142:143], v[142:143] op_sel:[0,0,1] op_sel_hi:[1,0,1]
    v_pk_fma_f32 v[28:29], v[92:93], v[142:143], v[142:143] op_sel:[0,0,1] op_sel_hi:[1,0,1]
    v_pk_fma_f32 v[30:31], v[94:95], v[142:143], v[142:143] op_sel:[0,0,1] op_sel_hi:[1,0,1]
    v_cvt_pk_bf16_f32 v132, v16, v17
    v_cvt_pk_bf16_f32 v133, v18, v19
    v_cvt_pk_bf16_f32 v134, v20, v21
    v_cvt_pk_bf16_f32 v135, v22, v23
    v_cvt_pk_bf16_f32 v136, v24, v25
    v_cvt_pk_bf16_f32 v137, v26, v27
    v_cvt_pk_bf16_f32 v138, v28, v29
    v_cvt_pk_bf16_f32 v139, v30, v31
    v_cmp_eq_u32 s[4:5], s58, v144
    v_cmp_eq_u32 s[6:7], s59, v144
    s_nop 0
    s_or_b64 s[70:71], s[4:5], s[6:7]
    s_cbranch_scc0 L_nocand2
    s_lshl_b32 s86, s51, 12
    s_lshl_b32 s87, s52, 7
    s_add_u32 s86, s86, s87
    s_add_u32 s86, s86, 6619136
    v_lshl_add_u32 v8, v1, 3, s86
    v_add_u32 v9, 2048, v8
    v_cndmask_b32 v8, v8, v9, s[6:7]
    v_mov_b32 v9, 2147483648
    v_cndmask_b32 v8, v9, v8, s[70:71]
    buffer_store_dwordx2 v[132:133], v8, s[16:19], 0 offen offset:0 sc1
    buffer_store_dwordx2 v[134:135], v8, s[16:19], 0 offen offset:32 sc1
    buffer_store_dwordx2 v[136:137], v8, s[16:19], 0 offen offset:64 sc1
    buffer_store_dwordx2 v[138:139], v8, s[16:19], 0 offen offset:96 sc1
    v_subrev_u32 v140, 65536, v8
L_nocand2:
    v_mov_b32 v9, 2147483648
    v_xor_b32 v6, 0x8000, v5
    v_lshlrev_b32 v16, 16, v96
    v_and_b32 v17, 0xffff0000, v96
    v_lshlrev_b32 v18, 16, v97
    v_and_b32 v19, 0xffff0000, v97
    v_lshlrev_b32 v20, 16, v98
    v_and_b32 v21, 0xffff0000, v98
    v_lshlrev_b32 v22, 16, v99
    v_and_b32 v23, 0xffff0000, v99
    v_lshlrev_b32 v24, 16, v100
    v_and_b32 v25, 0xffff0000, v100
    v_lshlrev_b32 v26, 16, v101
    v_and_b32 v27, 0xffff0000, v101
    v_lshlrev_b32 v28, 16, v102
    v_and_b32 v29, 0xffff0000, v102
    v_lshlrev_b32 v30, 16, v103
    v_and_b32 v31, 0xffff0000, v103
    v_pk_add_f32 v[16:17], v[16:17], v[40:41]
    v_pk_add_f32 v[18:19], v[18:19], v[42:43]
    v_pk_add_f32 v[20:21], v[20:21], v[44:45]
    v_pk_add_f32 v[22:23], v[22:23], v[46:47]
    v_pk_add_f32 v[24:25], v[24:25], v[48:49]
    v_pk_add_f32 v[26:27], v[26:27], v[50:51]
    v_pk_add_f32 v[28:29], v[28:29], v[52:53]
    v_pk_add_f32 v[30:31], v[30:31], v[54:55]
    v_cvt_pk_bf16_f32 v104, v16, v17
    v_cvt_pk_bf16_f32 v105, v18, v19
    v_cvt_pk_bf16_f32 v106, v20, v21
    v_cvt_pk_bf16_f32 v107, v22, v23
    v_cvt_pk_bf16_f32 v108, v24, v25
    v_cvt_pk_bf16_f32 v109, v26, v27
    v_cvt_pk_bf16_f32 v110, v28, v29
    v_cvt_pk_bf16_f32 v111, v30, v31
    v_permlane16_swap_b32 v104, v106
    v_permlane16_swap_b32 v105, v107
    v_permlane16_swap_b32 v108, v110
    v_permlane16_swap_b32 v109, v111
    v_mov_b32 v16, v104
    v_mov_b32 v17, v105
    v_mov_b32 v18, v106
    v_mov_b32 v19, v107
    v_mov_b32_dpp v104, v108 row_ror:8 row_mask:0xf bank_mask:0xc
    v_mov_b32_dpp v105, v109 row_ror:8 row_mask:0xf bank_mask:0xc
    v_mov_b32_dpp v106, v110 row_ror:8 row_mask:0xf bank_mask:0xc
    v_mov_b32_dpp v107, v111 row_ror:8 row_mask:0xf bank_mask:0xc
    v_mov_b32_dpp v108, v16 row_ror:8 row_mask:0xf bank_mask:0x3
    v_mov_b32_dpp v109, v17 row_ror:8 row_mask:0xf bank_mask:0x3
    v_mov_b32_dpp v110, v18 row_ror:8 row_mask:0xf bank_mask:0x3
    v_mov_b32_dpp v111, v19 row_ror:8 row_mask:0xf bank_mask:0x3
    v_cndmask_b32 v8, v5, v9, s[96:97]
    v_lshlrev_b32 v16, 16, v132
    v_and_b32 v17, 0xffff0000, v132
    v_lshlrev_b32 v18, 16, v133
    v_and_b32 v19, 0xffff0000, v133
    v_lshlrev_b32 v20, 16, v134
    v_and_b32 v21, 0xffff0000, v134
    v_lshlrev_b32 v22, 16, v135
    v_and_b32 v23, 0xffff0000, v135
    v_lshlrev_b32 v24, 16, v136
    v_and_b32 v25, 0xffff0000, v136
    v_lshlrev_b32 v26, 16, v137
    v_and_b32 v27, 0xffff0000, v137
    v_lshlrev_b32 v28, 16, v138
    v_and_b32 v29, 0xffff0000, v138
    v_lshlrev_b32 v30, 16, v139
    v_and_b32 v31, 0xffff0000, v139
    v_pk_add_f32 v[16:17], v[16:17], v[80:81]
    v_pk_add_f32 v[18:19], v[18:19], v[82:83]
    v_pk_add_f32 v[20:21], v[20:21], v[84:85]
    v_pk_add_f32 v[22:23], v[22:23], v[86:87]
    v_pk_add_f32 v[24:25], v[24:25], v[88:89]
    v_pk_add_f32 v[26:27], v[26:27], v[90:91]
    v_pk_add_f32 v[28:29], v[28:29], v[92:93]
    v_pk_add_f32 v[30:31], v[30:31], v[94:95]
    v_cvt_pk_bf16_f32 v120, v16, v17
    v_cvt_pk_bf16_f32 v121, v18, v19
    v_cvt_pk_bf16_f32 v122, v20, v21
    v_cvt_pk_bf16_f32 v123, v22, v23
    v_cvt_pk_bf16_f32 v124, v24, v25
    v_cvt_pk_bf16_f32 v125, v26, v27
    v_cvt_pk_bf16_f32 v126, v28, v29
    v_cvt_pk_bf16_f32 v127, v30, v31
    v_permlane16_swap_b32 v120, v122
    v_permlane16_swap_b32 v121, v123
    v_permlane16_swap_b32 v124, v126
    v_permlane16_swap_b32 v125, v127
    v_mov_b32 v16, v120
    v_mov_b32 v17, v121
    v_mov_b32 v18, v122
    v_mov_b32 v19, v123
    v_mov_b32_dpp v120, v124 row_ror:8 row_mask:0xf bank_mask:0xc
    v_mov_b32_dpp v121, v125 row_ror:8 row_mask:0xf bank_mask:0xc
    v_mov_b32_dpp v122, v126 row_ror:8 row_mask:0xf bank_mask:0xc
    v_mov_b32_dpp v123, v127 row_ror:8 row_mask:0xf bank_mask:0xc
    v_mov_b32_dpp v124, v16 row_ror:8 row_mask:0xf bank_mask:0x3
    v_mov_b32_dpp v125, v17 row_ror:8 row_mask:0xf bank_mask:0x3
    v_mov_b32_dpp v126, v18 row_ror:8 row_mask:0xf bank_mask:0x3
    v_mov_b32_dpp v127, v19 row_ror:8 row_mask:0xf bank_mask:0x3
    s_cmp_eq_u64 s[96:97], 0
    s_cbranch_scc1 L_noha
    buffer_store_dwordx2 v[32:33], v131, s[16:19], 0 offen offset:0 sc1
    buffer_store_dwordx2 v[34:35], v131, s[16:19], 0 offen offset:32 sc1
    buffer_store_dwordx2 v[36:37], v131, s[16:19], 0 offen offset:64 sc1
    buffer_store_dwordx2 v[38:39], v131, s[16:19], 0 offen offset:96 sc1
L_noha:
    s_cmp_eq_u64 s[70:71], 0
    s_cbranch_scc1 L_nohb
    buffer_store_dwordx2 v[112:113], v140, s[16:19], 0 offen offset:0 sc1
    buffer_store_dwordx2 v[114:115], v140, s[16:19], 0 offen offset:32 sc1
    buffer_store_dwordx2 v[116:117], v140, s[16:19], 0 offen offset:64 sc1
    buffer_store_dwordx2 v[118:119], v140, s[16:19], 0 offen offset:96 sc1
L_nohb:
    v_mov_b32 v8, 66304
L_walk_21:
    s_cbranch_execz L_walked
    s_barrier
    ds_read_b64 v[10:11], v8
    s_barrier
    s_waitcnt lgkmcnt(0)
    v_cmp_ne_u32 s[4:5], v10, v13
    v_cmp_ne_u32 s[6:7], v11, v13
    s_nop 0
    s_and_b64 s[4:5], s[4:5], s[6:7]
    v_cndmask_b32 v8, v9, v5, s[4:5]
    v_add_u32 v7, 64, v8
    v_mov_b32 v4, v8
    s_nop 1
    v_mov_b32_dpp v4, v7 row_ror:8 row_mask:0xf bank_mask:0xc
    v_mov_b32_dpp v7, v8 row_ror:8 row_mask:0xf bank_mask:0x3
    buffer_store_dwordx4 v[104:107], v4, s[24:27], 0 offen sc1
    buffer_store_dwordx4 v[108:111], v7, s[24:27], 0 offen sc1
    v_cmp_ne_u32 s[4:5], v10, v144
    v_cmp_ne_u32 s[6:7], v11, v144
    s_nop 0
    s_and_b64 s[4:5], s[4:5], s[6:7]
    v_cndmask_b32 v8, v9, v6, s[4:5]
    v_add_u32 v7, 64, v8
    v_mov_b32 v4, v8
    s_nop 1
    v_mov_b32_dpp v4, v7 row_ror:8 row_mask:0xf bank_mask:0xc
    v_mov_b32_dpp v7, v8 row_ror:8 row_mask:0xf bank_mask:0x3
    buffer_store_dwordx4 v[120:123], v4, s[24:27], 0 offen sc1
    buffer_store_dwordx4 v[124:127], v7, s[24:27], 0 offen sc1
    s_branch L_fin
L_t3_ld:
    s_mov_b32 s90, 6144
    buffer_load_dwordx4 v[240:243], v14, s[36:39], s90 offen
    s_mov_b32 s90, 8192
    buffer_load_dwordx4 v[244:247], v14, s[36:39], s90 offen
    s_mov_b32 s90, 10240
    buffer_load_dwordx4 v[248:251], v14, s[36:39], s90 offen
    s_mov_b32 s90, 12288
    buffer_load_dwordx4 v[252:255], v14, s[36:39], s90 offen
    v_bfe_u32 v8, v0, 3, 1
    v_lshl_add_u32 v10, v1, 5, s67
    s_mov_b32 s60, 0
    s_mov_b32 s61, 0
    s_lshl_b32 s63, 1, s51
    s_mov_b32 m0, s51
    s_waitcnt lgkmcnt(0)
    v_max_u32 v98, v64, v65
    v_min_u32 v99, v64, v65
    s_nop 0
    v_min_u32_dpp v96, v98, v98 row_ror:8 row_mask:0xf bank_mask:0xf
    v_max_u32_dpp v98, v98, v98 row_ror:8 row_mask:0xf bank_mask:0xf
    v_max_u32_dpp v97, v99, v99 row_ror:8 row_mask:0xf bank_mask:0xf
    v_max_u32 v99, v96, v97
    v_min_u32_dpp v96, v98, v98 row_ror:4 row_mask:0xf bank_mask:0xf
    v_max_u32_dpp v98, v98, v98 row_ror:4 row_mask:0xf bank_mask:0xf
    v_max_u32_dpp v97, v99, v99 row_ror:4 row_mask:0xf bank_mask:0xf
    v_max_u32 v99, v96, v97
    v_min_u32_dpp v96, v98, v98 row_ror:2 row_mask:0xf bank_mask:0xf
    v_max_u32_dpp v98, v98, v98 row_ror:2 row_mask:0xf bank_mask:0xf
    v_max_u32_dpp v97, v99, v99 row_ror:2 row_mask:0xf bank_mask:0xf
    v_max_u32 v99, v96, v97
    v_min_u32_dpp v96, v98, v98 row_ror:1 row_mask:0xf bank_mask:0xf
    v_max_u32_dpp v98, v98, v98 row_ror:1 row_mask:0xf bank_mask:0xf
    v_max_u32_dpp v97, v99, v99 row_ror:1 row_mask:0xf bank_mask:0xf
    v_max_u32 v99, v96, v97
    v_readlane_b32 s58, v98, 0
    v_readlane_b32 s59, v99, 0
    v_readlane_b32 s86, v98, 16
    v_readlane_b32 s87, v99, 16
    s_nop 0
    s_max_u32 s59, s59, s87
    s_min_u32 s87, s58, s86
    s_max_u32 s58, s58, s86
    s_max_u32 s59, s59, s87
    v_readlane_b32 s86, v98, 32
    v_readlane_b32 s87, v99, 32
    s_nop 0
    s_max_u32 s59, s59, s87
    s_min_u32 s87, s58, s86
    s_max_u32 s58, s58, s86
    s_max_u32 s59, s59, s87
    v_readlane_b32 s86, v98, 48
    v_readlane_b32 s87, v99, 48
    s_nop 0
    s_max_u32 s59, s59, s87
    s_min_u32 s87, s58, s86
    s_max_u32 s58, s58, s86
    s_max_u32 s59, s59, s87
    s_waitcnt vmcnt(4)
    s_branch L_h4_chk0
L_h4_w0:
    s_waitcnt vmcnt(0)
L_h4_chk0:
    v_cmp_eq_u32 vcc, -1, v128
    s_nop 0
    s_andn2_b32 s86, vcc_lo, s63
    s_cbranch_scc0 L_h4_all0
    v_cndmask_b32 v96, v128, 0, vcc
    v_cndmask_b32 v97, v129, 0, vcc
    v_mov_b32 v128, 0
    v_mov_b32 v129, 0
    buffer_atomic_or_x2 v[128:129], v148, s[16:19], 0 offen sc0 sc1
    s_sub_u32 s56, s56, 1
    s_cbranch_scc1 L_h4_out
    v_min_u32_dpp v98, v96, v96 row_ror:8 row_mask:0xf bank_mask:0xf
    v_max_u32_dpp v96, v96, v96 row_ror:8 row_mask:0xf bank_mask:0xf
    v_max_u32_dpp v99, v97, v97 row_ror:8 row_mask:0xf bank_mask:0xf
    v_max_u32 v97, v98, v99
    v_min_u32_dpp v98, v96, v96 row_ror:4 row_mask:0xf bank_mask:0xf
    v_max_u32_dpp v96, v96, v96 row_ror:4 row_mask:0xf bank_mask:0xf
    v_max_u32_dpp v99, v97, v97 row_ror:4 row_mask:0xf bank_mask:0xf
    v_max_u32 v97, v98, v99
    v_min_u32_dpp v98, v96, v96 row_ror:2 row_mask:0xf bank_mask:0xf
    v_max_u32_dpp v96, v96, v96 row_ror:2 row_mask:0xf bank_mask:0xf
    v_max_u32_dpp v99, v97, v97 row_ror:2 row_mask:0xf bank_mask:0xf
    v_max_u32 v97, v98, v99
    v_min_u32_dpp v98, v96, v96 row_ror:1 row_mask:0xf bank_mask:0xf
    v_max_u32_dpp v96, v96, v96 row_ror:1 row_mask:0xf bank_mask:0xf
    v_max_u32_dpp v99, v97, v97 row_ror:1 row_mask:0xf bank_mask:0xf
    v_max_u32 v97, v98, v99
    v_readlane_b32 s70, v96, 0
    v_readlane_b32 s71, v97, 0
    s_nop 0
    s_cmp_eq_u64 s[70:71], s[60:61]
    s_cbranch_scc1 L_h4_w0
    s_mov_b64 s[60:61], s[70:71]
    s_bfe_u32 s86, s60, 0x40007
    s_bfe_u32 s87, s61, 0x40007
    s_sub_u32 s87, s86, s87
    s_lshl_b32 s87, s87, 12
    s_cselect_b32 s69, s87, 2048
    v_mad_i32_i24 v130, v8, s69, v10
    s_xor_b32 s86, s86, 15
    s_lshl_b32 s66, s86, 12
    buffer_load_dwordx4 v[64:67], v130, s[16:19], s66 offen sc1
    buffer_load_dwordx4 v[68:71], v130, s[16:19], s66 offen offset:16 sc1
    s_waitcnt vmcnt(2)
    s_branch L_h4_chk0
L_h4_own:
    s_waitcnt vmcnt(0)
    v_mov_b32 v128, 0
    v_mov_b32 v129, 0
    buffer_atomic_or_x2 v[128:129], v148, s[16:19], 0 offen sc0 sc1
    s_sub_u32 s56, s56, 1
    s_cbranch_scc0 L_h4_w0
L_h4_out:
    s_mov_b32 s56, 0
    s_waitcnt vmcnt(0)
    s_mov_b64 vcc, 0
L_h4_all0:
    v_writelane_b32 v128, s58, m0
    v_writelane_b32 v129, s59, m0
    s_nop 0
    v_min_u32_dpp v98, v128, v128 row_ror:8 row_mask:0xf bank_mask:0xf
    v_max_u32_dpp v96, v128, v128 row_ror:8 row_mask:0xf bank_mask:0xf
    v_max_u32_dpp v99, v129, v129 row_ror:8 row_mask:0xf bank_mask:0xf
    v_max_u32 v97, v98, v99
L_h4_all:
    v_min_u32_dpp v98, v96, v96 row_ror:4 row_mask:0xf bank_mask:0xf
    v_max_u32_dpp v96, v96, v96 row_ror:4 row_mask:0xf bank_mask:0xf
    v_max_u32_dpp v99, v97, v97 row_ror:4 row_mask:0xf bank_mask:0xf
    v_max_u32 v97, v98, v99
    v_min_u32_dpp v98, v96, v96 row_ror:2 row_mask:0xf bank_mask:0xf
    v_max_u32_dpp v96, v96, v96 row_ror:2 row_mask:0xf bank_mask:0xf
    v_max_u32_dpp v99, v97, v97 row_ror:2 row_mask:0xf bank_mask:0xf
    v_max_u32 v97, v98, v99
    v_min_u32_dpp v98, v96, v96 row_ror:1 row_mask:0xf bank_mask:0xf
    v_max_u32_dpp v96, v96, v96 row_ror:1 row_mask:0xf bank_mask:0xf
    v_max_u32_dpp v99, v97, v97 row_ror:1 row_mask:0xf bank_mask:0xf
    v_max_u32 v97, v98, v99
    v_readlane_b32 s70, v96, 0
    v_readlane_b32 s71, v97, 0
    s_nop 0
    s_cmp_ge_u32 s58, s71
    s_cselect_b32 s86, vcc_lo, 0
    s_cmp_lg_u32 s86, 0
    s_cbranch_scc1 L_h4_own
    s_cmp_eq_u64 s[70:71], s[60:61]
    s_cbranch_scc1 L_h4_go
    s_mov_b64 s[60:61], s[70:71]
    s_bfe_u32 s86, s60, 0x40007
    s_bfe_u32 s87, s61, 0x40007
    s_sub_u32 s87, s86, s87
    s_lshl_b32 s87, s87, 12
    s_cselect_b32 s69, s87, 2048
    v_mad_i32_i24 v130, v8, s69, v10
    s_xor_b32 s86, s86, 15
    s_lshl_b32 s66, s86, 12
    buffer_load_dwordx4 v[64:67], v130, s[16:19], s66 offen sc1
    buffer_load_dwordx4 v[68:71], v130, s[16:19], s66 offen offset:16 sc1
L_h4_go:
    v_mov_b32 v16, 66304
    v_mov_b32 v24, s60
    v_mov_b32 v25, s61
    ds_write_b64 v16, v[24:25]
    s_waitcnt vmcnt(0)
    s_branch L_seg_chk
L_walk_22:
    s_cbranch_execz L_walked
L_seg:
    buffer_load_dwordx4 v[64:67], v130, s[16:19], s66 offen sc1
    buffer_load_dwordx4 v[68:71], v130, s[16:19], s66 offen offset:16 sc1
    s_waitcnt vmcnt(0)
L_seg_chk:
    v_max3_u32 v16, v65, v67, v69
    v_max_u32 v16, v16, v71
    v_cmp_eq_u32 vcc, -1, v16
    s_cbranch_vccz L_ok_5
    s_sub_u32 s56, s56, 1
    s_cbranch_scc0 L_seg
    s_mov_b32 s56, 0
L_ok_5:
    v_perm_b32 v80, v64, v64, v72
    v_perm_b32 v81, v64, v64, v73
    v_perm_b32 v82, v64, v64, v74
    v_perm_b32 v83, v64, v64, v75
    v_perm_b32 v84, v64, v64, v76
    v_perm_b32 v85, v64, v64, v77
    v_perm_b32 v86, v64, v64, v78
    v_perm_b32 v87, v64, v64, v79
    v_mfma_f32_16x16x32_bf16 v[88:91], v[80:83], v[164:167], 0
    v_perm_b32 v92, v65, v65, v72
    v_perm_b32 v93, v65, v65, v73
    v_perm_b32 v94, v65, v65, v74
    v_perm_b32 v95, v65, v65, v75
    v_mfma_f32_16x16x32_bf16 v[88:91], v[84:87], v[168:171], v[88:91]
    v_perm_b32 v80, v65, v65, v76
    v_perm_b32 v81, v65, v65, v77
    v_perm_b32 v82, v65, v65, v78
    v_perm_b32 v83, v65, v65, v79
    v_mfma_f32_16x16x32_bf16 v[88:91], v[92:95], v[172:175], v[88:91]
    v_perm_b32 v84, v66, v66, v72
    v_perm_b32 v85, v66, v66, v73
    v_perm_b32 v86, v66, v66, v74
    v_perm_b32 v87, v66, v66, v75
    v_mfma_f32_16x16x32_bf16 v[88:91], v[80:83], v[176:179], v[88:91]
    v_perm_b32 v92, v66, v66, v76
    v_perm_b32 v93, v66, v66, v77
    v_perm_b32 v94, v66, v66, v78
    v_perm_b32 v95, v66, v66, v79
    v_mfma_f32_16x16x32_bf16 v[88:91], v[84:87], v[180:183], v[88:91]
    v_perm_b32 v80, v67, v67, v72
    v_perm_b32 v81, v67, v67, v73
    v_perm_b32 v82, v67, v67, v74
    v_perm_b32 v83, v67, v67, v75
    v_mfma_f32_16x16x32_bf16 v[88:91], v[92:95], v[184:187], v[88:91]
    v_perm_b32 v84, v67, v67, v76
    v_perm_b32 v85, v67, v67, v77
    v_perm_b32 v86, v67, v67, v78
    v_perm_b32 v87, v67, v67, v79
    v_mfma_f32_16x16x32_bf16 v[88:91], v[80:83], v[188:191], v[88:91]
    v_perm_b32 v92, v68, v68, v72
    v_perm_b32 v93, v68, v68, v73
    v_perm_b32 v94, v68, v68, v74
    v_perm_b32 v95, v68, v68, v75
    v_mfma_f32_16x16x32_bf16 v[88:91], v[84:87], v[192:195], v[88:91]
    v_perm_b32 v80, v68, v68, v76
    v_perm_b32 v81, v68, v68, v77
    v_perm_b32 v82, v68, v68, v78
    v_perm_b32 v83, v68, v68, v79
    v_mfma_f32_16x16x32_bf16 v[88:91], v[92:95], v[196:199], v[88:91]
    v_perm_b32 v84, v69, v69, v72
    v_perm_b32 v85, v69, v69, v73
    v_perm_b32 v86, v69, v69, v74
    v_perm_b32 v87, v69, v69, v75
    v_mfma_f32_16x16x32_bf16 v[88:91], v[80:83], v[200:203], v[88:91]
    v_perm_b32 v92, v69, v69, v76
    v_perm_b32 v93, v69, v69, v77
    v_perm_b32 v94, v69, v69, v78
    v_perm_b32 v95, v69, v69, v79
    v_mfma_f32_16x16x32_bf16 v[88:91], v[84:87], v[204:207], v[88:91]
    v_perm_b32 v80, v70, v70, v72
    v_perm_b32 v81, v70, v70, v73
    v_perm_b32 v82, v70, v70, v74
    v_perm_b32 v83, v70, v70, v75
    v_mfma_f32_16x16x32_bf16 v[88:91], v[92:95], v[208:211], v[88:91]
    v_perm_b32 v84, v70, v70, v76
    v_perm_b32 v85, v70, v70, v77
    v_perm_b32 v86, v70, v70, v78
    v_perm_b32 v87, v70, v70, v79
    v_mfma_f32_16x16x32_bf16 v[88:91], v[80:83], v[212:215], v[88:91]
    v_perm_b32 v92, v71, v71, v72
    v_perm_b32 v93, v71, v71, v73
    v_perm_b32 v94, v71, v71, v74
    v_perm_b32 v95, v71, v71, v75
    v_mfma_f32_16x16x32_bf16 v[88:91], v[84:87], v[216:219], v[88:91]
    v_perm_b32 v80, v71, v71, v76
    v_perm_b32 v81, v71, v71, v77
    v_perm_b32 v82, v71, v71, v78
    v_perm_b32 v83, v71, v71, v79
    v_mfma_f32_16x16x32_bf16 v[88:91], v[92:95], v[220:223], v[88:91]
    s_nop 0
    v_mfma_f32_16x16x32_bf16 v[88:91], v[80:83], v[224:227], v[88:91]
    s_nop 7
    ds_write_b128 v18, v[88:91]
    s_waitcnt lgkmcnt(0)
    s_barrier
    ds_read2st64_b32 v[24:25], v133 offset0:0 offset1:4
    ds_read2st64_b32 v[26:27], v133 offset0:8 offset1:12
    ds_read2st64_b32 v[28:29], v134 offset0:0 offset1:4
    ds_read2st64_b32 v[30:31], v134 offset0:8 offset1:12
    s_waitcnt lgkmcnt(2)
    v_pk_add_f32 v[24:25], v[24:25], v[26:27]
    v_add_f32 v24, v24, v25
    v_cndmask_b32 v24, v24, v135, s[4:5]
    buffer_atomic_add_f32 v24, v131, s[16:19], 0 offen sc1
    s_waitcnt lgkmcnt(0)
    v_pk_add_f32 v[28:29], v[28:29], v[30:31]
    v_add_f32 v28, v28, v29
    v_cndmask_b32 v28, v28, v136, s[4:5]
    buffer_atomic_add_f32 v28, v132, s[16:19], 0 offen sc1
    s_lshr_b32 s88, s48, 1
    s_cselect_b32 s86, s69, 0
    s_cselect_b32 s63, s61, s60
    s_and_b32 s87, s48, 1
    s_lshl1_add_u32 s87, s44, s87
    s_lshl_b32 s87, s87, 7
    s_add_u32 s86, s86, s66
    s_add_u32 s86, s86, s87
    s_add_u32 s86, s86, 6553600
    v_lshl_add_u32 v142, v0, 1, s86
    v_mov_b32 v140, 0
    v_mov_b32 v141, 0
    s_mov_b32 s65, 65536
    buffer_load_short_d16_hi v140, v142, s[16:19], 0 offen sc1
    buffer_load_short_d16_hi v141, v142, s[16:19], s65 offen sc1
    s_and_b32 s86, s63, 0x7ff
    s_sub_u32 s86, 2047, s86
    s_lshl_b32 s86, s86, 11
    s_add_u32 s86, s86, s87
    v_lshl_add_u32 v143, v0, 1, s86
    s_ashr_i32 s86, s63, 31
    s_orn2_b32 s86, 0x80000000, s86
    s_xor_b32 s63, s63, s86
    s_and_b32 s63, s63, 0xffff0000
    s_lshr_b32 s86, s48, 1
    s_and_b32 s87, s48, 1
    s_lshl_b32 s88, s86, 9
    s_lshl_b32 s89, s87, 7
    s_add_u32 s88, s88, s89
    s_add_u32 s88, s88, 94208
    v_lshrrev_b32 v17, 3, v0
    v_lshl_add_u32 v20, v17, 4, s88
    v_bfe_u32 v9, v0, 2, 1
    v_lshl_add_u32 v20, v9, 8, v20
    v_and_b32 v9, 3, v0
    v_lshl_add_u32 v20, v9, 2, v20
    s_lshl3_add_u32 s86, s86, s44
    s_lshl1_add_u32 s86, s86, s87
    s_lshl_b32 s86, s86, 11
L_walk_23:
    s_cbranch_execz L_walked
    s_add_u32 s86, s86, 917504
    v_lshl_add_u32 v9, v17, 8, s86
    v_and_b32 v17, 7, v0
    v_lshl_add_u32 v9, v17, 3, v9
    s_mov_b32 s76, 0
    s_mov_b32 s77, 0x41900000
    s_lshl_b32 s86, s48, 7
    s_add_u32 s86, s86, 100352
    v_lshl_add_u32 v11, v8, 6, s86
    v_lshl_add_u32 v11, v1, 4, v11
    v_and_b32 v16, 7, v0
    v_lshl_or_b32 v16, v16, 1, v8
    v_cmp_le_u32 vcc, 7, v16
    v_add_u32 v17, 1, v16
    s_nop 0
    v_cndmask_b32 v16, v16, v17, vcc
    v_min_u32 v16, 15, v16
    v_lshrrev_b32 v17, 5, v0
    v_lshl_add_u32 v16, v17, 4, v16
    v_bfe_u32 v17, v0, 4, 1
    v_lshl_add_u32 v16, v17, 5, v16
    v_lshl_add_u32 v10, v16, 1, s86
    v_cmp_eq_u32 vcc, 1, v8
    v_mov_b32 v16, 0x01000c0c
    v_mov_b32 v17, 0x07060c0c
    v_cndmask_b32 v21, v16, v17, vcc
    v_mov_b32 v16, 0x05040c0c
    v_mov_b32 v17, 0x03020c0c
    v_cndmask_b32 v22, v16, v17, vcc
    v_mov_b32 v144, s63
    v_mul_f32 v144, 0xbfb8aa3b, v144
    v_exp_f32 v144, v144
    s_nop 0
    v_add_f32 v144, 1.0, v144
    v_rcp_f32 v144, v144
    s_nop 0
    v_cvt_pk_bf16_f32 v144, v144, v144
    v_lshlrev_b32 v144, 16, v144
    s_mov_b32 s6, 0x80808080
    s_mov_b32 s7, 0x80808080
    v_mov_b32 v19, v9
    buffer_atomic_or_x2 v[138:139], v137, s[16:19], 0 offen sc0 sc1
    s_barrier
    s_waitcnt vmcnt(0)
    s_branch L_h5_chk
L_h5:
    s_lshr_b64 s[4:5], vcc, 7
    s_sub_u32 s4, vcc_lo, s4
    s_sub_u32 s5, vcc_hi, s5
    s_or_b64 exec, s[4:5], vcc
    v_mov_b32 v138, 0
    v_mov_b32 v139, 0
    buffer_atomic_or_x2 v[138:139], v137, s[16:19], 0 offen sc0 sc1
    s_mov_b64 exec, -1
    s_waitcnt vmcnt(0)
L_h5_chk:
    v_cmp_neq_f32 vcc, 0x42600000, v138
    v_cvt_pk_bf16_f32 v25, v138, v139
    s_and_b64 vcc, vcc, s[6:7]
    s_cbranch_vccz L_ok_6
    s_sub_u32 s56, s56, 1
    s_cbranch_scc0 L_h5
    s_mov_b32 s56, 0
L_ok_6:
    v_mov_b32_dpp v26, v25 row_ror:8 row_mask:0xf bank_mask:0xf
    v_perm_b32 v24, v26, v25, v21
    v_perm_b32 v28, v26, v25, v22
    v_mul_f32 v25, 0xbfb8aa3b, v24
    v_exp_f32 v25, v25
    s_nop 0
    v_add_f32 v25, 1.0, v25
    v_rcp_f32 v25, v25
    s_nop 0
    v_mul_f32 v24, v24, v25
    v_cvt_pk_bf16_f32 v24, v24, v24
    v_lshlrev_b32 v24, 16, v24
    v_mul_f32 v24, v24, v28
    v_cvt_pk_bf16_f32 v24, v24, v24
    ds_write_b16 v10, v24
    s_waitcnt lgkmcnt(0)
    ds_read_b128 v[64:67], v11
    s_waitcnt lgkmcnt(0)
    v_perm_b32 v80, v64, v64, v72
    v_perm_b32 v81, v64, v64, v73
    v_perm_b32 v82, v64, v64, v74
    v_perm_b32 v83, v64, v64, v75
    v_perm_b32 v84, v64, v64, v76
    v_perm_b32 v85, v64, v64, v77
    v_perm_b32 v86, v64, v64, v78
    v_perm_b32 v87, v64, v64, v79
    v_mfma_f32_16x16x32_bf16 v[88:91], v[80:83], v[228:231], 0
    v_perm_b32 v92, v65, v65, v72
    v_perm_b32 v93, v65, v65, v73
    v_perm_b32 v94, v65, v65, v74
    v_perm_b32 v95, v65, v65, v75
    v_mfma_f32_16x16x32_bf16 v[88:91], v[84:87], v[232:235], v[88:91]
    v_perm_b32 v80, v65, v65, v76
    v_perm_b32 v81, v65, v65, v77
    v_perm_b32 v82, v65, v65, v78
    v_perm_b32 v83, v65, v65, v79
    v_mfma_f32_16x16x32_bf16 v[88:91], v[92:95], v[236:239], v[88:91]
    v_perm_b32 v84, v66, v66, v72
    v_perm_b32 v85, v66, v66, v73
    v_perm_b32 v86, v66, v66, v74
    v_perm_b32 v87, v66, v66, v75
    v_mfma_f32_16x16x32_bf16 v[88:91], v[80:83], v[240:243], v[88:91]
    v_perm_b32 v92, v66, v66, v76
    v_perm_b32 v93, v66, v66, v77
    v_perm_b32 v94, v66, v66, v78
    v_perm_b32 v95, v66, v66, v79
    v_mfma_f32_16x16x32_bf16 v[88:91], v[84:87], v[244:247], v[88:91]
    v_perm_b32 v80, v67, v67, v72
    v_perm_b32 v81, v67, v67, v73
    v_perm_b32 v82, v67, v67, v74
    v_perm_b32 v83, v67, v67, v75
    v_mfma_f32_16x16x32_bf16 v[88:91], v[92:95], v[248:251], v[88:91]
    s_nop 0
    v_mfma_f32_16x16x32_bf16 v[88:91], v[80:83], v[252:255], v[88:91]
    s_nop 7
    ds_write_b128 v18, v[88:91] offset:4096
    s_waitcnt lgkmcnt(0)
    s_barrier
    ds_read2st64_b32 v[24:25], v20 offset0:0 offset1:4
    ds_read2st64_b32 v[26:27], v20 offset0:8 offset1:12
    s_waitcnt lgkmcnt(0)
    v_pk_add_f32 v[24:25], v[24:25], v[26:27]
    v_add_f32 v24, v24, v25
    v_cvt_f64_f32 v[26:27], v24
    v_add_f64 v[24:25], v[26:27], s[76:77]
    buffer_atomic_add_f64 v[24:25], v19, s[16:19], 0 offen sc0 sc1
    s_mov_b32 s77, 0xc1df0000
    v_add_f64 v[26:27], v[26:27], s[76:77]
    s_waitcnt vmcnt(1)
    v_max_u32 v16, v140, v141
    v_cmp_eq_u32 vcc, 0xffff0000, v16
    s_cbranch_vccnz L_fin_ld
L_fin_go:
    s_mov_b32 s88, 0x4c000000
    v_mov_b32 v17, 2147483648
    s_waitcnt vmcnt(0)
    v_add_f64 v[24:25], v[24:25], v[26:27]
    v_cvt_f32_f64 v24, v[24:25]
    v_cmp_lt_f32 vcc, |v24|, s88
    v_cvt_pk_bf16_f32 v24, v24, v24
    v_lshlrev_b32 v24, 16, v24
    v_mul_f32 v24, v24, v144
    v_cndmask_b32 v17, v17, v143, vcc
    v_cvt_pk_bf16_f32 v24, v24, v24
    v_lshlrev_b32 v24, 16, v24
    v_add_f32 v24, v24, v141
    v_cvt_pk_bf16_f32 v24, v24, v24
    v_lshlrev_b32 v24, 16, v24
    v_add_f32 v24, v24, v140
    v_cvt_pk_bf16_f32 v24, v24, v24
    buffer_store_short v24, v17, s[24:27], 0 offen
L_fin:
L_end:
    s_endpgm
L_b_restart:
    s_waitcnt vmcnt(0)
    v_xor_b32 v9, 0x8000, v7
    buffer_load_dwordx4 v[136:139], v7, s[8:11], 0 offen
    buffer_load_dwordx4 v[140:143], v9, s[8:11], 0 offen
    v_mov_b32 v8, s68
    s_mov_b32 s66, 0xffffaaaa
    s_mov_b32 s63, 1
    s_branch L_b_init
L_b_p0:
    v_mov_b32 v8, 0
    buffer_atomic_or v8, v159, s[16:19], 0 offen sc0 sc1
L_b_w0:
    s_waitcnt vmcnt(0)
    v_cmp_eq_u32 vcc, s68, v8
    s_nop 0
    s_lshr_b32 s65, vcc_lo, 1
    s_and_b32 s65, s65, vcc_lo
    s_andn2_b32 s65, s65, s66
    s_cbranch_scc0 L_b_q0
    s_or_b32 s66, s66, s65
    s_branch L_b_r0
L_b_q0:
    s_sub_u32 s56, s56, 1
    s_cbranch_scc0 L_b_p0
    s_mov_b32 s56, 0
    s_not_b32 s65, s66
    s_branch L_b_r0
L_b_p1:
    v_mov_b32 v8, 0
    buffer_atomic_or v8, v159, s[16:19], 0 offen sc0 sc1
    s_waitcnt vmcnt(0)
    v_cmp_eq_u32 vcc, s68, v8
    s_nop 0
    s_lshr_b32 s65, vcc_lo, 1
    s_and_b32 s65, s65, vcc_lo
    s_andn2_b32 s65, s65, s66
    s_cbranch_scc0 L_b_q1
    s_or_b32 s66, s66, s65
    s_branch L_b_r1
L_walk_24:
    s_cbranch_execz L_walked
L_b_q1:
    s_sub_u32 s56, s56, 1
    s_cbranch_scc0 L_b_p1
    s_mov_b32 s56, 0
    s_not_b32 s65, s66
    s_branch L_b_r1
L_b_p2:
    v_mov_b32 v8, 0
    buffer_atomic_or v8, v159, s[16:19], 0 offen sc0 sc1
    s_waitcnt vmcnt(0)
    v_cmp_eq_u32 vcc, s68, v8
    s_nop 0
    s_lshr_b32 s65, vcc_lo, 1
    s_and_b32 s65, s65, vcc_lo
    s_andn2_b32 s65, s65, s66
    s_cbranch_scc0 L_b_q2
    s_or_b32 s66, s66, s65
    s_branch L_b_r2
L_b_q2:
    s_sub_u32 s56, s56, 1
    s_cbranch_scc0 L_b_p2
    s_mov_b32 s56, 0
    s_not_b32 s65, s66
    s_branch L_b_r2
L_b_p3:
    v_mov_b32 v8, 0
    buffer_atomic_or v8, v159, s[16:19], 0 offen sc0 sc1
    s_waitcnt vmcnt(0)
    v_cmp_eq_u32 vcc, s68, v8
    s_nop 0
    s_lshr_b32 s65, vcc_lo, 1
    s_and_b32 s65, s65, vcc_lo
    s_andn2_b32 s65, s65, s66
    s_cbranch_scc0 L_b_q3
    s_or_b32 s66, s66, s65
    s_branch L_b_r3
L_b_q3:
    s_sub_u32 s56, s56, 1
    s_cbranch_scc0 L_b_p3
    s_mov_b32 s56, 0
    s_not_b32 s65, s66
    s_branch L_b_r3
L_b_p4:
    v_mov_b32 v8, 0
    buffer_atomic_or v8, v159, s[16:19], 0 offen sc0 sc1
    s_waitcnt vmcnt(0)
    v_cmp_eq_u32 vcc, s68, v8
    s_nop 0
    s_lshr_b32 s65, vcc_lo, 1
    s_and_b32 s65, s65, vcc_lo
    s_andn2_b32 s65, s65, s66
    s_cbranch_scc0 L_b_q4
    s_or_b32 s66, s66, s65
    s_branch L_b_r4
L_b_q4:
    s_sub_u32 s56, s56, 1
    s_cbranch_scc0 L_b_p4
    s_mov_b32 s56, 0
    s_not_b32 s65, s66
    s_branch L_b_r4
L_b_p5:
    v_mov_b32 v8, 0
    buffer_atomic_or v8, v159, s[16:19], 0 offen sc0 sc1
    s_waitcnt vmcnt(0)
    v_cmp_eq_u32 vcc, s68, v8
    s_nop 0
    s_lshr_b32 s65, vcc_lo, 1
    s_and_b32 s65, s65, vcc_lo
    s_andn2_b32 s65, s65, s66
    s_cbranch_scc0 L_b_q5
    s_or_b32 s66, s66, s65
    s_branch L_b_r5
L_b_q5:
    s_sub_u32 s56, s56, 1
    s_cbranch_scc0 L_b_p5
    s_mov_b32 s56, 0
    s_not_b32 s65, s66
    s_branch L_b_r5
L_b_p6:
    v_mov_b32 v8, 0
    buffer_atomic_or v8, v159, s[16:19], 0 offen sc0 sc1
    s_waitcnt vmcnt(0)
    v_cmp_eq_u32 vcc, s68, v8
    s_nop 0
    s_lshr_b32 s65, vcc_lo, 1
    s_and_b32 s65, s65, vcc_lo
    s_andn2_b32 s65, s65, s66
    s_cbranch_scc0 L_b_q6
    s_or_b32 s66, s66, s65
    s_branch L_b_r6
L_b_q6:
    s_sub_u32 s56, s56, 1
    s_cbranch_scc0 L_b_p6
    s_mov_b32 s56, 0
    s_not_b32 s65, s66
    s_branch L_b_r6
L_b_p7:
    v_mov_b32 v8, 0
    buffer_atomic_or v8, v159, s[16:19], 0 offen sc0 sc1
    s_waitcnt vmcnt(0)
    v_cmp_eq_u32 vcc, s68, v8
    s_nop 0
    s_lshr_b32 s65, vcc_lo, 1
    s_and_b32 s65, s65, vcc_lo
    s_andn2_b32 s65, s65, s66
    s_cbranch_scc0 L_b_q7
    s_or_b32 s66, s66, s65
    s_branch L_b_r7
L_b_q7:
    s_sub_u32 s56, s56, 1
    s_cbranch_scc0 L_b_p7
    s_mov_b32 s56, 0
    s_not_b32 s65, s66
    s_branch L_b_r7
L_fin_ld:
    buffer_load_short_d16_hi v140, v142, s[16:19], 0 offen sc1
    buffer_load_short_d16_hi v141, v142, s[16:19], s65 offen sc1
    s_waitcnt vmcnt(0)
    v_max_u32 v16, v140, v141
    v_cmp_eq_u32 vcc, 0xffff0000, v16
    s_cbranch_vccz L_fin_go
    s_sub_u32 s56, s56, 1
    s_cbranch_scc0 L_fin_ld
    s_branch L_fin_go
L_last:
    s_endpgm
.section .rodata,"a"
.p2align 6
.amdhsa_kernel sequential_preLN__linear_attn_block__moe_arch_mod__prompt_kernel
  .amdhsa_next_free_vgpr 256
  .amdhsa_next_free_sgpr 102
  .amdhsa_accum_offset 256
  .amdhsa_group_segment_fixed_size 0
  .amdhsa_kernarg_size 88
  .amdhsa_user_sgpr_count 2
  .amdhsa_user_sgpr_kernarg_segment_ptr 1
  .amdhsa_system_sgpr_workgroup_id_x 1
.end_amdhsa_kernel
```

```asm
; @launch grid=(256,1,1) block=(512,1,1) lds=163840
.amdgcn_target "amdgcn-amd-amdhsa--gfx950"
.text
.globl sequential_preLN__linear_attn_block__moe_arch_mod__prompt_kernel
.p2align 8
.type sequential_preLN__linear_attn_block__moe_arch_mod__prompt_kernel,@function
sequential_preLN__linear_attn_block__moe_arch_mod__prompt_kernel:
    s_cmp_ge_u32 s2, 256
    s_cbranch_scc1 L_end
    s_load_dwordx16 s[64:79], s[0:1], 0
    s_load_dwordx4 s[80:83], s[0:1], 64
    s_load_dwordx2 s[84:85], s[0:1], 80
    v_lshrrev_b32 v1, 6, v0
    v_and_b32 v0, 63, v0
    v_readfirstlane_b32 s3, v1
    s_and_b32 s44, s2, 7
    s_lshr_b32 s45, s2, 3
    s_and_b32 s46, s44, 1
    s_lshl_b32 s46, s46, 3
    s_and_b32 s86, s45, 7
    s_add_u32 s46, s46, s86
    s_lshr_b32 s47, s44, 1
    s_lshl_b32 s47, s47, 2
    s_lshr_b32 s86, s45, 3
    s_add_u32 s47, s47, s86
    s_mov_b32 s51, s47
    s_mov_b32 s52, s46
    s_and_b32 s48, s3, 3
    s_and_b32 s49, s3, 1
    s_bfe_u32 s50, s3, 0x10001
    s_mov_b32 s56, 65536
    s_mov_b32 s95, 0x3f803f80
    s_movk_i32 s92, 0x1000
    s_movk_i32 s93, 0x2000
    s_movk_i32 s94, 0x3000
    s_cmp_lt_u32 s3, 4
    s_cbranch_scc1 L_comp0
    v_lshrrev_b32 v20, 3, v0
    v_and_b32 v21, 7, v0
    v_lshrrev_b32 v22, 4, v0
    v_xor_b32 v23, v21, v22
    v_xor_b32 v24, 4, v23
    s_lshl_b32 s86, s48, 5
    v_add_u32 v25, s86, v20
    v_lshlrev_b32 v25, 11, v25
    v_lshl_add_u32 v2, v23, 4, v25
    v_lshl_add_u32 v3, v24, 4, v25
    v_add_u32 v3, 15360, v3
    v_lshl_add_u32 v4, v23, 4, v25
    v_add_u32 v4, 30720, v4
    v_lshl_add_u32 v5, v24, 4, v25
    v_add_u32 v5, 46080, v5
    s_lshl_b32 s86, s48, 4
    v_add_u32 v25, s86, v20
    v_mul_u32_u24 v25, 6144, v25
    s_lshl_b32 s86, s47, 7
    v_add_u32 v25, s86, v25
    v_bfe_u32 v26, v0, 4, 1
    v_lshlrev_b32 v26, 1, v26
    v_xor_b32 v26, v26, v21
    v_xor_b32 v27, 4, v26
    v_lshl_add_u32 v6, v26, 4, v25
    v_lshl_add_u32 v7, v27, 4, v25
    v_add_u32 v7, 48128, v7
    v_lshl_add_u32 v8, v26, 4, v25
    v_add_u32 v8, 2048, v8
    v_lshl_add_u32 v9, v27, 4, v25
    v_add_u32 v9, 50176, v9
    v_lshl_add_u32 v10, v26, 4, v25
    v_add_u32 v10, 4096, v10
    v_lshl_add_u32 v11, v27, 4, v25
    v_add_u32 v11, 52224, v11
    s_lshl_b32 s63, s46, 18
    s_lshl_b32 s53, s48, 12
    s_lshl_b32 s62, s48, 11
    s_add_u32 s62, s62, 16384
    s_setprio 1
    s_lshl_b32 s86, s45, 2
    s_add_u32 s86, s86, s48
    s_mul_i32 s87, s86, 12288
    s_and_b32 s88, s47, 12
    s_lshl_b32 s88, s88, 7
    s_add_u32 s87, s87, s88
    s_add_u32 s87, s87, 384
    s_bitcmp1_b32 s47, 2
    s_cselect_b32 s87, 2147483648, s87
    v_lshl_add_u32 v37, v0, 11, s87
    v_mov_b32 v24, 2147483648
    v_cmp_gt_u32 vcc, 6, v0
    s_nop 1
    v_cndmask_b32 v37, v24, v37, vcc
    s_lshl_b32 s86, s86, 14
    s_and_b32 s88, s46, 8
    s_lshl_b32 s88, s88, 7
    s_add_u32 s86, s86, s88
    s_add_u32 s86, s86, 384
    v_lshl_add_u32 v38, v0, 11, s86
    v_cmp_gt_u32 vcc, 8, v0
    s_nop 1
    v_cndmask_b32 v38, v24, v38, vcc
    s_waitcnt lgkmcnt(0)
    s_mov_b32 s8, s64
    s_and_b32 s9, s65, 0xffff
    s_mov_b32 s10, 4194304
    s_mov_b32 s11, 0x20000
    s_mov_b32 s12, s66
    s_and_b32 s13, s67, 0xffff
    s_mov_b32 s14, 6291456
    s_mov_b32 s15, 0x20000
    s_and_b32 s86, s47, 12
    s_and_b32 s87, s46, 8
    s_add_u32 s64, s86, s87
    s_and_b32 s64, s64, 15
    s_mov_b32 s67, s64
    s_load_dword s61, s[84:85], 524288
    s_lshr_b32 s90, s67, 2
    s_mul_i32 s90, s90, 1572864
    buffer_load_dword v39, v37, s[12:15], s90 offen
    s_add_u32 m0, s53, 40960
    s_lshl_b32 s70, s64, 7
    s_add_u32 s70, s70, s63
    buffer_load_dwordx4 v2, s[8:11], s70 offen offset:0 lds
    buffer_load_dwordx4 v3, s[8:11], s70 offen offset:1024 lds
    buffer_load_dwordx4 v4, s[8:11], s70 offen offset:2048 lds
    buffer_load_dwordx4 v5, s[8:11], s70 offen offset:3072 lds
    s_mul_i32 s91, s64, 393216
    s_add_u32 s64, s64, 1
    s_and_b32 s64, s64, 15
    s_add_u32 m0, s62, 40960
    s_nop 0
    buffer_load_dwordx4 v6, s[12:15], s91 offen offset:0 lds
    buffer_load_dwordx4 v7, s[12:15], s91 offen offset:1024 lds
    s_add_u32 m0, s62, 49152
    s_nop 0
    buffer_load_dwordx4 v8, s[12:15], s91 offen offset:0 lds
    buffer_load_dwordx4 v9, s[12:15], s91 offen offset:1024 lds
    s_add_u32 m0, s62, 57344
    s_nop 0
    buffer_load_dwordx4 v10, s[12:15], s91 offen offset:0 lds
    buffer_load_dwordx4 v11, s[12:15], s91 offen offset:1024 lds
    s_branch L_ld1
L_comp0:
    s_lshl2_add_u32 s86, s45, s3
    s_cmp_ge_u32 s86, 4
    s_cbranch_scc1 L_noipf
    s_getpc_b64 s[4:5]
L_ipf:
    s_sub_u32 s4, s4, L_ipf-sequential_preLN__linear_attn_block__moe_arch_mod__prompt_kernel
    s_subb_u32 s5, s5, 0
    s_lshl_b32 s86, s86, 13
    v_lshl_add_u32 v31, v0, 7, s86
    v_min_u32 v31, L_last-sequential_preLN__linear_attn_block__moe_arch_mod__prompt_kernel, v31
    global_load_dword v30, v31, s[4:5]
L_noipf:
    s_cmp_eq_u32 s3, 3
    s_cbranch_scc1 L_comp
    s_mov_b64 exec, 0
    s_cmp_eq_u32 s3, 2
    s_cbranch_scc1 L_walkA2
    s_cmp_eq_u32 s3, 1
    s_cbranch_scc1 L_walkA1
    s_branch L_walkA0
L_ld1:
    s_mov_b32 s16, s84
    s_and_b32 s17, s85, 0xffff
    s_mov_b32 s18, 268435456
    s_mov_b32 s19, 0x20000
    s_mov_b32 s20, s68
    s_and_b32 s21, s69, 0xffff
    s_mov_b32 s22, 2097152
    s_mov_b32 s23, 0x20000
    s_mov_b32 s24, s80
    s_and_b32 s25, s81, 0xffff
    s_mov_b32 s26, 4194304
    s_mov_b32 s27, 0x20000
    s_mov_b32 s28, s82
    s_and_b32 s29, s83, 0xffff
    s_mov_b32 s30, 256
    s_mov_b32 s31, 0x20000
    s_bitcmp1_b32 s2, 0
    s_cselect_b32 s32, s76, s74
    s_cselect_b32 s33, s77, s75
    s_and_b32 s33, s33, 0xffff
    s_mov_b32 s34, 7340032
    s_mov_b32 s35, 0x20000
    s_mov_b32 s36, s78
    s_and_b32 s37, s79, 0xffff
    s_mov_b32 s38, 7340032
    s_mov_b32 s39, 0x20000
    s_mov_b32 s40, s72
    s_and_b32 s41, s73, 0xffff
    s_mov_b32 s42, 2048
    s_mov_b32 s43, 0x20000
    v_lshrrev_b32 v22, 4, v0
    v_and_b32 v23, 15, v0
    s_lshl_b32 s86, s45, 2
    s_add_u32 s86, s86, s48
    s_mul_i32 s87, s86, 6
    v_mul_u32_u24 v24, 43, v0
L_walkA0:
    s_cbranch_execz L_comp
    v_lshrrev_b32 v24, 8, v24
    v_mul_u32_u24 v25, 6, v24
    v_sub_u32 v25, v0, v25
    v_add_u32 v25, s87, v25
    s_add_u32 s87, s67, 2
    v_add_u32 v24, s87, v24
    v_and_b32 v24, 15, v24
    v_mul_u32_u24 v124, 393216, v24
    v_lshrrev_b32 v24, 2, v25
    v_lshl_add_u32 v124, v24, 11, v124
    v_and_b32 v25, 3, v25
    s_and_b32 s88, s47, 12
    v_add_u32 v25, s88, v25
    v_lshl_add_u32 v124, v25, 7, v124
    v_mov_b32 v24, 2147483648
    v_cmp_gt_u32 vcc, 36, v0
    s_nop 1
    v_cndmask_b32 v124, v24, v124, vcc
    v_add_u32 v24, s87, v20
    v_and_b32 v24, 15, v24
    s_and_b32 s88, s46, 8
    s_lshl4_add_u32 s86, s88, s86
    s_lshl_b32 s86, s86, 14
    v_lshl_add_u32 v123, v21, 11, s86
    v_mov_b32 v125, v123
    v_lshl_add_u32 v123, v24, 7, v123
    v_mov_b32 v24, 2147483648
    v_cmp_gt_u32 vcc, 16, v0
    s_nop 1
    v_cndmask_b32 v123, v24, v123, vcc
    s_add_u32 m0, s53, 81920
    s_lshl_b32 s70, s64, 7
    s_add_u32 s70, s70, s63
    buffer_load_dwordx4 v2, s[8:11], s70 offen offset:0 lds
    buffer_load_dwordx4 v3, s[8:11], s70 offen offset:1024 lds
    buffer_load_dwordx4 v4, s[8:11], s70 offen offset:2048 lds
    buffer_load_dwordx4 v5, s[8:11], s70 offen offset:3072 lds
    s_mul_i32 s91, s64, 393216
    s_add_u32 s64, s64, 1
    s_and_b32 s64, s64, 15
    s_add_u32 m0, s62, 81920
    s_nop 0
    buffer_load_dwordx4 v6, s[12:15], s91 offen offset:0 lds
    buffer_load_dwordx4 v7, s[12:15], s91 offen offset:1024 lds
    s_add_u32 m0, s62, 90112
    s_nop 0
    buffer_load_dwordx4 v8, s[12:15], s91 offen offset:0 lds
    buffer_load_dwordx4 v9, s[12:15], s91 offen offset:1024 lds
    s_add_u32 m0, s62, 98304
    s_nop 0
    buffer_load_dwordx4 v10, s[12:15], s91 offen offset:0 lds
    buffer_load_dwordx4 v11, s[12:15], s91 offen offset:1024 lds
    buffer_load_dword v122, v123, s[8:11], 0 offen
    buffer_load_dword v122, v124, s[12:15], 0 offen
    s_and_b32 s65, s45, 7
    s_lshr_b32 s66, s45, 3
    s_add_u32 s86, s65, 1
    s_and_b32 s86, s86, 3
    s_mul_i32 s86, s86, 40960
    s_lshl_b32 s87, s48, 13
    s_cmp_eq_u32 s48, 3
    s_cselect_b32 s87, 0, s87
    s_add_u32 s86, s86, s87
    s_add_u32 s86, s86, 16384
    v_lshl_add_u32 v25, v20, 7, s86
    v_lshl_add_u32 v28, v26, 4, v25
    v_lshl_add_u32 v29, v27, 4, v25
    s_add_u32 s86, s66, 1
    s_and_b32 s86, s86, 3
    s_mul_i32 s86, s86, 40960
    s_add_u32 s86, s86, s53
    v_lshl_add_u32 v16, v0, 6, s86
    v_bfe_u32 v25, v0, 2, 2
    v_lshl_add_u32 v16, v25, 4, v16
    v_xor_b32 v17, 16, v16
    v_xor_b32 v18, 32, v16
    v_xor_b32 v19, 48, v16
    s_lshl_b32 s86, s46, 14
    s_lshl_b32 s87, s48, 8
    s_add_u32 s86, s86, s87
    s_add_u32 s86, s86, 262144
    v_lshl_add_u32 v33, v23, 4, s86
    v_lshl_add_u32 v33, v22, 10, v33
    s_lshl_b32 s87, s47, 10
    s_add_u32 s86, s86, s87
    v_lshl_add_u32 v13, v0, 2, s86
    v_and_b32 v25, 3, v0
    v_cmp_eq_u32 vcc, 0, v25
    v_mov_b32 v24, 2147483648
    s_nop 0
    v_cndmask_b32 v13, v24, v13, vcc
    s_mul_i32 s86, s47, 12288
    s_add_u32 s86, s86, 65536
    s_lshl_b32 s87, s48, 8
    s_cmp_eq_u32 s48, 3
    s_cselect_b32 s87, 2147483648, s87
    s_mov_b32 s88, 0
    s_add_u32 s86, s86, s87
    v_lshl_add_u32 v32, v23, 4, s86
    v_mul_u32_u24 v25, 768, v22
    v_add_u32 v32, v32, v25
    s_mul_i32 s87, s46, 768
    s_add_u32 s86, s86, s87
    s_add_u32 s86, s86, s88
    v_lshl_add_u32 v34, v23, 5, s86
    v_lshl_add_u32 v34, v22, 4, v34
    v_and_b32 v25, 0x28, v0
    v_cmp_eq_u32 vcc, 0, v25
    s_nop 1
    v_cndmask_b32 v34, v24, v34, vcc
    s_bfe_u32 s86, s2, 0x20001
    s_lshl_b32 s86, s86, 2
    s_add_u32 s86, s86, s48
    s_lshl_b32 s86, s86, 6
    v_lshl_add_u32 v30, v22, 4, s86
    v_mul_u32_u24 v30, 7168, v30
    s_lshl_b32 s86, s45, 1
    s_sub_u32 s86, s86, 14
    s_mul_i32 s87, s86, 37
    s_lshr_b32 s87, s87, 8
    s_add_u32 s80, s86, s87
    s_and_b32 s87, s80, 7
    s_cmp_ge_u32 s87, 3
    s_addc_u32 s80, s80, 0
    s_lshl_b32 s86, s45, 1
    s_sub_u32 s86, s86, 13
    s_mul_i32 s87, s86, 37
    s_lshr_b32 s87, s87, 8
    s_add_u32 s81, s86, s87
    s_and_b32 s87, s81, 7
    s_cmp_ge_u32 s87, 3
    s_addc_u32 s81, s81, 0
    s_lshl_b32 s86, s45, 3
    s_add_u32 s86, s86, 3
    s_cmp_lt_u32 s45, 7
    s_cselect_b32 s80, s86, s80
    s_cselect_b32 s81, 56, s81
    v_mov_b32 v24, s80
    v_mov_b32 v25, s81
    s_mov_b32 vcc_lo, 4278255360
    s_mov_b32 vcc_hi, vcc_lo
    v_cndmask_b32 v24, v24, v25, vcc
    v_cmp_gt_u32 vcc, 56, v24
    v_and_b32 v25, 7, v0
    v_lshlrev_b32 v24, 7, v24
    v_lshl_add_u32 v24, v25, 4, v24
    v_add_u32 v30, v30, v24
    v_mov_b32 v24, 2147483648
    v_cndmask_b32 v30, v24, v30, vcc
    s_mul_i32 s86, s45, 112
    s_mul_i32 s87, s48, 28
    s_add_u32 s86, s86, s87
    v_mul_u32_u24 v31, 7, v22
    v_add_u32 v31, s86, v31
    v_lshlrev_b32 v31, 11, v31
    s_lshl_b32 s86, s44, 8
    v_lshl_add_u32 v24, v23, 4, s86
    v_add_u32 v31, v31, v24
    v_lshlrev_b32 v24, 1, v22
    v_xor_b32 v24, v24, v21
    s_lshl_b32 s86, s48, 3
    v_add_u32 v12, s86, v20
    v_lshlrev_b32 v12, 11, v12
    s_lshl_b32 s86, s52, 7
    v_lshl_add_u32 v24, v24, 4, s86
    v_add_u32 v12, v12, v24
    s_lshl_b32 s89, s48, 10
    v_and_b32 v24, 1, v0
    v_lshlrev_b32 v24, 4, v24
    v_mov_b32 v25, 0x3f80
    v_lshlrev_b32 v24, v24, v25
    v_bfe_u32 v25, v0, 1, 2
    v_cmp_eq_u32 vcc, 0, v25
    s_nop 1
    v_cndmask_b32 v104, 0, v24, vcc
    v_cmp_eq_u32 vcc, 1, v25
    s_nop 1
    v_cndmask_b32 v105, 0, v24, vcc
    v_cmp_eq_u32 vcc, 2, v25
    s_nop 1
    v_cndmask_b32 v106, 0, v24, vcc
    v_cmp_eq_u32 vcc, 3, v25
    s_nop 1
    v_cndmask_b32 v107, 0, v24, vcc
    s_waitcnt lgkmcnt(0)
    s_add_u32 s68, s61, 0x9e3779b9
    v_mov_b32 v35, s68
    s_lshl_b32 s86, s46, 2
    s_add_u32 s86, s86, s48
    s_lshl_b32 s86, s86, 7
    s_add_u32 s86, s86, 655360
    s_lshl_b32 s87, s47, 2
    s_add_u32 s87, s87, s48
    s_lshl_b32 s87, s87, 7
    s_add_u32 s87, s87, 663552
    s_cmp_eq_u32 s48, 3
    s_cselect_b32 s87, 2147483648, s87
    s_cselect_b32 s76, 0xffff, -1
    s_mov_b32 s77, 0
    v_mov_b32 v24, s86
    v_mov_b32 v25, s87
    v_cmp_gt_u32 vcc, 16, v0
    s_nop 1
    v_cndmask_b32 v117, v25, v24, vcc
    v_lshl_add_u32 v117, v23, 2, v117
    v_mov_b32 v116, 2147483648
    v_cmp_gt_u32 vcc, 32, v0
    s_nop 1
    v_cndmask_b32 v117, v116, v117, vcc
    s_lshl2_add_u32 s86, s47, s86
    s_lshl2_add_u32 s87, s46, s87
    v_writelane_b32 v116, s86, 0
    v_writelane_b32 v116, s87, 1
L_walkA1:
    s_cbranch_execz L_comp
    s_waitcnt vmcnt(12)
    s_barrier
    s_add_u32 m0, s53, 122880
    s_lshl_b32 s70, s64, 7
    s_add_u32 s70, s70, s63
    buffer_load_dwordx4 v2, s[8:11], s70 offen offset:0 lds
    buffer_load_dwordx4 v3, s[8:11], s70 offen offset:1024 lds
    buffer_load_dwordx4 v4, s[8:11], s70 offen offset:2048 lds
    buffer_load_dwordx4 v5, s[8:11], s70 offen offset:3072 lds
    s_mul_i32 s91, s64, 393216
    s_add_u32 s64, s64, 1
    s_and_b32 s64, s64, 15
    s_add_u32 m0, s62, 122880
    s_nop 0
    buffer_load_dwordx4 v6, s[12:15], s91 offen offset:0 lds
    buffer_load_dwordx4 v7, s[12:15], s91 offen offset:1024 lds
    s_add_u32 m0, s62, 131072
    s_nop 0
    buffer_load_dwordx4 v8, s[12:15], s91 offen offset:0 lds
    buffer_load_dwordx4 v9, s[12:15], s91 offen offset:1024 lds
    s_add_u32 m0, s62, 139264
    s_nop 0
    buffer_load_dwordx4 v10, s[12:15], s91 offen offset:0 lds
    buffer_load_dwordx4 v11, s[12:15], s91 offen offset:1024 lds
    s_add_u32 s87, s67, 4
    v_add_u32 v24, s87, v20
    v_and_b32 v24, 15, v24
    v_lshl_add_u32 v123, v24, 7, v125
    v_mov_b32 v24, 2147483648
    v_cmp_gt_u32 vcc, 32, v0
    s_nop 1
    v_cndmask_b32 v123, v24, v123, vcc
    buffer_load_dword v122, v123, s[8:11], 0 offen
    s_cmp_lg_u32 s65, 0
    s_cbranch_scc1 L_h0c0
    ds_read_b128 v[40:43], v28 offset:0
    ds_read_b128 v[44:47], v29 offset:1024
    ds_read_b128 v[48:51], v28 offset:2048
    ds_read_b128 v[52:55], v29 offset:3072
    ds_read_b128 v[56:59], v28 offset:4096
    ds_read_b128 v[60:63], v29 offset:5120
    ds_read_b128 v[64:67], v28 offset:6144
    ds_read_b128 v[68:71], v29 offset:7168
L_h0c0:
    s_cmp_lg_u32 s66, 0
    s_cbranch_scc1 L_h0r0
    ds_read_b128 v[72:75], v16
    ds_read_b128 v[76:79], v17
    ds_read_b128 v[80:83], v18
    ds_read_b128 v[84:87], v19
L_h0r0:
    s_waitcnt lgkmcnt(0)
    s_waitcnt vmcnt(13)
    s_barrier
    s_add_u32 m0, s53, 0
    s_lshl_b32 s70, s64, 7
    s_add_u32 s70, s70, s63
    buffer_load_dwordx4 v2, s[8:11], s70 offen offset:0 lds
    buffer_load_dwordx4 v3, s[8:11], s70 offen offset:1024 lds
    buffer_load_dwordx4 v4, s[8:11], s70 offen offset:2048 lds
    buffer_load_dwordx4 v5, s[8:11], s70 offen offset:3072 lds
    s_mul_i32 s91, s64, 393216
    s_add_u32 s64, s64, 1
    s_and_b32 s64, s64, 15
    s_add_u32 m0, s62, 0
    s_nop 0
    buffer_load_dwordx4 v6, s[12:15], s91 offen offset:0 lds
    buffer_load_dwordx4 v7, s[12:15], s91 offen offset:1024 lds
    s_add_u32 m0, s62, 8192
    s_nop 0
    buffer_load_dwordx4 v8, s[12:15], s91 offen offset:0 lds
    buffer_load_dwordx4 v9, s[12:15], s91 offen offset:1024 lds
    s_add_u32 m0, s62, 16384
    s_nop 0
    buffer_load_dwordx4 v10, s[12:15], s91 offen offset:0 lds
    buffer_load_dwordx4 v11, s[12:15], s91 offen offset:1024 lds
    s_cmp_lg_u32 s65, 1
    s_cbranch_scc1 L_h0c1
    ds_read_b128 v[40:43], v28 offset:0
    ds_read_b128 v[44:47], v29 offset:1024
    ds_read_b128 v[48:51], v28 offset:2048
    ds_read_b128 v[52:55], v29 offset:3072
    ds_read_b128 v[56:59], v28 offset:4096
    ds_read_b128 v[60:63], v29 offset:5120
    ds_read_b128 v[64:67], v28 offset:6144
    ds_read_b128 v[68:71], v29 offset:7168
L_h0c1:
    s_cmp_lg_u32 s66, 1
    s_cbranch_scc1 L_h0r1
    ds_read_b128 v[72:75], v16
    ds_read_b128 v[76:79], v17
    ds_read_b128 v[80:83], v18
    ds_read_b128 v[84:87], v19
L_h0r1:
    s_waitcnt lgkmcnt(0)
    s_waitcnt vmcnt(11)
    s_barrier
    s_add_u32 m0, s53, 40960
    s_lshl_b32 s70, s64, 7
    s_add_u32 s70, s70, s63
    buffer_load_dwordx4 v2, s[8:11], s70 offen offset:0 lds
    buffer_load_dwordx4 v3, s[8:11], s70 offen offset:1024 lds
    buffer_load_dwordx4 v4, s[8:11], s70 offen offset:2048 lds
    buffer_load_dwordx4 v5, s[8:11], s70 offen offset:3072 lds
    s_mul_i32 s91, s64, 393216
    s_add_u32 s64, s64, 1
    s_and_b32 s64, s64, 15
    s_add_u32 m0, s62, 40960
    s_nop 0
    buffer_load_dwordx4 v6, s[12:15], s91 offen offset:0 lds
    buffer_load_dwordx4 v7, s[12:15], s91 offen offset:1024 lds
    s_add_u32 m0, s62, 49152
    s_nop 0
    buffer_load_dwordx4 v8, s[12:15], s91 offen offset:0 lds
    buffer_load_dwordx4 v9, s[12:15], s91 offen offset:1024 lds
    s_add_u32 m0, s62, 57344
    s_nop 0
    buffer_load_dwordx4 v10, s[12:15], s91 offen offset:0 lds
    buffer_load_dwordx4 v11, s[12:15], s91 offen offset:1024 lds
    s_cmp_lg_u32 s65, 2
    s_cbranch_scc1 L_h0c2
    ds_read_b128 v[40:43], v28 offset:0
    ds_read_b128 v[44:47], v29 offset:1024
    ds_read_b128 v[48:51], v28 offset:2048
    ds_read_b128 v[52:55], v29 offset:3072
    ds_read_b128 v[56:59], v28 offset:4096
    ds_read_b128 v[60:63], v29 offset:5120
    ds_read_b128 v[64:67], v28 offset:6144
    ds_read_b128 v[68:71], v29 offset:7168
L_h0c2:
    s_cmp_lg_u32 s66, 2
    s_cbranch_scc1 L_h0r2
    ds_read_b128 v[72:75], v16
    ds_read_b128 v[76:79], v17
    ds_read_b128 v[80:83], v18
    ds_read_b128 v[84:87], v19
L_h0r2:
    s_waitcnt lgkmcnt(0)
    s_waitcnt vmcnt(10)
    s_barrier
    s_add_u32 m0, s53, 81920
    s_lshl_b32 s70, s64, 7
    s_add_u32 s70, s70, s63
    buffer_load_dwordx4 v2, s[8:11], s70 offen offset:0 lds
    buffer_load_dwordx4 v3, s[8:11], s70 offen offset:1024 lds
    buffer_load_dwordx4 v4, s[8:11], s70 offen offset:2048 lds
    buffer_load_dwordx4 v5, s[8:11], s70 offen offset:3072 lds
    s_mul_i32 s91, s64, 393216
    s_add_u32 s64, s64, 1
    s_and_b32 s64, s64, 15
    s_add_u32 m0, s62, 81920
    s_nop 0
    buffer_load_dwordx4 v6, s[12:15], s91 offen offset:0 lds
    buffer_load_dwordx4 v7, s[12:15], s91 offen offset:1024 lds
    s_add_u32 m0, s62, 90112
    s_nop 0
    buffer_load_dwordx4 v8, s[12:15], s91 offen offset:0 lds
    buffer_load_dwordx4 v9, s[12:15], s91 offen offset:1024 lds
    s_add_u32 m0, s62, 98304
    s_nop 0
    buffer_load_dwordx4 v10, s[12:15], s91 offen offset:0 lds
    buffer_load_dwordx4 v11, s[12:15], s91 offen offset:1024 lds
    s_lshr_b32 s90, s67, 2
    s_add_u32 s90, s90, 2
    s_and_b32 s90, s90, 3
    s_mul_i32 s90, s90, 1572864
    buffer_load_dword v39, v37, s[12:15], s90 offen
    s_cmp_lg_u32 s65, 3
    s_cbranch_scc1 L_h0c3
    ds_read_b128 v[40:43], v28 offset:0
L_walkB0:
    s_cbranch_execz L_walk_4
    ds_read_b128 v[44:47], v29 offset:1024
    ds_read_b128 v[48:51], v28 offset:2048
    ds_read_b128 v[52:55], v29 offset:3072
    ds_read_b128 v[56:59], v28 offset:4096
    ds_read_b128 v[60:63], v29 offset:5120
    ds_read_b128 v[64:67], v28 offset:6144
    ds_read_b128 v[68:71], v29 offset:7168
L_h0c3:
    s_cmp_lg_u32 s66, 3
    s_cbranch_scc1 L_h0r3
    ds_read_b128 v[72:75], v16
    ds_read_b128 v[76:79], v17
    ds_read_b128 v[80:83], v18
    ds_read_b128 v[84:87], v19
L_h0r3:
    s_waitcnt lgkmcnt(0)
    s_waitcnt vmcnt(11)
    s_barrier
    s_add_u32 m0, s53, 122880
    s_lshl_b32 s70, s64, 7
    s_add_u32 s70, s70, s63
    buffer_load_dwordx4 v2, s[8:11], s70 offen offset:0 lds
    buffer_load_dwordx4 v3, s[8:11], s70 offen offset:1024 lds
    buffer_load_dwordx4 v4, s[8:11], s70 offen offset:2048 lds
    buffer_load_dwordx4 v5, s[8:11], s70 offen offset:3072 lds
    s_mul_i32 s91, s64, 393216
    s_add_u32 s64, s64, 1
    s_and_b32 s64, s64, 15
    s_add_u32 m0, s62, 122880
    s_nop 0
    buffer_load_dwordx4 v6, s[12:15], s91 offen offset:0 lds
    buffer_load_dwordx4 v7, s[12:15], s91 offen offset:1024 lds
    s_add_u32 m0, s62, 131072
    s_nop 0
    buffer_load_dwordx4 v8, s[12:15], s91 offen offset:0 lds
    buffer_load_dwordx4 v9, s[12:15], s91 offen offset:1024 lds
    s_add_u32 m0, s62, 139264
    s_nop 0
    buffer_load_dwordx4 v10, s[12:15], s91 offen offset:0 lds
    buffer_load_dwordx4 v11, s[12:15], s91 offen offset:1024 lds
    s_cmp_lg_u32 s65, 4
    s_cbranch_scc1 L_h0c4
    ds_read_b128 v[40:43], v28 offset:0
    ds_read_b128 v[44:47], v29 offset:1024
    ds_read_b128 v[48:51], v28 offset:2048
    ds_read_b128 v[52:55], v29 offset:3072
    ds_read_b128 v[56:59], v28 offset:4096
    ds_read_b128 v[60:63], v29 offset:5120
    ds_read_b128 v[64:67], v28 offset:6144
    ds_read_b128 v[68:71], v29 offset:7168
L_h0c4:
    s_waitcnt lgkmcnt(0)
    v_mov_b32 v88, 0
    v_mov_b32 v89, 0
    v_mov_b32 v90, 0
    v_mov_b32 v91, 0
    v_mov_b32 v92, 0
    v_mov_b32 v93, 0
    v_mov_b32 v94, 0
    v_mov_b32 v95, 0
    v_dot2c_f32_bf16 v88, s95, v72
    v_dot2c_f32_bf16 v89, s95, v73
    v_dot2c_f32_bf16 v90, s95, v74
    v_dot2c_f32_bf16 v91, s95, v75
    v_dot2c_f32_bf16 v92, v72, v72
    v_dot2c_f32_bf16 v93, v73, v73
    v_dot2c_f32_bf16 v94, v74, v74
    v_dot2c_f32_bf16 v95, v75, v75
    v_dot2c_f32_bf16 v88, s95, v76
    v_dot2c_f32_bf16 v89, s95, v77
    v_dot2c_f32_bf16 v90, s95, v78
    v_dot2c_f32_bf16 v91, s95, v79
    v_dot2c_f32_bf16 v92, v76, v76
    v_dot2c_f32_bf16 v93, v77, v77
    v_dot2c_f32_bf16 v94, v78, v78
    v_dot2c_f32_bf16 v95, v79, v79
    v_dot2c_f32_bf16 v88, s95, v80
    v_dot2c_f32_bf16 v89, s95, v81
    v_dot2c_f32_bf16 v90, s95, v82
    v_dot2c_f32_bf16 v91, s95, v83
    v_dot2c_f32_bf16 v92, v80, v80
    v_dot2c_f32_bf16 v93, v81, v81
    v_dot2c_f32_bf16 v94, v82, v82
    v_dot2c_f32_bf16 v95, v83, v83
    v_dot2c_f32_bf16 v88, s95, v84
    v_dot2c_f32_bf16 v89, s95, v85
    v_dot2c_f32_bf16 v90, s95, v86
    v_dot2c_f32_bf16 v91, s95, v87
    v_dot2c_f32_bf16 v92, v84, v84
    v_dot2c_f32_bf16 v93, v85, v85
    v_dot2c_f32_bf16 v94, v86, v86
    v_dot2c_f32_bf16 v95, v87, v87
    s_waitcnt vmcnt(11)
    s_barrier
    s_add_u32 m0, s53, 0
    s_lshl_b32 s70, s64, 7
    s_add_u32 s70, s70, s63
    buffer_load_dwordx4 v2, s[8:11], s70 offen offset:0 lds
    buffer_load_dwordx4 v3, s[8:11], s70 offen offset:1024 lds
    buffer_load_dwordx4 v4, s[8:11], s70 offen offset:2048 lds
    buffer_load_dwordx4 v5, s[8:11], s70 offen offset:3072 lds
    s_mul_i32 s91, s64, 393216
    s_add_u32 s64, s64, 1
    s_and_b32 s64, s64, 15
    s_add_u32 m0, s62, 0
    s_nop 0
    buffer_load_dwordx4 v6, s[12:15], s91 offen offset:0 lds
    buffer_load_dwordx4 v7, s[12:15], s91 offen offset:1024 lds
    s_add_u32 m0, s62, 8192
    s_nop 0
    buffer_load_dwordx4 v8, s[12:15], s91 offen offset:0 lds
    buffer_load_dwordx4 v9, s[12:15], s91 offen offset:1024 lds
    s_add_u32 m0, s62, 16384
    s_nop 0
    buffer_load_dwordx4 v10, s[12:15], s91 offen offset:0 lds
    buffer_load_dwordx4 v11, s[12:15], s91 offen offset:1024 lds
    buffer_load_dword v39, v38, s[20:23], 0 offen
    s_cmp_lg_u32 s65, 5
    s_cbranch_scc1 L_h0c5
    ds_read_b128 v[40:43], v28 offset:0
    ds_read_b128 v[44:47], v29 offset:1024
    ds_read_b128 v[48:51], v28 offset:2048
    ds_read_b128 v[52:55], v29 offset:3072
    ds_read_b128 v[56:59], v28 offset:4096
    ds_read_b128 v[60:63], v29 offset:5120
    ds_read_b128 v[64:67], v28 offset:6144
    ds_read_b128 v[68:71], v29 offset:7168
L_h0c5:
    s_waitcnt lgkmcnt(0)
    v_pk_add_f32 v[88:89], v[88:89], v[90:91]
    v_pk_add_f32 v[92:93], v[92:93], v[94:95]
    v_add_f32 v88, v88, v89
    v_add_f32 v89, v92, v93
    s_nop 0
    v_add_f32_dpp v88, v88, v88 quad_perm:[1,0,3,2] row_mask:0xf bank_mask:0xf
    v_add_f32_dpp v89, v89, v89 quad_perm:[1,0,3,2] row_mask:0xf bank_mask:0xf
    s_nop 0
    v_mov_b32_dpp v90, v88 quad_perm:[2,2,2,2] row_mask:0xf bank_mask:0xf
    v_mov_b32_dpp v91, v89 quad_perm:[2,2,2,2] row_mask:0xf bank_mask:0xf
    buffer_store_dwordx4 v[88:91], v13, s[16:19], 0 offen sc1
    s_lshl_b32 s86, s48, 7
    s_add_u32 s86, s86, 131072
    v_lshl_add_u32 v16, v23, 3, s86
    v_lshrrev_b32 v17, 5, v0
    v_lshl_add_u32 v16, v17, 2, v16
    s_lshl_b32 s86, s48, 8
    s_add_u32 s86, s86, 132608
    v_lshl_add_u32 v17, v23, 4, s86
    v_lshl_add_u32 v17, v22, 2, v17
    s_waitcnt vmcnt(12)
    s_barrier
    s_add_u32 m0, s53, 40960
    s_lshl_b32 s70, s64, 7
    s_add_u32 s70, s70, s63
    buffer_load_dwordx4 v2, s[8:11], s70 offen offset:0 lds
    buffer_load_dwordx4 v3, s[8:11], s70 offen offset:1024 lds
    buffer_load_dwordx4 v4, s[8:11], s70 offen offset:2048 lds
    buffer_load_dwordx4 v5, s[8:11], s70 offen offset:3072 lds
    s_mul_i32 s91, s64, 393216
    s_add_u32 s64, s64, 1
    s_and_b32 s64, s64, 15
    s_add_u32 m0, s62, 40960
    s_nop 0
    buffer_load_dwordx4 v6, s[12:15], s91 offen offset:0 lds
    buffer_load_dwordx4 v7, s[12:15], s91 offen offset:1024 lds
    s_add_u32 m0, s62, 49152
    s_nop 0
    buffer_load_dwordx4 v8, s[12:15], s91 offen offset:0 lds
    buffer_load_dwordx4 v9, s[12:15], s91 offen offset:1024 lds
    s_add_u32 m0, s62, 57344
    s_nop 0
    buffer_load_dwordx4 v10, s[12:15], s91 offen offset:0 lds
    buffer_load_dwordx4 v11, s[12:15], s91 offen offset:1024 lds
    s_lshr_b32 s90, s67, 2
    s_add_u32 s90, s90, 3
    s_and_b32 s90, s90, 3
    s_mul_i32 s90, s90, 1572864
    buffer_load_dword v39, v37, s[12:15], s90 offen
    s_cmp_lg_u32 s65, 6
    s_cbranch_scc1 L_h0c6
    ds_read_b128 v[40:43], v28 offset:0
    ds_read_b128 v[44:47], v29 offset:1024
    ds_read_b128 v[48:51], v28 offset:2048
    ds_read_b128 v[52:55], v29 offset:3072
    ds_read_b128 v[56:59], v28 offset:4096
    ds_read_b128 v[60:63], v29 offset:5120
    ds_read_b128 v[64:67], v28 offset:6144
    ds_read_b128 v[68:71], v29 offset:7168
L_h0c6:
    s_waitcnt lgkmcnt(0)
L_walkB1:
    s_cbranch_execz L_walk_5
    s_waitcnt vmcnt(13)
    s_barrier
    s_add_u32 m0, s53, 81920
    s_lshl_b32 s70, s64, 7
    s_add_u32 s70, s70, s63
    buffer_load_dwordx4 v2, s[8:11], s70 offen offset:0 lds
    buffer_load_dwordx4 v3, s[8:11], s70 offen offset:1024 lds
    buffer_load_dwordx4 v4, s[8:11], s70 offen offset:2048 lds
    buffer_load_dwordx4 v5, s[8:11], s70 offen offset:3072 lds
    s_mul_i32 s91, s64, 393216
    s_add_u32 s64, s64, 1
    s_and_b32 s64, s64, 15
    s_add_u32 m0, s62, 81920
    s_nop 0
    buffer_load_dwordx4 v6, s[12:15], s91 offen offset:0 lds
    buffer_load_dwordx4 v7, s[12:15], s91 offen offset:1024 lds
    s_add_u32 m0, s62, 90112
    s_nop 0
    buffer_load_dwordx4 v8, s[12:15], s91 offen offset:0 lds
    buffer_load_dwordx4 v9, s[12:15], s91 offen offset:1024 lds
    s_add_u32 m0, s62, 98304
    s_nop 0
    buffer_load_dwordx4 v10, s[12:15], s91 offen offset:0 lds
    buffer_load_dwordx4 v11, s[12:15], s91 offen offset:1024 lds
    s_add_u32 m0, s53, 122880
    s_lshl_b32 s70, s64, 7
    s_add_u32 s70, s70, s63
    buffer_load_dwordx4 v2, s[8:11], s70 offen offset:0 lds
    buffer_load_dwordx4 v3, s[8:11], s70 offen offset:1024 lds
    s_cmp_lg_u32 s65, 7
    s_cbranch_scc1 L_h0c7
    ds_read_b128 v[40:43], v28 offset:0
    ds_read_b128 v[44:47], v29 offset:1024
    ds_read_b128 v[48:51], v28 offset:2048
    ds_read_b128 v[52:55], v29 offset:3072
    ds_read_b128 v[56:59], v28 offset:4096
    ds_read_b128 v[60:63], v29 offset:5120
    ds_read_b128 v[64:67], v28 offset:6144
    ds_read_b128 v[68:71], v29 offset:7168
L_h0c7:
    s_waitcnt lgkmcnt(0)
    s_waitcnt vmcnt(13)
    s_barrier
    s_add_u32 m0, s53, 122880
    s_nop 0
    buffer_load_dwordx4 v4, s[8:11], s70 offen offset:2048 lds
    buffer_load_dwordx4 v5, s[8:11], s70 offen offset:3072 lds
    s_mul_i32 s91, s64, 393216
    s_add_u32 s64, s64, 1
    s_and_b32 s64, s64, 15
    s_add_u32 m0, s62, 122880
    s_nop 0
    buffer_load_dwordx4 v6, s[12:15], s91 offen offset:0 lds
    buffer_load_dwordx4 v7, s[12:15], s91 offen offset:1024 lds
    s_add_u32 m0, s62, 131072
    s_nop 0
    buffer_load_dwordx4 v8, s[12:15], s91 offen offset:0 lds
    buffer_load_dwordx4 v9, s[12:15], s91 offen offset:1024 lds
    s_add_u32 m0, s62, 139264
    s_nop 0
    buffer_load_dwordx4 v10, s[12:15], s91 offen offset:0 lds
    buffer_load_dwordx4 v11, s[12:15], s91 offen offset:1024 lds
    s_add_u32 m0, s53, 0
    s_lshl_b32 s70, s64, 7
    s_add_u32 s70, s70, s63
    buffer_load_dwordx4 v2, s[8:11], s70 offen offset:0 lds
    buffer_load_dwordx4 v3, s[8:11], s70 offen offset:1024 lds
    v_mfma_f32_16x16x32_bf16 v[108:111], v[104:107], v[40:43], 0
    v_mfma_f32_16x16x32_bf16 v[108:111], v[104:107], v[44:47], v[108:111]
    v_mfma_f32_16x16x32_bf16 v[108:111], v[104:107], v[48:51], v[108:111]
    v_mfma_f32_16x16x32_bf16 v[108:111], v[104:107], v[52:55], v[108:111]
    v_mfma_f32_16x16x32_bf16 v[108:111], v[104:107], v[56:59], v[108:111]
    v_mfma_f32_16x16x32_bf16 v[108:111], v[104:107], v[60:63], v[108:111]
    v_mfma_f32_16x16x32_bf16 v[108:111], v[104:107], v[64:67], v[108:111]
    v_mfma_f32_16x16x32_bf16 v[108:111], v[104:107], v[68:71], v[108:111]
    s_nop 7
    v_add_f32_dpp v108, v108, v108 row_ror:8 row_mask:0xf bank_mask:0xf
    v_add_f32_dpp v109, v109, v109 row_ror:8 row_mask:0xf bank_mask:0xf
    v_add_f32_dpp v110, v110, v110 row_ror:8 row_mask:0xf bank_mask:0xf
    v_add_f32_dpp v111, v111, v111 row_ror:8 row_mask:0xf bank_mask:0xf
    buffer_store_dwordx4 v[108:111], v34, s[16:19], 0 offen sc1
    s_waitcnt vmcnt(13)
    s_barrier
    s_add_u32 m0, s53, 0
    s_nop 0
    buffer_load_dwordx4 v4, s[8:11], s70 offen offset:2048 lds
    buffer_load_dwordx4 v5, s[8:11], s70 offen offset:3072 lds
    s_mul_i32 s91, s64, 393216
    s_add_u32 s64, s64, 1
    s_and_b32 s64, s64, 15
    s_add_u32 m0, s62, 0
    s_nop 0
    buffer_load_dwordx4 v6, s[12:15], s91 offen offset:0 lds
    buffer_load_dwordx4 v7, s[12:15], s91 offen offset:1024 lds
    s_add_u32 m0, s62, 8192
    s_nop 0
    buffer_load_dwordx4 v8, s[12:15], s91 offen offset:0 lds
    buffer_load_dwordx4 v9, s[12:15], s91 offen offset:1024 lds
    s_add_u32 m0, s62, 16384
    s_nop 0
    buffer_load_dwordx4 v10, s[12:15], s91 offen offset:0 lds
    buffer_load_dwordx4 v11, s[12:15], s91 offen offset:1024 lds
    s_add_u32 m0, s53, 40960
    s_lshl_b32 s70, s64, 7
    s_add_u32 s70, s70, s63
    buffer_load_dwordx4 v2, s[8:11], s70 offen offset:0 lds
    buffer_load_dwordx4 v3, s[8:11], s70 offen offset:1024 lds
    buffer_load_dwordx4 v4, s[8:11], s70 offen offset:2048 lds
    buffer_load_dwordx4 v5, s[8:11], s70 offen offset:3072 lds
    s_mul_i32 s91, s64, 393216
    s_add_u32 s64, s64, 1
    s_and_b32 s64, s64, 15
    s_waitcnt vmcnt(12)
    s_barrier
    buffer_atomic_swap v35, v116, s[16:19], 0 offen sc1
    s_add_u32 m0, s62, 40960
    s_nop 0
    buffer_load_dwordx4 v6, s[12:15], s91 offen offset:0 lds
    buffer_load_dwordx4 v7, s[12:15], s91 offen offset:1024 lds
    s_add_u32 m0, s62, 49152
    s_nop 0
    buffer_load_dwordx4 v8, s[12:15], s91 offen offset:0 lds
    buffer_load_dwordx4 v9, s[12:15], s91 offen offset:1024 lds
    s_add_u32 m0, s62, 57344
    s_nop 0
    buffer_load_dwordx4 v10, s[12:15], s91 offen offset:0 lds
    buffer_load_dwordx4 v11, s[12:15], s91 offen offset:1024 lds
    s_add_u32 m0, s53, 81920
    s_lshl_b32 s70, s64, 7
    s_add_u32 s70, s70, s63
    buffer_load_dwordx4 v2, s[8:11], s70 offen offset:0 lds
    buffer_load_dwordx4 v3, s[8:11], s70 offen offset:1024 lds
    buffer_load_dwordx4 v4, s[8:11], s70 offen offset:2048 lds
    buffer_load_dwordx4 v5, s[8:11], s70 offen offset:3072 lds
    s_mul_i32 s91, s64, 393216
    s_add_u32 s64, s64, 1
    s_and_b32 s64, s64, 15
    s_add_u32 m0, s62, 81920
    s_nop 0
    buffer_load_dwordx4 v6, s[12:15], s91 offen offset:0 lds
    buffer_load_dwordx4 v7, s[12:15], s91 offen offset:1024 lds
    s_waitcnt vmcnt(17)
    s_barrier
    s_add_u32 m0, s62, 90112
    s_nop 0
    buffer_load_dwordx4 v8, s[12:15], s91 offen offset:0 lds
    buffer_load_dwordx4 v9, s[12:15], s91 offen offset:1024 lds
    s_add_u32 m0, s62, 98304
    s_nop 0
    buffer_load_dwordx4 v10, s[12:15], s91 offen offset:0 lds
    buffer_load_dwordx4 v11, s[12:15], s91 offen offset:1024 lds
    s_add_u32 m0, s53, 122880
    s_lshl_b32 s70, s64, 7
    s_add_u32 s70, s70, s63
    buffer_load_dwordx4 v2, s[8:11], s70 offen offset:0 lds
    buffer_load_dwordx4 v3, s[8:11], s70 offen offset:1024 lds
    buffer_load_dwordx4 v4, s[8:11], s70 offen offset:2048 lds
    buffer_load_dwordx4 v5, s[8:11], s70 offen offset:3072 lds
    s_mul_i32 s91, s64, 393216
    s_add_u32 s64, s64, 1
    s_and_b32 s64, s64, 15
    s_add_u32 m0, s62, 122880
    s_nop 0
    buffer_load_dwordx4 v6, s[12:15], s91 offen offset:0 lds
    buffer_load_dwordx4 v7, s[12:15], s91 offen offset:1024 lds
    s_add_u32 m0, s62, 131072
    s_nop 0
    buffer_load_dwordx4 v8, s[12:15], s91 offen offset:0 lds
    buffer_load_dwordx4 v9, s[12:15], s91 offen offset:1024 lds
L_walk_4:
    s_cbranch_execz L_walk_8
    s_waitcnt vmcnt(18)
    s_barrier
    s_add_u32 m0, s62, 139264
    s_nop 0
    buffer_load_dwordx4 v10, s[12:15], s91 offen offset:0 lds
    buffer_load_dwordx4 v11, s[12:15], s91 offen offset:1024 lds
    s_add_u32 m0, s53, 0
    s_lshl_b32 s70, s64, 7
    s_add_u32 s70, s70, s63
    buffer_load_dwordx4 v2, s[8:11], s70 offen offset:0 lds
    buffer_load_dwordx4 v3, s[8:11], s70 offen offset:1024 lds
    buffer_load_dwordx4 v4, s[8:11], s70 offen offset:2048 lds
    buffer_load_dwordx4 v5, s[8:11], s70 offen offset:3072 lds
    s_mul_i32 s91, s64, 393216
    s_add_u32 s64, s64, 1
    s_and_b32 s64, s64, 15
    s_add_u32 m0, s62, 0
    s_nop 0
    buffer_load_dwordx4 v6, s[12:15], s91 offen offset:0 lds
    buffer_load_dwordx4 v7, s[12:15], s91 offen offset:1024 lds
    s_add_u32 m0, s62, 8192
    s_nop 0
    buffer_load_dwordx4 v8, s[12:15], s91 offen offset:0 lds
    buffer_load_dwordx4 v9, s[12:15], s91 offen offset:1024 lds
    s_add_u32 m0, s62, 16384
    s_nop 0
    buffer_load_dwordx4 v10, s[12:15], s91 offen offset:0 lds
    buffer_load_dwordx4 v11, s[12:15], s91 offen offset:1024 lds
    s_waitcnt vmcnt(20)
    s_barrier
    v_mov_b32 v118, 0
    buffer_atomic_or v118, v117, s[16:19], 0 offen sc0 sc1
    s_add_u32 m0, s89, 40960
    s_mov_b32 s90, 655360
    buffer_load_dwordx4 v12, s[20:23], s90 offen lds
    s_add_u32 m0, s89, 45056
    s_mov_b32 s90, 720896
    buffer_load_dwordx4 v12, s[20:23], s90 offen lds
    s_add_u32 m0, s89, 49152
    s_mov_b32 s90, 786432
    buffer_load_dwordx4 v12, s[20:23], s90 offen lds
    s_add_u32 m0, s89, 53248
    s_mov_b32 s90, 851968
    buffer_load_dwordx4 v12, s[20:23], s90 offen lds
    s_mov_b32 s90, 0
    buffer_load_dwordx4 v[164:167], v30, s[32:35], s90 offen
    s_mov_b32 s90, 7168
    buffer_load_dwordx4 v[168:171], v30, s[32:35], s90 offen
    s_mov_b32 s90, 14336
    buffer_load_dwordx4 v[172:175], v30, s[32:35], s90 offen
    s_mov_b32 s90, 21504
    buffer_load_dwordx4 v[176:179], v30, s[32:35], s90 offen
    s_waitcnt vmcnt(19)
    s_barrier
    s_waitcnt vmcnt(8)
    s_branch L_h0_chk0
L_h0_spin:
    v_mov_b32 v118, 0
    buffer_atomic_or v118, v117, s[16:19], 0 offen sc0 sc1
    s_waitcnt vmcnt(0)
L_h0_chk0:
    v_cmp_ne_u32 vcc, s68, v118
    s_nop 0
    s_and_b64 vcc, vcc, s[76:77]
    s_cbranch_vccz L_ok_1
    s_sub_u32 s56, s56, 1
    s_cbranch_scc0 L_h0_spin
    s_mov_b32 s56, 0
L_ok_1:
    s_mov_b32 s90, 0
    buffer_load_dwordx4 v[40:43], v32, s[16:19], s90 offen sc1
    s_mov_b32 s90, 3072
    buffer_load_dwordx4 v[44:47], v32, s[16:19], s90 offen sc1
    s_mov_b32 s90, 6144
    buffer_load_dwordx4 v[48:51], v32, s[16:19], s90 offen sc1
    s_mov_b32 s90, 9216
    buffer_load_dwordx4 v[52:55], v32, s[16:19], s90 offen sc1
    buffer_load_dwordx4 v[56:59], v33, s[16:19], 0 offen sc1
    buffer_load_dwordx4 v[60:63], v33, s[16:19], s92 offen sc1
    buffer_load_dwordx4 v[64:67], v33, s[16:19], s93 offen sc1
    buffer_load_dwordx4 v[68:71], v33, s[16:19], s94 offen sc1
    s_mov_b32 s90, 28672
    buffer_load_dwordx4 v[180:183], v30, s[32:35], s90 offen
    s_mov_b32 s90, 35840
    buffer_load_dwordx4 v[184:187], v30, s[32:35], s90 offen
    s_mov_b32 s90, 43008
    buffer_load_dwordx4 v[188:191], v30, s[32:35], s90 offen
    s_waitcnt vmcnt(20)
    s_barrier
    v_mov_b32 v24, 135168
    v_lshl_add_u32 v24, v21, 2, v24
    v_mov_b32 v25, 0
    ds_write_b32 v24, v25
    s_add_u32 m0, s89, 57344
    s_mov_b32 s90, 917504
    buffer_load_dwordx4 v12, s[20:23], s90 offen lds
    s_add_u32 m0, s89, 61440
    s_mov_b32 s90, 983040
    buffer_load_dwordx4 v12, s[20:23], s90 offen lds
    s_add_u32 m0, s89, 65536
    s_mov_b32 s90, 1048576
    buffer_load_dwordx4 v12, s[20:23], s90 offen lds
    s_add_u32 m0, s89, 69632
    s_mov_b32 s90, 1114112
    buffer_load_dwordx4 v12, s[20:23], s90 offen lds
    s_add_u32 m0, s89, 73728
    s_mov_b32 s90, 1179648
    buffer_load_dwordx4 v12, s[20:23], s90 offen lds
    s_add_u32 m0, s89, 77824
    s_mov_b32 s90, 1245184
    buffer_load_dwordx4 v12, s[20:23], s90 offen lds
    s_waitcnt vmcnt(9)
    v_add_f32 v40, v40, v44
    v_add_f32 v41, v41, v45
    v_add_f32 v42, v42, v46
    v_add_f32 v43, v43, v47
    v_add_f32 v40, v40, v48
    v_add_f32 v41, v41, v49
    v_add_f32 v42, v42, v50
    v_add_f32 v43, v43, v51
    v_add_f32 v40, v40, v52
    v_add_f32 v41, v41, v53
    v_add_f32 v42, v42, v54
    v_add_f32 v43, v43, v55
    v_add_f32 v56, v56, v60
    v_add_f32 v57, v57, v61
    v_add_f32 v58, v58, v62
    v_add_f32 v59, v59, v63
    v_add_f32 v56, v56, v64
    v_add_f32 v57, v57, v65
    v_add_f32 v58, v58, v66
    v_add_f32 v59, v59, v67
    v_add_f32 v56, v56, v68
    v_add_f32 v57, v57, v69
    v_add_f32 v58, v58, v70
    v_add_f32 v59, v59, v71
    s_nop 0
    v_permlane32_swap_b32 v56, v58
    v_permlane32_swap_b32 v57, v59
    v_permlane32_swap_b32 v40, v42
    v_permlane32_swap_b32 v41, v43
    v_add_f32 v56, v56, v58
    v_add_f32 v57, v57, v59
    v_add_f32 v40, v40, v42
    v_add_f32 v41, v41, v43
    v_mov_b32 v58, v56
    v_mov_b32 v59, v57
    v_permlane16_swap_b32 v40, v41
    v_permlane16_swap_b32 v56, v58
    v_permlane16_swap_b32 v57, v59
    v_add_f32 v40, v40, v41
    v_add_f32 v56, v56, v58
    v_add_f32 v57, v57, v59
    ds_write_b32 v17, v40
    v_mul_f32 v56, 0x3a800000, v56
    v_mul_f32 v57, 0x3a800000, v57
    v_fma_f32 v57, -v56, v56, v57
    v_max_f32 v57, 0, v57
    v_cvt_pk_bf16_f32 v48, v56, v57
    v_lshlrev_b32 v44, 16, v48
    v_and_b32 v48, 0xffff0000, v48
    v_add_f32 v48, 0x3727c5ac, v48
    v_cvt_pk_bf16_f32 v48, v48, v48
    v_lshlrev_b32 v48, 16, v48
    v_sqrt_f32 v48, v48
    s_nop 0
    v_cvt_pk_bf16_f32 v48, v48, v48
    v_lshlrev_b32 v48, 16, v48
    v_rcp_f32 v46, v48
    v_sub_f32 v44, 0, v44
    v_mul_f32 v48, 0x3fb8aa3b, v46
    ds_write_b32 v16, v44
    ds_write_b32 v16, v46 offset:512
    ds_write_b32 v16, v48 offset:1024
    s_waitcnt lgkmcnt(0)
L_walk_5:
    s_cbranch_execz L_walk_12
    s_barrier
    s_setprio 0
    s_add_u32 m0, s89, 81920
    s_mov_b32 s90, 1310720
    buffer_load_dwordx4 v12, s[20:23], s90 offen lds
    s_add_u32 m0, s89, 86016
    s_mov_b32 s90, 1376256
    buffer_load_dwordx4 v12, s[20:23], s90 offen lds
    s_add_u32 m0, s89, 90112
    s_mov_b32 s90, 1441792
    buffer_load_dwordx4 v12, s[20:23], s90 offen lds
    s_add_u32 m0, s89, 94208
    s_mov_b32 s90, 1507328
    buffer_load_dwordx4 v12, s[20:23], s90 offen lds
    s_add_u32 m0, s89, 98304
    s_mov_b32 s90, 1572864
    buffer_load_dwordx4 v12, s[20:23], s90 offen lds
    s_add_u32 m0, s89, 102400
    s_mov_b32 s90, 1638400
    buffer_load_dwordx4 v12, s[20:23], s90 offen lds
    s_add_u32 m0, s89, 106496
    s_mov_b32 s90, 1703936
    buffer_load_dwordx4 v12, s[20:23], s90 offen lds
    s_add_u32 m0, s89, 110592
    s_mov_b32 s90, 1769472
    buffer_load_dwordx4 v12, s[20:23], s90 offen lds
    s_add_u32 m0, s89, 114688
    s_mov_b32 s90, 1835008
    buffer_load_dwordx4 v12, s[20:23], s90 offen lds
    s_add_u32 m0, s89, 118784
    s_mov_b32 s90, 1900544
    buffer_load_dwordx4 v12, s[20:23], s90 offen lds
    s_add_u32 m0, s89, 122880
    s_mov_b32 s90, 1966080
    buffer_load_dwordx4 v12, s[20:23], s90 offen lds
    s_add_u32 m0, s89, 126976
    s_mov_b32 s90, 2031616
    buffer_load_dwordx4 v12, s[20:23], s90 offen lds
    s_add_u32 m0, s89, 0
    s_mov_b32 s90, 0
    buffer_load_dwordx4 v12, s[20:23], s90 offen lds
    s_add_u32 m0, s89, 4096
    s_mov_b32 s90, 65536
    buffer_load_dwordx4 v12, s[20:23], s90 offen lds
    s_add_u32 m0, s89, 8192
    s_mov_b32 s90, 131072
    buffer_load_dwordx4 v12, s[20:23], s90 offen lds
    s_add_u32 m0, s89, 12288
    s_mov_b32 s90, 196608
    buffer_load_dwordx4 v12, s[20:23], s90 offen lds
    s_add_u32 m0, s89, 16384
    s_mov_b32 s90, 262144
    buffer_load_dwordx4 v12, s[20:23], s90 offen lds
    s_add_u32 m0, s89, 20480
    s_mov_b32 s90, 327680
    buffer_load_dwordx4 v12, s[20:23], s90 offen lds
    s_add_u32 m0, s89, 24576
    s_mov_b32 s90, 393216
    buffer_load_dwordx4 v12, s[20:23], s90 offen lds
    s_add_u32 m0, s89, 28672
    s_mov_b32 s90, 458752
    buffer_load_dwordx4 v12, s[20:23], s90 offen lds
    s_add_u32 m0, s89, 32768
    s_mov_b32 s90, 524288
    buffer_load_dwordx4 v12, s[20:23], s90 offen lds
    s_add_u32 m0, s89, 36864
    s_mov_b32 s90, 589824
    buffer_load_dwordx4 v12, s[20:23], s90 offen lds
    s_lshl_b32 s86, s47, 2
    s_add_u32 s86, s86, s48
    s_lshl_b32 s87, s86, 7
    s_add_u32 s87, s87, 671744
    v_lshl_add_u32 v6, v0, 2, s87
    v_mov_b32 v4, 2147483648
    v_cmp_gt_u32 vcc, 16, v0
    s_nop 1
    v_cndmask_b32 v6, v4, v6, vcc
    s_lshl_b32 s86, s86, 14
    s_add_u32 s86, s86, 5242880
    v_lshl_add_u32 v2, v0, 4, s86
    s_lshl_b32 s86, s47, 1
    s_add_u32 s86, s86, s50
    s_lshl_b32 s86, s86, 11
    s_lshl_b32 s87, s49, 6
    s_add_u32 s86, s86, s87
    s_add_u32 s86, s86, 6881280
    v_lshl_add_u32 v3, v23, 7, s86
    v_lshl_add_u32 v3, v22, 4, v3
    v_mov_b32 v112, 0
    v_mov_b32 v113, 0
    v_mov_b32 v114, 0
    v_mov_b32 v115, 0
    v_mov_b32 v116, 0
    v_mov_b32 v117, 0
    v_mov_b32 v118, 0
    v_mov_b32 v119, 0
    s_lshr_b32 s62, s3, 2
    s_lshl_b32 s53, s51, 3
    s_lshl_b32 s86, s48, 1
    s_add_u32 s53, s53, s86
    s_add_u32 s53, s53, s62
    v_lshrrev_b32 v36, 4, v0
    v_and_b32 v37, 15, v0
    s_lshl_b32 s87, s53, 15
    s_lshl_b32 s86, s62, 14
    s_add_u32 s86, s86, s87
    s_add_u32 s86, s86, 1048576
    v_lshl_add_u32 v157, v0, 4, s86
    v_xor_b32 v158, 0x8000, v157
    s_lshl_b32 s86, s51, 1
    s_lshr_b32 s87, s48, 1
    s_add_u32 s86, s86, s87
    s_lshl_b32 s86, s86, 1
    s_add_u32 s86, s86, s62
    s_lshl_b32 s86, s86, 1
    s_and_b32 s87, s48, 1
    s_add_u32 s86, s86, s87
    s_lshl_b32 s86, s86, 7
    s_add_u32 s86, s86, 688128
    v_lshl_add_u32 v159, v0, 2, s86
    v_mov_b32 v38, 2147483648
    v_cmp_gt_u32 vcc, 16, v0
    s_nop 1
    v_cndmask_b32 v159, v38, v159, vcc
    v_bfe_u32 v38, v0, 2, 2
    v_lshl_add_u32 v38, v36, 2, v38
    v_bfe_u32 v39, v38, 1, 2
    v_lshlrev_b32 v38, 7, v38
    v_lshl_add_u32 v38, v39, 5, v38
    v_and_b32 v39, 3, v0
    v_lshl_add_u32 v38, v39, 3, v38
    s_lshl_b32 s86, s62, 16
    s_add_u32 s86, s86, 0
    v_add_u32 v144, s86, v38
    v_xor_b32 v145, 32, v144
    v_xor_b32 v146, 64, v144
    v_xor_b32 v147, 96, v144
    v_cmp_eq_u32 s[4:5], 1, v39
    v_cmp_eq_u32 s[6:7], 2, v39
    v_cmp_eq_u32 s[98:99], 3, v39
    s_lshl_b32 s86, s53, 10
    s_add_u32 s86, s86, 786432
    v_lshl_add_u32 v160, v0, 2, s86
    v_mul_u32_u24 v161, 192, v36
    v_add_u32 v160, v160, v161
    s_mov_b32 s72, 0x00f0000f
    s_mov_b32 s73, 0xf0000f00
    s_mov_b32 s74, 0x0f00f000
    s_mov_b32 s75, 0x0f00f000
    v_lshrrev_b32 v38, 2, v37
    v_lshl_add_u32 v161, v38, 4, v37
    v_lshlrev_b32 v161, 2, v161
    s_lshl_b32 s86, s3, 12
    s_add_u32 s86, s86, 131072
    v_lshl_add_u32 v162, v0, 4, s86
    v_xor_b32 v163, 0x4000, v162
    s_lshl_b32 s86, s52, 7
    v_lshl_add_u32 v36, v36, 3, s86
    s_lshl_b32 s87, s53, 15
    s_add_u32 s87, s87, s86
    s_lshl_b32 s86, s62, 6
    s_add_u32 s87, s87, s86
    v_lshl_add_u32 v39, v37, 11, s87
    v_and_b32 v38, 48, v0
    v_add_u32 v39, v39, v38
    v_xor_b32 v37, 0x8000, v39
    v_lshlrev_b32 v38, 4, v0
L_walk_6:
    s_cbranch_execz L_walk_13
    buffer_load_dwordx2 v[148:149], v36, s[40:43], 0 offen offset:0
    buffer_load_dwordx2 v[150:151], v36, s[40:43], 0 offen offset:32
    buffer_load_dwordx2 v[152:153], v36, s[40:43], 0 offen offset:64
    buffer_load_dwordx2 v[154:155], v36, s[40:43], 0 offen offset:96
    buffer_load_dwordx4 v[128:131], v38, s[40:43], 0 offen
    buffer_load_dwordx4 v[132:135], v38, s[40:43], 0 offen offset:1024
    buffer_load_dwordx4 v[136:139], v39, s[8:11], 0 offen
    buffer_load_dwordx4 v[140:143], v37, s[8:11], 0 offen
    s_mov_b32 s90, 50176
    buffer_load_dwordx4 v[192:195], v30, s[32:35], s90 offen
    s_mov_b32 s90, 57344
    buffer_load_dwordx4 v[196:199], v30, s[32:35], s90 offen
    s_mov_b32 s90, 64512
    buffer_load_dwordx4 v[200:203], v30, s[32:35], s90 offen
    s_waitcnt vmcnt(5)
    v_mov_b32 v4, 0
    buffer_atomic_or v4, v6, s[16:19], 0 offen sc0 sc1
    v_bfe_u32 v36, v0, 2, 1
    v_cmp_eq_u32 vcc, 1, v36
    v_mov_b32 v36, s95
    v_mov_b32 v38, 0
    v_dot2c_f32_bf16 v38, s95, v128
    v_dot2c_f32_bf16 v38, s95, v129
    v_dot2c_f32_bf16 v38, s95, v130
    v_dot2c_f32_bf16 v38, s95, v131
    v_dot2c_f32_bf16 v38, s95, v132
    v_dot2c_f32_bf16 v38, s95, v133
    v_dot2c_f32_bf16 v38, s95, v134
    v_dot2c_f32_bf16 v38, s95, v135
    v_cndmask_b32 v148, v36, v148, vcc
    v_cndmask_b32 v149, v36, v149, vcc
    v_cndmask_b32 v150, v36, v150, vcc
    v_cndmask_b32 v151, v36, v151, vcc
    v_cndmask_b32 v152, v36, v152, vcc
    v_cndmask_b32 v153, v36, v153, vcc
    v_cndmask_b32 v154, v36, v154, vcc
    v_cndmask_b32 v155, v36, v155, vcc
    v_add_f32_dpp v38, v38, v38 row_ror:8 row_mask:0xf bank_mask:0xf
    s_nop 1
    v_add_f32_dpp v38, v38, v38 row_ror:4 row_mask:0xf bank_mask:0xf
    s_nop 1
    v_add_f32_dpp v38, v38, v38 row_ror:2 row_mask:0xf bank_mask:0xf
    s_nop 1
    v_add_f32_dpp v38, v38, v38 row_ror:1 row_mask:0xf bank_mask:0xf
    v_mov_b32 v36, v38
    s_nop 1
    v_permlane32_swap_b32 v38, v36
    v_add_f32 v38, v38, v36
    v_mov_b32 v36, v38
    s_nop 1
    v_permlane16_swap_b32 v38, v36
    v_add_f32 v38, v38, v36
    v_mov_b32 v36, 135200
    v_readfirstlane_b32 s57, v38
    ds_write_b32 v36, v38
    s_mul_i32 s86, s50, 3072
    s_add_u32 s86, s86, 151552
    v_lshl_add_u32 v7, v0, 4, s86
    s_lshl_b32 s86, s49, 10
    v_add_u32 v5, s86, v7
    s_lshl_b32 s86, s49, 3
    v_add_u32 v7, s86, v7
    s_mov_b32 s88, 0xffff0000
    s_mov_b32 s86, 0x00003f80
    s_mov_b32 s87, 0x3f800000
    s_branch L_h1_w0
L_h1_r0:
    s_ff1_i32_b32 s66, s65
    s_bitset0_b32 s65, s66
    s_lshl_b32 s66, s66, 10
    buffer_load_dwordx4 v[40:43], v2, s[16:19], s66 offen sc1
    s_cmp_eq_u32 s65, 0
    s_cbranch_scc1 L_h1_p1
L_h1_r1:
    s_ff1_i32_b32 s66, s65
    s_bitset0_b32 s65, s66
    s_lshl_b32 s66, s66, 10
    buffer_load_dwordx4 v[44:47], v2, s[16:19], s66 offen sc1
    s_cmp_eq_u32 s65, 0
    s_cbranch_scc1 L_h1_p2
L_h1_r2:
    s_ff1_i32_b32 s66, s65
    s_bitset0_b32 s65, s66
    s_lshl_b32 s66, s66, 10
    buffer_load_dwordx4 v[48:51], v2, s[16:19], s66 offen sc1
    s_cmp_eq_u32 s65, 0
    s_cbranch_scc1 L_h1_p3
L_h1_r3:
    s_ff1_i32_b32 s66, s65
    s_bitset0_b32 s65, s66
    s_lshl_b32 s66, s66, 10
    buffer_load_dwordx4 v[52:55], v2, s[16:19], s66 offen sc1
    s_cmp_eq_u32 s65, 0
    s_cbranch_scc1 L_h1_p4
L_h1_r4:
    s_ff1_i32_b32 s66, s65
    s_bitset0_b32 s65, s66
    s_lshl_b32 s66, s66, 10
    buffer_load_dwordx4 v[56:59], v2, s[16:19], s66 offen sc1
    s_cmp_eq_u32 s65, 0
    s_cbranch_scc1 L_h1_p5
L_h1_r5:
    s_ff1_i32_b32 s66, s65
    s_bitset0_b32 s65, s66
    s_lshl_b32 s66, s66, 10
    buffer_load_dwordx4 v[60:63], v2, s[16:19], s66 offen sc1
    s_cmp_eq_u32 s65, 0
    s_cbranch_scc1 L_h1_p6
L_h1_r6:
    s_ff1_i32_b32 s66, s65
    s_bitset0_b32 s65, s66
    s_lshl_b32 s66, s66, 10
    buffer_load_dwordx4 v[64:67], v2, s[16:19], s66 offen sc1
    s_cmp_eq_u32 s65, 0
    s_cbranch_scc1 L_h1_p7
L_h1_r7:
    s_ff1_i32_b32 s66, s65
    s_bitset0_b32 s65, s66
    s_lshl_b32 s66, s66, 10
    buffer_load_dwordx4 v[68:71], v2, s[16:19], s66 offen sc1
    s_cmp_eq_u32 s65, 0
    s_cbranch_scc1 L_h1_p8
L_h1_r8:
    s_ff1_i32_b32 s66, s65
    s_bitset0_b32 s65, s66
    s_lshl_b32 s66, s66, 10
    buffer_load_dwordx4 v[72:75], v2, s[16:19], s66 offen sc1
    s_cmp_eq_u32 s65, 0
    s_cbranch_scc1 L_h1_p9
L_h1_r9:
    s_ff1_i32_b32 s66, s65
    s_bitset0_b32 s65, s66
    s_lshl_b32 s66, s66, 10
    buffer_load_dwordx4 v[76:79], v2, s[16:19], s66 offen sc1
    s_cmp_eq_u32 s65, 0
    s_cbranch_scc1 L_h1_p10
L_h1_r10:
    s_ff1_i32_b32 s66, s65
    s_bitset0_b32 s65, s66
    s_lshl_b32 s66, s66, 10
    buffer_load_dwordx4 v[80:83], v2, s[16:19], s66 offen sc1
    s_cmp_eq_u32 s65, 0
    s_cbranch_scc1 L_h1_p11
L_h1_r11:
    s_ff1_i32_b32 s66, s65
    s_bitset0_b32 s65, s66
    s_lshl_b32 s66, s66, 10
    buffer_load_dwordx4 v[84:87], v2, s[16:19], s66 offen sc1
    s_cmp_eq_u32 s65, 0
    s_cbranch_scc1 L_h1_p12
L_h1_r12:
    s_ff1_i32_b32 s66, s65
    s_bitset0_b32 s65, s66
    s_lshl_b32 s66, s66, 10
    buffer_load_dwordx4 v[88:91], v2, s[16:19], s66 offen sc1
    s_cmp_eq_u32 s65, 0
    s_cbranch_scc1 L_h1_p13
L_h1_r13:
    s_ff1_i32_b32 s66, s65
    s_bitset0_b32 s65, s66
    s_lshl_b32 s66, s66, 10
    buffer_load_dwordx4 v[92:95], v2, s[16:19], s66 offen sc1
    s_cmp_eq_u32 s65, 0
    s_cbranch_scc1 L_h1_p14
L_h1_r14:
    s_ff1_i32_b32 s66, s65
    s_bitset0_b32 s65, s66
    s_lshl_b32 s66, s66, 10
    buffer_load_dwordx4 v[96:99], v2, s[16:19], s66 offen sc1
    s_cmp_eq_u32 s65, 0
    s_cbranch_scc1 L_h1_p15
L_h1_r15:
    s_ff1_i32_b32 s66, s65
    s_bitset0_b32 s65, s66
    s_lshl_b32 s66, s66, 10
    buffer_load_dwordx4 v[100:103], v2, s[16:19], s66 offen sc1
    buffer_load_dwordx4 v[104:107], v3, s[16:19], 0 offen sc1
L_h1_acc:
    s_waitcnt vmcnt(16)
    v_dot2c_f32_bf16 v112, s86, v40
    v_dot2c_f32_bf16 v113, s87, v40
    v_dot2c_f32_bf16 v114, s86, v41
    v_dot2c_f32_bf16 v115, s87, v41
    v_dot2c_f32_bf16 v116, s86, v42
    v_dot2c_f32_bf16 v117, s87, v42
    v_dot2c_f32_bf16 v118, s86, v43
    v_dot2c_f32_bf16 v119, s87, v43
    s_waitcnt vmcnt(15)
    v_dot2c_f32_bf16 v112, s86, v44
    v_dot2c_f32_bf16 v113, s87, v44
    v_dot2c_f32_bf16 v114, s86, v45
    v_dot2c_f32_bf16 v115, s87, v45
    v_dot2c_f32_bf16 v116, s86, v46
    v_dot2c_f32_bf16 v117, s87, v46
    v_dot2c_f32_bf16 v118, s86, v47
    v_dot2c_f32_bf16 v119, s87, v47
    s_waitcnt vmcnt(14)
    v_dot2c_f32_bf16 v112, s86, v48
    v_dot2c_f32_bf16 v113, s87, v48
    v_dot2c_f32_bf16 v114, s86, v49
    v_dot2c_f32_bf16 v115, s87, v49
    v_dot2c_f32_bf16 v116, s86, v50
    v_dot2c_f32_bf16 v117, s87, v50
    v_dot2c_f32_bf16 v118, s86, v51
    v_dot2c_f32_bf16 v119, s87, v51
    v_max3_u32 v4, v43, v47, v51
    s_waitcnt vmcnt(13)
    v_dot2c_f32_bf16 v112, s86, v52
    v_dot2c_f32_bf16 v113, s87, v52
    v_dot2c_f32_bf16 v114, s86, v53
    v_dot2c_f32_bf16 v115, s87, v53
    v_dot2c_f32_bf16 v116, s86, v54
    v_dot2c_f32_bf16 v117, s87, v54
    v_dot2c_f32_bf16 v118, s86, v55
    v_dot2c_f32_bf16 v119, s87, v55
    s_waitcnt vmcnt(12)
    v_dot2c_f32_bf16 v112, s86, v56
    v_dot2c_f32_bf16 v113, s87, v56
    v_dot2c_f32_bf16 v114, s86, v57
    v_dot2c_f32_bf16 v115, s87, v57
    v_dot2c_f32_bf16 v116, s86, v58
    v_dot2c_f32_bf16 v117, s87, v58
    v_dot2c_f32_bf16 v118, s86, v59
    v_dot2c_f32_bf16 v119, s87, v59
    v_max3_u32 v4, v4, v55, v59
    s_waitcnt vmcnt(11)
    v_dot2c_f32_bf16 v112, s86, v60
    v_dot2c_f32_bf16 v113, s87, v60
    v_dot2c_f32_bf16 v114, s86, v61
    v_dot2c_f32_bf16 v115, s87, v61
    v_dot2c_f32_bf16 v116, s86, v62
    v_dot2c_f32_bf16 v117, s87, v62
    v_dot2c_f32_bf16 v118, s86, v63
    v_dot2c_f32_bf16 v119, s87, v63
    s_waitcnt vmcnt(10)
    v_dot2c_f32_bf16 v112, s86, v64
    v_dot2c_f32_bf16 v113, s87, v64
    v_dot2c_f32_bf16 v114, s86, v65
    v_dot2c_f32_bf16 v115, s87, v65
    v_dot2c_f32_bf16 v116, s86, v66
    v_dot2c_f32_bf16 v117, s87, v66
    v_dot2c_f32_bf16 v118, s86, v67
    v_dot2c_f32_bf16 v119, s87, v67
    v_max3_u32 v4, v4, v63, v67
L_walk_7:
    s_cbranch_execz L_walk_14
    s_waitcnt vmcnt(9)
    v_dot2c_f32_bf16 v112, s86, v68
    v_dot2c_f32_bf16 v113, s87, v68
    v_dot2c_f32_bf16 v114, s86, v69
    v_dot2c_f32_bf16 v115, s87, v69
    v_dot2c_f32_bf16 v116, s86, v70
    v_dot2c_f32_bf16 v117, s87, v70
    v_dot2c_f32_bf16 v118, s86, v71
    v_dot2c_f32_bf16 v119, s87, v71
    s_waitcnt vmcnt(8)
    v_dot2c_f32_bf16 v112, s86, v72
    v_dot2c_f32_bf16 v113, s87, v72
    v_dot2c_f32_bf16 v114, s86, v73
    v_dot2c_f32_bf16 v115, s87, v73
    v_dot2c_f32_bf16 v116, s86, v74
    v_dot2c_f32_bf16 v117, s87, v74
    v_dot2c_f32_bf16 v118, s86, v75
    v_dot2c_f32_bf16 v119, s87, v75
    v_max3_u32 v4, v4, v71, v75
    s_waitcnt vmcnt(7)
    v_dot2c_f32_bf16 v112, s86, v76
    v_dot2c_f32_bf16 v113, s87, v76
    v_dot2c_f32_bf16 v114, s86, v77
    v_dot2c_f32_bf16 v115, s87, v77
    v_dot2c_f32_bf16 v116, s86, v78
    v_dot2c_f32_bf16 v117, s87, v78
    v_dot2c_f32_bf16 v118, s86, v79
    v_dot2c_f32_bf16 v119, s87, v79
    s_waitcnt vmcnt(6)
    v_dot2c_f32_bf16 v112, s86, v80
    v_dot2c_f32_bf16 v113, s87, v80
    v_dot2c_f32_bf16 v114, s86, v81
    v_dot2c_f32_bf16 v115, s87, v81
    v_dot2c_f32_bf16 v116, s86, v82
    v_dot2c_f32_bf16 v117, s87, v82
    v_dot2c_f32_bf16 v118, s86, v83
    v_dot2c_f32_bf16 v119, s87, v83
    v_max3_u32 v4, v4, v79, v83
    s_waitcnt vmcnt(5)
    v_dot2c_f32_bf16 v112, s86, v84
    v_dot2c_f32_bf16 v113, s87, v84
    v_dot2c_f32_bf16 v114, s86, v85
    v_dot2c_f32_bf16 v115, s87, v85
    v_dot2c_f32_bf16 v116, s86, v86
    v_dot2c_f32_bf16 v117, s87, v86
    v_dot2c_f32_bf16 v118, s86, v87
    v_dot2c_f32_bf16 v119, s87, v87
    s_waitcnt vmcnt(4)
    v_dot2c_f32_bf16 v112, s86, v88
    v_dot2c_f32_bf16 v113, s87, v88
    v_dot2c_f32_bf16 v114, s86, v89
    v_dot2c_f32_bf16 v115, s87, v89
    v_dot2c_f32_bf16 v116, s86, v90
    v_dot2c_f32_bf16 v117, s87, v90
    v_dot2c_f32_bf16 v118, s86, v91
    v_dot2c_f32_bf16 v119, s87, v91
    v_max3_u32 v4, v4, v87, v91
    s_waitcnt vmcnt(3)
    v_dot2c_f32_bf16 v112, s86, v92
    v_dot2c_f32_bf16 v113, s87, v92
    v_dot2c_f32_bf16 v114, s86, v93
    v_dot2c_f32_bf16 v115, s87, v93
    v_dot2c_f32_bf16 v116, s86, v94
    v_dot2c_f32_bf16 v117, s87, v94
    v_dot2c_f32_bf16 v118, s86, v95
    v_dot2c_f32_bf16 v119, s87, v95
    s_waitcnt vmcnt(2)
    v_dot2c_f32_bf16 v112, s86, v96
    v_dot2c_f32_bf16 v113, s87, v96
    v_dot2c_f32_bf16 v114, s86, v97
    v_dot2c_f32_bf16 v115, s87, v97
    v_dot2c_f32_bf16 v116, s86, v98
    v_dot2c_f32_bf16 v117, s87, v98
    v_dot2c_f32_bf16 v118, s86, v99
    v_dot2c_f32_bf16 v119, s87, v99
    v_max3_u32 v4, v4, v95, v99
    s_waitcnt vmcnt(1)
    v_dot2c_f32_bf16 v112, s86, v100
    v_dot2c_f32_bf16 v113, s87, v100
    v_dot2c_f32_bf16 v114, s86, v101
    v_dot2c_f32_bf16 v115, s87, v101
    v_dot2c_f32_bf16 v116, s86, v102
    v_dot2c_f32_bf16 v117, s87, v102
    v_dot2c_f32_bf16 v118, s86, v103
    v_dot2c_f32_bf16 v119, s87, v103
    s_waitcnt vmcnt(0)
    v_max3_u32 v4, v4, v103, v107
    v_add_f32_dpp v104, v104, v104 row_ror:8 row_mask:0xf bank_mask:0xf
    v_add_f32_dpp v105, v105, v105 row_ror:8 row_mask:0xf bank_mask:0xf
    v_add_f32_dpp v106, v106, v106 row_ror:8 row_mask:0xf bank_mask:0xf
    v_add_f32_dpp v107, v107, v107 row_ror:8 row_mask:0xf bank_mask:0xf
    v_cvt_pk_bf16_f32 v120, v112, v113
    v_cvt_pk_bf16_f32 v121, v114, v115
    v_cvt_pk_bf16_f32 v122, v116, v117
    v_cvt_pk_bf16_f32 v123, v118, v119
    ds_write_b128 v5, v[120:123]
    v_add_f32_dpp v104, v104, v104 row_ror:4 row_mask:0xf bank_mask:0xf
    v_add_f32_dpp v105, v105, v105 row_ror:4 row_mask:0xf bank_mask:0xf
    v_add_f32_dpp v106, v106, v106 row_ror:4 row_mask:0xf bank_mask:0xf
    v_add_f32_dpp v107, v107, v107 row_ror:4 row_mask:0xf bank_mask:0xf
    v_add_f32_dpp v104, v104, v104 row_ror:2 row_mask:0xf bank_mask:0xf
    v_add_f32_dpp v105, v105, v105 row_ror:2 row_mask:0xf bank_mask:0xf
    v_add_f32_dpp v106, v106, v106 row_ror:2 row_mask:0xf bank_mask:0xf
    v_add_f32_dpp v107, v107, v107 row_ror:2 row_mask:0xf bank_mask:0xf
    v_add_f32_dpp v104, v104, v104 row_ror:1 row_mask:0xf bank_mask:0xf
    v_add_f32_dpp v105, v105, v105 row_ror:1 row_mask:0xf bank_mask:0xf
    v_add_f32_dpp v106, v106, v106 row_ror:1 row_mask:0xf bank_mask:0xf
    v_add_f32_dpp v107, v107, v107 row_ror:1 row_mask:0xf bank_mask:0xf
    v_cmp_eq_u32 vcc, -1, v4
    v_cvt_pk_bf16_f32 v124, v104, v105
    v_cvt_pk_bf16_f32 v125, v106, v107
    ds_write_b64 v7, v[124:125] offset:2048
    s_cbranch_vccnz L_h1_again
L_h1_done:
    s_waitcnt lgkmcnt(0)
    s_barrier
    s_or_b32 s86, s2, s48
    s_cmp_eq_u32 s86, 0
    s_cselect_b32 s86, 0, 2147483648
    s_add_u32 s86, s86, 524288
    v_mov_b32 v6, s86
    buffer_store_dword v35, v6, s[16:19], 0 offen sc1
    v_mov_b32 v11, v30
    v_mov_b32 v14, v31
    v_mov_b32 v8, 0
    buffer_atomic_or v8, v159, s[16:19], 0 offen sc0 sc1
    s_branch L_phaseB
L_h1_p0:
    v_mov_b32 v4, 0
    buffer_atomic_or v4, v6, s[16:19], 0 offen sc0 sc1
L_h1_w0:
    s_waitcnt vmcnt(0)
    v_cmp_eq_u32 vcc, s68, v4
    s_nop 0
    s_andn2_b32 s65, vcc_lo, s88
    s_or_b32 s88, s88, s65
    s_cmp_lg_u32 s65, 0
    s_cbranch_scc1 L_h1_r0
    s_sub_u32 s56, s56, 1
    s_cbranch_scc0 L_h1_p0
    s_mov_b32 s56, 0
    s_not_b32 s65, s88
    s_branch L_h1_r0
L_h1_p1:
    v_mov_b32 v4, 0
    buffer_atomic_or v4, v6, s[16:19], 0 offen sc0 sc1
    s_waitcnt vmcnt(0)
    v_cmp_eq_u32 vcc, s68, v4
    s_nop 0
    s_andn2_b32 s65, vcc_lo, s88
    s_or_b32 s88, s88, s65
    s_cmp_lg_u32 s65, 0
    s_cbranch_scc1 L_h1_r1
    s_sub_u32 s56, s56, 1
    s_cbranch_scc0 L_h1_p1
    s_mov_b32 s56, 0
    s_not_b32 s65, s88
    s_branch L_h1_r1
L_h1_p2:
    v_mov_b32 v4, 0
    buffer_atomic_or v4, v6, s[16:19], 0 offen sc0 sc1
    s_waitcnt vmcnt(0)
    v_cmp_eq_u32 vcc, s68, v4
    s_nop 0
    s_andn2_b32 s65, vcc_lo, s88
    s_or_b32 s88, s88, s65
    s_cmp_lg_u32 s65, 0
    s_cbranch_scc1 L_h1_r2
    s_sub_u32 s56, s56, 1
    s_cbranch_scc0 L_h1_p2
    s_mov_b32 s56, 0
    s_not_b32 s65, s88
    s_branch L_h1_r2
L_h1_p3:
    v_mov_b32 v4, 0
    buffer_atomic_or v4, v6, s[16:19], 0 offen sc0 sc1
    s_waitcnt vmcnt(0)
    v_cmp_eq_u32 vcc, s68, v4
    s_nop 0
    s_andn2_b32 s65, vcc_lo, s88
    s_or_b32 s88, s88, s65
    s_cmp_lg_u32 s65, 0
    s_cbranch_scc1 L_h1_r3
    s_sub_u32 s56, s56, 1
    s_cbranch_scc0 L_h1_p3
    s_mov_b32 s56, 0
    s_not_b32 s65, s88
    s_branch L_h1_r3
L_h1_p4:
    v_mov_b32 v4, 0
    buffer_atomic_or v4, v6, s[16:19], 0 offen sc0 sc1
    s_waitcnt vmcnt(0)
    v_cmp_eq_u32 vcc, s68, v4
    s_nop 0
    s_andn2_b32 s65, vcc_lo, s88
    s_or_b32 s88, s88, s65
    s_cmp_lg_u32 s65, 0
    s_cbranch_scc1 L_h1_r4
    s_sub_u32 s56, s56, 1
    s_cbranch_scc0 L_h1_p4
    s_mov_b32 s56, 0
    s_not_b32 s65, s88
    s_branch L_h1_r4
L_h1_p5:
    v_mov_b32 v4, 0
    buffer_atomic_or v4, v6, s[16:19], 0 offen sc0 sc1
    s_waitcnt vmcnt(0)
    v_cmp_eq_u32 vcc, s68, v4
    s_nop 0
    s_andn2_b32 s65, vcc_lo, s88
    s_or_b32 s88, s88, s65
    s_cmp_lg_u32 s65, 0
    s_cbranch_scc1 L_h1_r5
    s_sub_u32 s56, s56, 1
    s_cbranch_scc0 L_h1_p5
    s_mov_b32 s56, 0
    s_not_b32 s65, s88
    s_branch L_h1_r5
L_h1_p6:
    v_mov_b32 v4, 0
    buffer_atomic_or v4, v6, s[16:19], 0 offen sc0 sc1
    s_waitcnt vmcnt(0)
    v_cmp_eq_u32 vcc, s68, v4
    s_nop 0
    s_andn2_b32 s65, vcc_lo, s88
    s_or_b32 s88, s88, s65
    s_cmp_lg_u32 s65, 0
    s_cbranch_scc1 L_h1_r6
    s_sub_u32 s56, s56, 1
    s_cbranch_scc0 L_h1_p6
    s_mov_b32 s56, 0
    s_not_b32 s65, s88
    s_branch L_h1_r6
L_h1_p7:
    v_mov_b32 v4, 0
    buffer_atomic_or v4, v6, s[16:19], 0 offen sc0 sc1
    s_waitcnt vmcnt(0)
    v_cmp_eq_u32 vcc, s68, v4
    s_nop 0
    s_andn2_b32 s65, vcc_lo, s88
    s_or_b32 s88, s88, s65
    s_cmp_lg_u32 s65, 0
    s_cbranch_scc1 L_h1_r7
    s_sub_u32 s56, s56, 1
    s_cbranch_scc0 L_h1_p7
    s_mov_b32 s56, 0
    s_not_b32 s65, s88
    s_branch L_h1_r7
L_walk_8:
    s_cbranch_execz L_walk_15
L_h1_p8:
    v_mov_b32 v4, 0
    buffer_atomic_or v4, v6, s[16:19], 0 offen sc0 sc1
    s_waitcnt vmcnt(0)
    v_cmp_eq_u32 vcc, s68, v4
    s_nop 0
    s_andn2_b32 s65, vcc_lo, s88
    s_or_b32 s88, s88, s65
    s_cmp_lg_u32 s65, 0
    s_cbranch_scc1 L_h1_r8
    s_sub_u32 s56, s56, 1
    s_cbranch_scc0 L_h1_p8
    s_mov_b32 s56, 0
    s_not_b32 s65, s88
    s_branch L_h1_r8
L_h1_p9:
    v_mov_b32 v4, 0
    buffer_atomic_or v4, v6, s[16:19], 0 offen sc0 sc1
    s_waitcnt vmcnt(0)
    v_cmp_eq_u32 vcc, s68, v4
    s_nop 0
    s_andn2_b32 s65, vcc_lo, s88
    s_or_b32 s88, s88, s65
    s_cmp_lg_u32 s65, 0
    s_cbranch_scc1 L_h1_r9
    s_sub_u32 s56, s56, 1
    s_cbranch_scc0 L_h1_p9
    s_mov_b32 s56, 0
    s_not_b32 s65, s88
    s_branch L_h1_r9
L_h1_p10:
    v_mov_b32 v4, 0
    buffer_atomic_or v4, v6, s[16:19], 0 offen sc0 sc1
    s_waitcnt vmcnt(0)
    v_cmp_eq_u32 vcc, s68, v4
    s_nop 0
    s_andn2_b32 s65, vcc_lo, s88
    s_or_b32 s88, s88, s65
    s_cmp_lg_u32 s65, 0
    s_cbranch_scc1 L_h1_r10
    s_sub_u32 s56, s56, 1
    s_cbranch_scc0 L_h1_p10
    s_mov_b32 s56, 0
    s_not_b32 s65, s88
    s_branch L_h1_r10
L_h1_p11:
    v_mov_b32 v4, 0
    buffer_atomic_or v4, v6, s[16:19], 0 offen sc0 sc1
    s_waitcnt vmcnt(0)
    v_cmp_eq_u32 vcc, s68, v4
    s_nop 0
    s_andn2_b32 s65, vcc_lo, s88
    s_or_b32 s88, s88, s65
    s_cmp_lg_u32 s65, 0
    s_cbranch_scc1 L_h1_r11
    s_sub_u32 s56, s56, 1
    s_cbranch_scc0 L_h1_p11
    s_mov_b32 s56, 0
    s_not_b32 s65, s88
    s_branch L_h1_r11
L_h1_p12:
    v_mov_b32 v4, 0
    buffer_atomic_or v4, v6, s[16:19], 0 offen sc0 sc1
    s_waitcnt vmcnt(0)
    v_cmp_eq_u32 vcc, s68, v4
    s_nop 0
    s_andn2_b32 s65, vcc_lo, s88
    s_or_b32 s88, s88, s65
    s_cmp_lg_u32 s65, 0
    s_cbranch_scc1 L_h1_r12
    s_sub_u32 s56, s56, 1
    s_cbranch_scc0 L_h1_p12
    s_mov_b32 s56, 0
    s_not_b32 s65, s88
    s_branch L_h1_r12
L_h1_p13:
    v_mov_b32 v4, 0
    buffer_atomic_or v4, v6, s[16:19], 0 offen sc0 sc1
    s_waitcnt vmcnt(0)
    v_cmp_eq_u32 vcc, s68, v4
    s_nop 0
    s_andn2_b32 s65, vcc_lo, s88
    s_or_b32 s88, s88, s65
    s_cmp_lg_u32 s65, 0
    s_cbranch_scc1 L_h1_r13
    s_sub_u32 s56, s56, 1
    s_cbranch_scc0 L_h1_p13
    s_mov_b32 s56, 0
    s_not_b32 s65, s88
    s_branch L_h1_r13
L_h1_p14:
    v_mov_b32 v4, 0
    buffer_atomic_or v4, v6, s[16:19], 0 offen sc0 sc1
    s_waitcnt vmcnt(0)
    v_cmp_eq_u32 vcc, s68, v4
    s_nop 0
    s_andn2_b32 s65, vcc_lo, s88
    s_or_b32 s88, s88, s65
    s_cmp_lg_u32 s65, 0
    s_cbranch_scc1 L_h1_r14
    s_sub_u32 s56, s56, 1
    s_cbranch_scc0 L_h1_p14
    s_mov_b32 s56, 0
    s_not_b32 s65, s88
    s_branch L_h1_r14
L_h1_p15:
    v_mov_b32 v4, 0
    buffer_atomic_or v4, v6, s[16:19], 0 offen sc0 sc1
    s_waitcnt vmcnt(0)
    v_cmp_eq_u32 vcc, s68, v4
    s_nop 0
    s_andn2_b32 s65, vcc_lo, s88
    s_or_b32 s88, s88, s65
    s_cmp_lg_u32 s65, 0
    s_cbranch_scc1 L_h1_r15
    s_sub_u32 s56, s56, 1
    s_cbranch_scc0 L_h1_p15
    s_mov_b32 s56, 0
    s_not_b32 s65, s88
    s_branch L_h1_r15
L_h1_again:
    s_sub_u32 s56, s56, 1
    s_cbranch_scc0 L_h1_re
    s_mov_b32 s56, 0
    s_branch L_h1_done
L_h1_re:
    buffer_load_dwordx4 v[40:43], v2, s[16:19], 0 offen offset:0 sc1
    buffer_load_dwordx4 v[44:47], v2, s[16:19], 0 offen offset:1024 sc1
    buffer_load_dwordx4 v[48:51], v2, s[16:19], 0 offen offset:2048 sc1
    buffer_load_dwordx4 v[52:55], v2, s[16:19], 0 offen offset:3072 sc1
    buffer_load_dwordx4 v[56:59], v2, s[16:19], s92 offen offset:0 sc1
    buffer_load_dwordx4 v[60:63], v2, s[16:19], s92 offen offset:1024 sc1
    buffer_load_dwordx4 v[64:67], v2, s[16:19], s92 offen offset:2048 sc1
    buffer_load_dwordx4 v[68:71], v2, s[16:19], s92 offen offset:3072 sc1
    buffer_load_dwordx4 v[72:75], v2, s[16:19], s93 offen offset:0 sc1
    buffer_load_dwordx4 v[76:79], v2, s[16:19], s93 offen offset:1024 sc1
    buffer_load_dwordx4 v[80:83], v2, s[16:19], s93 offen offset:2048 sc1
    buffer_load_dwordx4 v[84:87], v2, s[16:19], s93 offen offset:3072 sc1
    buffer_load_dwordx4 v[88:91], v2, s[16:19], s94 offen offset:0 sc1
    buffer_load_dwordx4 v[92:95], v2, s[16:19], s94 offen offset:1024 sc1
    buffer_load_dwordx4 v[96:99], v2, s[16:19], s94 offen offset:2048 sc1
    buffer_load_dwordx4 v[100:103], v2, s[16:19], s94 offen offset:3072 sc1
    buffer_load_dwordx4 v[104:107], v3, s[16:19], 0 offen sc1
    v_mov_b32 v112, 0
    v_mov_b32 v113, 0
    v_mov_b32 v114, 0
    v_mov_b32 v115, 0
    v_mov_b32 v116, 0
    v_mov_b32 v117, 0
    v_mov_b32 v118, 0
    v_mov_b32 v119, 0
    s_branch L_h1_acc
L_comp:
    s_mov_b64 exec, -1
    v_and_b32 v20, 15, v0
    v_lshrrev_b32 v21, 4, v0
    v_bfe_u32 v22, v0, 1, 3
    s_lshl_b32 s86, s49, 13
    v_lshl_add_u32 v20, v20, 7, s86
    v_or_b32 v23, 0, v21
    v_xor_b32 v23, v23, v22
    v_lshl_add_u32 v2, v23, 4, v20
    v_or_b32 v23, 4, v21
    v_xor_b32 v23, v23, v22
    v_lshl_add_u32 v3, v23, 4, v20
    v_bfe_u32 v22, v0, 2, 2
    v_lshl_add_u32 v22, v21, 3, v22
    v_lshlrev_b32 v22, 7, v22
    v_bfe_u32 v23, v0, 3, 2
    s_lshl_b32 s86, s50, 1
    v_xor_b32 v23, s86, v23
    v_lshl_add_u32 v22, v23, 5, v22
    v_and_b32 v23, 3, v0
    v_lshl_add_u32 v22, v23, 3, v22
    v_add_u32 v4, 16384, v22
    v_xor_b32 v5, 32, v4
    s_lshl_b32 s53, s2, 2
    s_add_u32 s53, s53, s3
    s_lshl_b32 s86, s53, 12
    s_add_u32 s86, s86, 1048576
    v_lshl_add_u32 v6, v0, 4, s86
    s_mul_i32 s53, s53, 160
    s_add_u32 s53, s53, 6553600
    v_lshl_add_u32 v17, v0, 4, s53
    v_mov_b32 v16, 2147483648
    v_cmp_gt_u32 vcc, 10, v0
    s_nop 1
    v_cndmask_b32 v17, v16, v17, vcc
    s_lshl_b32 s86, s47, 1
    s_add_u32 s86, s86, s50
    s_lshl_b32 s87, s86, 4
    s_add_u32 s87, s87, s46
    s_lshl_b32 s87, s87, 1
    s_add_u32 s87, s87, s49
    s_lshl_b32 s87, s87, 6
    s_add_u32 s87, s87, 6880320
    v_lshl_add_u32 v16, v0, 4, s87
    v_cmp_le_u32 vcc, 60, v0
    s_nop 1
    v_cndmask_b32 v17, v17, v16, vcc
    s_lshl_b32 s87, s86, 1
    s_add_u32 s87, s87, s49
    s_lshl_b32 s87, s87, 4
    s_add_u32 s87, s87, s46
    s_lshl_b32 s87, s87, 10
    s_add_u32 s87, s87, 5242880
    v_lshl_add_u32 v16, v0, 4, s87
    v_mov_b32 v8, -1
    v_mov_b32 v9, -1
    v_mov_b32 v10, -1
    v_mov_b32 v11, -1
    s_waitcnt lgkmcnt(0)
    s_load_dword s61, s[84:85], 524288
    s_mov_b32 s16, s84
    s_and_b32 s17, s85, 0xffff
    s_mov_b32 s18, 268435456
    s_mov_b32 s19, 0x20000
    s_mov_b32 s8, s64
    s_and_b32 s9, s65, 0xffff
    s_mov_b32 s10, 4194304
    s_mov_b32 s11, 0x20000
    s_mov_b32 s20, s68
    s_and_b32 s21, s69, 0xffff
    s_mov_b32 s22, 2097152
    s_mov_b32 s23, 0x20000
    s_mov_b32 s24, s80
    s_and_b32 s25, s81, 0xffff
    s_mov_b32 s26, 4194304
    s_mov_b32 s27, 0x20000
    s_mov_b32 s28, s82
    s_and_b32 s29, s83, 0xffff
    s_mov_b32 s30, 256
    s_mov_b32 s31, 0x20000
    s_bitcmp1_b32 s2, 0
    s_cselect_b32 s32, s76, s74
    s_cselect_b32 s33, s77, s75
    s_and_b32 s33, s33, 0xffff
    s_mov_b32 s34, 7340032
    s_mov_b32 s35, 0x20000
    s_mov_b32 s36, s78
    s_and_b32 s37, s79, 0xffff
    s_mov_b32 s38, 7340032
    s_mov_b32 s39, 0x20000
    s_mov_b32 s40, s72
    s_and_b32 s41, s73, 0xffff
    s_mov_b32 s42, 2048
    s_mov_b32 s43, 0x20000
    s_lshl_b32 s86, s2, 9
    s_add_u32 s86, s86, 786432
    s_cmp_eq_u32 s3, 0
    s_cselect_b32 s86, s86, 2147483648
    v_lshl_add_u32 v7, v0, 2, s86
    v_mul_u32_u24 v12, 192, v21
    v_add_u32 v7, v7, v12
    s_lshl_b32 s86, s2, 8
    s_add_u32 s86, s86, 917376
    s_cmp_eq_u32 s3, 0
    s_cselect_b32 s86, s86, 2147483648
    v_lshl_add_u32 v12, v0, 2, s86
    v_cmp_gt_u32 vcc, 32, v0
    s_nop 1
    v_cndmask_b32 v7, v12, v7, vcc
    v_mov_b32 v12, 2147483648
    v_cmp_gt_u32 vcc, 48, v0
    s_nop 1
    v_cndmask_b32 v7, v12, v7, vcc
    s_lshl_b32 s86, s2, 9
    s_add_u32 s86, s86, 6291456
    v_lshl_add_u32 v13, v0, 2, s86
    v_mul_u32_u24 v12, 64, v21
    v_add_u32 v13, v13, v12
    s_cmp_eq_u32 s3, 1
    s_cselect_b64 vcc, -1, 0
    v_cndmask_b32 v7, v7, v13, vcc
    v_mov_b32 v12, 0
    buffer_store_dword v12, v7, s[16:19], 0 offen sc1
    v_mov_b32 v128, 0
    v_mov_b32 v129, 0
    v_mov_b32 v130, 0
    v_mov_b32 v131, 0
    v_mov_b32 v132, 0
    v_mov_b32 v133, 0
    v_mov_b32 v134, 0
    v_mov_b32 v135, 0
    v_mov_b32 v136, 0
    v_mov_b32 v137, 0
    v_mov_b32 v138, 0
    v_mov_b32 v139, 0
    v_mov_b32 v140, 0
    v_mov_b32 v141, 0
    v_mov_b32 v142, 0
    v_mov_b32 v143, 0
    v_mov_b32 v144, 0
    v_mov_b32 v145, 0
    v_mov_b32 v146, 0
    v_mov_b32 v147, 0
    v_mov_b32 v148, 0
    v_mov_b32 v149, 0
    v_mov_b32 v150, 0
    v_mov_b32 v151, 0
    v_mov_b32 v152, 0
    v_mov_b32 v153, 0
    v_mov_b32 v154, 0
    v_mov_b32 v155, 0
    v_mov_b32 v156, 0
    v_mov_b32 v157, 0
    v_mov_b32 v158, 0
    v_mov_b32 v159, 0
    v_mov_b32 v160, 0
    v_mov_b32 v161, 0
    v_mov_b32 v162, 0
    v_mov_b32 v163, 0
    v_mov_b32 v164, 0
    v_mov_b32 v165, 0
    v_mov_b32 v166, 0
    v_mov_b32 v167, 0
    v_mov_b32 v168, 0
    v_mov_b32 v169, 0
    v_mov_b32 v170, 0
    v_mov_b32 v171, 0
    v_mov_b32 v172, 0
    v_mov_b32 v173, 0
    v_mov_b32 v174, 0
    v_mov_b32 v175, 0
    v_mov_b32 v176, 0
    v_mov_b32 v177, 0
    v_mov_b32 v178, 0
    v_mov_b32 v179, 0
    v_mov_b32 v180, 0
    v_mov_b32 v181, 0
    v_mov_b32 v182, 0
    v_mov_b32 v183, 0
    v_mov_b32 v184, 0
    v_mov_b32 v185, 0
    v_mov_b32 v186, 0
    v_mov_b32 v187, 0
    v_mov_b32 v188, 0
    v_mov_b32 v189, 0
    v_mov_b32 v190, 0
    v_mov_b32 v191, 0
    v_mov_b32 v192, 0
    v_mov_b32 v193, 0
    v_mov_b32 v194, 0
    v_mov_b32 v195, 0
    v_mov_b32 v196, 0
    v_mov_b32 v197, 0
    v_mov_b32 v198, 0
    v_mov_b32 v199, 0
    v_mov_b32 v200, 0
    v_mov_b32 v201, 0
    v_mov_b32 v202, 0
    v_mov_b32 v203, 0
    v_mov_b32 v204, 0
    v_mov_b32 v205, 0
    v_mov_b32 v206, 0
    v_mov_b32 v207, 0
    v_mov_b32 v208, 0
    v_mov_b32 v209, 0
    v_mov_b32 v210, 0
    v_mov_b32 v211, 0
    v_mov_b32 v212, 0
    v_mov_b32 v213, 0
    v_mov_b32 v214, 0
    v_mov_b32 v215, 0
    v_mov_b32 v216, 0
    v_mov_b32 v217, 0
L_walkA2:
    s_cbranch_execz L_comp
    v_mov_b32 v218, 0
    v_mov_b32 v219, 0
    v_mov_b32 v220, 0
    v_mov_b32 v221, 0
    v_mov_b32 v222, 0
    v_mov_b32 v223, 0
    s_mov_b32 s54, 0x358637bd
    s_mov_b32 s55, 0x358637bd
    s_mov_b32 s62, 0
    s_mov_b32 s63, 1
    v_add_u32 v2, 40960, v2
    v_add_u32 v3, 40960, v3
    v_add_u32 v4, 40960, v4
    v_add_u32 v5, 40960, v5
    s_mov_b64 exec, 0
    s_cmp_eq_u32 s3, 0
    s_cbranch_scc1 L_walkB0
    s_cmp_eq_u32 s3, 1
    s_cbranch_scc1 L_walkB1
    s_cmp_eq_u32 s3, 2
    s_cbranch_scc1 L_walkB2
    s_branch L_walkB3
L_walked:
    s_mov_b64 exec, -1
    s_waitcnt lgkmcnt(0)
    s_add_u32 s68, s61, 0x9e3779b9
    s_barrier
    ds_read_b128 v[40:43], v2 offset:0
    ds_read_b128 v[44:47], v2 offset:2048
    ds_read_b128 v[48:51], v2 offset:4096
    ds_read_b128 v[52:55], v2 offset:6144
    ds_read_b64_tr_b16 v[56:57], v4 offset:0
    ds_read_b64_tr_b16 v[58:59], v4 offset:512
    ds_read_b64_tr_b16 v[60:61], v5 offset:0
    ds_read_b64_tr_b16 v[62:63], v5 offset:512
    ds_read_b64_tr_b16 v[64:65], v4 offset:8192
    ds_read_b64_tr_b16 v[66:67], v4 offset:8704
    ds_read_b64_tr_b16 v[68:69], v5 offset:8192
    ds_read_b64_tr_b16 v[70:71], v5 offset:8704
    ds_read_b64_tr_b16 v[72:73], v4 offset:16384
    ds_read_b64_tr_b16 v[74:75], v4 offset:16896
    ds_read_b64_tr_b16 v[76:77], v5 offset:16384
    ds_read_b64_tr_b16 v[78:79], v5 offset:16896
L_cloop:
    s_waitcnt lgkmcnt(0)
    v_mfma_f32_16x16x32_bf16 v[128:131], v[56:59], v[40:43], v[128:131]
    ds_read_b128 v[80:83], v3 offset:0
    v_mfma_f32_16x16x32_bf16 v[132:135], v[56:59], v[44:47], v[132:135]
    ds_read_b128 v[84:87], v3 offset:2048
    v_mfma_f32_16x16x32_bf16 v[136:139], v[56:59], v[48:51], v[136:139]
    ds_read_b128 v[88:91], v3 offset:4096
    v_mfma_f32_16x16x32_bf16 v[140:143], v[56:59], v[52:55], v[140:143]
    ds_read_b128 v[92:95], v3 offset:6144
    v_mfma_f32_16x16x32_bf16 v[144:147], v[60:63], v[40:43], v[144:147]
    ds_read_b64_tr_b16 v[96:97], v4 offset:4096
    v_mfma_f32_16x16x32_bf16 v[148:151], v[60:63], v[44:47], v[148:151]
    ds_read_b64_tr_b16 v[98:99], v4 offset:4608
    v_mfma_f32_16x16x32_bf16 v[152:155], v[60:63], v[48:51], v[152:155]
    ds_read_b64_tr_b16 v[100:101], v5 offset:4096
    v_mfma_f32_16x16x32_bf16 v[156:159], v[60:63], v[52:55], v[156:159]
    ds_read_b64_tr_b16 v[102:103], v5 offset:4608
    v_mfma_f32_16x16x32_bf16 v[160:163], v[40:43], v[64:67], v[160:163]
    ds_read_b64_tr_b16 v[104:105], v4 offset:12288
    v_mfma_f32_16x16x32_bf16 v[164:167], v[44:47], v[64:67], v[164:167]
    ds_read_b64_tr_b16 v[106:107], v4 offset:12800
    v_mfma_f32_16x16x32_bf16 v[168:171], v[48:51], v[64:67], v[168:171]
    ds_read_b64_tr_b16 v[108:109], v5 offset:12288
    v_mfma_f32_16x16x32_bf16 v[172:175], v[52:55], v[64:67], v[172:175]
    ds_read_b64_tr_b16 v[110:111], v5 offset:12800
    v_mfma_f32_16x16x32_bf16 v[176:179], v[40:43], v[68:71], v[176:179]
    ds_read_b64_tr_b16 v[112:113], v4 offset:20480
    v_mfma_f32_16x16x32_bf16 v[180:183], v[44:47], v[68:71], v[180:183]
    ds_read_b64_tr_b16 v[114:115], v4 offset:20992
    v_mfma_f32_16x16x32_bf16 v[184:187], v[48:51], v[68:71], v[184:187]
    ds_read_b64_tr_b16 v[116:117], v5 offset:20480
    v_mfma_f32_16x16x32_bf16 v[188:191], v[52:55], v[68:71], v[188:191]
    ds_read_b64_tr_b16 v[118:119], v5 offset:20992
    v_mfma_f32_16x16x32_bf16 v[192:195], v[40:43], v[72:75], v[192:195]
    s_add_u32 s63, s63, 1
    s_cmp_eq_u32 s63, 4
    s_cselect_b32 s53, 4294803456, 0
    s_cselect_b32 s63, 0, s63
    s_add_u32 s53, s53, 40960
    v_mfma_f32_16x16x32_bf16 v[196:199], v[44:47], v[72:75], v[196:199]
    v_add_u32 v2, s53, v2
    v_mfma_f32_16x16x32_bf16 v[200:203], v[48:51], v[72:75], v[200:203]
    v_add_u32 v4, s53, v4
    v_mfma_f32_16x16x32_bf16 v[204:207], v[52:55], v[72:75], v[204:207]
    v_add_u32 v5, s53, v5
    v_mfma_f32_16x16x32_bf16 v[208:211], v[40:43], v[76:79], v[208:211]
    v_add_u32 v3, s53, v3
    v_mfma_f32_16x16x32_bf16 v[212:215], v[44:47], v[76:79], v[212:215]
    s_cmp_ge_u32 s62, 6
    s_cbranch_scc1 L_cl_none
    buffer_store_dwordx4 v[8:11], v6, s[16:19], 0 offen sc1
    v_add_u32 v6, 1024, v6
    s_cmp_lt_u32 s62, 3
    s_cbranch_scc1 L_cl_none
    v_mov_b32 v6, v16
    v_mov_b32 v16, v17
L_cl_none:
    v_mfma_f32_16x16x32_bf16 v[216:219], v[48:51], v[76:79], v[216:219]
    v_mfma_f32_16x16x32_bf16 v[220:223], v[52:55], v[76:79], v[220:223]
    s_waitcnt lgkmcnt(0)
    v_mfma_f32_16x16x32_bf16 v[128:131], v[96:99], v[80:83], v[128:131]
    s_barrier
    ds_read_b128 v[40:43], v2 offset:0
    v_mfma_f32_16x16x32_bf16 v[132:135], v[96:99], v[84:87], v[132:135]
    ds_read_b128 v[44:47], v2 offset:2048
    v_mfma_f32_16x16x32_bf16 v[136:139], v[96:99], v[88:91], v[136:139]
    ds_read_b128 v[48:51], v2 offset:4096
    v_mfma_f32_16x16x32_bf16 v[140:143], v[96:99], v[92:95], v[140:143]
    ds_read_b128 v[52:55], v2 offset:6144
    v_mfma_f32_16x16x32_bf16 v[144:147], v[100:103], v[80:83], v[144:147]
    ds_read_b64_tr_b16 v[56:57], v4 offset:0
    v_mfma_f32_16x16x32_bf16 v[148:151], v[100:103], v[84:87], v[148:151]
    ds_read_b64_tr_b16 v[58:59], v4 offset:512
    v_mfma_f32_16x16x32_bf16 v[152:155], v[100:103], v[88:91], v[152:155]
    ds_read_b64_tr_b16 v[60:61], v5 offset:0
    v_mfma_f32_16x16x32_bf16 v[156:159], v[100:103], v[92:95], v[156:159]
    ds_read_b64_tr_b16 v[62:63], v5 offset:512
    v_mfma_f32_16x16x32_bf16 v[160:163], v[80:83], v[104:107], v[160:163]
    ds_read_b64_tr_b16 v[64:65], v4 offset:8192
    v_mfma_f32_16x16x32_bf16 v[164:167], v[84:87], v[104:107], v[164:167]
    ds_read_b64_tr_b16 v[66:67], v4 offset:8704
    v_mfma_f32_16x16x32_bf16 v[168:171], v[88:91], v[104:107], v[168:171]
    ds_read_b64_tr_b16 v[68:69], v5 offset:8192
    v_mfma_f32_16x16x32_bf16 v[172:175], v[92:95], v[104:107], v[172:175]
    ds_read_b64_tr_b16 v[70:71], v5 offset:8704
    v_mfma_f32_16x16x32_bf16 v[176:179], v[80:83], v[108:111], v[176:179]
    ds_read_b64_tr_b16 v[72:73], v4 offset:16384
    v_mfma_f32_16x16x32_bf16 v[180:183], v[84:87], v[108:111], v[180:183]
    ds_read_b64_tr_b16 v[74:75], v4 offset:16896
    v_mfma_f32_16x16x32_bf16 v[184:187], v[88:91], v[108:111], v[184:187]
    ds_read_b64_tr_b16 v[76:77], v5 offset:16384
    v_mfma_f32_16x16x32_bf16 v[188:191], v[92:95], v[108:111], v[188:191]
    ds_read_b64_tr_b16 v[78:79], v5 offset:16896
    v_mfma_f32_16x16x32_bf16 v[192:195], v[80:83], v[112:115], v[192:195]
    v_mfma_f32_16x16x32_bf16 v[196:199], v[84:87], v[112:115], v[196:199]
    s_cmp_lg_u32 s62, 8
    s_cbranch_scc1 L_cl_nw
    s_waitcnt vmcnt(0)
L_cl_nw:
    v_mfma_f32_16x16x32_bf16 v[200:203], v[88:91], v[112:115], v[200:203]
    v_mfma_f32_16x16x32_bf16 v[204:207], v[92:95], v[112:115], v[204:207]
    v_mfma_f32_16x16x32_bf16 v[208:211], v[80:83], v[116:119], v[208:211]
    s_add_u32 s62, s62, 1
    v_mfma_f32_16x16x32_bf16 v[212:215], v[84:87], v[116:119], v[212:215]
    v_mfma_f32_16x16x32_bf16 v[216:219], v[88:91], v[116:119], v[216:219]
    v_mfma_f32_16x16x32_bf16 v[220:223], v[92:95], v[116:119], v[220:223]
    s_cmp_lt_u32 s62, 15
    s_cbranch_scc1 L_cloop
    s_waitcnt lgkmcnt(0)
    v_mfma_f32_16x16x32_bf16 v[128:131], v[56:59], v[40:43], v[128:131]
    ds_read_b128 v[80:83], v3 offset:0
    v_mfma_f32_16x16x32_bf16 v[132:135], v[56:59], v[44:47], v[132:135]
    ds_read_b128 v[84:87], v3 offset:2048
    v_mfma_f32_16x16x32_bf16 v[136:139], v[56:59], v[48:51], v[136:139]
    ds_read_b128 v[88:91], v3 offset:4096
    v_mfma_f32_16x16x32_bf16 v[140:143], v[56:59], v[52:55], v[140:143]
    ds_read_b128 v[92:95], v3 offset:6144
L_walkB2:
    s_cbranch_execz L_walk_6
    v_mfma_f32_16x16x32_bf16 v[144:147], v[60:63], v[40:43], v[144:147]
    ds_read_b64_tr_b16 v[96:97], v4 offset:4096
    v_mfma_f32_16x16x32_bf16 v[148:151], v[60:63], v[44:47], v[148:151]
    ds_read_b64_tr_b16 v[98:99], v4 offset:4608
    v_mfma_f32_16x16x32_bf16 v[152:155], v[60:63], v[48:51], v[152:155]
    ds_read_b64_tr_b16 v[100:101], v5 offset:4096
    v_mfma_f32_16x16x32_bf16 v[156:159], v[60:63], v[52:55], v[156:159]
    ds_read_b64_tr_b16 v[102:103], v5 offset:4608
    v_mfma_f32_16x16x32_bf16 v[160:163], v[40:43], v[64:67], v[160:163]
    ds_read_b64_tr_b16 v[104:105], v4 offset:12288
    v_mfma_f32_16x16x32_bf16 v[164:167], v[44:47], v[64:67], v[164:167]
    ds_read_b64_tr_b16 v[106:107], v4 offset:12800
    v_mfma_f32_16x16x32_bf16 v[168:171], v[48:51], v[64:67], v[168:171]
    ds_read_b64_tr_b16 v[108:109], v5 offset:12288
    v_mfma_f32_16x16x32_bf16 v[172:175], v[52:55], v[64:67], v[172:175]
    ds_read_b64_tr_b16 v[110:111], v5 offset:12800
    v_mfma_f32_16x16x32_bf16 v[176:179], v[40:43], v[68:71], v[176:179]
    ds_read_b64_tr_b16 v[112:113], v4 offset:20480
    v_mfma_f32_16x16x32_bf16 v[180:183], v[44:47], v[68:71], v[180:183]
    ds_read_b64_tr_b16 v[114:115], v4 offset:20992
    v_mfma_f32_16x16x32_bf16 v[184:187], v[48:51], v[68:71], v[184:187]
    ds_read_b64_tr_b16 v[116:117], v5 offset:20480
    v_mfma_f32_16x16x32_bf16 v[188:191], v[52:55], v[68:71], v[188:191]
    ds_read_b64_tr_b16 v[118:119], v5 offset:20992
    v_mfma_f32_16x16x32_bf16 v[192:195], v[40:43], v[72:75], v[192:195]
    v_lshrrev_b32 v21, 4, v0
    v_and_b32 v22, 15, v0
    v_mfma_f32_16x16x32_bf16 v[196:199], v[44:47], v[72:75], v[196:199]
    s_lshl_b32 s86, s49, 8
    s_add_u32 s86, s86, 131072
    v_lshl_add_u32 v6, v21, 4, s86
    v_mfma_f32_16x16x32_bf16 v[200:203], v[48:51], v[72:75], v[200:203]
    v_lshl_add_u32 v7, v22, 2, s86
    v_mfma_f32_16x16x32_bf16 v[204:207], v[52:55], v[72:75], v[204:207]
    s_lshl_b32 s86, s50, 7
    s_add_u32 s86, s86, 132608
    v_lshl_add_u32 v8, v22, 2, s86
    v_mfma_f32_16x16x32_bf16 v[208:211], v[40:43], v[76:79], v[208:211]
    v_lshl_add_u32 v9, v21, 4, s86
    v_mfma_f32_16x16x32_bf16 v[212:215], v[44:47], v[76:79], v[212:215]
    s_lshl_b32 s86, s3, 2
    s_add_u32 s86, s86, 135168
    v_mov_b32 v12, s86
    v_mfma_f32_16x16x32_bf16 v[216:219], v[48:51], v[76:79], v[216:219]
    v_xor_b32 v13, 4, v12
    v_mfma_f32_16x16x32_bf16 v[220:223], v[52:55], v[76:79], v[220:223]
    s_waitcnt lgkmcnt(0)
    v_mfma_f32_16x16x32_bf16 v[160:163], v[80:83], v[104:107], v[160:163]
    v_mfma_f32_16x16x32_bf16 v[164:167], v[84:87], v[104:107], v[164:167]
    v_mfma_f32_16x16x32_bf16 v[168:171], v[88:91], v[104:107], v[168:171]
    v_mfma_f32_16x16x32_bf16 v[172:175], v[92:95], v[104:107], v[172:175]
    v_mfma_f32_16x16x32_bf16 v[176:179], v[80:83], v[108:111], v[176:179]
    v_mfma_f32_16x16x32_bf16 v[180:183], v[84:87], v[108:111], v[180:183]
    v_mfma_f32_16x16x32_bf16 v[184:187], v[88:91], v[108:111], v[184:187]
    v_mfma_f32_16x16x32_bf16 v[188:191], v[92:95], v[108:111], v[188:191]
    v_mfma_f32_16x16x32_bf16 v[192:195], v[80:83], v[112:115], v[192:195]
    v_mfma_f32_16x16x32_bf16 v[196:199], v[84:87], v[112:115], v[196:199]
    v_mfma_f32_16x16x32_bf16 v[200:203], v[88:91], v[112:115], v[200:203]
    v_mfma_f32_16x16x32_bf16 v[204:207], v[92:95], v[112:115], v[204:207]
    v_mfma_f32_16x16x32_bf16 v[208:211], v[80:83], v[116:119], v[208:211]
    s_barrier
    ds_read_b128 v[40:43], v6 offset:0
    ds_read_b128 v[44:47], v6 offset:64
    v_mfma_f32_16x16x32_bf16 v[212:215], v[84:87], v[116:119], v[212:215]
    ds_read_b128 v[48:51], v6 offset:128
    ds_read_b128 v[52:55], v6 offset:192
    v_mfma_f32_16x16x32_bf16 v[216:219], v[88:91], v[116:119], v[216:219]
    ds_read_b32 v72, v8 offset:256
    ds_read_b32 v73, v8 offset:320
    v_mfma_f32_16x16x32_bf16 v[220:223], v[92:95], v[116:119], v[220:223]
    ds_read_b32 v74, v8 offset:512
    ds_read_b32 v75, v8 offset:576
    v_mfma_f32_16x16x32_bf16 v[128:131], v[96:99], v[80:83], v[128:131]
    ds_read_b128 v[56:59], v6 offset:512
    ds_read_b128 v[60:63], v6 offset:576
    v_mfma_f32_16x16x32_bf16 v[132:135], v[96:99], v[84:87], v[132:135]
    ds_read_b128 v[64:67], v6 offset:640
    ds_read_b128 v[68:71], v6 offset:704
    v_mfma_f32_16x16x32_bf16 v[136:139], v[96:99], v[88:91], v[136:139]
    ds_read_b128 v[224:227], v6 offset:1024
    ds_read_b128 v[228:231], v6 offset:1088
    v_mfma_f32_16x16x32_bf16 v[140:143], v[96:99], v[92:95], v[140:143]
    ds_read_b128 v[232:235], v6 offset:1152
    ds_read_b128 v[236:239], v6 offset:1216
    v_mfma_f32_16x16x32_bf16 v[144:147], v[100:103], v[80:83], v[144:147]
    ds_read_b128 v[28:31], v9 offset:0
    ds_read_b128 v[32:35], v9 offset:64
    v_mfma_f32_16x16x32_bf16 v[148:151], v[100:103], v[84:87], v[148:151]
    v_mfma_f32_16x16x32_bf16 v[152:155], v[100:103], v[88:91], v[152:155]
    v_mfma_f32_16x16x32_bf16 v[156:159], v[100:103], v[92:95], v[156:159]
    ds_read_b32 v240, v7 offset:0
    ds_read_b32 v244, v7 offset:512
    ds_read_b32 v248, v7 offset:1024
    ds_read_b32 v241, v7 offset:64
    ds_read_b32 v245, v7 offset:576
    ds_read_b32 v249, v7 offset:1088
    ds_read_b32 v242, v7 offset:128
    ds_read_b32 v246, v7 offset:640
    ds_read_b32 v250, v7 offset:1152
    ds_read_b32 v243, v7 offset:192
    ds_read_b32 v247, v7 offset:704
    ds_read_b32 v251, v7 offset:1216
    s_waitcnt lgkmcnt(12)
    v_pk_fma_f32 v[160:161], v[40:41], v[72:73], v[160:161] op_sel_hi:[1,0,1]
    v_pk_mul_f32 v[112:113], v[160:161], v[224:225]
    v_pk_fma_f32 v[160:161], v[160:161], v[56:57], s[54:55]
    v_exp_f32 v112, v112 clamp
    v_exp_f32 v113, v113 clamp
    v_max_f32 v160, s54, v160
    v_max_f32 v161, s54, v161
    v_pk_add_f32 v[160:161], v[160:161], v[112:113]
    v_cvt_pk_bf16_f32 v80, v160, v161
    v_pk_fma_f32 v[162:163], v[42:43], v[72:73], v[162:163] op_sel_hi:[1,0,1]
    v_pk_mul_f32 v[114:115], v[162:163], v[226:227]
    v_pk_fma_f32 v[162:163], v[162:163], v[58:59], s[54:55]
    v_exp_f32 v114, v114 clamp
    v_exp_f32 v115, v115 clamp
    v_max_f32 v162, s54, v162
    v_max_f32 v163, s54, v163
    v_pk_add_f32 v[162:163], v[162:163], v[114:115]
    v_cvt_pk_bf16_f32 v81, v162, v163
    v_pk_fma_f32 v[164:165], v[44:45], v[72:73], v[164:165] op_sel_hi:[1,0,1]
    v_pk_mul_f32 v[116:117], v[164:165], v[228:229]
    v_pk_fma_f32 v[164:165], v[164:165], v[60:61], s[54:55]
    v_exp_f32 v116, v116 clamp
    v_exp_f32 v117, v117 clamp
    v_max_f32 v164, s54, v164
    v_max_f32 v165, s54, v165
    v_pk_add_f32 v[164:165], v[164:165], v[116:117]
    v_cvt_pk_bf16_f32 v82, v164, v165
    v_pk_fma_f32 v[166:167], v[46:47], v[72:73], v[166:167] op_sel_hi:[1,0,1]
    v_pk_mul_f32 v[118:119], v[166:167], v[230:231]
    v_pk_fma_f32 v[166:167], v[166:167], v[62:63], s[54:55]
    v_exp_f32 v118, v118 clamp
    v_exp_f32 v119, v119 clamp
    v_max_f32 v166, s54, v166
    v_max_f32 v167, s54, v167
    v_pk_add_f32 v[166:167], v[166:167], v[118:119]
    v_cvt_pk_bf16_f32 v83, v166, v167
    v_pk_fma_f32 v[168:169], v[48:49], v[72:73], v[168:169] op_sel_hi:[1,0,1]
    v_pk_mul_f32 v[112:113], v[168:169], v[232:233]
    v_pk_fma_f32 v[168:169], v[168:169], v[64:65], s[54:55]
    v_exp_f32 v112, v112 clamp
    v_exp_f32 v113, v113 clamp
L_walkB3:
    s_cbranch_execz L_walk_7
    v_max_f32 v168, s54, v168
    v_max_f32 v169, s54, v169
    v_pk_add_f32 v[168:169], v[168:169], v[112:113]
    v_cvt_pk_bf16_f32 v84, v168, v169
    v_pk_fma_f32 v[170:171], v[50:51], v[72:73], v[170:171] op_sel_hi:[1,0,1]
    v_pk_mul_f32 v[114:115], v[170:171], v[234:235]
    v_pk_fma_f32 v[170:171], v[170:171], v[66:67], s[54:55]
    v_exp_f32 v114, v114 clamp
    v_exp_f32 v115, v115 clamp
    v_max_f32 v170, s54, v170
    v_max_f32 v171, s54, v171
    v_pk_add_f32 v[170:171], v[170:171], v[114:115]
    v_cvt_pk_bf16_f32 v85, v170, v171
    v_pk_fma_f32 v[172:173], v[52:53], v[72:73], v[172:173] op_sel_hi:[1,0,1]
    v_pk_mul_f32 v[116:117], v[172:173], v[236:237]
    v_pk_fma_f32 v[172:173], v[172:173], v[68:69], s[54:55]
    v_exp_f32 v116, v116 clamp
    v_exp_f32 v117, v117 clamp
    v_max_f32 v172, s54, v172
    v_max_f32 v173, s54, v173
    v_pk_add_f32 v[172:173], v[172:173], v[116:117]
    v_cvt_pk_bf16_f32 v86, v172, v173
    v_pk_fma_f32 v[174:175], v[54:55], v[72:73], v[174:175] op_sel_hi:[1,0,1]
    v_pk_mul_f32 v[118:119], v[174:175], v[238:239]
    v_pk_fma_f32 v[174:175], v[174:175], v[70:71], s[54:55]
    v_exp_f32 v118, v118 clamp
    v_exp_f32 v119, v119 clamp
    v_max_f32 v174, s54, v174
    v_max_f32 v175, s54, v175
    v_pk_add_f32 v[174:175], v[174:175], v[118:119]
    v_cvt_pk_bf16_f32 v87, v174, v175
    v_pk_fma_f32 v[176:177], v[40:41], v[72:73], v[176:177] op_sel:[0,1,0] op_sel_hi:[1,1,1]
    v_pk_mul_f32 v[112:113], v[176:177], v[224:225]
    v_pk_fma_f32 v[176:177], v[176:177], v[56:57], s[54:55]
    v_exp_f32 v112, v112 clamp
    v_exp_f32 v113, v113 clamp
    v_max_f32 v176, s54, v176
    v_max_f32 v177, s54, v177
    v_pk_add_f32 v[176:177], v[176:177], v[112:113]
    v_cvt_pk_bf16_f32 v88, v176, v177
    v_pk_fma_f32 v[178:179], v[42:43], v[72:73], v[178:179] op_sel:[0,1,0] op_sel_hi:[1,1,1]
    v_pk_mul_f32 v[114:115], v[178:179], v[226:227]
    v_pk_fma_f32 v[178:179], v[178:179], v[58:59], s[54:55]
    v_exp_f32 v114, v114 clamp
    v_exp_f32 v115, v115 clamp
    v_max_f32 v178, s54, v178
    v_max_f32 v179, s54, v179
    v_pk_add_f32 v[178:179], v[178:179], v[114:115]
    v_cvt_pk_bf16_f32 v89, v178, v179
    v_pk_fma_f32 v[180:181], v[44:45], v[72:73], v[180:181] op_sel:[0,1,0] op_sel_hi:[1,1,1]
    v_pk_mul_f32 v[116:117], v[180:181], v[228:229]
    v_pk_fma_f32 v[180:181], v[180:181], v[60:61], s[54:55]
    v_exp_f32 v116, v116 clamp
    v_exp_f32 v117, v117 clamp
    v_max_f32 v180, s54, v180
    v_max_f32 v181, s54, v181
    v_pk_add_f32 v[180:181], v[180:181], v[116:117]
    v_cvt_pk_bf16_f32 v90, v180, v181
    v_pk_fma_f32 v[182:183], v[46:47], v[72:73], v[182:183] op_sel:[0,1,0] op_sel_hi:[1,1,1]
    v_pk_mul_f32 v[118:119], v[182:183], v[230:231]
    v_pk_fma_f32 v[182:183], v[182:183], v[62:63], s[54:55]
    v_exp_f32 v118, v118 clamp
    v_exp_f32 v119, v119 clamp
    v_max_f32 v182, s54, v182
    v_max_f32 v183, s54, v183
    v_pk_add_f32 v[182:183], v[182:183], v[118:119]
    v_cvt_pk_bf16_f32 v91, v182, v183
    v_pk_fma_f32 v[184:185], v[48:49], v[72:73], v[184:185] op_sel:[0,1,0] op_sel_hi:[1,1,1]
    v_pk_mul_f32 v[112:113], v[184:185], v[232:233]
    v_pk_fma_f32 v[184:185], v[184:185], v[64:65], s[54:55]
    v_exp_f32 v112, v112 clamp
    v_exp_f32 v113, v113 clamp
    v_max_f32 v184, s54, v184
    v_max_f32 v185, s54, v185
    v_pk_add_f32 v[184:185], v[184:185], v[112:113]
    v_cvt_pk_bf16_f32 v92, v184, v185
    v_pk_fma_f32 v[186:187], v[50:51], v[72:73], v[186:187] op_sel:[0,1,0] op_sel_hi:[1,1,1]
    v_pk_mul_f32 v[114:115], v[186:187], v[234:235]
    v_pk_fma_f32 v[186:187], v[186:187], v[66:67], s[54:55]
    v_exp_f32 v114, v114 clamp
    v_exp_f32 v115, v115 clamp
    v_max_f32 v186, s54, v186
    v_max_f32 v187, s54, v187
    v_pk_add_f32 v[186:187], v[186:187], v[114:115]
    v_cvt_pk_bf16_f32 v93, v186, v187
    v_pk_fma_f32 v[188:189], v[52:53], v[72:73], v[188:189] op_sel:[0,1,0] op_sel_hi:[1,1,1]
    v_pk_mul_f32 v[116:117], v[188:189], v[236:237]
    v_pk_fma_f32 v[188:189], v[188:189], v[68:69], s[54:55]
    v_exp_f32 v116, v116 clamp
    v_exp_f32 v117, v117 clamp
    v_max_f32 v188, s54, v188
    v_max_f32 v189, s54, v189
    v_pk_add_f32 v[188:189], v[188:189], v[116:117]
    v_cvt_pk_bf16_f32 v94, v188, v189
    v_pk_fma_f32 v[190:191], v[54:55], v[72:73], v[190:191] op_sel:[0,1,0] op_sel_hi:[1,1,1]
    v_pk_mul_f32 v[118:119], v[190:191], v[238:239]
    v_pk_fma_f32 v[190:191], v[190:191], v[70:71], s[54:55]
    v_exp_f32 v118, v118 clamp
    v_exp_f32 v119, v119 clamp
    v_max_f32 v190, s54, v190
    v_max_f32 v191, s54, v191
    v_pk_add_f32 v[190:191], v[190:191], v[118:119]
    v_cvt_pk_bf16_f32 v95, v190, v191
    v_mov_b32 v120, s95
    v_mov_b32 v121, s95
    v_mov_b32 v122, s95
    v_mov_b32 v123, s95
    v_pk_fma_f32 v[192:193], v[40:41], v[74:75], v[192:193] op_sel_hi:[1,0,1]
    v_pk_mul_f32 v[192:193], v[192:193], v[56:57]
    v_cvt_pk_bf16_f32 v96, v192, v193
    v_pk_fma_f32 v[194:195], v[42:43], v[74:75], v[194:195] op_sel_hi:[1,0,1]
    v_pk_mul_f32 v[194:195], v[194:195], v[58:59]
    v_cvt_pk_bf16_f32 v97, v194, v195
    v_pk_fma_f32 v[196:197], v[44:45], v[74:75], v[196:197] op_sel_hi:[1,0,1]
    v_pk_mul_f32 v[196:197], v[196:197], v[60:61]
    v_cvt_pk_bf16_f32 v98, v196, v197
    v_pk_fma_f32 v[198:199], v[46:47], v[74:75], v[198:199] op_sel_hi:[1,0,1]
    v_pk_mul_f32 v[198:199], v[198:199], v[62:63]
    v_cvt_pk_bf16_f32 v99, v198, v199
    v_pk_fma_f32 v[200:201], v[48:49], v[74:75], v[200:201] op_sel_hi:[1,0,1]
    v_pk_mul_f32 v[200:201], v[200:201], v[64:65]
    v_cvt_pk_bf16_f32 v100, v200, v201
    v_pk_fma_f32 v[202:203], v[50:51], v[74:75], v[202:203] op_sel_hi:[1,0,1]
    v_pk_mul_f32 v[202:203], v[202:203], v[66:67]
    v_cvt_pk_bf16_f32 v101, v202, v203
    v_pk_fma_f32 v[204:205], v[52:53], v[74:75], v[204:205] op_sel_hi:[1,0,1]
    v_pk_mul_f32 v[204:205], v[204:205], v[68:69]
    v_cvt_pk_bf16_f32 v102, v204, v205
    v_pk_fma_f32 v[206:207], v[54:55], v[74:75], v[206:207] op_sel_hi:[1,0,1]
    v_pk_mul_f32 v[206:207], v[206:207], v[70:71]
    v_cvt_pk_bf16_f32 v103, v206, v207
    v_pk_fma_f32 v[208:209], v[40:41], v[74:75], v[208:209] op_sel:[0,1,0] op_sel_hi:[1,1,1]
    v_pk_mul_f32 v[208:209], v[208:209], v[56:57]
    v_cvt_pk_bf16_f32 v104, v208, v209
    v_pk_fma_f32 v[210:211], v[42:43], v[74:75], v[210:211] op_sel:[0,1,0] op_sel_hi:[1,1,1]
    v_pk_mul_f32 v[210:211], v[210:211], v[58:59]
    v_cvt_pk_bf16_f32 v105, v210, v211
    v_pk_fma_f32 v[212:213], v[44:45], v[74:75], v[212:213] op_sel:[0,1,0] op_sel_hi:[1,1,1]
    v_pk_mul_f32 v[212:213], v[212:213], v[60:61]
    v_cvt_pk_bf16_f32 v106, v212, v213
    v_pk_fma_f32 v[214:215], v[46:47], v[74:75], v[214:215] op_sel:[0,1,0] op_sel_hi:[1,1,1]
    v_pk_mul_f32 v[214:215], v[214:215], v[62:63]
    v_cvt_pk_bf16_f32 v107, v214, v215
    v_pk_fma_f32 v[216:217], v[48:49], v[74:75], v[216:217] op_sel:[0,1,0] op_sel_hi:[1,1,1]
    v_pk_mul_f32 v[216:217], v[216:217], v[64:65]
    v_cvt_pk_bf16_f32 v108, v216, v217
    v_pk_fma_f32 v[218:219], v[50:51], v[74:75], v[218:219] op_sel:[0,1,0] op_sel_hi:[1,1,1]
    v_pk_mul_f32 v[218:219], v[218:219], v[66:67]
    v_cvt_pk_bf16_f32 v109, v218, v219
    v_pk_fma_f32 v[220:221], v[52:53], v[74:75], v[220:221] op_sel:[0,1,0] op_sel_hi:[1,1,1]
L_walk_12:
    s_cbranch_execz L_walk_16
    v_pk_mul_f32 v[220:221], v[220:221], v[68:69]
    v_cvt_pk_bf16_f32 v110, v220, v221
    v_pk_fma_f32 v[222:223], v[54:55], v[74:75], v[222:223] op_sel:[0,1,0] op_sel_hi:[1,1,1]
    v_pk_mul_f32 v[222:223], v[222:223], v[70:71]
    v_cvt_pk_bf16_f32 v111, v222, v223
    s_mul_i32 s86, s3, 3072
    s_add_u32 s86, s86, 139264
    v_lshl_add_u32 v6, v0, 4, s86
    s_xor_b32 s86, s3, 1
    s_mul_i32 s86, s86, 3072
    s_add_u32 s86, s86, 139264
    v_lshl_add_u32 v7, v0, 4, s86
    s_cmp_eq_u32 s49, 1
    s_cbranch_scc1 L_kv1
    v_mfma_f32_16x16x32_bf16 v[172:175], v[80:83], v[104:107], 0
    v_mfma_f32_16x16x32_bf16 v[176:179], v[88:91], v[104:107], 0
    v_mfma_f32_16x16x32_bf16 v[180:183], v[88:91], v[120:123], 0
    v_mfma_f32_16x16x32_bf16 v[160:163], v[80:83], v[96:99], 0
    v_mfma_f32_16x16x32_bf16 v[164:167], v[88:91], v[96:99], 0
    v_mfma_f32_16x16x32_bf16 v[168:171], v[80:83], v[120:123], 0
    v_mfma_f32_16x16x32_bf16 v[172:175], v[84:87], v[108:111], v[172:175]
    v_mfma_f32_16x16x32_bf16 v[176:179], v[92:95], v[108:111], v[176:179]
    v_mfma_f32_16x16x32_bf16 v[180:183], v[92:95], v[120:123], v[180:183]
    v_mfma_f32_16x16x32_bf16 v[160:163], v[84:87], v[100:103], v[160:163]
    v_mfma_f32_16x16x32_bf16 v[164:167], v[92:95], v[100:103], v[164:167]
    v_mfma_f32_16x16x32_bf16 v[168:171], v[84:87], v[120:123], v[168:171]
    s_branch L_kvd
L_kv1:
    v_mfma_f32_16x16x32_bf16 v[172:175], v[80:83], v[96:99], 0
    v_mfma_f32_16x16x32_bf16 v[176:179], v[88:91], v[96:99], 0
    v_mfma_f32_16x16x32_bf16 v[180:183], v[80:83], v[120:123], 0
    v_mfma_f32_16x16x32_bf16 v[160:163], v[80:83], v[104:107], 0
    v_mfma_f32_16x16x32_bf16 v[164:167], v[88:91], v[104:107], 0
    v_mfma_f32_16x16x32_bf16 v[168:171], v[88:91], v[120:123], 0
    v_mfma_f32_16x16x32_bf16 v[172:175], v[84:87], v[100:103], v[172:175]
    v_mfma_f32_16x16x32_bf16 v[176:179], v[92:95], v[100:103], v[176:179]
    v_mfma_f32_16x16x32_bf16 v[180:183], v[84:87], v[120:123], v[180:183]
    v_mfma_f32_16x16x32_bf16 v[160:163], v[84:87], v[108:111], v[160:163]
    v_mfma_f32_16x16x32_bf16 v[164:167], v[92:95], v[108:111], v[164:167]
    v_mfma_f32_16x16x32_bf16 v[168:171], v[92:95], v[120:123], v[168:171]
L_kvd:
    s_lshl_b32 s86, s47, 1
    s_add_u32 s86, s86, s50
    s_lshl_b32 s87, s86, 1
    s_add_u32 s87, s87, s49
    s_lshl_b32 s87, s87, 4
    s_add_u32 s87, s87, s46
    s_lshl_b32 s87, s87, 10
    s_add_u32 s87, s87, 5242880
    v_lshl_add_u32 v8, v0, 4, s87
    s_lshl_b32 s87, s86, 4
    s_add_u32 s87, s87, s46
    s_lshl_b32 s87, s87, 7
    s_lshl_b32 s88, s49, 6
    s_add_u32 s87, s87, s88
    s_add_u32 s87, s87, 6881280
    v_add_u32 v9, s87, v0
    s_mov_b32 vcc_lo, 0x00010001
    s_mov_b32 vcc_hi, vcc_lo
    v_mov_b32 v14, 2147483648
    v_cndmask_b32 v9, v14, v9, vcc
    ds_write_b128 v6, v[172:175] offset:0
    ds_write_b128 v6, v[176:179] offset:1024
    ds_write_b128 v6, v[180:183] offset:2048
    ds_write_b32 v12, v12
    s_lshl_b32 s86, s47, 1
    s_add_u32 s86, s86, s50
    s_lshl_b32 s87, s46, 3
    s_lshl_b32 s88, s49, 2
    s_add_u32 s87, s87, s88
    s_lshl_b32 s87, s87, 5
    s_add_u32 s87, s87, s86
    s_lshl_b32 s87, s87, 10
    s_add_u32 s87, s87, 1048576
    v_lshl_add_u32 v10, v0, 4, s87
    s_mul_i32 s87, s50, 3072
    s_add_u32 s87, s87, 151552
    v_lshl_add_u32 v11, v0, 4, s87
    s_lshl_b32 s87, s86, 1
    s_add_u32 s87, s87, s49
    s_lshl_b32 s87, s87, 5
    s_add_u32 s87, s87, s46
    s_lshl2_add_u32 s87, s87, 671744
    v_mov_b32 v16, 2147483648
    v_mov_b32 v18, 2147483648
    v_writelane_b32 v16, s87, 0
    s_lshl_b32 s87, s46, 1
    s_add_u32 s87, s87, s49
    s_lshl_b32 s87, s87, 1
    s_lshr_b32 s88, s86, 4
    s_add_u32 s87, s87, s88
    s_lshl_b32 s87, s87, 6
    s_and_b32 s88, s86, 15
    s_add_u32 s87, s87, s88
    s_lshl2_add_u32 s87, s87, 688128
    v_writelane_b32 v18, s87, 0
    s_add_u32 s87, s87, 128
    v_writelane_b32 v18, s87, 1
    v_mov_b32 v17, s68
L_xkv:
    ds_read_b32 v14, v13
    ds_read_b128 v[172:175], v7 offset:0
    ds_read_b128 v[176:179], v7 offset:1024
    ds_read_b128 v[180:183], v7 offset:2048
    s_waitcnt lgkmcnt(0)
    v_cmp_eq_u32 vcc, 0, v14
    s_cbranch_vccz L_ok_2
    s_sub_u32 s56, s56, 1
    s_cbranch_scc0 L_xkv
    s_mov_b32 s56, 0
L_ok_2:
    v_pk_add_f32 v[160:161], v[160:161], v[172:173]
    v_pk_add_f32 v[162:163], v[162:163], v[174:175]
    v_pk_add_f32 v[164:165], v[164:165], v[176:177]
    v_pk_add_f32 v[166:167], v[166:167], v[178:179]
    v_pk_add_f32 v[168:169], v[168:169], v[180:181]
    v_pk_add_f32 v[170:171], v[170:171], v[182:183]
    v_cvt_pk_bf16_f32 v184, v160, v161
    v_cvt_pk_bf16_f32 v185, v162, v163
    v_cvt_pk_bf16_f32 v186, v164, v165
    v_cvt_pk_bf16_f32 v187, v166, v167
    buffer_store_dwordx4 v[184:187], v8, s[16:19], 0 offen sc1
    buffer_store_dwordx4 v[168:171], v9, s[16:19], 0 offen sc1
    buffer_atomic_swap v17, v16, s[16:19], 0 offen sc1
    v_pk_fma_f32 v[128:129], v[28:29], v[240:241], v[128:129] op_sel_hi:[1,0,1]
    v_pk_mul_f32 v[112:113], v[128:129], v[248:249] op_sel_hi:[1,0]
    v_pk_fma_f32 v[128:129], v[128:129], v[244:245], s[54:55] op_sel_hi:[1,0,1]
    v_exp_f32 v112, v112 clamp
    v_exp_f32 v113, v113 clamp
    v_max_f32 v128, s54, v128
    v_max_f32 v129, s54, v129
    v_pk_add_f32 v[128:129], v[128:129], v[112:113]
    v_cvt_pk_bf16_f32 v192, v128, v129
    v_pk_fma_f32 v[130:131], v[30:31], v[240:241], v[130:131] op_sel_hi:[1,0,1]
    v_pk_mul_f32 v[114:115], v[130:131], v[248:249] op_sel_hi:[1,0]
    v_pk_fma_f32 v[130:131], v[130:131], v[244:245], s[54:55] op_sel_hi:[1,0,1]
    v_exp_f32 v114, v114 clamp
    v_exp_f32 v115, v115 clamp
    v_max_f32 v130, s54, v130
    v_max_f32 v131, s54, v131
    v_pk_add_f32 v[130:131], v[130:131], v[114:115]
    v_cvt_pk_bf16_f32 v193, v130, v131
    v_pk_fma_f32 v[144:145], v[32:33], v[240:241], v[144:145] op_sel_hi:[1,0,1]
    v_pk_mul_f32 v[116:117], v[144:145], v[248:249] op_sel_hi:[1,0]
    v_pk_fma_f32 v[144:145], v[144:145], v[244:245], s[54:55] op_sel_hi:[1,0,1]
    v_exp_f32 v116, v116 clamp
    v_exp_f32 v117, v117 clamp
    v_max_f32 v144, s54, v144
    v_max_f32 v145, s54, v145
    v_pk_add_f32 v[144:145], v[144:145], v[116:117]
    v_cvt_pk_bf16_f32 v194, v144, v145
    v_pk_fma_f32 v[146:147], v[34:35], v[240:241], v[146:147] op_sel_hi:[1,0,1]
    v_pk_mul_f32 v[118:119], v[146:147], v[248:249] op_sel_hi:[1,0]
    v_pk_fma_f32 v[146:147], v[146:147], v[244:245], s[54:55] op_sel_hi:[1,0,1]
    v_exp_f32 v118, v118 clamp
    v_exp_f32 v119, v119 clamp
    v_max_f32 v146, s54, v146
    v_max_f32 v147, s54, v147
    v_pk_add_f32 v[146:147], v[146:147], v[118:119]
    v_cvt_pk_bf16_f32 v195, v146, v147
    v_pk_fma_f32 v[132:133], v[28:29], v[240:241], v[132:133] op_sel:[0,1,0] op_sel_hi:[1,1,1]
    v_pk_mul_f32 v[112:113], v[132:133], v[248:249] op_sel:[0,1] op_sel_hi:[1,1]
    v_pk_fma_f32 v[132:133], v[132:133], v[244:245], s[54:55] op_sel:[0,1,0] op_sel_hi:[1,1,1]
    v_exp_f32 v112, v112 clamp
    v_exp_f32 v113, v113 clamp
    v_max_f32 v132, s54, v132
    v_max_f32 v133, s54, v133
L_walk_13:
    s_cbranch_execz L_walk_17
    v_pk_add_f32 v[132:133], v[132:133], v[112:113]
    v_cvt_pk_bf16_f32 v196, v132, v133
    v_pk_fma_f32 v[134:135], v[30:31], v[240:241], v[134:135] op_sel:[0,1,0] op_sel_hi:[1,1,1]
    v_pk_mul_f32 v[114:115], v[134:135], v[248:249] op_sel:[0,1] op_sel_hi:[1,1]
    v_pk_fma_f32 v[134:135], v[134:135], v[244:245], s[54:55] op_sel:[0,1,0] op_sel_hi:[1,1,1]
    v_exp_f32 v114, v114 clamp
    v_exp_f32 v115, v115 clamp
    v_max_f32 v134, s54, v134
    v_max_f32 v135, s54, v135
    v_pk_add_f32 v[134:135], v[134:135], v[114:115]
    v_cvt_pk_bf16_f32 v197, v134, v135
    v_pk_fma_f32 v[148:149], v[32:33], v[240:241], v[148:149] op_sel:[0,1,0] op_sel_hi:[1,1,1]
    v_pk_mul_f32 v[116:117], v[148:149], v[248:249] op_sel:[0,1] op_sel_hi:[1,1]
    v_pk_fma_f32 v[148:149], v[148:149], v[244:245], s[54:55] op_sel:[0,1,0] op_sel_hi:[1,1,1]
    v_exp_f32 v116, v116 clamp
    v_exp_f32 v117, v117 clamp
    v_max_f32 v148, s54, v148
    v_max_f32 v149, s54, v149
    v_pk_add_f32 v[148:149], v[148:149], v[116:117]
    v_cvt_pk_bf16_f32 v198, v148, v149
    v_pk_fma_f32 v[150:151], v[34:35], v[240:241], v[150:151] op_sel:[0,1,0] op_sel_hi:[1,1,1]
    v_pk_mul_f32 v[118:119], v[150:151], v[248:249] op_sel:[0,1] op_sel_hi:[1,1]
    v_pk_fma_f32 v[150:151], v[150:151], v[244:245], s[54:55] op_sel:[0,1,0] op_sel_hi:[1,1,1]
    v_exp_f32 v118, v118 clamp
    v_exp_f32 v119, v119 clamp
    v_max_f32 v150, s54, v150
    v_max_f32 v151, s54, v151
    v_pk_add_f32 v[150:151], v[150:151], v[118:119]
    v_cvt_pk_bf16_f32 v199, v150, v151
    v_pk_fma_f32 v[136:137], v[28:29], v[242:243], v[136:137] op_sel_hi:[1,0,1]
    v_pk_mul_f32 v[112:113], v[136:137], v[250:251] op_sel_hi:[1,0]
    v_pk_fma_f32 v[136:137], v[136:137], v[246:247], s[54:55] op_sel_hi:[1,0,1]
    v_exp_f32 v112, v112 clamp
    v_exp_f32 v113, v113 clamp
    v_max_f32 v136, s54, v136
    v_max_f32 v137, s54, v137
    v_pk_add_f32 v[136:137], v[136:137], v[112:113]
    v_cvt_pk_bf16_f32 v200, v136, v137
    v_pk_fma_f32 v[138:139], v[30:31], v[242:243], v[138:139] op_sel_hi:[1,0,1]
    v_pk_mul_f32 v[114:115], v[138:139], v[250:251] op_sel_hi:[1,0]
    v_pk_fma_f32 v[138:139], v[138:139], v[246:247], s[54:55] op_sel_hi:[1,0,1]
    v_exp_f32 v114, v114 clamp
    v_exp_f32 v115, v115 clamp
    v_max_f32 v138, s54, v138
    v_max_f32 v139, s54, v139
    v_pk_add_f32 v[138:139], v[138:139], v[114:115]
    v_cvt_pk_bf16_f32 v201, v138, v139
    v_pk_fma_f32 v[152:153], v[32:33], v[242:243], v[152:153] op_sel_hi:[1,0,1]
    v_pk_mul_f32 v[116:117], v[152:153], v[250:251] op_sel_hi:[1,0]
    v_pk_fma_f32 v[152:153], v[152:153], v[246:247], s[54:55] op_sel_hi:[1,0,1]
    v_exp_f32 v116, v116 clamp
    v_exp_f32 v117, v117 clamp
    v_max_f32 v152, s54, v152
    v_max_f32 v153, s54, v153
    v_pk_add_f32 v[152:153], v[152:153], v[116:117]
    v_cvt_pk_bf16_f32 v202, v152, v153
    v_pk_fma_f32 v[154:155], v[34:35], v[242:243], v[154:155] op_sel_hi:[1,0,1]
    v_pk_mul_f32 v[118:119], v[154:155], v[250:251] op_sel_hi:[1,0]
    v_pk_fma_f32 v[154:155], v[154:155], v[246:247], s[54:55] op_sel_hi:[1,0,1]
    v_exp_f32 v118, v118 clamp
    v_exp_f32 v119, v119 clamp
    v_max_f32 v154, s54, v154
    v_max_f32 v155, s54, v155
    v_pk_add_f32 v[154:155], v[154:155], v[118:119]
    v_cvt_pk_bf16_f32 v203, v154, v155
    v_pk_fma_f32 v[140:141], v[28:29], v[242:243], v[140:141] op_sel:[0,1,0] op_sel_hi:[1,1,1]
    v_pk_mul_f32 v[112:113], v[140:141], v[250:251] op_sel:[0,1] op_sel_hi:[1,1]
    v_pk_fma_f32 v[140:141], v[140:141], v[246:247], s[54:55] op_sel:[0,1,0] op_sel_hi:[1,1,1]
    v_exp_f32 v112, v112 clamp
    v_exp_f32 v113, v113 clamp
    v_max_f32 v140, s54, v140
    v_max_f32 v141, s54, v141
    v_pk_add_f32 v[140:141], v[140:141], v[112:113]
    v_cvt_pk_bf16_f32 v204, v140, v141
    v_pk_fma_f32 v[142:143], v[30:31], v[242:243], v[142:143] op_sel:[0,1,0] op_sel_hi:[1,1,1]
    v_pk_mul_f32 v[114:115], v[142:143], v[250:251] op_sel:[0,1] op_sel_hi:[1,1]
    v_pk_fma_f32 v[142:143], v[142:143], v[246:247], s[54:55] op_sel:[0,1,0] op_sel_hi:[1,1,1]
    v_exp_f32 v114, v114 clamp
    v_exp_f32 v115, v115 clamp
    v_max_f32 v142, s54, v142
    v_max_f32 v143, s54, v143
    v_pk_add_f32 v[142:143], v[142:143], v[114:115]
    v_cvt_pk_bf16_f32 v205, v142, v143
    v_pk_fma_f32 v[156:157], v[32:33], v[242:243], v[156:157] op_sel:[0,1,0] op_sel_hi:[1,1,1]
    v_pk_mul_f32 v[116:117], v[156:157], v[250:251] op_sel:[0,1] op_sel_hi:[1,1]
    v_pk_fma_f32 v[156:157], v[156:157], v[246:247], s[54:55] op_sel:[0,1,0] op_sel_hi:[1,1,1]
    v_exp_f32 v116, v116 clamp
    v_exp_f32 v117, v117 clamp
    v_max_f32 v156, s54, v156
    v_max_f32 v157, s54, v157
    v_pk_add_f32 v[156:157], v[156:157], v[116:117]
    v_cvt_pk_bf16_f32 v206, v156, v157
    v_pk_fma_f32 v[158:159], v[34:35], v[242:243], v[158:159] op_sel:[0,1,0] op_sel_hi:[1,1,1]
    v_pk_mul_f32 v[118:119], v[158:159], v[250:251] op_sel:[0,1] op_sel_hi:[1,1]
    v_pk_fma_f32 v[158:159], v[158:159], v[246:247], s[54:55] op_sel:[0,1,0] op_sel_hi:[1,1,1]
    v_exp_f32 v118, v118 clamp
    v_exp_f32 v119, v119 clamp
    v_max_f32 v158, s54, v158
    v_max_f32 v159, s54, v159
    v_pk_add_f32 v[158:159], v[158:159], v[118:119]
    v_cvt_pk_bf16_f32 v207, v158, v159
    s_lshr_b32 s62, s3, 2
    s_lshl_b32 s53, s51, 3
    s_lshl_b32 s86, s48, 1
    s_add_u32 s53, s53, s86
    s_add_u32 s53, s53, s62
    v_lshrrev_b32 v36, 4, v0
    v_and_b32 v37, 15, v0
    s_lshl_b32 s87, s53, 15
    s_lshl_b32 s86, s62, 14
    s_add_u32 s86, s86, s87
    s_add_u32 s86, s86, 1048576
    v_lshl_add_u32 v157, v0, 4, s86
    v_xor_b32 v158, 0x8000, v157
    s_lshl_b32 s86, s51, 1
    s_lshr_b32 s87, s48, 1
    s_add_u32 s86, s86, s87
    s_lshl_b32 s86, s86, 1
    s_add_u32 s86, s86, s62
    s_lshl_b32 s86, s86, 1
    s_and_b32 s87, s48, 1
    s_add_u32 s86, s86, s87
    s_lshl_b32 s86, s86, 7
    s_add_u32 s86, s86, 688128
    v_lshl_add_u32 v159, v0, 2, s86
    v_mov_b32 v38, 2147483648
    v_cmp_gt_u32 vcc, 16, v0
    s_nop 1
    v_cndmask_b32 v159, v38, v159, vcc
    v_bfe_u32 v38, v0, 2, 2
    v_lshl_add_u32 v38, v36, 2, v38
    v_bfe_u32 v39, v38, 1, 2
    v_lshlrev_b32 v38, 7, v38
    v_lshl_add_u32 v38, v39, 5, v38
    v_and_b32 v39, 3, v0
    v_lshl_add_u32 v38, v39, 3, v38
    s_lshl_b32 s86, s62, 16
    s_add_u32 s86, s86, 0
    v_add_u32 v144, s86, v38
    v_xor_b32 v145, 32, v144
    v_xor_b32 v146, 64, v144
    v_xor_b32 v147, 96, v144
    v_cmp_eq_u32 s[4:5], 1, v39
    v_cmp_eq_u32 s[6:7], 2, v39
    v_cmp_eq_u32 s[98:99], 3, v39
    s_lshl_b32 s86, s53, 10
    s_add_u32 s86, s86, 786432
    v_lshl_add_u32 v160, v0, 2, s86
    v_mul_u32_u24 v161, 192, v36
    v_add_u32 v160, v160, v161
    s_mov_b32 s72, 0x00f0000f
    s_mov_b32 s73, 0xf0000f00
    s_mov_b32 s74, 0x0f00f000
    s_mov_b32 s75, 0x0f00f000
    v_lshrrev_b32 v38, 2, v37
    v_lshl_add_u32 v161, v38, 4, v37
    v_lshlrev_b32 v161, 2, v161
    s_lshl_b32 s86, s3, 12
    s_add_u32 s86, s86, 131072
    v_lshl_add_u32 v162, v0, 4, s86
    v_xor_b32 v163, 0x4000, v162
    s_lshl_b32 s86, s52, 7
    v_lshl_add_u32 v36, v36, 3, s86
    s_lshl_b32 s87, s53, 15
    s_add_u32 s87, s87, s86
L_walk_14:
    s_cbranch_execz L_walk_18
    s_lshl_b32 s86, s62, 6
    s_add_u32 s87, s87, s86
    v_lshl_add_u32 v39, v37, 11, s87
    v_and_b32 v38, 48, v0
    v_add_u32 v39, v39, v38
    v_xor_b32 v37, 0x8000, v39
    buffer_load_dwordx4 v[136:139], v39, s[8:11], 0 offen
    buffer_load_dwordx4 v[140:143], v37, s[8:11], 0 offen
    buffer_load_dwordx2 v[148:149], v36, s[40:43], 0 offen offset:0
    buffer_load_dwordx2 v[150:151], v36, s[40:43], 0 offen offset:32
    buffer_load_dwordx2 v[152:153], v36, s[40:43], 0 offen offset:64
    buffer_load_dwordx2 v[154:155], v36, s[40:43], 0 offen offset:96
    s_barrier
    ds_read_b128 v[40:43], v11 offset:0
    ds_read_b128 v[44:47], v11 offset:1024
    ds_read_b128 v[48:51], v11 offset:2048
    v_mov_b32 v38, 135200
    ds_read_b32 v38, v38
    s_mov_b32 s86, 0x8000
    s_mov_b32 s87, 0x10000
    s_mov_b32 s88, 0x18000
    s_waitcnt lgkmcnt(0)
    v_mfma_f32_16x16x32_bf16 v[216:219], v[48:51], v[192:195], 0
    v_mfma_f32_16x16x32_bf16 v[208:211], v[40:43], v[192:195], 0
    v_mfma_f32_16x16x32_bf16 v[212:215], v[44:47], v[192:195], 0
    v_mfma_f32_16x16x32_bf16 v[228:231], v[48:51], v[196:199], 0
    v_mfma_f32_16x16x32_bf16 v[220:223], v[40:43], v[196:199], 0
    v_mfma_f32_16x16x32_bf16 v[224:227], v[44:47], v[196:199], 0
    v_mfma_f32_16x16x32_bf16 v[240:243], v[48:51], v[200:203], 0
    v_mfma_f32_16x16x32_bf16 v[232:235], v[40:43], v[200:203], 0
    v_mfma_f32_16x16x32_bf16 v[236:239], v[44:47], v[200:203], 0
    v_mfma_f32_16x16x32_bf16 v[252:255], v[48:51], v[204:207], 0
    v_mfma_f32_16x16x32_bf16 v[244:247], v[40:43], v[204:207], 0
    v_mfma_f32_16x16x32_bf16 v[248:251], v[44:47], v[204:207], 0
    v_add_f32 v216, s54, v216
    v_rcp_f32 v216, v216
    s_nop 0
    v_pk_mul_f32 v[208:209], v[208:209], v[216:217] op_sel_hi:[1,0]
    v_pk_mul_f32 v[210:211], v[210:211], v[216:217] op_sel_hi:[1,0]
    v_pk_mul_f32 v[212:213], v[212:213], v[216:217] op_sel_hi:[1,0]
    v_pk_mul_f32 v[214:215], v[214:215], v[216:217] op_sel_hi:[1,0]
    v_cvt_pk_bf16_f32 v60, v208, v209
    v_cvt_pk_bf16_f32 v61, v210, v211
    v_cvt_pk_bf16_f32 v62, v212, v213
    v_cvt_pk_bf16_f32 v63, v214, v215
    buffer_store_dwordx4 v[60:63], v10, s[16:19], 0 offen sc1
    v_add_f32 v228, s54, v228
    v_rcp_f32 v228, v228
    s_nop 0
    v_pk_mul_f32 v[220:221], v[220:221], v[228:229] op_sel_hi:[1,0]
    v_pk_mul_f32 v[222:223], v[222:223], v[228:229] op_sel_hi:[1,0]
    v_pk_mul_f32 v[224:225], v[224:225], v[228:229] op_sel_hi:[1,0]
    v_pk_mul_f32 v[226:227], v[226:227], v[228:229] op_sel_hi:[1,0]
    v_cvt_pk_bf16_f32 v64, v220, v221
    v_cvt_pk_bf16_f32 v65, v222, v223
    v_cvt_pk_bf16_f32 v66, v224, v225
    v_cvt_pk_bf16_f32 v67, v226, v227
    buffer_store_dwordx4 v[64:67], v10, s[16:19], s86 offen sc1
    v_add_f32 v240, s54, v240
    v_rcp_f32 v240, v240
    s_nop 0
    v_pk_mul_f32 v[232:233], v[232:233], v[240:241] op_sel_hi:[1,0]
    v_pk_mul_f32 v[234:235], v[234:235], v[240:241] op_sel_hi:[1,0]
    v_pk_mul_f32 v[236:237], v[236:237], v[240:241] op_sel_hi:[1,0]
    v_pk_mul_f32 v[238:239], v[238:239], v[240:241] op_sel_hi:[1,0]
    v_cvt_pk_bf16_f32 v68, v232, v233
    v_cvt_pk_bf16_f32 v69, v234, v235
    v_cvt_pk_bf16_f32 v70, v236, v237
    v_cvt_pk_bf16_f32 v71, v238, v239
    buffer_store_dwordx4 v[68:71], v10, s[16:19], s87 offen sc1
    v_add_f32 v252, s54, v252
    v_rcp_f32 v252, v252
    s_nop 0
    v_pk_mul_f32 v[244:245], v[244:245], v[252:253] op_sel_hi:[1,0]
    v_pk_mul_f32 v[246:247], v[246:247], v[252:253] op_sel_hi:[1,0]
    v_pk_mul_f32 v[248:249], v[248:249], v[252:253] op_sel_hi:[1,0]
    v_pk_mul_f32 v[250:251], v[250:251], v[252:253] op_sel_hi:[1,0]
    v_cvt_pk_bf16_f32 v72, v244, v245
    v_cvt_pk_bf16_f32 v73, v246, v247
    v_cvt_pk_bf16_f32 v74, v248, v249
    v_cvt_pk_bf16_f32 v75, v250, v251
    buffer_store_dwordx4 v[72:75], v10, s[16:19], s88 offen sc1
    buffer_atomic_swap v17, v18, s[16:19], 0 offen sc1
    v_mov_b32 v8, 0
    buffer_atomic_or v8, v159, s[16:19], 0 offen sc0 sc1
    v_mov_b32 v14, 2147483648
    v_mov_b32 v11, 2147483648
    s_waitcnt vmcnt(6)
    v_bfe_u32 v36, v0, 2, 1
    v_cmp_eq_u32 vcc, 1, v36
    v_mov_b32 v36, s95
    s_nop 0
    v_cndmask_b32 v148, v36, v148, vcc
    v_cndmask_b32 v149, v36, v149, vcc
    v_cndmask_b32 v150, v36, v150, vcc
    v_cndmask_b32 v151, v36, v151, vcc
    v_cndmask_b32 v152, v36, v152, vcc
    v_cndmask_b32 v153, v36, v153, vcc
    v_cndmask_b32 v154, v36, v154, vcc
    v_cndmask_b32 v155, v36, v155, vcc
    v_readfirstlane_b32 s57, v38
L_phaseB:
    v_lshrrev_b32 v1, 4, v0
    v_and_b32 v2, 15, v0
    v_mov_b32 v3, 0x3f80
    s_lshl_b32 s87, s53, 4
    v_add_u32 v6, s87, v2
    s_lshl_b32 s86, s52, 7
    v_lshl_add_u32 v5, v6, 11, s86
    v_sub_u32 v6, 2047, v6
    v_mov_b32 v7, v39
    v_lshrrev_b32 v9, 1, v1
    v_lshl_add_u32 v5, v9, 4, v5
    v_and_b32 v9, 1, v1
    v_lshl_add_u32 v5, v9, 5, v5
    s_mov_b32 s67, 0
    s_mov_b32 s66, 0xffffaaaa
    s_mov_b32 s63, 0
L_b_init:
    v_bfe_u32 v9, v0, 3, 1
    v_bfe_u32 v10, v0, 4, 1
    v_xor_b32 v9, v9, v10
    v_bfe_u32 v10, v0, 1, 2
    v_lshl_add_u32 v9, v9, 3, v10
    v_lshrrev_b32 v10, 5, v0
    v_lshl_add_u32 v9, v10, 2, v9
    v_and_b32 v10, 1, v0
    v_lshlrev_b32 v10, 4, v10
    v_lshlrev_b32 v10, v10, v3
    v_cmp_eq_u32 vcc, 0, v9
    s_nop 1
    v_cndmask_b32 v128, 0, v10, vcc
    v_cmp_eq_u32 vcc, 1, v9
    s_nop 1
    v_cndmask_b32 v129, 0, v10, vcc
    v_cmp_eq_u32 vcc, 2, v9
    s_nop 1
    v_cndmask_b32 v130, 0, v10, vcc
    v_cmp_eq_u32 vcc, 3, v9
    s_nop 1
    v_cndmask_b32 v131, 0, v10, vcc
    v_cmp_eq_u32 vcc, 4, v9
    s_nop 1
    v_cndmask_b32 v132, 0, v10, vcc
    v_cmp_eq_u32 vcc, 5, v9
    s_nop 1
    v_cndmask_b32 v133, 0, v10, vcc
    v_cmp_eq_u32 vcc, 6, v9
    s_nop 1
    v_cndmask_b32 v134, 0, v10, vcc
    v_cmp_eq_u32 vcc, 7, v9
    s_nop 1
    v_cndmask_b32 v135, 0, v10, vcc
    v_mov_b32 v80, 0
    v_mov_b32 v81, 0
    v_mov_b32 v82, 0
    v_mov_b32 v83, 0
    v_mov_b32 v84, 0
    v_mov_b32 v85, 0
    v_mov_b32 v86, 0
    v_mov_b32 v87, 0
    v_mov_b32 v88, 0
    v_mov_b32 v89, 0
    v_mov_b32 v90, 0
    v_mov_b32 v91, 0
    v_mov_b32 v92, 0
    v_mov_b32 v93, 0
    v_mov_b32 v94, 0
    v_mov_b32 v95, 0
    v_mov_b32 v96, 0
    v_mov_b32 v97, 0
    v_mov_b32 v98, 0
    v_mov_b32 v99, 0
    v_mov_b32 v100, 0
    v_mov_b32 v101, 0
    v_mov_b32 v102, 0
    v_mov_b32 v103, 0
    v_mov_b32 v104, 0
    v_mov_b32 v105, 0
    v_mov_b32 v106, 0
    v_mov_b32 v107, 0
    v_mov_b32 v108, 0
    v_mov_b32 v109, 0
    v_mov_b32 v110, 0
    v_mov_b32 v111, 0
    v_mov_b32 v156, 0
    s_branch L_b_w0
L_b_r0:
    s_ff1_i32_b32 s91, s65
    s_bitset0_b32 s65, s91
    s_lshl_b32 s76, s91, 12
    s_lshl_b32 s91, s91, 10
    buffer_load_dwordx4 v[16:19], v157, s[16:19], s91 offen offset:0 sc1
L_walk_15:
    s_cbranch_execz L_walk_19
    buffer_load_dwordx4 v[20:23], v158, s[16:19], s91 offen offset:0 sc1
    buffer_load_dwordx4 v[24:27], v157, s[16:19], s91 offen offset:1024 sc1
    buffer_load_dwordx4 v[28:31], v158, s[16:19], s91 offen offset:1024 sc1
    s_cmp_eq_u32 s65, 0
    s_cbranch_scc1 L_b_p1
L_b_r1:
    s_ff1_i32_b32 s91, s65
    s_bitset0_b32 s65, s91
    s_lshl_b32 s77, s91, 12
    s_lshl_b32 s91, s91, 10
    buffer_load_dwordx4 v[32:35], v157, s[16:19], s91 offen offset:0 sc1
    buffer_load_dwordx4 v[36:39], v158, s[16:19], s91 offen offset:0 sc1
    buffer_load_dwordx4 v[40:43], v157, s[16:19], s91 offen offset:1024 sc1
    buffer_load_dwordx4 v[44:47], v158, s[16:19], s91 offen offset:1024 sc1
    s_xor_b32 s89, s67, s76
    s_mov_b32 s67, s76
    v_xor_b32 v144, s89, v144
    ds_read_b64_tr_b16 v[112:113], v144 offset:0
    ds_read_b64_tr_b16 v[114:115], v144 offset:2048
    v_xor_b32 v145, s89, v145
    ds_read_b64_tr_b16 v[116:117], v145 offset:0
    ds_read_b64_tr_b16 v[118:119], v145 offset:2048
    v_xor_b32 v146, s89, v146
    ds_read_b64_tr_b16 v[120:121], v146 offset:0
    ds_read_b64_tr_b16 v[122:123], v146 offset:2048
    v_xor_b32 v147, s89, v147
    ds_read_b64_tr_b16 v[124:125], v147 offset:0
    ds_read_b64_tr_b16 v[126:127], v147 offset:2048
    s_cmp_eq_u32 s62, 0
    s_cbranch_scc0 L_b_x1
    v_mfma_f32_16x16x32_bf16 v[80:83], v[128:131], v[136:139], 0
    v_mfma_f32_16x16x32_bf16 v[96:99], v[128:131], v[140:143], 0
    v_mfma_f32_16x16x32_bf16 v[84:87], v[132:135], v[136:139], 0
    v_mfma_f32_16x16x32_bf16 v[100:103], v[132:135], v[140:143], 0
    s_branch L_b_xd
L_b_x1:
    s_setprio 1
    v_mfma_f32_16x16x32_bf16 v[88:91], v[128:131], v[136:139], 0
    v_mfma_f32_16x16x32_bf16 v[104:107], v[128:131], v[140:143], 0
    v_mfma_f32_16x16x32_bf16 v[92:95], v[132:135], v[136:139], 0
    v_mfma_f32_16x16x32_bf16 v[108:111], v[132:135], v[140:143], 0
L_b_xd:
    s_waitcnt vmcnt(6) lgkmcnt(6)
    v_max3_u32 v156, v156, v19, v23
    v_mfma_f32_16x16x32_bf16 v[80:83], v[112:115], v[16:19], v[80:83]
    ds_read_b64_tr_b16 v[128:129], v144 offset:4096
    v_mfma_f32_16x16x32_bf16 v[96:99], v[112:115], v[20:23], v[96:99]
    ds_read_b64_tr_b16 v[130:131], v144 offset:6144
    s_waitcnt lgkmcnt(6)
    v_mfma_f32_16x16x32_bf16 v[84:87], v[116:119], v[16:19], v[84:87]
    ds_read_b64_tr_b16 v[132:133], v145 offset:4096
    v_mfma_f32_16x16x32_bf16 v[100:103], v[116:119], v[20:23], v[100:103]
    ds_read_b64_tr_b16 v[134:135], v145 offset:6144
    s_waitcnt lgkmcnt(6)
    v_mfma_f32_16x16x32_bf16 v[88:91], v[120:123], v[16:19], v[88:91]
    ds_read_b64_tr_b16 v[136:137], v146 offset:4096
    v_mfma_f32_16x16x32_bf16 v[104:107], v[120:123], v[20:23], v[104:107]
    ds_read_b64_tr_b16 v[138:139], v146 offset:6144
    s_waitcnt lgkmcnt(6)
    v_mfma_f32_16x16x32_bf16 v[92:95], v[124:127], v[16:19], v[92:95]
    ds_read_b64_tr_b16 v[140:141], v147 offset:4096
    v_mfma_f32_16x16x32_bf16 v[108:111], v[124:127], v[20:23], v[108:111]
    ds_read_b64_tr_b16 v[142:143], v147 offset:6144
    s_not_b32 s91, s66
    s_cmp_eq_u32 s65, 0
    s_cselect_b32 s65, s91, s65
    s_cselect_b32 s66, -1, s66
    s_ff1_i32_b32 s91, s65
    s_bitset0_b32 s65, s91
    s_lshl_b32 s78, s91, 12
    s_lshl_b32 s91, s91, 10
    buffer_load_dwordx4 v[48:51], v157, s[16:19], s91 offen offset:0 sc1
    buffer_load_dwordx4 v[52:55], v158, s[16:19], s91 offen offset:0 sc1
    s_waitcnt vmcnt(6) lgkmcnt(6)
    v_max3_u32 v156, v156, v27, v31
    v_mfma_f32_16x16x32_bf16 v[80:83], v[128:131], v[24:27], v[80:83]
    s_xor_b32 s89, s67, s77
    s_mov_b32 s67, s77
    v_xor_b32 v144, s89, v144
    ds_read_b64_tr_b16 v[112:113], v144 offset:0
    v_mfma_f32_16x16x32_bf16 v[96:99], v[128:131], v[28:31], v[96:99]
    ds_read_b64_tr_b16 v[114:115], v144 offset:2048
    s_waitcnt lgkmcnt(6)
    v_mfma_f32_16x16x32_bf16 v[84:87], v[132:135], v[24:27], v[84:87]
    v_xor_b32 v145, s89, v145
    ds_read_b64_tr_b16 v[116:117], v145 offset:0
    v_mfma_f32_16x16x32_bf16 v[100:103], v[132:135], v[28:31], v[100:103]
    ds_read_b64_tr_b16 v[118:119], v145 offset:2048
    s_waitcnt lgkmcnt(6)
    v_mfma_f32_16x16x32_bf16 v[88:91], v[136:139], v[24:27], v[88:91]
    v_xor_b32 v146, s89, v146
    ds_read_b64_tr_b16 v[120:121], v146 offset:0
    v_mfma_f32_16x16x32_bf16 v[104:107], v[136:139], v[28:31], v[104:107]
    ds_read_b64_tr_b16 v[122:123], v146 offset:2048
    s_waitcnt lgkmcnt(6)
    v_mfma_f32_16x16x32_bf16 v[92:95], v[140:143], v[24:27], v[92:95]
    v_xor_b32 v147, s89, v147
    ds_read_b64_tr_b16 v[124:125], v147 offset:0
    v_mfma_f32_16x16x32_bf16 v[108:111], v[140:143], v[28:31], v[108:111]
    ds_read_b64_tr_b16 v[126:127], v147 offset:2048
    buffer_load_dwordx4 v[56:59], v157, s[16:19], s91 offen offset:1024 sc1
    buffer_load_dwordx4 v[60:63], v158, s[16:19], s91 offen offset:1024 sc1
    s_waitcnt vmcnt(6) lgkmcnt(6)
    v_max3_u32 v156, v156, v35, v39
    v_mfma_f32_16x16x32_bf16 v[80:83], v[112:115], v[32:35], v[80:83]
    ds_read_b64_tr_b16 v[128:129], v144 offset:4096
    v_mfma_f32_16x16x32_bf16 v[96:99], v[112:115], v[36:39], v[96:99]
    ds_read_b64_tr_b16 v[130:131], v144 offset:6144
    s_waitcnt lgkmcnt(6)
    v_mfma_f32_16x16x32_bf16 v[84:87], v[116:119], v[32:35], v[84:87]
    ds_read_b64_tr_b16 v[132:133], v145 offset:4096
    v_mfma_f32_16x16x32_bf16 v[100:103], v[116:119], v[36:39], v[100:103]
    ds_read_b64_tr_b16 v[134:135], v145 offset:6144
    s_waitcnt lgkmcnt(6)
    v_mfma_f32_16x16x32_bf16 v[88:91], v[120:123], v[32:35], v[88:91]
    ds_read_b64_tr_b16 v[136:137], v146 offset:4096
    v_mfma_f32_16x16x32_bf16 v[104:107], v[120:123], v[36:39], v[104:107]
    ds_read_b64_tr_b16 v[138:139], v146 offset:6144
    s_waitcnt lgkmcnt(6)
    v_mfma_f32_16x16x32_bf16 v[92:95], v[124:127], v[32:35], v[92:95]
    ds_read_b64_tr_b16 v[140:141], v147 offset:4096
    v_mfma_f32_16x16x32_bf16 v[108:111], v[124:127], v[36:39], v[108:111]
    ds_read_b64_tr_b16 v[142:143], v147 offset:6144
    s_not_b32 s91, s66
    s_cmp_eq_u32 s65, 0
    s_cselect_b32 s65, s91, s65
    s_cselect_b32 s66, -1, s66
    s_ff1_i32_b32 s91, s65
    s_bitset0_b32 s65, s91
    s_lshl_b32 s79, s91, 12
    s_lshl_b32 s91, s91, 10
    buffer_load_dwordx4 v[64:67], v157, s[16:19], s91 offen offset:0 sc1
    buffer_load_dwordx4 v[68:71], v158, s[16:19], s91 offen offset:0 sc1
    s_waitcnt vmcnt(6) lgkmcnt(6)
    v_max3_u32 v156, v156, v43, v47
    v_mfma_f32_16x16x32_bf16 v[80:83], v[128:131], v[40:43], v[80:83]
    s_xor_b32 s89, s67, s78
    s_mov_b32 s67, s78
    v_xor_b32 v144, s89, v144
    ds_read_b64_tr_b16 v[112:113], v144 offset:0
    v_mfma_f32_16x16x32_bf16 v[96:99], v[128:131], v[44:47], v[96:99]
    ds_read_b64_tr_b16 v[114:115], v144 offset:2048
    s_waitcnt lgkmcnt(6)
    v_mfma_f32_16x16x32_bf16 v[84:87], v[132:135], v[40:43], v[84:87]
    v_xor_b32 v145, s89, v145
    ds_read_b64_tr_b16 v[116:117], v145 offset:0
    v_mfma_f32_16x16x32_bf16 v[100:103], v[132:135], v[44:47], v[100:103]
    ds_read_b64_tr_b16 v[118:119], v145 offset:2048
    s_waitcnt lgkmcnt(6)
    v_mfma_f32_16x16x32_bf16 v[88:91], v[136:139], v[40:43], v[88:91]
    v_xor_b32 v146, s89, v146
    ds_read_b64_tr_b16 v[120:121], v146 offset:0
    v_mfma_f32_16x16x32_bf16 v[104:107], v[136:139], v[44:47], v[104:107]
    ds_read_b64_tr_b16 v[122:123], v146 offset:2048
    s_waitcnt lgkmcnt(6)
    v_mfma_f32_16x16x32_bf16 v[92:95], v[140:143], v[40:43], v[92:95]
    v_xor_b32 v147, s89, v147
    ds_read_b64_tr_b16 v[124:125], v147 offset:0
    v_mfma_f32_16x16x32_bf16 v[108:111], v[140:143], v[44:47], v[108:111]
    ds_read_b64_tr_b16 v[126:127], v147 offset:2048
    buffer_load_dwordx4 v[72:75], v157, s[16:19], s91 offen offset:1024 sc1
    buffer_load_dwordx4 v[76:79], v158, s[16:19], s91 offen offset:1024 sc1
    s_waitcnt vmcnt(6) lgkmcnt(6)
L_b_c4:
    v_max_u32 v4, v51, v55
    v_cmp_eq_u32 vcc, -1, v4
    s_cbranch_vccnz L_b_g4
L_b_d4:
    v_mfma_f32_16x16x32_bf16 v[80:83], v[112:115], v[48:51], v[80:83]
    ds_read_b64_tr_b16 v[128:129], v144 offset:4096
    v_mfma_f32_16x16x32_bf16 v[96:99], v[112:115], v[52:55], v[96:99]
    ds_read_b64_tr_b16 v[130:131], v144 offset:6144
    s_waitcnt lgkmcnt(6)
L_walk_16:
    s_cbranch_execz L_walk_20
    v_mfma_f32_16x16x32_bf16 v[84:87], v[116:119], v[48:51], v[84:87]
    ds_read_b64_tr_b16 v[132:133], v145 offset:4096
    v_mfma_f32_16x16x32_bf16 v[100:103], v[116:119], v[52:55], v[100:103]
    ds_read_b64_tr_b16 v[134:135], v145 offset:6144
    s_waitcnt lgkmcnt(6)
    v_mfma_f32_16x16x32_bf16 v[88:91], v[120:123], v[48:51], v[88:91]
    ds_read_b64_tr_b16 v[136:137], v146 offset:4096
    v_mfma_f32_16x16x32_bf16 v[104:107], v[120:123], v[52:55], v[104:107]
    ds_read_b64_tr_b16 v[138:139], v146 offset:6144
    s_waitcnt lgkmcnt(6)
    v_mfma_f32_16x16x32_bf16 v[92:95], v[124:127], v[48:51], v[92:95]
    ds_read_b64_tr_b16 v[140:141], v147 offset:4096
    v_mfma_f32_16x16x32_bf16 v[108:111], v[124:127], v[52:55], v[108:111]
    ds_read_b64_tr_b16 v[142:143], v147 offset:6144
    s_not_b32 s91, s66
    s_cmp_eq_u32 s65, 0
    s_cselect_b32 s65, s91, s65
    s_cselect_b32 s66, -1, s66
    s_ff1_i32_b32 s91, s65
    s_bitset0_b32 s65, s91
    s_lshl_b32 s76, s91, 12
    s_lshl_b32 s91, s91, 10
    buffer_load_dwordx4 v[16:19], v157, s[16:19], s91 offen offset:0 sc1
    buffer_load_dwordx4 v[20:23], v158, s[16:19], s91 offen offset:0 sc1
    s_waitcnt vmcnt(6) lgkmcnt(6)
L_b_c5:
    v_max_u32 v4, v59, v63
    v_cmp_eq_u32 vcc, -1, v4
    s_cbranch_vccnz L_b_g5
L_b_d5:
    v_mfma_f32_16x16x32_bf16 v[80:83], v[128:131], v[56:59], v[80:83]
    s_xor_b32 s89, s67, s79
    s_mov_b32 s67, s79
    v_xor_b32 v144, s89, v144
    ds_read_b64_tr_b16 v[112:113], v144 offset:0
    v_mfma_f32_16x16x32_bf16 v[96:99], v[128:131], v[60:63], v[96:99]
    ds_read_b64_tr_b16 v[114:115], v144 offset:2048
    s_waitcnt lgkmcnt(6)
    v_mfma_f32_16x16x32_bf16 v[84:87], v[132:135], v[56:59], v[84:87]
    v_xor_b32 v145, s89, v145
    ds_read_b64_tr_b16 v[116:117], v145 offset:0
    v_mfma_f32_16x16x32_bf16 v[100:103], v[132:135], v[60:63], v[100:103]
    ds_read_b64_tr_b16 v[118:119], v145 offset:2048
    s_waitcnt lgkmcnt(6)
    v_mfma_f32_16x16x32_bf16 v[88:91], v[136:139], v[56:59], v[88:91]
    v_xor_b32 v146, s89, v146
    ds_read_b64_tr_b16 v[120:121], v146 offset:0
    v_mfma_f32_16x16x32_bf16 v[104:107], v[136:139], v[60:63], v[104:107]
    ds_read_b64_tr_b16 v[122:123], v146 offset:2048
    s_waitcnt lgkmcnt(6)
    v_mfma_f32_16x16x32_bf16 v[92:95], v[140:143], v[56:59], v[92:95]
    v_xor_b32 v147, s89, v147
    ds_read_b64_tr_b16 v[124:125], v147 offset:0
    v_mfma_f32_16x16x32_bf16 v[108:111], v[140:143], v[60:63], v[108:111]
    ds_read_b64_tr_b16 v[126:127], v147 offset:2048
    buffer_load_dwordx4 v[24:27], v157, s[16:19], s91 offen offset:1024 sc1
    buffer_load_dwordx4 v[28:31], v158, s[16:19], s91 offen offset:1024 sc1
    s_setprio 0
    s_waitcnt vmcnt(6) lgkmcnt(6)
L_b_c6:
    v_max_u32 v4, v67, v71
    v_cmp_eq_u32 vcc, -1, v4
    s_cbranch_vccnz L_b_g6
L_b_d6:
    v_mfma_f32_16x16x32_bf16 v[80:83], v[112:115], v[64:67], v[80:83]
    ds_read_b64_tr_b16 v[128:129], v144 offset:4096
    v_mfma_f32_16x16x32_bf16 v[96:99], v[112:115], v[68:71], v[96:99]
    ds_read_b64_tr_b16 v[130:131], v144 offset:6144
    s_waitcnt lgkmcnt(6)
    v_mfma_f32_16x16x32_bf16 v[84:87], v[116:119], v[64:67], v[84:87]
    ds_read_b64_tr_b16 v[132:133], v145 offset:4096
    v_mfma_f32_16x16x32_bf16 v[100:103], v[116:119], v[68:71], v[100:103]
    ds_read_b64_tr_b16 v[134:135], v145 offset:6144
    s_waitcnt lgkmcnt(6)
    v_mfma_f32_16x16x32_bf16 v[88:91], v[120:123], v[64:67], v[88:91]
    ds_read_b64_tr_b16 v[136:137], v146 offset:4096
    v_mfma_f32_16x16x32_bf16 v[104:107], v[120:123], v[68:71], v[104:107]
    ds_read_b64_tr_b16 v[138:139], v146 offset:6144
    s_waitcnt lgkmcnt(6)
    v_mfma_f32_16x16x32_bf16 v[92:95], v[124:127], v[64:67], v[92:95]
    ds_read_b64_tr_b16 v[140:141], v147 offset:4096
    v_mfma_f32_16x16x32_bf16 v[108:111], v[124:127], v[68:71], v[108:111]
    ds_read_b64_tr_b16 v[142:143], v147 offset:6144
    s_not_b32 s91, s66
    s_cmp_eq_u32 s65, 0
    s_cselect_b32 s65, s91, s65
    s_cselect_b32 s66, -1, s66
    s_ff1_i32_b32 s91, s65
    s_bitset0_b32 s65, s91
    s_lshl_b32 s77, s91, 12
    s_lshl_b32 s91, s91, 10
    buffer_load_dwordx4 v[32:35], v157, s[16:19], s91 offen offset:0 sc1
    buffer_load_dwordx4 v[36:39], v158, s[16:19], s91 offen offset:0 sc1
    s_waitcnt vmcnt(6) lgkmcnt(6)
L_b_c7:
    v_max_u32 v4, v75, v79
    v_cmp_eq_u32 vcc, -1, v4
    s_cbranch_vccnz L_b_g7
L_b_d7:
    v_mfma_f32_16x16x32_bf16 v[80:83], v[128:131], v[72:75], v[80:83]
    s_xor_b32 s89, s67, s76
    s_mov_b32 s67, s76
    v_xor_b32 v144, s89, v144
    ds_read_b64_tr_b16 v[112:113], v144 offset:0
    v_mfma_f32_16x16x32_bf16 v[96:99], v[128:131], v[76:79], v[96:99]
    ds_read_b64_tr_b16 v[114:115], v144 offset:2048
    s_waitcnt lgkmcnt(6)
    v_mfma_f32_16x16x32_bf16 v[84:87], v[132:135], v[72:75], v[84:87]
    v_xor_b32 v145, s89, v145
    ds_read_b64_tr_b16 v[116:117], v145 offset:0
    v_mfma_f32_16x16x32_bf16 v[100:103], v[132:135], v[76:79], v[100:103]
    ds_read_b64_tr_b16 v[118:119], v145 offset:2048
    s_waitcnt lgkmcnt(6)
    v_mfma_f32_16x16x32_bf16 v[88:91], v[136:139], v[72:75], v[88:91]
    v_xor_b32 v146, s89, v146
    ds_read_b64_tr_b16 v[120:121], v146 offset:0
    v_mfma_f32_16x16x32_bf16 v[104:107], v[136:139], v[76:79], v[104:107]
    ds_read_b64_tr_b16 v[122:123], v146 offset:2048
    s_waitcnt lgkmcnt(6)
    v_mfma_f32_16x16x32_bf16 v[92:95], v[140:143], v[72:75], v[92:95]
    v_xor_b32 v147, s89, v147
    ds_read_b64_tr_b16 v[124:125], v147 offset:0
    v_mfma_f32_16x16x32_bf16 v[108:111], v[140:143], v[76:79], v[108:111]
    ds_read_b64_tr_b16 v[126:127], v147 offset:2048
    buffer_load_dwordx4 v[40:43], v157, s[16:19], s91 offen offset:1024 sc1
    buffer_load_dwordx4 v[44:47], v158, s[16:19], s91 offen offset:1024 sc1
    s_waitcnt vmcnt(6) lgkmcnt(6)
L_b_c8:
    v_max_u32 v4, v19, v23
    v_cmp_eq_u32 vcc, -1, v4
    s_cbranch_vccnz L_b_g8
L_b_d8:
    v_mfma_f32_16x16x32_bf16 v[80:83], v[112:115], v[16:19], v[80:83]
    ds_read_b64_tr_b16 v[128:129], v144 offset:4096
    v_mfma_f32_16x16x32_bf16 v[96:99], v[112:115], v[20:23], v[96:99]
    ds_read_b64_tr_b16 v[130:131], v144 offset:6144
    s_waitcnt lgkmcnt(6)
    v_mfma_f32_16x16x32_bf16 v[84:87], v[116:119], v[16:19], v[84:87]
    ds_read_b64_tr_b16 v[132:133], v145 offset:4096
    v_mfma_f32_16x16x32_bf16 v[100:103], v[116:119], v[20:23], v[100:103]
    ds_read_b64_tr_b16 v[134:135], v145 offset:6144
    s_waitcnt lgkmcnt(6)
    v_mfma_f32_16x16x32_bf16 v[88:91], v[120:123], v[16:19], v[88:91]
    ds_read_b64_tr_b16 v[136:137], v146 offset:4096
    v_mfma_f32_16x16x32_bf16 v[104:107], v[120:123], v[20:23], v[104:107]
    ds_read_b64_tr_b16 v[138:139], v146 offset:6144
    s_waitcnt lgkmcnt(6)
    v_mfma_f32_16x16x32_bf16 v[92:95], v[124:127], v[16:19], v[92:95]
    ds_read_b64_tr_b16 v[140:141], v147 offset:4096
    v_mfma_f32_16x16x32_bf16 v[108:111], v[124:127], v[20:23], v[108:111]
    ds_read_b64_tr_b16 v[142:143], v147 offset:6144
    s_not_b32 s91, s66
    s_cmp_eq_u32 s65, 0
    s_cselect_b32 s65, s91, s65
    s_cselect_b32 s66, -1, s66
    s_ff1_i32_b32 s91, s65
    s_bitset0_b32 s65, s91
    s_lshl_b32 s78, s91, 12
    s_lshl_b32 s91, s91, 10
    buffer_load_dwordx4 v[48:51], v157, s[16:19], s91 offen offset:0 sc1
    buffer_load_dwordx4 v[52:55], v158, s[16:19], s91 offen offset:0 sc1
    s_waitcnt vmcnt(6) lgkmcnt(6)
L_b_c9:
    v_max_u32 v4, v27, v31
    v_cmp_eq_u32 vcc, -1, v4
    s_cbranch_vccnz L_b_g9
L_b_d9:
    v_mfma_f32_16x16x32_bf16 v[80:83], v[128:131], v[24:27], v[80:83]
    s_xor_b32 s89, s67, s77
    s_mov_b32 s67, s77
    v_xor_b32 v144, s89, v144
    ds_read_b64_tr_b16 v[112:113], v144 offset:0
    v_mfma_f32_16x16x32_bf16 v[96:99], v[128:131], v[28:31], v[96:99]
    ds_read_b64_tr_b16 v[114:115], v144 offset:2048
    s_waitcnt lgkmcnt(6)
    v_mfma_f32_16x16x32_bf16 v[84:87], v[132:135], v[24:27], v[84:87]
    v_xor_b32 v145, s89, v145
    ds_read_b64_tr_b16 v[116:117], v145 offset:0
    v_mfma_f32_16x16x32_bf16 v[100:103], v[132:135], v[28:31], v[100:103]
    ds_read_b64_tr_b16 v[118:119], v145 offset:2048
    s_waitcnt lgkmcnt(6)
    v_mfma_f32_16x16x32_bf16 v[88:91], v[136:139], v[24:27], v[88:91]
    v_xor_b32 v146, s89, v146
    ds_read_b64_tr_b16 v[120:121], v146 offset:0
    v_mfma_f32_16x16x32_bf16 v[104:107], v[136:139], v[28:31], v[104:107]
L_walk_17:
    s_cbranch_execz L_walk_21
    ds_read_b64_tr_b16 v[122:123], v146 offset:2048
    s_waitcnt lgkmcnt(6)
    v_mfma_f32_16x16x32_bf16 v[92:95], v[140:143], v[24:27], v[92:95]
    v_xor_b32 v147, s89, v147
    ds_read_b64_tr_b16 v[124:125], v147 offset:0
    v_mfma_f32_16x16x32_bf16 v[108:111], v[140:143], v[28:31], v[108:111]
    ds_read_b64_tr_b16 v[126:127], v147 offset:2048
    buffer_load_dwordx4 v[56:59], v157, s[16:19], s91 offen offset:1024 sc1
    buffer_load_dwordx4 v[60:63], v158, s[16:19], s91 offen offset:1024 sc1
    s_waitcnt vmcnt(6) lgkmcnt(6)
L_b_c10:
    v_max_u32 v4, v35, v39
    v_cmp_eq_u32 vcc, -1, v4
    s_cbranch_vccnz L_b_g10
L_b_d10:
    v_mfma_f32_16x16x32_bf16 v[80:83], v[112:115], v[32:35], v[80:83]
    ds_read_b64_tr_b16 v[128:129], v144 offset:4096
    v_mfma_f32_16x16x32_bf16 v[96:99], v[112:115], v[36:39], v[96:99]
    ds_read_b64_tr_b16 v[130:131], v144 offset:6144
    s_waitcnt lgkmcnt(6)
    v_mfma_f32_16x16x32_bf16 v[84:87], v[116:119], v[32:35], v[84:87]
    ds_read_b64_tr_b16 v[132:133], v145 offset:4096
    v_mfma_f32_16x16x32_bf16 v[100:103], v[116:119], v[36:39], v[100:103]
    ds_read_b64_tr_b16 v[134:135], v145 offset:6144
    s_waitcnt lgkmcnt(6)
    v_mfma_f32_16x16x32_bf16 v[88:91], v[120:123], v[32:35], v[88:91]
    ds_read_b64_tr_b16 v[136:137], v146 offset:4096
    v_mfma_f32_16x16x32_bf16 v[104:107], v[120:123], v[36:39], v[104:107]
    ds_read_b64_tr_b16 v[138:139], v146 offset:6144
    s_waitcnt lgkmcnt(6)
    v_mfma_f32_16x16x32_bf16 v[92:95], v[124:127], v[32:35], v[92:95]
    ds_read_b64_tr_b16 v[140:141], v147 offset:4096
    v_mfma_f32_16x16x32_bf16 v[108:111], v[124:127], v[36:39], v[108:111]
    ds_read_b64_tr_b16 v[142:143], v147 offset:6144
    s_not_b32 s91, s66
    s_or_b32 s65, s65, s91
    s_ff1_i32_b32 s91, s65
    s_bitset0_b32 s65, s91
    s_lshl_b32 s79, s91, 12
    s_lshl_b32 s91, s91, 10
    buffer_load_dwordx4 v[64:67], v157, s[16:19], s91 offen offset:0 sc1
    buffer_load_dwordx4 v[68:71], v158, s[16:19], s91 offen offset:0 sc1
    s_waitcnt vmcnt(6) lgkmcnt(6)
L_b_c11:
    v_max_u32 v4, v43, v47
    v_cmp_eq_u32 vcc, -1, v4
    s_cbranch_vccnz L_b_g11
L_b_d11:
    v_mfma_f32_16x16x32_bf16 v[80:83], v[128:131], v[40:43], v[80:83]
    s_xor_b32 s89, s67, s78
    s_mov_b32 s67, s78
    v_xor_b32 v144, s89, v144
    ds_read_b64_tr_b16 v[112:113], v144 offset:0
    v_mfma_f32_16x16x32_bf16 v[96:99], v[128:131], v[44:47], v[96:99]
    ds_read_b64_tr_b16 v[114:115], v144 offset:2048
    s_waitcnt lgkmcnt(6)
    v_mfma_f32_16x16x32_bf16 v[84:87], v[132:135], v[40:43], v[84:87]
    v_xor_b32 v145, s89, v145
    ds_read_b64_tr_b16 v[116:117], v145 offset:0
    v_mfma_f32_16x16x32_bf16 v[100:103], v[132:135], v[44:47], v[100:103]
    ds_read_b64_tr_b16 v[118:119], v145 offset:2048
    s_waitcnt lgkmcnt(6)
    v_mfma_f32_16x16x32_bf16 v[88:91], v[136:139], v[40:43], v[88:91]
    v_xor_b32 v146, s89, v146
    ds_read_b64_tr_b16 v[120:121], v146 offset:0
    v_mfma_f32_16x16x32_bf16 v[104:107], v[136:139], v[44:47], v[104:107]
    ds_read_b64_tr_b16 v[122:123], v146 offset:2048
    s_waitcnt lgkmcnt(6)
    v_mfma_f32_16x16x32_bf16 v[92:95], v[140:143], v[40:43], v[92:95]
    v_xor_b32 v147, s89, v147
    ds_read_b64_tr_b16 v[124:125], v147 offset:0
    v_mfma_f32_16x16x32_bf16 v[108:111], v[140:143], v[44:47], v[108:111]
    ds_read_b64_tr_b16 v[126:127], v147 offset:2048
    buffer_load_dwordx4 v[72:75], v157, s[16:19], s91 offen offset:1024 sc1
    buffer_load_dwordx4 v[76:79], v158, s[16:19], s91 offen offset:1024 sc1
    s_waitcnt vmcnt(6) lgkmcnt(6)
L_b_c12:
    v_max_u32 v4, v51, v55
    v_cmp_eq_u32 vcc, -1, v4
    s_cbranch_vccnz L_b_g12
L_b_d12:
    v_mfma_f32_16x16x32_bf16 v[80:83], v[112:115], v[48:51], v[80:83]
    ds_read_b64_tr_b16 v[128:129], v144 offset:4096
    v_mfma_f32_16x16x32_bf16 v[96:99], v[112:115], v[52:55], v[96:99]
    ds_read_b64_tr_b16 v[130:131], v144 offset:6144
    s_waitcnt lgkmcnt(6)
    v_mfma_f32_16x16x32_bf16 v[84:87], v[116:119], v[48:51], v[84:87]
    ds_read_b64_tr_b16 v[132:133], v145 offset:4096
    v_mfma_f32_16x16x32_bf16 v[100:103], v[116:119], v[52:55], v[100:103]
    ds_read_b64_tr_b16 v[134:135], v145 offset:6144
    s_waitcnt lgkmcnt(6)
    v_mfma_f32_16x16x32_bf16 v[88:91], v[120:123], v[48:51], v[88:91]
    ds_read_b64_tr_b16 v[136:137], v146 offset:4096
    v_mfma_f32_16x16x32_bf16 v[104:107], v[120:123], v[52:55], v[104:107]
    ds_read_b64_tr_b16 v[138:139], v146 offset:6144
    s_waitcnt lgkmcnt(6)
    v_mfma_f32_16x16x32_bf16 v[92:95], v[124:127], v[48:51], v[92:95]
    ds_read_b64_tr_b16 v[140:141], v147 offset:4096
    v_mfma_f32_16x16x32_bf16 v[108:111], v[124:127], v[52:55], v[108:111]
    ds_read_b64_tr_b16 v[142:143], v147 offset:6144
    s_waitcnt vmcnt(4) lgkmcnt(6)
L_b_c13:
    v_max_u32 v4, v59, v63
    v_cmp_eq_u32 vcc, -1, v4
    s_cbranch_vccnz L_b_g13
L_b_d13:
    v_mfma_f32_16x16x32_bf16 v[80:83], v[128:131], v[56:59], v[80:83]
    s_xor_b32 s89, s67, s79
    s_mov_b32 s67, s79
    v_xor_b32 v144, s89, v144
    ds_read_b64_tr_b16 v[112:113], v144 offset:0
    v_mfma_f32_16x16x32_bf16 v[96:99], v[128:131], v[60:63], v[96:99]
    ds_read_b64_tr_b16 v[114:115], v144 offset:2048
    s_waitcnt lgkmcnt(6)
    v_mfma_f32_16x16x32_bf16 v[84:87], v[132:135], v[56:59], v[84:87]
    v_xor_b32 v145, s89, v145
    ds_read_b64_tr_b16 v[116:117], v145 offset:0
    v_mfma_f32_16x16x32_bf16 v[100:103], v[132:135], v[60:63], v[100:103]
    ds_read_b64_tr_b16 v[118:119], v145 offset:2048
    s_waitcnt lgkmcnt(6)
    v_mfma_f32_16x16x32_bf16 v[88:91], v[136:139], v[56:59], v[88:91]
    v_xor_b32 v146, s89, v146
    ds_read_b64_tr_b16 v[120:121], v146 offset:0
    v_mfma_f32_16x16x32_bf16 v[104:107], v[136:139], v[60:63], v[104:107]
    ds_read_b64_tr_b16 v[122:123], v146 offset:2048
    s_waitcnt lgkmcnt(6)
    v_mfma_f32_16x16x32_bf16 v[92:95], v[140:143], v[56:59], v[92:95]
    v_xor_b32 v147, s89, v147
    ds_read_b64_tr_b16 v[124:125], v147 offset:0
    v_mfma_f32_16x16x32_bf16 v[108:111], v[140:143], v[60:63], v[108:111]
    ds_read_b64_tr_b16 v[126:127], v147 offset:2048
    s_waitcnt vmcnt(2) lgkmcnt(6)
L_b_c14:
    v_max_u32 v4, v67, v71
    v_cmp_eq_u32 vcc, -1, v4
    s_cbranch_vccnz L_b_g14
L_b_d14:
    v_mfma_f32_16x16x32_bf16 v[80:83], v[112:115], v[64:67], v[80:83]
    ds_read_b64_tr_b16 v[128:129], v144 offset:4096
    v_mfma_f32_16x16x32_bf16 v[96:99], v[112:115], v[68:71], v[96:99]
    ds_read_b64_tr_b16 v[130:131], v144 offset:6144
    s_waitcnt lgkmcnt(6)
    v_mfma_f32_16x16x32_bf16 v[84:87], v[116:119], v[64:67], v[84:87]
    ds_read_b64_tr_b16 v[132:133], v145 offset:4096
    v_mfma_f32_16x16x32_bf16 v[100:103], v[116:119], v[68:71], v[100:103]
    ds_read_b64_tr_b16 v[134:135], v145 offset:6144
    s_waitcnt lgkmcnt(6)
    v_mfma_f32_16x16x32_bf16 v[88:91], v[120:123], v[64:67], v[88:91]
    ds_read_b64_tr_b16 v[136:137], v146 offset:4096
    v_mfma_f32_16x16x32_bf16 v[104:107], v[120:123], v[68:71], v[104:107]
    ds_read_b64_tr_b16 v[138:139], v146 offset:6144
    s_waitcnt lgkmcnt(6)
    v_mfma_f32_16x16x32_bf16 v[92:95], v[124:127], v[64:67], v[92:95]
    ds_read_b64_tr_b16 v[140:141], v147 offset:4096
    v_mfma_f32_16x16x32_bf16 v[108:111], v[124:127], v[68:71], v[108:111]
    ds_read_b64_tr_b16 v[142:143], v147 offset:6144
    s_waitcnt vmcnt(0) lgkmcnt(6)
L_b_c15:
    v_max_u32 v4, v75, v79
    v_cmp_eq_u32 vcc, -1, v4
    s_cbranch_vccnz L_b_g15
L_b_d15:
    v_cmp_eq_u32 vcc, -1, v156
    s_cbranch_vccz L_ok_3
    s_sub_u32 s56, s56, 1
    s_cbranch_scc0 L_b_restart
    s_mov_b32 s56, 0
L_ok_3:
    v_mfma_f32_16x16x32_bf16 v[80:83], v[128:131], v[72:75], v[80:83]
    s_mov_b32 s90, 71680
    buffer_load_dwordx4 v[204:207], v11, s[32:35], s90 offen
    v_mfma_f32_16x16x32_bf16 v[96:99], v[128:131], v[76:79], v[96:99]
    s_mov_b32 s90, 78848
    buffer_load_dwordx4 v[208:211], v11, s[32:35], s90 offen
    s_waitcnt lgkmcnt(4)
    v_mfma_f32_16x16x32_bf16 v[84:87], v[132:135], v[72:75], v[84:87]
    v_mfma_f32_16x16x32_bf16 v[100:103], v[132:135], v[76:79], v[100:103]
    s_mov_b32 s90, 86016
    buffer_load_dwordx4 v[212:215], v11, s[32:35], s90 offen
    s_waitcnt lgkmcnt(2)
    v_mfma_f32_16x16x32_bf16 v[88:91], v[136:139], v[72:75], v[88:91]
L_walk_18:
    s_cbranch_execz L_walk_22
    s_mov_b32 s90, 93184
    buffer_load_dwordx4 v[216:219], v11, s[32:35], s90 offen
    v_mfma_f32_16x16x32_bf16 v[104:107], v[136:139], v[76:79], v[104:107]
    s_mov_b32 s90, 100352
    buffer_load_dwordx4 v[220:223], v11, s[32:35], s90 offen
    s_waitcnt lgkmcnt(0)
    v_mfma_f32_16x16x32_bf16 v[92:95], v[140:143], v[72:75], v[92:95]
    v_mfma_f32_16x16x32_bf16 v[108:111], v[140:143], v[76:79], v[108:111]
    s_mov_b32 s90, 107520
    buffer_load_dwordx4 v[224:227], v11, s[32:35], s90 offen
    ds_write_b128 v162, v[96:99] offset:0
    ds_write_b128 v162, v[100:103] offset:1024
    ds_write_b128 v162, v[104:107] offset:2048
    s_nop 2
    ds_write_b128 v162, v[108:111] offset:3072
    s_waitcnt lgkmcnt(0)
    s_barrier
    ds_read_b128 v[16:19], v163 offset:0
    ds_read_b128 v[20:23], v163 offset:1024
    ds_read_b128 v[24:27], v163 offset:2048
    ds_read_b128 v[28:31], v163 offset:3072
    s_waitcnt lgkmcnt(3)
    v_pk_add_f32 v[80:81], v[80:81], v[16:17]
    v_pk_add_f32 v[82:83], v[82:83], v[18:19]
    v_cvt_pk_bf16_f32 v32, v80, v81
    v_cvt_pk_bf16_f32 v33, v82, v83
    s_waitcnt lgkmcnt(2)
    v_pk_add_f32 v[84:85], v[84:85], v[20:21]
    v_pk_add_f32 v[86:87], v[86:87], v[22:23]
    v_cvt_pk_bf16_f32 v34, v84, v85
    v_cvt_pk_bf16_f32 v35, v86, v87
    s_waitcnt lgkmcnt(1)
    v_pk_add_f32 v[88:89], v[88:89], v[24:25]
    v_pk_add_f32 v[90:91], v[90:91], v[26:27]
    v_cvt_pk_bf16_f32 v36, v88, v89
    v_cvt_pk_bf16_f32 v37, v90, v91
    s_waitcnt lgkmcnt(0)
    v_pk_add_f32 v[92:93], v[92:93], v[28:29]
    v_pk_add_f32 v[94:95], v[94:95], v[30:31]
    v_cvt_pk_bf16_f32 v38, v92, v93
    v_cvt_pk_bf16_f32 v39, v94, v95
    v_mfma_f32_16x16x32_bf16 v[60:63], v[32:35], v[32:35], 0
    v_mfma_f32_16x16x32_bf16 v[56:59], v[32:35], v[148:151], 0
    v_mfma_f32_16x16x32_bf16 v[60:63], v[36:39], v[36:39], v[60:63]
    v_mfma_f32_16x16x32_bf16 v[56:59], v[36:39], v[152:155], v[56:59]
    v_lshlrev_b32 v40, 16, v32
    v_and_b32 v41, 0xffff0000, v32
    v_lshlrev_b32 v42, 16, v33
    v_and_b32 v43, 0xffff0000, v33
    v_lshlrev_b32 v44, 16, v34
    v_and_b32 v45, 0xffff0000, v34
    s_nop 1
    v_cndmask_b32 v56, v56, v60, s[72:73]
    v_cndmask_b32 v57, v57, v61, s[72:73]
    v_cndmask_b32 v58, v58, v62, s[72:73]
    v_cndmask_b32 v59, v59, v63, s[72:73]
    v_cndmask_b32 v56, v56, v57, s[4:5]
    v_cndmask_b32 v58, v58, v59, s[98:99]
    s_or_b64 vcc, s[6:7], s[98:99]
    v_cndmask_b32 v56, v56, v58, vcc
    v_cndmask_b32 v56, v56, 1.0, s[74:75]
    v_mov_b32 v67, v56
    buffer_atomic_add_f32 v67, v160, s[16:19], 0 offen sc0 sc1
    s_mov_b32 s90, 0
    buffer_load_dwordx4 v[228:231], v14, s[36:39], s90 offen
    s_mov_b32 s90, 2048
    buffer_load_dwordx4 v[232:235], v14, s[36:39], s90 offen
    s_mov_b32 s90, 4096
    buffer_load_dwordx4 v[236:239], v14, s[36:39], s90 offen
    s_lshl_b32 s86, s3, 11
    s_add_u32 s86, s86, 69632
    v_lshl_add_u32 v150, v0, 4, s86
    ds_write_b128 v150, v[32:35]
    ds_write_b128 v150, v[36:39] offset:1024
    s_lshl_b32 s86, s3, 7
    s_add_u32 s86, s86, 66560
    v_lshl_add_u32 v151, v2, 3, s86
    s_cmp_eq_u32 s62, 0
    s_cbranch_scc1 L_unp
    v_and_b32 v24, 1, v0
    v_cmp_eq_u32 vcc, 1, v24
    v_mov_b32 v24, 0x0c0c0100
    v_mov_b32 v25, 0x01000c0c
    v_cndmask_b32 v16, v24, v25, vcc
    v_mov_b32 v24, 0x0c0c0302
    v_mov_b32 v25, 0x03020c0c
    v_cndmask_b32 v17, v24, v25, vcc
    v_bfe_u32 v24, v0, 1, 2
    v_mov_b32 v25, 0x0c0c0c0c
    v_cmp_eq_u32 vcc, 0, v24
    s_nop 1
    v_cndmask_b32 v72, v25, v16, vcc
    v_cndmask_b32 v76, v25, v17, vcc
    v_cmp_eq_u32 vcc, 1, v24
    s_nop 1
    v_cndmask_b32 v73, v25, v16, vcc
    v_cndmask_b32 v77, v25, v17, vcc
    v_cmp_eq_u32 vcc, 2, v24
    s_nop 1
    v_cndmask_b32 v74, v25, v16, vcc
    v_cndmask_b32 v78, v25, v17, vcc
    v_cmp_eq_u32 vcc, 3, v24
    s_nop 1
    v_cndmask_b32 v75, v25, v16, vcc
    v_cndmask_b32 v79, v25, v17, vcc
    s_lshl_b32 s86, s48, 10
    s_add_u32 s86, s86, 90112
    v_lshl_add_u32 v18, v0, 4, s86
    s_and_b32 s86, s48, 1
    s_cselect_b32 s87, s81, s80
    s_mul_i32 s88, s87, 299616
    s_lshr_b32 s88, s88, 16
    s_mul_i32 s89, s88, 14
    s_lshl_b32 s90, s87, 6
    s_sub_u32 s89, s89, s90
    s_lshr_b32 s90, s48, 1
    s_lshl1_add_u32 s88, s88, s90
    s_and_b32 s91, s2, 1
    s_lshl1_add_u32 s88, s88, s91
    s_lshl_b32 s88, s88, 7
    s_add_u32 s88, s88, 6291456
    s_cmp_lt_u32 s87, 56
    s_cselect_b32 s88, s88, 2147483648
    s_lshl_b32 s90, s90, 9
    s_lshl_b32 s86, s86, 7
    s_add_u32 s86, s86, s90
    s_add_u32 s86, s86, 90112
    v_mul_u32_u24 v16, 14, v1
    v_add3_u32 v16, v16, v2, s89
    v_cmp_eq_u32 s[4:5], 14, v2
    v_cmp_gt_u32 vcc, 14, v2
    s_nop 1
    v_cndmask_b32 v21, 0, 64, vcc
    v_mov_b32 v17, 78
    v_cndmask_b32 v21, v21, v17, s[4:5]
    v_lshl_add_u32 v22, v1, 9, s88
    v_lshl_add_u32 v22, v2, 2, v22
    v_mov_b32 v23, 2147483648
    v_cmp_lt_u32 vcc, v16, v21
    s_nop 1
    v_cndmask_b32 v131, v23, v22, vcc
    v_sub_u32 v17, 78, v16
    v_min3_i32 v17, v17, v16, 14
    v_cvt_f32_i32 v135, v17
    v_bfe_u32 v17, v16, 3, 3
    v_lshl_add_u32 v133, v17, 4, s86
    v_bfe_u32 v17, v16, 2, 1
    v_lshl_add_u32 v133, v17, 8, v133
    v_and_b32 v17, 3, v16
    v_lshl_add_u32 v133, v17, 2, v133
    v_add_u32 v16, 56, v16
    v_add_u32 v22, 2048, v22
    v_cmp_lt_u32 vcc, v16, v21
    s_nop 1
    v_cndmask_b32 v132, v23, v22, vcc
    v_sub_u32 v17, 78, v16
    v_min3_i32 v17, v17, v16, 14
    v_cvt_f32_i32 v136, v17
    v_bfe_u32 v17, v16, 3, 3
    v_lshl_add_u32 v134, v17, 4, s86
    v_bfe_u32 v17, v16, 2, 1
    v_lshl_add_u32 v134, v17, 8, v134
    v_and_b32 v17, 3, v16
    v_lshl_add_u32 v134, v17, 2, v134
    s_lshl2_add_u32 s86, s45, s48
    s_lshl_b32 s86, s86, 10
    s_add_u32 s86, s86, 6291456
    v_lshrrev_b32 v16, 3, v0
    v_lshl_add_u32 v137, v16, 7, s86
    v_and_b32 v16, 7, v0
    v_lshl_add_u32 v137, v16, 3, v137
    v_mov_b32 v138, 0
    v_mov_b32 v139, 0
    s_branch L_unpd
L_walk_19:
    s_cbranch_execz L_walk_23
L_unp:
    v_lshlrev_b32 v46, 16, v35
    v_and_b32 v47, 0xffff0000, v35
    v_lshlrev_b32 v48, 16, v36
    v_and_b32 v49, 0xffff0000, v36
    v_lshlrev_b32 v50, 16, v37
    v_and_b32 v51, 0xffff0000, v37
    v_lshlrev_b32 v52, 16, v38
    v_and_b32 v53, 0xffff0000, v38
    v_lshlrev_b32 v54, 16, v39
    v_and_b32 v55, 0xffff0000, v39
L_unpd:
    v_lshrrev_b32 v8, 2, v2
    v_lshlrev_b32 v9, 4, v8
    v_sub_u32 v9, v161, v9
    v_cmp_eq_u32 vcc, 0, v8
    s_nop 1
    v_cndmask_b32 v10, 0, 32, vcc
    v_add_u32 v10, v9, v10
    v_cmp_eq_u32 vcc, 1, v8
    s_nop 1
    v_cndmask_b32 v8, 16, 48, vcc
    v_add_u32 v9, v9, v8
    s_lshl_b32 s86, s52, 11
    s_lshr_b32 s87, s51, 3
    s_lshl_b32 s87, s87, 6
    s_add_u32 s86, s86, s87
    s_and_b32 s87, s51, 7
    s_lshl3_add_u32 s86, s87, s86
    s_add_u32 s86, s86, 6684672
    v_lshl_add_u32 v149, v0, 7, s86
    v_mov_b32 v8, 2147483648
    v_cmp_gt_u32 vcc, 16, v0
    s_nop 1
    v_cndmask_b32 v149, v8, v149, vcc
    s_bfe_u32 s67, s2, 0x20001
    s_lshl2_add_u32 s67, s67, s48
    s_and_b32 s86, s2, 1
    s_lshl1_add_u32 s87, s45, s86
    s_and_b32 s87, s87, 15
    s_lshl_b32 s86, s67, 4
    s_add_u32 s86, s86, s87
    s_lshl_b32 s86, s86, 7
    s_add_u32 s86, s86, 6684672
    v_lshl_add_u32 v148, v0, 3, s86
    v_mov_b32 v8, 2147483648
    v_cmp_gt_u32 vcc, 16, v0
    s_nop 1
    v_cndmask_b32 v148, v8, v148, vcc
    s_lshl_b32 s67, s67, 7
    s_add_u32 s67, s67, 6619136
    s_waitcnt vmcnt(3)
    v_add_f32 v67, v67, v56
    s_branch L_h3_chk
L_h3:
    v_mov_b32 v67, 0
    buffer_atomic_or v67, v160, s[16:19], 0 offen sc0 sc1
    s_waitcnt vmcnt(0)
L_h3_chk:
    v_cmp_ne_u32 vcc, 0x41800000, v67
    s_nop 0
    s_and_b64 vcc, vcc, s[74:75]
    s_cbranch_vccz L_ok_4
    s_sub_u32 s56, s56, 1
    s_cbranch_scc0 L_h3
    s_mov_b32 s56, 0
L_ok_4:
    ds_bpermute_b32 v64, v10, v67
    ds_bpermute_b32 v66, v161, v67
    ds_bpermute_b32 v65, v9, v67
    s_cmp_eq_u32 s62, 0
    s_cbranch_scc1 L_nop0
    v_mov_b32 v128, 0
    v_mov_b32 v129, 0
    buffer_atomic_or_x2 v[128:129], v148, s[16:19], 0 offen sc0 sc1
L_nop0:
    s_waitcnt lgkmcnt(0)
    v_mul_f32 v64, 0x3a800000, v64
    v_mul_f32 v66, 0x3a800000, v66
    v_fma_f32 v66, -v64, v64, v66
    v_max_f32 v66, 0, v66
    v_cvt_pk_bf16_f32 v69, v64, v66
    v_lshlrev_b32 v68, 16, v69
    v_and_b32 v69, 0xffff0000, v69
    v_add_f32 v69, 0x3727c5ac, v69
    v_cvt_pk_bf16_f32 v69, v69, v69
    v_lshlrev_b32 v69, 16, v69
    v_sqrt_f32 v69, v69
    s_nop 0
    v_cvt_pk_bf16_f32 v69, v69, v69
    v_lshlrev_b32 v69, 16, v69
    v_rcp_f32 v70, v69
    v_fma_f32 v12, -v68, s57, v65
    v_mul_f32 v12, v12, v70
    v_mul_f32 v71, -v68, v70
    v_cvt_pk_bf16_f32 v12, v12, v12
    v_ashrrev_i32 v8, 31, v12
    v_or_b32 v8, 0x80000000, v8
    v_xor_b32 v8, v8, v12
    v_and_b32 v8, 4294901760, v8
    v_or_b32 v13, v8, v6
    s_lshl_b32 s86, s3, 6
    s_add_u32 s86, s86, 65536
    v_lshl_add_u32 v8, v2, 2, s86
    ds_write_b32 v8, v13
    ds_write_b64 v151, v[70:71]
    v_mov_b32 v152, v8
    s_cmp_lg_u32 s62, 0
    s_cbranch_scc1 L_nohn
    v_pk_fma_f32 v[16:17], v[40:41], v[70:71], v[70:71] op_sel:[0,0,1] op_sel_hi:[1,0,1]
    v_pk_fma_f32 v[18:19], v[42:43], v[70:71], v[70:71] op_sel:[0,0,1] op_sel_hi:[1,0,1]
    v_pk_fma_f32 v[20:21], v[44:45], v[70:71], v[70:71] op_sel:[0,0,1] op_sel_hi:[1,0,1]
    v_pk_fma_f32 v[22:23], v[46:47], v[70:71], v[70:71] op_sel:[0,0,1] op_sel_hi:[1,0,1]
    v_pk_fma_f32 v[24:25], v[48:49], v[70:71], v[70:71] op_sel:[0,0,1] op_sel_hi:[1,0,1]
    v_pk_fma_f32 v[26:27], v[50:51], v[70:71], v[70:71] op_sel:[0,0,1] op_sel_hi:[1,0,1]
    v_pk_fma_f32 v[28:29], v[52:53], v[70:71], v[70:71] op_sel:[0,0,1] op_sel_hi:[1,0,1]
    v_pk_fma_f32 v[30:31], v[54:55], v[70:71], v[70:71] op_sel:[0,0,1] op_sel_hi:[1,0,1]
L_nohn:
    v_lshlrev_b32 v8, 3, v0
    v_add_u32 v8, 65536, v8
    s_waitcnt lgkmcnt(0)
    s_barrier
    ds_read_b64 v[64:65], v8
    s_cmp_lg_u32 s62, 0
    s_cbranch_scc1 L_t3_ld
    ds_read_b32 v144, v152 offset:256
    ds_read_b64 v[142:143], v151 offset:512
    ds_read_b128 v[112:115], v150 offset:8192
    ds_read_b128 v[116:119], v150 offset:9216
    v_cvt_pk_bf16_f32 v96, v16, v17
    v_cvt_pk_bf16_f32 v97, v18, v19
    v_cvt_pk_bf16_f32 v98, v20, v21
    v_cvt_pk_bf16_f32 v99, v22, v23
    v_cvt_pk_bf16_f32 v100, v24, v25
    v_cvt_pk_bf16_f32 v101, v26, v27
    v_cvt_pk_bf16_f32 v102, v28, v29
    v_cvt_pk_bf16_f32 v103, v30, v31
    s_waitcnt lgkmcnt(4)
    v_max_u32 v66, v64, v65
    v_min_u32 v67, v64, v65
    s_nop 0
    v_min_u32_dpp v64, v66, v66 row_ror:8 row_mask:0xf bank_mask:0xf
    v_max_u32_dpp v66, v66, v66 row_ror:8 row_mask:0xf bank_mask:0xf
    v_max_u32_dpp v65, v67, v67 row_ror:8 row_mask:0xf bank_mask:0xf
    v_max_u32 v67, v64, v65
    v_min_u32_dpp v64, v66, v66 row_ror:4 row_mask:0xf bank_mask:0xf
    v_max_u32_dpp v66, v66, v66 row_ror:4 row_mask:0xf bank_mask:0xf
    v_max_u32_dpp v65, v67, v67 row_ror:4 row_mask:0xf bank_mask:0xf
    v_max_u32 v67, v64, v65
    v_min_u32_dpp v64, v66, v66 row_ror:2 row_mask:0xf bank_mask:0xf
    v_max_u32_dpp v66, v66, v66 row_ror:2 row_mask:0xf bank_mask:0xf
    v_max_u32_dpp v65, v67, v67 row_ror:2 row_mask:0xf bank_mask:0xf
    v_max_u32 v67, v64, v65
    v_min_u32_dpp v64, v66, v66 row_ror:1 row_mask:0xf bank_mask:0xf
    v_max_u32_dpp v66, v66, v66 row_ror:1 row_mask:0xf bank_mask:0xf
    v_max_u32_dpp v65, v67, v67 row_ror:1 row_mask:0xf bank_mask:0xf
    v_max_u32 v67, v64, v65
    v_readlane_b32 s58, v66, 0
    v_readlane_b32 s59, v67, 0
    v_readlane_b32 s86, v66, 16
    v_readlane_b32 s87, v67, 16
    s_nop 0
    s_max_u32 s59, s59, s87
    s_min_u32 s87, s58, s86
    s_max_u32 s58, s58, s86
    s_max_u32 s59, s59, s87
    v_readlane_b32 s86, v66, 32
    v_readlane_b32 s87, v67, 32
    s_nop 0
    s_max_u32 s59, s59, s87
    s_min_u32 s87, s58, s86
    s_max_u32 s58, s58, s86
    s_max_u32 s59, s59, s87
    v_readlane_b32 s86, v66, 48
    v_readlane_b32 s87, v67, 48
    s_nop 0
    s_max_u32 s59, s59, s87
    s_min_u32 s87, s58, s86
    s_max_u32 s58, s58, s86
    s_max_u32 s59, s59, s87
    s_cmp_lg_u32 s3, 0
    s_cbranch_scc1 L_nokey
    v_mov_b32 v8, s58
    v_mov_b32 v9, s59
    buffer_atomic_swap_x2 v[8:9], v149, s[16:19], 0 offen sc1
L_nokey:
    v_cmp_eq_u32 s[4:5], s58, v13
    v_cmp_eq_u32 s[6:7], s59, v13
    s_nop 0
    s_or_b64 s[96:97], s[4:5], s[6:7]
    s_cbranch_scc0 L_nocand
    s_lshl_b32 s86, s51, 12
    s_lshl_b32 s87, s52, 7
    s_add_u32 s86, s86, s87
    s_add_u32 s86, s86, 6619136
L_walk_20:
    s_cbranch_execz L_walk_24
    v_lshl_add_u32 v8, v1, 3, s86
    v_add_u32 v9, 2048, v8
    v_cndmask_b32 v8, v8, v9, s[6:7]
    v_mov_b32 v9, 2147483648
    v_cndmask_b32 v8, v9, v8, s[96:97]
    buffer_store_dwordx2 v[96:97], v8, s[16:19], 0 offen offset:0 sc1
    buffer_store_dwordx2 v[98:99], v8, s[16:19], 0 offen offset:32 sc1
    buffer_store_dwordx2 v[100:101], v8, s[16:19], 0 offen offset:64 sc1
    buffer_store_dwordx2 v[102:103], v8, s[16:19], 0 offen offset:96 sc1
    v_subrev_u32 v131, 65536, v8
L_nocand:
    s_waitcnt lgkmcnt(0)
    v_lshlrev_b32 v80, 16, v112
    v_and_b32 v81, 0xffff0000, v112
    v_lshlrev_b32 v82, 16, v113
    v_and_b32 v83, 0xffff0000, v113
    v_lshlrev_b32 v84, 16, v114
    v_and_b32 v85, 0xffff0000, v114
    v_lshlrev_b32 v86, 16, v115
    v_and_b32 v87, 0xffff0000, v115
    v_lshlrev_b32 v88, 16, v116
    v_and_b32 v89, 0xffff0000, v116
    v_lshlrev_b32 v90, 16, v117
    v_and_b32 v91, 0xffff0000, v117
    v_lshlrev_b32 v92, 16, v118
    v_and_b32 v93, 0xffff0000, v118
    v_lshlrev_b32 v94, 16, v119
    v_and_b32 v95, 0xffff0000, v119
    v_pk_fma_f32 v[16:17], v[80:81], v[142:143], v[142:143] op_sel:[0,0,1] op_sel_hi:[1,0,1]
    v_pk_fma_f32 v[18:19], v[82:83], v[142:143], v[142:143] op_sel:[0,0,1] op_sel_hi:[1,0,1]
    v_pk_fma_f32 v[20:21], v[84:85], v[142:143], v[142:143] op_sel:[0,0,1] op_sel_hi:[1,0,1]
    v_pk_fma_f32 v[22:23], v[86:87], v[142:143], v[142:143] op_sel:[0,0,1] op_sel_hi:[1,0,1]
    v_pk_fma_f32 v[24:25], v[88:89], v[142:143], v[142:143] op_sel:[0,0,1] op_sel_hi:[1,0,1]
    v_pk_fma_f32 v[26:27], v[90:91], v[142:143], v[142:143] op_sel:[0,0,1] op_sel_hi:[1,0,1]
    v_pk_fma_f32 v[28:29], v[92:93], v[142:143], v[142:143] op_sel:[0,0,1] op_sel_hi:[1,0,1]
    v_pk_fma_f32 v[30:31], v[94:95], v[142:143], v[142:143] op_sel:[0,0,1] op_sel_hi:[1,0,1]
    v_cvt_pk_bf16_f32 v132, v16, v17
    v_cvt_pk_bf16_f32 v133, v18, v19
    v_cvt_pk_bf16_f32 v134, v20, v21
    v_cvt_pk_bf16_f32 v135, v22, v23
    v_cvt_pk_bf16_f32 v136, v24, v25
    v_cvt_pk_bf16_f32 v137, v26, v27
    v_cvt_pk_bf16_f32 v138, v28, v29
    v_cvt_pk_bf16_f32 v139, v30, v31
    v_cmp_eq_u32 s[4:5], s58, v144
    v_cmp_eq_u32 s[6:7], s59, v144
    s_nop 0
    s_or_b64 s[70:71], s[4:5], s[6:7]
    s_cbranch_scc0 L_nocand2
    s_lshl_b32 s86, s51, 12
    s_lshl_b32 s87, s52, 7
    s_add_u32 s86, s86, s87
    s_add_u32 s86, s86, 6619136
    v_lshl_add_u32 v8, v1, 3, s86
    v_add_u32 v9, 2048, v8
    v_cndmask_b32 v8, v8, v9, s[6:7]
    v_mov_b32 v9, 2147483648
    v_cndmask_b32 v8, v9, v8, s[70:71]
    buffer_store_dwordx2 v[132:133], v8, s[16:19], 0 offen offset:0 sc1
    buffer_store_dwordx2 v[134:135], v8, s[16:19], 0 offen offset:32 sc1
    buffer_store_dwordx2 v[136:137], v8, s[16:19], 0 offen offset:64 sc1
    buffer_store_dwordx2 v[138:139], v8, s[16:19], 0 offen offset:96 sc1
    v_subrev_u32 v140, 65536, v8
L_nocand2:
    v_mov_b32 v9, 2147483648
    v_xor_b32 v6, 0x8000, v5
    v_lshlrev_b32 v16, 16, v96
    v_and_b32 v17, 0xffff0000, v96
    v_lshlrev_b32 v18, 16, v97
    v_and_b32 v19, 0xffff0000, v97
    v_lshlrev_b32 v20, 16, v98
    v_and_b32 v21, 0xffff0000, v98
    v_lshlrev_b32 v22, 16, v99
    v_and_b32 v23, 0xffff0000, v99
    v_lshlrev_b32 v24, 16, v100
    v_and_b32 v25, 0xffff0000, v100
    v_lshlrev_b32 v26, 16, v101
    v_and_b32 v27, 0xffff0000, v101
    v_lshlrev_b32 v28, 16, v102
    v_and_b32 v29, 0xffff0000, v102
    v_lshlrev_b32 v30, 16, v103
    v_and_b32 v31, 0xffff0000, v103
    v_pk_add_f32 v[16:17], v[16:17], v[40:41]
    v_pk_add_f32 v[18:19], v[18:19], v[42:43]
    v_pk_add_f32 v[20:21], v[20:21], v[44:45]
    v_pk_add_f32 v[22:23], v[22:23], v[46:47]
    v_pk_add_f32 v[24:25], v[24:25], v[48:49]
    v_pk_add_f32 v[26:27], v[26:27], v[50:51]
    v_pk_add_f32 v[28:29], v[28:29], v[52:53]
    v_pk_add_f32 v[30:31], v[30:31], v[54:55]
    v_cvt_pk_bf16_f32 v104, v16, v17
    v_cvt_pk_bf16_f32 v105, v18, v19
    v_cvt_pk_bf16_f32 v106, v20, v21
    v_cvt_pk_bf16_f32 v107, v22, v23
    v_cvt_pk_bf16_f32 v108, v24, v25
    v_cvt_pk_bf16_f32 v109, v26, v27
    v_cvt_pk_bf16_f32 v110, v28, v29
    v_cvt_pk_bf16_f32 v111, v30, v31
    v_permlane16_swap_b32 v104, v106
    v_permlane16_swap_b32 v105, v107
    v_permlane16_swap_b32 v108, v110
    v_permlane16_swap_b32 v109, v111
    v_mov_b32 v16, v104
    v_mov_b32 v17, v105
    v_mov_b32 v18, v106
    v_mov_b32 v19, v107
    v_mov_b32_dpp v104, v108 row_ror:8 row_mask:0xf bank_mask:0xc
    v_mov_b32_dpp v105, v109 row_ror:8 row_mask:0xf bank_mask:0xc
    v_mov_b32_dpp v106, v110 row_ror:8 row_mask:0xf bank_mask:0xc
    v_mov_b32_dpp v107, v111 row_ror:8 row_mask:0xf bank_mask:0xc
    v_mov_b32_dpp v108, v16 row_ror:8 row_mask:0xf bank_mask:0x3
    v_mov_b32_dpp v109, v17 row_ror:8 row_mask:0xf bank_mask:0x3
    v_mov_b32_dpp v110, v18 row_ror:8 row_mask:0xf bank_mask:0x3
    v_mov_b32_dpp v111, v19 row_ror:8 row_mask:0xf bank_mask:0x3
    v_cndmask_b32 v8, v5, v9, s[96:97]
    v_lshlrev_b32 v16, 16, v132
    v_and_b32 v17, 0xffff0000, v132
    v_lshlrev_b32 v18, 16, v133
    v_and_b32 v19, 0xffff0000, v133
    v_lshlrev_b32 v20, 16, v134
    v_and_b32 v21, 0xffff0000, v134
    v_lshlrev_b32 v22, 16, v135
    v_and_b32 v23, 0xffff0000, v135
    v_lshlrev_b32 v24, 16, v136
    v_and_b32 v25, 0xffff0000, v136
    v_lshlrev_b32 v26, 16, v137
    v_and_b32 v27, 0xffff0000, v137
    v_lshlrev_b32 v28, 16, v138
    v_and_b32 v29, 0xffff0000, v138
    v_lshlrev_b32 v30, 16, v139
    v_and_b32 v31, 0xffff0000, v139
    v_pk_add_f32 v[16:17], v[16:17], v[80:81]
    v_pk_add_f32 v[18:19], v[18:19], v[82:83]
    v_pk_add_f32 v[20:21], v[20:21], v[84:85]
    v_pk_add_f32 v[22:23], v[22:23], v[86:87]
    v_pk_add_f32 v[24:25], v[24:25], v[88:89]
    v_pk_add_f32 v[26:27], v[26:27], v[90:91]
    v_pk_add_f32 v[28:29], v[28:29], v[92:93]
    v_pk_add_f32 v[30:31], v[30:31], v[94:95]
    v_cvt_pk_bf16_f32 v120, v16, v17
    v_cvt_pk_bf16_f32 v121, v18, v19
    v_cvt_pk_bf16_f32 v122, v20, v21
    v_cvt_pk_bf16_f32 v123, v22, v23
    v_cvt_pk_bf16_f32 v124, v24, v25
    v_cvt_pk_bf16_f32 v125, v26, v27
    v_cvt_pk_bf16_f32 v126, v28, v29
    v_cvt_pk_bf16_f32 v127, v30, v31
    v_permlane16_swap_b32 v120, v122
    v_permlane16_swap_b32 v121, v123
    v_permlane16_swap_b32 v124, v126
    v_permlane16_swap_b32 v125, v127
    v_mov_b32 v16, v120
    v_mov_b32 v17, v121
    v_mov_b32 v18, v122
    v_mov_b32 v19, v123
    v_mov_b32_dpp v120, v124 row_ror:8 row_mask:0xf bank_mask:0xc
    v_mov_b32_dpp v121, v125 row_ror:8 row_mask:0xf bank_mask:0xc
    v_mov_b32_dpp v122, v126 row_ror:8 row_mask:0xf bank_mask:0xc
    v_mov_b32_dpp v123, v127 row_ror:8 row_mask:0xf bank_mask:0xc
    v_mov_b32_dpp v124, v16 row_ror:8 row_mask:0xf bank_mask:0x3
    v_mov_b32_dpp v125, v17 row_ror:8 row_mask:0xf bank_mask:0x3
L_walk_21:
    s_cbranch_execz L_walked
    v_mov_b32_dpp v126, v18 row_ror:8 row_mask:0xf bank_mask:0x3
    v_mov_b32_dpp v127, v19 row_ror:8 row_mask:0xf bank_mask:0x3
    s_cmp_eq_u64 s[96:97], 0
    s_cbranch_scc1 L_noha
    buffer_store_dwordx2 v[32:33], v131, s[16:19], 0 offen offset:0 sc1
    buffer_store_dwordx2 v[34:35], v131, s[16:19], 0 offen offset:32 sc1
    buffer_store_dwordx2 v[36:37], v131, s[16:19], 0 offen offset:64 sc1
    buffer_store_dwordx2 v[38:39], v131, s[16:19], 0 offen offset:96 sc1
L_noha:
    s_cmp_eq_u64 s[70:71], 0
    s_cbranch_scc1 L_nohb
    buffer_store_dwordx2 v[112:113], v140, s[16:19], 0 offen offset:0 sc1
    buffer_store_dwordx2 v[114:115], v140, s[16:19], 0 offen offset:32 sc1
    buffer_store_dwordx2 v[116:117], v140, s[16:19], 0 offen offset:64 sc1
    buffer_store_dwordx2 v[118:119], v140, s[16:19], 0 offen offset:96 sc1
L_nohb:
    v_mov_b32 v8, 66304
    s_barrier
    ds_read_b64 v[10:11], v8
    s_barrier
    s_waitcnt lgkmcnt(0)
    v_cmp_ne_u32 s[4:5], v10, v13
    v_cmp_ne_u32 s[6:7], v11, v13
    s_nop 0
    s_and_b64 s[4:5], s[4:5], s[6:7]
    v_cndmask_b32 v8, v9, v5, s[4:5]
    v_add_u32 v7, 64, v8
    v_mov_b32 v4, v8
    s_nop 1
    v_mov_b32_dpp v4, v7 row_ror:8 row_mask:0xf bank_mask:0xc
    v_mov_b32_dpp v7, v8 row_ror:8 row_mask:0xf bank_mask:0x3
    buffer_store_dwordx4 v[104:107], v4, s[24:27], 0 offen sc1
    buffer_store_dwordx4 v[108:111], v7, s[24:27], 0 offen sc1
    v_cmp_ne_u32 s[4:5], v10, v144
    v_cmp_ne_u32 s[6:7], v11, v144
    s_nop 0
    s_and_b64 s[4:5], s[4:5], s[6:7]
    v_cndmask_b32 v8, v9, v6, s[4:5]
    v_add_u32 v7, 64, v8
    v_mov_b32 v4, v8
    s_nop 1
    v_mov_b32_dpp v4, v7 row_ror:8 row_mask:0xf bank_mask:0xc
    v_mov_b32_dpp v7, v8 row_ror:8 row_mask:0xf bank_mask:0x3
    buffer_store_dwordx4 v[120:123], v4, s[24:27], 0 offen sc1
    buffer_store_dwordx4 v[124:127], v7, s[24:27], 0 offen sc1
    s_branch L_fin
L_t3_ld:
    s_mov_b32 s90, 6144
    buffer_load_dwordx4 v[240:243], v14, s[36:39], s90 offen
    s_mov_b32 s90, 8192
    buffer_load_dwordx4 v[244:247], v14, s[36:39], s90 offen
    s_mov_b32 s90, 10240
    buffer_load_dwordx4 v[248:251], v14, s[36:39], s90 offen
    s_mov_b32 s90, 12288
    buffer_load_dwordx4 v[252:255], v14, s[36:39], s90 offen
    v_bfe_u32 v8, v0, 3, 1
    v_lshl_add_u32 v10, v1, 5, s67
    s_mov_b32 s60, 0
    s_mov_b32 s61, 0
    s_lshl_b32 s63, 1, s51
    s_mov_b32 m0, s51
    s_waitcnt lgkmcnt(0)
    v_max_u32 v98, v64, v65
    v_min_u32 v99, v64, v65
    s_nop 0
    v_min_u32_dpp v96, v98, v98 row_ror:8 row_mask:0xf bank_mask:0xf
    v_max_u32_dpp v98, v98, v98 row_ror:8 row_mask:0xf bank_mask:0xf
    v_max_u32_dpp v97, v99, v99 row_ror:8 row_mask:0xf bank_mask:0xf
    v_max_u32 v99, v96, v97
    v_min_u32_dpp v96, v98, v98 row_ror:4 row_mask:0xf bank_mask:0xf
    v_max_u32_dpp v98, v98, v98 row_ror:4 row_mask:0xf bank_mask:0xf
    v_max_u32_dpp v97, v99, v99 row_ror:4 row_mask:0xf bank_mask:0xf
    v_max_u32 v99, v96, v97
    v_min_u32_dpp v96, v98, v98 row_ror:2 row_mask:0xf bank_mask:0xf
    v_max_u32_dpp v98, v98, v98 row_ror:2 row_mask:0xf bank_mask:0xf
    v_max_u32_dpp v97, v99, v99 row_ror:2 row_mask:0xf bank_mask:0xf
    v_max_u32 v99, v96, v97
    v_min_u32_dpp v96, v98, v98 row_ror:1 row_mask:0xf bank_mask:0xf
    v_max_u32_dpp v98, v98, v98 row_ror:1 row_mask:0xf bank_mask:0xf
    v_max_u32_dpp v97, v99, v99 row_ror:1 row_mask:0xf bank_mask:0xf
    v_max_u32 v99, v96, v97
    v_readlane_b32 s58, v98, 0
    v_readlane_b32 s59, v99, 0
    v_readlane_b32 s86, v98, 16
    v_readlane_b32 s87, v99, 16
    s_nop 0
    s_max_u32 s59, s59, s87
    s_min_u32 s87, s58, s86
    s_max_u32 s58, s58, s86
    s_max_u32 s59, s59, s87
    v_readlane_b32 s86, v98, 32
    v_readlane_b32 s87, v99, 32
    s_nop 0
    s_max_u32 s59, s59, s87
    s_min_u32 s87, s58, s86
    s_max_u32 s58, s58, s86
    s_max_u32 s59, s59, s87
    v_readlane_b32 s86, v98, 48
    v_readlane_b32 s87, v99, 48
    s_nop 0
    s_max_u32 s59, s59, s87
    s_min_u32 s87, s58, s86
    s_max_u32 s58, s58, s86
    s_max_u32 s59, s59, s87
    s_waitcnt vmcnt(4)
    s_branch L_h4_chk0
L_h4_w0:
    s_waitcnt vmcnt(0)
L_h4_chk0:
    v_cmp_eq_u32 vcc, -1, v128
    s_nop 0
    s_andn2_b32 s86, vcc_lo, s63
    s_cbranch_scc0 L_h4_all0
    v_cndmask_b32 v96, v128, 0, vcc
    v_cndmask_b32 v97, v129, 0, vcc
    v_mov_b32 v128, 0
    v_mov_b32 v129, 0
    buffer_atomic_or_x2 v[128:129], v148, s[16:19], 0 offen sc0 sc1
    s_sub_u32 s56, s56, 1
    s_cbranch_scc1 L_h4_out
    v_min_u32_dpp v98, v96, v96 row_ror:8 row_mask:0xf bank_mask:0xf
    v_max_u32_dpp v96, v96, v96 row_ror:8 row_mask:0xf bank_mask:0xf
    v_max_u32_dpp v99, v97, v97 row_ror:8 row_mask:0xf bank_mask:0xf
    v_max_u32 v97, v98, v99
    v_min_u32_dpp v98, v96, v96 row_ror:4 row_mask:0xf bank_mask:0xf
    v_max_u32_dpp v96, v96, v96 row_ror:4 row_mask:0xf bank_mask:0xf
    v_max_u32_dpp v99, v97, v97 row_ror:4 row_mask:0xf bank_mask:0xf
    v_max_u32 v97, v98, v99
    v_min_u32_dpp v98, v96, v96 row_ror:2 row_mask:0xf bank_mask:0xf
    v_max_u32_dpp v96, v96, v96 row_ror:2 row_mask:0xf bank_mask:0xf
    v_max_u32_dpp v99, v97, v97 row_ror:2 row_mask:0xf bank_mask:0xf
    v_max_u32 v97, v98, v99
    v_min_u32_dpp v98, v96, v96 row_ror:1 row_mask:0xf bank_mask:0xf
    v_max_u32_dpp v96, v96, v96 row_ror:1 row_mask:0xf bank_mask:0xf
    v_max_u32_dpp v99, v97, v97 row_ror:1 row_mask:0xf bank_mask:0xf
    v_max_u32 v97, v98, v99
    v_readlane_b32 s70, v96, 0
    v_readlane_b32 s71, v97, 0
    s_nop 0
    s_cmp_eq_u64 s[70:71], s[60:61]
    s_cbranch_scc1 L_h4_w0
    s_mov_b64 s[60:61], s[70:71]
    s_bfe_u32 s86, s60, 0x40007
    s_bfe_u32 s87, s61, 0x40007
    s_sub_u32 s87, s86, s87
    s_lshl_b32 s87, s87, 12
    s_cselect_b32 s69, s87, 2048
    v_mad_i32_i24 v130, v8, s69, v10
    s_xor_b32 s86, s86, 15
    s_lshl_b32 s66, s86, 12
    buffer_load_dwordx4 v[64:67], v130, s[16:19], s66 offen sc1
    buffer_load_dwordx4 v[68:71], v130, s[16:19], s66 offen offset:16 sc1
    s_waitcnt vmcnt(2)
    s_branch L_h4_chk0
L_h4_own:
    s_waitcnt vmcnt(0)
    v_mov_b32 v128, 0
    v_mov_b32 v129, 0
    buffer_atomic_or_x2 v[128:129], v148, s[16:19], 0 offen sc0 sc1
    s_sub_u32 s56, s56, 1
    s_cbranch_scc0 L_h4_w0
L_h4_out:
    s_mov_b32 s56, 0
    s_waitcnt vmcnt(0)
    s_mov_b64 vcc, 0
L_h4_all0:
    v_writelane_b32 v128, s58, m0
    v_writelane_b32 v129, s59, m0
    s_nop 0
    v_min_u32_dpp v98, v128, v128 row_ror:8 row_mask:0xf bank_mask:0xf
    v_max_u32_dpp v96, v128, v128 row_ror:8 row_mask:0xf bank_mask:0xf
    v_max_u32_dpp v99, v129, v129 row_ror:8 row_mask:0xf bank_mask:0xf
    v_max_u32 v97, v98, v99
L_h4_all:
    v_min_u32_dpp v98, v96, v96 row_ror:4 row_mask:0xf bank_mask:0xf
    v_max_u32_dpp v96, v96, v96 row_ror:4 row_mask:0xf bank_mask:0xf
    v_max_u32_dpp v99, v97, v97 row_ror:4 row_mask:0xf bank_mask:0xf
    v_max_u32 v97, v98, v99
    v_min_u32_dpp v98, v96, v96 row_ror:2 row_mask:0xf bank_mask:0xf
    v_max_u32_dpp v96, v96, v96 row_ror:2 row_mask:0xf bank_mask:0xf
    v_max_u32_dpp v99, v97, v97 row_ror:2 row_mask:0xf bank_mask:0xf
    v_max_u32 v97, v98, v99
    v_min_u32_dpp v98, v96, v96 row_ror:1 row_mask:0xf bank_mask:0xf
    v_max_u32_dpp v96, v96, v96 row_ror:1 row_mask:0xf bank_mask:0xf
    v_max_u32_dpp v99, v97, v97 row_ror:1 row_mask:0xf bank_mask:0xf
    v_max_u32 v97, v98, v99
L_walk_22:
    s_cbranch_execz L_walked
    v_readlane_b32 s70, v96, 0
    v_readlane_b32 s71, v97, 0
    s_nop 0
    s_cmp_ge_u32 s58, s71
    s_cselect_b32 s86, vcc_lo, 0
    s_cmp_lg_u32 s86, 0
    s_cbranch_scc1 L_h4_own
    s_cmp_eq_u64 s[70:71], s[60:61]
    s_cbranch_scc1 L_h4_go
    s_mov_b64 s[60:61], s[70:71]
    s_bfe_u32 s86, s60, 0x40007
    s_bfe_u32 s87, s61, 0x40007
    s_sub_u32 s87, s86, s87
    s_lshl_b32 s87, s87, 12
    s_cselect_b32 s69, s87, 2048
    v_mad_i32_i24 v130, v8, s69, v10
    s_xor_b32 s86, s86, 15
    s_lshl_b32 s66, s86, 12
    buffer_load_dwordx4 v[64:67], v130, s[16:19], s66 offen sc1
    buffer_load_dwordx4 v[68:71], v130, s[16:19], s66 offen offset:16 sc1
L_h4_go:
    v_mov_b32 v16, 66304
    v_mov_b32 v24, s60
    v_mov_b32 v25, s61
    ds_write_b64 v16, v[24:25]
    s_waitcnt vmcnt(0)
    s_branch L_seg_chk
L_seg:
    buffer_load_dwordx4 v[64:67], v130, s[16:19], s66 offen sc1
    buffer_load_dwordx4 v[68:71], v130, s[16:19], s66 offen offset:16 sc1
    s_waitcnt vmcnt(0)
L_seg_chk:
    v_max3_u32 v16, v65, v67, v69
    v_max_u32 v16, v16, v71
    v_cmp_eq_u32 vcc, -1, v16
    s_cbranch_vccz L_ok_5
    s_sub_u32 s56, s56, 1
    s_cbranch_scc0 L_seg
    s_mov_b32 s56, 0
L_ok_5:
    v_perm_b32 v80, v64, v64, v72
    v_perm_b32 v81, v64, v64, v73
    v_perm_b32 v82, v64, v64, v74
    v_perm_b32 v83, v64, v64, v75
    v_perm_b32 v84, v64, v64, v76
    v_perm_b32 v85, v64, v64, v77
    v_perm_b32 v86, v64, v64, v78
    v_perm_b32 v87, v64, v64, v79
    v_mfma_f32_16x16x32_bf16 v[88:91], v[80:83], v[164:167], 0
    v_perm_b32 v92, v65, v65, v72
    v_perm_b32 v93, v65, v65, v73
    v_perm_b32 v94, v65, v65, v74
    v_perm_b32 v95, v65, v65, v75
    v_mfma_f32_16x16x32_bf16 v[88:91], v[84:87], v[168:171], v[88:91]
    v_perm_b32 v80, v65, v65, v76
    v_perm_b32 v81, v65, v65, v77
    v_perm_b32 v82, v65, v65, v78
    v_perm_b32 v83, v65, v65, v79
    v_mfma_f32_16x16x32_bf16 v[88:91], v[92:95], v[172:175], v[88:91]
    v_perm_b32 v84, v66, v66, v72
    v_perm_b32 v85, v66, v66, v73
    v_perm_b32 v86, v66, v66, v74
    v_perm_b32 v87, v66, v66, v75
    v_mfma_f32_16x16x32_bf16 v[88:91], v[80:83], v[176:179], v[88:91]
    v_perm_b32 v92, v66, v66, v76
    v_perm_b32 v93, v66, v66, v77
    v_perm_b32 v94, v66, v66, v78
    v_perm_b32 v95, v66, v66, v79
    v_mfma_f32_16x16x32_bf16 v[88:91], v[84:87], v[180:183], v[88:91]
    v_perm_b32 v80, v67, v67, v72
    v_perm_b32 v81, v67, v67, v73
    v_perm_b32 v82, v67, v67, v74
    v_perm_b32 v83, v67, v67, v75
    v_mfma_f32_16x16x32_bf16 v[88:91], v[92:95], v[184:187], v[88:91]
    v_perm_b32 v84, v67, v67, v76
    v_perm_b32 v85, v67, v67, v77
    v_perm_b32 v86, v67, v67, v78
    v_perm_b32 v87, v67, v67, v79
    v_mfma_f32_16x16x32_bf16 v[88:91], v[80:83], v[188:191], v[88:91]
    v_perm_b32 v92, v68, v68, v72
    v_perm_b32 v93, v68, v68, v73
    v_perm_b32 v94, v68, v68, v74
    v_perm_b32 v95, v68, v68, v75
    v_mfma_f32_16x16x32_bf16 v[88:91], v[84:87], v[192:195], v[88:91]
    v_perm_b32 v80, v68, v68, v76
    v_perm_b32 v81, v68, v68, v77
    v_perm_b32 v82, v68, v68, v78
    v_perm_b32 v83, v68, v68, v79
    v_mfma_f32_16x16x32_bf16 v[88:91], v[92:95], v[196:199], v[88:91]
    v_perm_b32 v84, v69, v69, v72
    v_perm_b32 v85, v69, v69, v73
    v_perm_b32 v86, v69, v69, v74
    v_perm_b32 v87, v69, v69, v75
    v_mfma_f32_16x16x32_bf16 v[88:91], v[80:83], v[200:203], v[88:91]
    v_perm_b32 v92, v69, v69, v76
    v_perm_b32 v93, v69, v69, v77
    v_perm_b32 v94, v69, v69, v78
    v_perm_b32 v95, v69, v69, v79
    v_mfma_f32_16x16x32_bf16 v[88:91], v[84:87], v[204:207], v[88:91]
    v_perm_b32 v80, v70, v70, v72
    v_perm_b32 v81, v70, v70, v73
    v_perm_b32 v82, v70, v70, v74
    v_perm_b32 v83, v70, v70, v75
    v_mfma_f32_16x16x32_bf16 v[88:91], v[92:95], v[208:211], v[88:91]
    v_perm_b32 v84, v70, v70, v76
    v_perm_b32 v85, v70, v70, v77
    v_perm_b32 v86, v70, v70, v78
    v_perm_b32 v87, v70, v70, v79
    v_mfma_f32_16x16x32_bf16 v[88:91], v[80:83], v[212:215], v[88:91]
    v_perm_b32 v92, v71, v71, v72
    v_perm_b32 v93, v71, v71, v73
    v_perm_b32 v94, v71, v71, v74
    v_perm_b32 v95, v71, v71, v75
    v_mfma_f32_16x16x32_bf16 v[88:91], v[84:87], v[216:219], v[88:91]
    v_perm_b32 v80, v71, v71, v76
    v_perm_b32 v81, v71, v71, v77
    v_perm_b32 v82, v71, v71, v78
    v_perm_b32 v83, v71, v71, v79
    v_mfma_f32_16x16x32_bf16 v[88:91], v[92:95], v[220:223], v[88:91]
    s_nop 0
    v_mfma_f32_16x16x32_bf16 v[88:91], v[80:83], v[224:227], v[88:91]
    s_nop 7
    ds_write_b128 v18, v[88:91]
    s_waitcnt lgkmcnt(0)
    s_barrier
    ds_read2st64_b32 v[24:25], v133 offset0:0 offset1:4
    ds_read2st64_b32 v[26:27], v133 offset0:8 offset1:12
    ds_read2st64_b32 v[28:29], v134 offset0:0 offset1:4
    ds_read2st64_b32 v[30:31], v134 offset0:8 offset1:12
    s_waitcnt lgkmcnt(2)
    v_pk_add_f32 v[24:25], v[24:25], v[26:27]
    v_add_f32 v24, v24, v25
    v_cndmask_b32 v24, v24, v135, s[4:5]
    buffer_atomic_add_f32 v24, v131, s[16:19], 0 offen sc1
    s_waitcnt lgkmcnt(0)
    v_pk_add_f32 v[28:29], v[28:29], v[30:31]
    v_add_f32 v28, v28, v29
    v_cndmask_b32 v28, v28, v136, s[4:5]
    buffer_atomic_add_f32 v28, v132, s[16:19], 0 offen sc1
    s_lshr_b32 s88, s48, 1
    s_cselect_b32 s86, s69, 0
    s_cselect_b32 s63, s61, s60
    s_and_b32 s87, s48, 1
    s_lshl1_add_u32 s87, s44, s87
    s_lshl_b32 s87, s87, 7
    s_add_u32 s86, s86, s66
    s_add_u32 s86, s86, s87
    s_add_u32 s86, s86, 6553600
    v_lshl_add_u32 v142, v0, 1, s86
    v_mov_b32 v140, 0
    v_mov_b32 v141, 0
    s_mov_b32 s65, 65536
    buffer_load_short_d16_hi v140, v142, s[16:19], 0 offen sc1
    buffer_load_short_d16_hi v141, v142, s[16:19], s65 offen sc1
    s_and_b32 s86, s63, 0x7ff
    s_sub_u32 s86, 2047, s86
    s_lshl_b32 s86, s86, 11
    s_add_u32 s86, s86, s87
    v_lshl_add_u32 v143, v0, 1, s86
    s_ashr_i32 s86, s63, 31
    s_orn2_b32 s86, 0x80000000, s86
    s_xor_b32 s63, s63, s86
L_walk_23:
    s_cbranch_execz L_walked
    s_and_b32 s63, s63, 0xffff0000
    s_lshr_b32 s86, s48, 1
    s_and_b32 s87, s48, 1
    s_lshl_b32 s88, s86, 9
    s_lshl_b32 s89, s87, 7
    s_add_u32 s88, s88, s89
    s_add_u32 s88, s88, 94208
    v_lshrrev_b32 v17, 3, v0
    v_lshl_add_u32 v20, v17, 4, s88
    v_bfe_u32 v9, v0, 2, 1
    v_lshl_add_u32 v20, v9, 8, v20
    v_and_b32 v9, 3, v0
    v_lshl_add_u32 v20, v9, 2, v20
    s_lshl3_add_u32 s86, s86, s44
    s_lshl1_add_u32 s86, s86, s87
    s_lshl_b32 s86, s86, 11
    s_add_u32 s86, s86, 917504
    v_lshl_add_u32 v9, v17, 8, s86
    v_and_b32 v17, 7, v0
    v_lshl_add_u32 v9, v17, 3, v9
    s_mov_b32 s76, 0
    s_mov_b32 s77, 0x41900000
    s_lshl_b32 s86, s48, 7
    s_add_u32 s86, s86, 100352
    v_lshl_add_u32 v11, v8, 6, s86
    v_lshl_add_u32 v11, v1, 4, v11
    v_and_b32 v16, 7, v0
    v_lshl_or_b32 v16, v16, 1, v8
    v_cmp_le_u32 vcc, 7, v16
    v_add_u32 v17, 1, v16
    s_nop 0
    v_cndmask_b32 v16, v16, v17, vcc
    v_min_u32 v16, 15, v16
    v_lshrrev_b32 v17, 5, v0
    v_lshl_add_u32 v16, v17, 4, v16
    v_bfe_u32 v17, v0, 4, 1
    v_lshl_add_u32 v16, v17, 5, v16
    v_lshl_add_u32 v10, v16, 1, s86
    v_cmp_eq_u32 vcc, 1, v8
    v_mov_b32 v16, 0x01000c0c
    v_mov_b32 v17, 0x07060c0c
    v_cndmask_b32 v21, v16, v17, vcc
    v_mov_b32 v16, 0x05040c0c
    v_mov_b32 v17, 0x03020c0c
    v_cndmask_b32 v22, v16, v17, vcc
    v_mov_b32 v144, s63
    v_mul_f32 v144, 0xbfb8aa3b, v144
    v_exp_f32 v144, v144
    s_nop 0
    v_add_f32 v144, 1.0, v144
    v_rcp_f32 v144, v144
    s_nop 0
    v_cvt_pk_bf16_f32 v144, v144, v144
    v_lshlrev_b32 v144, 16, v144
    s_mov_b32 s6, 0x80808080
    s_mov_b32 s7, 0x80808080
    v_mov_b32 v19, v9
    buffer_atomic_or_x2 v[138:139], v137, s[16:19], 0 offen sc0 sc1
    s_barrier
    s_waitcnt vmcnt(0)
    s_branch L_h5_chk
L_h5:
    s_lshr_b64 s[4:5], vcc, 7
    s_sub_u32 s4, vcc_lo, s4
    s_sub_u32 s5, vcc_hi, s5
    s_or_b64 exec, s[4:5], vcc
    v_mov_b32 v138, 0
    v_mov_b32 v139, 0
    buffer_atomic_or_x2 v[138:139], v137, s[16:19], 0 offen sc0 sc1
    s_mov_b64 exec, -1
    s_waitcnt vmcnt(0)
L_h5_chk:
    v_cmp_neq_f32 vcc, 0x42600000, v138
    v_cvt_pk_bf16_f32 v25, v138, v139
    s_and_b64 vcc, vcc, s[6:7]
    s_cbranch_vccz L_ok_6
    s_sub_u32 s56, s56, 1
    s_cbranch_scc0 L_h5
    s_mov_b32 s56, 0
L_ok_6:
    v_mov_b32_dpp v26, v25 row_ror:8 row_mask:0xf bank_mask:0xf
    v_perm_b32 v24, v26, v25, v21
    v_perm_b32 v28, v26, v25, v22
    v_mul_f32 v25, 0xbfb8aa3b, v24
    v_exp_f32 v25, v25
    s_nop 0
    v_add_f32 v25, 1.0, v25
    v_rcp_f32 v25, v25
    s_nop 0
    v_mul_f32 v24, v24, v25
    v_cvt_pk_bf16_f32 v24, v24, v24
    v_lshlrev_b32 v24, 16, v24
    v_mul_f32 v24, v24, v28
    v_cvt_pk_bf16_f32 v24, v24, v24
    ds_write_b16 v10, v24
    s_waitcnt lgkmcnt(0)
    ds_read_b128 v[64:67], v11
    s_waitcnt lgkmcnt(0)
    v_perm_b32 v80, v64, v64, v72
    v_perm_b32 v81, v64, v64, v73
    v_perm_b32 v82, v64, v64, v74
    v_perm_b32 v83, v64, v64, v75
    v_perm_b32 v84, v64, v64, v76
    v_perm_b32 v85, v64, v64, v77
    v_perm_b32 v86, v64, v64, v78
    v_perm_b32 v87, v64, v64, v79
    v_mfma_f32_16x16x32_bf16 v[88:91], v[80:83], v[228:231], 0
    v_perm_b32 v92, v65, v65, v72
    v_perm_b32 v93, v65, v65, v73
    v_perm_b32 v94, v65, v65, v74
    v_perm_b32 v95, v65, v65, v75
    v_mfma_f32_16x16x32_bf16 v[88:91], v[84:87], v[232:235], v[88:91]
    v_perm_b32 v80, v65, v65, v76
    v_perm_b32 v81, v65, v65, v77
    v_perm_b32 v82, v65, v65, v78
    v_perm_b32 v83, v65, v65, v79
    v_mfma_f32_16x16x32_bf16 v[88:91], v[92:95], v[236:239], v[88:91]
    v_perm_b32 v84, v66, v66, v72
    v_perm_b32 v85, v66, v66, v73
    v_perm_b32 v86, v66, v66, v74
    v_perm_b32 v87, v66, v66, v75
    v_mfma_f32_16x16x32_bf16 v[88:91], v[80:83], v[240:243], v[88:91]
    v_perm_b32 v92, v66, v66, v76
    v_perm_b32 v93, v66, v66, v77
    v_perm_b32 v94, v66, v66, v78
    v_perm_b32 v95, v66, v66, v79
    v_mfma_f32_16x16x32_bf16 v[88:91], v[84:87], v[244:247], v[88:91]
    v_perm_b32 v80, v67, v67, v72
    v_perm_b32 v81, v67, v67, v73
    v_perm_b32 v82, v67, v67, v74
    v_perm_b32 v83, v67, v67, v75
    v_mfma_f32_16x16x32_bf16 v[88:91], v[92:95], v[248:251], v[88:91]
    s_nop 0
    v_mfma_f32_16x16x32_bf16 v[88:91], v[80:83], v[252:255], v[88:91]
    s_nop 7
    ds_write_b128 v18, v[88:91] offset:4096
    s_waitcnt lgkmcnt(0)
    s_barrier
    ds_read2st64_b32 v[24:25], v20 offset0:0 offset1:4
    ds_read2st64_b32 v[26:27], v20 offset0:8 offset1:12
    s_waitcnt lgkmcnt(0)
    v_pk_add_f32 v[24:25], v[24:25], v[26:27]
    v_add_f32 v24, v24, v25
    v_cvt_f64_f32 v[26:27], v24
    v_add_f64 v[24:25], v[26:27], s[76:77]
    buffer_atomic_add_f64 v[24:25], v19, s[16:19], 0 offen sc0 sc1
    s_mov_b32 s77, 0xc1df0000
    v_add_f64 v[26:27], v[26:27], s[76:77]
    s_waitcnt vmcnt(1)
    v_max_u32 v16, v140, v141
    v_cmp_eq_u32 vcc, 0xffff0000, v16
    s_cbranch_vccnz L_fin_ld
L_fin_go:
    s_mov_b32 s88, 0x4c000000
    v_mov_b32 v17, 2147483648
    s_waitcnt vmcnt(0)
    v_add_f64 v[24:25], v[24:25], v[26:27]
    v_cvt_f32_f64 v24, v[24:25]
    v_cmp_lt_f32 vcc, |v24|, s88
    v_cvt_pk_bf16_f32 v24, v24, v24
    v_lshlrev_b32 v24, 16, v24
    v_mul_f32 v24, v24, v144
    v_cndmask_b32 v17, v17, v143, vcc
    v_cvt_pk_bf16_f32 v24, v24, v24
    v_lshlrev_b32 v24, 16, v24
    v_add_f32 v24, v24, v141
    v_cvt_pk_bf16_f32 v24, v24, v24
    v_lshlrev_b32 v24, 16, v24
    v_add_f32 v24, v24, v140
    v_cvt_pk_bf16_f32 v24, v24, v24
    buffer_store_short v24, v17, s[24:27], 0 offen
L_fin:
L_end:
    s_endpgm
L_b_restart:
    s_waitcnt vmcnt(0)
    v_xor_b32 v9, 0x8000, v7
    buffer_load_dwordx4 v[136:139], v7, s[8:11], 0 offen
    buffer_load_dwordx4 v[140:143], v9, s[8:11], 0 offen
    v_mov_b32 v8, s68
    s_mov_b32 s66, 0xffffaaaa
    s_mov_b32 s63, 1
    s_branch L_b_init
L_walk_24:
    s_cbranch_execz L_walked
L_b_g4:
    s_lshr_b32 s86, s78, 2
    buffer_load_dwordx4 v[48:51], v157, s[16:19], s86 offen offset:0 sc1
    buffer_load_dwordx4 v[52:55], v158, s[16:19], s86 offen offset:0 sc1
    s_waitcnt vmcnt(0)
    s_sub_u32 s56, s56, 1
    s_cbranch_scc0 L_b_c4
    s_mov_b32 s56, 0
    s_branch L_b_d4
L_b_g5:
    s_lshr_b32 s86, s78, 2
    buffer_load_dwordx4 v[56:59], v157, s[16:19], s86 offen offset:1024 sc1
    buffer_load_dwordx4 v[60:63], v158, s[16:19], s86 offen offset:1024 sc1
    s_waitcnt vmcnt(0)
    s_sub_u32 s56, s56, 1
    s_cbranch_scc0 L_b_c5
    s_mov_b32 s56, 0
    s_branch L_b_d5
L_b_g6:
    s_lshr_b32 s86, s79, 2
    buffer_load_dwordx4 v[64:67], v157, s[16:19], s86 offen offset:0 sc1
    buffer_load_dwordx4 v[68:71], v158, s[16:19], s86 offen offset:0 sc1
    s_waitcnt vmcnt(0)
    s_sub_u32 s56, s56, 1
    s_cbranch_scc0 L_b_c6
    s_mov_b32 s56, 0
    s_branch L_b_d6
L_b_g7:
    s_lshr_b32 s86, s79, 2
    buffer_load_dwordx4 v[72:75], v157, s[16:19], s86 offen offset:1024 sc1
    buffer_load_dwordx4 v[76:79], v158, s[16:19], s86 offen offset:1024 sc1
    s_waitcnt vmcnt(0)
    s_sub_u32 s56, s56, 1
    s_cbranch_scc0 L_b_c7
    s_mov_b32 s56, 0
    s_branch L_b_d7
L_b_g8:
    s_lshr_b32 s86, s76, 2
    buffer_load_dwordx4 v[16:19], v157, s[16:19], s86 offen offset:0 sc1
    buffer_load_dwordx4 v[20:23], v158, s[16:19], s86 offen offset:0 sc1
    s_waitcnt vmcnt(0)
    s_sub_u32 s56, s56, 1
    s_cbranch_scc0 L_b_c8
    s_mov_b32 s56, 0
    s_branch L_b_d8
L_b_g9:
    s_lshr_b32 s86, s76, 2
    buffer_load_dwordx4 v[24:27], v157, s[16:19], s86 offen offset:1024 sc1
    buffer_load_dwordx4 v[28:31], v158, s[16:19], s86 offen offset:1024 sc1
    s_waitcnt vmcnt(0)
    s_sub_u32 s56, s56, 1
    s_cbranch_scc0 L_b_c9
    s_mov_b32 s56, 0
    s_branch L_b_d9
L_b_g10:
    s_lshr_b32 s86, s77, 2
    buffer_load_dwordx4 v[32:35], v157, s[16:19], s86 offen offset:0 sc1
    buffer_load_dwordx4 v[36:39], v158, s[16:19], s86 offen offset:0 sc1
    s_waitcnt vmcnt(0)
    s_sub_u32 s56, s56, 1
    s_cbranch_scc0 L_b_c10
    s_mov_b32 s56, 0
    s_branch L_b_d10
L_b_g11:
    s_lshr_b32 s86, s77, 2
    buffer_load_dwordx4 v[40:43], v157, s[16:19], s86 offen offset:1024 sc1
    buffer_load_dwordx4 v[44:47], v158, s[16:19], s86 offen offset:1024 sc1
    s_waitcnt vmcnt(0)
    s_sub_u32 s56, s56, 1
    s_cbranch_scc0 L_b_c11
    s_mov_b32 s56, 0
    s_branch L_b_d11
L_b_g12:
    s_lshr_b32 s86, s78, 2
    buffer_load_dwordx4 v[48:51], v157, s[16:19], s86 offen offset:0 sc1
    buffer_load_dwordx4 v[52:55], v158, s[16:19], s86 offen offset:0 sc1
    s_waitcnt vmcnt(0)
    s_sub_u32 s56, s56, 1
    s_cbranch_scc0 L_b_c12
    s_mov_b32 s56, 0
    s_branch L_b_d12
L_b_g13:
    s_lshr_b32 s86, s78, 2
    buffer_load_dwordx4 v[56:59], v157, s[16:19], s86 offen offset:1024 sc1
    buffer_load_dwordx4 v[60:63], v158, s[16:19], s86 offen offset:1024 sc1
    s_waitcnt vmcnt(0)
    s_sub_u32 s56, s56, 1
    s_cbranch_scc0 L_b_c13
    s_mov_b32 s56, 0
    s_branch L_b_d13
L_b_g14:
    s_lshr_b32 s86, s79, 2
    buffer_load_dwordx4 v[64:67], v157, s[16:19], s86 offen offset:0 sc1
    buffer_load_dwordx4 v[68:71], v158, s[16:19], s86 offen offset:0 sc1
    s_waitcnt vmcnt(0)
    s_sub_u32 s56, s56, 1
    s_cbranch_scc0 L_b_c14
    s_mov_b32 s56, 0
    s_branch L_b_d14
L_b_g15:
    s_lshr_b32 s86, s79, 2
    buffer_load_dwordx4 v[72:75], v157, s[16:19], s86 offen offset:1024 sc1
    buffer_load_dwordx4 v[76:79], v158, s[16:19], s86 offen offset:1024 sc1
    s_waitcnt vmcnt(0)
    s_sub_u32 s56, s56, 1
    s_cbranch_scc0 L_b_c15
    s_mov_b32 s56, 0
    s_branch L_b_d15
L_b_p0:
    v_mov_b32 v8, 0
    buffer_atomic_or v8, v159, s[16:19], 0 offen sc0 sc1
L_b_w0:
    s_waitcnt vmcnt(0)
    v_cmp_eq_u32 vcc, s68, v8
    s_nop 0
    s_lshr_b32 s65, vcc_lo, 1
    s_and_b32 s65, s65, vcc_lo
    s_andn2_b32 s65, s65, s66
    s_cbranch_scc0 L_b_q0
    s_or_b32 s66, s66, s65
    s_branch L_b_r0
L_b_q0:
    s_sub_u32 s56, s56, 1
    s_cbranch_scc0 L_b_p0
    s_mov_b32 s56, 0
    s_not_b32 s65, s66
    s_branch L_b_r0
L_b_p1:
    v_mov_b32 v8, 0
    buffer_atomic_or v8, v159, s[16:19], 0 offen sc0 sc1
    s_waitcnt vmcnt(0)
    v_cmp_eq_u32 vcc, s68, v8
    s_nop 0
    s_lshr_b32 s65, vcc_lo, 1
    s_and_b32 s65, s65, vcc_lo
    s_andn2_b32 s65, s65, s66
    s_cbranch_scc0 L_b_q1
    s_or_b32 s66, s66, s65
    s_branch L_b_r1
L_b_q1:
    s_sub_u32 s56, s56, 1
    s_cbranch_scc0 L_b_p1
    s_mov_b32 s56, 0
    s_not_b32 s65, s66
    s_branch L_b_r1
L_fin_ld:
    buffer_load_short_d16_hi v140, v142, s[16:19], 0 offen sc1
    buffer_load_short_d16_hi v141, v142, s[16:19], s65 offen sc1
    s_waitcnt vmcnt(0)
    v_max_u32 v16, v140, v141
    v_cmp_eq_u32 vcc, 0xffff0000, v16
    s_cbranch_vccz L_fin_go
    s_sub_u32 s56, s56, 1
    s_cbranch_scc0 L_fin_ld
    s_branch L_fin_go
L_last:
    s_endpgm
.section .rodata,"a"
.p2align 6
.amdhsa_kernel sequential_preLN__linear_attn_block__moe_arch_mod__prompt_kernel
  .amdhsa_next_free_vgpr 256
  .amdhsa_next_free_sgpr 102
  .amdhsa_accum_offset 256
  .amdhsa_group_segment_fixed_size 0
  .amdhsa_kernarg_size 88
  .amdhsa_user_sgpr_count 2
  .amdhsa_user_sgpr_kernarg_segment_ptr 1
  .amdhsa_system_sgpr_workgroup_id_x 1
.end_amdhsa_kernel
```

```asm
; @launch grid=(256,1,1) block=(512,1,1) lds=163840
.amdgcn_target "amdgcn-amd-amdhsa--gfx950"
.text
.globl sequential_preLN__linear_attn_block__moe_arch_mod__prompt_kernel
.p2align 8
.type sequential_preLN__linear_attn_block__moe_arch_mod__prompt_kernel,@function
sequential_preLN__linear_attn_block__moe_arch_mod__prompt_kernel:
    s_cmp_ge_u32 s2, 256
    s_cbranch_scc1 L_end
    s_load_dwordx16 s[64:79], s[0:1], 0
    s_load_dwordx4 s[80:83], s[0:1], 64
    s_load_dwordx2 s[84:85], s[0:1], 80
    v_lshrrev_b32 v1, 6, v0
    v_and_b32 v0, 63, v0
    v_readfirstlane_b32 s3, v1
    s_and_b32 s44, s2, 7
    s_lshr_b32 s45, s2, 3
    s_and_b32 s46, s44, 1
    s_lshl_b32 s46, s46, 3
    s_and_b32 s86, s45, 7
    s_add_u32 s46, s46, s86
    s_lshr_b32 s47, s44, 1
    s_lshl_b32 s47, s47, 2
    s_lshr_b32 s86, s45, 3
    s_add_u32 s47, s47, s86
    s_mov_b32 s51, s47
    s_mov_b32 s52, s46
    s_and_b32 s48, s3, 3
    s_and_b32 s49, s3, 1
    s_bfe_u32 s50, s3, 0x10001
    s_mov_b32 s56, 65536
    s_mov_b32 s95, 0x3f803f80
    s_movk_i32 s92, 0x1000
    s_movk_i32 s93, 0x2000
    s_movk_i32 s94, 0x3000
    s_cmp_lt_u32 s3, 4
    s_cbranch_scc1 L_comp0
    v_lshrrev_b32 v20, 3, v0
    v_and_b32 v21, 7, v0
    v_lshrrev_b32 v22, 4, v0
    v_xor_b32 v23, v21, v22
    v_xor_b32 v24, 4, v23
    s_lshl_b32 s86, s48, 5
    v_add_u32 v25, s86, v20
    v_lshlrev_b32 v25, 11, v25
    v_lshl_add_u32 v2, v23, 4, v25
    v_lshl_add_u32 v3, v24, 4, v25
    v_add_u32 v3, 15360, v3
    v_lshl_add_u32 v4, v23, 4, v25
    v_add_u32 v4, 30720, v4
    v_lshl_add_u32 v5, v24, 4, v25
    v_add_u32 v5, 46080, v5
    s_lshl_b32 s86, s48, 4
    v_add_u32 v25, s86, v20
    v_mul_u32_u24 v25, 6144, v25
    s_lshl_b32 s86, s47, 7
    v_add_u32 v25, s86, v25
    v_bfe_u32 v26, v0, 4, 1
    v_lshlrev_b32 v26, 1, v26
    v_xor_b32 v26, v26, v21
    v_xor_b32 v27, 4, v26
    v_lshl_add_u32 v6, v26, 4, v25
    v_lshl_add_u32 v7, v27, 4, v25
    v_add_u32 v7, 48128, v7
    v_lshl_add_u32 v8, v26, 4, v25
    v_add_u32 v8, 2048, v8
    v_lshl_add_u32 v9, v27, 4, v25
    v_add_u32 v9, 50176, v9
    v_lshl_add_u32 v10, v26, 4, v25
    v_add_u32 v10, 4096, v10
    v_lshl_add_u32 v11, v27, 4, v25
    v_add_u32 v11, 52224, v11
    s_lshl_b32 s63, s46, 18
    s_lshl_b32 s53, s48, 12
    s_lshl_b32 s62, s48, 11
    s_add_u32 s62, s62, 16384
    s_setprio 1
    s_lshl_b32 s86, s45, 2
    s_add_u32 s86, s86, s48
    s_mul_i32 s87, s86, 12288
    s_and_b32 s88, s47, 12
    s_lshl_b32 s88, s88, 7
    s_add_u32 s87, s87, s88
    s_add_u32 s87, s87, 384
    s_bitcmp1_b32 s47, 2
    s_cselect_b32 s87, 2147483648, s87
    v_lshl_add_u32 v37, v0, 11, s87
    v_mov_b32 v24, 2147483648
    v_cmp_gt_u32 vcc, 6, v0
    s_nop 1
    v_cndmask_b32 v37, v24, v37, vcc
    s_lshl_b32 s86, s86, 14
    s_and_b32 s88, s52, 8
    s_lshl_b32 s88, s88, 7
    s_add_u32 s86, s86, s88
    s_add_u32 s86, s86, 384
    v_lshl_add_u32 v38, v0, 11, s86
    v_cmp_gt_u32 vcc, 8, v0
    s_nop 1
    v_cndmask_b32 v38, v24, v38, vcc
    s_waitcnt lgkmcnt(0)
    s_mov_b32 s8, s64
    s_and_b32 s9, s65, 0xffff
    s_mov_b32 s10, 4194304
    s_mov_b32 s11, 0x20000
    s_mov_b32 s12, s66
    s_and_b32 s13, s67, 0xffff
    s_mov_b32 s14, 6291456
    s_mov_b32 s15, 0x20000
    s_and_b32 s86, s47, 12
    s_and_b32 s87, s46, 8
    s_add_u32 s64, s86, s87
    s_and_b32 s64, s64, 15
    s_mov_b32 s67, s64
    s_load_dword s61, s[84:85], 524288
    s_lshr_b32 s90, s67, 2
    s_mul_i32 s90, s90, 1572864
    buffer_load_dword v39, v37, s[12:15], s90 offen
    s_add_u32 m0, s53, 40960
    s_lshl_b32 s70, s64, 7
    s_add_u32 s70, s70, s63
    buffer_load_dwordx4 v2, s[8:11], s70 offen offset:0 lds
    buffer_load_dwordx4 v3, s[8:11], s70 offen offset:1024 lds
    buffer_load_dwordx4 v4, s[8:11], s70 offen offset:2048 lds
    buffer_load_dwordx4 v5, s[8:11], s70 offen offset:3072 lds
    s_mul_i32 s91, s64, 393216
    s_add_u32 s64, s64, 1
    s_and_b32 s64, s64, 15
    s_add_u32 m0, s62, 40960
    s_nop 0
    buffer_load_dwordx4 v6, s[12:15], s91 offen offset:0 lds
    buffer_load_dwordx4 v7, s[12:15], s91 offen offset:1024 lds
    s_add_u32 m0, s62, 49152
    s_nop 0
    buffer_load_dwordx4 v8, s[12:15], s91 offen offset:0 lds
    buffer_load_dwordx4 v9, s[12:15], s91 offen offset:1024 lds
    s_add_u32 m0, s62, 57344
    s_nop 0
    buffer_load_dwordx4 v10, s[12:15], s91 offen offset:0 lds
    buffer_load_dwordx4 v11, s[12:15], s91 offen offset:1024 lds
    s_branch L_ld1
L_comp0:
    s_lshl2_add_u32 s86, s45, s3
    s_cmp_ge_u32 s86, 4
    s_cbranch_scc1 L_noipf
    s_getpc_b64 s[4:5]
L_ipf:
    s_sub_u32 s4, s4, L_ipf-sequential_preLN__linear_attn_block__moe_arch_mod__prompt_kernel
    s_subb_u32 s5, s5, 0
    s_lshl_b32 s86, s86, 13
    v_lshl_add_u32 v31, v0, 7, s86
    v_min_u32 v31, L_last-sequential_preLN__linear_attn_block__moe_arch_mod__prompt_kernel, v31
    global_load_dword v30, v31, s[4:5]
L_noipf:
    s_cmp_eq_u32 s3, 3
    s_cbranch_scc1 L_comp
    s_mov_b64 exec, 0
    s_cmp_eq_u32 s3, 2
    s_cbranch_scc1 L_walkA2
    s_cmp_eq_u32 s3, 1
    s_cbranch_scc1 L_walkA1
    s_branch L_walkA0
L_ld1:
    s_mov_b32 s16, s84
    s_and_b32 s17, s85, 0xffff
    s_mov_b32 s18, 268435456
    s_mov_b32 s19, 0x20000
    s_mov_b32 s20, s68
    s_and_b32 s21, s69, 0xffff
    s_mov_b32 s22, 2097152
    s_mov_b32 s23, 0x20000
    s_mov_b32 s24, s80
    s_and_b32 s25, s81, 0xffff
    s_mov_b32 s26, 4194304
    s_mov_b32 s27, 0x20000
    s_mov_b32 s28, s82
    s_and_b32 s29, s83, 0xffff
    s_mov_b32 s30, 256
    s_mov_b32 s31, 0x20000
    s_bitcmp1_b32 s2, 3
    s_cselect_b32 s32, s76, s74
    s_cselect_b32 s33, s77, s75
    s_and_b32 s33, s33, 0xffff
    s_mov_b32 s34, 7340032
    s_mov_b32 s35, 0x20000
    s_mov_b32 s36, s78
    s_and_b32 s37, s79, 0xffff
    s_mov_b32 s38, 7340032
    s_mov_b32 s39, 0x20000
    s_mov_b32 s40, s72
    s_and_b32 s41, s73, 0xffff
    s_mov_b32 s42, 2048
    s_mov_b32 s43, 0x20000
    s_lshl_b32 s82, s44, 5
    s_or_b32 s82, s82, s45
    v_lshrrev_b32 v22, 4, v0
    v_and_b32 v23, 15, v0
    s_lshl_b32 s86, s45, 2
    s_add_u32 s86, s86, s48
L_walkA0:
    s_cbranch_execz L_comp
    s_mul_i32 s87, s86, 6
    v_mul_u32_u24 v24, 43, v0
    v_lshrrev_b32 v24, 8, v24
    v_mul_u32_u24 v25, 6, v24
    v_sub_u32 v25, v0, v25
    v_add_u32 v25, s87, v25
    s_add_u32 s87, s67, 2
    v_add_u32 v24, s87, v24
    v_and_b32 v24, 15, v24
    v_mul_u32_u24 v124, 393216, v24
    v_lshrrev_b32 v24, 2, v25
    v_lshl_add_u32 v124, v24, 11, v124
    v_and_b32 v25, 3, v25
    s_and_b32 s88, s47, 12
    v_add_u32 v25, s88, v25
    v_lshl_add_u32 v124, v25, 7, v124
    v_mov_b32 v24, 2147483648
    v_cmp_gt_u32 vcc, 36, v0
    s_nop 1
    v_cndmask_b32 v124, v24, v124, vcc
    v_add_u32 v24, s87, v20
    v_and_b32 v24, 15, v24
    s_and_b32 s88, s46, 8
    s_lshl4_add_u32 s86, s88, s86
    s_lshl_b32 s86, s86, 14
    v_lshl_add_u32 v123, v21, 11, s86
    v_mov_b32 v125, v123
    v_lshl_add_u32 v123, v24, 7, v123
    v_mov_b32 v24, 2147483648
    v_cmp_gt_u32 vcc, 16, v0
    s_nop 1
    v_cndmask_b32 v123, v24, v123, vcc
    s_add_u32 m0, s53, 81920
    s_lshl_b32 s70, s64, 7
    s_add_u32 s70, s70, s63
    buffer_load_dwordx4 v2, s[8:11], s70 offen offset:0 lds
    buffer_load_dwordx4 v3, s[8:11], s70 offen offset:1024 lds
    buffer_load_dwordx4 v4, s[8:11], s70 offen offset:2048 lds
    buffer_load_dwordx4 v5, s[8:11], s70 offen offset:3072 lds
    s_mul_i32 s91, s64, 393216
    s_add_u32 s64, s64, 1
    s_and_b32 s64, s64, 15
    s_add_u32 m0, s62, 81920
    s_nop 0
    buffer_load_dwordx4 v6, s[12:15], s91 offen offset:0 lds
    buffer_load_dwordx4 v7, s[12:15], s91 offen offset:1024 lds
    s_add_u32 m0, s62, 90112
    s_nop 0
    buffer_load_dwordx4 v8, s[12:15], s91 offen offset:0 lds
    buffer_load_dwordx4 v9, s[12:15], s91 offen offset:1024 lds
    s_add_u32 m0, s62, 98304
    s_nop 0
    buffer_load_dwordx4 v10, s[12:15], s91 offen offset:0 lds
    buffer_load_dwordx4 v11, s[12:15], s91 offen offset:1024 lds
    buffer_load_dword v122, v123, s[8:11], 0 offen
    buffer_load_dword v122, v124, s[12:15], 0 offen
    s_and_b32 s65, s45, 7
    s_lshr_b32 s66, s45, 3
    s_add_u32 s86, s65, 1
    s_and_b32 s86, s86, 3
    s_mul_i32 s86, s86, 40960
    s_lshl_b32 s87, s48, 13
    s_cmp_eq_u32 s48, 3
    s_cselect_b32 s87, 0, s87
    s_add_u32 s86, s86, s87
    s_add_u32 s86, s86, 16384
    v_lshl_add_u32 v25, v20, 7, s86
    v_lshl_add_u32 v28, v26, 4, v25
    v_lshl_add_u32 v29, v27, 4, v25
    s_add_u32 s86, s66, 1
    s_and_b32 s86, s86, 3
    s_mul_i32 s86, s86, 40960
    s_add_u32 s86, s86, s53
    v_lshl_add_u32 v16, v0, 6, s86
    v_bfe_u32 v25, v0, 2, 2
    v_lshl_add_u32 v16, v25, 4, v16
    v_xor_b32 v17, 16, v16
    v_xor_b32 v18, 32, v16
    v_xor_b32 v19, 48, v16
    s_lshl_b32 s86, s46, 14
    s_lshl_b32 s87, s48, 8
    s_add_u32 s86, s86, s87
    s_add_u32 s86, s86, 262144
    v_lshl_add_u32 v33, v23, 4, s86
    v_lshl_add_u32 v33, v22, 10, v33
    s_lshl_b32 s87, s47, 10
    s_add_u32 s86, s86, s87
    v_lshl_add_u32 v13, v0, 2, s86
    v_and_b32 v25, 3, v0
    v_cmp_eq_u32 vcc, 0, v25
    v_mov_b32 v24, 2147483648
    s_nop 0
    v_cndmask_b32 v13, v24, v13, vcc
    s_mul_i32 s86, s47, 12288
    s_add_u32 s86, s86, 65536
    s_lshl_b32 s87, s48, 8
    s_cmp_eq_u32 s48, 3
    s_cselect_b32 s87, 2147483648, s87
    s_mov_b32 s88, 0
    s_add_u32 s86, s86, s87
    v_lshl_add_u32 v32, v23, 4, s86
    v_mul_u32_u24 v25, 768, v22
    v_add_u32 v32, v32, v25
    s_mul_i32 s87, s46, 768
    s_add_u32 s86, s86, s87
    s_add_u32 s86, s86, s88
    v_lshl_add_u32 v34, v23, 5, s86
    v_lshl_add_u32 v34, v22, 4, v34
    v_and_b32 v25, 0x28, v0
    v_cmp_eq_u32 vcc, 0, v25
    s_nop 1
    v_cndmask_b32 v34, v24, v34, vcc
    s_bfe_u32 s86, s82, 0x20001
    s_lshl_b32 s86, s86, 2
    s_add_u32 s86, s86, s48
    s_lshl_b32 s86, s86, 6
    v_lshl_add_u32 v30, v22, 4, s86
    v_mul_u32_u24 v30, 7168, v30
    s_add_u32 s86, s44, 3
    s_and_b32 s86, s86, 7
    s_min_u32 s86, s86, 6
    s_mul_i32 s87, s44, 7
    s_lshr_b32 s88, s45, 3
    s_lshl_b32 s88, s88, 1
    s_sub_u32 s80, s88, 2
    s_cmp_ge_u32 s80, s86
    s_addc_u32 s80, s80, s87
    s_sub_u32 s81, s88, 1
    s_cmp_ge_u32 s81, s86
    s_addc_u32 s81, s81, s87
    s_add_u32 s86, s86, s87
    s_cmp_lt_u32 s45, 8
    s_cselect_b32 s80, s86, s80
    s_cselect_b32 s81, 56, s81
    v_mov_b32 v24, s80
    v_mov_b32 v25, s81
    s_mov_b32 vcc_lo, 4278255360
    s_mov_b32 vcc_hi, vcc_lo
    v_cndmask_b32 v24, v24, v25, vcc
    v_cmp_gt_u32 vcc, 56, v24
    v_and_b32 v25, 7, v0
    v_lshlrev_b32 v24, 7, v24
    v_lshl_add_u32 v24, v25, 4, v24
    v_add_u32 v30, v30, v24
    v_mov_b32 v24, 2147483648
    v_cndmask_b32 v30, v24, v30, vcc
    s_lshr_b32 s86, s82, 3
    s_mul_i32 s86, s86, 112
    s_mul_i32 s87, s48, 28
    s_add_u32 s86, s86, s87
    v_mul_u32_u24 v31, 7, v22
    v_add_u32 v31, s86, v31
    v_lshlrev_b32 v31, 11, v31
    s_and_b32 s86, s82, 7
    s_lshl_b32 s86, s86, 8
    v_lshl_add_u32 v24, v23, 4, s86
    v_add_u32 v31, v31, v24
    v_lshlrev_b32 v24, 1, v22
    v_xor_b32 v24, v24, v21
    s_lshl_b32 s86, s48, 3
    v_add_u32 v12, s86, v20
    v_lshlrev_b32 v12, 11, v12
    s_lshl_b32 s86, s52, 7
    v_lshl_add_u32 v24, v24, 4, s86
    v_add_u32 v12, v12, v24
    s_lshl_b32 s89, s48, 10
    v_and_b32 v24, 1, v0
    v_lshlrev_b32 v24, 4, v24
    v_mov_b32 v25, 0x3f80
    v_lshlrev_b32 v24, v24, v25
    v_bfe_u32 v25, v0, 1, 2
    v_cmp_eq_u32 vcc, 0, v25
    s_nop 1
    v_cndmask_b32 v104, 0, v24, vcc
    v_cmp_eq_u32 vcc, 1, v25
    s_nop 1
    v_cndmask_b32 v105, 0, v24, vcc
    v_cmp_eq_u32 vcc, 2, v25
    s_nop 1
    v_cndmask_b32 v106, 0, v24, vcc
    v_cmp_eq_u32 vcc, 3, v25
    s_nop 1
    v_cndmask_b32 v107, 0, v24, vcc
    s_waitcnt lgkmcnt(0)
    s_add_u32 s68, s61, 0x9e3779b9
    v_mov_b32 v35, s68
    s_lshl_b32 s86, s46, 2
    s_add_u32 s86, s86, s48
    s_lshl_b32 s86, s86, 7
    s_add_u32 s86, s86, 655360
    s_lshl_b32 s87, s47, 2
    s_add_u32 s87, s87, s48
    s_lshl_b32 s87, s87, 7
    s_add_u32 s87, s87, 663552
    s_cmp_eq_u32 s48, 3
    s_cselect_b32 s87, 2147483648, s87
    s_cselect_b32 s76, 0xffff, -1
    s_mov_b32 s77, 0
    v_mov_b32 v24, s86
    v_mov_b32 v25, s87
    v_cmp_gt_u32 vcc, 16, v0
    s_nop 1
    v_cndmask_b32 v117, v25, v24, vcc
    v_lshl_add_u32 v117, v23, 2, v117
    v_mov_b32 v116, 2147483648
    v_cmp_gt_u32 vcc, 32, v0
    s_nop 1
L_walkA1:
    s_cbranch_execz L_comp
    v_cndmask_b32 v117, v116, v117, vcc
    s_lshl2_add_u32 s86, s47, s86
    s_lshl2_add_u32 s87, s46, s87
    v_writelane_b32 v116, s86, 0
    v_writelane_b32 v116, s87, 1
    s_getreg_b32 s83, hwreg(HW_REG_XCC_ID, 0, 4)
    s_add_u32 s83, s83, s68
    v_mov_b32 v121, s83
    s_lshl_b32 s86, s44, 7
    s_add_u32 s86, s86, 753664
    v_lshl_add_u32 v119, v0, 2, s86
    v_mov_b32 v120, 2147483648
    v_cmp_gt_u32 vcc, 32, v0
    s_nop 1
    v_cndmask_b32 v119, v120, v119, vcc
    s_lshl_b32 s86, s48, 6
    s_add_u32 s86, s86, s45
    v_cmp_eq_u32 vcc, s86, v0
    s_nop 1
    v_cndmask_b32 v120, v120, v119, vcc
    s_waitcnt vmcnt(12)
    s_barrier
    buffer_store_dword v121, v120, s[16:19], 0 offen sc1
    s_add_u32 m0, s53, 122880
    s_lshl_b32 s70, s64, 7
    s_add_u32 s70, s70, s63
    buffer_load_dwordx4 v2, s[8:11], s70 offen offset:0 lds
    buffer_load_dwordx4 v3, s[8:11], s70 offen offset:1024 lds
    buffer_load_dwordx4 v4, s[8:11], s70 offen offset:2048 lds
    buffer_load_dwordx4 v5, s[8:11], s70 offen offset:3072 lds
    s_mul_i32 s91, s64, 393216
    s_add_u32 s64, s64, 1
    s_and_b32 s64, s64, 15
    s_add_u32 m0, s62, 122880
    s_nop 0
    buffer_load_dwordx4 v6, s[12:15], s91 offen offset:0 lds
    buffer_load_dwordx4 v7, s[12:15], s91 offen offset:1024 lds
    s_add_u32 m0, s62, 131072
    s_nop 0
    buffer_load_dwordx4 v8, s[12:15], s91 offen offset:0 lds
    buffer_load_dwordx4 v9, s[12:15], s91 offen offset:1024 lds
    s_add_u32 m0, s62, 139264
    s_nop 0
    buffer_load_dwordx4 v10, s[12:15], s91 offen offset:0 lds
    buffer_load_dwordx4 v11, s[12:15], s91 offen offset:1024 lds
    s_add_u32 s87, s67, 4
    v_add_u32 v24, s87, v20
    v_and_b32 v24, 15, v24
    v_lshl_add_u32 v123, v24, 7, v125
    v_mov_b32 v24, 2147483648
    v_cmp_gt_u32 vcc, 32, v0
    s_nop 1
    v_cndmask_b32 v123, v24, v123, vcc
    buffer_load_dword v122, v123, s[8:11], 0 offen
    s_cmp_lg_u32 s65, 0
    s_cbranch_scc1 L_h0c0
    ds_read_b128 v[40:43], v28 offset:0
    ds_read_b128 v[44:47], v29 offset:1024
    ds_read_b128 v[48:51], v28 offset:2048
    ds_read_b128 v[52:55], v29 offset:3072
    ds_read_b128 v[56:59], v28 offset:4096
    ds_read_b128 v[60:63], v29 offset:5120
    ds_read_b128 v[64:67], v28 offset:6144
    ds_read_b128 v[68:71], v29 offset:7168
L_h0c0:
    s_cmp_lg_u32 s66, 0
    s_cbranch_scc1 L_h0r0
    ds_read_b128 v[72:75], v16
    ds_read_b128 v[76:79], v17
    ds_read_b128 v[80:83], v18
    ds_read_b128 v[84:87], v19
L_h0r0:
    s_waitcnt lgkmcnt(0)
    s_waitcnt vmcnt(14)
    s_barrier
    s_add_u32 m0, s53, 0
    s_lshl_b32 s70, s64, 7
    s_add_u32 s70, s70, s63
    buffer_load_dwordx4 v2, s[8:11], s70 offen offset:0 lds
    buffer_load_dwordx4 v3, s[8:11], s70 offen offset:1024 lds
    buffer_load_dwordx4 v4, s[8:11], s70 offen offset:2048 lds
    buffer_load_dwordx4 v5, s[8:11], s70 offen offset:3072 lds
    s_mul_i32 s91, s64, 393216
    s_add_u32 s64, s64, 1
    s_and_b32 s64, s64, 15
    s_add_u32 m0, s62, 0
    s_nop 0
    buffer_load_dwordx4 v6, s[12:15], s91 offen offset:0 lds
    buffer_load_dwordx4 v7, s[12:15], s91 offen offset:1024 lds
    s_add_u32 m0, s62, 8192
    s_nop 0
    buffer_load_dwordx4 v8, s[12:15], s91 offen offset:0 lds
    buffer_load_dwordx4 v9, s[12:15], s91 offen offset:1024 lds
    s_add_u32 m0, s62, 16384
    s_nop 0
    buffer_load_dwordx4 v10, s[12:15], s91 offen offset:0 lds
    buffer_load_dwordx4 v11, s[12:15], s91 offen offset:1024 lds
    s_cmp_lg_u32 s65, 1
    s_cbranch_scc1 L_h0c1
    ds_read_b128 v[40:43], v28 offset:0
    ds_read_b128 v[44:47], v29 offset:1024
    ds_read_b128 v[48:51], v28 offset:2048
    ds_read_b128 v[52:55], v29 offset:3072
    ds_read_b128 v[56:59], v28 offset:4096
    ds_read_b128 v[60:63], v29 offset:5120
    ds_read_b128 v[64:67], v28 offset:6144
    ds_read_b128 v[68:71], v29 offset:7168
L_h0c1:
    s_cmp_lg_u32 s66, 1
    s_cbranch_scc1 L_h0r1
    ds_read_b128 v[72:75], v16
    ds_read_b128 v[76:79], v17
    ds_read_b128 v[80:83], v18
    ds_read_b128 v[84:87], v19
L_h0r1:
    s_waitcnt lgkmcnt(0)
    s_waitcnt vmcnt(11)
    s_barrier
    s_add_u32 m0, s53, 40960
    s_lshl_b32 s70, s64, 7
    s_add_u32 s70, s70, s63
    buffer_load_dwordx4 v2, s[8:11], s70 offen offset:0 lds
    buffer_load_dwordx4 v3, s[8:11], s70 offen offset:1024 lds
    buffer_load_dwordx4 v4, s[8:11], s70 offen offset:2048 lds
    buffer_load_dwordx4 v5, s[8:11], s70 offen offset:3072 lds
    s_mul_i32 s91, s64, 393216
    s_add_u32 s64, s64, 1
    s_and_b32 s64, s64, 15
    s_add_u32 m0, s62, 40960
    s_nop 0
    buffer_load_dwordx4 v6, s[12:15], s91 offen offset:0 lds
    buffer_load_dwordx4 v7, s[12:15], s91 offen offset:1024 lds
    s_add_u32 m0, s62, 49152
    s_nop 0
    buffer_load_dwordx4 v8, s[12:15], s91 offen offset:0 lds
    buffer_load_dwordx4 v9, s[12:15], s91 offen offset:1024 lds
    s_add_u32 m0, s62, 57344
    s_nop 0
    buffer_load_dwordx4 v10, s[12:15], s91 offen offset:0 lds
    buffer_load_dwordx4 v11, s[12:15], s91 offen offset:1024 lds
    s_cmp_lg_u32 s65, 2
    s_cbranch_scc1 L_h0c2
    ds_read_b128 v[40:43], v28 offset:0
    ds_read_b128 v[44:47], v29 offset:1024
    ds_read_b128 v[48:51], v28 offset:2048
    ds_read_b128 v[52:55], v29 offset:3072
    ds_read_b128 v[56:59], v28 offset:4096
    ds_read_b128 v[60:63], v29 offset:5120
    ds_read_b128 v[64:67], v28 offset:6144
    ds_read_b128 v[68:71], v29 offset:7168
L_h0c2:
    s_cmp_lg_u32 s66, 2
    s_cbranch_scc1 L_h0r2
    ds_read_b128 v[72:75], v16
    ds_read_b128 v[76:79], v17
    ds_read_b128 v[80:83], v18
    ds_read_b128 v[84:87], v19
L_h0r2:
    s_waitcnt lgkmcnt(0)
    s_waitcnt vmcnt(10)
    s_barrier
    s_add_u32 m0, s53, 81920
    s_lshl_b32 s70, s64, 7
    s_add_u32 s70, s70, s63
    buffer_load_dwordx4 v2, s[8:11], s70 offen offset:0 lds
    buffer_load_dwordx4 v3, s[8:11], s70 offen offset:1024 lds
    buffer_load_dwordx4 v4, s[8:11], s70 offen offset:2048 lds
    buffer_load_dwordx4 v5, s[8:11], s70 offen offset:3072 lds
    s_mul_i32 s91, s64, 393216
    s_add_u32 s64, s64, 1
    s_and_b32 s64, s64, 15
    s_add_u32 m0, s62, 81920
    s_nop 0
    buffer_load_dwordx4 v6, s[12:15], s91 offen offset:0 lds
    buffer_load_dwordx4 v7, s[12:15], s91 offen offset:1024 lds
    s_add_u32 m0, s62, 90112
    s_nop 0
    buffer_load_dwordx4 v8, s[12:15], s91 offen offset:0 lds
L_walkB0:
    s_cbranch_execz L_walk_4
    buffer_load_dwordx4 v9, s[12:15], s91 offen offset:1024 lds
    s_add_u32 m0, s62, 98304
    s_nop 0
    buffer_load_dwordx4 v10, s[12:15], s91 offen offset:0 lds
    buffer_load_dwordx4 v11, s[12:15], s91 offen offset:1024 lds
    s_lshr_b32 s90, s67, 2
    s_add_u32 s90, s90, 2
    s_and_b32 s90, s90, 3
    s_mul_i32 s90, s90, 1572864
    buffer_load_dword v39, v37, s[12:15], s90 offen
    s_cmp_lg_u32 s65, 3
    s_cbranch_scc1 L_h0c3
    ds_read_b128 v[40:43], v28 offset:0
    ds_read_b128 v[44:47], v29 offset:1024
    ds_read_b128 v[48:51], v28 offset:2048
    ds_read_b128 v[52:55], v29 offset:3072
    ds_read_b128 v[56:59], v28 offset:4096
    ds_read_b128 v[60:63], v29 offset:5120
    ds_read_b128 v[64:67], v28 offset:6144
    ds_read_b128 v[68:71], v29 offset:7168
L_h0c3:
    s_cmp_lg_u32 s66, 3
    s_cbranch_scc1 L_h0r3
    ds_read_b128 v[72:75], v16
    ds_read_b128 v[76:79], v17
    ds_read_b128 v[80:83], v18
    ds_read_b128 v[84:87], v19
L_h0r3:
    s_waitcnt lgkmcnt(0)
    s_waitcnt vmcnt(11)
    s_barrier
    s_add_u32 m0, s53, 122880
    s_lshl_b32 s70, s64, 7
    s_add_u32 s70, s70, s63
    buffer_load_dwordx4 v2, s[8:11], s70 offen offset:0 lds
    buffer_load_dwordx4 v3, s[8:11], s70 offen offset:1024 lds
    buffer_load_dwordx4 v4, s[8:11], s70 offen offset:2048 lds
    buffer_load_dwordx4 v5, s[8:11], s70 offen offset:3072 lds
    s_mul_i32 s91, s64, 393216
    s_add_u32 s64, s64, 1
    s_and_b32 s64, s64, 15
    s_add_u32 m0, s62, 122880
    s_nop 0
    buffer_load_dwordx4 v6, s[12:15], s91 offen offset:0 lds
    buffer_load_dwordx4 v7, s[12:15], s91 offen offset:1024 lds
    s_add_u32 m0, s62, 131072
    s_nop 0
    buffer_load_dwordx4 v8, s[12:15], s91 offen offset:0 lds
    buffer_load_dwordx4 v9, s[12:15], s91 offen offset:1024 lds
    s_add_u32 m0, s62, 139264
    s_nop 0
    buffer_load_dwordx4 v10, s[12:15], s91 offen offset:0 lds
    buffer_load_dwordx4 v11, s[12:15], s91 offen offset:1024 lds
    s_cmp_lg_u32 s65, 4
    s_cbranch_scc1 L_h0c4
    ds_read_b128 v[40:43], v28 offset:0
    ds_read_b128 v[44:47], v29 offset:1024
    ds_read_b128 v[48:51], v28 offset:2048
    ds_read_b128 v[52:55], v29 offset:3072
    ds_read_b128 v[56:59], v28 offset:4096
    ds_read_b128 v[60:63], v29 offset:5120
    ds_read_b128 v[64:67], v28 offset:6144
    ds_read_b128 v[68:71], v29 offset:7168
L_h0c4:
    s_waitcnt lgkmcnt(0)
    v_mov_b32 v88, 0
    v_mov_b32 v89, 0
    v_mov_b32 v90, 0
    v_mov_b32 v91, 0
    v_mov_b32 v92, 0
    v_mov_b32 v93, 0
    v_mov_b32 v94, 0
    v_mov_b32 v95, 0
    v_dot2c_f32_bf16 v88, s95, v72
    v_dot2c_f32_bf16 v89, s95, v73
    v_dot2c_f32_bf16 v90, s95, v74
    v_dot2c_f32_bf16 v91, s95, v75
    v_dot2c_f32_bf16 v92, v72, v72
    v_dot2c_f32_bf16 v93, v73, v73
    v_dot2c_f32_bf16 v94, v74, v74
    v_dot2c_f32_bf16 v95, v75, v75
    v_dot2c_f32_bf16 v88, s95, v76
    v_dot2c_f32_bf16 v89, s95, v77
    v_dot2c_f32_bf16 v90, s95, v78
    v_dot2c_f32_bf16 v91, s95, v79
    v_dot2c_f32_bf16 v92, v76, v76
    v_dot2c_f32_bf16 v93, v77, v77
    v_dot2c_f32_bf16 v94, v78, v78
    v_dot2c_f32_bf16 v95, v79, v79
    v_dot2c_f32_bf16 v88, s95, v80
    v_dot2c_f32_bf16 v89, s95, v81
    v_dot2c_f32_bf16 v90, s95, v82
    v_dot2c_f32_bf16 v91, s95, v83
    v_dot2c_f32_bf16 v92, v80, v80
    v_dot2c_f32_bf16 v93, v81, v81
    v_dot2c_f32_bf16 v94, v82, v82
    v_dot2c_f32_bf16 v95, v83, v83
    v_dot2c_f32_bf16 v88, s95, v84
    v_dot2c_f32_bf16 v89, s95, v85
    v_dot2c_f32_bf16 v90, s95, v86
    v_dot2c_f32_bf16 v91, s95, v87
    v_dot2c_f32_bf16 v92, v84, v84
    v_dot2c_f32_bf16 v93, v85, v85
    v_dot2c_f32_bf16 v94, v86, v86
    v_dot2c_f32_bf16 v95, v87, v87
    s_waitcnt vmcnt(11)
    s_barrier
    s_add_u32 m0, s53, 0
    s_lshl_b32 s70, s64, 7
    s_add_u32 s70, s70, s63
    buffer_load_dwordx4 v2, s[8:11], s70 offen offset:0 lds
    buffer_load_dwordx4 v3, s[8:11], s70 offen offset:1024 lds
    buffer_load_dwordx4 v4, s[8:11], s70 offen offset:2048 lds
    buffer_load_dwordx4 v5, s[8:11], s70 offen offset:3072 lds
    s_mul_i32 s91, s64, 393216
    s_add_u32 s64, s64, 1
    s_and_b32 s64, s64, 15
    s_add_u32 m0, s62, 0
    s_nop 0
    buffer_load_dwordx4 v6, s[12:15], s91 offen offset:0 lds
    buffer_load_dwordx4 v7, s[12:15], s91 offen offset:1024 lds
    s_add_u32 m0, s62, 8192
    s_nop 0
    buffer_load_dwordx4 v8, s[12:15], s91 offen offset:0 lds
    buffer_load_dwordx4 v9, s[12:15], s91 offen offset:1024 lds
    s_add_u32 m0, s62, 16384
    s_nop 0
    buffer_load_dwordx4 v10, s[12:15], s91 offen offset:0 lds
    buffer_load_dwordx4 v11, s[12:15], s91 offen offset:1024 lds
    buffer_load_dword v39, v38, s[20:23], 0 offen
    s_cmp_lg_u32 s65, 5
    s_cbranch_scc1 L_h0c5
    ds_read_b128 v[40:43], v28 offset:0
    ds_read_b128 v[44:47], v29 offset:1024
    ds_read_b128 v[48:51], v28 offset:2048
    ds_read_b128 v[52:55], v29 offset:3072
    ds_read_b128 v[56:59], v28 offset:4096
    ds_read_b128 v[60:63], v29 offset:5120
    ds_read_b128 v[64:67], v28 offset:6144
    ds_read_b128 v[68:71], v29 offset:7168
L_h0c5:
    s_waitcnt lgkmcnt(0)
    v_pk_add_f32 v[88:89], v[88:89], v[90:91]
    v_pk_add_f32 v[92:93], v[92:93], v[94:95]
    v_add_f32 v88, v88, v89
    v_add_f32 v89, v92, v93
    s_nop 0
    v_add_f32_dpp v88, v88, v88 quad_perm:[1,0,3,2] row_mask:0xf bank_mask:0xf
    v_add_f32_dpp v89, v89, v89 quad_perm:[1,0,3,2] row_mask:0xf bank_mask:0xf
    s_nop 0
    v_mov_b32_dpp v90, v88 quad_perm:[2,2,2,2] row_mask:0xf bank_mask:0xf
    v_mov_b32_dpp v91, v89 quad_perm:[2,2,2,2] row_mask:0xf bank_mask:0xf
    buffer_store_dwordx4 v[88:91], v13, s[16:19], 0 offen sc1
    s_lshl_b32 s86, s48, 7
    s_add_u32 s86, s86, 131072
    v_lshl_add_u32 v16, v23, 3, s86
    v_lshrrev_b32 v17, 5, v0
    v_lshl_add_u32 v16, v17, 2, v16
    s_lshl_b32 s86, s48, 8
    s_add_u32 s86, s86, 132608
    v_lshl_add_u32 v17, v23, 4, s86
    v_lshl_add_u32 v17, v22, 2, v17
    s_waitcnt vmcnt(12)
    s_barrier
    s_add_u32 m0, s53, 40960
    s_lshl_b32 s70, s64, 7
    s_add_u32 s70, s70, s63
    buffer_load_dwordx4 v2, s[8:11], s70 offen offset:0 lds
    buffer_load_dwordx4 v3, s[8:11], s70 offen offset:1024 lds
    buffer_load_dwordx4 v4, s[8:11], s70 offen offset:2048 lds
    buffer_load_dwordx4 v5, s[8:11], s70 offen offset:3072 lds
    s_mul_i32 s91, s64, 393216
    s_add_u32 s64, s64, 1
    s_and_b32 s64, s64, 15
    s_add_u32 m0, s62, 40960
    s_nop 0
    buffer_load_dwordx4 v6, s[12:15], s91 offen offset:0 lds
    buffer_load_dwordx4 v7, s[12:15], s91 offen offset:1024 lds
    s_add_u32 m0, s62, 49152
    s_nop 0
    buffer_load_dwordx4 v8, s[12:15], s91 offen offset:0 lds
    buffer_load_dwordx4 v9, s[12:15], s91 offen offset:1024 lds
    s_add_u32 m0, s62, 57344
    s_nop 0
    buffer_load_dwordx4 v10, s[12:15], s91 offen offset:0 lds
L_walkB1:
    s_cbranch_execz L_walk_5
    buffer_load_dwordx4 v11, s[12:15], s91 offen offset:1024 lds
    s_lshr_b32 s90, s67, 2
    s_add_u32 s90, s90, 3
    s_and_b32 s90, s90, 3
    s_mul_i32 s90, s90, 1572864
    buffer_load_dword v39, v37, s[12:15], s90 offen
    s_cmp_lg_u32 s65, 6
    s_cbranch_scc1 L_h0c6
    ds_read_b128 v[40:43], v28 offset:0
    ds_read_b128 v[44:47], v29 offset:1024
    ds_read_b128 v[48:51], v28 offset:2048
    ds_read_b128 v[52:55], v29 offset:3072
    ds_read_b128 v[56:59], v28 offset:4096
    ds_read_b128 v[60:63], v29 offset:5120
    ds_read_b128 v[64:67], v28 offset:6144
    ds_read_b128 v[68:71], v29 offset:7168
L_h0c6:
    s_waitcnt lgkmcnt(0)
    s_waitcnt vmcnt(13)
    s_barrier
    s_add_u32 m0, s53, 81920
    s_lshl_b32 s70, s64, 7
    s_add_u32 s70, s70, s63
    buffer_load_dwordx4 v2, s[8:11], s70 offen offset:0 lds
    buffer_load_dwordx4 v3, s[8:11], s70 offen offset:1024 lds
    buffer_load_dwordx4 v4, s[8:11], s70 offen offset:2048 lds
    buffer_load_dwordx4 v5, s[8:11], s70 offen offset:3072 lds
    s_mul_i32 s91, s64, 393216
    s_add_u32 s64, s64, 1
    s_and_b32 s64, s64, 15
    s_add_u32 m0, s62, 81920
    s_nop 0
    buffer_load_dwordx4 v6, s[12:15], s91 offen offset:0 lds
    buffer_load_dwordx4 v7, s[12:15], s91 offen offset:1024 lds
    s_add_u32 m0, s62, 90112
    s_nop 0
    buffer_load_dwordx4 v8, s[12:15], s91 offen offset:0 lds
    buffer_load_dwordx4 v9, s[12:15], s91 offen offset:1024 lds
    s_add_u32 m0, s62, 98304
    s_nop 0
    buffer_load_dwordx4 v10, s[12:15], s91 offen offset:0 lds
    buffer_load_dwordx4 v11, s[12:15], s91 offen offset:1024 lds
    s_add_u32 m0, s53, 122880
    s_lshl_b32 s70, s64, 7
    s_add_u32 s70, s70, s63
    buffer_load_dwordx4 v2, s[8:11], s70 offen offset:0 lds
    buffer_load_dwordx4 v3, s[8:11], s70 offen offset:1024 lds
    s_cmp_lg_u32 s65, 7
    s_cbranch_scc1 L_h0c7
    ds_read_b128 v[40:43], v28 offset:0
    ds_read_b128 v[44:47], v29 offset:1024
    ds_read_b128 v[48:51], v28 offset:2048
    ds_read_b128 v[52:55], v29 offset:3072
    ds_read_b128 v[56:59], v28 offset:4096
    ds_read_b128 v[60:63], v29 offset:5120
    ds_read_b128 v[64:67], v28 offset:6144
    ds_read_b128 v[68:71], v29 offset:7168
L_h0c7:
    s_waitcnt lgkmcnt(0)
    s_waitcnt vmcnt(13)
    s_barrier
    s_add_u32 m0, s53, 122880
    s_nop 0
    buffer_load_dwordx4 v4, s[8:11], s70 offen offset:2048 lds
    buffer_load_dwordx4 v5, s[8:11], s70 offen offset:3072 lds
    s_mul_i32 s91, s64, 393216
    s_add_u32 s64, s64, 1
    s_and_b32 s64, s64, 15
    s_add_u32 m0, s62, 122880
    s_nop 0
    buffer_load_dwordx4 v6, s[12:15], s91 offen offset:0 lds
    buffer_load_dwordx4 v7, s[12:15], s91 offen offset:1024 lds
    s_add_u32 m0, s62, 131072
    s_nop 0
    buffer_load_dwordx4 v8, s[12:15], s91 offen offset:0 lds
    buffer_load_dwordx4 v9, s[12:15], s91 offen offset:1024 lds
    s_add_u32 m0, s62, 139264
    s_nop 0
    buffer_load_dwordx4 v10, s[12:15], s91 offen offset:0 lds
    buffer_load_dwordx4 v11, s[12:15], s91 offen offset:1024 lds
    s_add_u32 m0, s53, 0
    s_lshl_b32 s70, s64, 7
    s_add_u32 s70, s70, s63
    buffer_load_dwordx4 v2, s[8:11], s70 offen offset:0 lds
    buffer_load_dwordx4 v3, s[8:11], s70 offen offset:1024 lds
    v_mfma_f32_16x16x32_bf16 v[108:111], v[104:107], v[40:43], 0
    v_mfma_f32_16x16x32_bf16 v[108:111], v[104:107], v[44:47], v[108:111]
    v_mfma_f32_16x16x32_bf16 v[108:111], v[104:107], v[48:51], v[108:111]
    v_mfma_f32_16x16x32_bf16 v[108:111], v[104:107], v[52:55], v[108:111]
    v_mfma_f32_16x16x32_bf16 v[108:111], v[104:107], v[56:59], v[108:111]
    v_mfma_f32_16x16x32_bf16 v[108:111], v[104:107], v[60:63], v[108:111]
    v_mfma_f32_16x16x32_bf16 v[108:111], v[104:107], v[64:67], v[108:111]
    v_mfma_f32_16x16x32_bf16 v[108:111], v[104:107], v[68:71], v[108:111]
    s_nop 7
    v_add_f32_dpp v108, v108, v108 row_ror:8 row_mask:0xf bank_mask:0xf
    v_add_f32_dpp v109, v109, v109 row_ror:8 row_mask:0xf bank_mask:0xf
    v_add_f32_dpp v110, v110, v110 row_ror:8 row_mask:0xf bank_mask:0xf
    v_add_f32_dpp v111, v111, v111 row_ror:8 row_mask:0xf bank_mask:0xf
    buffer_store_dwordx4 v[108:111], v34, s[16:19], 0 offen sc1
    s_waitcnt vmcnt(13)
    s_barrier
    s_add_u32 m0, s53, 0
    s_nop 0
    buffer_load_dwordx4 v4, s[8:11], s70 offen offset:2048 lds
    buffer_load_dwordx4 v5, s[8:11], s70 offen offset:3072 lds
    s_mul_i32 s91, s64, 393216
    s_add_u32 s64, s64, 1
    s_and_b32 s64, s64, 15
    s_add_u32 m0, s62, 0
    s_nop 0
    buffer_load_dwordx4 v6, s[12:15], s91 offen offset:0 lds
    buffer_load_dwordx4 v7, s[12:15], s91 offen offset:1024 lds
    s_add_u32 m0, s62, 8192
    s_nop 0
    buffer_load_dwordx4 v8, s[12:15], s91 offen offset:0 lds
    buffer_load_dwordx4 v9, s[12:15], s91 offen offset:1024 lds
    s_add_u32 m0, s62, 16384
    s_nop 0
    buffer_load_dwordx4 v10, s[12:15], s91 offen offset:0 lds
    buffer_load_dwordx4 v11, s[12:15], s91 offen offset:1024 lds
    s_add_u32 m0, s53, 40960
    s_lshl_b32 s70, s64, 7
    s_add_u32 s70, s70, s63
    buffer_load_dwordx4 v2, s[8:11], s70 offen offset:0 lds
    buffer_load_dwordx4 v3, s[8:11], s70 offen offset:1024 lds
    buffer_load_dwordx4 v4, s[8:11], s70 offen offset:2048 lds
    buffer_load_dwordx4 v5, s[8:11], s70 offen offset:3072 lds
    s_mul_i32 s91, s64, 393216
    s_add_u32 s64, s64, 1
    s_and_b32 s64, s64, 15
    s_waitcnt vmcnt(12)
    s_barrier
    buffer_atomic_swap v35, v116, s[16:19], 0 offen sc1
    s_add_u32 m0, s62, 40960
    s_nop 0
    buffer_load_dwordx4 v6, s[12:15], s91 offen offset:0 lds
    buffer_load_dwordx4 v7, s[12:15], s91 offen offset:1024 lds
    s_add_u32 m0, s62, 49152
    s_nop 0
    buffer_load_dwordx4 v8, s[12:15], s91 offen offset:0 lds
    buffer_load_dwordx4 v9, s[12:15], s91 offen offset:1024 lds
    s_add_u32 m0, s62, 57344
    s_nop 0
    buffer_load_dwordx4 v10, s[12:15], s91 offen offset:0 lds
    buffer_load_dwordx4 v11, s[12:15], s91 offen offset:1024 lds
    s_add_u32 m0, s53, 81920
    s_lshl_b32 s70, s64, 7
    s_add_u32 s70, s70, s63
    buffer_load_dwordx4 v2, s[8:11], s70 offen offset:0 lds
    buffer_load_dwordx4 v3, s[8:11], s70 offen offset:1024 lds
    buffer_load_dwordx4 v4, s[8:11], s70 offen offset:2048 lds
    buffer_load_dwordx4 v5, s[8:11], s70 offen offset:3072 lds
    s_mul_i32 s91, s64, 393216
    s_add_u32 s64, s64, 1
    s_and_b32 s64, s64, 15
    s_add_u32 m0, s62, 81920
    s_nop 0
    buffer_load_dwordx4 v6, s[12:15], s91 offen offset:0 lds
    buffer_load_dwordx4 v7, s[12:15], s91 offen offset:1024 lds
    s_waitcnt vmcnt(17)
    s_barrier
    buffer_load_dword v121, v119, s[16:19], 0 offen sc1
    s_add_u32 m0, s62, 90112
    s_nop 0
    buffer_load_dwordx4 v8, s[12:15], s91 offen offset:0 lds
    buffer_load_dwordx4 v9, s[12:15], s91 offen offset:1024 lds
    s_add_u32 m0, s62, 98304
L_walk_4:
    s_cbranch_execz L_walk_8
    s_nop 0
    buffer_load_dwordx4 v10, s[12:15], s91 offen offset:0 lds
    buffer_load_dwordx4 v11, s[12:15], s91 offen offset:1024 lds
    s_add_u32 m0, s53, 122880
    s_lshl_b32 s70, s64, 7
    s_add_u32 s70, s70, s63
    buffer_load_dwordx4 v2, s[8:11], s70 offen offset:0 lds
    buffer_load_dwordx4 v3, s[8:11], s70 offen offset:1024 lds
    buffer_load_dwordx4 v4, s[8:11], s70 offen offset:2048 lds
    buffer_load_dwordx4 v5, s[8:11], s70 offen offset:3072 lds
    s_mul_i32 s91, s64, 393216
    s_add_u32 s64, s64, 1
    s_and_b32 s64, s64, 15
    s_add_u32 m0, s62, 122880
    s_nop 0
    buffer_load_dwordx4 v6, s[12:15], s91 offen offset:0 lds
    buffer_load_dwordx4 v7, s[12:15], s91 offen offset:1024 lds
    s_add_u32 m0, s62, 131072
    s_nop 0
    buffer_load_dwordx4 v8, s[12:15], s91 offen offset:0 lds
    buffer_load_dwordx4 v9, s[12:15], s91 offen offset:1024 lds
    s_waitcnt vmcnt(19)
    s_barrier
    s_add_u32 m0, s62, 139264
    s_nop 0
    buffer_load_dwordx4 v10, s[12:15], s91 offen offset:0 lds
    buffer_load_dwordx4 v11, s[12:15], s91 offen offset:1024 lds
    s_add_u32 m0, s53, 0
    s_lshl_b32 s70, s64, 7
    s_add_u32 s70, s70, s63
    buffer_load_dwordx4 v2, s[8:11], s70 offen offset:0 lds
    buffer_load_dwordx4 v3, s[8:11], s70 offen offset:1024 lds
    buffer_load_dwordx4 v4, s[8:11], s70 offen offset:2048 lds
    buffer_load_dwordx4 v5, s[8:11], s70 offen offset:3072 lds
    s_mul_i32 s91, s64, 393216
    s_add_u32 s64, s64, 1
    s_and_b32 s64, s64, 15
    s_add_u32 m0, s62, 0
    s_nop 0
    buffer_load_dwordx4 v6, s[12:15], s91 offen offset:0 lds
    buffer_load_dwordx4 v7, s[12:15], s91 offen offset:1024 lds
    s_add_u32 m0, s62, 8192
    s_nop 0
    buffer_load_dwordx4 v8, s[12:15], s91 offen offset:0 lds
    buffer_load_dwordx4 v9, s[12:15], s91 offen offset:1024 lds
    s_add_u32 m0, s62, 16384
    s_nop 0
    buffer_load_dwordx4 v10, s[12:15], s91 offen offset:0 lds
    buffer_load_dwordx4 v11, s[12:15], s91 offen offset:1024 lds
    s_waitcnt vmcnt(20)
    s_barrier
    v_mov_b32 v118, 0
    buffer_atomic_or v118, v117, s[16:19], 0 offen sc0 sc1
    s_add_u32 m0, s89, 40960
    s_mov_b32 s90, 655360
    buffer_load_dwordx4 v12, s[20:23], s90 offen lds
    s_add_u32 m0, s89, 45056
    s_mov_b32 s90, 720896
    buffer_load_dwordx4 v12, s[20:23], s90 offen lds
    s_add_u32 m0, s89, 49152
    s_mov_b32 s90, 786432
    buffer_load_dwordx4 v12, s[20:23], s90 offen lds
    s_add_u32 m0, s89, 53248
    s_mov_b32 s90, 851968
    buffer_load_dwordx4 v12, s[20:23], s90 offen lds
    s_mov_b32 s90, 0
    buffer_load_dwordx4 v[164:167], v30, s[32:35], s90 offen
    s_mov_b32 s90, 7168
    buffer_load_dwordx4 v[168:171], v30, s[32:35], s90 offen
    s_mov_b32 s90, 14336
    buffer_load_dwordx4 v[172:175], v30, s[32:35], s90 offen
    s_mov_b32 s90, 21504
    buffer_load_dwordx4 v[176:179], v30, s[32:35], s90 offen
    s_waitcnt vmcnt(19)
    s_barrier
    s_waitcnt vmcnt(8)
    s_branch L_h0_chk0
L_h0_spin:
    v_mov_b32 v118, 0
    buffer_atomic_or v118, v117, s[16:19], 0 offen sc0 sc1
    s_waitcnt vmcnt(0)
L_h0_chk0:
    v_cmp_ne_u32 vcc, s68, v118
    s_nop 0
    s_and_b64 vcc, vcc, s[76:77]
    s_cbranch_vccz L_ok_1
    s_sub_u32 s56, s56, 1
    s_cbranch_scc0 L_h0_spin
    s_mov_b32 s56, 0
L_ok_1:
    v_cmp_eq_u32 vcc, s83, v121
    s_nop 0
    s_cmp_eq_u32 vcc_lo, -1
    s_cselect_b32 s83, 1, 0
    s_mov_b32 s90, 0
    buffer_load_dwordx4 v[40:43], v32, s[16:19], s90 offen sc1
    s_mov_b32 s90, 3072
    buffer_load_dwordx4 v[44:47], v32, s[16:19], s90 offen sc1
    s_mov_b32 s90, 6144
    buffer_load_dwordx4 v[48:51], v32, s[16:19], s90 offen sc1
    s_mov_b32 s90, 9216
    buffer_load_dwordx4 v[52:55], v32, s[16:19], s90 offen sc1
    buffer_load_dwordx4 v[56:59], v33, s[16:19], 0 offen sc1
    buffer_load_dwordx4 v[60:63], v33, s[16:19], s92 offen sc1
    buffer_load_dwordx4 v[64:67], v33, s[16:19], s93 offen sc1
    buffer_load_dwordx4 v[68:71], v33, s[16:19], s94 offen sc1
    s_mov_b32 s90, 28672
    buffer_load_dwordx4 v[180:183], v30, s[32:35], s90 offen
    s_mov_b32 s90, 35840
    buffer_load_dwordx4 v[184:187], v30, s[32:35], s90 offen
    s_mov_b32 s90, 43008
    buffer_load_dwordx4 v[188:191], v30, s[32:35], s90 offen
    s_waitcnt vmcnt(20)
    s_barrier
    v_mov_b32 v24, 135168
    v_lshl_add_u32 v24, v21, 2, v24
    v_mov_b32 v25, 0
    ds_write_b32 v24, v25
    s_add_u32 m0, s89, 57344
    s_mov_b32 s90, 917504
    buffer_load_dwordx4 v12, s[20:23], s90 offen lds
    s_add_u32 m0, s89, 61440
    s_mov_b32 s90, 983040
    buffer_load_dwordx4 v12, s[20:23], s90 offen lds
    s_add_u32 m0, s89, 65536
    s_mov_b32 s90, 1048576
    buffer_load_dwordx4 v12, s[20:23], s90 offen lds
    s_add_u32 m0, s89, 69632
    s_mov_b32 s90, 1114112
    buffer_load_dwordx4 v12, s[20:23], s90 offen lds
    s_add_u32 m0, s89, 73728
    s_mov_b32 s90, 1179648
    buffer_load_dwordx4 v12, s[20:23], s90 offen lds
    s_add_u32 m0, s89, 77824
    s_mov_b32 s90, 1245184
    buffer_load_dwordx4 v12, s[20:23], s90 offen lds
    s_waitcnt vmcnt(9)
    v_add_f32 v40, v40, v44
    v_add_f32 v41, v41, v45
    v_add_f32 v42, v42, v46
    v_add_f32 v43, v43, v47
    v_add_f32 v40, v40, v48
    v_add_f32 v41, v41, v49
    v_add_f32 v42, v42, v50
    v_add_f32 v43, v43, v51
    v_add_f32 v40, v40, v52
    v_add_f32 v41, v41, v53
    v_add_f32 v42, v42, v54
    v_add_f32 v43, v43, v55
    v_add_f32 v56, v56, v60
    v_add_f32 v57, v57, v61
    v_add_f32 v58, v58, v62
    v_add_f32 v59, v59, v63
    v_add_f32 v56, v56, v64
    v_add_f32 v57, v57, v65
    v_add_f32 v58, v58, v66
    v_add_f32 v59, v59, v67
    v_add_f32 v56, v56, v68
    v_add_f32 v57, v57, v69
    v_add_f32 v58, v58, v70
    v_add_f32 v59, v59, v71
    s_nop 0
    v_permlane32_swap_b32 v56, v58
    v_permlane32_swap_b32 v57, v59
    v_permlane32_swap_b32 v40, v42
    v_permlane32_swap_b32 v41, v43
    v_add_f32 v56, v56, v58
    v_add_f32 v57, v57, v59
    v_add_f32 v40, v40, v42
    v_add_f32 v41, v41, v43
    v_mov_b32 v58, v56
    v_mov_b32 v59, v57
    v_permlane16_swap_b32 v40, v41
    v_permlane16_swap_b32 v56, v58
    v_permlane16_swap_b32 v57, v59
    v_add_f32 v40, v40, v41
    v_add_f32 v56, v56, v58
    v_add_f32 v57, v57, v59
    ds_write_b32 v17, v40
    v_mul_f32 v56, 0x3a800000, v56
    v_mul_f32 v57, 0x3a800000, v57
    v_fma_f32 v57, -v56, v56, v57
L_walk_5:
    s_cbranch_execz L_walk_12
    v_max_f32 v57, 0, v57
    v_cvt_pk_bf16_f32 v48, v56, v57
    v_lshlrev_b32 v44, 16, v48
    v_and_b32 v48, 0xffff0000, v48
    v_add_f32 v48, 0x3727c5ac, v48
    v_cvt_pk_bf16_f32 v48, v48, v48
    v_lshlrev_b32 v48, 16, v48
    v_sqrt_f32 v48, v48
    s_nop 0
    v_cvt_pk_bf16_f32 v48, v48, v48
    v_lshlrev_b32 v48, 16, v48
    v_rcp_f32 v46, v48
    v_sub_f32 v44, 0, v44
    v_mul_f32 v48, 0x3fb8aa3b, v46
    ds_write_b32 v16, v44
    ds_write_b32 v16, v46 offset:512
    ds_write_b32 v16, v48 offset:1024
    s_waitcnt lgkmcnt(0)
    s_barrier
    s_setprio 0
    s_add_u32 m0, s89, 81920
    s_mov_b32 s90, 1310720
    buffer_load_dwordx4 v12, s[20:23], s90 offen lds
    s_add_u32 m0, s89, 86016
    s_mov_b32 s90, 1376256
    buffer_load_dwordx4 v12, s[20:23], s90 offen lds
    s_add_u32 m0, s89, 90112
    s_mov_b32 s90, 1441792
    buffer_load_dwordx4 v12, s[20:23], s90 offen lds
    s_add_u32 m0, s89, 94208
    s_mov_b32 s90, 1507328
    buffer_load_dwordx4 v12, s[20:23], s90 offen lds
    s_add_u32 m0, s89, 98304
    s_mov_b32 s90, 1572864
    buffer_load_dwordx4 v12, s[20:23], s90 offen lds
    s_add_u32 m0, s89, 102400
    s_mov_b32 s90, 1638400
    buffer_load_dwordx4 v12, s[20:23], s90 offen lds
    s_add_u32 m0, s89, 106496
    s_mov_b32 s90, 1703936
    buffer_load_dwordx4 v12, s[20:23], s90 offen lds
    s_add_u32 m0, s89, 110592
    s_mov_b32 s90, 1769472
    buffer_load_dwordx4 v12, s[20:23], s90 offen lds
    s_add_u32 m0, s89, 114688
    s_mov_b32 s90, 1835008
    buffer_load_dwordx4 v12, s[20:23], s90 offen lds
    s_add_u32 m0, s89, 118784
    s_mov_b32 s90, 1900544
    buffer_load_dwordx4 v12, s[20:23], s90 offen lds
    s_add_u32 m0, s89, 122880
    s_mov_b32 s90, 1966080
    buffer_load_dwordx4 v12, s[20:23], s90 offen lds
    s_add_u32 m0, s89, 126976
    s_mov_b32 s90, 2031616
    buffer_load_dwordx4 v12, s[20:23], s90 offen lds
    s_add_u32 m0, s89, 0
    s_mov_b32 s90, 0
    buffer_load_dwordx4 v12, s[20:23], s90 offen lds
    s_add_u32 m0, s89, 4096
    s_mov_b32 s90, 65536
    buffer_load_dwordx4 v12, s[20:23], s90 offen lds
    s_add_u32 m0, s89, 8192
    s_mov_b32 s90, 131072
    buffer_load_dwordx4 v12, s[20:23], s90 offen lds
    s_add_u32 m0, s89, 12288
    s_mov_b32 s90, 196608
    buffer_load_dwordx4 v12, s[20:23], s90 offen lds
    s_add_u32 m0, s89, 16384
    s_mov_b32 s90, 262144
    buffer_load_dwordx4 v12, s[20:23], s90 offen lds
    s_add_u32 m0, s89, 20480
    s_mov_b32 s90, 327680
    buffer_load_dwordx4 v12, s[20:23], s90 offen lds
    s_add_u32 m0, s89, 24576
    s_mov_b32 s90, 393216
    buffer_load_dwordx4 v12, s[20:23], s90 offen lds
    s_add_u32 m0, s89, 28672
    s_mov_b32 s90, 458752
    buffer_load_dwordx4 v12, s[20:23], s90 offen lds
    s_add_u32 m0, s89, 32768
    s_mov_b32 s90, 524288
    buffer_load_dwordx4 v12, s[20:23], s90 offen lds
    s_add_u32 m0, s89, 36864
    s_mov_b32 s90, 589824
    buffer_load_dwordx4 v12, s[20:23], s90 offen lds
    s_lshl_b32 s86, s47, 2
    s_add_u32 s86, s86, s48
    s_lshl_b32 s87, s86, 7
    s_add_u32 s87, s87, 671744
    v_lshl_add_u32 v6, v0, 2, s87
    v_mov_b32 v4, 2147483648
    v_cmp_gt_u32 vcc, 16, v0
    s_nop 1
    v_cndmask_b32 v6, v4, v6, vcc
    s_lshl_b32 s86, s86, 14
    s_add_u32 s86, s86, 5242880
    v_lshl_add_u32 v2, v0, 4, s86
    s_lshl_b32 s86, s47, 1
    s_add_u32 s86, s86, s50
    s_lshl_b32 s86, s86, 11
    s_lshl_b32 s87, s49, 6
    s_add_u32 s86, s86, s87
    s_add_u32 s86, s86, 6881280
    v_lshl_add_u32 v3, v23, 7, s86
    v_lshl_add_u32 v3, v22, 4, v3
    v_mov_b32 v112, 0
    v_mov_b32 v113, 0
    v_mov_b32 v114, 0
    v_mov_b32 v115, 0
    v_mov_b32 v116, 0
    v_mov_b32 v117, 0
    v_mov_b32 v118, 0
    v_mov_b32 v119, 0
    s_lshr_b32 s62, s3, 2
    s_lshl_b32 s53, s51, 3
    s_lshl_b32 s86, s48, 1
    s_add_u32 s53, s53, s86
    s_add_u32 s53, s53, s62
    v_lshrrev_b32 v36, 4, v0
    v_and_b32 v37, 15, v0
    s_lshl_b32 s87, s53, 15
    s_lshl_b32 s86, s62, 14
    s_add_u32 s86, s86, s87
    s_add_u32 s86, s86, 1048576
    v_lshl_add_u32 v157, v0, 4, s86
    v_xor_b32 v158, 0x8000, v157
    s_lshl_b32 s86, s51, 1
    s_lshr_b32 s87, s48, 1
    s_add_u32 s86, s86, s87
    s_lshl_b32 s86, s86, 1
    s_add_u32 s86, s86, s62
    s_lshl_b32 s86, s86, 1
    s_and_b32 s87, s48, 1
    s_add_u32 s86, s86, s87
    s_lshl_b32 s86, s86, 7
    s_add_u32 s86, s86, 688128
    v_lshl_add_u32 v159, v0, 2, s86
    v_mov_b32 v38, 2147483648
    v_cmp_gt_u32 vcc, 16, v0
    s_nop 1
    v_cndmask_b32 v159, v38, v159, vcc
    v_bfe_u32 v38, v0, 2, 2
    v_lshl_add_u32 v38, v36, 2, v38
    v_bfe_u32 v39, v38, 1, 2
    v_lshlrev_b32 v38, 7, v38
    v_lshl_add_u32 v38, v39, 5, v38
    v_and_b32 v39, 3, v0
    v_lshl_add_u32 v38, v39, 3, v38
    s_lshl_b32 s86, s62, 16
    s_add_u32 s86, s86, 0
    v_add_u32 v144, s86, v38
    v_xor_b32 v145, 32, v144
    v_xor_b32 v146, 64, v144
    v_xor_b32 v147, 96, v144
    v_cmp_eq_u32 s[4:5], 1, v39
    v_cmp_eq_u32 s[6:7], 2, v39
    v_cmp_eq_u32 s[98:99], 3, v39
    s_lshl_b32 s86, s53, 10
    s_add_u32 s86, s86, 786432
    v_lshl_add_u32 v160, v0, 2, s86
    v_mul_u32_u24 v161, 192, v36
    v_add_u32 v160, v160, v161
    s_mov_b32 s72, 0x00f0000f
    s_mov_b32 s73, 0xf0000f00
    s_mov_b32 s74, 0x0f00f000
    s_mov_b32 s75, 0x0f00f000
L_walk_6:
    s_cbranch_execz L_walk_13
    v_lshrrev_b32 v38, 2, v37
    v_lshl_add_u32 v161, v38, 4, v37
    v_lshlrev_b32 v161, 2, v161
    s_lshl_b32 s86, s3, 12
    s_add_u32 s86, s86, 131072
    v_lshl_add_u32 v162, v0, 4, s86
    v_xor_b32 v163, 0x4000, v162
    s_lshl_b32 s86, s52, 7
    v_lshl_add_u32 v36, v36, 3, s86
    s_lshl_b32 s87, s53, 15
    s_add_u32 s87, s87, s86
    s_lshl_b32 s86, s62, 6
    s_add_u32 s87, s87, s86
    v_lshl_add_u32 v39, v37, 11, s87
    v_and_b32 v38, 48, v0
    v_add_u32 v39, v39, v38
    v_xor_b32 v37, 0x8000, v39
    v_lshlrev_b32 v38, 4, v0
    buffer_load_dwordx2 v[148:149], v36, s[40:43], 0 offen offset:0
    buffer_load_dwordx2 v[150:151], v36, s[40:43], 0 offen offset:32
    buffer_load_dwordx2 v[152:153], v36, s[40:43], 0 offen offset:64
    buffer_load_dwordx2 v[154:155], v36, s[40:43], 0 offen offset:96
    buffer_load_dwordx4 v[128:131], v38, s[40:43], 0 offen
    buffer_load_dwordx4 v[132:135], v38, s[40:43], 0 offen offset:1024
    buffer_load_dwordx4 v[136:139], v39, s[8:11], 0 offen
    buffer_load_dwordx4 v[140:143], v37, s[8:11], 0 offen
    s_mov_b32 s90, 50176
    buffer_load_dwordx4 v[192:195], v30, s[32:35], s90 offen
    s_mov_b32 s90, 57344
    buffer_load_dwordx4 v[196:199], v30, s[32:35], s90 offen
    s_mov_b32 s90, 64512
    buffer_load_dwordx4 v[200:203], v30, s[32:35], s90 offen
    s_waitcnt vmcnt(5)
    v_mov_b32 v4, 0
    buffer_atomic_or v4, v6, s[16:19], 0 offen sc0 sc1
    v_bfe_u32 v36, v0, 2, 1
    v_cmp_eq_u32 vcc, 1, v36
    v_mov_b32 v36, s95
    v_mov_b32 v38, 0
    v_dot2c_f32_bf16 v38, s95, v128
    v_dot2c_f32_bf16 v38, s95, v129
    v_dot2c_f32_bf16 v38, s95, v130
    v_dot2c_f32_bf16 v38, s95, v131
    v_dot2c_f32_bf16 v38, s95, v132
    v_dot2c_f32_bf16 v38, s95, v133
    v_dot2c_f32_bf16 v38, s95, v134
    v_dot2c_f32_bf16 v38, s95, v135
    v_cndmask_b32 v148, v36, v148, vcc
    v_cndmask_b32 v149, v36, v149, vcc
    v_cndmask_b32 v150, v36, v150, vcc
    v_cndmask_b32 v151, v36, v151, vcc
    v_cndmask_b32 v152, v36, v152, vcc
    v_cndmask_b32 v153, v36, v153, vcc
    v_cndmask_b32 v154, v36, v154, vcc
    v_cndmask_b32 v155, v36, v155, vcc
    v_add_f32_dpp v38, v38, v38 row_ror:8 row_mask:0xf bank_mask:0xf
    s_nop 1
    v_add_f32_dpp v38, v38, v38 row_ror:4 row_mask:0xf bank_mask:0xf
    s_nop 1
    v_add_f32_dpp v38, v38, v38 row_ror:2 row_mask:0xf bank_mask:0xf
    s_nop 1
    v_add_f32_dpp v38, v38, v38 row_ror:1 row_mask:0xf bank_mask:0xf
    v_mov_b32 v36, v38
    s_nop 1
    v_permlane32_swap_b32 v38, v36
    v_add_f32 v38, v38, v36
    v_mov_b32 v36, v38
    s_nop 1
    v_permlane16_swap_b32 v38, v36
    v_add_f32 v38, v38, v36
    v_mov_b32 v36, 135200
    v_readfirstlane_b32 s57, v38
    ds_write_b32 v36, v38
    s_mul_i32 s86, s50, 3072
    s_add_u32 s86, s86, 151552
    v_lshl_add_u32 v7, v0, 4, s86
    s_lshl_b32 s86, s49, 10
    v_add_u32 v5, s86, v7
    s_lshl_b32 s86, s49, 3
    v_add_u32 v7, s86, v7
    s_mov_b32 s88, 0xffff0000
    s_mov_b32 s86, 0x00003f80
    s_mov_b32 s87, 0x3f800000
    s_branch L_h1_w0
L_h1_r0:
    s_ff1_i32_b32 s66, s65
    s_bitset0_b32 s65, s66
    s_lshl_b32 s66, s66, 10
    buffer_load_dwordx4 v[40:43], v2, s[16:19], s66 offen sc1
    s_cmp_eq_u32 s65, 0
    s_cbranch_scc1 L_h1_p1
L_h1_r1:
    s_ff1_i32_b32 s66, s65
    s_bitset0_b32 s65, s66
    s_lshl_b32 s66, s66, 10
    buffer_load_dwordx4 v[44:47], v2, s[16:19], s66 offen sc1
    s_cmp_eq_u32 s65, 0
    s_cbranch_scc1 L_h1_p2
L_h1_r2:
    s_ff1_i32_b32 s66, s65
    s_bitset0_b32 s65, s66
    s_lshl_b32 s66, s66, 10
    buffer_load_dwordx4 v[48:51], v2, s[16:19], s66 offen sc1
    s_cmp_eq_u32 s65, 0
    s_cbranch_scc1 L_h1_p3
L_h1_r3:
    s_ff1_i32_b32 s66, s65
    s_bitset0_b32 s65, s66
    s_lshl_b32 s66, s66, 10
    buffer_load_dwordx4 v[52:55], v2, s[16:19], s66 offen sc1
    s_cmp_eq_u32 s65, 0
    s_cbranch_scc1 L_h1_p4
L_h1_r4:
    s_ff1_i32_b32 s66, s65
    s_bitset0_b32 s65, s66
    s_lshl_b32 s66, s66, 10
    buffer_load_dwordx4 v[56:59], v2, s[16:19], s66 offen sc1
    s_cmp_eq_u32 s65, 0
    s_cbranch_scc1 L_h1_p5
L_h1_r5:
    s_ff1_i32_b32 s66, s65
    s_bitset0_b32 s65, s66
    s_lshl_b32 s66, s66, 10
    buffer_load_dwordx4 v[60:63], v2, s[16:19], s66 offen sc1
    s_cmp_eq_u32 s65, 0
    s_cbranch_scc1 L_h1_p6
L_h1_r6:
    s_ff1_i32_b32 s66, s65
    s_bitset0_b32 s65, s66
    s_lshl_b32 s66, s66, 10
    buffer_load_dwordx4 v[64:67], v2, s[16:19], s66 offen sc1
    s_cmp_eq_u32 s65, 0
    s_cbranch_scc1 L_h1_p7
L_h1_r7:
    s_ff1_i32_b32 s66, s65
    s_bitset0_b32 s65, s66
    s_lshl_b32 s66, s66, 10
    buffer_load_dwordx4 v[68:71], v2, s[16:19], s66 offen sc1
    s_cmp_eq_u32 s65, 0
    s_cbranch_scc1 L_h1_p8
L_h1_r8:
    s_ff1_i32_b32 s66, s65
    s_bitset0_b32 s65, s66
    s_lshl_b32 s66, s66, 10
    buffer_load_dwordx4 v[72:75], v2, s[16:19], s66 offen sc1
    s_cmp_eq_u32 s65, 0
    s_cbranch_scc1 L_h1_p9
L_h1_r9:
    s_ff1_i32_b32 s66, s65
    s_bitset0_b32 s65, s66
    s_lshl_b32 s66, s66, 10
    buffer_load_dwordx4 v[76:79], v2, s[16:19], s66 offen sc1
    s_cmp_eq_u32 s65, 0
    s_cbranch_scc1 L_h1_p10
L_h1_r10:
    s_ff1_i32_b32 s66, s65
    s_bitset0_b32 s65, s66
    s_lshl_b32 s66, s66, 10
    buffer_load_dwordx4 v[80:83], v2, s[16:19], s66 offen sc1
    s_cmp_eq_u32 s65, 0
    s_cbranch_scc1 L_h1_p11
L_h1_r11:
    s_ff1_i32_b32 s66, s65
    s_bitset0_b32 s65, s66
    s_lshl_b32 s66, s66, 10
    buffer_load_dwordx4 v[84:87], v2, s[16:19], s66 offen sc1
    s_cmp_eq_u32 s65, 0
    s_cbranch_scc1 L_h1_p12
L_h1_r12:
    s_ff1_i32_b32 s66, s65
    s_bitset0_b32 s65, s66
    s_lshl_b32 s66, s66, 10
    buffer_load_dwordx4 v[88:91], v2, s[16:19], s66 offen sc1
    s_cmp_eq_u32 s65, 0
    s_cbranch_scc1 L_h1_p13
L_h1_r13:
    s_ff1_i32_b32 s66, s65
    s_bitset0_b32 s65, s66
    s_lshl_b32 s66, s66, 10
    buffer_load_dwordx4 v[92:95], v2, s[16:19], s66 offen sc1
    s_cmp_eq_u32 s65, 0
    s_cbranch_scc1 L_h1_p14
L_h1_r14:
    s_ff1_i32_b32 s66, s65
    s_bitset0_b32 s65, s66
    s_lshl_b32 s66, s66, 10
    buffer_load_dwordx4 v[96:99], v2, s[16:19], s66 offen sc1
    s_cmp_eq_u32 s65, 0
    s_cbranch_scc1 L_h1_p15
L_h1_r15:
    s_ff1_i32_b32 s66, s65
    s_bitset0_b32 s65, s66
    s_lshl_b32 s66, s66, 10
    buffer_load_dwordx4 v[100:103], v2, s[16:19], s66 offen sc1
    buffer_load_dwordx4 v[104:107], v3, s[16:19], 0 offen sc1
L_h1_acc:
    s_waitcnt vmcnt(16)
    v_dot2c_f32_bf16 v112, s86, v40
    v_dot2c_f32_bf16 v113, s87, v40
    v_dot2c_f32_bf16 v114, s86, v41
    v_dot2c_f32_bf16 v115, s87, v41
    v_dot2c_f32_bf16 v116, s86, v42
    v_dot2c_f32_bf16 v117, s87, v42
    v_dot2c_f32_bf16 v118, s86, v43
    v_dot2c_f32_bf16 v119, s87, v43
    s_waitcnt vmcnt(15)
    v_dot2c_f32_bf16 v112, s86, v44
    v_dot2c_f32_bf16 v113, s87, v44
    v_dot2c_f32_bf16 v114, s86, v45
    v_dot2c_f32_bf16 v115, s87, v45
    v_dot2c_f32_bf16 v116, s86, v46
    v_dot2c_f32_bf16 v117, s87, v46
    v_dot2c_f32_bf16 v118, s86, v47
    v_dot2c_f32_bf16 v119, s87, v47
    s_waitcnt vmcnt(14)
    v_dot2c_f32_bf16 v112, s86, v48
    v_dot2c_f32_bf16 v113, s87, v48
    v_dot2c_f32_bf16 v114, s86, v49
    v_dot2c_f32_bf16 v115, s87, v49
    v_dot2c_f32_bf16 v116, s86, v50
    v_dot2c_f32_bf16 v117, s87, v50
    v_dot2c_f32_bf16 v118, s86, v51
    v_dot2c_f32_bf16 v119, s87, v51
    v_max3_u32 v4, v43, v47, v51
    s_waitcnt vmcnt(13)
    v_dot2c_f32_bf16 v112, s86, v52
    v_dot2c_f32_bf16 v113, s87, v52
    v_dot2c_f32_bf16 v114, s86, v53
    v_dot2c_f32_bf16 v115, s87, v53
    v_dot2c_f32_bf16 v116, s86, v54
    v_dot2c_f32_bf16 v117, s87, v54
    v_dot2c_f32_bf16 v118, s86, v55
    v_dot2c_f32_bf16 v119, s87, v55
    s_waitcnt vmcnt(12)
    v_dot2c_f32_bf16 v112, s86, v56
    v_dot2c_f32_bf16 v113, s87, v56
    v_dot2c_f32_bf16 v114, s86, v57
    v_dot2c_f32_bf16 v115, s87, v57
    v_dot2c_f32_bf16 v116, s86, v58
    v_dot2c_f32_bf16 v117, s87, v58
    v_dot2c_f32_bf16 v118, s86, v59
    v_dot2c_f32_bf16 v119, s87, v59
    v_max3_u32 v4, v4, v55, v59
L_walk_7:
    s_cbranch_execz L_walk_14
    s_waitcnt vmcnt(11)
    v_dot2c_f32_bf16 v112, s86, v60
    v_dot2c_f32_bf16 v113, s87, v60
    v_dot2c_f32_bf16 v114, s86, v61
    v_dot2c_f32_bf16 v115, s87, v61
    v_dot2c_f32_bf16 v116, s86, v62
    v_dot2c_f32_bf16 v117, s87, v62
    v_dot2c_f32_bf16 v118, s86, v63
    v_dot2c_f32_bf16 v119, s87, v63
    s_waitcnt vmcnt(10)
    v_dot2c_f32_bf16 v112, s86, v64
    v_dot2c_f32_bf16 v113, s87, v64
    v_dot2c_f32_bf16 v114, s86, v65
    v_dot2c_f32_bf16 v115, s87, v65
    v_dot2c_f32_bf16 v116, s86, v66
    v_dot2c_f32_bf16 v117, s87, v66
    v_dot2c_f32_bf16 v118, s86, v67
    v_dot2c_f32_bf16 v119, s87, v67
    v_max3_u32 v4, v4, v63, v67
    s_waitcnt vmcnt(9)
    v_dot2c_f32_bf16 v112, s86, v68
    v_dot2c_f32_bf16 v113, s87, v68
    v_dot2c_f32_bf16 v114, s86, v69
    v_dot2c_f32_bf16 v115, s87, v69
    v_dot2c_f32_bf16 v116, s86, v70
    v_dot2c_f32_bf16 v117, s87, v70
    v_dot2c_f32_bf16 v118, s86, v71
    v_dot2c_f32_bf16 v119, s87, v71
    s_waitcnt vmcnt(8)
    v_dot2c_f32_bf16 v112, s86, v72
    v_dot2c_f32_bf16 v113, s87, v72
    v_dot2c_f32_bf16 v114, s86, v73
    v_dot2c_f32_bf16 v115, s87, v73
    v_dot2c_f32_bf16 v116, s86, v74
    v_dot2c_f32_bf16 v117, s87, v74
    v_dot2c_f32_bf16 v118, s86, v75
    v_dot2c_f32_bf16 v119, s87, v75
    v_max3_u32 v4, v4, v71, v75
    s_waitcnt vmcnt(7)
    v_dot2c_f32_bf16 v112, s86, v76
    v_dot2c_f32_bf16 v113, s87, v76
    v_dot2c_f32_bf16 v114, s86, v77
    v_dot2c_f32_bf16 v115, s87, v77
    v_dot2c_f32_bf16 v116, s86, v78
    v_dot2c_f32_bf16 v117, s87, v78
    v_dot2c_f32_bf16 v118, s86, v79
    v_dot2c_f32_bf16 v119, s87, v79
    s_waitcnt vmcnt(6)
    v_dot2c_f32_bf16 v112, s86, v80
    v_dot2c_f32_bf16 v113, s87, v80
    v_dot2c_f32_bf16 v114, s86, v81
    v_dot2c_f32_bf16 v115, s87, v81
    v_dot2c_f32_bf16 v116, s86, v82
    v_dot2c_f32_bf16 v117, s87, v82
    v_dot2c_f32_bf16 v118, s86, v83
    v_dot2c_f32_bf16 v119, s87, v83
    v_max3_u32 v4, v4, v79, v83
    s_waitcnt vmcnt(5)
    v_dot2c_f32_bf16 v112, s86, v84
    v_dot2c_f32_bf16 v113, s87, v84
    v_dot2c_f32_bf16 v114, s86, v85
    v_dot2c_f32_bf16 v115, s87, v85
    v_dot2c_f32_bf16 v116, s86, v86
    v_dot2c_f32_bf16 v117, s87, v86
    v_dot2c_f32_bf16 v118, s86, v87
    v_dot2c_f32_bf16 v119, s87, v87
    s_waitcnt vmcnt(4)
    v_dot2c_f32_bf16 v112, s86, v88
    v_dot2c_f32_bf16 v113, s87, v88
    v_dot2c_f32_bf16 v114, s86, v89
    v_dot2c_f32_bf16 v115, s87, v89
    v_dot2c_f32_bf16 v116, s86, v90
    v_dot2c_f32_bf16 v117, s87, v90
    v_dot2c_f32_bf16 v118, s86, v91
    v_dot2c_f32_bf16 v119, s87, v91
    v_max3_u32 v4, v4, v87, v91
    s_waitcnt vmcnt(3)
    v_dot2c_f32_bf16 v112, s86, v92
    v_dot2c_f32_bf16 v113, s87, v92
    v_dot2c_f32_bf16 v114, s86, v93
    v_dot2c_f32_bf16 v115, s87, v93
    v_dot2c_f32_bf16 v116, s86, v94
    v_dot2c_f32_bf16 v117, s87, v94
    v_dot2c_f32_bf16 v118, s86, v95
    v_dot2c_f32_bf16 v119, s87, v95
    s_waitcnt vmcnt(2)
    v_dot2c_f32_bf16 v112, s86, v96
    v_dot2c_f32_bf16 v113, s87, v96
    v_dot2c_f32_bf16 v114, s86, v97
    v_dot2c_f32_bf16 v115, s87, v97
    v_dot2c_f32_bf16 v116, s86, v98
    v_dot2c_f32_bf16 v117, s87, v98
    v_dot2c_f32_bf16 v118, s86, v99
    v_dot2c_f32_bf16 v119, s87, v99
    v_max3_u32 v4, v4, v95, v99
    s_waitcnt vmcnt(1)
    v_dot2c_f32_bf16 v112, s86, v100
    v_dot2c_f32_bf16 v113, s87, v100
    v_dot2c_f32_bf16 v114, s86, v101
    v_dot2c_f32_bf16 v115, s87, v101
    v_dot2c_f32_bf16 v116, s86, v102
    v_dot2c_f32_bf16 v117, s87, v102
    v_dot2c_f32_bf16 v118, s86, v103
    v_dot2c_f32_bf16 v119, s87, v103
    s_waitcnt vmcnt(0)
    v_max3_u32 v4, v4, v103, v107
    v_add_f32_dpp v104, v104, v104 row_ror:8 row_mask:0xf bank_mask:0xf
    v_add_f32_dpp v105, v105, v105 row_ror:8 row_mask:0xf bank_mask:0xf
    v_add_f32_dpp v106, v106, v106 row_ror:8 row_mask:0xf bank_mask:0xf
    v_add_f32_dpp v107, v107, v107 row_ror:8 row_mask:0xf bank_mask:0xf
    v_cvt_pk_bf16_f32 v120, v112, v113
    v_cvt_pk_bf16_f32 v121, v114, v115
    v_cvt_pk_bf16_f32 v122, v116, v117
    v_cvt_pk_bf16_f32 v123, v118, v119
    ds_write_b128 v5, v[120:123]
    v_add_f32_dpp v104, v104, v104 row_ror:4 row_mask:0xf bank_mask:0xf
    v_add_f32_dpp v105, v105, v105 row_ror:4 row_mask:0xf bank_mask:0xf
    v_add_f32_dpp v106, v106, v106 row_ror:4 row_mask:0xf bank_mask:0xf
    v_add_f32_dpp v107, v107, v107 row_ror:4 row_mask:0xf bank_mask:0xf
    v_add_f32_dpp v104, v104, v104 row_ror:2 row_mask:0xf bank_mask:0xf
    v_add_f32_dpp v105, v105, v105 row_ror:2 row_mask:0xf bank_mask:0xf
    v_add_f32_dpp v106, v106, v106 row_ror:2 row_mask:0xf bank_mask:0xf
    v_add_f32_dpp v107, v107, v107 row_ror:2 row_mask:0xf bank_mask:0xf
    v_add_f32_dpp v104, v104, v104 row_ror:1 row_mask:0xf bank_mask:0xf
    v_add_f32_dpp v105, v105, v105 row_ror:1 row_mask:0xf bank_mask:0xf
    v_add_f32_dpp v106, v106, v106 row_ror:1 row_mask:0xf bank_mask:0xf
    v_add_f32_dpp v107, v107, v107 row_ror:1 row_mask:0xf bank_mask:0xf
    v_cmp_eq_u32 vcc, -1, v4
    v_cvt_pk_bf16_f32 v124, v104, v105
    v_cvt_pk_bf16_f32 v125, v106, v107
    ds_write_b64 v7, v[124:125] offset:2048
    s_cbranch_vccnz L_h1_again
L_h1_done:
    s_waitcnt lgkmcnt(0)
    s_barrier
    s_or_b32 s86, s2, s48
    s_cmp_eq_u32 s86, 0
    s_cselect_b32 s86, 0, 2147483648
    s_add_u32 s86, s86, 524288
    v_mov_b32 v6, s86
    buffer_store_dword v35, v6, s[16:19], 0 offen sc1
    v_mov_b32 v11, v30
    v_mov_b32 v14, v31
    v_mov_b32 v8, 0
    buffer_atomic_or v8, v159, s[16:19], 0 offen sc0 sc1
    s_branch L_phaseB
L_h1_p0:
    v_mov_b32 v4, 0
    buffer_atomic_or v4, v6, s[16:19], 0 offen sc0 sc1
L_h1_w0:
    s_waitcnt vmcnt(0)
    v_cmp_eq_u32 vcc, s68, v4
    s_nop 0
    s_andn2_b32 s65, vcc_lo, s88
    s_or_b32 s88, s88, s65
    s_cmp_lg_u32 s65, 0
    s_cbranch_scc1 L_h1_r0
    s_sub_u32 s56, s56, 1
    s_cbranch_scc0 L_h1_p0
    s_mov_b32 s56, 0
    s_not_b32 s65, s88
    s_branch L_h1_r0
L_h1_p1:
    v_mov_b32 v4, 0
    buffer_atomic_or v4, v6, s[16:19], 0 offen sc0 sc1
    s_waitcnt vmcnt(0)
    v_cmp_eq_u32 vcc, s68, v4
    s_nop 0
    s_andn2_b32 s65, vcc_lo, s88
    s_or_b32 s88, s88, s65
    s_cmp_lg_u32 s65, 0
    s_cbranch_scc1 L_h1_r1
    s_sub_u32 s56, s56, 1
    s_cbranch_scc0 L_h1_p1
    s_mov_b32 s56, 0
    s_not_b32 s65, s88
    s_branch L_h1_r1
L_h1_p2:
    v_mov_b32 v4, 0
    buffer_atomic_or v4, v6, s[16:19], 0 offen sc0 sc1
    s_waitcnt vmcnt(0)
    v_cmp_eq_u32 vcc, s68, v4
    s_nop 0
    s_andn2_b32 s65, vcc_lo, s88
    s_or_b32 s88, s88, s65
    s_cmp_lg_u32 s65, 0
    s_cbranch_scc1 L_h1_r2
    s_sub_u32 s56, s56, 1
    s_cbranch_scc0 L_h1_p2
    s_mov_b32 s56, 0
    s_not_b32 s65, s88
    s_branch L_h1_r2
L_h1_p3:
    v_mov_b32 v4, 0
    buffer_atomic_or v4, v6, s[16:19], 0 offen sc0 sc1
    s_waitcnt vmcnt(0)
    v_cmp_eq_u32 vcc, s68, v4
    s_nop 0
    s_andn2_b32 s65, vcc_lo, s88
    s_or_b32 s88, s88, s65
    s_cmp_lg_u32 s65, 0
    s_cbranch_scc1 L_h1_r3
    s_sub_u32 s56, s56, 1
    s_cbranch_scc0 L_h1_p3
    s_mov_b32 s56, 0
    s_not_b32 s65, s88
    s_branch L_h1_r3
L_h1_p4:
    v_mov_b32 v4, 0
    buffer_atomic_or v4, v6, s[16:19], 0 offen sc0 sc1
    s_waitcnt vmcnt(0)
    v_cmp_eq_u32 vcc, s68, v4
    s_nop 0
    s_andn2_b32 s65, vcc_lo, s88
    s_or_b32 s88, s88, s65
    s_cmp_lg_u32 s65, 0
    s_cbranch_scc1 L_h1_r4
    s_sub_u32 s56, s56, 1
    s_cbranch_scc0 L_h1_p4
    s_mov_b32 s56, 0
    s_not_b32 s65, s88
    s_branch L_h1_r4
L_h1_p5:
    v_mov_b32 v4, 0
    buffer_atomic_or v4, v6, s[16:19], 0 offen sc0 sc1
    s_waitcnt vmcnt(0)
    v_cmp_eq_u32 vcc, s68, v4
    s_nop 0
    s_andn2_b32 s65, vcc_lo, s88
    s_or_b32 s88, s88, s65
    s_cmp_lg_u32 s65, 0
    s_cbranch_scc1 L_h1_r5
    s_sub_u32 s56, s56, 1
    s_cbranch_scc0 L_h1_p5
    s_mov_b32 s56, 0
    s_not_b32 s65, s88
    s_branch L_h1_r5
L_walk_8:
    s_cbranch_execz L_walk_15
L_h1_p6:
    v_mov_b32 v4, 0
    buffer_atomic_or v4, v6, s[16:19], 0 offen sc0 sc1
    s_waitcnt vmcnt(0)
    v_cmp_eq_u32 vcc, s68, v4
    s_nop 0
    s_andn2_b32 s65, vcc_lo, s88
    s_or_b32 s88, s88, s65
    s_cmp_lg_u32 s65, 0
    s_cbranch_scc1 L_h1_r6
    s_sub_u32 s56, s56, 1
    s_cbranch_scc0 L_h1_p6
    s_mov_b32 s56, 0
    s_not_b32 s65, s88
    s_branch L_h1_r6
L_h1_p7:
    v_mov_b32 v4, 0
    buffer_atomic_or v4, v6, s[16:19], 0 offen sc0 sc1
    s_waitcnt vmcnt(0)
    v_cmp_eq_u32 vcc, s68, v4
    s_nop 0
    s_andn2_b32 s65, vcc_lo, s88
    s_or_b32 s88, s88, s65
    s_cmp_lg_u32 s65, 0
    s_cbranch_scc1 L_h1_r7
    s_sub_u32 s56, s56, 1
    s_cbranch_scc0 L_h1_p7
    s_mov_b32 s56, 0
    s_not_b32 s65, s88
    s_branch L_h1_r7
L_h1_p8:
    v_mov_b32 v4, 0
    buffer_atomic_or v4, v6, s[16:19], 0 offen sc0 sc1
    s_waitcnt vmcnt(0)
    v_cmp_eq_u32 vcc, s68, v4
    s_nop 0
    s_andn2_b32 s65, vcc_lo, s88
    s_or_b32 s88, s88, s65
    s_cmp_lg_u32 s65, 0
    s_cbranch_scc1 L_h1_r8
    s_sub_u32 s56, s56, 1
    s_cbranch_scc0 L_h1_p8
    s_mov_b32 s56, 0
    s_not_b32 s65, s88
    s_branch L_h1_r8
L_h1_p9:
    v_mov_b32 v4, 0
    buffer_atomic_or v4, v6, s[16:19], 0 offen sc0 sc1
    s_waitcnt vmcnt(0)
    v_cmp_eq_u32 vcc, s68, v4
    s_nop 0
    s_andn2_b32 s65, vcc_lo, s88
    s_or_b32 s88, s88, s65
    s_cmp_lg_u32 s65, 0
    s_cbranch_scc1 L_h1_r9
    s_sub_u32 s56, s56, 1
    s_cbranch_scc0 L_h1_p9
    s_mov_b32 s56, 0
    s_not_b32 s65, s88
    s_branch L_h1_r9
L_h1_p10:
    v_mov_b32 v4, 0
    buffer_atomic_or v4, v6, s[16:19], 0 offen sc0 sc1
    s_waitcnt vmcnt(0)
    v_cmp_eq_u32 vcc, s68, v4
    s_nop 0
    s_andn2_b32 s65, vcc_lo, s88
    s_or_b32 s88, s88, s65
    s_cmp_lg_u32 s65, 0
    s_cbranch_scc1 L_h1_r10
    s_sub_u32 s56, s56, 1
    s_cbranch_scc0 L_h1_p10
    s_mov_b32 s56, 0
    s_not_b32 s65, s88
    s_branch L_h1_r10
L_h1_p11:
    v_mov_b32 v4, 0
    buffer_atomic_or v4, v6, s[16:19], 0 offen sc0 sc1
    s_waitcnt vmcnt(0)
    v_cmp_eq_u32 vcc, s68, v4
    s_nop 0
    s_andn2_b32 s65, vcc_lo, s88
    s_or_b32 s88, s88, s65
    s_cmp_lg_u32 s65, 0
    s_cbranch_scc1 L_h1_r11
    s_sub_u32 s56, s56, 1
    s_cbranch_scc0 L_h1_p11
    s_mov_b32 s56, 0
    s_not_b32 s65, s88
    s_branch L_h1_r11
L_h1_p12:
    v_mov_b32 v4, 0
    buffer_atomic_or v4, v6, s[16:19], 0 offen sc0 sc1
    s_waitcnt vmcnt(0)
    v_cmp_eq_u32 vcc, s68, v4
    s_nop 0
    s_andn2_b32 s65, vcc_lo, s88
    s_or_b32 s88, s88, s65
    s_cmp_lg_u32 s65, 0
    s_cbranch_scc1 L_h1_r12
    s_sub_u32 s56, s56, 1
    s_cbranch_scc0 L_h1_p12
    s_mov_b32 s56, 0
    s_not_b32 s65, s88
    s_branch L_h1_r12
L_h1_p13:
    v_mov_b32 v4, 0
    buffer_atomic_or v4, v6, s[16:19], 0 offen sc0 sc1
    s_waitcnt vmcnt(0)
    v_cmp_eq_u32 vcc, s68, v4
    s_nop 0
    s_andn2_b32 s65, vcc_lo, s88
    s_or_b32 s88, s88, s65
    s_cmp_lg_u32 s65, 0
    s_cbranch_scc1 L_h1_r13
    s_sub_u32 s56, s56, 1
    s_cbranch_scc0 L_h1_p13
    s_mov_b32 s56, 0
    s_not_b32 s65, s88
    s_branch L_h1_r13
L_h1_p14:
    v_mov_b32 v4, 0
    buffer_atomic_or v4, v6, s[16:19], 0 offen sc0 sc1
    s_waitcnt vmcnt(0)
    v_cmp_eq_u32 vcc, s68, v4
    s_nop 0
    s_andn2_b32 s65, vcc_lo, s88
    s_or_b32 s88, s88, s65
    s_cmp_lg_u32 s65, 0
    s_cbranch_scc1 L_h1_r14
    s_sub_u32 s56, s56, 1
    s_cbranch_scc0 L_h1_p14
    s_mov_b32 s56, 0
    s_not_b32 s65, s88
    s_branch L_h1_r14
L_h1_p15:
    v_mov_b32 v4, 0
    buffer_atomic_or v4, v6, s[16:19], 0 offen sc0 sc1
    s_waitcnt vmcnt(0)
    v_cmp_eq_u32 vcc, s68, v4
    s_nop 0
    s_andn2_b32 s65, vcc_lo, s88
    s_or_b32 s88, s88, s65
    s_cmp_lg_u32 s65, 0
    s_cbranch_scc1 L_h1_r15
    s_sub_u32 s56, s56, 1
    s_cbranch_scc0 L_h1_p15
    s_mov_b32 s56, 0
    s_not_b32 s65, s88
    s_branch L_h1_r15
L_h1_again:
    s_sub_u32 s56, s56, 1
    s_cbranch_scc0 L_h1_re
    s_mov_b32 s56, 0
    s_branch L_h1_done
L_h1_re:
    buffer_load_dwordx4 v[40:43], v2, s[16:19], 0 offen offset:0 sc1
    buffer_load_dwordx4 v[44:47], v2, s[16:19], 0 offen offset:1024 sc1
    buffer_load_dwordx4 v[48:51], v2, s[16:19], 0 offen offset:2048 sc1
    buffer_load_dwordx4 v[52:55], v2, s[16:19], 0 offen offset:3072 sc1
    buffer_load_dwordx4 v[56:59], v2, s[16:19], s92 offen offset:0 sc1
    buffer_load_dwordx4 v[60:63], v2, s[16:19], s92 offen offset:1024 sc1
    buffer_load_dwordx4 v[64:67], v2, s[16:19], s92 offen offset:2048 sc1
    buffer_load_dwordx4 v[68:71], v2, s[16:19], s92 offen offset:3072 sc1
    buffer_load_dwordx4 v[72:75], v2, s[16:19], s93 offen offset:0 sc1
    buffer_load_dwordx4 v[76:79], v2, s[16:19], s93 offen offset:1024 sc1
    buffer_load_dwordx4 v[80:83], v2, s[16:19], s93 offen offset:2048 sc1
    buffer_load_dwordx4 v[84:87], v2, s[16:19], s93 offen offset:3072 sc1
    buffer_load_dwordx4 v[88:91], v2, s[16:19], s94 offen offset:0 sc1
    buffer_load_dwordx4 v[92:95], v2, s[16:19], s94 offen offset:1024 sc1
    buffer_load_dwordx4 v[96:99], v2, s[16:19], s94 offen offset:2048 sc1
    buffer_load_dwordx4 v[100:103], v2, s[16:19], s94 offen offset:3072 sc1
    buffer_load_dwordx4 v[104:107], v3, s[16:19], 0 offen sc1
    v_mov_b32 v112, 0
    v_mov_b32 v113, 0
    v_mov_b32 v114, 0
    v_mov_b32 v115, 0
    v_mov_b32 v116, 0
    v_mov_b32 v117, 0
    v_mov_b32 v118, 0
    v_mov_b32 v119, 0
    s_branch L_h1_acc
L_comp:
    s_mov_b64 exec, -1
    v_and_b32 v20, 15, v0
    v_lshrrev_b32 v21, 4, v0
    v_bfe_u32 v22, v0, 1, 3
    s_lshl_b32 s86, s49, 13
    v_lshl_add_u32 v20, v20, 7, s86
    v_or_b32 v23, 0, v21
    v_xor_b32 v23, v23, v22
    v_lshl_add_u32 v2, v23, 4, v20
    v_or_b32 v23, 4, v21
    v_xor_b32 v23, v23, v22
    v_lshl_add_u32 v3, v23, 4, v20
    v_bfe_u32 v22, v0, 2, 2
    v_lshl_add_u32 v22, v21, 3, v22
    v_lshlrev_b32 v22, 7, v22
    v_bfe_u32 v23, v0, 3, 2
    s_lshl_b32 s86, s50, 1
    v_xor_b32 v23, s86, v23
    v_lshl_add_u32 v22, v23, 5, v22
    v_and_b32 v23, 3, v0
    v_lshl_add_u32 v22, v23, 3, v22
    v_add_u32 v4, 16384, v22
    v_xor_b32 v5, 32, v4
    s_lshl_b32 s53, s2, 2
    s_add_u32 s53, s53, s3
    s_lshl_b32 s86, s53, 12
    s_add_u32 s86, s86, 1048576
    v_lshl_add_u32 v6, v0, 4, s86
    s_mul_i32 s53, s53, 160
    s_add_u32 s53, s53, 6553600
    v_lshl_add_u32 v17, v0, 4, s53
    v_mov_b32 v16, 2147483648
    v_cmp_gt_u32 vcc, 10, v0
    s_nop 1
    v_cndmask_b32 v17, v16, v17, vcc
    s_lshl2_add_u32 s86, s45, s3
    s_lshr_b32 s87, s86, 3
    s_mul_i32 s87, s87, 14336
    s_and_b32 s86, s86, 7
    s_lshl3_add_u32 s86, s44, s86
    s_mul_i32 s86, s86, 224
    s_add_u32 s86, s86, s87
    s_add_u32 s86, s86, 7864064
    v_lshl_add_u32 v16, v0, 4, s86
    s_mov_b32 vcc_lo, 0x3fff0000
    s_mov_b32 vcc_hi, 0
    v_cndmask_b32 v17, v17, v16, vcc
    s_lshl_b32 s86, s47, 1
    s_add_u32 s86, s86, s50
    s_lshl_b32 s87, s86, 4
    s_add_u32 s87, s87, s46
    s_lshl_b32 s87, s87, 1
    s_add_u32 s87, s87, s49
    s_lshl_b32 s87, s87, 6
    s_add_u32 s87, s87, 6880320
    v_lshl_add_u32 v16, v0, 4, s87
    v_cmp_le_u32 vcc, 60, v0
    s_nop 1
    v_cndmask_b32 v17, v17, v16, vcc
    s_lshl_b32 s87, s86, 1
    s_add_u32 s87, s87, s49
    s_lshl_b32 s87, s87, 4
    s_add_u32 s87, s87, s46
    s_lshl_b32 s87, s87, 10
    s_add_u32 s87, s87, 5242880
    v_lshl_add_u32 v16, v0, 4, s87
    v_mov_b32 v8, -1
    v_mov_b32 v9, -1
    v_mov_b32 v10, -1
    v_mov_b32 v11, -1
    s_waitcnt lgkmcnt(0)
    s_load_dword s61, s[84:85], 524288
    s_mov_b32 s16, s84
    s_and_b32 s17, s85, 0xffff
    s_mov_b32 s18, 268435456
    s_mov_b32 s19, 0x20000
    s_mov_b32 s8, s64
    s_and_b32 s9, s65, 0xffff
    s_mov_b32 s10, 4194304
    s_mov_b32 s11, 0x20000
    s_mov_b32 s20, s68
    s_and_b32 s21, s69, 0xffff
    s_mov_b32 s22, 2097152
    s_mov_b32 s23, 0x20000
    s_mov_b32 s24, s80
    s_and_b32 s25, s81, 0xffff
    s_mov_b32 s26, 4194304
    s_mov_b32 s27, 0x20000
    s_mov_b32 s28, s82
    s_and_b32 s29, s83, 0xffff
    s_mov_b32 s30, 256
    s_mov_b32 s31, 0x20000
    s_bitcmp1_b32 s2, 3
    s_cselect_b32 s32, s76, s74
    s_cselect_b32 s33, s77, s75
    s_and_b32 s33, s33, 0xffff
    s_mov_b32 s34, 7340032
    s_mov_b32 s35, 0x20000
    s_mov_b32 s36, s78
    s_and_b32 s37, s79, 0xffff
    s_mov_b32 s38, 7340032
    s_mov_b32 s39, 0x20000
    s_mov_b32 s40, s72
    s_and_b32 s41, s73, 0xffff
    s_mov_b32 s42, 2048
    s_mov_b32 s43, 0x20000
    s_lshl_b32 s82, s44, 5
    s_or_b32 s82, s82, s45
    s_lshl_b32 s86, s2, 9
    s_add_u32 s86, s86, 786432
    s_cmp_eq_u32 s3, 0
    s_cselect_b32 s86, s86, 2147483648
    v_lshl_add_u32 v7, v0, 2, s86
    v_mul_u32_u24 v12, 192, v21
    v_add_u32 v7, v7, v12
    s_lshl_b32 s86, s2, 8
    s_add_u32 s86, s86, 917376
    s_cmp_eq_u32 s3, 0
    s_cselect_b32 s86, s86, 2147483648
    v_lshl_add_u32 v12, v0, 2, s86
    v_cmp_gt_u32 vcc, 32, v0
    s_nop 1
    v_cndmask_b32 v7, v12, v7, vcc
    v_mov_b32 v12, 2147483648
    v_cmp_gt_u32 vcc, 48, v0
    s_nop 1
    v_cndmask_b32 v7, v12, v7, vcc
    s_lshl_b32 s86, s2, 9
    s_add_u32 s86, s86, 6291456
    v_lshl_add_u32 v13, v0, 2, s86
    v_mul_u32_u24 v12, 64, v21
    v_add_u32 v13, v13, v12
    s_cmp_eq_u32 s3, 1
    s_cselect_b64 vcc, -1, 0
    v_cndmask_b32 v7, v7, v13, vcc
    v_mov_b32 v12, 0
    buffer_store_dword v12, v7, s[16:19], 0 offen sc1
    v_mov_b32 v128, 0
    v_mov_b32 v129, 0
    v_mov_b32 v130, 0
    v_mov_b32 v131, 0
    v_mov_b32 v132, 0
    v_mov_b32 v133, 0
    v_mov_b32 v134, 0
    v_mov_b32 v135, 0
    v_mov_b32 v136, 0
    v_mov_b32 v137, 0
    v_mov_b32 v138, 0
    v_mov_b32 v139, 0
    v_mov_b32 v140, 0
    v_mov_b32 v141, 0
    v_mov_b32 v142, 0
    v_mov_b32 v143, 0
    v_mov_b32 v144, 0
    v_mov_b32 v145, 0
    v_mov_b32 v146, 0
    v_mov_b32 v147, 0
    v_mov_b32 v148, 0
    v_mov_b32 v149, 0
    v_mov_b32 v150, 0
    v_mov_b32 v151, 0
    v_mov_b32 v152, 0
    v_mov_b32 v153, 0
    v_mov_b32 v154, 0
    v_mov_b32 v155, 0
    v_mov_b32 v156, 0
    v_mov_b32 v157, 0
    v_mov_b32 v158, 0
    v_mov_b32 v159, 0
    v_mov_b32 v160, 0
    v_mov_b32 v161, 0
    v_mov_b32 v162, 0
    v_mov_b32 v163, 0
    v_mov_b32 v164, 0
    v_mov_b32 v165, 0
    v_mov_b32 v166, 0
    v_mov_b32 v167, 0
    v_mov_b32 v168, 0
    v_mov_b32 v169, 0
    v_mov_b32 v170, 0
    v_mov_b32 v171, 0
    v_mov_b32 v172, 0
    v_mov_b32 v173, 0
    v_mov_b32 v174, 0
    v_mov_b32 v175, 0
    v_mov_b32 v176, 0
    v_mov_b32 v177, 0
    v_mov_b32 v178, 0
    v_mov_b32 v179, 0
    v_mov_b32 v180, 0
    v_mov_b32 v181, 0
    v_mov_b32 v182, 0
    v_mov_b32 v183, 0
    v_mov_b32 v184, 0
    v_mov_b32 v185, 0
    v_mov_b32 v186, 0
    v_mov_b32 v187, 0
    v_mov_b32 v188, 0
    v_mov_b32 v189, 0
L_walkA2:
    s_cbranch_execz L_comp
    v_mov_b32 v190, 0
    v_mov_b32 v191, 0
    v_mov_b32 v192, 0
    v_mov_b32 v193, 0
    v_mov_b32 v194, 0
    v_mov_b32 v195, 0
    v_mov_b32 v196, 0
    v_mov_b32 v197, 0
    v_mov_b32 v198, 0
    v_mov_b32 v199, 0
    v_mov_b32 v200, 0
    v_mov_b32 v201, 0
    v_mov_b32 v202, 0
    v_mov_b32 v203, 0
    v_mov_b32 v204, 0
    v_mov_b32 v205, 0
    v_mov_b32 v206, 0
    v_mov_b32 v207, 0
    v_mov_b32 v208, 0
    v_mov_b32 v209, 0
    v_mov_b32 v210, 0
    v_mov_b32 v211, 0
    v_mov_b32 v212, 0
    v_mov_b32 v213, 0
    v_mov_b32 v214, 0
    v_mov_b32 v215, 0
    v_mov_b32 v216, 0
    v_mov_b32 v217, 0
    v_mov_b32 v218, 0
    v_mov_b32 v219, 0
    v_mov_b32 v220, 0
    v_mov_b32 v221, 0
    v_mov_b32 v222, 0
    v_mov_b32 v223, 0
    s_mov_b32 s54, 0x358637bd
    s_mov_b32 s55, 0x358637bd
    s_mov_b32 s62, 0
    s_mov_b32 s63, 1
    v_add_u32 v2, 40960, v2
    v_add_u32 v3, 40960, v3
    v_add_u32 v4, 40960, v4
    v_add_u32 v5, 40960, v5
    s_mov_b64 exec, 0
    s_cmp_eq_u32 s3, 0
    s_cbranch_scc1 L_walkB0
    s_cmp_eq_u32 s3, 1
    s_cbranch_scc1 L_walkB1
    s_cmp_eq_u32 s3, 2
    s_cbranch_scc1 L_walkB2
    s_branch L_walkB3
L_walked:
    s_mov_b64 exec, -1
    s_waitcnt lgkmcnt(0)
    s_add_u32 s68, s61, 0x9e3779b9
    s_barrier
    ds_read_b128 v[40:43], v2 offset:0
    ds_read_b128 v[44:47], v2 offset:2048
    ds_read_b128 v[48:51], v2 offset:4096
    ds_read_b128 v[52:55], v2 offset:6144
    ds_read_b64_tr_b16 v[56:57], v4 offset:0
    ds_read_b64_tr_b16 v[58:59], v4 offset:512
    ds_read_b64_tr_b16 v[60:61], v5 offset:0
    ds_read_b64_tr_b16 v[62:63], v5 offset:512
    ds_read_b64_tr_b16 v[64:65], v4 offset:8192
    ds_read_b64_tr_b16 v[66:67], v4 offset:8704
    ds_read_b64_tr_b16 v[68:69], v5 offset:8192
    ds_read_b64_tr_b16 v[70:71], v5 offset:8704
    ds_read_b64_tr_b16 v[72:73], v4 offset:16384
    ds_read_b64_tr_b16 v[74:75], v4 offset:16896
    ds_read_b64_tr_b16 v[76:77], v5 offset:16384
    ds_read_b64_tr_b16 v[78:79], v5 offset:16896
L_cloop:
    s_waitcnt lgkmcnt(0)
    v_mfma_f32_16x16x32_bf16 v[128:131], v[56:59], v[40:43], v[128:131]
    ds_read_b128 v[80:83], v3 offset:0
    v_mfma_f32_16x16x32_bf16 v[132:135], v[56:59], v[44:47], v[132:135]
    ds_read_b128 v[84:87], v3 offset:2048
    v_mfma_f32_16x16x32_bf16 v[136:139], v[56:59], v[48:51], v[136:139]
    ds_read_b128 v[88:91], v3 offset:4096
    v_mfma_f32_16x16x32_bf16 v[140:143], v[56:59], v[52:55], v[140:143]
    ds_read_b128 v[92:95], v3 offset:6144
    v_mfma_f32_16x16x32_bf16 v[144:147], v[60:63], v[40:43], v[144:147]
    ds_read_b64_tr_b16 v[96:97], v4 offset:4096
    v_mfma_f32_16x16x32_bf16 v[148:151], v[60:63], v[44:47], v[148:151]
    ds_read_b64_tr_b16 v[98:99], v4 offset:4608
    v_mfma_f32_16x16x32_bf16 v[152:155], v[60:63], v[48:51], v[152:155]
    ds_read_b64_tr_b16 v[100:101], v5 offset:4096
    v_mfma_f32_16x16x32_bf16 v[156:159], v[60:63], v[52:55], v[156:159]
    ds_read_b64_tr_b16 v[102:103], v5 offset:4608
    v_mfma_f32_16x16x32_bf16 v[160:163], v[40:43], v[64:67], v[160:163]
    ds_read_b64_tr_b16 v[104:105], v4 offset:12288
    v_mfma_f32_16x16x32_bf16 v[164:167], v[44:47], v[64:67], v[164:167]
    ds_read_b64_tr_b16 v[106:107], v4 offset:12800
    v_mfma_f32_16x16x32_bf16 v[168:171], v[48:51], v[64:67], v[168:171]
    ds_read_b64_tr_b16 v[108:109], v5 offset:12288
    v_mfma_f32_16x16x32_bf16 v[172:175], v[52:55], v[64:67], v[172:175]
    ds_read_b64_tr_b16 v[110:111], v5 offset:12800
    v_mfma_f32_16x16x32_bf16 v[176:179], v[40:43], v[68:71], v[176:179]
    ds_read_b64_tr_b16 v[112:113], v4 offset:20480
    v_mfma_f32_16x16x32_bf16 v[180:183], v[44:47], v[68:71], v[180:183]
    ds_read_b64_tr_b16 v[114:115], v4 offset:20992
    v_mfma_f32_16x16x32_bf16 v[184:187], v[48:51], v[68:71], v[184:187]
    ds_read_b64_tr_b16 v[116:117], v5 offset:20480
    v_mfma_f32_16x16x32_bf16 v[188:191], v[52:55], v[68:71], v[188:191]
    ds_read_b64_tr_b16 v[118:119], v5 offset:20992
    v_mfma_f32_16x16x32_bf16 v[192:195], v[40:43], v[72:75], v[192:195]
    s_add_u32 s63, s63, 1
    s_cmp_eq_u32 s63, 4
    s_cselect_b32 s53, 4294803456, 0
    s_cselect_b32 s63, 0, s63
    s_add_u32 s53, s53, 40960
    v_mfma_f32_16x16x32_bf16 v[196:199], v[44:47], v[72:75], v[196:199]
    v_add_u32 v2, s53, v2
    v_mfma_f32_16x16x32_bf16 v[200:203], v[48:51], v[72:75], v[200:203]
    v_add_u32 v4, s53, v4
    v_mfma_f32_16x16x32_bf16 v[204:207], v[52:55], v[72:75], v[204:207]
    v_add_u32 v5, s53, v5
    v_mfma_f32_16x16x32_bf16 v[208:211], v[40:43], v[76:79], v[208:211]
    v_add_u32 v3, s53, v3
    v_mfma_f32_16x16x32_bf16 v[212:215], v[44:47], v[76:79], v[212:215]
    s_cmp_ge_u32 s62, 6
    s_cbranch_scc1 L_cl_none
    buffer_store_dwordx4 v[8:11], v6, s[16:19], 0 offen sc1
    v_add_u32 v6, 1024, v6
    s_cmp_lt_u32 s62, 3
    s_cbranch_scc1 L_cl_none
    v_mov_b32 v6, v16
    v_mov_b32 v16, v17
L_cl_none:
    v_mfma_f32_16x16x32_bf16 v[216:219], v[48:51], v[76:79], v[216:219]
    v_mfma_f32_16x16x32_bf16 v[220:223], v[52:55], v[76:79], v[220:223]
    s_waitcnt lgkmcnt(0)
    v_mfma_f32_16x16x32_bf16 v[128:131], v[96:99], v[80:83], v[128:131]
    s_barrier
    ds_read_b128 v[40:43], v2 offset:0
    v_mfma_f32_16x16x32_bf16 v[132:135], v[96:99], v[84:87], v[132:135]
    ds_read_b128 v[44:47], v2 offset:2048
    v_mfma_f32_16x16x32_bf16 v[136:139], v[96:99], v[88:91], v[136:139]
    ds_read_b128 v[48:51], v2 offset:4096
    v_mfma_f32_16x16x32_bf16 v[140:143], v[96:99], v[92:95], v[140:143]
    ds_read_b128 v[52:55], v2 offset:6144
    v_mfma_f32_16x16x32_bf16 v[144:147], v[100:103], v[80:83], v[144:147]
    ds_read_b64_tr_b16 v[56:57], v4 offset:0
    v_mfma_f32_16x16x32_bf16 v[148:151], v[100:103], v[84:87], v[148:151]
    ds_read_b64_tr_b16 v[58:59], v4 offset:512
    v_mfma_f32_16x16x32_bf16 v[152:155], v[100:103], v[88:91], v[152:155]
    ds_read_b64_tr_b16 v[60:61], v5 offset:0
    v_mfma_f32_16x16x32_bf16 v[156:159], v[100:103], v[92:95], v[156:159]
    ds_read_b64_tr_b16 v[62:63], v5 offset:512
    v_mfma_f32_16x16x32_bf16 v[160:163], v[80:83], v[104:107], v[160:163]
    ds_read_b64_tr_b16 v[64:65], v4 offset:8192
    v_mfma_f32_16x16x32_bf16 v[164:167], v[84:87], v[104:107], v[164:167]
    ds_read_b64_tr_b16 v[66:67], v4 offset:8704
    v_mfma_f32_16x16x32_bf16 v[168:171], v[88:91], v[104:107], v[168:171]
    ds_read_b64_tr_b16 v[68:69], v5 offset:8192
    v_mfma_f32_16x16x32_bf16 v[172:175], v[92:95], v[104:107], v[172:175]
    ds_read_b64_tr_b16 v[70:71], v5 offset:8704
    v_mfma_f32_16x16x32_bf16 v[176:179], v[80:83], v[108:111], v[176:179]
    ds_read_b64_tr_b16 v[72:73], v4 offset:16384
    v_mfma_f32_16x16x32_bf16 v[180:183], v[84:87], v[108:111], v[180:183]
    ds_read_b64_tr_b16 v[74:75], v4 offset:16896
    v_mfma_f32_16x16x32_bf16 v[184:187], v[88:91], v[108:111], v[184:187]
    ds_read_b64_tr_b16 v[76:77], v5 offset:16384
    v_mfma_f32_16x16x32_bf16 v[188:191], v[92:95], v[108:111], v[188:191]
    ds_read_b64_tr_b16 v[78:79], v5 offset:16896
    v_mfma_f32_16x16x32_bf16 v[192:195], v[80:83], v[112:115], v[192:195]
    v_mfma_f32_16x16x32_bf16 v[196:199], v[84:87], v[112:115], v[196:199]
    s_cmp_lg_u32 s62, 8
    s_cbranch_scc1 L_cl_nw
    s_waitcnt vmcnt(0)
L_cl_nw:
    v_mfma_f32_16x16x32_bf16 v[200:203], v[88:91], v[112:115], v[200:203]
    v_mfma_f32_16x16x32_bf16 v[204:207], v[92:95], v[112:115], v[204:207]
L_walkB2:
    s_cbranch_execz L_walk_6
    v_mfma_f32_16x16x32_bf16 v[208:211], v[80:83], v[116:119], v[208:211]
    s_add_u32 s62, s62, 1
    v_mfma_f32_16x16x32_bf16 v[212:215], v[84:87], v[116:119], v[212:215]
    v_mfma_f32_16x16x32_bf16 v[216:219], v[88:91], v[116:119], v[216:219]
    v_mfma_f32_16x16x32_bf16 v[220:223], v[92:95], v[116:119], v[220:223]
    s_cmp_lt_u32 s62, 15
    s_cbranch_scc1 L_cloop
    s_waitcnt lgkmcnt(0)
    v_mfma_f32_16x16x32_bf16 v[128:131], v[56:59], v[40:43], v[128:131]
    ds_read_b128 v[80:83], v3 offset:0
    v_mfma_f32_16x16x32_bf16 v[132:135], v[56:59], v[44:47], v[132:135]
    ds_read_b128 v[84:87], v3 offset:2048
    v_mfma_f32_16x16x32_bf16 v[136:139], v[56:59], v[48:51], v[136:139]
    ds_read_b128 v[88:91], v3 offset:4096
    v_mfma_f32_16x16x32_bf16 v[140:143], v[56:59], v[52:55], v[140:143]
    ds_read_b128 v[92:95], v3 offset:6144
    v_mfma_f32_16x16x32_bf16 v[144:147], v[60:63], v[40:43], v[144:147]
    ds_read_b64_tr_b16 v[96:97], v4 offset:4096
    v_mfma_f32_16x16x32_bf16 v[148:151], v[60:63], v[44:47], v[148:151]
    ds_read_b64_tr_b16 v[98:99], v4 offset:4608
    v_mfma_f32_16x16x32_bf16 v[152:155], v[60:63], v[48:51], v[152:155]
    ds_read_b64_tr_b16 v[100:101], v5 offset:4096
    v_mfma_f32_16x16x32_bf16 v[156:159], v[60:63], v[52:55], v[156:159]
    ds_read_b64_tr_b16 v[102:103], v5 offset:4608
    v_mfma_f32_16x16x32_bf16 v[160:163], v[40:43], v[64:67], v[160:163]
    ds_read_b64_tr_b16 v[104:105], v4 offset:12288
    v_mfma_f32_16x16x32_bf16 v[164:167], v[44:47], v[64:67], v[164:167]
    ds_read_b64_tr_b16 v[106:107], v4 offset:12800
    v_mfma_f32_16x16x32_bf16 v[168:171], v[48:51], v[64:67], v[168:171]
    ds_read_b64_tr_b16 v[108:109], v5 offset:12288
    v_mfma_f32_16x16x32_bf16 v[172:175], v[52:55], v[64:67], v[172:175]
    ds_read_b64_tr_b16 v[110:111], v5 offset:12800
    v_mfma_f32_16x16x32_bf16 v[176:179], v[40:43], v[68:71], v[176:179]
    ds_read_b64_tr_b16 v[112:113], v4 offset:20480
    v_mfma_f32_16x16x32_bf16 v[180:183], v[44:47], v[68:71], v[180:183]
    ds_read_b64_tr_b16 v[114:115], v4 offset:20992
    v_mfma_f32_16x16x32_bf16 v[184:187], v[48:51], v[68:71], v[184:187]
    ds_read_b64_tr_b16 v[116:117], v5 offset:20480
    v_mfma_f32_16x16x32_bf16 v[188:191], v[52:55], v[68:71], v[188:191]
    ds_read_b64_tr_b16 v[118:119], v5 offset:20992
    v_mfma_f32_16x16x32_bf16 v[192:195], v[40:43], v[72:75], v[192:195]
    v_lshrrev_b32 v21, 4, v0
    v_and_b32 v22, 15, v0
    v_mfma_f32_16x16x32_bf16 v[196:199], v[44:47], v[72:75], v[196:199]
    s_lshl_b32 s86, s49, 8
    s_add_u32 s86, s86, 131072
    v_lshl_add_u32 v6, v21, 4, s86
    v_mfma_f32_16x16x32_bf16 v[200:203], v[48:51], v[72:75], v[200:203]
    v_lshl_add_u32 v7, v22, 2, s86
    v_mfma_f32_16x16x32_bf16 v[204:207], v[52:55], v[72:75], v[204:207]
    s_lshl_b32 s86, s50, 7
    s_add_u32 s86, s86, 132608
    v_lshl_add_u32 v8, v22, 2, s86
    v_mfma_f32_16x16x32_bf16 v[208:211], v[40:43], v[76:79], v[208:211]
    v_lshl_add_u32 v9, v21, 4, s86
    v_mfma_f32_16x16x32_bf16 v[212:215], v[44:47], v[76:79], v[212:215]
    s_lshl_b32 s86, s3, 2
    s_add_u32 s86, s86, 135168
    v_mov_b32 v12, s86
    v_mfma_f32_16x16x32_bf16 v[216:219], v[48:51], v[76:79], v[216:219]
    v_xor_b32 v13, 4, v12
    v_mfma_f32_16x16x32_bf16 v[220:223], v[52:55], v[76:79], v[220:223]
    s_waitcnt lgkmcnt(0)
    v_mfma_f32_16x16x32_bf16 v[160:163], v[80:83], v[104:107], v[160:163]
    v_mfma_f32_16x16x32_bf16 v[164:167], v[84:87], v[104:107], v[164:167]
    v_mfma_f32_16x16x32_bf16 v[168:171], v[88:91], v[104:107], v[168:171]
    v_mfma_f32_16x16x32_bf16 v[172:175], v[92:95], v[104:107], v[172:175]
    v_mfma_f32_16x16x32_bf16 v[176:179], v[80:83], v[108:111], v[176:179]
    v_mfma_f32_16x16x32_bf16 v[180:183], v[84:87], v[108:111], v[180:183]
    v_mfma_f32_16x16x32_bf16 v[184:187], v[88:91], v[108:111], v[184:187]
    v_mfma_f32_16x16x32_bf16 v[188:191], v[92:95], v[108:111], v[188:191]
    v_mfma_f32_16x16x32_bf16 v[192:195], v[80:83], v[112:115], v[192:195]
    v_mfma_f32_16x16x32_bf16 v[196:199], v[84:87], v[112:115], v[196:199]
    v_mfma_f32_16x16x32_bf16 v[200:203], v[88:91], v[112:115], v[200:203]
    v_mfma_f32_16x16x32_bf16 v[204:207], v[92:95], v[112:115], v[204:207]
    v_mfma_f32_16x16x32_bf16 v[208:211], v[80:83], v[116:119], v[208:211]
    s_barrier
    ds_read_b128 v[40:43], v6 offset:0
    ds_read_b128 v[44:47], v6 offset:64
    v_mfma_f32_16x16x32_bf16 v[212:215], v[84:87], v[116:119], v[212:215]
    ds_read_b128 v[48:51], v6 offset:128
    ds_read_b128 v[52:55], v6 offset:192
    v_mfma_f32_16x16x32_bf16 v[216:219], v[88:91], v[116:119], v[216:219]
    ds_read_b32 v72, v8 offset:256
    ds_read_b32 v73, v8 offset:320
    v_mfma_f32_16x16x32_bf16 v[220:223], v[92:95], v[116:119], v[220:223]
    ds_read_b32 v74, v8 offset:512
    ds_read_b32 v75, v8 offset:576
    v_mfma_f32_16x16x32_bf16 v[128:131], v[96:99], v[80:83], v[128:131]
    ds_read_b128 v[56:59], v6 offset:512
    ds_read_b128 v[60:63], v6 offset:576
    v_mfma_f32_16x16x32_bf16 v[132:135], v[96:99], v[84:87], v[132:135]
    ds_read_b128 v[64:67], v6 offset:640
    ds_read_b128 v[68:71], v6 offset:704
    v_mfma_f32_16x16x32_bf16 v[136:139], v[96:99], v[88:91], v[136:139]
    ds_read_b128 v[224:227], v6 offset:1024
    ds_read_b128 v[228:231], v6 offset:1088
    v_mfma_f32_16x16x32_bf16 v[140:143], v[96:99], v[92:95], v[140:143]
    ds_read_b128 v[232:235], v6 offset:1152
    ds_read_b128 v[236:239], v6 offset:1216
    v_mfma_f32_16x16x32_bf16 v[144:147], v[100:103], v[80:83], v[144:147]
    ds_read_b128 v[28:31], v9 offset:0
    ds_read_b128 v[32:35], v9 offset:64
    v_mfma_f32_16x16x32_bf16 v[148:151], v[100:103], v[84:87], v[148:151]
    v_mfma_f32_16x16x32_bf16 v[152:155], v[100:103], v[88:91], v[152:155]
    v_mfma_f32_16x16x32_bf16 v[156:159], v[100:103], v[92:95], v[156:159]
    ds_read_b32 v240, v7 offset:0
    ds_read_b32 v244, v7 offset:512
    ds_read_b32 v248, v7 offset:1024
    ds_read_b32 v241, v7 offset:64
    ds_read_b32 v245, v7 offset:576
    ds_read_b32 v249, v7 offset:1088
    ds_read_b32 v242, v7 offset:128
    ds_read_b32 v246, v7 offset:640
    ds_read_b32 v250, v7 offset:1152
    ds_read_b32 v243, v7 offset:192
    ds_read_b32 v247, v7 offset:704
    ds_read_b32 v251, v7 offset:1216
    s_waitcnt lgkmcnt(12)
    v_pk_fma_f32 v[160:161], v[40:41], v[72:73], v[160:161] op_sel_hi:[1,0,1]
    v_pk_mul_f32 v[112:113], v[160:161], v[224:225]
    v_pk_fma_f32 v[160:161], v[160:161], v[56:57], s[54:55]
    v_exp_f32 v112, v112 clamp
    v_exp_f32 v113, v113 clamp
    v_max_f32 v160, s54, v160
    v_max_f32 v161, s54, v161
    v_pk_add_f32 v[160:161], v[160:161], v[112:113]
    v_cvt_pk_bf16_f32 v80, v160, v161
    v_pk_fma_f32 v[162:163], v[42:43], v[72:73], v[162:163] op_sel_hi:[1,0,1]
    v_pk_mul_f32 v[114:115], v[162:163], v[226:227]
    v_pk_fma_f32 v[162:163], v[162:163], v[58:59], s[54:55]
    v_exp_f32 v114, v114 clamp
    v_exp_f32 v115, v115 clamp
    v_max_f32 v162, s54, v162
    v_max_f32 v163, s54, v163
    v_pk_add_f32 v[162:163], v[162:163], v[114:115]
    v_cvt_pk_bf16_f32 v81, v162, v163
    v_pk_fma_f32 v[164:165], v[44:45], v[72:73], v[164:165] op_sel_hi:[1,0,1]
    v_pk_mul_f32 v[116:117], v[164:165], v[228:229]
    v_pk_fma_f32 v[164:165], v[164:165], v[60:61], s[54:55]
    v_exp_f32 v116, v116 clamp
    v_exp_f32 v117, v117 clamp
    v_max_f32 v164, s54, v164
    v_max_f32 v165, s54, v165
    v_pk_add_f32 v[164:165], v[164:165], v[116:117]
L_walkB3:
    s_cbranch_execz L_walk_7
    v_cvt_pk_bf16_f32 v82, v164, v165
    v_pk_fma_f32 v[166:167], v[46:47], v[72:73], v[166:167] op_sel_hi:[1,0,1]
    v_pk_mul_f32 v[118:119], v[166:167], v[230:231]
    v_pk_fma_f32 v[166:167], v[166:167], v[62:63], s[54:55]
    v_exp_f32 v118, v118 clamp
    v_exp_f32 v119, v119 clamp
    v_max_f32 v166, s54, v166
    v_max_f32 v167, s54, v167
    v_pk_add_f32 v[166:167], v[166:167], v[118:119]
    v_cvt_pk_bf16_f32 v83, v166, v167
    v_pk_fma_f32 v[168:169], v[48:49], v[72:73], v[168:169] op_sel_hi:[1,0,1]
    v_pk_mul_f32 v[112:113], v[168:169], v[232:233]
    v_pk_fma_f32 v[168:169], v[168:169], v[64:65], s[54:55]
    v_exp_f32 v112, v112 clamp
    v_exp_f32 v113, v113 clamp
    v_max_f32 v168, s54, v168
    v_max_f32 v169, s54, v169
    v_pk_add_f32 v[168:169], v[168:169], v[112:113]
    v_cvt_pk_bf16_f32 v84, v168, v169
    v_pk_fma_f32 v[170:171], v[50:51], v[72:73], v[170:171] op_sel_hi:[1,0,1]
    v_pk_mul_f32 v[114:115], v[170:171], v[234:235]
    v_pk_fma_f32 v[170:171], v[170:171], v[66:67], s[54:55]
    v_exp_f32 v114, v114 clamp
    v_exp_f32 v115, v115 clamp
    v_max_f32 v170, s54, v170
    v_max_f32 v171, s54, v171
    v_pk_add_f32 v[170:171], v[170:171], v[114:115]
    v_cvt_pk_bf16_f32 v85, v170, v171
    v_pk_fma_f32 v[172:173], v[52:53], v[72:73], v[172:173] op_sel_hi:[1,0,1]
    v_pk_mul_f32 v[116:117], v[172:173], v[236:237]
    v_pk_fma_f32 v[172:173], v[172:173], v[68:69], s[54:55]
    v_exp_f32 v116, v116 clamp
    v_exp_f32 v117, v117 clamp
    v_max_f32 v172, s54, v172
    v_max_f32 v173, s54, v173
    v_pk_add_f32 v[172:173], v[172:173], v[116:117]
    v_cvt_pk_bf16_f32 v86, v172, v173
    v_pk_fma_f32 v[174:175], v[54:55], v[72:73], v[174:175] op_sel_hi:[1,0,1]
    v_pk_mul_f32 v[118:119], v[174:175], v[238:239]
    v_pk_fma_f32 v[174:175], v[174:175], v[70:71], s[54:55]
    v_exp_f32 v118, v118 clamp
    v_exp_f32 v119, v119 clamp
    v_max_f32 v174, s54, v174
    v_max_f32 v175, s54, v175
    v_pk_add_f32 v[174:175], v[174:175], v[118:119]
    v_cvt_pk_bf16_f32 v87, v174, v175
    v_pk_fma_f32 v[176:177], v[40:41], v[72:73], v[176:177] op_sel:[0,1,0] op_sel_hi:[1,1,1]
    v_pk_mul_f32 v[112:113], v[176:177], v[224:225]
    v_pk_fma_f32 v[176:177], v[176:177], v[56:57], s[54:55]
    v_exp_f32 v112, v112 clamp
    v_exp_f32 v113, v113 clamp
    v_max_f32 v176, s54, v176
    v_max_f32 v177, s54, v177
    v_pk_add_f32 v[176:177], v[176:177], v[112:113]
    v_cvt_pk_bf16_f32 v88, v176, v177
    v_pk_fma_f32 v[178:179], v[42:43], v[72:73], v[178:179] op_sel:[0,1,0] op_sel_hi:[1,1,1]
    v_pk_mul_f32 v[114:115], v[178:179], v[226:227]
    v_pk_fma_f32 v[178:179], v[178:179], v[58:59], s[54:55]
    v_exp_f32 v114, v114 clamp
    v_exp_f32 v115, v115 clamp
    v_max_f32 v178, s54, v178
    v_max_f32 v179, s54, v179
    v_pk_add_f32 v[178:179], v[178:179], v[114:115]
    v_cvt_pk_bf16_f32 v89, v178, v179
    v_pk_fma_f32 v[180:181], v[44:45], v[72:73], v[180:181] op_sel:[0,1,0] op_sel_hi:[1,1,1]
    v_pk_mul_f32 v[116:117], v[180:181], v[228:229]
    v_pk_fma_f32 v[180:181], v[180:181], v[60:61], s[54:55]
    v_exp_f32 v116, v116 clamp
    v_exp_f32 v117, v117 clamp
    v_max_f32 v180, s54, v180
    v_max_f32 v181, s54, v181
    v_pk_add_f32 v[180:181], v[180:181], v[116:117]
    v_cvt_pk_bf16_f32 v90, v180, v181
    v_pk_fma_f32 v[182:183], v[46:47], v[72:73], v[182:183] op_sel:[0,1,0] op_sel_hi:[1,1,1]
    v_pk_mul_f32 v[118:119], v[182:183], v[230:231]
    v_pk_fma_f32 v[182:183], v[182:183], v[62:63], s[54:55]
    v_exp_f32 v118, v118 clamp
    v_exp_f32 v119, v119 clamp
    v_max_f32 v182, s54, v182
    v_max_f32 v183, s54, v183
    v_pk_add_f32 v[182:183], v[182:183], v[118:119]
    v_cvt_pk_bf16_f32 v91, v182, v183
    v_pk_fma_f32 v[184:185], v[48:49], v[72:73], v[184:185] op_sel:[0,1,0] op_sel_hi:[1,1,1]
    v_pk_mul_f32 v[112:113], v[184:185], v[232:233]
    v_pk_fma_f32 v[184:185], v[184:185], v[64:65], s[54:55]
    v_exp_f32 v112, v112 clamp
    v_exp_f32 v113, v113 clamp
    v_max_f32 v184, s54, v184
    v_max_f32 v185, s54, v185
    v_pk_add_f32 v[184:185], v[184:185], v[112:113]
    v_cvt_pk_bf16_f32 v92, v184, v185
    v_pk_fma_f32 v[186:187], v[50:51], v[72:73], v[186:187] op_sel:[0,1,0] op_sel_hi:[1,1,1]
    v_pk_mul_f32 v[114:115], v[186:187], v[234:235]
    v_pk_fma_f32 v[186:187], v[186:187], v[66:67], s[54:55]
    v_exp_f32 v114, v114 clamp
    v_exp_f32 v115, v115 clamp
    v_max_f32 v186, s54, v186
    v_max_f32 v187, s54, v187
    v_pk_add_f32 v[186:187], v[186:187], v[114:115]
    v_cvt_pk_bf16_f32 v93, v186, v187
    v_pk_fma_f32 v[188:189], v[52:53], v[72:73], v[188:189] op_sel:[0,1,0] op_sel_hi:[1,1,1]
    v_pk_mul_f32 v[116:117], v[188:189], v[236:237]
    v_pk_fma_f32 v[188:189], v[188:189], v[68:69], s[54:55]
    v_exp_f32 v116, v116 clamp
    v_exp_f32 v117, v117 clamp
    v_max_f32 v188, s54, v188
    v_max_f32 v189, s54, v189
    v_pk_add_f32 v[188:189], v[188:189], v[116:117]
    v_cvt_pk_bf16_f32 v94, v188, v189
    v_pk_fma_f32 v[190:191], v[54:55], v[72:73], v[190:191] op_sel:[0,1,0] op_sel_hi:[1,1,1]
    v_pk_mul_f32 v[118:119], v[190:191], v[238:239]
    v_pk_fma_f32 v[190:191], v[190:191], v[70:71], s[54:55]
    v_exp_f32 v118, v118 clamp
    v_exp_f32 v119, v119 clamp
    v_max_f32 v190, s54, v190
    v_max_f32 v191, s54, v191
    v_pk_add_f32 v[190:191], v[190:191], v[118:119]
    v_cvt_pk_bf16_f32 v95, v190, v191
    v_mov_b32 v120, s95
    v_mov_b32 v121, s95
    v_mov_b32 v122, s95
    v_mov_b32 v123, s95
    v_pk_fma_f32 v[192:193], v[40:41], v[74:75], v[192:193] op_sel_hi:[1,0,1]
    v_pk_mul_f32 v[192:193], v[192:193], v[56:57]
    v_cvt_pk_bf16_f32 v96, v192, v193
    v_pk_fma_f32 v[194:195], v[42:43], v[74:75], v[194:195] op_sel_hi:[1,0,1]
    v_pk_mul_f32 v[194:195], v[194:195], v[58:59]
    v_cvt_pk_bf16_f32 v97, v194, v195
    v_pk_fma_f32 v[196:197], v[44:45], v[74:75], v[196:197] op_sel_hi:[1,0,1]
    v_pk_mul_f32 v[196:197], v[196:197], v[60:61]
    v_cvt_pk_bf16_f32 v98, v196, v197
    v_pk_fma_f32 v[198:199], v[46:47], v[74:75], v[198:199] op_sel_hi:[1,0,1]
    v_pk_mul_f32 v[198:199], v[198:199], v[62:63]
    v_cvt_pk_bf16_f32 v99, v198, v199
    v_pk_fma_f32 v[200:201], v[48:49], v[74:75], v[200:201] op_sel_hi:[1,0,1]
    v_pk_mul_f32 v[200:201], v[200:201], v[64:65]
    v_cvt_pk_bf16_f32 v100, v200, v201
    v_pk_fma_f32 v[202:203], v[50:51], v[74:75], v[202:203] op_sel_hi:[1,0,1]
    v_pk_mul_f32 v[202:203], v[202:203], v[66:67]
    v_cvt_pk_bf16_f32 v101, v202, v203
    v_pk_fma_f32 v[204:205], v[52:53], v[74:75], v[204:205] op_sel_hi:[1,0,1]
    v_pk_mul_f32 v[204:205], v[204:205], v[68:69]
    v_cvt_pk_bf16_f32 v102, v204, v205
    v_pk_fma_f32 v[206:207], v[54:55], v[74:75], v[206:207] op_sel_hi:[1,0,1]
    v_pk_mul_f32 v[206:207], v[206:207], v[70:71]
    v_cvt_pk_bf16_f32 v103, v206, v207
    v_pk_fma_f32 v[208:209], v[40:41], v[74:75], v[208:209] op_sel:[0,1,0] op_sel_hi:[1,1,1]
    v_pk_mul_f32 v[208:209], v[208:209], v[56:57]
    v_cvt_pk_bf16_f32 v104, v208, v209
    v_pk_fma_f32 v[210:211], v[42:43], v[74:75], v[210:211] op_sel:[0,1,0] op_sel_hi:[1,1,1]
    v_pk_mul_f32 v[210:211], v[210:211], v[58:59]
L_walk_12:
    s_cbranch_execz L_walk_16
    v_cvt_pk_bf16_f32 v105, v210, v211
    v_pk_fma_f32 v[212:213], v[44:45], v[74:75], v[212:213] op_sel:[0,1,0] op_sel_hi:[1,1,1]
    v_pk_mul_f32 v[212:213], v[212:213], v[60:61]
    v_cvt_pk_bf16_f32 v106, v212, v213
    v_pk_fma_f32 v[214:215], v[46:47], v[74:75], v[214:215] op_sel:[0,1,0] op_sel_hi:[1,1,1]
    v_pk_mul_f32 v[214:215], v[214:215], v[62:63]
    v_cvt_pk_bf16_f32 v107, v214, v215
    v_pk_fma_f32 v[216:217], v[48:49], v[74:75], v[216:217] op_sel:[0,1,0] op_sel_hi:[1,1,1]
    v_pk_mul_f32 v[216:217], v[216:217], v[64:65]
    v_cvt_pk_bf16_f32 v108, v216, v217
    v_pk_fma_f32 v[218:219], v[50:51], v[74:75], v[218:219] op_sel:[0,1,0] op_sel_hi:[1,1,1]
    v_pk_mul_f32 v[218:219], v[218:219], v[66:67]
    v_cvt_pk_bf16_f32 v109, v218, v219
    v_pk_fma_f32 v[220:221], v[52:53], v[74:75], v[220:221] op_sel:[0,1,0] op_sel_hi:[1,1,1]
    v_pk_mul_f32 v[220:221], v[220:221], v[68:69]
    v_cvt_pk_bf16_f32 v110, v220, v221
    v_pk_fma_f32 v[222:223], v[54:55], v[74:75], v[222:223] op_sel:[0,1,0] op_sel_hi:[1,1,1]
    v_pk_mul_f32 v[222:223], v[222:223], v[70:71]
    v_cvt_pk_bf16_f32 v111, v222, v223
    s_mul_i32 s86, s3, 3072
    s_add_u32 s86, s86, 139264
    v_lshl_add_u32 v6, v0, 4, s86
    s_xor_b32 s86, s3, 1
    s_mul_i32 s86, s86, 3072
    s_add_u32 s86, s86, 139264
    v_lshl_add_u32 v7, v0, 4, s86
    s_cmp_eq_u32 s49, 1
    s_cbranch_scc1 L_kv1
    v_mfma_f32_16x16x32_bf16 v[172:175], v[80:83], v[104:107], 0
    v_mfma_f32_16x16x32_bf16 v[176:179], v[88:91], v[104:107], 0
    v_mfma_f32_16x16x32_bf16 v[180:183], v[88:91], v[120:123], 0
    v_mfma_f32_16x16x32_bf16 v[160:163], v[80:83], v[96:99], 0
    v_mfma_f32_16x16x32_bf16 v[164:167], v[88:91], v[96:99], 0
    v_mfma_f32_16x16x32_bf16 v[168:171], v[80:83], v[120:123], 0
    v_mfma_f32_16x16x32_bf16 v[172:175], v[84:87], v[108:111], v[172:175]
    v_mfma_f32_16x16x32_bf16 v[176:179], v[92:95], v[108:111], v[176:179]
    v_mfma_f32_16x16x32_bf16 v[180:183], v[92:95], v[120:123], v[180:183]
    v_mfma_f32_16x16x32_bf16 v[160:163], v[84:87], v[100:103], v[160:163]
    v_mfma_f32_16x16x32_bf16 v[164:167], v[92:95], v[100:103], v[164:167]
    v_mfma_f32_16x16x32_bf16 v[168:171], v[84:87], v[120:123], v[168:171]
    s_branch L_kvd
L_kv1:
    v_mfma_f32_16x16x32_bf16 v[172:175], v[80:83], v[96:99], 0
    v_mfma_f32_16x16x32_bf16 v[176:179], v[88:91], v[96:99], 0
    v_mfma_f32_16x16x32_bf16 v[180:183], v[80:83], v[120:123], 0
    v_mfma_f32_16x16x32_bf16 v[160:163], v[80:83], v[104:107], 0
    v_mfma_f32_16x16x32_bf16 v[164:167], v[88:91], v[104:107], 0
    v_mfma_f32_16x16x32_bf16 v[168:171], v[88:91], v[120:123], 0
    v_mfma_f32_16x16x32_bf16 v[172:175], v[84:87], v[100:103], v[172:175]
    v_mfma_f32_16x16x32_bf16 v[176:179], v[92:95], v[100:103], v[176:179]
    v_mfma_f32_16x16x32_bf16 v[180:183], v[84:87], v[120:123], v[180:183]
    v_mfma_f32_16x16x32_bf16 v[160:163], v[84:87], v[108:111], v[160:163]
    v_mfma_f32_16x16x32_bf16 v[164:167], v[92:95], v[108:111], v[164:167]
    v_mfma_f32_16x16x32_bf16 v[168:171], v[92:95], v[120:123], v[168:171]
L_kvd:
    s_lshl_b32 s86, s47, 1
    s_add_u32 s86, s86, s50
    s_lshl_b32 s87, s86, 1
    s_add_u32 s87, s87, s49
    s_lshl_b32 s87, s87, 4
    s_add_u32 s87, s87, s46
    s_lshl_b32 s87, s87, 10
    s_add_u32 s87, s87, 5242880
    v_lshl_add_u32 v8, v0, 4, s87
    s_lshl_b32 s87, s86, 4
    s_add_u32 s87, s87, s46
    s_lshl_b32 s87, s87, 7
    s_lshl_b32 s88, s49, 6
    s_add_u32 s87, s87, s88
    s_add_u32 s87, s87, 6881280
    v_add_u32 v9, s87, v0
    s_mov_b32 vcc_lo, 0x00010001
    s_mov_b32 vcc_hi, vcc_lo
    v_mov_b32 v14, 2147483648
    v_cndmask_b32 v9, v14, v9, vcc
    ds_write_b128 v6, v[172:175] offset:0
    ds_write_b128 v6, v[176:179] offset:1024
    ds_write_b128 v6, v[180:183] offset:2048
    ds_write_b32 v12, v12
    s_lshl_b32 s86, s47, 1
    s_add_u32 s86, s86, s50
    s_lshl_b32 s87, s46, 3
    s_lshl_b32 s88, s49, 2
    s_add_u32 s87, s87, s88
    s_lshl_b32 s87, s87, 5
    s_add_u32 s87, s87, s86
    s_lshl_b32 s87, s87, 10
    s_add_u32 s87, s87, 1048576
    v_lshl_add_u32 v10, v0, 4, s87
    s_mul_i32 s87, s50, 3072
    s_add_u32 s87, s87, 151552
    v_lshl_add_u32 v11, v0, 4, s87
    s_lshl_b32 s87, s86, 1
    s_add_u32 s87, s87, s49
    s_lshl_b32 s87, s87, 5
    s_add_u32 s87, s87, s46
    s_lshl2_add_u32 s87, s87, 671744
    v_mov_b32 v16, 2147483648
    v_mov_b32 v18, 2147483648
    v_writelane_b32 v16, s87, 0
    s_lshl_b32 s87, s46, 1
    s_add_u32 s87, s87, s49
    s_lshl_b32 s87, s87, 1
    s_lshr_b32 s88, s86, 4
    s_add_u32 s87, s87, s88
    s_lshl_b32 s87, s87, 6
    s_and_b32 s88, s86, 15
    s_add_u32 s87, s87, s88
    s_lshl2_add_u32 s87, s87, 688128
    v_writelane_b32 v18, s87, 0
    s_add_u32 s87, s87, 128
    v_writelane_b32 v18, s87, 1
    v_mov_b32 v17, s68
L_xkv:
    ds_read_b32 v14, v13
    ds_read_b128 v[172:175], v7 offset:0
    ds_read_b128 v[176:179], v7 offset:1024
    ds_read_b128 v[180:183], v7 offset:2048
    s_waitcnt lgkmcnt(0)
    v_cmp_eq_u32 vcc, 0, v14
    s_cbranch_vccz L_ok_2
    s_sub_u32 s56, s56, 1
    s_cbranch_scc0 L_xkv
    s_mov_b32 s56, 0
L_ok_2:
    v_pk_add_f32 v[160:161], v[160:161], v[172:173]
    v_pk_add_f32 v[162:163], v[162:163], v[174:175]
    v_pk_add_f32 v[164:165], v[164:165], v[176:177]
    v_pk_add_f32 v[166:167], v[166:167], v[178:179]
    v_pk_add_f32 v[168:169], v[168:169], v[180:181]
    v_pk_add_f32 v[170:171], v[170:171], v[182:183]
    v_cvt_pk_bf16_f32 v184, v160, v161
    v_cvt_pk_bf16_f32 v185, v162, v163
    v_cvt_pk_bf16_f32 v186, v164, v165
    v_cvt_pk_bf16_f32 v187, v166, v167
    buffer_store_dwordx4 v[184:187], v8, s[16:19], 0 offen sc1
    buffer_store_dwordx4 v[168:171], v9, s[16:19], 0 offen sc1
    buffer_atomic_swap v17, v16, s[16:19], 0 offen sc1
    v_pk_fma_f32 v[128:129], v[28:29], v[240:241], v[128:129] op_sel_hi:[1,0,1]
    v_pk_mul_f32 v[112:113], v[128:129], v[248:249] op_sel_hi:[1,0]
    v_pk_fma_f32 v[128:129], v[128:129], v[244:245], s[54:55] op_sel_hi:[1,0,1]
    v_exp_f32 v112, v112 clamp
    v_exp_f32 v113, v113 clamp
    v_max_f32 v128, s54, v128
    v_max_f32 v129, s54, v129
    v_pk_add_f32 v[128:129], v[128:129], v[112:113]
    v_cvt_pk_bf16_f32 v192, v128, v129
    v_pk_fma_f32 v[130:131], v[30:31], v[240:241], v[130:131] op_sel_hi:[1,0,1]
    v_pk_mul_f32 v[114:115], v[130:131], v[248:249] op_sel_hi:[1,0]
    v_pk_fma_f32 v[130:131], v[130:131], v[244:245], s[54:55] op_sel_hi:[1,0,1]
    v_exp_f32 v114, v114 clamp
    v_exp_f32 v115, v115 clamp
    v_max_f32 v130, s54, v130
    v_max_f32 v131, s54, v131
    v_pk_add_f32 v[130:131], v[130:131], v[114:115]
    v_cvt_pk_bf16_f32 v193, v130, v131
    v_pk_fma_f32 v[144:145], v[32:33], v[240:241], v[144:145] op_sel_hi:[1,0,1]
    v_pk_mul_f32 v[116:117], v[144:145], v[248:249] op_sel_hi:[1,0]
    v_pk_fma_f32 v[144:145], v[144:145], v[244:245], s[54:55] op_sel_hi:[1,0,1]
    v_exp_f32 v116, v116 clamp
    v_exp_f32 v117, v117 clamp
    v_max_f32 v144, s54, v144
    v_max_f32 v145, s54, v145
    v_pk_add_f32 v[144:145], v[144:145], v[116:117]
    v_cvt_pk_bf16_f32 v194, v144, v145
L_walk_13:
    s_cbranch_execz L_walk_17
    v_pk_fma_f32 v[146:147], v[34:35], v[240:241], v[146:147] op_sel_hi:[1,0,1]
    v_pk_mul_f32 v[118:119], v[146:147], v[248:249] op_sel_hi:[1,0]
    v_pk_fma_f32 v[146:147], v[146:147], v[244:245], s[54:55] op_sel_hi:[1,0,1]
    v_exp_f32 v118, v118 clamp
    v_exp_f32 v119, v119 clamp
    v_max_f32 v146, s54, v146
    v_max_f32 v147, s54, v147
    v_pk_add_f32 v[146:147], v[146:147], v[118:119]
    v_cvt_pk_bf16_f32 v195, v146, v147
    v_pk_fma_f32 v[132:133], v[28:29], v[240:241], v[132:133] op_sel:[0,1,0] op_sel_hi:[1,1,1]
    v_pk_mul_f32 v[112:113], v[132:133], v[248:249] op_sel:[0,1] op_sel_hi:[1,1]
    v_pk_fma_f32 v[132:133], v[132:133], v[244:245], s[54:55] op_sel:[0,1,0] op_sel_hi:[1,1,1]
    v_exp_f32 v112, v112 clamp
    v_exp_f32 v113, v113 clamp
    v_max_f32 v132, s54, v132
    v_max_f32 v133, s54, v133
    v_pk_add_f32 v[132:133], v[132:133], v[112:113]
    v_cvt_pk_bf16_f32 v196, v132, v133
    v_pk_fma_f32 v[134:135], v[30:31], v[240:241], v[134:135] op_sel:[0,1,0] op_sel_hi:[1,1,1]
    v_pk_mul_f32 v[114:115], v[134:135], v[248:249] op_sel:[0,1] op_sel_hi:[1,1]
    v_pk_fma_f32 v[134:135], v[134:135], v[244:245], s[54:55] op_sel:[0,1,0] op_sel_hi:[1,1,1]
    v_exp_f32 v114, v114 clamp
    v_exp_f32 v115, v115 clamp
    v_max_f32 v134, s54, v134
    v_max_f32 v135, s54, v135
    v_pk_add_f32 v[134:135], v[134:135], v[114:115]
    v_cvt_pk_bf16_f32 v197, v134, v135
    v_pk_fma_f32 v[148:149], v[32:33], v[240:241], v[148:149] op_sel:[0,1,0] op_sel_hi:[1,1,1]
    v_pk_mul_f32 v[116:117], v[148:149], v[248:249] op_sel:[0,1] op_sel_hi:[1,1]
    v_pk_fma_f32 v[148:149], v[148:149], v[244:245], s[54:55] op_sel:[0,1,0] op_sel_hi:[1,1,1]
    v_exp_f32 v116, v116 clamp
    v_exp_f32 v117, v117 clamp
    v_max_f32 v148, s54, v148
    v_max_f32 v149, s54, v149
    v_pk_add_f32 v[148:149], v[148:149], v[116:117]
    v_cvt_pk_bf16_f32 v198, v148, v149
    v_pk_fma_f32 v[150:151], v[34:35], v[240:241], v[150:151] op_sel:[0,1,0] op_sel_hi:[1,1,1]
    v_pk_mul_f32 v[118:119], v[150:151], v[248:249] op_sel:[0,1] op_sel_hi:[1,1]
    v_pk_fma_f32 v[150:151], v[150:151], v[244:245], s[54:55] op_sel:[0,1,0] op_sel_hi:[1,1,1]
    v_exp_f32 v118, v118 clamp
    v_exp_f32 v119, v119 clamp
    v_max_f32 v150, s54, v150
    v_max_f32 v151, s54, v151
    v_pk_add_f32 v[150:151], v[150:151], v[118:119]
    v_cvt_pk_bf16_f32 v199, v150, v151
    v_pk_fma_f32 v[136:137], v[28:29], v[242:243], v[136:137] op_sel_hi:[1,0,1]
    v_pk_mul_f32 v[112:113], v[136:137], v[250:251] op_sel_hi:[1,0]
    v_pk_fma_f32 v[136:137], v[136:137], v[246:247], s[54:55] op_sel_hi:[1,0,1]
    v_exp_f32 v112, v112 clamp
    v_exp_f32 v113, v113 clamp
    v_max_f32 v136, s54, v136
    v_max_f32 v137, s54, v137
    v_pk_add_f32 v[136:137], v[136:137], v[112:113]
    v_cvt_pk_bf16_f32 v200, v136, v137
    v_pk_fma_f32 v[138:139], v[30:31], v[242:243], v[138:139] op_sel_hi:[1,0,1]
    v_pk_mul_f32 v[114:115], v[138:139], v[250:251] op_sel_hi:[1,0]
    v_pk_fma_f32 v[138:139], v[138:139], v[246:247], s[54:55] op_sel_hi:[1,0,1]
    v_exp_f32 v114, v114 clamp
    v_exp_f32 v115, v115 clamp
    v_max_f32 v138, s54, v138
    v_max_f32 v139, s54, v139
    v_pk_add_f32 v[138:139], v[138:139], v[114:115]
    v_cvt_pk_bf16_f32 v201, v138, v139
    v_pk_fma_f32 v[152:153], v[32:33], v[242:243], v[152:153] op_sel_hi:[1,0,1]
    v_pk_mul_f32 v[116:117], v[152:153], v[250:251] op_sel_hi:[1,0]
    v_pk_fma_f32 v[152:153], v[152:153], v[246:247], s[54:55] op_sel_hi:[1,0,1]
    v_exp_f32 v116, v116 clamp
    v_exp_f32 v117, v117 clamp
    v_max_f32 v152, s54, v152
    v_max_f32 v153, s54, v153
    v_pk_add_f32 v[152:153], v[152:153], v[116:117]
    v_cvt_pk_bf16_f32 v202, v152, v153
    v_pk_fma_f32 v[154:155], v[34:35], v[242:243], v[154:155] op_sel_hi:[1,0,1]
    v_pk_mul_f32 v[118:119], v[154:155], v[250:251] op_sel_hi:[1,0]
    v_pk_fma_f32 v[154:155], v[154:155], v[246:247], s[54:55] op_sel_hi:[1,0,1]
    v_exp_f32 v118, v118 clamp
    v_exp_f32 v119, v119 clamp
    v_max_f32 v154, s54, v154
    v_max_f32 v155, s54, v155
    v_pk_add_f32 v[154:155], v[154:155], v[118:119]
    v_cvt_pk_bf16_f32 v203, v154, v155
    v_pk_fma_f32 v[140:141], v[28:29], v[242:243], v[140:141] op_sel:[0,1,0] op_sel_hi:[1,1,1]
    v_pk_mul_f32 v[112:113], v[140:141], v[250:251] op_sel:[0,1] op_sel_hi:[1,1]
    v_pk_fma_f32 v[140:141], v[140:141], v[246:247], s[54:55] op_sel:[0,1,0] op_sel_hi:[1,1,1]
    v_exp_f32 v112, v112 clamp
    v_exp_f32 v113, v113 clamp
    v_max_f32 v140, s54, v140
    v_max_f32 v141, s54, v141
    v_pk_add_f32 v[140:141], v[140:141], v[112:113]
    v_cvt_pk_bf16_f32 v204, v140, v141
    v_pk_fma_f32 v[142:143], v[30:31], v[242:243], v[142:143] op_sel:[0,1,0] op_sel_hi:[1,1,1]
    v_pk_mul_f32 v[114:115], v[142:143], v[250:251] op_sel:[0,1] op_sel_hi:[1,1]
    v_pk_fma_f32 v[142:143], v[142:143], v[246:247], s[54:55] op_sel:[0,1,0] op_sel_hi:[1,1,1]
    v_exp_f32 v114, v114 clamp
    v_exp_f32 v115, v115 clamp
    v_max_f32 v142, s54, v142
    v_max_f32 v143, s54, v143
    v_pk_add_f32 v[142:143], v[142:143], v[114:115]
    v_cvt_pk_bf16_f32 v205, v142, v143
    v_pk_fma_f32 v[156:157], v[32:33], v[242:243], v[156:157] op_sel:[0,1,0] op_sel_hi:[1,1,1]
    v_pk_mul_f32 v[116:117], v[156:157], v[250:251] op_sel:[0,1] op_sel_hi:[1,1]
    v_pk_fma_f32 v[156:157], v[156:157], v[246:247], s[54:55] op_sel:[0,1,0] op_sel_hi:[1,1,1]
    v_exp_f32 v116, v116 clamp
    v_exp_f32 v117, v117 clamp
    v_max_f32 v156, s54, v156
    v_max_f32 v157, s54, v157
    v_pk_add_f32 v[156:157], v[156:157], v[116:117]
    v_cvt_pk_bf16_f32 v206, v156, v157
    v_pk_fma_f32 v[158:159], v[34:35], v[242:243], v[158:159] op_sel:[0,1,0] op_sel_hi:[1,1,1]
    v_pk_mul_f32 v[118:119], v[158:159], v[250:251] op_sel:[0,1] op_sel_hi:[1,1]
    v_pk_fma_f32 v[158:159], v[158:159], v[246:247], s[54:55] op_sel:[0,1,0] op_sel_hi:[1,1,1]
    v_exp_f32 v118, v118 clamp
    v_exp_f32 v119, v119 clamp
    v_max_f32 v158, s54, v158
    v_max_f32 v159, s54, v159
    v_pk_add_f32 v[158:159], v[158:159], v[118:119]
    v_cvt_pk_bf16_f32 v207, v158, v159
    s_lshr_b32 s62, s3, 2
    s_lshl_b32 s53, s51, 3
    s_lshl_b32 s86, s48, 1
    s_add_u32 s53, s53, s86
    s_add_u32 s53, s53, s62
    v_lshrrev_b32 v36, 4, v0
    v_and_b32 v37, 15, v0
    s_lshl_b32 s87, s53, 15
    s_lshl_b32 s86, s62, 14
    s_add_u32 s86, s86, s87
    s_add_u32 s86, s86, 1048576
    v_lshl_add_u32 v157, v0, 4, s86
    v_xor_b32 v158, 0x8000, v157
    s_lshl_b32 s86, s51, 1
    s_lshr_b32 s87, s48, 1
    s_add_u32 s86, s86, s87
    s_lshl_b32 s86, s86, 1
    s_add_u32 s86, s86, s62
    s_lshl_b32 s86, s86, 1
    s_and_b32 s87, s48, 1
    s_add_u32 s86, s86, s87
    s_lshl_b32 s86, s86, 7
    s_add_u32 s86, s86, 688128
    v_lshl_add_u32 v159, v0, 2, s86
    v_mov_b32 v38, 2147483648
    v_cmp_gt_u32 vcc, 16, v0
    s_nop 1
    v_cndmask_b32 v159, v38, v159, vcc
    v_bfe_u32 v38, v0, 2, 2
    v_lshl_add_u32 v38, v36, 2, v38
    v_bfe_u32 v39, v38, 1, 2
    v_lshlrev_b32 v38, 7, v38
    v_lshl_add_u32 v38, v39, 5, v38
    v_and_b32 v39, 3, v0
    v_lshl_add_u32 v38, v39, 3, v38
    s_lshl_b32 s86, s62, 16
    s_add_u32 s86, s86, 0
    v_add_u32 v144, s86, v38
    v_xor_b32 v145, 32, v144
    v_xor_b32 v146, 64, v144
    v_xor_b32 v147, 96, v144
    v_cmp_eq_u32 s[4:5], 1, v39
    v_cmp_eq_u32 s[6:7], 2, v39
    v_cmp_eq_u32 s[98:99], 3, v39
    s_lshl_b32 s86, s53, 10
    s_add_u32 s86, s86, 786432
    v_lshl_add_u32 v160, v0, 2, s86
L_walk_14:
    s_cbranch_execz L_walk_18
    v_mul_u32_u24 v161, 192, v36
    v_add_u32 v160, v160, v161
    s_mov_b32 s72, 0x00f0000f
    s_mov_b32 s73, 0xf0000f00
    s_mov_b32 s74, 0x0f00f000
    s_mov_b32 s75, 0x0f00f000
    v_lshrrev_b32 v38, 2, v37
    v_lshl_add_u32 v161, v38, 4, v37
    v_lshlrev_b32 v161, 2, v161
    s_lshl_b32 s86, s3, 12
    s_add_u32 s86, s86, 131072
    v_lshl_add_u32 v162, v0, 4, s86
    v_xor_b32 v163, 0x4000, v162
    s_lshl_b32 s86, s52, 7
    v_lshl_add_u32 v36, v36, 3, s86
    s_lshl_b32 s87, s53, 15
    s_add_u32 s87, s87, s86
    s_lshl_b32 s86, s62, 6
    s_add_u32 s87, s87, s86
    v_lshl_add_u32 v39, v37, 11, s87
    v_and_b32 v38, 48, v0
    v_add_u32 v39, v39, v38
    v_xor_b32 v37, 0x8000, v39
    buffer_load_dwordx4 v[136:139], v39, s[8:11], 0 offen
    buffer_load_dwordx4 v[140:143], v37, s[8:11], 0 offen
    buffer_load_dwordx2 v[148:149], v36, s[40:43], 0 offen offset:0
    buffer_load_dwordx2 v[150:151], v36, s[40:43], 0 offen offset:32
    buffer_load_dwordx2 v[152:153], v36, s[40:43], 0 offen offset:64
    buffer_load_dwordx2 v[154:155], v36, s[40:43], 0 offen offset:96
    s_barrier
    ds_read_b128 v[40:43], v11 offset:0
    ds_read_b128 v[44:47], v11 offset:1024
    ds_read_b128 v[48:51], v11 offset:2048
    v_mov_b32 v38, 135200
    ds_read_b32 v38, v38
    s_mov_b32 s86, 0x8000
    s_mov_b32 s87, 0x10000
    s_mov_b32 s88, 0x18000
    s_waitcnt lgkmcnt(0)
    v_mfma_f32_16x16x32_bf16 v[216:219], v[48:51], v[192:195], 0
    v_mfma_f32_16x16x32_bf16 v[208:211], v[40:43], v[192:195], 0
    v_mfma_f32_16x16x32_bf16 v[212:215], v[44:47], v[192:195], 0
    v_mfma_f32_16x16x32_bf16 v[228:231], v[48:51], v[196:199], 0
    v_mfma_f32_16x16x32_bf16 v[220:223], v[40:43], v[196:199], 0
    v_mfma_f32_16x16x32_bf16 v[224:227], v[44:47], v[196:199], 0
    v_mfma_f32_16x16x32_bf16 v[240:243], v[48:51], v[200:203], 0
    v_mfma_f32_16x16x32_bf16 v[232:235], v[40:43], v[200:203], 0
    v_mfma_f32_16x16x32_bf16 v[236:239], v[44:47], v[200:203], 0
    v_mfma_f32_16x16x32_bf16 v[252:255], v[48:51], v[204:207], 0
    v_mfma_f32_16x16x32_bf16 v[244:247], v[40:43], v[204:207], 0
    v_mfma_f32_16x16x32_bf16 v[248:251], v[44:47], v[204:207], 0
    v_add_f32 v216, s54, v216
    v_rcp_f32 v216, v216
    s_nop 0
    v_pk_mul_f32 v[208:209], v[208:209], v[216:217] op_sel_hi:[1,0]
    v_pk_mul_f32 v[210:211], v[210:211], v[216:217] op_sel_hi:[1,0]
    v_pk_mul_f32 v[212:213], v[212:213], v[216:217] op_sel_hi:[1,0]
    v_pk_mul_f32 v[214:215], v[214:215], v[216:217] op_sel_hi:[1,0]
    v_cvt_pk_bf16_f32 v60, v208, v209
    v_cvt_pk_bf16_f32 v61, v210, v211
    v_cvt_pk_bf16_f32 v62, v212, v213
    v_cvt_pk_bf16_f32 v63, v214, v215
    buffer_store_dwordx4 v[60:63], v10, s[16:19], 0 offen sc1
    v_add_f32 v228, s54, v228
    v_rcp_f32 v228, v228
    s_nop 0
    v_pk_mul_f32 v[220:221], v[220:221], v[228:229] op_sel_hi:[1,0]
    v_pk_mul_f32 v[222:223], v[222:223], v[228:229] op_sel_hi:[1,0]
    v_pk_mul_f32 v[224:225], v[224:225], v[228:229] op_sel_hi:[1,0]
    v_pk_mul_f32 v[226:227], v[226:227], v[228:229] op_sel_hi:[1,0]
    v_cvt_pk_bf16_f32 v64, v220, v221
    v_cvt_pk_bf16_f32 v65, v222, v223
    v_cvt_pk_bf16_f32 v66, v224, v225
    v_cvt_pk_bf16_f32 v67, v226, v227
    buffer_store_dwordx4 v[64:67], v10, s[16:19], s86 offen sc1
    v_add_f32 v240, s54, v240
    v_rcp_f32 v240, v240
    s_nop 0
    v_pk_mul_f32 v[232:233], v[232:233], v[240:241] op_sel_hi:[1,0]
    v_pk_mul_f32 v[234:235], v[234:235], v[240:241] op_sel_hi:[1,0]
    v_pk_mul_f32 v[236:237], v[236:237], v[240:241] op_sel_hi:[1,0]
    v_pk_mul_f32 v[238:239], v[238:239], v[240:241] op_sel_hi:[1,0]
    v_cvt_pk_bf16_f32 v68, v232, v233
    v_cvt_pk_bf16_f32 v69, v234, v235
    v_cvt_pk_bf16_f32 v70, v236, v237
    v_cvt_pk_bf16_f32 v71, v238, v239
    buffer_store_dwordx4 v[68:71], v10, s[16:19], s87 offen sc1
    v_add_f32 v252, s54, v252
    v_rcp_f32 v252, v252
    s_nop 0
    v_pk_mul_f32 v[244:245], v[244:245], v[252:253] op_sel_hi:[1,0]
    v_pk_mul_f32 v[246:247], v[246:247], v[252:253] op_sel_hi:[1,0]
    v_pk_mul_f32 v[248:249], v[248:249], v[252:253] op_sel_hi:[1,0]
    v_pk_mul_f32 v[250:251], v[250:251], v[252:253] op_sel_hi:[1,0]
    v_cvt_pk_bf16_f32 v72, v244, v245
    v_cvt_pk_bf16_f32 v73, v246, v247
    v_cvt_pk_bf16_f32 v74, v248, v249
    v_cvt_pk_bf16_f32 v75, v250, v251
    buffer_store_dwordx4 v[72:75], v10, s[16:19], s88 offen sc1
    buffer_atomic_swap v17, v18, s[16:19], 0 offen sc1
    v_mov_b32 v8, 0
    buffer_atomic_or v8, v159, s[16:19], 0 offen sc0 sc1
    v_mov_b32 v14, 2147483648
    v_mov_b32 v11, 2147483648
    s_waitcnt vmcnt(6)
    v_bfe_u32 v36, v0, 2, 1
    v_cmp_eq_u32 vcc, 1, v36
    v_mov_b32 v36, s95
    s_nop 0
    v_cndmask_b32 v148, v36, v148, vcc
    v_cndmask_b32 v149, v36, v149, vcc
    v_cndmask_b32 v150, v36, v150, vcc
    v_cndmask_b32 v151, v36, v151, vcc
    v_cndmask_b32 v152, v36, v152, vcc
    v_cndmask_b32 v153, v36, v153, vcc
    v_cndmask_b32 v154, v36, v154, vcc
    v_cndmask_b32 v155, v36, v155, vcc
    v_readfirstlane_b32 s57, v38
L_phaseB:
    v_lshrrev_b32 v1, 4, v0
    v_and_b32 v2, 15, v0
    v_mov_b32 v3, 0x3f80
    s_lshl_b32 s87, s53, 4
    v_add_u32 v6, s87, v2
    s_lshl_b32 s86, s52, 7
    v_lshl_add_u32 v5, v6, 11, s86
    v_sub_u32 v6, 2047, v6
    v_mov_b32 v7, v39
    v_lshrrev_b32 v9, 1, v1
    v_lshl_add_u32 v5, v9, 4, v5
    v_and_b32 v9, 1, v1
    v_lshl_add_u32 v5, v9, 5, v5
    s_mov_b32 s67, 0
    s_mov_b32 s66, 0xffffaaaa
    s_mov_b32 s63, 0
L_b_init:
    v_bfe_u32 v9, v0, 3, 1
    v_bfe_u32 v10, v0, 4, 1
    v_xor_b32 v9, v9, v10
    v_bfe_u32 v10, v0, 1, 2
    v_lshl_add_u32 v9, v9, 3, v10
    v_lshrrev_b32 v10, 5, v0
    v_lshl_add_u32 v9, v10, 2, v9
    v_and_b32 v10, 1, v0
    v_lshlrev_b32 v10, 4, v10
    v_lshlrev_b32 v10, v10, v3
    v_cmp_eq_u32 vcc, 0, v9
    s_nop 1
    v_cndmask_b32 v128, 0, v10, vcc
    v_cmp_eq_u32 vcc, 1, v9
    s_nop 1
    v_cndmask_b32 v129, 0, v10, vcc
    v_cmp_eq_u32 vcc, 2, v9
    s_nop 1
    v_cndmask_b32 v130, 0, v10, vcc
    v_cmp_eq_u32 vcc, 3, v9
    s_nop 1
    v_cndmask_b32 v131, 0, v10, vcc
    v_cmp_eq_u32 vcc, 4, v9
    s_nop 1
    v_cndmask_b32 v132, 0, v10, vcc
    v_cmp_eq_u32 vcc, 5, v9
    s_nop 1
    v_cndmask_b32 v133, 0, v10, vcc
    v_cmp_eq_u32 vcc, 6, v9
    s_nop 1
    v_cndmask_b32 v134, 0, v10, vcc
    v_cmp_eq_u32 vcc, 7, v9
    s_nop 1
    v_cndmask_b32 v135, 0, v10, vcc
    v_mov_b32 v80, 0
    v_mov_b32 v81, 0
    v_mov_b32 v82, 0
    v_mov_b32 v83, 0
    v_mov_b32 v84, 0
    v_mov_b32 v85, 0
    v_mov_b32 v86, 0
    v_mov_b32 v87, 0
    v_mov_b32 v88, 0
    v_mov_b32 v89, 0
    v_mov_b32 v90, 0
    v_mov_b32 v91, 0
L_walk_15:
    s_cbranch_execz L_walk_19
    v_mov_b32 v92, 0
    v_mov_b32 v93, 0
    v_mov_b32 v94, 0
    v_mov_b32 v95, 0
    v_mov_b32 v96, 0
    v_mov_b32 v97, 0
    v_mov_b32 v98, 0
    v_mov_b32 v99, 0
    v_mov_b32 v100, 0
    v_mov_b32 v101, 0
    v_mov_b32 v102, 0
    v_mov_b32 v103, 0
    v_mov_b32 v104, 0
    v_mov_b32 v105, 0
    v_mov_b32 v106, 0
    v_mov_b32 v107, 0
    v_mov_b32 v108, 0
    v_mov_b32 v109, 0
    v_mov_b32 v110, 0
    v_mov_b32 v111, 0
    v_mov_b32 v156, 0
    s_branch L_b_w0
L_b_r0:
    s_ff1_i32_b32 s91, s65
    s_bitset0_b32 s65, s91
    s_lshl_b32 s76, s91, 12
    s_lshl_b32 s91, s91, 10
    buffer_load_dwordx4 v[16:19], v157, s[16:19], s91 offen offset:0 sc1
    buffer_load_dwordx4 v[20:23], v158, s[16:19], s91 offen offset:0 sc1
    buffer_load_dwordx4 v[24:27], v157, s[16:19], s91 offen offset:1024 sc1
    buffer_load_dwordx4 v[28:31], v158, s[16:19], s91 offen offset:1024 sc1
    s_cmp_eq_u32 s65, 0
    s_cbranch_scc1 L_b_p1
L_b_r1:
    s_ff1_i32_b32 s91, s65
    s_bitset0_b32 s65, s91
    s_lshl_b32 s77, s91, 12
    s_lshl_b32 s91, s91, 10
    buffer_load_dwordx4 v[32:35], v157, s[16:19], s91 offen offset:0 sc1
    buffer_load_dwordx4 v[36:39], v158, s[16:19], s91 offen offset:0 sc1
    buffer_load_dwordx4 v[40:43], v157, s[16:19], s91 offen offset:1024 sc1
    buffer_load_dwordx4 v[44:47], v158, s[16:19], s91 offen offset:1024 sc1
    s_xor_b32 s89, s67, s76
    s_mov_b32 s67, s76
    v_xor_b32 v144, s89, v144
    ds_read_b64_tr_b16 v[112:113], v144 offset:0
    ds_read_b64_tr_b16 v[114:115], v144 offset:2048
    v_xor_b32 v145, s89, v145
    ds_read_b64_tr_b16 v[116:117], v145 offset:0
    ds_read_b64_tr_b16 v[118:119], v145 offset:2048
    v_xor_b32 v146, s89, v146
    ds_read_b64_tr_b16 v[120:121], v146 offset:0
    ds_read_b64_tr_b16 v[122:123], v146 offset:2048
    v_xor_b32 v147, s89, v147
    ds_read_b64_tr_b16 v[124:125], v147 offset:0
    ds_read_b64_tr_b16 v[126:127], v147 offset:2048
    s_cmp_eq_u32 s62, 0
    s_cbranch_scc0 L_b_x1
    v_mfma_f32_16x16x32_bf16 v[80:83], v[128:131], v[136:139], 0
    v_mfma_f32_16x16x32_bf16 v[96:99], v[128:131], v[140:143], 0
    v_mfma_f32_16x16x32_bf16 v[84:87], v[132:135], v[136:139], 0
    v_mfma_f32_16x16x32_bf16 v[100:103], v[132:135], v[140:143], 0
    s_branch L_b_xd
L_b_x1:
    s_setprio 1
    v_mfma_f32_16x16x32_bf16 v[88:91], v[128:131], v[136:139], 0
    v_mfma_f32_16x16x32_bf16 v[104:107], v[128:131], v[140:143], 0
    v_mfma_f32_16x16x32_bf16 v[92:95], v[132:135], v[136:139], 0
    v_mfma_f32_16x16x32_bf16 v[108:111], v[132:135], v[140:143], 0
L_b_xd:
    s_waitcnt vmcnt(6) lgkmcnt(6)
    v_max3_u32 v156, v156, v19, v23
    v_mfma_f32_16x16x32_bf16 v[80:83], v[112:115], v[16:19], v[80:83]
    ds_read_b64_tr_b16 v[128:129], v144 offset:4096
    v_mfma_f32_16x16x32_bf16 v[96:99], v[112:115], v[20:23], v[96:99]
    ds_read_b64_tr_b16 v[130:131], v144 offset:6144
    s_waitcnt lgkmcnt(6)
    v_mfma_f32_16x16x32_bf16 v[84:87], v[116:119], v[16:19], v[84:87]
    ds_read_b64_tr_b16 v[132:133], v145 offset:4096
    v_mfma_f32_16x16x32_bf16 v[100:103], v[116:119], v[20:23], v[100:103]
    ds_read_b64_tr_b16 v[134:135], v145 offset:6144
    s_waitcnt lgkmcnt(6)
    v_mfma_f32_16x16x32_bf16 v[88:91], v[120:123], v[16:19], v[88:91]
    ds_read_b64_tr_b16 v[136:137], v146 offset:4096
    v_mfma_f32_16x16x32_bf16 v[104:107], v[120:123], v[20:23], v[104:107]
    ds_read_b64_tr_b16 v[138:139], v146 offset:6144
    s_waitcnt lgkmcnt(6)
    v_mfma_f32_16x16x32_bf16 v[92:95], v[124:127], v[16:19], v[92:95]
    ds_read_b64_tr_b16 v[140:141], v147 offset:4096
    v_mfma_f32_16x16x32_bf16 v[108:111], v[124:127], v[20:23], v[108:111]
    ds_read_b64_tr_b16 v[142:143], v147 offset:6144
    s_not_b32 s91, s66
    s_cmp_eq_u32 s65, 0
    s_cselect_b32 s65, s91, s65
    s_cselect_b32 s66, -1, s66
    s_ff1_i32_b32 s91, s65
    s_bitset0_b32 s65, s91
    s_lshl_b32 s78, s91, 12
    s_lshl_b32 s91, s91, 10
    buffer_load_dwordx4 v[48:51], v157, s[16:19], s91 offen offset:0 sc1
    buffer_load_dwordx4 v[52:55], v158, s[16:19], s91 offen offset:0 sc1
    s_waitcnt vmcnt(6) lgkmcnt(6)
    v_max3_u32 v156, v156, v27, v31
    v_mfma_f32_16x16x32_bf16 v[80:83], v[128:131], v[24:27], v[80:83]
    s_xor_b32 s89, s67, s77
    s_mov_b32 s67, s77
    v_xor_b32 v144, s89, v144
    ds_read_b64_tr_b16 v[112:113], v144 offset:0
    v_mfma_f32_16x16x32_bf16 v[96:99], v[128:131], v[28:31], v[96:99]
    ds_read_b64_tr_b16 v[114:115], v144 offset:2048
    s_waitcnt lgkmcnt(6)
    v_mfma_f32_16x16x32_bf16 v[84:87], v[132:135], v[24:27], v[84:87]
    v_xor_b32 v145, s89, v145
    ds_read_b64_tr_b16 v[116:117], v145 offset:0
    v_mfma_f32_16x16x32_bf16 v[100:103], v[132:135], v[28:31], v[100:103]
    ds_read_b64_tr_b16 v[118:119], v145 offset:2048
    s_waitcnt lgkmcnt(6)
    v_mfma_f32_16x16x32_bf16 v[88:91], v[136:139], v[24:27], v[88:91]
    v_xor_b32 v146, s89, v146
    ds_read_b64_tr_b16 v[120:121], v146 offset:0
    v_mfma_f32_16x16x32_bf16 v[104:107], v[136:139], v[28:31], v[104:107]
    ds_read_b64_tr_b16 v[122:123], v146 offset:2048
    s_waitcnt lgkmcnt(6)
    v_mfma_f32_16x16x32_bf16 v[92:95], v[140:143], v[24:27], v[92:95]
    v_xor_b32 v147, s89, v147
    ds_read_b64_tr_b16 v[124:125], v147 offset:0
    v_mfma_f32_16x16x32_bf16 v[108:111], v[140:143], v[28:31], v[108:111]
    ds_read_b64_tr_b16 v[126:127], v147 offset:2048
    buffer_load_dwordx4 v[56:59], v157, s[16:19], s91 offen offset:1024 sc1
    buffer_load_dwordx4 v[60:63], v158, s[16:19], s91 offen offset:1024 sc1
    s_waitcnt vmcnt(6) lgkmcnt(6)
    v_max3_u32 v156, v156, v35, v39
    v_mfma_f32_16x16x32_bf16 v[80:83], v[112:115], v[32:35], v[80:83]
    ds_read_b64_tr_b16 v[128:129], v144 offset:4096
    v_mfma_f32_16x16x32_bf16 v[96:99], v[112:115], v[36:39], v[96:99]
    ds_read_b64_tr_b16 v[130:131], v144 offset:6144
    s_waitcnt lgkmcnt(6)
    v_mfma_f32_16x16x32_bf16 v[84:87], v[116:119], v[32:35], v[84:87]
    ds_read_b64_tr_b16 v[132:133], v145 offset:4096
    v_mfma_f32_16x16x32_bf16 v[100:103], v[116:119], v[36:39], v[100:103]
    ds_read_b64_tr_b16 v[134:135], v145 offset:6144
    s_waitcnt lgkmcnt(6)
    v_mfma_f32_16x16x32_bf16 v[88:91], v[120:123], v[32:35], v[88:91]
    ds_read_b64_tr_b16 v[136:137], v146 offset:4096
    v_mfma_f32_16x16x32_bf16 v[104:107], v[120:123], v[36:39], v[104:107]
    ds_read_b64_tr_b16 v[138:139], v146 offset:6144
    s_waitcnt lgkmcnt(6)
    v_mfma_f32_16x16x32_bf16 v[92:95], v[124:127], v[32:35], v[92:95]
    ds_read_b64_tr_b16 v[140:141], v147 offset:4096
    v_mfma_f32_16x16x32_bf16 v[108:111], v[124:127], v[36:39], v[108:111]
    ds_read_b64_tr_b16 v[142:143], v147 offset:6144
    s_not_b32 s91, s66
    s_cmp_eq_u32 s65, 0
    s_cselect_b32 s65, s91, s65
    s_cselect_b32 s66, -1, s66
    s_ff1_i32_b32 s91, s65
    s_bitset0_b32 s65, s91
    s_lshl_b32 s79, s91, 12
    s_lshl_b32 s91, s91, 10
    buffer_load_dwordx4 v[64:67], v157, s[16:19], s91 offen offset:0 sc1
    buffer_load_dwordx4 v[68:71], v158, s[16:19], s91 offen offset:0 sc1
    s_waitcnt vmcnt(6) lgkmcnt(6)
    v_max3_u32 v156, v156, v43, v47
    v_mfma_f32_16x16x32_bf16 v[80:83], v[128:131], v[40:43], v[80:83]
    s_xor_b32 s89, s67, s78
    s_mov_b32 s67, s78
    v_xor_b32 v144, s89, v144
    ds_read_b64_tr_b16 v[112:113], v144 offset:0
    v_mfma_f32_16x16x32_bf16 v[96:99], v[128:131], v[44:47], v[96:99]
    ds_read_b64_tr_b16 v[114:115], v144 offset:2048
    s_waitcnt lgkmcnt(6)
    v_mfma_f32_16x16x32_bf16 v[84:87], v[132:135], v[40:43], v[84:87]
    v_xor_b32 v145, s89, v145
    ds_read_b64_tr_b16 v[116:117], v145 offset:0
    v_mfma_f32_16x16x32_bf16 v[100:103], v[132:135], v[44:47], v[100:103]
    ds_read_b64_tr_b16 v[118:119], v145 offset:2048
    s_waitcnt lgkmcnt(6)
    v_mfma_f32_16x16x32_bf16 v[88:91], v[136:139], v[40:43], v[88:91]
    v_xor_b32 v146, s89, v146
    ds_read_b64_tr_b16 v[120:121], v146 offset:0
    v_mfma_f32_16x16x32_bf16 v[104:107], v[136:139], v[44:47], v[104:107]
    ds_read_b64_tr_b16 v[122:123], v146 offset:2048
    s_waitcnt lgkmcnt(6)
    v_mfma_f32_16x16x32_bf16 v[92:95], v[140:143], v[40:43], v[92:95]
    v_xor_b32 v147, s89, v147
    ds_read_b64_tr_b16 v[124:125], v147 offset:0
    v_mfma_f32_16x16x32_bf16 v[108:111], v[140:143], v[44:47], v[108:111]
    ds_read_b64_tr_b16 v[126:127], v147 offset:2048
    buffer_load_dwordx4 v[72:75], v157, s[16:19], s91 offen offset:1024 sc1
    buffer_load_dwordx4 v[76:79], v158, s[16:19], s91 offen offset:1024 sc1
L_walk_16:
    s_cbranch_execz L_walk_20
    s_waitcnt vmcnt(6) lgkmcnt(6)
L_b_c4:
    v_max_u32 v4, v51, v55
    v_cmp_eq_u32 vcc, -1, v4
    s_cbranch_vccnz L_b_g4
L_b_d4:
    v_mfma_f32_16x16x32_bf16 v[80:83], v[112:115], v[48:51], v[80:83]
    ds_read_b64_tr_b16 v[128:129], v144 offset:4096
    v_mfma_f32_16x16x32_bf16 v[96:99], v[112:115], v[52:55], v[96:99]
    ds_read_b64_tr_b16 v[130:131], v144 offset:6144
    s_waitcnt lgkmcnt(6)
    v_mfma_f32_16x16x32_bf16 v[84:87], v[116:119], v[48:51], v[84:87]
    ds_read_b64_tr_b16 v[132:133], v145 offset:4096
    v_mfma_f32_16x16x32_bf16 v[100:103], v[116:119], v[52:55], v[100:103]
    ds_read_b64_tr_b16 v[134:135], v145 offset:6144
    s_waitcnt lgkmcnt(6)
    v_mfma_f32_16x16x32_bf16 v[88:91], v[120:123], v[48:51], v[88:91]
    ds_read_b64_tr_b16 v[136:137], v146 offset:4096
    v_mfma_f32_16x16x32_bf16 v[104:107], v[120:123], v[52:55], v[104:107]
    ds_read_b64_tr_b16 v[138:139], v146 offset:6144
    s_waitcnt lgkmcnt(6)
    v_mfma_f32_16x16x32_bf16 v[92:95], v[124:127], v[48:51], v[92:95]
    ds_read_b64_tr_b16 v[140:141], v147 offset:4096
    v_mfma_f32_16x16x32_bf16 v[108:111], v[124:127], v[52:55], v[108:111]
    ds_read_b64_tr_b16 v[142:143], v147 offset:6144
    s_not_b32 s91, s66
    s_cmp_eq_u32 s65, 0
    s_cselect_b32 s65, s91, s65
    s_cselect_b32 s66, -1, s66
    s_ff1_i32_b32 s91, s65
    s_bitset0_b32 s65, s91
    s_lshl_b32 s76, s91, 12
    s_lshl_b32 s91, s91, 10
    buffer_load_dwordx4 v[16:19], v157, s[16:19], s91 offen offset:0 sc1
    buffer_load_dwordx4 v[20:23], v158, s[16:19], s91 offen offset:0 sc1
    s_waitcnt vmcnt(6) lgkmcnt(6)
L_b_c5:
    v_max_u32 v4, v59, v63
    v_cmp_eq_u32 vcc, -1, v4
    s_cbranch_vccnz L_b_g5
L_b_d5:
    v_mfma_f32_16x16x32_bf16 v[80:83], v[128:131], v[56:59], v[80:83]
    s_xor_b32 s89, s67, s79
    s_mov_b32 s67, s79
    v_xor_b32 v144, s89, v144
    ds_read_b64_tr_b16 v[112:113], v144 offset:0
    v_mfma_f32_16x16x32_bf16 v[96:99], v[128:131], v[60:63], v[96:99]
    ds_read_b64_tr_b16 v[114:115], v144 offset:2048
    s_waitcnt lgkmcnt(6)
    v_mfma_f32_16x16x32_bf16 v[84:87], v[132:135], v[56:59], v[84:87]
    v_xor_b32 v145, s89, v145
    ds_read_b64_tr_b16 v[116:117], v145 offset:0
    v_mfma_f32_16x16x32_bf16 v[100:103], v[132:135], v[60:63], v[100:103]
    ds_read_b64_tr_b16 v[118:119], v145 offset:2048
    s_waitcnt lgkmcnt(6)
    v_mfma_f32_16x16x32_bf16 v[88:91], v[136:139], v[56:59], v[88:91]
    v_xor_b32 v146, s89, v146
    ds_read_b64_tr_b16 v[120:121], v146 offset:0
    v_mfma_f32_16x16x32_bf16 v[104:107], v[136:139], v[60:63], v[104:107]
    ds_read_b64_tr_b16 v[122:123], v146 offset:2048
    s_waitcnt lgkmcnt(6)
    v_mfma_f32_16x16x32_bf16 v[92:95], v[140:143], v[56:59], v[92:95]
    v_xor_b32 v147, s89, v147
    ds_read_b64_tr_b16 v[124:125], v147 offset:0
    v_mfma_f32_16x16x32_bf16 v[108:111], v[140:143], v[60:63], v[108:111]
    ds_read_b64_tr_b16 v[126:127], v147 offset:2048
    buffer_load_dwordx4 v[24:27], v157, s[16:19], s91 offen offset:1024 sc1
    buffer_load_dwordx4 v[28:31], v158, s[16:19], s91 offen offset:1024 sc1
    s_setprio 0
    s_waitcnt vmcnt(6) lgkmcnt(6)
L_b_c6:
    v_max_u32 v4, v67, v71
    v_cmp_eq_u32 vcc, -1, v4
    s_cbranch_vccnz L_b_g6
L_b_d6:
    v_mfma_f32_16x16x32_bf16 v[80:83], v[112:115], v[64:67], v[80:83]
    ds_read_b64_tr_b16 v[128:129], v144 offset:4096
    v_mfma_f32_16x16x32_bf16 v[96:99], v[112:115], v[68:71], v[96:99]
    ds_read_b64_tr_b16 v[130:131], v144 offset:6144
    s_waitcnt lgkmcnt(6)
    v_mfma_f32_16x16x32_bf16 v[84:87], v[116:119], v[64:67], v[84:87]
    ds_read_b64_tr_b16 v[132:133], v145 offset:4096
    v_mfma_f32_16x16x32_bf16 v[100:103], v[116:119], v[68:71], v[100:103]
    ds_read_b64_tr_b16 v[134:135], v145 offset:6144
    s_waitcnt lgkmcnt(6)
    v_mfma_f32_16x16x32_bf16 v[88:91], v[120:123], v[64:67], v[88:91]
    ds_read_b64_tr_b16 v[136:137], v146 offset:4096
    v_mfma_f32_16x16x32_bf16 v[104:107], v[120:123], v[68:71], v[104:107]
    ds_read_b64_tr_b16 v[138:139], v146 offset:6144
    s_waitcnt lgkmcnt(6)
    v_mfma_f32_16x16x32_bf16 v[92:95], v[124:127], v[64:67], v[92:95]
    ds_read_b64_tr_b16 v[140:141], v147 offset:4096
    v_mfma_f32_16x16x32_bf16 v[108:111], v[124:127], v[68:71], v[108:111]
    ds_read_b64_tr_b16 v[142:143], v147 offset:6144
    s_not_b32 s91, s66
    s_cmp_eq_u32 s65, 0
    s_cselect_b32 s65, s91, s65
    s_cselect_b32 s66, -1, s66
    s_ff1_i32_b32 s91, s65
    s_bitset0_b32 s65, s91
    s_lshl_b32 s77, s91, 12
    s_lshl_b32 s91, s91, 10
    buffer_load_dwordx4 v[32:35], v157, s[16:19], s91 offen offset:0 sc1
    buffer_load_dwordx4 v[36:39], v158, s[16:19], s91 offen offset:0 sc1
    s_waitcnt vmcnt(6) lgkmcnt(6)
L_b_c7:
    v_max_u32 v4, v75, v79
    v_cmp_eq_u32 vcc, -1, v4
    s_cbranch_vccnz L_b_g7
L_b_d7:
    v_mfma_f32_16x16x32_bf16 v[80:83], v[128:131], v[72:75], v[80:83]
    s_xor_b32 s89, s67, s76
    s_mov_b32 s67, s76
    v_xor_b32 v144, s89, v144
    ds_read_b64_tr_b16 v[112:113], v144 offset:0
    v_mfma_f32_16x16x32_bf16 v[96:99], v[128:131], v[76:79], v[96:99]
    ds_read_b64_tr_b16 v[114:115], v144 offset:2048
    s_waitcnt lgkmcnt(6)
    v_mfma_f32_16x16x32_bf16 v[84:87], v[132:135], v[72:75], v[84:87]
    v_xor_b32 v145, s89, v145
    ds_read_b64_tr_b16 v[116:117], v145 offset:0
    v_mfma_f32_16x16x32_bf16 v[100:103], v[132:135], v[76:79], v[100:103]
    ds_read_b64_tr_b16 v[118:119], v145 offset:2048
    s_waitcnt lgkmcnt(6)
    v_mfma_f32_16x16x32_bf16 v[88:91], v[136:139], v[72:75], v[88:91]
    v_xor_b32 v146, s89, v146
    ds_read_b64_tr_b16 v[120:121], v146 offset:0
    v_mfma_f32_16x16x32_bf16 v[104:107], v[136:139], v[76:79], v[104:107]
    ds_read_b64_tr_b16 v[122:123], v146 offset:2048
    s_waitcnt lgkmcnt(6)
    v_mfma_f32_16x16x32_bf16 v[92:95], v[140:143], v[72:75], v[92:95]
    v_xor_b32 v147, s89, v147
    ds_read_b64_tr_b16 v[124:125], v147 offset:0
    v_mfma_f32_16x16x32_bf16 v[108:111], v[140:143], v[76:79], v[108:111]
    ds_read_b64_tr_b16 v[126:127], v147 offset:2048
    buffer_load_dwordx4 v[40:43], v157, s[16:19], s91 offen offset:1024 sc1
    buffer_load_dwordx4 v[44:47], v158, s[16:19], s91 offen offset:1024 sc1
    s_waitcnt vmcnt(6) lgkmcnt(6)
L_b_c8:
    v_max_u32 v4, v19, v23
    v_cmp_eq_u32 vcc, -1, v4
    s_cbranch_vccnz L_b_g8
L_b_d8:
    v_mfma_f32_16x16x32_bf16 v[80:83], v[112:115], v[16:19], v[80:83]
    ds_read_b64_tr_b16 v[128:129], v144 offset:4096
    v_mfma_f32_16x16x32_bf16 v[96:99], v[112:115], v[20:23], v[96:99]
    ds_read_b64_tr_b16 v[130:131], v144 offset:6144
    s_waitcnt lgkmcnt(6)
    v_mfma_f32_16x16x32_bf16 v[84:87], v[116:119], v[16:19], v[84:87]
    ds_read_b64_tr_b16 v[132:133], v145 offset:4096
    v_mfma_f32_16x16x32_bf16 v[100:103], v[116:119], v[20:23], v[100:103]
    ds_read_b64_tr_b16 v[134:135], v145 offset:6144
    s_waitcnt lgkmcnt(6)
    v_mfma_f32_16x16x32_bf16 v[88:91], v[120:123], v[16:19], v[88:91]
    ds_read_b64_tr_b16 v[136:137], v146 offset:4096
    v_mfma_f32_16x16x32_bf16 v[104:107], v[120:123], v[20:23], v[104:107]
    ds_read_b64_tr_b16 v[138:139], v146 offset:6144
    s_waitcnt lgkmcnt(6)
    v_mfma_f32_16x16x32_bf16 v[92:95], v[124:127], v[16:19], v[92:95]
    ds_read_b64_tr_b16 v[140:141], v147 offset:4096
    v_mfma_f32_16x16x32_bf16 v[108:111], v[124:127], v[20:23], v[108:111]
    ds_read_b64_tr_b16 v[142:143], v147 offset:6144
    s_not_b32 s91, s66
    s_cmp_eq_u32 s65, 0
    s_cselect_b32 s65, s91, s65
    s_cselect_b32 s66, -1, s66
    s_ff1_i32_b32 s91, s65
    s_bitset0_b32 s65, s91
    s_lshl_b32 s78, s91, 12
    s_lshl_b32 s91, s91, 10
    buffer_load_dwordx4 v[48:51], v157, s[16:19], s91 offen offset:0 sc1
    buffer_load_dwordx4 v[52:55], v158, s[16:19], s91 offen offset:0 sc1
    s_waitcnt vmcnt(6) lgkmcnt(6)
L_b_c9:
    v_max_u32 v4, v27, v31
    v_cmp_eq_u32 vcc, -1, v4
    s_cbranch_vccnz L_b_g9
L_walk_17:
    s_cbranch_execz L_walk_21
L_b_d9:
    v_mfma_f32_16x16x32_bf16 v[80:83], v[128:131], v[24:27], v[80:83]
    s_xor_b32 s89, s67, s77
    s_mov_b32 s67, s77
    v_xor_b32 v144, s89, v144
    ds_read_b64_tr_b16 v[112:113], v144 offset:0
    v_mfma_f32_16x16x32_bf16 v[96:99], v[128:131], v[28:31], v[96:99]
    ds_read_b64_tr_b16 v[114:115], v144 offset:2048
    s_waitcnt lgkmcnt(6)
    v_mfma_f32_16x16x32_bf16 v[84:87], v[132:135], v[24:27], v[84:87]
    v_xor_b32 v145, s89, v145
    ds_read_b64_tr_b16 v[116:117], v145 offset:0
    v_mfma_f32_16x16x32_bf16 v[100:103], v[132:135], v[28:31], v[100:103]
    ds_read_b64_tr_b16 v[118:119], v145 offset:2048
    s_waitcnt lgkmcnt(6)
    v_mfma_f32_16x16x32_bf16 v[88:91], v[136:139], v[24:27], v[88:91]
    v_xor_b32 v146, s89, v146
    ds_read_b64_tr_b16 v[120:121], v146 offset:0
    v_mfma_f32_16x16x32_bf16 v[104:107], v[136:139], v[28:31], v[104:107]
    ds_read_b64_tr_b16 v[122:123], v146 offset:2048
    s_waitcnt lgkmcnt(6)
    v_mfma_f32_16x16x32_bf16 v[92:95], v[140:143], v[24:27], v[92:95]
    v_xor_b32 v147, s89, v147
    ds_read_b64_tr_b16 v[124:125], v147 offset:0
    v_mfma_f32_16x16x32_bf16 v[108:111], v[140:143], v[28:31], v[108:111]
    ds_read_b64_tr_b16 v[126:127], v147 offset:2048
    buffer_load_dwordx4 v[56:59], v157, s[16:19], s91 offen offset:1024 sc1
    buffer_load_dwordx4 v[60:63], v158, s[16:19], s91 offen offset:1024 sc1
    s_waitcnt vmcnt(6) lgkmcnt(6)
L_b_c10:
    v_max_u32 v4, v35, v39
    v_cmp_eq_u32 vcc, -1, v4
    s_cbranch_vccnz L_b_g10
L_b_d10:
    v_mfma_f32_16x16x32_bf16 v[80:83], v[112:115], v[32:35], v[80:83]
    ds_read_b64_tr_b16 v[128:129], v144 offset:4096
    v_mfma_f32_16x16x32_bf16 v[96:99], v[112:115], v[36:39], v[96:99]
    ds_read_b64_tr_b16 v[130:131], v144 offset:6144
    s_waitcnt lgkmcnt(6)
    v_mfma_f32_16x16x32_bf16 v[84:87], v[116:119], v[32:35], v[84:87]
    ds_read_b64_tr_b16 v[132:133], v145 offset:4096
    v_mfma_f32_16x16x32_bf16 v[100:103], v[116:119], v[36:39], v[100:103]
    ds_read_b64_tr_b16 v[134:135], v145 offset:6144
    s_waitcnt lgkmcnt(6)
    v_mfma_f32_16x16x32_bf16 v[88:91], v[120:123], v[32:35], v[88:91]
    ds_read_b64_tr_b16 v[136:137], v146 offset:4096
    v_mfma_f32_16x16x32_bf16 v[104:107], v[120:123], v[36:39], v[104:107]
    ds_read_b64_tr_b16 v[138:139], v146 offset:6144
    s_waitcnt lgkmcnt(6)
    v_mfma_f32_16x16x32_bf16 v[92:95], v[124:127], v[32:35], v[92:95]
    ds_read_b64_tr_b16 v[140:141], v147 offset:4096
    v_mfma_f32_16x16x32_bf16 v[108:111], v[124:127], v[36:39], v[108:111]
    ds_read_b64_tr_b16 v[142:143], v147 offset:6144
    s_not_b32 s91, s66
    s_or_b32 s65, s65, s91
    s_ff1_i32_b32 s91, s65
    s_bitset0_b32 s65, s91
    s_lshl_b32 s79, s91, 12
    s_lshl_b32 s91, s91, 10
    buffer_load_dwordx4 v[64:67], v157, s[16:19], s91 offen offset:0 sc1
    buffer_load_dwordx4 v[68:71], v158, s[16:19], s91 offen offset:0 sc1
    s_waitcnt vmcnt(6) lgkmcnt(6)
L_b_c11:
    v_max_u32 v4, v43, v47
    v_cmp_eq_u32 vcc, -1, v4
    s_cbranch_vccnz L_b_g11
L_b_d11:
    v_mfma_f32_16x16x32_bf16 v[80:83], v[128:131], v[40:43], v[80:83]
    s_xor_b32 s89, s67, s78
    s_mov_b32 s67, s78
    v_xor_b32 v144, s89, v144
    ds_read_b64_tr_b16 v[112:113], v144 offset:0
    v_mfma_f32_16x16x32_bf16 v[96:99], v[128:131], v[44:47], v[96:99]
    ds_read_b64_tr_b16 v[114:115], v144 offset:2048
    s_waitcnt lgkmcnt(6)
    v_mfma_f32_16x16x32_bf16 v[84:87], v[132:135], v[40:43], v[84:87]
    v_xor_b32 v145, s89, v145
    ds_read_b64_tr_b16 v[116:117], v145 offset:0
    v_mfma_f32_16x16x32_bf16 v[100:103], v[132:135], v[44:47], v[100:103]
    ds_read_b64_tr_b16 v[118:119], v145 offset:2048
    s_waitcnt lgkmcnt(6)
    v_mfma_f32_16x16x32_bf16 v[88:91], v[136:139], v[40:43], v[88:91]
    v_xor_b32 v146, s89, v146
    ds_read_b64_tr_b16 v[120:121], v146 offset:0
    v_mfma_f32_16x16x32_bf16 v[104:107], v[136:139], v[44:47], v[104:107]
    ds_read_b64_tr_b16 v[122:123], v146 offset:2048
    s_waitcnt lgkmcnt(6)
    v_mfma_f32_16x16x32_bf16 v[92:95], v[140:143], v[40:43], v[92:95]
    v_xor_b32 v147, s89, v147
    ds_read_b64_tr_b16 v[124:125], v147 offset:0
    v_mfma_f32_16x16x32_bf16 v[108:111], v[140:143], v[44:47], v[108:111]
    ds_read_b64_tr_b16 v[126:127], v147 offset:2048
    buffer_load_dwordx4 v[72:75], v157, s[16:19], s91 offen offset:1024 sc1
    buffer_load_dwordx4 v[76:79], v158, s[16:19], s91 offen offset:1024 sc1
    s_waitcnt vmcnt(6) lgkmcnt(6)
L_b_c12:
    v_max_u32 v4, v51, v55
    v_cmp_eq_u32 vcc, -1, v4
    s_cbranch_vccnz L_b_g12
L_b_d12:
    v_mfma_f32_16x16x32_bf16 v[80:83], v[112:115], v[48:51], v[80:83]
    ds_read_b64_tr_b16 v[128:129], v144 offset:4096
    v_mfma_f32_16x16x32_bf16 v[96:99], v[112:115], v[52:55], v[96:99]
    ds_read_b64_tr_b16 v[130:131], v144 offset:6144
    s_waitcnt lgkmcnt(6)
    v_mfma_f32_16x16x32_bf16 v[84:87], v[116:119], v[48:51], v[84:87]
    ds_read_b64_tr_b16 v[132:133], v145 offset:4096
    v_mfma_f32_16x16x32_bf16 v[100:103], v[116:119], v[52:55], v[100:103]
    ds_read_b64_tr_b16 v[134:135], v145 offset:6144
    s_waitcnt lgkmcnt(6)
    v_mfma_f32_16x16x32_bf16 v[88:91], v[120:123], v[48:51], v[88:91]
    ds_read_b64_tr_b16 v[136:137], v146 offset:4096
    v_mfma_f32_16x16x32_bf16 v[104:107], v[120:123], v[52:55], v[104:107]
    ds_read_b64_tr_b16 v[138:139], v146 offset:6144
    s_waitcnt lgkmcnt(6)
    v_mfma_f32_16x16x32_bf16 v[92:95], v[124:127], v[48:51], v[92:95]
    ds_read_b64_tr_b16 v[140:141], v147 offset:4096
    v_mfma_f32_16x16x32_bf16 v[108:111], v[124:127], v[52:55], v[108:111]
    ds_read_b64_tr_b16 v[142:143], v147 offset:6144
    s_waitcnt vmcnt(4) lgkmcnt(6)
L_b_c13:
    v_max_u32 v4, v59, v63
    v_cmp_eq_u32 vcc, -1, v4
    s_cbranch_vccnz L_b_g13
L_b_d13:
    v_mfma_f32_16x16x32_bf16 v[80:83], v[128:131], v[56:59], v[80:83]
    s_xor_b32 s89, s67, s79
    s_mov_b32 s67, s79
    v_xor_b32 v144, s89, v144
    ds_read_b64_tr_b16 v[112:113], v144 offset:0
    v_mfma_f32_16x16x32_bf16 v[96:99], v[128:131], v[60:63], v[96:99]
    ds_read_b64_tr_b16 v[114:115], v144 offset:2048
    s_waitcnt lgkmcnt(6)
    v_mfma_f32_16x16x32_bf16 v[84:87], v[132:135], v[56:59], v[84:87]
    v_xor_b32 v145, s89, v145
    ds_read_b64_tr_b16 v[116:117], v145 offset:0
    v_mfma_f32_16x16x32_bf16 v[100:103], v[132:135], v[60:63], v[100:103]
    ds_read_b64_tr_b16 v[118:119], v145 offset:2048
    s_waitcnt lgkmcnt(6)
    v_mfma_f32_16x16x32_bf16 v[88:91], v[136:139], v[56:59], v[88:91]
    v_xor_b32 v146, s89, v146
    ds_read_b64_tr_b16 v[120:121], v146 offset:0
    v_mfma_f32_16x16x32_bf16 v[104:107], v[136:139], v[60:63], v[104:107]
    ds_read_b64_tr_b16 v[122:123], v146 offset:2048
    s_waitcnt lgkmcnt(6)
    v_mfma_f32_16x16x32_bf16 v[92:95], v[140:143], v[56:59], v[92:95]
    v_xor_b32 v147, s89, v147
    ds_read_b64_tr_b16 v[124:125], v147 offset:0
    v_mfma_f32_16x16x32_bf16 v[108:111], v[140:143], v[60:63], v[108:111]
    ds_read_b64_tr_b16 v[126:127], v147 offset:2048
    s_waitcnt vmcnt(2) lgkmcnt(6)
L_b_c14:
    v_max_u32 v4, v67, v71
    v_cmp_eq_u32 vcc, -1, v4
    s_cbranch_vccnz L_b_g14
L_b_d14:
    v_mfma_f32_16x16x32_bf16 v[80:83], v[112:115], v[64:67], v[80:83]
    ds_read_b64_tr_b16 v[128:129], v144 offset:4096
    v_mfma_f32_16x16x32_bf16 v[96:99], v[112:115], v[68:71], v[96:99]
    ds_read_b64_tr_b16 v[130:131], v144 offset:6144
    s_waitcnt lgkmcnt(6)
    v_mfma_f32_16x16x32_bf16 v[84:87], v[116:119], v[64:67], v[84:87]
    ds_read_b64_tr_b16 v[132:133], v145 offset:4096
    v_mfma_f32_16x16x32_bf16 v[100:103], v[116:119], v[68:71], v[100:103]
    ds_read_b64_tr_b16 v[134:135], v145 offset:6144
    s_waitcnt lgkmcnt(6)
    v_mfma_f32_16x16x32_bf16 v[88:91], v[120:123], v[64:67], v[88:91]
    ds_read_b64_tr_b16 v[136:137], v146 offset:4096
    v_mfma_f32_16x16x32_bf16 v[104:107], v[120:123], v[68:71], v[104:107]
    ds_read_b64_tr_b16 v[138:139], v146 offset:6144
    s_waitcnt lgkmcnt(6)
    v_mfma_f32_16x16x32_bf16 v[92:95], v[124:127], v[64:67], v[92:95]
    ds_read_b64_tr_b16 v[140:141], v147 offset:4096
    v_mfma_f32_16x16x32_bf16 v[108:111], v[124:127], v[68:71], v[108:111]
    ds_read_b64_tr_b16 v[142:143], v147 offset:6144
    s_waitcnt vmcnt(0) lgkmcnt(6)
L_b_c15:
    v_max_u32 v4, v75, v79
    v_cmp_eq_u32 vcc, -1, v4
    s_cbranch_vccnz L_b_g15
L_b_d15:
    v_cmp_eq_u32 vcc, -1, v156
L_walk_18:
    s_cbranch_execz L_walk_22
    s_cbranch_vccz L_ok_3
    s_sub_u32 s56, s56, 1
    s_cbranch_scc0 L_b_restart
    s_mov_b32 s56, 0
L_ok_3:
    v_mfma_f32_16x16x32_bf16 v[80:83], v[128:131], v[72:75], v[80:83]
    s_mov_b32 s90, 71680
    buffer_load_dwordx4 v[204:207], v11, s[32:35], s90 offen
    v_mfma_f32_16x16x32_bf16 v[96:99], v[128:131], v[76:79], v[96:99]
    s_mov_b32 s90, 78848
    buffer_load_dwordx4 v[208:211], v11, s[32:35], s90 offen
    s_waitcnt lgkmcnt(4)
    v_mfma_f32_16x16x32_bf16 v[84:87], v[132:135], v[72:75], v[84:87]
    v_mfma_f32_16x16x32_bf16 v[100:103], v[132:135], v[76:79], v[100:103]
    s_mov_b32 s90, 86016
    buffer_load_dwordx4 v[212:215], v11, s[32:35], s90 offen
    s_waitcnt lgkmcnt(2)
    v_mfma_f32_16x16x32_bf16 v[88:91], v[136:139], v[72:75], v[88:91]
    s_mov_b32 s90, 93184
    buffer_load_dwordx4 v[216:219], v11, s[32:35], s90 offen
    v_mfma_f32_16x16x32_bf16 v[104:107], v[136:139], v[76:79], v[104:107]
    s_mov_b32 s90, 100352
    buffer_load_dwordx4 v[220:223], v11, s[32:35], s90 offen
    s_waitcnt lgkmcnt(0)
    v_mfma_f32_16x16x32_bf16 v[92:95], v[140:143], v[72:75], v[92:95]
    v_mfma_f32_16x16x32_bf16 v[108:111], v[140:143], v[76:79], v[108:111]
    s_mov_b32 s90, 107520
    buffer_load_dwordx4 v[224:227], v11, s[32:35], s90 offen
    ds_write_b128 v162, v[96:99] offset:0
    ds_write_b128 v162, v[100:103] offset:1024
    ds_write_b128 v162, v[104:107] offset:2048
    s_nop 2
    ds_write_b128 v162, v[108:111] offset:3072
    s_waitcnt lgkmcnt(0)
    s_barrier
    ds_read_b128 v[16:19], v163 offset:0
    ds_read_b128 v[20:23], v163 offset:1024
    ds_read_b128 v[24:27], v163 offset:2048
    ds_read_b128 v[28:31], v163 offset:3072
    s_waitcnt lgkmcnt(3)
    v_pk_add_f32 v[80:81], v[80:81], v[16:17]
    v_pk_add_f32 v[82:83], v[82:83], v[18:19]
    v_cvt_pk_bf16_f32 v32, v80, v81
    v_cvt_pk_bf16_f32 v33, v82, v83
    s_waitcnt lgkmcnt(2)
    v_pk_add_f32 v[84:85], v[84:85], v[20:21]
    v_pk_add_f32 v[86:87], v[86:87], v[22:23]
    v_cvt_pk_bf16_f32 v34, v84, v85
    v_cvt_pk_bf16_f32 v35, v86, v87
    s_waitcnt lgkmcnt(1)
    v_pk_add_f32 v[88:89], v[88:89], v[24:25]
    v_pk_add_f32 v[90:91], v[90:91], v[26:27]
    v_cvt_pk_bf16_f32 v36, v88, v89
    v_cvt_pk_bf16_f32 v37, v90, v91
    s_waitcnt lgkmcnt(0)
    v_pk_add_f32 v[92:93], v[92:93], v[28:29]
    v_pk_add_f32 v[94:95], v[94:95], v[30:31]
    v_cvt_pk_bf16_f32 v38, v92, v93
    v_cvt_pk_bf16_f32 v39, v94, v95
    v_mfma_f32_16x16x32_bf16 v[60:63], v[32:35], v[32:35], 0
    v_mfma_f32_16x16x32_bf16 v[56:59], v[32:35], v[148:151], 0
    v_mfma_f32_16x16x32_bf16 v[60:63], v[36:39], v[36:39], v[60:63]
    v_mfma_f32_16x16x32_bf16 v[56:59], v[36:39], v[152:155], v[56:59]
    v_lshlrev_b32 v40, 16, v32
    v_and_b32 v41, 0xffff0000, v32
    v_lshlrev_b32 v42, 16, v33
    v_and_b32 v43, 0xffff0000, v33
    v_lshlrev_b32 v44, 16, v34
    v_and_b32 v45, 0xffff0000, v34
    s_nop 1
    v_cndmask_b32 v56, v56, v60, s[72:73]
    v_cndmask_b32 v57, v57, v61, s[72:73]
    v_cndmask_b32 v58, v58, v62, s[72:73]
    v_cndmask_b32 v59, v59, v63, s[72:73]
    v_cndmask_b32 v56, v56, v57, s[4:5]
    v_cndmask_b32 v58, v58, v59, s[98:99]
    s_or_b64 vcc, s[6:7], s[98:99]
    v_cndmask_b32 v56, v56, v58, vcc
    v_cndmask_b32 v56, v56, 1.0, s[74:75]
    v_mov_b32 v67, v56
    buffer_atomic_add_f32 v67, v160, s[16:19], 0 offen sc0 sc1
    s_mov_b32 s90, 0
    buffer_load_dwordx4 v[228:231], v14, s[36:39], s90 offen
    s_mov_b32 s90, 2048
    buffer_load_dwordx4 v[232:235], v14, s[36:39], s90 offen
    s_mov_b32 s90, 4096
    buffer_load_dwordx4 v[236:239], v14, s[36:39], s90 offen
    s_lshl_b32 s86, s3, 11
    s_add_u32 s86, s86, 69632
    v_lshl_add_u32 v150, v0, 4, s86
    ds_write_b128 v150, v[32:35]
    ds_write_b128 v150, v[36:39] offset:1024
    s_lshl_b32 s86, s3, 7
    s_add_u32 s86, s86, 66560
    v_lshl_add_u32 v151, v2, 3, s86
    s_cmp_eq_u32 s62, 0
    s_cbranch_scc1 L_unp
    v_and_b32 v24, 1, v0
    v_cmp_eq_u32 vcc, 1, v24
    v_mov_b32 v24, 0x0c0c0100
    v_mov_b32 v25, 0x01000c0c
    v_cndmask_b32 v16, v24, v25, vcc
    v_mov_b32 v24, 0x0c0c0302
    v_mov_b32 v25, 0x03020c0c
    v_cndmask_b32 v17, v24, v25, vcc
    v_bfe_u32 v24, v0, 1, 2
    v_mov_b32 v25, 0x0c0c0c0c
    v_cmp_eq_u32 vcc, 0, v24
    s_nop 1
    v_cndmask_b32 v72, v25, v16, vcc
    v_cndmask_b32 v76, v25, v17, vcc
    v_cmp_eq_u32 vcc, 1, v24
    s_nop 1
    v_cndmask_b32 v73, v25, v16, vcc
    v_cndmask_b32 v77, v25, v17, vcc
    v_cmp_eq_u32 vcc, 2, v24
    s_nop 1
    v_cndmask_b32 v74, v25, v16, vcc
    v_cndmask_b32 v78, v25, v17, vcc
    v_cmp_eq_u32 vcc, 3, v24
    s_nop 1
    v_cndmask_b32 v75, v25, v16, vcc
    v_cndmask_b32 v79, v25, v17, vcc
    s_lshl_b32 s86, s48, 10
    s_add_u32 s86, s86, 90112
    v_lshl_add_u32 v18, v0, 4, s86
    s_and_b32 s86, s48, 1
    s_cselect_b32 s87, s81, s80
    s_lshr_b32 s90, s48, 1
    s_and_b32 s88, s82, 1
    s_and_b32 s89, s82, 6
    s_lshl3_add_u32 s88, s88, s89
    s_add_u32 s88, s88, s90
    s_mul_i32 s88, s88, 56
    s_add_u32 s88, s88, s87
    s_lshl_b32 s88, s88, 8
    s_add_u32 s88, s88, 7864320
    s_cmp_lt_u32 s87, 56
    s_cselect_b32 s88, s88, 2147483648
    v_lshl_add_u32 v131, v0, 2, s88
    s_lshl2_add_u32 s86, s90, s86
    s_lshl_b32 s86, s86, 7
    s_add_u32 s86, s86, 90112
    v_lshrrev_b32 v16, 3, v0
    v_lshl_add_u32 v133, v16, 4, s86
    v_bfe_u32 v17, v0, 2, 1
    v_lshl_add_u32 v133, v17, 8, v133
    v_and_b32 v17, 3, v0
    v_lshl_add_u32 v133, v17, 2, v133
    s_lshr_b32 s86, s82, 3
    s_lshl2_add_u32 s86, s86, s48
    s_mul_i32 s86, s86, 112
    s_add_u32 s86, s86, 7864320
    v_mul_u32_u24 v16, 14336, v16
    v_and_b32 v17, 7, v0
    v_lshl_add_u32 v137, v17, 4, s86
    v_add_u32 v137, v137, v16
    v_mov_b32 v16, 2147483648
    v_cmp_eq_u32 vcc, 7, v17
    s_nop 1
    v_cndmask_b32 v137, v137, v16, vcc
    s_branch L_unpd
L_unp:
    v_lshlrev_b32 v46, 16, v35
    v_and_b32 v47, 0xffff0000, v35
    v_lshlrev_b32 v48, 16, v36
    v_and_b32 v49, 0xffff0000, v36
    v_lshlrev_b32 v50, 16, v37
    v_and_b32 v51, 0xffff0000, v37
    v_lshlrev_b32 v52, 16, v38
    v_and_b32 v53, 0xffff0000, v38
    v_lshlrev_b32 v54, 16, v39
    v_and_b32 v55, 0xffff0000, v39
L_unpd:
    v_lshrrev_b32 v8, 2, v2
    v_lshlrev_b32 v9, 4, v8
    v_sub_u32 v9, v161, v9
    v_cmp_eq_u32 vcc, 0, v8
L_walk_19:
    s_cbranch_execz L_walk_23
    s_nop 1
    v_cndmask_b32 v10, 0, 32, vcc
    v_add_u32 v10, v9, v10
    v_cmp_eq_u32 vcc, 1, v8
    s_nop 1
    v_cndmask_b32 v8, 16, 48, vcc
    v_add_u32 v9, v9, v8
    s_lshl_b32 s86, s52, 11
    s_lshr_b32 s87, s51, 3
    s_lshl_b32 s87, s87, 6
    s_add_u32 s86, s86, s87
    s_and_b32 s87, s51, 7
    s_lshl3_add_u32 s86, s87, s86
    s_add_u32 s86, s86, 6684672
    v_lshl_add_u32 v149, v0, 7, s86
    v_mov_b32 v8, 2147483648
    v_cmp_gt_u32 vcc, 16, v0
    s_nop 1
    v_cndmask_b32 v149, v8, v149, vcc
    s_bfe_u32 s67, s82, 0x20001
    s_lshl2_add_u32 s67, s67, s48
    s_and_b32 s87, s2, 15
    s_lshl_b32 s86, s67, 4
    s_add_u32 s86, s86, s87
    s_lshl_b32 s86, s86, 7
    s_add_u32 s86, s86, 6684672
    v_lshl_add_u32 v148, v0, 3, s86
    v_mov_b32 v8, 2147483648
    v_cmp_gt_u32 vcc, 16, v0
    s_nop 1
    v_cndmask_b32 v148, v8, v148, vcc
    s_lshl_b32 s67, s67, 7
    s_add_u32 s67, s67, 6619136
    s_waitcnt vmcnt(3)
    v_add_f32 v67, v67, v56
    s_branch L_h3_chk
L_h3:
    v_mov_b32 v67, 0
    buffer_atomic_or v67, v160, s[16:19], 0 offen sc0 sc1
    s_waitcnt vmcnt(0)
L_h3_chk:
    v_cmp_ne_u32 vcc, 0x41800000, v67
    s_nop 0
    s_and_b64 vcc, vcc, s[74:75]
    s_cbranch_vccz L_ok_4
    s_sub_u32 s56, s56, 1
    s_cbranch_scc0 L_h3
    s_mov_b32 s56, 0
L_ok_4:
    ds_bpermute_b32 v64, v10, v67
    ds_bpermute_b32 v66, v161, v67
    ds_bpermute_b32 v65, v9, v67
    s_cmp_eq_u32 s62, 0
    s_cbranch_scc1 L_nop0
    v_mov_b32 v128, 0
    v_mov_b32 v129, 0
    buffer_atomic_or_x2 v[128:129], v148, s[16:19], 0 offen sc0 sc1
L_nop0:
    s_waitcnt lgkmcnt(0)
    v_mul_f32 v64, 0x3a800000, v64
    v_mul_f32 v66, 0x3a800000, v66
    v_fma_f32 v66, -v64, v64, v66
    v_max_f32 v66, 0, v66
    v_cvt_pk_bf16_f32 v69, v64, v66
    v_lshlrev_b32 v68, 16, v69
    v_and_b32 v69, 0xffff0000, v69
    v_add_f32 v69, 0x3727c5ac, v69
    v_cvt_pk_bf16_f32 v69, v69, v69
    v_lshlrev_b32 v69, 16, v69
    v_sqrt_f32 v69, v69
    s_nop 0
    v_cvt_pk_bf16_f32 v69, v69, v69
    v_lshlrev_b32 v69, 16, v69
    v_rcp_f32 v70, v69
    v_fma_f32 v12, -v68, s57, v65
    v_mul_f32 v12, v12, v70
    v_mul_f32 v71, -v68, v70
    v_cvt_pk_bf16_f32 v12, v12, v12
    v_ashrrev_i32 v8, 31, v12
    v_or_b32 v8, 0x80000000, v8
    v_xor_b32 v8, v8, v12
    v_and_b32 v8, 4294901760, v8
    v_or_b32 v13, v8, v6
    s_lshl_b32 s86, s3, 6
    s_add_u32 s86, s86, 65536
    v_lshl_add_u32 v8, v2, 2, s86
    ds_write_b32 v8, v13
    ds_write_b64 v151, v[70:71]
    v_mov_b32 v152, v8
    s_cmp_lg_u32 s62, 0
    s_cbranch_scc1 L_nohn
    v_pk_fma_f32 v[16:17], v[40:41], v[70:71], v[70:71] op_sel:[0,0,1] op_sel_hi:[1,0,1]
    v_pk_fma_f32 v[18:19], v[42:43], v[70:71], v[70:71] op_sel:[0,0,1] op_sel_hi:[1,0,1]
    v_pk_fma_f32 v[20:21], v[44:45], v[70:71], v[70:71] op_sel:[0,0,1] op_sel_hi:[1,0,1]
    v_pk_fma_f32 v[22:23], v[46:47], v[70:71], v[70:71] op_sel:[0,0,1] op_sel_hi:[1,0,1]
    v_pk_fma_f32 v[24:25], v[48:49], v[70:71], v[70:71] op_sel:[0,0,1] op_sel_hi:[1,0,1]
    v_pk_fma_f32 v[26:27], v[50:51], v[70:71], v[70:71] op_sel:[0,0,1] op_sel_hi:[1,0,1]
    v_pk_fma_f32 v[28:29], v[52:53], v[70:71], v[70:71] op_sel:[0,0,1] op_sel_hi:[1,0,1]
    v_pk_fma_f32 v[30:31], v[54:55], v[70:71], v[70:71] op_sel:[0,0,1] op_sel_hi:[1,0,1]
L_nohn:
    v_lshlrev_b32 v8, 3, v0
    v_add_u32 v8, 65536, v8
    s_waitcnt lgkmcnt(0)
    s_barrier
    ds_read_b64 v[64:65], v8
    s_cmp_lg_u32 s62, 0
    s_cbranch_scc1 L_t3_ld
    ds_read_b32 v144, v152 offset:256
    ds_read_b64 v[142:143], v151 offset:512
    ds_read_b128 v[112:115], v150 offset:8192
    ds_read_b128 v[116:119], v150 offset:9216
    v_cvt_pk_bf16_f32 v96, v16, v17
    v_cvt_pk_bf16_f32 v97, v18, v19
    v_cvt_pk_bf16_f32 v98, v20, v21
    v_cvt_pk_bf16_f32 v99, v22, v23
    v_cvt_pk_bf16_f32 v100, v24, v25
    v_cvt_pk_bf16_f32 v101, v26, v27
    v_cvt_pk_bf16_f32 v102, v28, v29
    v_cvt_pk_bf16_f32 v103, v30, v31
    s_waitcnt lgkmcnt(4)
    v_max_u32 v66, v64, v65
    v_min_u32 v67, v64, v65
    s_nop 0
    v_min_u32_dpp v64, v66, v66 row_ror:8 row_mask:0xf bank_mask:0xf
    v_max_u32_dpp v66, v66, v66 row_ror:8 row_mask:0xf bank_mask:0xf
    v_max_u32_dpp v65, v67, v67 row_ror:8 row_mask:0xf bank_mask:0xf
    v_max_u32 v67, v64, v65
    v_min_u32_dpp v64, v66, v66 row_ror:4 row_mask:0xf bank_mask:0xf
    v_max_u32_dpp v66, v66, v66 row_ror:4 row_mask:0xf bank_mask:0xf
    v_max_u32_dpp v65, v67, v67 row_ror:4 row_mask:0xf bank_mask:0xf
    v_max_u32 v67, v64, v65
    v_min_u32_dpp v64, v66, v66 row_ror:2 row_mask:0xf bank_mask:0xf
    v_max_u32_dpp v66, v66, v66 row_ror:2 row_mask:0xf bank_mask:0xf
    v_max_u32_dpp v65, v67, v67 row_ror:2 row_mask:0xf bank_mask:0xf
    v_max_u32 v67, v64, v65
    v_min_u32_dpp v64, v66, v66 row_ror:1 row_mask:0xf bank_mask:0xf
    v_max_u32_dpp v66, v66, v66 row_ror:1 row_mask:0xf bank_mask:0xf
    v_max_u32_dpp v65, v67, v67 row_ror:1 row_mask:0xf bank_mask:0xf
    v_max_u32 v67, v64, v65
    v_readlane_b32 s58, v66, 0
    v_readlane_b32 s59, v67, 0
    v_readlane_b32 s86, v66, 16
    v_readlane_b32 s87, v67, 16
    s_nop 0
    s_max_u32 s59, s59, s87
    s_min_u32 s87, s58, s86
    s_max_u32 s58, s58, s86
    s_max_u32 s59, s59, s87
    v_readlane_b32 s86, v66, 32
    v_readlane_b32 s87, v67, 32
    s_nop 0
    s_max_u32 s59, s59, s87
    s_min_u32 s87, s58, s86
    s_max_u32 s58, s58, s86
    s_max_u32 s59, s59, s87
    v_readlane_b32 s86, v66, 48
    v_readlane_b32 s87, v67, 48
    s_nop 0
    s_max_u32 s59, s59, s87
    s_min_u32 s87, s58, s86
    s_max_u32 s58, s58, s86
    s_max_u32 s59, s59, s87
    s_cmp_lg_u32 s3, 0
    s_cbranch_scc1 L_nokey
    v_mov_b32 v8, s58
    v_mov_b32 v9, s59
    buffer_atomic_swap_x2 v[8:9], v149, s[16:19], 0 offen sc1
L_nokey:
    v_cmp_eq_u32 s[4:5], s58, v13
    v_cmp_eq_u32 s[6:7], s59, v13
    s_nop 0
    s_or_b64 s[96:97], s[4:5], s[6:7]
    s_cbranch_scc0 L_nocand
    s_lshl_b32 s86, s51, 12
    s_lshl_b32 s87, s52, 7
    s_add_u32 s86, s86, s87
    s_add_u32 s86, s86, 6619136
    v_lshl_add_u32 v8, v1, 3, s86
    v_add_u32 v9, 2048, v8
    v_cndmask_b32 v8, v8, v9, s[6:7]
    v_mov_b32 v9, 2147483648
    v_cndmask_b32 v8, v9, v8, s[96:97]
    buffer_store_dwordx2 v[96:97], v8, s[16:19], 0 offen offset:0 sc1
    buffer_store_dwordx2 v[98:99], v8, s[16:19], 0 offen offset:32 sc1
    buffer_store_dwordx2 v[100:101], v8, s[16:19], 0 offen offset:64 sc1
    buffer_store_dwordx2 v[102:103], v8, s[16:19], 0 offen offset:96 sc1
    v_subrev_u32 v131, 65536, v8
L_nocand:
    s_waitcnt lgkmcnt(0)
L_walk_20:
    s_cbranch_execz L_walk_24
    v_lshlrev_b32 v80, 16, v112
    v_and_b32 v81, 0xffff0000, v112
    v_lshlrev_b32 v82, 16, v113
    v_and_b32 v83, 0xffff0000, v113
    v_lshlrev_b32 v84, 16, v114
    v_and_b32 v85, 0xffff0000, v114
    v_lshlrev_b32 v86, 16, v115
    v_and_b32 v87, 0xffff0000, v115
    v_lshlrev_b32 v88, 16, v116
    v_and_b32 v89, 0xffff0000, v116
    v_lshlrev_b32 v90, 16, v117
    v_and_b32 v91, 0xffff0000, v117
    v_lshlrev_b32 v92, 16, v118
    v_and_b32 v93, 0xffff0000, v118
    v_lshlrev_b32 v94, 16, v119
    v_and_b32 v95, 0xffff0000, v119
    v_pk_fma_f32 v[16:17], v[80:81], v[142:143], v[142:143] op_sel:[0,0,1] op_sel_hi:[1,0,1]
    v_pk_fma_f32 v[18:19], v[82:83], v[142:143], v[142:143] op_sel:[0,0,1] op_sel_hi:[1,0,1]
    v_pk_fma_f32 v[20:21], v[84:85], v[142:143], v[142:143] op_sel:[0,0,1] op_sel_hi:[1,0,1]
    v_pk_fma_f32 v[22:23], v[86:87], v[142:143], v[142:143] op_sel:[0,0,1] op_sel_hi:[1,0,1]
    v_pk_fma_f32 v[24:25], v[88:89], v[142:143], v[142:143] op_sel:[0,0,1] op_sel_hi:[1,0,1]
    v_pk_fma_f32 v[26:27], v[90:91], v[142:143], v[142:143] op_sel:[0,0,1] op_sel_hi:[1,0,1]
    v_pk_fma_f32 v[28:29], v[92:93], v[142:143], v[142:143] op_sel:[0,0,1] op_sel_hi:[1,0,1]
    v_pk_fma_f32 v[30:31], v[94:95], v[142:143], v[142:143] op_sel:[0,0,1] op_sel_hi:[1,0,1]
    v_cvt_pk_bf16_f32 v132, v16, v17
    v_cvt_pk_bf16_f32 v133, v18, v19
    v_cvt_pk_bf16_f32 v134, v20, v21
    v_cvt_pk_bf16_f32 v135, v22, v23
    v_cvt_pk_bf16_f32 v136, v24, v25
    v_cvt_pk_bf16_f32 v137, v26, v27
    v_cvt_pk_bf16_f32 v138, v28, v29
    v_cvt_pk_bf16_f32 v139, v30, v31
    v_cmp_eq_u32 s[4:5], s58, v144
    v_cmp_eq_u32 s[6:7], s59, v144
    s_nop 0
    s_or_b64 s[70:71], s[4:5], s[6:7]
    s_cbranch_scc0 L_nocand2
    s_lshl_b32 s86, s51, 12
    s_lshl_b32 s87, s52, 7
    s_add_u32 s86, s86, s87
    s_add_u32 s86, s86, 6619136
    v_lshl_add_u32 v8, v1, 3, s86
    v_add_u32 v9, 2048, v8
    v_cndmask_b32 v8, v8, v9, s[6:7]
    v_mov_b32 v9, 2147483648
    v_cndmask_b32 v8, v9, v8, s[70:71]
    buffer_store_dwordx2 v[132:133], v8, s[16:19], 0 offen offset:0 sc1
    buffer_store_dwordx2 v[134:135], v8, s[16:19], 0 offen offset:32 sc1
    buffer_store_dwordx2 v[136:137], v8, s[16:19], 0 offen offset:64 sc1
    buffer_store_dwordx2 v[138:139], v8, s[16:19], 0 offen offset:96 sc1
    v_subrev_u32 v140, 65536, v8
L_nocand2:
    v_mov_b32 v9, 2147483648
    v_xor_b32 v6, 0x8000, v5
    v_lshlrev_b32 v16, 16, v96
    v_and_b32 v17, 0xffff0000, v96
    v_lshlrev_b32 v18, 16, v97
    v_and_b32 v19, 0xffff0000, v97
    v_lshlrev_b32 v20, 16, v98
    v_and_b32 v21, 0xffff0000, v98
    v_lshlrev_b32 v22, 16, v99
    v_and_b32 v23, 0xffff0000, v99
    v_lshlrev_b32 v24, 16, v100
    v_and_b32 v25, 0xffff0000, v100
    v_lshlrev_b32 v26, 16, v101
    v_and_b32 v27, 0xffff0000, v101
    v_lshlrev_b32 v28, 16, v102
    v_and_b32 v29, 0xffff0000, v102
    v_lshlrev_b32 v30, 16, v103
    v_and_b32 v31, 0xffff0000, v103
    v_pk_add_f32 v[16:17], v[16:17], v[40:41]
    v_pk_add_f32 v[18:19], v[18:19], v[42:43]
    v_pk_add_f32 v[20:21], v[20:21], v[44:45]
    v_pk_add_f32 v[22:23], v[22:23], v[46:47]
    v_pk_add_f32 v[24:25], v[24:25], v[48:49]
    v_pk_add_f32 v[26:27], v[26:27], v[50:51]
    v_pk_add_f32 v[28:29], v[28:29], v[52:53]
    v_pk_add_f32 v[30:31], v[30:31], v[54:55]
    v_cvt_pk_bf16_f32 v104, v16, v17
    v_cvt_pk_bf16_f32 v105, v18, v19
    v_cvt_pk_bf16_f32 v106, v20, v21
    v_cvt_pk_bf16_f32 v107, v22, v23
    v_cvt_pk_bf16_f32 v108, v24, v25
    v_cvt_pk_bf16_f32 v109, v26, v27
    v_cvt_pk_bf16_f32 v110, v28, v29
    v_cvt_pk_bf16_f32 v111, v30, v31
    v_permlane16_swap_b32 v104, v106
    v_permlane16_swap_b32 v105, v107
    v_permlane16_swap_b32 v108, v110
    v_permlane16_swap_b32 v109, v111
    v_mov_b32 v16, v104
    v_mov_b32 v17, v105
    v_mov_b32 v18, v106
    v_mov_b32 v19, v107
    v_mov_b32_dpp v104, v108 row_ror:8 row_mask:0xf bank_mask:0xc
    v_mov_b32_dpp v105, v109 row_ror:8 row_mask:0xf bank_mask:0xc
    v_mov_b32_dpp v106, v110 row_ror:8 row_mask:0xf bank_mask:0xc
    v_mov_b32_dpp v107, v111 row_ror:8 row_mask:0xf bank_mask:0xc
    v_mov_b32_dpp v108, v16 row_ror:8 row_mask:0xf bank_mask:0x3
    v_mov_b32_dpp v109, v17 row_ror:8 row_mask:0xf bank_mask:0x3
    v_mov_b32_dpp v110, v18 row_ror:8 row_mask:0xf bank_mask:0x3
    v_mov_b32_dpp v111, v19 row_ror:8 row_mask:0xf bank_mask:0x3
    v_cndmask_b32 v8, v5, v9, s[96:97]
    v_lshlrev_b32 v16, 16, v132
    v_and_b32 v17, 0xffff0000, v132
    v_lshlrev_b32 v18, 16, v133
    v_and_b32 v19, 0xffff0000, v133
    v_lshlrev_b32 v20, 16, v134
    v_and_b32 v21, 0xffff0000, v134
    v_lshlrev_b32 v22, 16, v135
    v_and_b32 v23, 0xffff0000, v135
    v_lshlrev_b32 v24, 16, v136
    v_and_b32 v25, 0xffff0000, v136
    v_lshlrev_b32 v26, 16, v137
    v_and_b32 v27, 0xffff0000, v137
    v_lshlrev_b32 v28, 16, v138
    v_and_b32 v29, 0xffff0000, v138
    v_lshlrev_b32 v30, 16, v139
    v_and_b32 v31, 0xffff0000, v139
    v_pk_add_f32 v[16:17], v[16:17], v[80:81]
    v_pk_add_f32 v[18:19], v[18:19], v[82:83]
    v_pk_add_f32 v[20:21], v[20:21], v[84:85]
    v_pk_add_f32 v[22:23], v[22:23], v[86:87]
    v_pk_add_f32 v[24:25], v[24:25], v[88:89]
    v_pk_add_f32 v[26:27], v[26:27], v[90:91]
    v_pk_add_f32 v[28:29], v[28:29], v[92:93]
    v_pk_add_f32 v[30:31], v[30:31], v[94:95]
    v_cvt_pk_bf16_f32 v120, v16, v17
    v_cvt_pk_bf16_f32 v121, v18, v19
    v_cvt_pk_bf16_f32 v122, v20, v21
    v_cvt_pk_bf16_f32 v123, v22, v23
    v_cvt_pk_bf16_f32 v124, v24, v25
    v_cvt_pk_bf16_f32 v125, v26, v27
    v_cvt_pk_bf16_f32 v126, v28, v29
    v_cvt_pk_bf16_f32 v127, v30, v31
    v_permlane16_swap_b32 v120, v122
    v_permlane16_swap_b32 v121, v123
    v_permlane16_swap_b32 v124, v126
    v_permlane16_swap_b32 v125, v127
    v_mov_b32 v16, v120
    v_mov_b32 v17, v121
    v_mov_b32 v18, v122
    v_mov_b32 v19, v123
    v_mov_b32_dpp v120, v124 row_ror:8 row_mask:0xf bank_mask:0xc
    v_mov_b32_dpp v121, v125 row_ror:8 row_mask:0xf bank_mask:0xc
    v_mov_b32_dpp v122, v126 row_ror:8 row_mask:0xf bank_mask:0xc
    v_mov_b32_dpp v123, v127 row_ror:8 row_mask:0xf bank_mask:0xc
    v_mov_b32_dpp v124, v16 row_ror:8 row_mask:0xf bank_mask:0x3
    v_mov_b32_dpp v125, v17 row_ror:8 row_mask:0xf bank_mask:0x3
    v_mov_b32_dpp v126, v18 row_ror:8 row_mask:0xf bank_mask:0x3
    v_mov_b32_dpp v127, v19 row_ror:8 row_mask:0xf bank_mask:0x3
    s_cmp_eq_u64 s[96:97], 0
    s_cbranch_scc1 L_noha
    buffer_store_dwordx2 v[32:33], v131, s[16:19], 0 offen offset:0 sc1
    buffer_store_dwordx2 v[34:35], v131, s[16:19], 0 offen offset:32 sc1
    buffer_store_dwordx2 v[36:37], v131, s[16:19], 0 offen offset:64 sc1
    buffer_store_dwordx2 v[38:39], v131, s[16:19], 0 offen offset:96 sc1
L_noha:
    s_cmp_eq_u64 s[70:71], 0
    s_cbranch_scc1 L_nohb
    buffer_store_dwordx2 v[112:113], v140, s[16:19], 0 offen offset:0 sc1
    buffer_store_dwordx2 v[114:115], v140, s[16:19], 0 offen offset:32 sc1
    buffer_store_dwordx2 v[116:117], v140, s[16:19], 0 offen offset:64 sc1
    buffer_store_dwordx2 v[118:119], v140, s[16:19], 0 offen offset:96 sc1
L_nohb:
    v_mov_b32 v8, 66304
L_walk_21:
    s_cbranch_execz L_walked
    s_barrier
    ds_read_b64 v[10:11], v8
    s_waitcnt lgkmcnt(0)
    v_cmp_ne_u32 s[4:5], v10, v13
    v_cmp_ne_u32 s[6:7], v11, v13
    s_nop 0
    s_and_b64 s[4:5], s[4:5], s[6:7]
    v_cndmask_b32 v8, v9, v5, s[4:5]
    v_add_u32 v17, 64, v8
    v_mov_b32 v16, v8
    s_nop 1
    v_mov_b32_dpp v16, v17 row_ror:8 row_mask:0xf bank_mask:0xc
    v_mov_b32_dpp v17, v8 row_ror:8 row_mask:0xf bank_mask:0x3
    buffer_store_dwordx4 v[104:107], v16, s[24:27], 0 offen sc1
    buffer_store_dwordx4 v[108:111], v17, s[24:27], 0 offen sc1
    v_cmp_ne_u32 s[4:5], v10, v144
    v_cmp_ne_u32 s[6:7], v11, v144
    s_nop 0
    s_and_b64 s[4:5], s[4:5], s[6:7]
    v_cndmask_b32 v8, v9, v6, s[4:5]
    v_add_u32 v19, 64, v8
    v_mov_b32 v18, v8
    s_nop 1
    v_mov_b32_dpp v18, v19 row_ror:8 row_mask:0xf bank_mask:0xc
    v_mov_b32_dpp v19, v8 row_ror:8 row_mask:0xf bank_mask:0x3
    s_barrier
    s_barrier
    s_barrier
    buffer_store_dwordx4 v[120:123], v18, s[24:27], 0 offen sc1
    buffer_store_dwordx4 v[124:127], v19, s[24:27], 0 offen sc1
    s_branch L_fin
L_t3_ld:
    s_mov_b32 s90, 6144
    buffer_load_dwordx4 v[240:243], v14, s[36:39], s90 offen
    s_mov_b32 s90, 8192
    buffer_load_dwordx4 v[244:247], v14, s[36:39], s90 offen
    s_mov_b32 s90, 10240
    buffer_load_dwordx4 v[248:251], v14, s[36:39], s90 offen
    s_mov_b32 s90, 12288
    buffer_load_dwordx4 v[252:255], v14, s[36:39], s90 offen
    v_bfe_u32 v8, v0, 3, 1
    v_lshl_add_u32 v10, v1, 5, s67
    s_mov_b32 s60, 0
    s_mov_b32 s61, 0
    s_lshl_b32 s63, 1, s51
    s_mov_b32 m0, s51
    s_waitcnt lgkmcnt(0)
    v_max_u32 v98, v64, v65
    v_min_u32 v99, v64, v65
    s_nop 0
    v_min_u32_dpp v96, v98, v98 row_ror:8 row_mask:0xf bank_mask:0xf
    v_max_u32_dpp v98, v98, v98 row_ror:8 row_mask:0xf bank_mask:0xf
    v_max_u32_dpp v97, v99, v99 row_ror:8 row_mask:0xf bank_mask:0xf
    v_max_u32 v99, v96, v97
    v_min_u32_dpp v96, v98, v98 row_ror:4 row_mask:0xf bank_mask:0xf
    v_max_u32_dpp v98, v98, v98 row_ror:4 row_mask:0xf bank_mask:0xf
    v_max_u32_dpp v97, v99, v99 row_ror:4 row_mask:0xf bank_mask:0xf
    v_max_u32 v99, v96, v97
    v_min_u32_dpp v96, v98, v98 row_ror:2 row_mask:0xf bank_mask:0xf
    v_max_u32_dpp v98, v98, v98 row_ror:2 row_mask:0xf bank_mask:0xf
    v_max_u32_dpp v97, v99, v99 row_ror:2 row_mask:0xf bank_mask:0xf
    v_max_u32 v99, v96, v97
    v_min_u32_dpp v96, v98, v98 row_ror:1 row_mask:0xf bank_mask:0xf
    v_max_u32_dpp v98, v98, v98 row_ror:1 row_mask:0xf bank_mask:0xf
    v_max_u32_dpp v97, v99, v99 row_ror:1 row_mask:0xf bank_mask:0xf
    v_max_u32 v99, v96, v97
    v_readlane_b32 s58, v98, 0
    v_readlane_b32 s59, v99, 0
    v_readlane_b32 s86, v98, 16
    v_readlane_b32 s87, v99, 16
    s_nop 0
    s_max_u32 s59, s59, s87
    s_min_u32 s87, s58, s86
    s_max_u32 s58, s58, s86
    s_max_u32 s59, s59, s87
    v_readlane_b32 s86, v98, 32
    v_readlane_b32 s87, v99, 32
    s_nop 0
    s_max_u32 s59, s59, s87
    s_min_u32 s87, s58, s86
    s_max_u32 s58, s58, s86
    s_max_u32 s59, s59, s87
    v_readlane_b32 s86, v98, 48
    v_readlane_b32 s87, v99, 48
    s_nop 0
    s_max_u32 s59, s59, s87
    s_min_u32 s87, s58, s86
    s_max_u32 s58, s58, s86
    s_max_u32 s59, s59, s87
    s_waitcnt vmcnt(4)
    s_branch L_h4_chk0
L_h4_w0:
    s_waitcnt vmcnt(0)
L_h4_chk0:
    v_cmp_eq_u32 vcc, -1, v128
    s_nop 0
    s_andn2_b32 s86, vcc_lo, s63
    s_cbranch_scc0 L_h4_all0
    v_cndmask_b32 v96, v128, 0, vcc
    v_cndmask_b32 v97, v129, 0, vcc
    v_mov_b32 v128, 0
    v_mov_b32 v129, 0
    buffer_atomic_or_x2 v[128:129], v148, s[16:19], 0 offen sc0 sc1
    s_sub_u32 s56, s56, 1
    s_cbranch_scc1 L_h4_out
    v_min_u32_dpp v98, v96, v96 row_ror:8 row_mask:0xf bank_mask:0xf
    v_max_u32_dpp v96, v96, v96 row_ror:8 row_mask:0xf bank_mask:0xf
    v_max_u32_dpp v99, v97, v97 row_ror:8 row_mask:0xf bank_mask:0xf
    v_max_u32 v97, v98, v99
    v_min_u32_dpp v98, v96, v96 row_ror:4 row_mask:0xf bank_mask:0xf
    v_max_u32_dpp v96, v96, v96 row_ror:4 row_mask:0xf bank_mask:0xf
    v_max_u32_dpp v99, v97, v97 row_ror:4 row_mask:0xf bank_mask:0xf
    v_max_u32 v97, v98, v99
    v_min_u32_dpp v98, v96, v96 row_ror:2 row_mask:0xf bank_mask:0xf
    v_max_u32_dpp v96, v96, v96 row_ror:2 row_mask:0xf bank_mask:0xf
    v_max_u32_dpp v99, v97, v97 row_ror:2 row_mask:0xf bank_mask:0xf
    v_max_u32 v97, v98, v99
    v_min_u32_dpp v98, v96, v96 row_ror:1 row_mask:0xf bank_mask:0xf
    v_max_u32_dpp v96, v96, v96 row_ror:1 row_mask:0xf bank_mask:0xf
    v_max_u32_dpp v99, v97, v97 row_ror:1 row_mask:0xf bank_mask:0xf
    v_max_u32 v97, v98, v99
    v_readlane_b32 s70, v96, 0
    v_readlane_b32 s71, v97, 0
    s_nop 0
    s_cmp_eq_u64 s[70:71], s[60:61]
    s_cbranch_scc1 L_h4_w0
    s_mov_b64 s[60:61], s[70:71]
    s_bfe_u32 s86, s60, 0x40007
    s_bfe_u32 s87, s61, 0x40007
    s_sub_u32 s87, s86, s87
    s_lshl_b32 s87, s87, 12
    s_cselect_b32 s69, s87, 2048
    v_mad_i32_i24 v130, v8, s69, v10
    s_xor_b32 s86, s86, 15
    s_lshl_b32 s66, s86, 12
    buffer_load_dwordx4 v[64:67], v130, s[16:19], s66 offen sc1
    buffer_load_dwordx4 v[68:71], v130, s[16:19], s66 offen offset:16 sc1
    s_waitcnt vmcnt(2)
    s_branch L_h4_chk0
L_h4_own:
    s_waitcnt vmcnt(0)
    v_mov_b32 v128, 0
    v_mov_b32 v129, 0
    buffer_atomic_or_x2 v[128:129], v148, s[16:19], 0 offen sc0 sc1
    s_sub_u32 s56, s56, 1
    s_cbranch_scc0 L_h4_w0
L_h4_out:
    s_mov_b32 s56, 0
    s_waitcnt vmcnt(0)
    s_mov_b64 vcc, 0
L_h4_all0:
    v_writelane_b32 v128, s58, m0
    v_writelane_b32 v129, s59, m0
    s_nop 0
    v_min_u32_dpp v98, v128, v128 row_ror:8 row_mask:0xf bank_mask:0xf
    v_max_u32_dpp v96, v128, v128 row_ror:8 row_mask:0xf bank_mask:0xf
    v_max_u32_dpp v99, v129, v129 row_ror:8 row_mask:0xf bank_mask:0xf
    v_max_u32 v97, v98, v99
L_h4_all:
    v_min_u32_dpp v98, v96, v96 row_ror:4 row_mask:0xf bank_mask:0xf
    v_max_u32_dpp v96, v96, v96 row_ror:4 row_mask:0xf bank_mask:0xf
    v_max_u32_dpp v99, v97, v97 row_ror:4 row_mask:0xf bank_mask:0xf
    v_max_u32 v97, v98, v99
    v_min_u32_dpp v98, v96, v96 row_ror:2 row_mask:0xf bank_mask:0xf
    v_max_u32_dpp v96, v96, v96 row_ror:2 row_mask:0xf bank_mask:0xf
    v_max_u32_dpp v99, v97, v97 row_ror:2 row_mask:0xf bank_mask:0xf
    v_max_u32 v97, v98, v99
    v_min_u32_dpp v98, v96, v96 row_ror:1 row_mask:0xf bank_mask:0xf
    v_max_u32_dpp v96, v96, v96 row_ror:1 row_mask:0xf bank_mask:0xf
    v_max_u32_dpp v99, v97, v97 row_ror:1 row_mask:0xf bank_mask:0xf
    v_max_u32 v97, v98, v99
    v_readlane_b32 s70, v96, 0
    v_readlane_b32 s71, v97, 0
    s_nop 0
    s_cmp_ge_u32 s58, s71
    s_cselect_b32 s86, vcc_lo, 0
    s_cmp_lg_u32 s86, 0
    s_cbranch_scc1 L_h4_own
    s_cmp_eq_u64 s[70:71], s[60:61]
    s_cbranch_scc1 L_h4_go
    s_mov_b64 s[60:61], s[70:71]
    s_bfe_u32 s86, s60, 0x40007
    s_bfe_u32 s87, s61, 0x40007
    s_sub_u32 s87, s86, s87
    s_lshl_b32 s87, s87, 12
    s_cselect_b32 s69, s87, 2048
L_walk_22:
    s_cbranch_execz L_walked
    v_mad_i32_i24 v130, v8, s69, v10
    s_xor_b32 s86, s86, 15
    s_lshl_b32 s66, s86, 12
    buffer_load_dwordx4 v[64:67], v130, s[16:19], s66 offen sc1
    buffer_load_dwordx4 v[68:71], v130, s[16:19], s66 offen offset:16 sc1
L_h4_go:
    v_mov_b32 v16, 66304
    v_mov_b32 v24, s60
    v_mov_b32 v25, s61
    ds_write_b64 v16, v[24:25]
    s_waitcnt lgkmcnt(0)
    s_barrier
    s_waitcnt vmcnt(0)
    s_branch L_seg_chk
L_seg:
    buffer_load_dwordx4 v[64:67], v130, s[16:19], s66 offen sc1
    buffer_load_dwordx4 v[68:71], v130, s[16:19], s66 offen offset:16 sc1
    s_waitcnt vmcnt(0)
L_seg_chk:
    v_max3_u32 v16, v65, v67, v69
    v_max_u32 v16, v16, v71
    v_cmp_eq_u32 vcc, -1, v16
    s_cbranch_vccz L_ok_5
    s_sub_u32 s56, s56, 1
    s_cbranch_scc0 L_seg
    s_mov_b32 s56, 0
L_ok_5:
    v_perm_b32 v80, v64, v64, v72
    v_perm_b32 v81, v64, v64, v73
    v_perm_b32 v82, v64, v64, v74
    v_perm_b32 v83, v64, v64, v75
    v_perm_b32 v84, v64, v64, v76
    v_perm_b32 v85, v64, v64, v77
    v_perm_b32 v86, v64, v64, v78
    v_perm_b32 v87, v64, v64, v79
    v_mfma_f32_16x16x32_bf16 v[88:91], v[80:83], v[164:167], 0
    v_perm_b32 v92, v65, v65, v72
    v_perm_b32 v93, v65, v65, v73
    v_perm_b32 v94, v65, v65, v74
    v_perm_b32 v95, v65, v65, v75
    v_mfma_f32_16x16x32_bf16 v[88:91], v[84:87], v[168:171], v[88:91]
    v_perm_b32 v80, v65, v65, v76
    v_perm_b32 v81, v65, v65, v77
    v_perm_b32 v82, v65, v65, v78
    v_perm_b32 v83, v65, v65, v79
    v_mfma_f32_16x16x32_bf16 v[88:91], v[92:95], v[172:175], v[88:91]
    v_perm_b32 v84, v66, v66, v72
    v_perm_b32 v85, v66, v66, v73
    v_perm_b32 v86, v66, v66, v74
    v_perm_b32 v87, v66, v66, v75
    v_mfma_f32_16x16x32_bf16 v[88:91], v[80:83], v[176:179], v[88:91]
    v_perm_b32 v92, v66, v66, v76
    v_perm_b32 v93, v66, v66, v77
    v_perm_b32 v94, v66, v66, v78
    v_perm_b32 v95, v66, v66, v79
    v_mfma_f32_16x16x32_bf16 v[88:91], v[84:87], v[180:183], v[88:91]
    v_perm_b32 v80, v67, v67, v72
    v_perm_b32 v81, v67, v67, v73
    v_perm_b32 v82, v67, v67, v74
    v_perm_b32 v83, v67, v67, v75
    v_mfma_f32_16x16x32_bf16 v[88:91], v[92:95], v[184:187], v[88:91]
    v_perm_b32 v84, v67, v67, v76
    v_perm_b32 v85, v67, v67, v77
    v_perm_b32 v86, v67, v67, v78
    v_perm_b32 v87, v67, v67, v79
    v_mfma_f32_16x16x32_bf16 v[88:91], v[80:83], v[188:191], v[88:91]
    v_perm_b32 v92, v68, v68, v72
    v_perm_b32 v93, v68, v68, v73
    v_perm_b32 v94, v68, v68, v74
    v_perm_b32 v95, v68, v68, v75
    v_mfma_f32_16x16x32_bf16 v[88:91], v[84:87], v[192:195], v[88:91]
    v_perm_b32 v80, v68, v68, v76
    v_perm_b32 v81, v68, v68, v77
    v_perm_b32 v82, v68, v68, v78
    v_perm_b32 v83, v68, v68, v79
    v_mfma_f32_16x16x32_bf16 v[88:91], v[92:95], v[196:199], v[88:91]
    v_perm_b32 v84, v69, v69, v72
    v_perm_b32 v85, v69, v69, v73
    v_perm_b32 v86, v69, v69, v74
    v_perm_b32 v87, v69, v69, v75
    v_mfma_f32_16x16x32_bf16 v[88:91], v[80:83], v[200:203], v[88:91]
    v_perm_b32 v92, v69, v69, v76
    v_perm_b32 v93, v69, v69, v77
    v_perm_b32 v94, v69, v69, v78
    v_perm_b32 v95, v69, v69, v79
    v_mfma_f32_16x16x32_bf16 v[88:91], v[84:87], v[204:207], v[88:91]
    v_perm_b32 v80, v70, v70, v72
    v_perm_b32 v81, v70, v70, v73
    v_perm_b32 v82, v70, v70, v74
    v_perm_b32 v83, v70, v70, v75
    v_mfma_f32_16x16x32_bf16 v[88:91], v[92:95], v[208:211], v[88:91]
    v_perm_b32 v84, v70, v70, v76
    v_perm_b32 v85, v70, v70, v77
    v_perm_b32 v86, v70, v70, v78
    v_perm_b32 v87, v70, v70, v79
    v_mfma_f32_16x16x32_bf16 v[88:91], v[80:83], v[212:215], v[88:91]
    v_perm_b32 v92, v71, v71, v72
    v_perm_b32 v93, v71, v71, v73
    v_perm_b32 v94, v71, v71, v74
    v_perm_b32 v95, v71, v71, v75
    v_mfma_f32_16x16x32_bf16 v[88:91], v[84:87], v[216:219], v[88:91]
    v_perm_b32 v80, v71, v71, v76
    v_perm_b32 v81, v71, v71, v77
    v_perm_b32 v82, v71, v71, v78
    v_perm_b32 v83, v71, v71, v79
    v_mfma_f32_16x16x32_bf16 v[88:91], v[92:95], v[220:223], v[88:91]
    s_nop 0
    v_mfma_f32_16x16x32_bf16 v[88:91], v[80:83], v[224:227], v[88:91]
    s_nop 7
    ds_write_b128 v18, v[88:91]
    s_waitcnt lgkmcnt(0)
    s_barrier
    ds_read2st64_b32 v[24:25], v133 offset0:0 offset1:4
    ds_read2st64_b32 v[26:27], v133 offset0:8 offset1:12
    s_mov_b32 s79, 114688
    s_cmp_eq_u32 s83, 0
    s_waitcnt lgkmcnt(0)
    v_pk_add_f32 v[24:25], v[24:25], v[26:27]
    v_add_f32 v24, v24, v25
    s_cbranch_scc1 L_h5_far
    buffer_store_dword v24, v131, s[16:19], 0 offen
L_h5_out:
    s_lshr_b32 s88, s48, 1
    s_cselect_b32 s86, s69, 0
    s_cselect_b32 s63, s61, s60
    s_and_b32 s87, s48, 1
    s_and_b32 s89, s82, 7
    s_lshl1_add_u32 s87, s89, s87
    s_lshl_b32 s87, s87, 7
    s_add_u32 s86, s86, s66
    s_add_u32 s86, s86, s87
    s_add_u32 s86, s86, 6553600
    v_lshl_add_u32 v142, v0, 1, s86
    v_mov_b32 v140, 0
    v_mov_b32 v141, 0
    s_mov_b32 s65, 65536
    buffer_load_short_d16_hi v140, v142, s[16:19], 0 offen sc1
    buffer_load_short_d16_hi v141, v142, s[16:19], s65 offen sc1
    s_and_b32 s86, s63, 0x7ff
    s_sub_u32 s86, 2047, s86
    s_lshl_b32 s86, s86, 11
    s_add_u32 s86, s86, s87
    v_lshl_add_u32 v143, v0, 1, s86
    s_ashr_i32 s86, s63, 31
    s_orn2_b32 s86, 0x80000000, s86
    s_xor_b32 s63, s63, s86
    s_and_b32 s63, s63, 0xffff0000
    s_lshr_b32 s86, s48, 1
    s_and_b32 s87, s48, 1
    s_lshl_b32 s88, s86, 9
    s_lshl_b32 s89, s87, 7
    s_add_u32 s88, s88, s89
    s_add_u32 s88, s88, 94208
    v_lshrrev_b32 v17, 3, v0
    v_lshl_add_u32 v20, v17, 4, s88
    v_bfe_u32 v9, v0, 2, 1
    v_lshl_add_u32 v20, v9, 8, v20
    v_and_b32 v9, 3, v0
    v_lshl_add_u32 v20, v9, 2, v20
    s_and_b32 s89, s82, 7
    s_lshl3_add_u32 s86, s86, s89
    s_lshl1_add_u32 s86, s86, s87
    s_lshl_b32 s86, s86, 11
    s_add_u32 s86, s86, 917504
    v_lshl_add_u32 v9, v17, 8, s86
L_walk_23:
    s_cbranch_execz L_walked
    v_and_b32 v17, 7, v0
    v_lshl_add_u32 v9, v17, 3, v9
    s_mov_b32 s76, 0
    s_mov_b32 s77, 0x41900000
    s_lshl_b32 s86, s48, 7
    s_add_u32 s86, s86, 100352
    v_lshl_add_u32 v11, v8, 6, s86
    v_lshl_add_u32 v11, v1, 4, v11
    v_and_b32 v16, 7, v0
    v_cmp_eq_u32 vcc, 7, v16
    v_lshl_add_u32 v16, v16, 2, v1
    v_mul_u32_u24 v17, 37, v16
    v_lshrrev_b32 v17, 8, v17
    v_add_u32 v16, v16, v17
    v_lshl_or_b32 v17, v1, 3, 7
    v_cndmask_b32 v16, v16, v17, vcc
    v_lshl_add_u32 v16, v8, 5, v16
    v_lshl_add_u32 v10, v16, 1, s86
    v_mov_b32 v144, s63
    v_mul_f32 v144, 0xbfb8aa3b, v144
    v_exp_f32 v144, v144
    s_nop 0
    v_add_f32 v144, 1.0, v144
    v_rcp_f32 v144, v144
    s_nop 0
    v_cvt_pk_bf16_f32 v144, v144, v144
    v_lshlrev_b32 v144, 16, v144
    s_mov_b32 s6, 0x80808080
    s_mov_b32 s7, 0x80808080
    v_mov_b32 v19, v9
    buffer_load_dwordx4 v[112:115], v137, s[16:19], 0 offen sc1
    buffer_load_dwordx4 v[116:119], v137, s[16:19], s79 offen sc1
    s_waitcnt vmcnt(0)
    s_branch L_h5_chk
L_h5:
    v_cmp_eq_u32 vcc, -1, v115
    s_cbranch_vccz L_h5_s0
    s_mov_b64 exec, vcc
    buffer_load_dwordx4 v[112:115], v137, s[16:19], 0 offen sc1
    s_mov_b64 exec, -1
L_h5_s0:
    v_cmp_eq_u32 vcc, -1, v119
    s_cbranch_vccz L_h5_s1
    s_mov_b64 exec, vcc
    buffer_load_dwordx4 v[116:119], v137, s[16:19], s79 offen sc1
    s_mov_b64 exec, -1
L_h5_s1:
    s_waitcnt vmcnt(0)
L_h5_chk:
    v_max_u32 v16, v115, v119
    v_cmp_eq_u32 vcc, -1, v16
    s_cbranch_vccz L_ok_6
    s_sub_u32 s56, s56, 1
    s_cbranch_scc0 L_h5
    s_mov_b32 s56, 0
L_ok_6:
    v_permlane32_swap_b32 v112, v114
    v_permlane32_swap_b32 v113, v115
    v_permlane32_swap_b32 v116, v118
    v_permlane32_swap_b32 v117, v119
    v_add_f32 v112, v112, v114
    v_add_f32 v113, v113, v115
    v_add_f32 v116, v116, v118
    v_add_f32 v117, v117, v119
    v_permlane16_swap_b32 v112, v113
    s_nop 0
    v_permlane16_swap_b32 v116, v117
    v_add_f32 v112, v112, v113
    v_add_f32 v116, v116, v117
    v_cvt_pk_bf16_f32 v25, v112, v116
    v_lshlrev_b32 v24, 16, v25
    v_and_b32 v28, 0xffff0000, v25
    v_mul_f32 v25, 0xbfb8aa3b, v24
    v_exp_f32 v25, v25
    s_nop 0
    v_add_f32 v25, 1.0, v25
    v_rcp_f32 v25, v25
    s_nop 0
    v_mul_f32 v24, v24, v25
    v_cvt_pk_bf16_f32 v24, v24, v24
    v_lshlrev_b32 v24, 16, v24
    v_mul_f32 v24, v24, v28
    v_cvt_pk_bf16_f32 v24, v24, v24
    ds_write_b16 v10, v24
    s_waitcnt lgkmcnt(0)
    ds_read_b128 v[64:67], v11
    s_waitcnt lgkmcnt(0)
    v_perm_b32 v80, v64, v64, v72
    v_perm_b32 v81, v64, v64, v73
    v_perm_b32 v82, v64, v64, v74
    v_perm_b32 v83, v64, v64, v75
    v_perm_b32 v84, v64, v64, v76
    v_perm_b32 v85, v64, v64, v77
    v_perm_b32 v86, v64, v64, v78
    v_perm_b32 v87, v64, v64, v79
    v_mfma_f32_16x16x32_bf16 v[88:91], v[80:83], v[228:231], 0
    v_perm_b32 v92, v65, v65, v72
    v_perm_b32 v93, v65, v65, v73
    v_perm_b32 v94, v65, v65, v74
    v_perm_b32 v95, v65, v65, v75
    v_mfma_f32_16x16x32_bf16 v[88:91], v[84:87], v[232:235], v[88:91]
    v_perm_b32 v80, v65, v65, v76
    v_perm_b32 v81, v65, v65, v77
    v_perm_b32 v82, v65, v65, v78
    v_perm_b32 v83, v65, v65, v79
    v_mfma_f32_16x16x32_bf16 v[88:91], v[92:95], v[236:239], v[88:91]
    v_perm_b32 v84, v66, v66, v72
    v_perm_b32 v85, v66, v66, v73
    v_perm_b32 v86, v66, v66, v74
    v_perm_b32 v87, v66, v66, v75
    v_mfma_f32_16x16x32_bf16 v[88:91], v[80:83], v[240:243], v[88:91]
    v_perm_b32 v92, v66, v66, v76
    v_perm_b32 v93, v66, v66, v77
    v_perm_b32 v94, v66, v66, v78
    v_perm_b32 v95, v66, v66, v79
    v_mfma_f32_16x16x32_bf16 v[88:91], v[84:87], v[244:247], v[88:91]
    v_perm_b32 v80, v67, v67, v72
    v_perm_b32 v81, v67, v67, v73
    v_perm_b32 v82, v67, v67, v74
    v_perm_b32 v83, v67, v67, v75
    v_mfma_f32_16x16x32_bf16 v[88:91], v[92:95], v[248:251], v[88:91]
    s_nop 0
    v_mfma_f32_16x16x32_bf16 v[88:91], v[80:83], v[252:255], v[88:91]
    s_nop 7
    ds_write_b128 v18, v[88:91] offset:4096
    s_waitcnt lgkmcnt(0)
    s_barrier
    ds_read2st64_b32 v[24:25], v20 offset0:0 offset1:4
    ds_read2st64_b32 v[26:27], v20 offset0:8 offset1:12
    s_waitcnt lgkmcnt(0)
    v_pk_add_f32 v[24:25], v[24:25], v[26:27]
    v_add_f32 v24, v24, v25
    v_cvt_f64_f32 v[26:27], v24
    v_add_f64 v[24:25], v[26:27], s[76:77]
    buffer_atomic_add_f64 v[24:25], v19, s[16:19], 0 offen sc0 sc1
    s_barrier
    s_mov_b32 s77, 0xc1df0000
    v_add_f64 v[26:27], v[26:27], s[76:77]
    s_waitcnt vmcnt(1)
    v_max_u32 v16, v140, v141
    v_cmp_eq_u32 vcc, 0xffff0000, v16
    s_cbranch_vccnz L_fin_ld
L_fin_go:
    s_mov_b32 s88, 0x4c000000
    v_mov_b32 v17, 2147483648
    s_waitcnt vmcnt(0)
    v_add_f64 v[24:25], v[24:25], v[26:27]
    v_cvt_f32_f64 v24, v[24:25]
    v_cmp_lt_f32 vcc, |v24|, s88
    v_cvt_pk_bf16_f32 v24, v24, v24
    v_lshlrev_b32 v24, 16, v24
    v_mul_f32 v24, v24, v144
    v_cndmask_b32 v17, v17, v143, vcc
    v_cvt_pk_bf16_f32 v24, v24, v24
    v_lshlrev_b32 v24, 16, v24
    v_add_f32 v24, v24, v141
    v_cvt_pk_bf16_f32 v24, v24, v24
    v_lshlrev_b32 v24, 16, v24
    v_add_f32 v24, v24, v140
    v_cvt_pk_bf16_f32 v24, v24, v24
    buffer_store_short v24, v17, s[24:27], 0 offen
L_fin:
L_end:
    s_endpgm
L_b_restart:
    s_waitcnt vmcnt(0)
    v_xor_b32 v9, 0x8000, v7
    buffer_load_dwordx4 v[136:139], v7, s[8:11], 0 offen
    buffer_load_dwordx4 v[140:143], v9, s[8:11], 0 offen
    v_mov_b32 v8, s68
    s_mov_b32 s66, 0xffffaaaa
    s_mov_b32 s63, 1
    s_branch L_b_init
L_b_g4:
    s_lshr_b32 s86, s78, 2
    buffer_load_dwordx4 v[48:51], v157, s[16:19], s86 offen offset:0 sc1
    buffer_load_dwordx4 v[52:55], v158, s[16:19], s86 offen offset:0 sc1
    s_waitcnt vmcnt(0)
    s_sub_u32 s56, s56, 1
    s_cbranch_scc0 L_b_c4
    s_mov_b32 s56, 0
    s_branch L_b_d4
L_b_g5:
    s_lshr_b32 s86, s78, 2
    buffer_load_dwordx4 v[56:59], v157, s[16:19], s86 offen offset:1024 sc1
    buffer_load_dwordx4 v[60:63], v158, s[16:19], s86 offen offset:1024 sc1
    s_waitcnt vmcnt(0)
    s_sub_u32 s56, s56, 1
    s_cbranch_scc0 L_b_c5
    s_mov_b32 s56, 0
    s_branch L_b_d5
L_b_g6:
    s_lshr_b32 s86, s79, 2
    buffer_load_dwordx4 v[64:67], v157, s[16:19], s86 offen offset:0 sc1
    buffer_load_dwordx4 v[68:71], v158, s[16:19], s86 offen offset:0 sc1
    s_waitcnt vmcnt(0)
    s_sub_u32 s56, s56, 1
    s_cbranch_scc0 L_b_c6
    s_mov_b32 s56, 0
    s_branch L_b_d6
L_walk_24:
    s_cbranch_execz L_walked
L_b_g7:
    s_lshr_b32 s86, s79, 2
    buffer_load_dwordx4 v[72:75], v157, s[16:19], s86 offen offset:1024 sc1
    buffer_load_dwordx4 v[76:79], v158, s[16:19], s86 offen offset:1024 sc1
    s_waitcnt vmcnt(0)
    s_sub_u32 s56, s56, 1
    s_cbranch_scc0 L_b_c7
    s_mov_b32 s56, 0
    s_branch L_b_d7
L_b_g8:
    s_lshr_b32 s86, s76, 2
    buffer_load_dwordx4 v[16:19], v157, s[16:19], s86 offen offset:0 sc1
    buffer_load_dwordx4 v[20:23], v158, s[16:19], s86 offen offset:0 sc1
    s_waitcnt vmcnt(0)
    s_sub_u32 s56, s56, 1
    s_cbranch_scc0 L_b_c8
    s_mov_b32 s56, 0
    s_branch L_b_d8
L_b_g9:
    s_lshr_b32 s86, s76, 2
    buffer_load_dwordx4 v[24:27], v157, s[16:19], s86 offen offset:1024 sc1
    buffer_load_dwordx4 v[28:31], v158, s[16:19], s86 offen offset:1024 sc1
    s_waitcnt vmcnt(0)
    s_sub_u32 s56, s56, 1
    s_cbranch_scc0 L_b_c9
    s_mov_b32 s56, 0
    s_branch L_b_d9
L_b_g10:
    s_lshr_b32 s86, s77, 2
    buffer_load_dwordx4 v[32:35], v157, s[16:19], s86 offen offset:0 sc1
    buffer_load_dwordx4 v[36:39], v158, s[16:19], s86 offen offset:0 sc1
    s_waitcnt vmcnt(0)
    s_sub_u32 s56, s56, 1
    s_cbranch_scc0 L_b_c10
    s_mov_b32 s56, 0
    s_branch L_b_d10
L_b_g11:
    s_lshr_b32 s86, s77, 2
    buffer_load_dwordx4 v[40:43], v157, s[16:19], s86 offen offset:1024 sc1
    buffer_load_dwordx4 v[44:47], v158, s[16:19], s86 offen offset:1024 sc1
    s_waitcnt vmcnt(0)
    s_sub_u32 s56, s56, 1
    s_cbranch_scc0 L_b_c11
    s_mov_b32 s56, 0
    s_branch L_b_d11
L_b_g12:
    s_lshr_b32 s86, s78, 2
    buffer_load_dwordx4 v[48:51], v157, s[16:19], s86 offen offset:0 sc1
    buffer_load_dwordx4 v[52:55], v158, s[16:19], s86 offen offset:0 sc1
    s_waitcnt vmcnt(0)
    s_sub_u32 s56, s56, 1
    s_cbranch_scc0 L_b_c12
    s_mov_b32 s56, 0
    s_branch L_b_d12
L_b_g13:
    s_lshr_b32 s86, s78, 2
    buffer_load_dwordx4 v[56:59], v157, s[16:19], s86 offen offset:1024 sc1
    buffer_load_dwordx4 v[60:63], v158, s[16:19], s86 offen offset:1024 sc1
    s_waitcnt vmcnt(0)
    s_sub_u32 s56, s56, 1
    s_cbranch_scc0 L_b_c13
    s_mov_b32 s56, 0
    s_branch L_b_d13
L_b_g14:
    s_lshr_b32 s86, s79, 2
    buffer_load_dwordx4 v[64:67], v157, s[16:19], s86 offen offset:0 sc1
    buffer_load_dwordx4 v[68:71], v158, s[16:19], s86 offen offset:0 sc1
    s_waitcnt vmcnt(0)
    s_sub_u32 s56, s56, 1
    s_cbranch_scc0 L_b_c14
    s_mov_b32 s56, 0
    s_branch L_b_d14
L_b_g15:
    s_lshr_b32 s86, s79, 2
    buffer_load_dwordx4 v[72:75], v157, s[16:19], s86 offen offset:1024 sc1
    buffer_load_dwordx4 v[76:79], v158, s[16:19], s86 offen offset:1024 sc1
    s_waitcnt vmcnt(0)
    s_sub_u32 s56, s56, 1
    s_cbranch_scc0 L_b_c15
    s_mov_b32 s56, 0
    s_branch L_b_d15
L_b_p0:
    v_mov_b32 v8, 0
    buffer_atomic_or v8, v159, s[16:19], 0 offen sc0 sc1
L_b_w0:
    s_waitcnt vmcnt(0)
    v_cmp_eq_u32 vcc, s68, v8
    s_nop 0
    s_lshr_b32 s65, vcc_lo, 1
    s_and_b32 s65, s65, vcc_lo
    s_andn2_b32 s65, s65, s66
    s_cbranch_scc0 L_b_q0
    s_or_b32 s66, s66, s65
    s_branch L_b_r0
L_b_q0:
    s_sub_u32 s56, s56, 1
    s_cbranch_scc0 L_b_p0
    s_mov_b32 s56, 0
    s_not_b32 s65, s66
    s_branch L_b_r0
L_b_p1:
    v_mov_b32 v8, 0
    buffer_atomic_or v8, v159, s[16:19], 0 offen sc0 sc1
    s_waitcnt vmcnt(0)
    v_cmp_eq_u32 vcc, s68, v8
    s_nop 0
    s_lshr_b32 s65, vcc_lo, 1
    s_and_b32 s65, s65, vcc_lo
    s_andn2_b32 s65, s65, s66
    s_cbranch_scc0 L_b_q1
    s_or_b32 s66, s66, s65
    s_branch L_b_r1
L_b_q1:
    s_sub_u32 s56, s56, 1
    s_cbranch_scc0 L_b_p1
    s_mov_b32 s56, 0
    s_not_b32 s65, s66
    s_branch L_b_r1
L_h5_far:
    buffer_store_dword v24, v131, s[16:19], 0 offen sc1
    s_branch L_h5_out
L_fin_ld:
    buffer_load_short_d16_hi v140, v142, s[16:19], 0 offen sc1
    buffer_load_short_d16_hi v141, v142, s[16:19], s65 offen sc1
    s_waitcnt vmcnt(0)
    v_max_u32 v16, v140, v141
    v_cmp_eq_u32 vcc, 0xffff0000, v16
    s_cbranch_vccz L_fin_go
    s_sub_u32 s56, s56, 1
    s_cbranch_scc0 L_fin_ld
    s_branch L_fin_go
L_last:
    s_endpgm
.section .rodata,"a"
.p2align 6
.amdhsa_kernel sequential_preLN__linear_attn_block__moe_arch_mod__prompt_kernel
  .amdhsa_next_free_vgpr 256
  .amdhsa_next_free_sgpr 102
  .amdhsa_accum_offset 256
  .amdhsa_group_segment_fixed_size 0
  .amdhsa_kernarg_size 88
  .amdhsa_user_sgpr_count 2
  .amdhsa_user_sgpr_kernarg_segment_ptr 1
  .amdhsa_system_sgpr_workgroup_id_x 1
.end_amdhsa_kernel
```

```asm
; @launch grid=(256,1,1) block=(512,1,1) lds=163840
.amdgcn_target "amdgcn-amd-amdhsa--gfx950"
.text
.globl sequential_preLN__linear_attn_block__moe_arch_mod__prompt_kernel
.p2align 8
.type sequential_preLN__linear_attn_block__moe_arch_mod__prompt_kernel,@function
sequential_preLN__linear_attn_block__moe_arch_mod__prompt_kernel:
    s_cmp_ge_u32 s2, 256
    s_cbranch_scc1 L_end
    s_load_dwordx16 s[64:79], s[0:1], 0
    s_load_dwordx4 s[80:83], s[0:1], 64
    s_load_dwordx2 s[84:85], s[0:1], 80
    v_lshrrev_b32 v1, 6, v0
    v_and_b32 v0, 63, v0
    v_readfirstlane_b32 s3, v1
    s_and_b32 s44, s2, 7
    s_lshr_b32 s45, s2, 3
    s_and_b32 s46, s44, 1
    s_lshl_b32 s46, s46, 3
    s_and_b32 s86, s45, 7
    s_add_u32 s46, s46, s86
    s_lshr_b32 s47, s44, 1
    s_lshl_b32 s47, s47, 2
    s_lshr_b32 s86, s45, 3
    s_add_u32 s47, s47, s86
    s_mov_b32 s51, s47
    s_mov_b32 s52, s46
    s_and_b32 s48, s3, 3
    s_and_b32 s49, s3, 1
    s_bfe_u32 s50, s3, 0x10001
    s_mov_b32 s56, 65536
    s_mov_b32 s95, 0x3f803f80
    s_movk_i32 s92, 0x1000
    s_movk_i32 s93, 0x2000
    s_movk_i32 s94, 0x3000
    s_cmp_lt_u32 s3, 4
    s_cbranch_scc1 L_comp0
    v_lshrrev_b32 v20, 3, v0
    v_and_b32 v21, 7, v0
    v_lshrrev_b32 v22, 4, v0
    v_xor_b32 v23, v21, v22
    v_xor_b32 v24, 4, v23
    s_lshl_b32 s86, s48, 5
    v_add_u32 v25, s86, v20
    v_lshlrev_b32 v25, 11, v25
    v_lshl_add_u32 v2, v23, 4, v25
    v_lshl_add_u32 v3, v24, 4, v25
    v_add_u32 v3, 15360, v3
    v_lshl_add_u32 v4, v23, 4, v25
    v_add_u32 v4, 30720, v4
    v_lshl_add_u32 v5, v24, 4, v25
    v_add_u32 v5, 46080, v5
    s_lshl_b32 s86, s48, 4
    v_add_u32 v25, s86, v20
    v_mul_u32_u24 v25, 6144, v25
    s_lshl_b32 s86, s47, 7
    v_add_u32 v25, s86, v25
    v_bfe_u32 v26, v0, 4, 1
    v_lshlrev_b32 v26, 1, v26
    v_xor_b32 v26, v26, v21
    v_xor_b32 v27, 4, v26
    v_lshl_add_u32 v6, v26, 4, v25
    v_lshl_add_u32 v7, v27, 4, v25
    v_add_u32 v7, 48128, v7
    v_lshl_add_u32 v8, v26, 4, v25
    v_add_u32 v8, 2048, v8
    v_lshl_add_u32 v9, v27, 4, v25
    v_add_u32 v9, 50176, v9
    v_lshl_add_u32 v10, v26, 4, v25
    v_add_u32 v10, 4096, v10
    v_lshl_add_u32 v11, v27, 4, v25
    v_add_u32 v11, 52224, v11
    s_lshl_b32 s63, s46, 18
    s_lshl_b32 s53, s48, 12
    s_lshl_b32 s62, s48, 11
    s_add_u32 s62, s62, 16384
    s_setprio 1
    s_lshl_b32 s86, s45, 2
    s_add_u32 s86, s86, s48
    s_mul_i32 s87, s86, 12288
    s_and_b32 s88, s47, 12
    s_lshl_b32 s88, s88, 7
    s_add_u32 s87, s87, s88
    s_add_u32 s87, s87, 384
    s_bitcmp1_b32 s47, 2
    s_cselect_b32 s87, 2147483648, s87
    v_lshl_add_u32 v37, v0, 11, s87
    v_mov_b32 v24, 2147483648
    v_cmp_gt_u32 vcc, 6, v0
    s_nop 1
    v_cndmask_b32 v37, v24, v37, vcc
    s_lshl_b32 s86, s86, 14
    s_and_b32 s88, s52, 8
    s_lshl_b32 s88, s88, 7
    s_add_u32 s86, s86, s88
    s_add_u32 s86, s86, 384
    v_lshl_add_u32 v38, v0, 11, s86
    v_cmp_gt_u32 vcc, 8, v0
    s_nop 1
    v_cndmask_b32 v38, v24, v38, vcc
    s_waitcnt lgkmcnt(0)
    s_mov_b32 s8, s64
    s_and_b32 s9, s65, 0xffff
    s_mov_b32 s10, 4194304
    s_mov_b32 s11, 0x20000
    s_mov_b32 s12, s66
    s_and_b32 s13, s67, 0xffff
    s_mov_b32 s14, 6291456
    s_mov_b32 s15, 0x20000
    s_and_b32 s86, s47, 12
    s_and_b32 s87, s46, 8
    s_add_u32 s64, s86, s87
    s_and_b32 s64, s64, 15
    s_mov_b32 s67, s64
    s_load_dword s61, s[84:85], 524288
    s_lshr_b32 s90, s67, 2
    s_mul_i32 s90, s90, 1572864
    buffer_load_dword v39, v37, s[12:15], s90 offen
    s_add_u32 m0, s53, 40960
    s_lshl_b32 s70, s64, 7
    s_add_u32 s70, s70, s63
    buffer_load_dwordx4 v2, s[8:11], s70 offen offset:0 lds
    buffer_load_dwordx4 v3, s[8:11], s70 offen offset:1024 lds
    buffer_load_dwordx4 v4, s[8:11], s70 offen offset:2048 lds
    buffer_load_dwordx4 v5, s[8:11], s70 offen offset:3072 lds
    s_mul_i32 s91, s64, 393216
    s_add_u32 s64, s64, 1
    s_and_b32 s64, s64, 15
    s_add_u32 m0, s62, 40960
    s_nop 0
    buffer_load_dwordx4 v6, s[12:15], s91 offen offset:0 lds
    buffer_load_dwordx4 v7, s[12:15], s91 offen offset:1024 lds
    s_add_u32 m0, s62, 49152
    s_nop 0
    buffer_load_dwordx4 v8, s[12:15], s91 offen offset:0 lds
    buffer_load_dwordx4 v9, s[12:15], s91 offen offset:1024 lds
    s_add_u32 m0, s62, 57344
    s_nop 0
    buffer_load_dwordx4 v10, s[12:15], s91 offen offset:0 lds
    buffer_load_dwordx4 v11, s[12:15], s91 offen offset:1024 lds
    s_branch L_ld1
L_comp0:
    s_lshl2_add_u32 s86, s45, s3
    s_cmp_ge_u32 s86, 4
    s_cbranch_scc1 L_noipf
    s_getpc_b64 s[4:5]
L_ipf:
    s_sub_u32 s4, s4, L_ipf-sequential_preLN__linear_attn_block__moe_arch_mod__prompt_kernel
    s_subb_u32 s5, s5, 0
    s_lshl_b32 s86, s86, 13
    v_lshl_add_u32 v31, v0, 7, s86
    v_min_u32 v31, L_last-sequential_preLN__linear_attn_block__moe_arch_mod__prompt_kernel, v31
    global_load_dword v30, v31, s[4:5]
L_noipf:
    s_cmp_eq_u32 s3, 3
    s_cbranch_scc1 L_comp
    s_mov_b64 exec, 0
    s_cmp_eq_u32 s3, 2
    s_cbranch_scc1 L_walkA2
    s_cmp_eq_u32 s3, 1
    s_cbranch_scc1 L_walkA1
    s_branch L_walkA0
L_ld1:
    s_mov_b32 s16, s84
    s_and_b32 s17, s85, 0xffff
    s_mov_b32 s18, 268435456
    s_mov_b32 s19, 0x20000
    s_mov_b32 s20, s68
    s_and_b32 s21, s69, 0xffff
    s_mov_b32 s22, 2097152
    s_mov_b32 s23, 0x20000
    s_mov_b32 s24, s80
    s_and_b32 s25, s81, 0xffff
    s_mov_b32 s26, 4194304
    s_mov_b32 s27, 0x20000
    s_mov_b32 s28, s82
    s_and_b32 s29, s83, 0xffff
    s_mov_b32 s30, 256
    s_mov_b32 s31, 0x20000
    s_bitcmp1_b32 s2, 3
    s_cselect_b32 s32, s76, s74
    s_cselect_b32 s33, s77, s75
    s_and_b32 s33, s33, 0xffff
    s_mov_b32 s34, 7340032
    s_mov_b32 s35, 0x20000
    s_mov_b32 s36, s78
    s_and_b32 s37, s79, 0xffff
    s_mov_b32 s38, 7340032
    s_mov_b32 s39, 0x20000
    s_mov_b32 s40, s72
    s_and_b32 s41, s73, 0xffff
    s_mov_b32 s42, 2048
    s_mov_b32 s43, 0x20000
    s_lshl_b32 s82, s44, 5
    s_or_b32 s82, s82, s45
    v_lshrrev_b32 v22, 4, v0
    v_and_b32 v23, 15, v0
    s_lshl_b32 s86, s45, 2
    s_add_u32 s86, s86, s48
L_walkA0:
    s_cbranch_execz L_comp
    s_mul_i32 s87, s86, 6
    v_mul_u32_u24 v24, 43, v0
    v_lshrrev_b32 v24, 8, v24
    v_mul_u32_u24 v25, 6, v24
    v_sub_u32 v25, v0, v25
    v_add_u32 v25, s87, v25
    s_add_u32 s87, s67, 2
    v_add_u32 v24, s87, v24
    v_and_b32 v24, 15, v24
    v_mul_u32_u24 v124, 393216, v24
    v_lshrrev_b32 v24, 2, v25
    v_lshl_add_u32 v124, v24, 11, v124
    v_and_b32 v25, 3, v25
    s_and_b32 s88, s47, 12
    v_add_u32 v25, s88, v25
    v_lshl_add_u32 v124, v25, 7, v124
    v_mov_b32 v24, 2147483648
    v_cmp_gt_u32 vcc, 36, v0
    s_nop 1
    v_cndmask_b32 v124, v24, v124, vcc
    v_add_u32 v24, s87, v20
    v_and_b32 v24, 15, v24
    s_and_b32 s88, s46, 8
    s_lshl4_add_u32 s86, s88, s86
    s_lshl_b32 s86, s86, 14
    v_lshl_add_u32 v123, v21, 11, s86
    v_mov_b32 v125, v123
    v_lshl_add_u32 v123, v24, 7, v123
    v_mov_b32 v24, 2147483648
    v_cmp_gt_u32 vcc, 16, v0
    s_nop 1
    v_cndmask_b32 v123, v24, v123, vcc
    s_add_u32 m0, s53, 81920
    s_lshl_b32 s70, s64, 7
    s_add_u32 s70, s70, s63
    buffer_load_dwordx4 v2, s[8:11], s70 offen offset:0 lds
    buffer_load_dwordx4 v3, s[8:11], s70 offen offset:1024 lds
    buffer_load_dwordx4 v4, s[8:11], s70 offen offset:2048 lds
    buffer_load_dwordx4 v5, s[8:11], s70 offen offset:3072 lds
    s_mul_i32 s91, s64, 393216
    s_add_u32 s64, s64, 1
    s_and_b32 s64, s64, 15
    s_add_u32 m0, s62, 81920
    s_nop 0
    buffer_load_dwordx4 v6, s[12:15], s91 offen offset:0 lds
    buffer_load_dwordx4 v7, s[12:15], s91 offen offset:1024 lds
    s_add_u32 m0, s62, 90112
    s_nop 0
    buffer_load_dwordx4 v8, s[12:15], s91 offen offset:0 lds
    buffer_load_dwordx4 v9, s[12:15], s91 offen offset:1024 lds
    s_add_u32 m0, s62, 98304
    s_nop 0
    buffer_load_dwordx4 v10, s[12:15], s91 offen offset:0 lds
    buffer_load_dwordx4 v11, s[12:15], s91 offen offset:1024 lds
    buffer_load_dword v122, v123, s[8:11], 0 offen
    buffer_load_dword v122, v124, s[12:15], 0 offen
    s_and_b32 s65, s45, 7
    s_lshr_b32 s66, s45, 3
    s_add_u32 s86, s65, 1
    s_and_b32 s86, s86, 3
    s_mul_i32 s86, s86, 40960
    s_lshl_b32 s87, s48, 13
    s_cmp_eq_u32 s48, 3
    s_cselect_b32 s87, 0, s87
    s_add_u32 s86, s86, s87
    s_add_u32 s86, s86, 16384
    v_lshl_add_u32 v25, v20, 7, s86
    v_lshl_add_u32 v28, v26, 4, v25
    v_lshl_add_u32 v29, v27, 4, v25
    s_add_u32 s86, s66, 1
    s_and_b32 s86, s86, 3
    s_mul_i32 s86, s86, 40960
    s_add_u32 s86, s86, s53
    v_lshl_add_u32 v16, v0, 6, s86
    v_bfe_u32 v25, v0, 2, 2
    v_lshl_add_u32 v16, v25, 4, v16
    v_xor_b32 v17, 16, v16
    v_xor_b32 v18, 32, v16
    v_xor_b32 v19, 48, v16
    s_lshl_b32 s86, s46, 14
    s_lshl_b32 s87, s48, 8
    s_add_u32 s86, s86, s87
    s_add_u32 s86, s86, 262144
    v_lshl_add_u32 v33, v23, 4, s86
    v_lshl_add_u32 v33, v22, 10, v33
    s_lshl_b32 s87, s47, 10
    s_add_u32 s86, s86, s87
    v_lshl_add_u32 v13, v0, 2, s86
    v_and_b32 v25, 3, v0
    v_cmp_eq_u32 vcc, 0, v25
    v_mov_b32 v24, 2147483648
    s_nop 0
    v_cndmask_b32 v13, v24, v13, vcc
    s_mul_i32 s86, s47, 12288
    s_add_u32 s86, s86, 65536
    s_lshl_b32 s87, s48, 8
    s_cmp_eq_u32 s48, 3
    s_cselect_b32 s87, 2147483648, s87
    s_mov_b32 s88, 0
    s_add_u32 s86, s86, s87
    v_lshl_add_u32 v32, v23, 4, s86
    v_mul_u32_u24 v25, 768, v22
    v_add_u32 v32, v32, v25
    s_mul_i32 s87, s46, 768
    s_add_u32 s86, s86, s87
    s_add_u32 s86, s86, s88
    v_lshl_add_u32 v34, v23, 5, s86
    v_lshl_add_u32 v34, v22, 4, v34
    v_and_b32 v25, 0x28, v0
    v_cmp_eq_u32 vcc, 0, v25
    s_nop 1
    v_cndmask_b32 v34, v24, v34, vcc
    s_bfe_u32 s86, s82, 0x20001
    s_lshl_b32 s86, s86, 2
    s_add_u32 s86, s86, s48
    s_lshl_b32 s86, s86, 6
    v_lshl_add_u32 v30, v22, 4, s86
    v_mul_u32_u24 v30, 7168, v30
    s_add_u32 s86, s44, 3
    s_and_b32 s86, s86, 7
    s_min_u32 s86, s86, 6
    s_mul_i32 s87, s44, 7
    s_lshr_b32 s88, s45, 3
    s_lshl_b32 s88, s88, 1
    s_sub_u32 s80, s88, 2
    s_cmp_ge_u32 s80, s86
    s_addc_u32 s80, s80, s87
    s_sub_u32 s81, s88, 1
    s_cmp_ge_u32 s81, s86
    s_addc_u32 s81, s81, s87
    s_add_u32 s86, s86, s87
    s_cmp_lt_u32 s45, 8
    s_cselect_b32 s80, s86, s80
    s_cselect_b32 s81, 56, s81
    v_mov_b32 v24, s80
    v_mov_b32 v25, s81
    s_mov_b32 vcc_lo, 4278255360
    s_mov_b32 vcc_hi, vcc_lo
    v_cndmask_b32 v24, v24, v25, vcc
    v_cmp_gt_u32 vcc, 56, v24
    v_and_b32 v25, 7, v0
    v_lshlrev_b32 v24, 7, v24
    v_lshl_add_u32 v24, v25, 4, v24
    v_add_u32 v30, v30, v24
    v_mov_b32 v24, 2147483648
    v_cndmask_b32 v30, v24, v30, vcc
    s_lshr_b32 s86, s82, 3
    s_mul_i32 s86, s86, 112
    s_mul_i32 s87, s48, 28
    s_add_u32 s86, s86, s87
    v_mul_u32_u24 v31, 7, v22
    v_add_u32 v31, s86, v31
    v_lshlrev_b32 v31, 11, v31
    s_and_b32 s86, s82, 7
    s_lshl_b32 s86, s86, 8
    v_lshl_add_u32 v24, v23, 4, s86
    v_add_u32 v31, v31, v24
    v_lshlrev_b32 v24, 1, v22
    v_xor_b32 v24, v24, v21
    s_lshl_b32 s86, s48, 3
    v_add_u32 v12, s86, v20
    v_lshlrev_b32 v12, 11, v12
    s_lshl_b32 s86, s52, 7
    v_lshl_add_u32 v24, v24, 4, s86
    v_add_u32 v12, v12, v24
    s_lshl_b32 s89, s48, 10
    v_and_b32 v24, 1, v0
    v_lshlrev_b32 v24, 4, v24
    v_mov_b32 v25, 0x3f80
    v_lshlrev_b32 v24, v24, v25
    v_bfe_u32 v25, v0, 1, 2
    v_cmp_eq_u32 vcc, 0, v25
    s_nop 1
    v_cndmask_b32 v104, 0, v24, vcc
    v_cmp_eq_u32 vcc, 1, v25
    s_nop 1
    v_cndmask_b32 v105, 0, v24, vcc
    v_cmp_eq_u32 vcc, 2, v25
    s_nop 1
    v_cndmask_b32 v106, 0, v24, vcc
    v_cmp_eq_u32 vcc, 3, v25
    s_nop 1
    v_cndmask_b32 v107, 0, v24, vcc
    s_waitcnt lgkmcnt(0)
    s_add_u32 s68, s61, 0x9e3779b9
    v_mov_b32 v35, s68
    s_lshl_b32 s86, s46, 2
    s_add_u32 s86, s86, s48
    s_lshl_b32 s86, s86, 7
    s_add_u32 s86, s86, 655360
    s_lshl_b32 s87, s47, 2
    s_add_u32 s87, s87, s48
    s_lshl_b32 s87, s87, 7
    s_add_u32 s87, s87, 663552
    s_cmp_eq_u32 s48, 3
    s_cselect_b32 s87, 2147483648, s87
    s_cselect_b32 s76, 0xffff, -1
    s_mov_b32 s77, 0
    v_mov_b32 v24, s86
    v_mov_b32 v25, s87
    v_cmp_gt_u32 vcc, 16, v0
    s_nop 1
    v_cndmask_b32 v117, v25, v24, vcc
    v_lshl_add_u32 v117, v23, 2, v117
    v_mov_b32 v116, 2147483648
    v_cmp_gt_u32 vcc, 32, v0
    s_nop 1
L_walkA1:
    s_cbranch_execz L_comp
    v_cndmask_b32 v117, v116, v117, vcc
    s_lshl2_add_u32 s86, s47, s86
    s_lshl2_add_u32 s87, s46, s87
    v_writelane_b32 v116, s86, 0
    v_writelane_b32 v116, s87, 1
    s_getreg_b32 s83, hwreg(HW_REG_XCC_ID, 0, 4)
    s_add_u32 s83, s83, s68
    v_mov_b32 v121, s83
    s_lshl_b32 s86, s44, 7
    s_add_u32 s86, s86, 753664
    v_lshl_add_u32 v119, v0, 2, s86
    v_mov_b32 v120, 2147483648
    v_cmp_gt_u32 vcc, 32, v0
    s_nop 1
    v_cndmask_b32 v119, v120, v119, vcc
    s_lshl_b32 s86, s48, 6
    s_add_u32 s86, s86, s45
    v_cmp_eq_u32 vcc, s86, v0
    s_nop 1
    v_cndmask_b32 v120, v120, v119, vcc
    s_waitcnt vmcnt(12)
    s_barrier
    buffer_store_dword v121, v120, s[16:19], 0 offen sc1
    s_add_u32 m0, s53, 122880
    s_lshl_b32 s70, s64, 7
    s_add_u32 s70, s70, s63
    buffer_load_dwordx4 v2, s[8:11], s70 offen offset:0 lds
    buffer_load_dwordx4 v3, s[8:11], s70 offen offset:1024 lds
    buffer_load_dwordx4 v4, s[8:11], s70 offen offset:2048 lds
    buffer_load_dwordx4 v5, s[8:11], s70 offen offset:3072 lds
    s_mul_i32 s91, s64, 393216
    s_add_u32 s64, s64, 1
    s_and_b32 s64, s64, 15
    s_add_u32 m0, s62, 122880
    s_nop 0
    buffer_load_dwordx4 v6, s[12:15], s91 offen offset:0 lds
    buffer_load_dwordx4 v7, s[12:15], s91 offen offset:1024 lds
    s_add_u32 m0, s62, 131072
    s_nop 0
    buffer_load_dwordx4 v8, s[12:15], s91 offen offset:0 lds
    buffer_load_dwordx4 v9, s[12:15], s91 offen offset:1024 lds
    s_add_u32 m0, s62, 139264
    s_nop 0
    buffer_load_dwordx4 v10, s[12:15], s91 offen offset:0 lds
    buffer_load_dwordx4 v11, s[12:15], s91 offen offset:1024 lds
    s_add_u32 s87, s67, 4
    v_add_u32 v24, s87, v20
    v_and_b32 v24, 15, v24
    v_lshl_add_u32 v123, v24, 7, v125
    v_mov_b32 v24, 2147483648
    v_cmp_gt_u32 vcc, 32, v0
    s_nop 1
    v_cndmask_b32 v123, v24, v123, vcc
    buffer_load_dword v122, v123, s[8:11], 0 offen
    s_cmp_lg_u32 s65, 0
    s_cbranch_scc1 L_h0c0
    ds_read_b128 v[40:43], v28 offset:0
    ds_read_b128 v[44:47], v29 offset:1024
    ds_read_b128 v[48:51], v28 offset:2048
    ds_read_b128 v[52:55], v29 offset:3072
    ds_read_b128 v[56:59], v28 offset:4096
    ds_read_b128 v[60:63], v29 offset:5120
    ds_read_b128 v[64:67], v28 offset:6144
    ds_read_b128 v[68:71], v29 offset:7168
L_h0c0:
    s_cmp_lg_u32 s66, 0
    s_cbranch_scc1 L_h0r0
    ds_read_b128 v[72:75], v16
    ds_read_b128 v[76:79], v17
    ds_read_b128 v[80:83], v18
    ds_read_b128 v[84:87], v19
L_h0r0:
    s_waitcnt lgkmcnt(0)
    s_waitcnt vmcnt(14)
    s_barrier
    s_add_u32 m0, s53, 0
    s_lshl_b32 s70, s64, 7
    s_add_u32 s70, s70, s63
    buffer_load_dwordx4 v2, s[8:11], s70 offen offset:0 lds
    buffer_load_dwordx4 v3, s[8:11], s70 offen offset:1024 lds
    buffer_load_dwordx4 v4, s[8:11], s70 offen offset:2048 lds
    buffer_load_dwordx4 v5, s[8:11], s70 offen offset:3072 lds
    s_mul_i32 s91, s64, 393216
    s_add_u32 s64, s64, 1
    s_and_b32 s64, s64, 15
    s_add_u32 m0, s62, 0
    s_nop 0
    buffer_load_dwordx4 v6, s[12:15], s91 offen offset:0 lds
    buffer_load_dwordx4 v7, s[12:15], s91 offen offset:1024 lds
    s_add_u32 m0, s62, 8192
    s_nop 0
    buffer_load_dwordx4 v8, s[12:15], s91 offen offset:0 lds
    buffer_load_dwordx4 v9, s[12:15], s91 offen offset:1024 lds
    s_add_u32 m0, s62, 16384
    s_nop 0
    buffer_load_dwordx4 v10, s[12:15], s91 offen offset:0 lds
    buffer_load_dwordx4 v11, s[12:15], s91 offen offset:1024 lds
    s_cmp_lg_u32 s65, 1
    s_cbranch_scc1 L_h0c1
    ds_read_b128 v[40:43], v28 offset:0
    ds_read_b128 v[44:47], v29 offset:1024
    ds_read_b128 v[48:51], v28 offset:2048
    ds_read_b128 v[52:55], v29 offset:3072
    ds_read_b128 v[56:59], v28 offset:4096
    ds_read_b128 v[60:63], v29 offset:5120
    ds_read_b128 v[64:67], v28 offset:6144
    ds_read_b128 v[68:71], v29 offset:7168
L_h0c1:
    s_cmp_lg_u32 s66, 1
    s_cbranch_scc1 L_h0r1
    ds_read_b128 v[72:75], v16
    ds_read_b128 v[76:79], v17
    ds_read_b128 v[80:83], v18
    ds_read_b128 v[84:87], v19
L_h0r1:
    s_waitcnt lgkmcnt(0)
    s_waitcnt vmcnt(11)
    s_barrier
    s_add_u32 m0, s53, 40960
    s_lshl_b32 s70, s64, 7
    s_add_u32 s70, s70, s63
    buffer_load_dwordx4 v2, s[8:11], s70 offen offset:0 lds
    buffer_load_dwordx4 v3, s[8:11], s70 offen offset:1024 lds
    buffer_load_dwordx4 v4, s[8:11], s70 offen offset:2048 lds
    buffer_load_dwordx4 v5, s[8:11], s70 offen offset:3072 lds
    s_mul_i32 s91, s64, 393216
    s_add_u32 s64, s64, 1
    s_and_b32 s64, s64, 15
    s_add_u32 m0, s62, 40960
    s_nop 0
    buffer_load_dwordx4 v6, s[12:15], s91 offen offset:0 lds
    buffer_load_dwordx4 v7, s[12:15], s91 offen offset:1024 lds
    s_add_u32 m0, s62, 49152
    s_nop 0
    buffer_load_dwordx4 v8, s[12:15], s91 offen offset:0 lds
    buffer_load_dwordx4 v9, s[12:15], s91 offen offset:1024 lds
    s_add_u32 m0, s62, 57344
    s_nop 0
    buffer_load_dwordx4 v10, s[12:15], s91 offen offset:0 lds
    buffer_load_dwordx4 v11, s[12:15], s91 offen offset:1024 lds
    s_cmp_lg_u32 s65, 2
    s_cbranch_scc1 L_h0c2
    ds_read_b128 v[40:43], v28 offset:0
    ds_read_b128 v[44:47], v29 offset:1024
    ds_read_b128 v[48:51], v28 offset:2048
    ds_read_b128 v[52:55], v29 offset:3072
    ds_read_b128 v[56:59], v28 offset:4096
    ds_read_b128 v[60:63], v29 offset:5120
    ds_read_b128 v[64:67], v28 offset:6144
    ds_read_b128 v[68:71], v29 offset:7168
L_h0c2:
    s_cmp_lg_u32 s66, 2
    s_cbranch_scc1 L_h0r2
    ds_read_b128 v[72:75], v16
    ds_read_b128 v[76:79], v17
    ds_read_b128 v[80:83], v18
    ds_read_b128 v[84:87], v19
L_h0r2:
    s_waitcnt lgkmcnt(0)
    s_waitcnt vmcnt(10)
    s_barrier
    s_add_u32 m0, s53, 81920
    s_lshl_b32 s70, s64, 7
    s_add_u32 s70, s70, s63
    buffer_load_dwordx4 v2, s[8:11], s70 offen offset:0 lds
    buffer_load_dwordx4 v3, s[8:11], s70 offen offset:1024 lds
    buffer_load_dwordx4 v4, s[8:11], s70 offen offset:2048 lds
    buffer_load_dwordx4 v5, s[8:11], s70 offen offset:3072 lds
    s_mul_i32 s91, s64, 393216
    s_add_u32 s64, s64, 1
    s_and_b32 s64, s64, 15
    s_add_u32 m0, s62, 81920
    s_nop 0
    buffer_load_dwordx4 v6, s[12:15], s91 offen offset:0 lds
    buffer_load_dwordx4 v7, s[12:15], s91 offen offset:1024 lds
    s_add_u32 m0, s62, 90112
    s_nop 0
    buffer_load_dwordx4 v8, s[12:15], s91 offen offset:0 lds
L_walkB0:
    s_cbranch_execz L_walk_4
    buffer_load_dwordx4 v9, s[12:15], s91 offen offset:1024 lds
    s_add_u32 m0, s62, 98304
    s_nop 0
    buffer_load_dwordx4 v10, s[12:15], s91 offen offset:0 lds
    buffer_load_dwordx4 v11, s[12:15], s91 offen offset:1024 lds
    s_lshr_b32 s90, s67, 2
    s_add_u32 s90, s90, 2
    s_and_b32 s90, s90, 3
    s_mul_i32 s90, s90, 1572864
    buffer_load_dword v39, v37, s[12:15], s90 offen
    s_cmp_lg_u32 s65, 3
    s_cbranch_scc1 L_h0c3
    ds_read_b128 v[40:43], v28 offset:0
    ds_read_b128 v[44:47], v29 offset:1024
    ds_read_b128 v[48:51], v28 offset:2048
    ds_read_b128 v[52:55], v29 offset:3072
    ds_read_b128 v[56:59], v28 offset:4096
    ds_read_b128 v[60:63], v29 offset:5120
    ds_read_b128 v[64:67], v28 offset:6144
    ds_read_b128 v[68:71], v29 offset:7168
L_h0c3:
    s_cmp_lg_u32 s66, 3
    s_cbranch_scc1 L_h0r3
    ds_read_b128 v[72:75], v16
    ds_read_b128 v[76:79], v17
    ds_read_b128 v[80:83], v18
    ds_read_b128 v[84:87], v19
L_h0r3:
    s_waitcnt lgkmcnt(0)
    s_waitcnt vmcnt(11)
    s_barrier
    s_add_u32 m0, s53, 122880
    s_lshl_b32 s70, s64, 7
    s_add_u32 s70, s70, s63
    buffer_load_dwordx4 v2, s[8:11], s70 offen offset:0 lds
    buffer_load_dwordx4 v3, s[8:11], s70 offen offset:1024 lds
    buffer_load_dwordx4 v4, s[8:11], s70 offen offset:2048 lds
    buffer_load_dwordx4 v5, s[8:11], s70 offen offset:3072 lds
    s_mul_i32 s91, s64, 393216
    s_add_u32 s64, s64, 1
    s_and_b32 s64, s64, 15
    s_add_u32 m0, s62, 122880
    s_nop 0
    buffer_load_dwordx4 v6, s[12:15], s91 offen offset:0 lds
    buffer_load_dwordx4 v7, s[12:15], s91 offen offset:1024 lds
    s_add_u32 m0, s62, 131072
    s_nop 0
    buffer_load_dwordx4 v8, s[12:15], s91 offen offset:0 lds
    buffer_load_dwordx4 v9, s[12:15], s91 offen offset:1024 lds
    s_add_u32 m0, s62, 139264
    s_nop 0
    buffer_load_dwordx4 v10, s[12:15], s91 offen offset:0 lds
    buffer_load_dwordx4 v11, s[12:15], s91 offen offset:1024 lds
    s_cmp_lg_u32 s65, 4
    s_cbranch_scc1 L_h0c4
    ds_read_b128 v[40:43], v28 offset:0
    ds_read_b128 v[44:47], v29 offset:1024
    ds_read_b128 v[48:51], v28 offset:2048
    ds_read_b128 v[52:55], v29 offset:3072
    ds_read_b128 v[56:59], v28 offset:4096
    ds_read_b128 v[60:63], v29 offset:5120
    ds_read_b128 v[64:67], v28 offset:6144
    ds_read_b128 v[68:71], v29 offset:7168
L_h0c4:
    s_waitcnt lgkmcnt(0)
    v_mov_b32 v88, 0
    v_mov_b32 v89, 0
    v_mov_b32 v90, 0
    v_mov_b32 v91, 0
    v_mov_b32 v92, 0
    v_mov_b32 v93, 0
    v_mov_b32 v94, 0
    v_mov_b32 v95, 0
    v_dot2c_f32_bf16 v88, s95, v72
    v_dot2c_f32_bf16 v89, s95, v73
    v_dot2c_f32_bf16 v90, s95, v74
    v_dot2c_f32_bf16 v91, s95, v75
    v_dot2c_f32_bf16 v92, v72, v72
    v_dot2c_f32_bf16 v93, v73, v73
    v_dot2c_f32_bf16 v94, v74, v74
    v_dot2c_f32_bf16 v95, v75, v75
    v_dot2c_f32_bf16 v88, s95, v76
    v_dot2c_f32_bf16 v89, s95, v77
    v_dot2c_f32_bf16 v90, s95, v78
    v_dot2c_f32_bf16 v91, s95, v79
    v_dot2c_f32_bf16 v92, v76, v76
    v_dot2c_f32_bf16 v93, v77, v77
    v_dot2c_f32_bf16 v94, v78, v78
    v_dot2c_f32_bf16 v95, v79, v79
    v_dot2c_f32_bf16 v88, s95, v80
    v_dot2c_f32_bf16 v89, s95, v81
    v_dot2c_f32_bf16 v90, s95, v82
    v_dot2c_f32_bf16 v91, s95, v83
    v_dot2c_f32_bf16 v92, v80, v80
    v_dot2c_f32_bf16 v93, v81, v81
    v_dot2c_f32_bf16 v94, v82, v82
    v_dot2c_f32_bf16 v95, v83, v83
    v_dot2c_f32_bf16 v88, s95, v84
    v_dot2c_f32_bf16 v89, s95, v85
    v_dot2c_f32_bf16 v90, s95, v86
    v_dot2c_f32_bf16 v91, s95, v87
    v_dot2c_f32_bf16 v92, v84, v84
    v_dot2c_f32_bf16 v93, v85, v85
    v_dot2c_f32_bf16 v94, v86, v86
    v_dot2c_f32_bf16 v95, v87, v87
    s_waitcnt vmcnt(11)
    s_barrier
    s_add_u32 m0, s53, 0
    s_lshl_b32 s70, s64, 7
    s_add_u32 s70, s70, s63
    buffer_load_dwordx4 v2, s[8:11], s70 offen offset:0 lds
    buffer_load_dwordx4 v3, s[8:11], s70 offen offset:1024 lds
    buffer_load_dwordx4 v4, s[8:11], s70 offen offset:2048 lds
    buffer_load_dwordx4 v5, s[8:11], s70 offen offset:3072 lds
    s_mul_i32 s91, s64, 393216
    s_add_u32 s64, s64, 1
    s_and_b32 s64, s64, 15
    s_add_u32 m0, s62, 0
    s_nop 0
    buffer_load_dwordx4 v6, s[12:15], s91 offen offset:0 lds
    buffer_load_dwordx4 v7, s[12:15], s91 offen offset:1024 lds
    s_add_u32 m0, s62, 8192
    s_nop 0
    buffer_load_dwordx4 v8, s[12:15], s91 offen offset:0 lds
    buffer_load_dwordx4 v9, s[12:15], s91 offen offset:1024 lds
    s_add_u32 m0, s62, 16384
    s_nop 0
    buffer_load_dwordx4 v10, s[12:15], s91 offen offset:0 lds
    buffer_load_dwordx4 v11, s[12:15], s91 offen offset:1024 lds
    buffer_load_dword v39, v38, s[20:23], 0 offen
    s_cmp_lg_u32 s65, 5
    s_cbranch_scc1 L_h0c5
    ds_read_b128 v[40:43], v28 offset:0
    ds_read_b128 v[44:47], v29 offset:1024
    ds_read_b128 v[48:51], v28 offset:2048
    ds_read_b128 v[52:55], v29 offset:3072
    ds_read_b128 v[56:59], v28 offset:4096
    ds_read_b128 v[60:63], v29 offset:5120
    ds_read_b128 v[64:67], v28 offset:6144
    ds_read_b128 v[68:71], v29 offset:7168
L_h0c5:
    s_waitcnt lgkmcnt(0)
    v_pk_add_f32 v[88:89], v[88:89], v[90:91]
    v_pk_add_f32 v[92:93], v[92:93], v[94:95]
    v_add_f32 v88, v88, v89
    v_add_f32 v89, v92, v93
    s_nop 0
    v_add_f32_dpp v88, v88, v88 quad_perm:[1,0,3,2] row_mask:0xf bank_mask:0xf
    v_add_f32_dpp v89, v89, v89 quad_perm:[1,0,3,2] row_mask:0xf bank_mask:0xf
    s_nop 0
    v_mov_b32_dpp v90, v88 quad_perm:[2,2,2,2] row_mask:0xf bank_mask:0xf
    v_mov_b32_dpp v91, v89 quad_perm:[2,2,2,2] row_mask:0xf bank_mask:0xf
    buffer_store_dwordx4 v[88:91], v13, s[16:19], 0 offen sc1
    s_lshl_b32 s86, s48, 7
    s_add_u32 s86, s86, 131072
    v_lshl_add_u32 v16, v23, 3, s86
    v_lshrrev_b32 v17, 5, v0
    v_lshl_add_u32 v16, v17, 2, v16
    s_lshl_b32 s86, s48, 8
    s_add_u32 s86, s86, 132608
    v_lshl_add_u32 v17, v23, 4, s86
    v_lshl_add_u32 v17, v22, 2, v17
    s_waitcnt vmcnt(12)
    s_barrier
    s_add_u32 m0, s53, 40960
    s_lshl_b32 s70, s64, 7
    s_add_u32 s70, s70, s63
    buffer_load_dwordx4 v2, s[8:11], s70 offen offset:0 lds
    buffer_load_dwordx4 v3, s[8:11], s70 offen offset:1024 lds
    buffer_load_dwordx4 v4, s[8:11], s70 offen offset:2048 lds
    buffer_load_dwordx4 v5, s[8:11], s70 offen offset:3072 lds
    s_mul_i32 s91, s64, 393216
    s_add_u32 s64, s64, 1
    s_and_b32 s64, s64, 15
    s_add_u32 m0, s62, 40960
    s_nop 0
    buffer_load_dwordx4 v6, s[12:15], s91 offen offset:0 lds
    buffer_load_dwordx4 v7, s[12:15], s91 offen offset:1024 lds
    s_add_u32 m0, s62, 49152
    s_nop 0
    buffer_load_dwordx4 v8, s[12:15], s91 offen offset:0 lds
    buffer_load_dwordx4 v9, s[12:15], s91 offen offset:1024 lds
    s_add_u32 m0, s62, 57344
    s_nop 0
    buffer_load_dwordx4 v10, s[12:15], s91 offen offset:0 lds
L_walkB1:
    s_cbranch_execz L_walk_5
    buffer_load_dwordx4 v11, s[12:15], s91 offen offset:1024 lds
    s_lshr_b32 s90, s67, 2
    s_add_u32 s90, s90, 3
    s_and_b32 s90, s90, 3
    s_mul_i32 s90, s90, 1572864
    buffer_load_dword v39, v37, s[12:15], s90 offen
    s_cmp_lg_u32 s65, 6
    s_cbranch_scc1 L_h0c6
    ds_read_b128 v[40:43], v28 offset:0
    ds_read_b128 v[44:47], v29 offset:1024
    ds_read_b128 v[48:51], v28 offset:2048
    ds_read_b128 v[52:55], v29 offset:3072
    ds_read_b128 v[56:59], v28 offset:4096
    ds_read_b128 v[60:63], v29 offset:5120
    ds_read_b128 v[64:67], v28 offset:6144
    ds_read_b128 v[68:71], v29 offset:7168
L_h0c6:
    s_waitcnt lgkmcnt(0)
    s_waitcnt vmcnt(13)
    s_barrier
    s_add_u32 m0, s53, 81920
    s_lshl_b32 s70, s64, 7
    s_add_u32 s70, s70, s63
    buffer_load_dwordx4 v2, s[8:11], s70 offen offset:0 lds
    buffer_load_dwordx4 v3, s[8:11], s70 offen offset:1024 lds
    buffer_load_dwordx4 v4, s[8:11], s70 offen offset:2048 lds
    buffer_load_dwordx4 v5, s[8:11], s70 offen offset:3072 lds
    s_mul_i32 s91, s64, 393216
    s_add_u32 s64, s64, 1
    s_and_b32 s64, s64, 15
    s_add_u32 m0, s62, 81920
    s_nop 0
    buffer_load_dwordx4 v6, s[12:15], s91 offen offset:0 lds
    buffer_load_dwordx4 v7, s[12:15], s91 offen offset:1024 lds
    s_add_u32 m0, s62, 90112
    s_nop 0
    buffer_load_dwordx4 v8, s[12:15], s91 offen offset:0 lds
    buffer_load_dwordx4 v9, s[12:15], s91 offen offset:1024 lds
    s_add_u32 m0, s62, 98304
    s_nop 0
    buffer_load_dwordx4 v10, s[12:15], s91 offen offset:0 lds
    buffer_load_dwordx4 v11, s[12:15], s91 offen offset:1024 lds
    s_add_u32 m0, s53, 122880
    s_lshl_b32 s70, s64, 7
    s_add_u32 s70, s70, s63
    buffer_load_dwordx4 v2, s[8:11], s70 offen offset:0 lds
    buffer_load_dwordx4 v3, s[8:11], s70 offen offset:1024 lds
    s_cmp_lg_u32 s65, 7
    s_cbranch_scc1 L_h0c7
    ds_read_b128 v[40:43], v28 offset:0
    ds_read_b128 v[44:47], v29 offset:1024
    ds_read_b128 v[48:51], v28 offset:2048
    ds_read_b128 v[52:55], v29 offset:3072
    ds_read_b128 v[56:59], v28 offset:4096
    ds_read_b128 v[60:63], v29 offset:5120
    ds_read_b128 v[64:67], v28 offset:6144
    ds_read_b128 v[68:71], v29 offset:7168
L_h0c7:
    s_waitcnt lgkmcnt(0)
    s_waitcnt vmcnt(13)
    s_barrier
    s_add_u32 m0, s53, 122880
    s_nop 0
    buffer_load_dwordx4 v4, s[8:11], s70 offen offset:2048 lds
    buffer_load_dwordx4 v5, s[8:11], s70 offen offset:3072 lds
    s_mul_i32 s91, s64, 393216
    s_add_u32 s64, s64, 1
    s_and_b32 s64, s64, 15
    s_add_u32 m0, s62, 122880
    s_nop 0
    buffer_load_dwordx4 v6, s[12:15], s91 offen offset:0 lds
    buffer_load_dwordx4 v7, s[12:15], s91 offen offset:1024 lds
    s_add_u32 m0, s62, 131072
    s_nop 0
    buffer_load_dwordx4 v8, s[12:15], s91 offen offset:0 lds
    buffer_load_dwordx4 v9, s[12:15], s91 offen offset:1024 lds
    s_add_u32 m0, s62, 139264
    s_nop 0
    buffer_load_dwordx4 v10, s[12:15], s91 offen offset:0 lds
    buffer_load_dwordx4 v11, s[12:15], s91 offen offset:1024 lds
    s_add_u32 m0, s53, 0
    s_lshl_b32 s70, s64, 7
    s_add_u32 s70, s70, s63
    buffer_load_dwordx4 v2, s[8:11], s70 offen offset:0 lds
    buffer_load_dwordx4 v3, s[8:11], s70 offen offset:1024 lds
    v_mfma_f32_16x16x32_bf16 v[108:111], v[104:107], v[40:43], 0
    v_mfma_f32_16x16x32_bf16 v[108:111], v[104:107], v[44:47], v[108:111]
    v_mfma_f32_16x16x32_bf16 v[108:111], v[104:107], v[48:51], v[108:111]
    v_mfma_f32_16x16x32_bf16 v[108:111], v[104:107], v[52:55], v[108:111]
    v_mfma_f32_16x16x32_bf16 v[108:111], v[104:107], v[56:59], v[108:111]
    v_mfma_f32_16x16x32_bf16 v[108:111], v[104:107], v[60:63], v[108:111]
    v_mfma_f32_16x16x32_bf16 v[108:111], v[104:107], v[64:67], v[108:111]
    v_mfma_f32_16x16x32_bf16 v[108:111], v[104:107], v[68:71], v[108:111]
    s_nop 7
    v_add_f32_dpp v108, v108, v108 row_ror:8 row_mask:0xf bank_mask:0xf
    v_add_f32_dpp v109, v109, v109 row_ror:8 row_mask:0xf bank_mask:0xf
    v_add_f32_dpp v110, v110, v110 row_ror:8 row_mask:0xf bank_mask:0xf
    v_add_f32_dpp v111, v111, v111 row_ror:8 row_mask:0xf bank_mask:0xf
    buffer_store_dwordx4 v[108:111], v34, s[16:19], 0 offen sc1
    s_waitcnt vmcnt(13)
    s_barrier
    s_add_u32 m0, s53, 0
    s_nop 0
    buffer_load_dwordx4 v4, s[8:11], s70 offen offset:2048 lds
    buffer_load_dwordx4 v5, s[8:11], s70 offen offset:3072 lds
    s_mul_i32 s91, s64, 393216
    s_add_u32 s64, s64, 1
    s_and_b32 s64, s64, 15
    s_add_u32 m0, s62, 0
    s_nop 0
    buffer_load_dwordx4 v6, s[12:15], s91 offen offset:0 lds
    buffer_load_dwordx4 v7, s[12:15], s91 offen offset:1024 lds
    s_add_u32 m0, s62, 8192
    s_nop 0
    buffer_load_dwordx4 v8, s[12:15], s91 offen offset:0 lds
    buffer_load_dwordx4 v9, s[12:15], s91 offen offset:1024 lds
    s_add_u32 m0, s62, 16384
    s_nop 0
    buffer_load_dwordx4 v10, s[12:15], s91 offen offset:0 lds
    buffer_load_dwordx4 v11, s[12:15], s91 offen offset:1024 lds
    s_add_u32 m0, s53, 40960
    s_lshl_b32 s70, s64, 7
    s_add_u32 s70, s70, s63
    buffer_load_dwordx4 v2, s[8:11], s70 offen offset:0 lds
    buffer_load_dwordx4 v3, s[8:11], s70 offen offset:1024 lds
    buffer_load_dwordx4 v4, s[8:11], s70 offen offset:2048 lds
    buffer_load_dwordx4 v5, s[8:11], s70 offen offset:3072 lds
    s_mul_i32 s91, s64, 393216
    s_add_u32 s64, s64, 1
    s_and_b32 s64, s64, 15
    s_waitcnt vmcnt(12)
    s_barrier
    buffer_atomic_swap v35, v116, s[16:19], 0 offen sc1
    s_add_u32 m0, s62, 40960
    s_nop 0
    buffer_load_dwordx4 v6, s[12:15], s91 offen offset:0 lds
    buffer_load_dwordx4 v7, s[12:15], s91 offen offset:1024 lds
    s_add_u32 m0, s62, 49152
    s_nop 0
    buffer_load_dwordx4 v8, s[12:15], s91 offen offset:0 lds
    buffer_load_dwordx4 v9, s[12:15], s91 offen offset:1024 lds
    s_add_u32 m0, s62, 57344
    s_nop 0
    buffer_load_dwordx4 v10, s[12:15], s91 offen offset:0 lds
    buffer_load_dwordx4 v11, s[12:15], s91 offen offset:1024 lds
    s_add_u32 m0, s53, 81920
    s_lshl_b32 s70, s64, 7
    s_add_u32 s70, s70, s63
    buffer_load_dwordx4 v2, s[8:11], s70 offen offset:0 lds
    buffer_load_dwordx4 v3, s[8:11], s70 offen offset:1024 lds
    buffer_load_dwordx4 v4, s[8:11], s70 offen offset:2048 lds
    buffer_load_dwordx4 v5, s[8:11], s70 offen offset:3072 lds
    s_mul_i32 s91, s64, 393216
    s_add_u32 s64, s64, 1
    s_and_b32 s64, s64, 15
    s_add_u32 m0, s62, 81920
    s_nop 0
    buffer_load_dwordx4 v6, s[12:15], s91 offen offset:0 lds
    buffer_load_dwordx4 v7, s[12:15], s91 offen offset:1024 lds
    s_waitcnt vmcnt(17)
    s_barrier
    buffer_load_dword v121, v119, s[16:19], 0 offen sc1
    s_add_u32 m0, s62, 90112
    s_nop 0
    buffer_load_dwordx4 v8, s[12:15], s91 offen offset:0 lds
    buffer_load_dwordx4 v9, s[12:15], s91 offen offset:1024 lds
    s_add_u32 m0, s62, 98304
L_walk_4:
    s_cbranch_execz L_walk_8
    s_nop 0
    buffer_load_dwordx4 v10, s[12:15], s91 offen offset:0 lds
    buffer_load_dwordx4 v11, s[12:15], s91 offen offset:1024 lds
    s_add_u32 m0, s53, 122880
    s_lshl_b32 s70, s64, 7
    s_add_u32 s70, s70, s63
    buffer_load_dwordx4 v2, s[8:11], s70 offen offset:0 lds
    buffer_load_dwordx4 v3, s[8:11], s70 offen offset:1024 lds
    buffer_load_dwordx4 v4, s[8:11], s70 offen offset:2048 lds
    buffer_load_dwordx4 v5, s[8:11], s70 offen offset:3072 lds
    s_mul_i32 s91, s64, 393216
    s_add_u32 s64, s64, 1
    s_and_b32 s64, s64, 15
    s_add_u32 m0, s62, 122880
    s_nop 0
    buffer_load_dwordx4 v6, s[12:15], s91 offen offset:0 lds
    buffer_load_dwordx4 v7, s[12:15], s91 offen offset:1024 lds
    s_add_u32 m0, s62, 131072
    s_nop 0
    buffer_load_dwordx4 v8, s[12:15], s91 offen offset:0 lds
    buffer_load_dwordx4 v9, s[12:15], s91 offen offset:1024 lds
    s_waitcnt vmcnt(19)
    s_barrier
    s_add_u32 m0, s62, 139264
    s_nop 0
    buffer_load_dwordx4 v10, s[12:15], s91 offen offset:0 lds
    buffer_load_dwordx4 v11, s[12:15], s91 offen offset:1024 lds
    s_add_u32 m0, s53, 0
    s_lshl_b32 s70, s64, 7
    s_add_u32 s70, s70, s63
    buffer_load_dwordx4 v2, s[8:11], s70 offen offset:0 lds
    buffer_load_dwordx4 v3, s[8:11], s70 offen offset:1024 lds
    buffer_load_dwordx4 v4, s[8:11], s70 offen offset:2048 lds
    buffer_load_dwordx4 v5, s[8:11], s70 offen offset:3072 lds
    s_mul_i32 s91, s64, 393216
    s_add_u32 s64, s64, 1
    s_and_b32 s64, s64, 15
    s_add_u32 m0, s62, 0
    s_nop 0
    buffer_load_dwordx4 v6, s[12:15], s91 offen offset:0 lds
    buffer_load_dwordx4 v7, s[12:15], s91 offen offset:1024 lds
    s_add_u32 m0, s62, 8192
    s_nop 0
    buffer_load_dwordx4 v8, s[12:15], s91 offen offset:0 lds
    buffer_load_dwordx4 v9, s[12:15], s91 offen offset:1024 lds
    s_add_u32 m0, s62, 16384
    s_nop 0
    buffer_load_dwordx4 v10, s[12:15], s91 offen offset:0 lds
    buffer_load_dwordx4 v11, s[12:15], s91 offen offset:1024 lds
    s_waitcnt vmcnt(20)
    s_barrier
    v_mov_b32 v118, 0
    buffer_atomic_or v118, v117, s[16:19], 0 offen sc0 sc1
    s_add_u32 m0, s89, 40960
    s_mov_b32 s90, 655360
    buffer_load_dwordx4 v12, s[20:23], s90 offen lds
    s_add_u32 m0, s89, 45056
    s_mov_b32 s90, 720896
    buffer_load_dwordx4 v12, s[20:23], s90 offen lds
    s_add_u32 m0, s89, 49152
    s_mov_b32 s90, 786432
    buffer_load_dwordx4 v12, s[20:23], s90 offen lds
    s_add_u32 m0, s89, 53248
    s_mov_b32 s90, 851968
    buffer_load_dwordx4 v12, s[20:23], s90 offen lds
    s_mov_b32 s90, 0
    buffer_load_dwordx4 v[164:167], v30, s[32:35], s90 offen
    s_mov_b32 s90, 7168
    buffer_load_dwordx4 v[168:171], v30, s[32:35], s90 offen
    s_mov_b32 s90, 14336
    buffer_load_dwordx4 v[172:175], v30, s[32:35], s90 offen
    s_mov_b32 s90, 21504
    buffer_load_dwordx4 v[176:179], v30, s[32:35], s90 offen
    s_waitcnt vmcnt(19)
    s_barrier
    s_waitcnt vmcnt(8)
    s_branch L_h0_chk0
L_h0_spin:
    v_mov_b32 v118, 0
    buffer_atomic_or v118, v117, s[16:19], 0 offen sc0 sc1
    s_waitcnt vmcnt(0)
L_h0_chk0:
    v_cmp_ne_u32 vcc, s68, v118
    s_nop 0
    s_and_b64 vcc, vcc, s[76:77]
    s_cbranch_vccz L_ok_1
    s_sub_u32 s56, s56, 1
    s_cbranch_scc0 L_h0_spin
    s_mov_b32 s56, 0
L_ok_1:
    v_cmp_eq_u32 vcc, s83, v121
    s_nop 0
    s_cmp_eq_u32 vcc_lo, -1
    s_cselect_b32 s83, 1, 0
    s_mov_b32 s90, 0
    buffer_load_dwordx4 v[40:43], v32, s[16:19], s90 offen sc1
    s_mov_b32 s90, 3072
    buffer_load_dwordx4 v[44:47], v32, s[16:19], s90 offen sc1
    s_mov_b32 s90, 6144
    buffer_load_dwordx4 v[48:51], v32, s[16:19], s90 offen sc1
    s_mov_b32 s90, 9216
    buffer_load_dwordx4 v[52:55], v32, s[16:19], s90 offen sc1
    buffer_load_dwordx4 v[56:59], v33, s[16:19], 0 offen sc1
    buffer_load_dwordx4 v[60:63], v33, s[16:19], s92 offen sc1
    buffer_load_dwordx4 v[64:67], v33, s[16:19], s93 offen sc1
    buffer_load_dwordx4 v[68:71], v33, s[16:19], s94 offen sc1
    s_mov_b32 s90, 28672
    buffer_load_dwordx4 v[180:183], v30, s[32:35], s90 offen
    s_mov_b32 s90, 35840
    buffer_load_dwordx4 v[184:187], v30, s[32:35], s90 offen
    s_mov_b32 s90, 43008
    buffer_load_dwordx4 v[188:191], v30, s[32:35], s90 offen
    s_waitcnt vmcnt(20)
    s_barrier
    v_mov_b32 v24, 135168
    v_lshl_add_u32 v24, v21, 2, v24
    v_mov_b32 v25, 0
    ds_write_b32 v24, v25
    s_add_u32 m0, s89, 57344
    s_mov_b32 s90, 917504
    buffer_load_dwordx4 v12, s[20:23], s90 offen lds
    s_add_u32 m0, s89, 61440
    s_mov_b32 s90, 983040
    buffer_load_dwordx4 v12, s[20:23], s90 offen lds
    s_add_u32 m0, s89, 65536
    s_mov_b32 s90, 1048576
    buffer_load_dwordx4 v12, s[20:23], s90 offen lds
    s_add_u32 m0, s89, 69632
    s_mov_b32 s90, 1114112
    buffer_load_dwordx4 v12, s[20:23], s90 offen lds
    s_add_u32 m0, s89, 73728
    s_mov_b32 s90, 1179648
    buffer_load_dwordx4 v12, s[20:23], s90 offen lds
    s_add_u32 m0, s89, 77824
    s_mov_b32 s90, 1245184
    buffer_load_dwordx4 v12, s[20:23], s90 offen lds
    s_waitcnt vmcnt(9)
    v_add_f32 v40, v40, v44
    v_add_f32 v41, v41, v45
    v_add_f32 v42, v42, v46
    v_add_f32 v43, v43, v47
    v_add_f32 v40, v40, v48
    v_add_f32 v41, v41, v49
    v_add_f32 v42, v42, v50
    v_add_f32 v43, v43, v51
    v_add_f32 v40, v40, v52
    v_add_f32 v41, v41, v53
    v_add_f32 v42, v42, v54
    v_add_f32 v43, v43, v55
    v_add_f32 v56, v56, v60
    v_add_f32 v57, v57, v61
    v_add_f32 v58, v58, v62
    v_add_f32 v59, v59, v63
    v_add_f32 v56, v56, v64
    v_add_f32 v57, v57, v65
    v_add_f32 v58, v58, v66
    v_add_f32 v59, v59, v67
    v_add_f32 v56, v56, v68
    v_add_f32 v57, v57, v69
    v_add_f32 v58, v58, v70
    v_add_f32 v59, v59, v71
    s_nop 0
    v_permlane32_swap_b32 v56, v58
    v_permlane32_swap_b32 v57, v59
    v_permlane32_swap_b32 v40, v42
    v_permlane32_swap_b32 v41, v43
    v_add_f32 v56, v56, v58
    v_add_f32 v57, v57, v59
    v_add_f32 v40, v40, v42
    v_add_f32 v41, v41, v43
    v_mov_b32 v58, v56
    v_mov_b32 v59, v57
    v_permlane16_swap_b32 v40, v41
    v_permlane16_swap_b32 v56, v58
    v_permlane16_swap_b32 v57, v59
    v_add_f32 v40, v40, v41
    v_add_f32 v56, v56, v58
    v_add_f32 v57, v57, v59
    ds_write_b32 v17, v40
    v_mul_f32 v56, 0x3a800000, v56
    v_mul_f32 v57, 0x3a800000, v57
    v_fma_f32 v57, -v56, v56, v57
L_walk_5:
    s_cbranch_execz L_walk_12
    v_max_f32 v57, 0, v57
    v_cvt_pk_bf16_f32 v48, v56, v57
    v_lshlrev_b32 v44, 16, v48
    v_and_b32 v48, 0xffff0000, v48
    v_add_f32 v48, 0x3727c5ac, v48
    v_cvt_pk_bf16_f32 v48, v48, v48
    v_lshlrev_b32 v48, 16, v48
    v_sqrt_f32 v48, v48
    s_nop 0
    v_cvt_pk_bf16_f32 v48, v48, v48
    v_lshlrev_b32 v48, 16, v48
    v_rcp_f32 v46, v48
    v_sub_f32 v44, 0, v44
    v_mul_f32 v48, 0x3fb8aa3b, v46
    ds_write_b32 v16, v44
    ds_write_b32 v16, v46 offset:512
    ds_write_b32 v16, v48 offset:1024
    s_waitcnt lgkmcnt(0)
    s_barrier
    s_setprio 0
    s_add_u32 m0, s89, 81920
    s_mov_b32 s90, 1310720
    buffer_load_dwordx4 v12, s[20:23], s90 offen lds
    s_add_u32 m0, s89, 86016
    s_mov_b32 s90, 1376256
    buffer_load_dwordx4 v12, s[20:23], s90 offen lds
    s_add_u32 m0, s89, 90112
    s_mov_b32 s90, 1441792
    buffer_load_dwordx4 v12, s[20:23], s90 offen lds
    s_add_u32 m0, s89, 94208
    s_mov_b32 s90, 1507328
    buffer_load_dwordx4 v12, s[20:23], s90 offen lds
    s_add_u32 m0, s89, 98304
    s_mov_b32 s90, 1572864
    buffer_load_dwordx4 v12, s[20:23], s90 offen lds
    s_add_u32 m0, s89, 102400
    s_mov_b32 s90, 1638400
    buffer_load_dwordx4 v12, s[20:23], s90 offen lds
    s_add_u32 m0, s89, 106496
    s_mov_b32 s90, 1703936
    buffer_load_dwordx4 v12, s[20:23], s90 offen lds
    s_add_u32 m0, s89, 110592
    s_mov_b32 s90, 1769472
    buffer_load_dwordx4 v12, s[20:23], s90 offen lds
    s_add_u32 m0, s89, 114688
    s_mov_b32 s90, 1835008
    buffer_load_dwordx4 v12, s[20:23], s90 offen lds
    s_add_u32 m0, s89, 118784
    s_mov_b32 s90, 1900544
    buffer_load_dwordx4 v12, s[20:23], s90 offen lds
    s_add_u32 m0, s89, 122880
    s_mov_b32 s90, 1966080
    buffer_load_dwordx4 v12, s[20:23], s90 offen lds
    s_add_u32 m0, s89, 126976
    s_mov_b32 s90, 2031616
    buffer_load_dwordx4 v12, s[20:23], s90 offen lds
    s_add_u32 m0, s89, 0
    s_mov_b32 s90, 0
    buffer_load_dwordx4 v12, s[20:23], s90 offen lds
    s_add_u32 m0, s89, 4096
    s_mov_b32 s90, 65536
    buffer_load_dwordx4 v12, s[20:23], s90 offen lds
    s_add_u32 m0, s89, 8192
    s_mov_b32 s90, 131072
    buffer_load_dwordx4 v12, s[20:23], s90 offen lds
    s_add_u32 m0, s89, 12288
    s_mov_b32 s90, 196608
    buffer_load_dwordx4 v12, s[20:23], s90 offen lds
    s_add_u32 m0, s89, 16384
    s_mov_b32 s90, 262144
    buffer_load_dwordx4 v12, s[20:23], s90 offen lds
    s_add_u32 m0, s89, 20480
    s_mov_b32 s90, 327680
    buffer_load_dwordx4 v12, s[20:23], s90 offen lds
    s_add_u32 m0, s89, 24576
    s_mov_b32 s90, 393216
    buffer_load_dwordx4 v12, s[20:23], s90 offen lds
    s_add_u32 m0, s89, 28672
    s_mov_b32 s90, 458752
    buffer_load_dwordx4 v12, s[20:23], s90 offen lds
    s_add_u32 m0, s89, 32768
    s_mov_b32 s90, 524288
    buffer_load_dwordx4 v12, s[20:23], s90 offen lds
    s_add_u32 m0, s89, 36864
    s_mov_b32 s90, 589824
    buffer_load_dwordx4 v12, s[20:23], s90 offen lds
    s_lshl_b32 s86, s47, 2
    s_add_u32 s86, s86, s48
    s_lshl_b32 s87, s86, 7
    s_add_u32 s87, s87, 671744
    v_lshl_add_u32 v6, v0, 2, s87
    v_mov_b32 v4, 2147483648
    v_cmp_gt_u32 vcc, 16, v0
    s_nop 1
    v_cndmask_b32 v6, v4, v6, vcc
    s_lshl_b32 s86, s86, 14
    s_add_u32 s86, s86, 5242880
    v_lshl_add_u32 v2, v0, 4, s86
    s_lshl_b32 s86, s47, 1
    s_add_u32 s86, s86, s50
    s_lshl_b32 s86, s86, 11
    s_lshl_b32 s87, s49, 6
    s_add_u32 s86, s86, s87
    s_add_u32 s86, s86, 6881280
    v_lshl_add_u32 v3, v23, 7, s86
    v_lshl_add_u32 v3, v22, 4, v3
    v_mov_b32 v112, 0
    v_mov_b32 v113, 0
    v_mov_b32 v114, 0
    v_mov_b32 v115, 0
    v_mov_b32 v116, 0
    v_mov_b32 v117, 0
    v_mov_b32 v118, 0
    v_mov_b32 v119, 0
    s_lshr_b32 s62, s3, 2
    s_lshl_b32 s53, s51, 3
    s_lshl_b32 s86, s48, 1
    s_add_u32 s53, s53, s86
    s_add_u32 s53, s53, s62
    v_lshrrev_b32 v36, 4, v0
    v_and_b32 v37, 15, v0
    s_lshl_b32 s87, s53, 15
    s_lshl_b32 s86, s62, 14
    s_add_u32 s86, s86, s87
    s_add_u32 s86, s86, 1048576
    v_lshl_add_u32 v157, v0, 4, s86
    v_xor_b32 v158, 0x8000, v157
    s_lshl_b32 s86, s51, 1
    s_lshr_b32 s87, s48, 1
    s_add_u32 s86, s86, s87
    s_lshl_b32 s86, s86, 1
    s_add_u32 s86, s86, s62
    s_lshl_b32 s86, s86, 1
    s_and_b32 s87, s48, 1
    s_add_u32 s86, s86, s87
    s_lshl_b32 s86, s86, 7
    s_add_u32 s86, s86, 688128
    v_lshl_add_u32 v159, v0, 2, s86
    v_mov_b32 v38, 2147483648
    v_cmp_gt_u32 vcc, 16, v0
    s_nop 1
    v_cndmask_b32 v159, v38, v159, vcc
    v_bfe_u32 v38, v0, 2, 2
    v_lshl_add_u32 v38, v36, 2, v38
    v_bfe_u32 v39, v38, 1, 2
    v_lshlrev_b32 v38, 7, v38
    v_lshl_add_u32 v38, v39, 5, v38
    v_and_b32 v39, 3, v0
    v_lshl_add_u32 v38, v39, 3, v38
    s_lshl_b32 s86, s62, 16
    s_add_u32 s86, s86, 0
    v_add_u32 v144, s86, v38
    v_xor_b32 v145, 32, v144
    v_xor_b32 v146, 64, v144
    v_xor_b32 v147, 96, v144
    v_cmp_eq_u32 s[4:5], 1, v39
    v_cmp_eq_u32 s[6:7], 2, v39
    v_cmp_eq_u32 s[98:99], 3, v39
    s_lshl_b32 s86, s53, 10
    s_add_u32 s86, s86, 786432
    v_lshl_add_u32 v160, v0, 2, s86
    v_mul_u32_u24 v161, 192, v36
    v_add_u32 v160, v160, v161
    s_mov_b32 s72, 0x00f0000f
    s_mov_b32 s73, 0xf0000f00
    s_mov_b32 s74, 0x0f00f000
    s_mov_b32 s75, 0x0f00f000
L_walk_6:
    s_cbranch_execz L_walk_13
    v_lshrrev_b32 v38, 2, v37
    v_lshl_add_u32 v161, v38, 4, v37
    v_lshlrev_b32 v161, 2, v161
    s_lshl_b32 s86, s3, 12
    s_add_u32 s86, s86, 131072
    v_lshl_add_u32 v162, v0, 4, s86
    v_xor_b32 v163, 0x4000, v162
    s_lshl_b32 s86, s52, 7
    v_lshl_add_u32 v36, v36, 3, s86
    s_lshl_b32 s87, s53, 15
    s_add_u32 s87, s87, s86
    s_lshl_b32 s86, s62, 6
    s_add_u32 s87, s87, s86
    v_lshl_add_u32 v39, v37, 11, s87
    v_and_b32 v38, 48, v0
    v_add_u32 v39, v39, v38
    v_xor_b32 v37, 0x8000, v39
    v_lshlrev_b32 v38, 4, v0
    buffer_load_dwordx2 v[148:149], v36, s[40:43], 0 offen offset:0
    buffer_load_dwordx2 v[150:151], v36, s[40:43], 0 offen offset:32
    buffer_load_dwordx2 v[152:153], v36, s[40:43], 0 offen offset:64
    buffer_load_dwordx2 v[154:155], v36, s[40:43], 0 offen offset:96
    buffer_load_dwordx4 v[128:131], v38, s[40:43], 0 offen
    buffer_load_dwordx4 v[132:135], v38, s[40:43], 0 offen offset:1024
    buffer_load_dwordx4 v[136:139], v39, s[8:11], 0 offen
    buffer_load_dwordx4 v[140:143], v37, s[8:11], 0 offen
    s_mov_b32 s90, 50176
    buffer_load_dwordx4 v[192:195], v30, s[32:35], s90 offen
    s_mov_b32 s90, 57344
    buffer_load_dwordx4 v[196:199], v30, s[32:35], s90 offen
    s_mov_b32 s90, 64512
    buffer_load_dwordx4 v[200:203], v30, s[32:35], s90 offen
    s_waitcnt vmcnt(5)
    v_mov_b32 v4, 0
    buffer_atomic_or v4, v6, s[16:19], 0 offen sc0 sc1
    v_bfe_u32 v36, v0, 2, 1
    v_cmp_eq_u32 vcc, 1, v36
    v_mov_b32 v36, s95
    v_mov_b32 v38, 0
    v_dot2c_f32_bf16 v38, s95, v128
    v_dot2c_f32_bf16 v38, s95, v129
    v_dot2c_f32_bf16 v38, s95, v130
    v_dot2c_f32_bf16 v38, s95, v131
    v_dot2c_f32_bf16 v38, s95, v132
    v_dot2c_f32_bf16 v38, s95, v133
    v_dot2c_f32_bf16 v38, s95, v134
    v_dot2c_f32_bf16 v38, s95, v135
    v_cndmask_b32 v148, v36, v148, vcc
    v_cndmask_b32 v149, v36, v149, vcc
    v_cndmask_b32 v150, v36, v150, vcc
    v_cndmask_b32 v151, v36, v151, vcc
    v_cndmask_b32 v152, v36, v152, vcc
    v_cndmask_b32 v153, v36, v153, vcc
    v_cndmask_b32 v154, v36, v154, vcc
    v_cndmask_b32 v155, v36, v155, vcc
    v_add_f32_dpp v38, v38, v38 row_ror:8 row_mask:0xf bank_mask:0xf
    s_nop 1
    v_add_f32_dpp v38, v38, v38 row_ror:4 row_mask:0xf bank_mask:0xf
    s_nop 1
    v_add_f32_dpp v38, v38, v38 row_ror:2 row_mask:0xf bank_mask:0xf
    s_nop 1
    v_add_f32_dpp v38, v38, v38 row_ror:1 row_mask:0xf bank_mask:0xf
    v_mov_b32 v36, v38
    s_nop 1
    v_permlane32_swap_b32 v38, v36
    v_add_f32 v38, v38, v36
    v_mov_b32 v36, v38
    s_nop 1
    v_permlane16_swap_b32 v38, v36
    v_add_f32 v38, v38, v36
    v_mov_b32 v36, 135200
    v_readfirstlane_b32 s57, v38
    ds_write_b32 v36, v38
    s_mul_i32 s86, s50, 3072
    s_add_u32 s86, s86, 151552
    v_lshl_add_u32 v7, v0, 4, s86
    s_lshl_b32 s86, s49, 10
    v_add_u32 v5, s86, v7
    s_lshl_b32 s86, s49, 3
    v_add_u32 v7, s86, v7
    s_mov_b32 s88, 0xffff0000
    s_mov_b32 s86, 0x00003f80
    s_mov_b32 s87, 0x3f800000
    s_branch L_h1_w0
L_h1_r0:
    s_ff1_i32_b32 s66, s65
    s_bitset0_b32 s65, s66
    s_lshl_b32 s66, s66, 10
    buffer_load_dwordx4 v[40:43], v2, s[16:19], s66 offen sc1
    s_cmp_eq_u32 s65, 0
    s_cbranch_scc1 L_h1_p1
L_h1_r1:
    s_ff1_i32_b32 s66, s65
    s_bitset0_b32 s65, s66
    s_lshl_b32 s66, s66, 10
    buffer_load_dwordx4 v[44:47], v2, s[16:19], s66 offen sc1
    s_cmp_eq_u32 s65, 0
    s_cbranch_scc1 L_h1_p2
L_h1_r2:
    s_ff1_i32_b32 s66, s65
    s_bitset0_b32 s65, s66
    s_lshl_b32 s66, s66, 10
    buffer_load_dwordx4 v[48:51], v2, s[16:19], s66 offen sc1
    s_cmp_eq_u32 s65, 0
    s_cbranch_scc1 L_h1_p3
L_h1_r3:
    s_ff1_i32_b32 s66, s65
    s_bitset0_b32 s65, s66
    s_lshl_b32 s66, s66, 10
    buffer_load_dwordx4 v[52:55], v2, s[16:19], s66 offen sc1
    s_cmp_eq_u32 s65, 0
    s_cbranch_scc1 L_h1_p4
L_h1_r4:
    s_ff1_i32_b32 s66, s65
    s_bitset0_b32 s65, s66
    s_lshl_b32 s66, s66, 10
    buffer_load_dwordx4 v[56:59], v2, s[16:19], s66 offen sc1
    s_cmp_eq_u32 s65, 0
    s_cbranch_scc1 L_h1_p5
L_h1_r5:
    s_ff1_i32_b32 s66, s65
    s_bitset0_b32 s65, s66
    s_lshl_b32 s66, s66, 10
    buffer_load_dwordx4 v[60:63], v2, s[16:19], s66 offen sc1
    s_cmp_eq_u32 s65, 0
    s_cbranch_scc1 L_h1_p6
L_h1_r6:
    s_ff1_i32_b32 s66, s65
    s_bitset0_b32 s65, s66
    s_lshl_b32 s66, s66, 10
    buffer_load_dwordx4 v[64:67], v2, s[16:19], s66 offen sc1
    s_cmp_eq_u32 s65, 0
    s_cbranch_scc1 L_h1_p7
L_h1_r7:
    s_ff1_i32_b32 s66, s65
    s_bitset0_b32 s65, s66
    s_lshl_b32 s66, s66, 10
    buffer_load_dwordx4 v[68:71], v2, s[16:19], s66 offen sc1
    s_cmp_eq_u32 s65, 0
    s_cbranch_scc1 L_h1_p8
L_h1_r8:
    s_ff1_i32_b32 s66, s65
    s_bitset0_b32 s65, s66
    s_lshl_b32 s66, s66, 10
    buffer_load_dwordx4 v[72:75], v2, s[16:19], s66 offen sc1
    s_cmp_eq_u32 s65, 0
    s_cbranch_scc1 L_h1_p9
L_h1_r9:
    s_ff1_i32_b32 s66, s65
    s_bitset0_b32 s65, s66
    s_lshl_b32 s66, s66, 10
    buffer_load_dwordx4 v[76:79], v2, s[16:19], s66 offen sc1
    s_cmp_eq_u32 s65, 0
    s_cbranch_scc1 L_h1_p10
L_h1_r10:
    s_ff1_i32_b32 s66, s65
    s_bitset0_b32 s65, s66
    s_lshl_b32 s66, s66, 10
    buffer_load_dwordx4 v[80:83], v2, s[16:19], s66 offen sc1
    s_cmp_eq_u32 s65, 0
    s_cbranch_scc1 L_h1_p11
L_h1_r11:
    s_ff1_i32_b32 s66, s65
    s_bitset0_b32 s65, s66
    s_lshl_b32 s66, s66, 10
    buffer_load_dwordx4 v[84:87], v2, s[16:19], s66 offen sc1
    s_cmp_eq_u32 s65, 0
    s_cbranch_scc1 L_h1_p12
L_h1_r12:
    s_ff1_i32_b32 s66, s65
    s_bitset0_b32 s65, s66
    s_lshl_b32 s66, s66, 10
    buffer_load_dwordx4 v[88:91], v2, s[16:19], s66 offen sc1
    s_cmp_eq_u32 s65, 0
    s_cbranch_scc1 L_h1_p13
L_h1_r13:
    s_ff1_i32_b32 s66, s65
    s_bitset0_b32 s65, s66
    s_lshl_b32 s66, s66, 10
    buffer_load_dwordx4 v[92:95], v2, s[16:19], s66 offen sc1
    s_cmp_eq_u32 s65, 0
    s_cbranch_scc1 L_h1_p14
L_h1_r14:
    s_ff1_i32_b32 s66, s65
    s_bitset0_b32 s65, s66
    s_lshl_b32 s66, s66, 10
    buffer_load_dwordx4 v[96:99], v2, s[16:19], s66 offen sc1
    s_cmp_eq_u32 s65, 0
    s_cbranch_scc1 L_h1_p15
L_h1_r15:
    s_ff1_i32_b32 s66, s65
    s_bitset0_b32 s65, s66
    s_lshl_b32 s66, s66, 10
    buffer_load_dwordx4 v[100:103], v2, s[16:19], s66 offen sc1
    buffer_load_dwordx4 v[104:107], v3, s[16:19], 0 offen sc1
L_h1_acc:
    s_waitcnt vmcnt(16)
    v_dot2c_f32_bf16 v112, s86, v40
    v_dot2c_f32_bf16 v113, s87, v40
    v_dot2c_f32_bf16 v114, s86, v41
    v_dot2c_f32_bf16 v115, s87, v41
    v_dot2c_f32_bf16 v116, s86, v42
    v_dot2c_f32_bf16 v117, s87, v42
    v_dot2c_f32_bf16 v118, s86, v43
    v_dot2c_f32_bf16 v119, s87, v43
    s_waitcnt vmcnt(15)
    v_dot2c_f32_bf16 v112, s86, v44
    v_dot2c_f32_bf16 v113, s87, v44
    v_dot2c_f32_bf16 v114, s86, v45
    v_dot2c_f32_bf16 v115, s87, v45
    v_dot2c_f32_bf16 v116, s86, v46
    v_dot2c_f32_bf16 v117, s87, v46
    v_dot2c_f32_bf16 v118, s86, v47
    v_dot2c_f32_bf16 v119, s87, v47
    s_waitcnt vmcnt(14)
    v_dot2c_f32_bf16 v112, s86, v48
    v_dot2c_f32_bf16 v113, s87, v48
    v_dot2c_f32_bf16 v114, s86, v49
    v_dot2c_f32_bf16 v115, s87, v49
    v_dot2c_f32_bf16 v116, s86, v50
    v_dot2c_f32_bf16 v117, s87, v50
    v_dot2c_f32_bf16 v118, s86, v51
    v_dot2c_f32_bf16 v119, s87, v51
    v_max3_u32 v4, v43, v47, v51
    s_waitcnt vmcnt(13)
    v_dot2c_f32_bf16 v112, s86, v52
    v_dot2c_f32_bf16 v113, s87, v52
    v_dot2c_f32_bf16 v114, s86, v53
    v_dot2c_f32_bf16 v115, s87, v53
    v_dot2c_f32_bf16 v116, s86, v54
    v_dot2c_f32_bf16 v117, s87, v54
    v_dot2c_f32_bf16 v118, s86, v55
    v_dot2c_f32_bf16 v119, s87, v55
    s_waitcnt vmcnt(12)
    v_dot2c_f32_bf16 v112, s86, v56
    v_dot2c_f32_bf16 v113, s87, v56
    v_dot2c_f32_bf16 v114, s86, v57
    v_dot2c_f32_bf16 v115, s87, v57
    v_dot2c_f32_bf16 v116, s86, v58
    v_dot2c_f32_bf16 v117, s87, v58
    v_dot2c_f32_bf16 v118, s86, v59
    v_dot2c_f32_bf16 v119, s87, v59
    v_max3_u32 v4, v4, v55, v59
L_walk_7:
    s_cbranch_execz L_walk_14
    s_waitcnt vmcnt(11)
    v_dot2c_f32_bf16 v112, s86, v60
    v_dot2c_f32_bf16 v113, s87, v60
    v_dot2c_f32_bf16 v114, s86, v61
    v_dot2c_f32_bf16 v115, s87, v61
    v_dot2c_f32_bf16 v116, s86, v62
    v_dot2c_f32_bf16 v117, s87, v62
    v_dot2c_f32_bf16 v118, s86, v63
    v_dot2c_f32_bf16 v119, s87, v63
    s_waitcnt vmcnt(10)
    v_dot2c_f32_bf16 v112, s86, v64
    v_dot2c_f32_bf16 v113, s87, v64
    v_dot2c_f32_bf16 v114, s86, v65
    v_dot2c_f32_bf16 v115, s87, v65
    v_dot2c_f32_bf16 v116, s86, v66
    v_dot2c_f32_bf16 v117, s87, v66
    v_dot2c_f32_bf16 v118, s86, v67
    v_dot2c_f32_bf16 v119, s87, v67
    v_max3_u32 v4, v4, v63, v67
    s_waitcnt vmcnt(9)
    v_dot2c_f32_bf16 v112, s86, v68
    v_dot2c_f32_bf16 v113, s87, v68
    v_dot2c_f32_bf16 v114, s86, v69
    v_dot2c_f32_bf16 v115, s87, v69
    v_dot2c_f32_bf16 v116, s86, v70
    v_dot2c_f32_bf16 v117, s87, v70
    v_dot2c_f32_bf16 v118, s86, v71
    v_dot2c_f32_bf16 v119, s87, v71
    s_waitcnt vmcnt(8)
    v_dot2c_f32_bf16 v112, s86, v72
    v_dot2c_f32_bf16 v113, s87, v72
    v_dot2c_f32_bf16 v114, s86, v73
    v_dot2c_f32_bf16 v115, s87, v73
    v_dot2c_f32_bf16 v116, s86, v74
    v_dot2c_f32_bf16 v117, s87, v74
    v_dot2c_f32_bf16 v118, s86, v75
    v_dot2c_f32_bf16 v119, s87, v75
    v_max3_u32 v4, v4, v71, v75
    s_waitcnt vmcnt(7)
    v_dot2c_f32_bf16 v112, s86, v76
    v_dot2c_f32_bf16 v113, s87, v76
    v_dot2c_f32_bf16 v114, s86, v77
    v_dot2c_f32_bf16 v115, s87, v77
    v_dot2c_f32_bf16 v116, s86, v78
    v_dot2c_f32_bf16 v117, s87, v78
    v_dot2c_f32_bf16 v118, s86, v79
    v_dot2c_f32_bf16 v119, s87, v79
    s_waitcnt vmcnt(6)
    v_dot2c_f32_bf16 v112, s86, v80
    v_dot2c_f32_bf16 v113, s87, v80
    v_dot2c_f32_bf16 v114, s86, v81
    v_dot2c_f32_bf16 v115, s87, v81
    v_dot2c_f32_bf16 v116, s86, v82
    v_dot2c_f32_bf16 v117, s87, v82
    v_dot2c_f32_bf16 v118, s86, v83
    v_dot2c_f32_bf16 v119, s87, v83
    v_max3_u32 v4, v4, v79, v83
    s_waitcnt vmcnt(5)
    v_dot2c_f32_bf16 v112, s86, v84
    v_dot2c_f32_bf16 v113, s87, v84
    v_dot2c_f32_bf16 v114, s86, v85
    v_dot2c_f32_bf16 v115, s87, v85
    v_dot2c_f32_bf16 v116, s86, v86
    v_dot2c_f32_bf16 v117, s87, v86
    v_dot2c_f32_bf16 v118, s86, v87
    v_dot2c_f32_bf16 v119, s87, v87
    s_waitcnt vmcnt(4)
    v_dot2c_f32_bf16 v112, s86, v88
    v_dot2c_f32_bf16 v113, s87, v88
    v_dot2c_f32_bf16 v114, s86, v89
    v_dot2c_f32_bf16 v115, s87, v89
    v_dot2c_f32_bf16 v116, s86, v90
    v_dot2c_f32_bf16 v117, s87, v90
    v_dot2c_f32_bf16 v118, s86, v91
    v_dot2c_f32_bf16 v119, s87, v91
    v_max3_u32 v4, v4, v87, v91
    s_waitcnt vmcnt(3)
    v_dot2c_f32_bf16 v112, s86, v92
    v_dot2c_f32_bf16 v113, s87, v92
    v_dot2c_f32_bf16 v114, s86, v93
    v_dot2c_f32_bf16 v115, s87, v93
    v_dot2c_f32_bf16 v116, s86, v94
    v_dot2c_f32_bf16 v117, s87, v94
    v_dot2c_f32_bf16 v118, s86, v95
    v_dot2c_f32_bf16 v119, s87, v95
    s_waitcnt vmcnt(2)
    v_dot2c_f32_bf16 v112, s86, v96
    v_dot2c_f32_bf16 v113, s87, v96
    v_dot2c_f32_bf16 v114, s86, v97
    v_dot2c_f32_bf16 v115, s87, v97
    v_dot2c_f32_bf16 v116, s86, v98
    v_dot2c_f32_bf16 v117, s87, v98
    v_dot2c_f32_bf16 v118, s86, v99
    v_dot2c_f32_bf16 v119, s87, v99
    v_max3_u32 v4, v4, v95, v99
    s_waitcnt vmcnt(1)
    v_dot2c_f32_bf16 v112, s86, v100
    v_dot2c_f32_bf16 v113, s87, v100
    v_dot2c_f32_bf16 v114, s86, v101
    v_dot2c_f32_bf16 v115, s87, v101
    v_dot2c_f32_bf16 v116, s86, v102
    v_dot2c_f32_bf16 v117, s87, v102
    v_dot2c_f32_bf16 v118, s86, v103
    v_dot2c_f32_bf16 v119, s87, v103
    s_waitcnt vmcnt(0)
    v_max3_u32 v4, v4, v103, v107
    v_add_f32_dpp v104, v104, v104 row_ror:8 row_mask:0xf bank_mask:0xf
    v_add_f32_dpp v105, v105, v105 row_ror:8 row_mask:0xf bank_mask:0xf
    v_add_f32_dpp v106, v106, v106 row_ror:8 row_mask:0xf bank_mask:0xf
    v_add_f32_dpp v107, v107, v107 row_ror:8 row_mask:0xf bank_mask:0xf
    v_cvt_pk_bf16_f32 v120, v112, v113
    v_cvt_pk_bf16_f32 v121, v114, v115
    v_cvt_pk_bf16_f32 v122, v116, v117
    v_cvt_pk_bf16_f32 v123, v118, v119
    ds_write_b128 v5, v[120:123]
    v_add_f32_dpp v104, v104, v104 row_ror:4 row_mask:0xf bank_mask:0xf
    v_add_f32_dpp v105, v105, v105 row_ror:4 row_mask:0xf bank_mask:0xf
    v_add_f32_dpp v106, v106, v106 row_ror:4 row_mask:0xf bank_mask:0xf
    v_add_f32_dpp v107, v107, v107 row_ror:4 row_mask:0xf bank_mask:0xf
    v_add_f32_dpp v104, v104, v104 row_ror:2 row_mask:0xf bank_mask:0xf
    v_add_f32_dpp v105, v105, v105 row_ror:2 row_mask:0xf bank_mask:0xf
    v_add_f32_dpp v106, v106, v106 row_ror:2 row_mask:0xf bank_mask:0xf
    v_add_f32_dpp v107, v107, v107 row_ror:2 row_mask:0xf bank_mask:0xf
    v_add_f32_dpp v104, v104, v104 row_ror:1 row_mask:0xf bank_mask:0xf
    v_add_f32_dpp v105, v105, v105 row_ror:1 row_mask:0xf bank_mask:0xf
    v_add_f32_dpp v106, v106, v106 row_ror:1 row_mask:0xf bank_mask:0xf
    v_add_f32_dpp v107, v107, v107 row_ror:1 row_mask:0xf bank_mask:0xf
    v_cmp_eq_u32 vcc, -1, v4
    v_cvt_pk_bf16_f32 v124, v104, v105
    v_cvt_pk_bf16_f32 v125, v106, v107
    ds_write_b64 v7, v[124:125] offset:2048
    s_cbranch_vccnz L_h1_again
L_h1_done:
    s_waitcnt lgkmcnt(0)
    s_barrier
    s_or_b32 s86, s2, s48
    s_cmp_eq_u32 s86, 0
    s_cselect_b32 s86, 0, 2147483648
    s_add_u32 s86, s86, 524288
    v_mov_b32 v6, s86
    buffer_store_dword v35, v6, s[16:19], 0 offen sc1
    v_mov_b32 v11, v30
    v_mov_b32 v14, v31
    v_mov_b32 v8, 0
    buffer_atomic_or v8, v159, s[16:19], 0 offen sc0 sc1
    s_branch L_phaseB
L_h1_p0:
    v_mov_b32 v4, 0
    buffer_atomic_or v4, v6, s[16:19], 0 offen sc0 sc1
L_h1_w0:
    s_waitcnt vmcnt(0)
    v_cmp_eq_u32 vcc, s68, v4
    s_nop 0
    s_andn2_b32 s65, vcc_lo, s88
    s_or_b32 s88, s88, s65
    s_cmp_lg_u32 s65, 0
    s_cbranch_scc1 L_h1_r0
    s_sub_u32 s56, s56, 1
    s_cbranch_scc0 L_h1_p0
    s_mov_b32 s56, 0
    s_not_b32 s65, s88
    s_branch L_h1_r0
L_h1_p1:
    v_mov_b32 v4, 0
    buffer_atomic_or v4, v6, s[16:19], 0 offen sc0 sc1
    s_waitcnt vmcnt(0)
    v_cmp_eq_u32 vcc, s68, v4
    s_nop 0
    s_andn2_b32 s65, vcc_lo, s88
    s_or_b32 s88, s88, s65
    s_cmp_lg_u32 s65, 0
    s_cbranch_scc1 L_h1_r1
    s_sub_u32 s56, s56, 1
    s_cbranch_scc0 L_h1_p1
    s_mov_b32 s56, 0
    s_not_b32 s65, s88
    s_branch L_h1_r1
L_h1_p2:
    v_mov_b32 v4, 0
    buffer_atomic_or v4, v6, s[16:19], 0 offen sc0 sc1
    s_waitcnt vmcnt(0)
    v_cmp_eq_u32 vcc, s68, v4
    s_nop 0
    s_andn2_b32 s65, vcc_lo, s88
    s_or_b32 s88, s88, s65
    s_cmp_lg_u32 s65, 0
    s_cbranch_scc1 L_h1_r2
    s_sub_u32 s56, s56, 1
    s_cbranch_scc0 L_h1_p2
    s_mov_b32 s56, 0
    s_not_b32 s65, s88
    s_branch L_h1_r2
L_h1_p3:
    v_mov_b32 v4, 0
    buffer_atomic_or v4, v6, s[16:19], 0 offen sc0 sc1
    s_waitcnt vmcnt(0)
    v_cmp_eq_u32 vcc, s68, v4
    s_nop 0
    s_andn2_b32 s65, vcc_lo, s88
    s_or_b32 s88, s88, s65
    s_cmp_lg_u32 s65, 0
    s_cbranch_scc1 L_h1_r3
    s_sub_u32 s56, s56, 1
    s_cbranch_scc0 L_h1_p3
    s_mov_b32 s56, 0
    s_not_b32 s65, s88
    s_branch L_h1_r3
L_h1_p4:
    v_mov_b32 v4, 0
    buffer_atomic_or v4, v6, s[16:19], 0 offen sc0 sc1
    s_waitcnt vmcnt(0)
    v_cmp_eq_u32 vcc, s68, v4
    s_nop 0
    s_andn2_b32 s65, vcc_lo, s88
    s_or_b32 s88, s88, s65
    s_cmp_lg_u32 s65, 0
    s_cbranch_scc1 L_h1_r4
    s_sub_u32 s56, s56, 1
    s_cbranch_scc0 L_h1_p4
    s_mov_b32 s56, 0
    s_not_b32 s65, s88
    s_branch L_h1_r4
L_h1_p5:
    v_mov_b32 v4, 0
    buffer_atomic_or v4, v6, s[16:19], 0 offen sc0 sc1
    s_waitcnt vmcnt(0)
    v_cmp_eq_u32 vcc, s68, v4
    s_nop 0
    s_andn2_b32 s65, vcc_lo, s88
    s_or_b32 s88, s88, s65
    s_cmp_lg_u32 s65, 0
    s_cbranch_scc1 L_h1_r5
    s_sub_u32 s56, s56, 1
    s_cbranch_scc0 L_h1_p5
    s_mov_b32 s56, 0
    s_not_b32 s65, s88
    s_branch L_h1_r5
L_walk_8:
    s_cbranch_execz L_walk_15
L_h1_p6:
    v_mov_b32 v4, 0
    buffer_atomic_or v4, v6, s[16:19], 0 offen sc0 sc1
    s_waitcnt vmcnt(0)
    v_cmp_eq_u32 vcc, s68, v4
    s_nop 0
    s_andn2_b32 s65, vcc_lo, s88
    s_or_b32 s88, s88, s65
    s_cmp_lg_u32 s65, 0
    s_cbranch_scc1 L_h1_r6
    s_sub_u32 s56, s56, 1
    s_cbranch_scc0 L_h1_p6
    s_mov_b32 s56, 0
    s_not_b32 s65, s88
    s_branch L_h1_r6
L_h1_p7:
    v_mov_b32 v4, 0
    buffer_atomic_or v4, v6, s[16:19], 0 offen sc0 sc1
    s_waitcnt vmcnt(0)
    v_cmp_eq_u32 vcc, s68, v4
    s_nop 0
    s_andn2_b32 s65, vcc_lo, s88
    s_or_b32 s88, s88, s65
    s_cmp_lg_u32 s65, 0
    s_cbranch_scc1 L_h1_r7
    s_sub_u32 s56, s56, 1
    s_cbranch_scc0 L_h1_p7
    s_mov_b32 s56, 0
    s_not_b32 s65, s88
    s_branch L_h1_r7
L_h1_p8:
    v_mov_b32 v4, 0
    buffer_atomic_or v4, v6, s[16:19], 0 offen sc0 sc1
    s_waitcnt vmcnt(0)
    v_cmp_eq_u32 vcc, s68, v4
    s_nop 0
    s_andn2_b32 s65, vcc_lo, s88
    s_or_b32 s88, s88, s65
    s_cmp_lg_u32 s65, 0
    s_cbranch_scc1 L_h1_r8
    s_sub_u32 s56, s56, 1
    s_cbranch_scc0 L_h1_p8
    s_mov_b32 s56, 0
    s_not_b32 s65, s88
    s_branch L_h1_r8
L_h1_p9:
    v_mov_b32 v4, 0
    buffer_atomic_or v4, v6, s[16:19], 0 offen sc0 sc1
    s_waitcnt vmcnt(0)
    v_cmp_eq_u32 vcc, s68, v4
    s_nop 0
    s_andn2_b32 s65, vcc_lo, s88
    s_or_b32 s88, s88, s65
    s_cmp_lg_u32 s65, 0
    s_cbranch_scc1 L_h1_r9
    s_sub_u32 s56, s56, 1
    s_cbranch_scc0 L_h1_p9
    s_mov_b32 s56, 0
    s_not_b32 s65, s88
    s_branch L_h1_r9
L_h1_p10:
    v_mov_b32 v4, 0
    buffer_atomic_or v4, v6, s[16:19], 0 offen sc0 sc1
    s_waitcnt vmcnt(0)
    v_cmp_eq_u32 vcc, s68, v4
    s_nop 0
    s_andn2_b32 s65, vcc_lo, s88
    s_or_b32 s88, s88, s65
    s_cmp_lg_u32 s65, 0
    s_cbranch_scc1 L_h1_r10
    s_sub_u32 s56, s56, 1
    s_cbranch_scc0 L_h1_p10
    s_mov_b32 s56, 0
    s_not_b32 s65, s88
    s_branch L_h1_r10
L_h1_p11:
    v_mov_b32 v4, 0
    buffer_atomic_or v4, v6, s[16:19], 0 offen sc0 sc1
    s_waitcnt vmcnt(0)
    v_cmp_eq_u32 vcc, s68, v4
    s_nop 0
    s_andn2_b32 s65, vcc_lo, s88
    s_or_b32 s88, s88, s65
    s_cmp_lg_u32 s65, 0
    s_cbranch_scc1 L_h1_r11
    s_sub_u32 s56, s56, 1
    s_cbranch_scc0 L_h1_p11
    s_mov_b32 s56, 0
    s_not_b32 s65, s88
    s_branch L_h1_r11
L_h1_p12:
    v_mov_b32 v4, 0
    buffer_atomic_or v4, v6, s[16:19], 0 offen sc0 sc1
    s_waitcnt vmcnt(0)
    v_cmp_eq_u32 vcc, s68, v4
    s_nop 0
    s_andn2_b32 s65, vcc_lo, s88
    s_or_b32 s88, s88, s65
    s_cmp_lg_u32 s65, 0
    s_cbranch_scc1 L_h1_r12
    s_sub_u32 s56, s56, 1
    s_cbranch_scc0 L_h1_p12
    s_mov_b32 s56, 0
    s_not_b32 s65, s88
    s_branch L_h1_r12
L_h1_p13:
    v_mov_b32 v4, 0
    buffer_atomic_or v4, v6, s[16:19], 0 offen sc0 sc1
    s_waitcnt vmcnt(0)
    v_cmp_eq_u32 vcc, s68, v4
    s_nop 0
    s_andn2_b32 s65, vcc_lo, s88
    s_or_b32 s88, s88, s65
    s_cmp_lg_u32 s65, 0
    s_cbranch_scc1 L_h1_r13
    s_sub_u32 s56, s56, 1
    s_cbranch_scc0 L_h1_p13
    s_mov_b32 s56, 0
    s_not_b32 s65, s88
    s_branch L_h1_r13
L_h1_p14:
    v_mov_b32 v4, 0
    buffer_atomic_or v4, v6, s[16:19], 0 offen sc0 sc1
    s_waitcnt vmcnt(0)
    v_cmp_eq_u32 vcc, s68, v4
    s_nop 0
    s_andn2_b32 s65, vcc_lo, s88
    s_or_b32 s88, s88, s65
    s_cmp_lg_u32 s65, 0
    s_cbranch_scc1 L_h1_r14
    s_sub_u32 s56, s56, 1
    s_cbranch_scc0 L_h1_p14
    s_mov_b32 s56, 0
    s_not_b32 s65, s88
    s_branch L_h1_r14
L_h1_p15:
    v_mov_b32 v4, 0
    buffer_atomic_or v4, v6, s[16:19], 0 offen sc0 sc1
    s_waitcnt vmcnt(0)
    v_cmp_eq_u32 vcc, s68, v4
    s_nop 0
    s_andn2_b32 s65, vcc_lo, s88
    s_or_b32 s88, s88, s65
    s_cmp_lg_u32 s65, 0
    s_cbranch_scc1 L_h1_r15
    s_sub_u32 s56, s56, 1
    s_cbranch_scc0 L_h1_p15
    s_mov_b32 s56, 0
    s_not_b32 s65, s88
    s_branch L_h1_r15
L_h1_again:
    s_sub_u32 s56, s56, 1
    s_cbranch_scc0 L_h1_re
    s_mov_b32 s56, 0
    s_branch L_h1_done
L_h1_re:
    buffer_load_dwordx4 v[40:43], v2, s[16:19], 0 offen offset:0 sc1
    buffer_load_dwordx4 v[44:47], v2, s[16:19], 0 offen offset:1024 sc1
    buffer_load_dwordx4 v[48:51], v2, s[16:19], 0 offen offset:2048 sc1
    buffer_load_dwordx4 v[52:55], v2, s[16:19], 0 offen offset:3072 sc1
    buffer_load_dwordx4 v[56:59], v2, s[16:19], s92 offen offset:0 sc1
    buffer_load_dwordx4 v[60:63], v2, s[16:19], s92 offen offset:1024 sc1
    buffer_load_dwordx4 v[64:67], v2, s[16:19], s92 offen offset:2048 sc1
    buffer_load_dwordx4 v[68:71], v2, s[16:19], s92 offen offset:3072 sc1
    buffer_load_dwordx4 v[72:75], v2, s[16:19], s93 offen offset:0 sc1
    buffer_load_dwordx4 v[76:79], v2, s[16:19], s93 offen offset:1024 sc1
    buffer_load_dwordx4 v[80:83], v2, s[16:19], s93 offen offset:2048 sc1
    buffer_load_dwordx4 v[84:87], v2, s[16:19], s93 offen offset:3072 sc1
    buffer_load_dwordx4 v[88:91], v2, s[16:19], s94 offen offset:0 sc1
    buffer_load_dwordx4 v[92:95], v2, s[16:19], s94 offen offset:1024 sc1
    buffer_load_dwordx4 v[96:99], v2, s[16:19], s94 offen offset:2048 sc1
    buffer_load_dwordx4 v[100:103], v2, s[16:19], s94 offen offset:3072 sc1
    buffer_load_dwordx4 v[104:107], v3, s[16:19], 0 offen sc1
    v_mov_b32 v112, 0
    v_mov_b32 v113, 0
    v_mov_b32 v114, 0
    v_mov_b32 v115, 0
    v_mov_b32 v116, 0
    v_mov_b32 v117, 0
    v_mov_b32 v118, 0
    v_mov_b32 v119, 0
    s_branch L_h1_acc
L_comp:
    s_mov_b64 exec, -1
    v_and_b32 v20, 15, v0
    v_lshrrev_b32 v21, 4, v0
    v_bfe_u32 v22, v0, 1, 3
    s_lshl_b32 s86, s49, 13
    v_lshl_add_u32 v20, v20, 7, s86
    v_or_b32 v23, 0, v21
    v_xor_b32 v23, v23, v22
    v_lshl_add_u32 v2, v23, 4, v20
    v_or_b32 v23, 4, v21
    v_xor_b32 v23, v23, v22
    v_lshl_add_u32 v3, v23, 4, v20
    v_bfe_u32 v22, v0, 2, 2
    v_lshl_add_u32 v22, v21, 3, v22
    v_lshlrev_b32 v22, 7, v22
    v_bfe_u32 v23, v0, 3, 2
    s_lshl_b32 s86, s50, 1
    v_xor_b32 v23, s86, v23
    v_lshl_add_u32 v22, v23, 5, v22
    v_and_b32 v23, 3, v0
    v_lshl_add_u32 v22, v23, 3, v22
    v_add_u32 v4, 16384, v22
    v_xor_b32 v5, 32, v4
    s_lshl_b32 s53, s2, 2
    s_add_u32 s53, s53, s3
    s_lshl_b32 s86, s53, 12
    s_add_u32 s86, s86, 1048576
    v_lshl_add_u32 v6, v0, 4, s86
    s_mul_i32 s53, s53, 160
    s_add_u32 s53, s53, 6553600
    v_lshl_add_u32 v17, v0, 4, s53
    v_mov_b32 v16, 2147483648
    v_cmp_gt_u32 vcc, 10, v0
    s_nop 1
    v_cndmask_b32 v17, v16, v17, vcc
    s_lshl2_add_u32 s86, s45, s3
    s_lshr_b32 s87, s86, 3
    s_mul_i32 s87, s87, 14336
    s_and_b32 s86, s86, 7
    s_lshl3_add_u32 s86, s44, s86
    s_mul_i32 s86, s86, 224
    s_add_u32 s86, s86, s87
    s_add_u32 s86, s86, 7864064
    v_lshl_add_u32 v16, v0, 4, s86
    s_mov_b32 vcc_lo, 0x3fff0000
    s_mov_b32 vcc_hi, 0
    v_cndmask_b32 v17, v17, v16, vcc
    s_lshl_b32 s86, s47, 1
    s_add_u32 s86, s86, s50
    s_lshl_b32 s87, s86, 4
    s_add_u32 s87, s87, s46
    s_lshl_b32 s87, s87, 1
    s_add_u32 s87, s87, s49
    s_lshl_b32 s87, s87, 6
    s_add_u32 s87, s87, 6880320
    v_lshl_add_u32 v16, v0, 4, s87
    v_cmp_le_u32 vcc, 60, v0
    s_nop 1
    v_cndmask_b32 v17, v17, v16, vcc
    s_lshl_b32 s87, s86, 1
    s_add_u32 s87, s87, s49
    s_lshl_b32 s87, s87, 4
    s_add_u32 s87, s87, s46
    s_lshl_b32 s87, s87, 10
    s_add_u32 s87, s87, 5242880
    v_lshl_add_u32 v16, v0, 4, s87
    v_mov_b32 v8, -1
    v_mov_b32 v9, -1
    v_mov_b32 v10, -1
    v_mov_b32 v11, -1
    s_waitcnt lgkmcnt(0)
    s_load_dword s61, s[84:85], 524288
    s_mov_b32 s16, s84
    s_and_b32 s17, s85, 0xffff
    s_mov_b32 s18, 268435456
    s_mov_b32 s19, 0x20000
    s_mov_b32 s8, s64
    s_and_b32 s9, s65, 0xffff
    s_mov_b32 s10, 4194304
    s_mov_b32 s11, 0x20000
    s_mov_b32 s20, s68
    s_and_b32 s21, s69, 0xffff
    s_mov_b32 s22, 2097152
    s_mov_b32 s23, 0x20000
    s_mov_b32 s24, s80
    s_and_b32 s25, s81, 0xffff
    s_mov_b32 s26, 4194304
    s_mov_b32 s27, 0x20000
    s_mov_b32 s28, s82
    s_and_b32 s29, s83, 0xffff
    s_mov_b32 s30, 256
    s_mov_b32 s31, 0x20000
    s_bitcmp1_b32 s2, 3
    s_cselect_b32 s32, s76, s74
    s_cselect_b32 s33, s77, s75
    s_and_b32 s33, s33, 0xffff
    s_mov_b32 s34, 7340032
    s_mov_b32 s35, 0x20000
    s_mov_b32 s36, s78
    s_and_b32 s37, s79, 0xffff
    s_mov_b32 s38, 7340032
    s_mov_b32 s39, 0x20000
    s_mov_b32 s40, s72
    s_and_b32 s41, s73, 0xffff
    s_mov_b32 s42, 2048
    s_mov_b32 s43, 0x20000
    s_lshl_b32 s82, s44, 5
    s_or_b32 s82, s82, s45
    s_lshl_b32 s86, s2, 9
    s_add_u32 s86, s86, 786432
    s_cmp_eq_u32 s3, 0
    s_cselect_b32 s86, s86, 2147483648
    v_lshl_add_u32 v7, v0, 2, s86
    v_mul_u32_u24 v12, 192, v21
    v_add_u32 v7, v7, v12
    s_lshl_b32 s86, s2, 8
    s_add_u32 s86, s86, 917376
    s_cmp_eq_u32 s3, 0
    s_cselect_b32 s86, s86, 2147483648
    v_lshl_add_u32 v12, v0, 2, s86
    v_cmp_gt_u32 vcc, 32, v0
    s_nop 1
    v_cndmask_b32 v7, v12, v7, vcc
    v_mov_b32 v12, 2147483648
    v_cmp_gt_u32 vcc, 48, v0
    s_nop 1
    v_cndmask_b32 v7, v12, v7, vcc
    s_lshl_b32 s86, s2, 9
    s_add_u32 s86, s86, 6291456
    v_lshl_add_u32 v13, v0, 2, s86
    v_mul_u32_u24 v12, 64, v21
    v_add_u32 v13, v13, v12
    s_cmp_eq_u32 s3, 1
    s_cselect_b64 vcc, -1, 0
    v_cndmask_b32 v7, v7, v13, vcc
    v_mov_b32 v12, 0
    buffer_store_dword v12, v7, s[16:19], 0 offen sc1
    v_mov_b32 v128, 0
    v_mov_b32 v129, 0
    v_mov_b32 v130, 0
    v_mov_b32 v131, 0
    v_mov_b32 v132, 0
    v_mov_b32 v133, 0
    v_mov_b32 v134, 0
    v_mov_b32 v135, 0
    v_mov_b32 v136, 0
    v_mov_b32 v137, 0
    v_mov_b32 v138, 0
    v_mov_b32 v139, 0
    v_mov_b32 v140, 0
    v_mov_b32 v141, 0
    v_mov_b32 v142, 0
    v_mov_b32 v143, 0
    v_mov_b32 v144, 0
    v_mov_b32 v145, 0
    v_mov_b32 v146, 0
    v_mov_b32 v147, 0
    v_mov_b32 v148, 0
    v_mov_b32 v149, 0
    v_mov_b32 v150, 0
    v_mov_b32 v151, 0
    v_mov_b32 v152, 0
    v_mov_b32 v153, 0
    v_mov_b32 v154, 0
    v_mov_b32 v155, 0
    v_mov_b32 v156, 0
    v_mov_b32 v157, 0
    v_mov_b32 v158, 0
    v_mov_b32 v159, 0
    v_mov_b32 v160, 0
    v_mov_b32 v161, 0
    v_mov_b32 v162, 0
    v_mov_b32 v163, 0
    v_mov_b32 v164, 0
    v_mov_b32 v165, 0
    v_mov_b32 v166, 0
    v_mov_b32 v167, 0
    v_mov_b32 v168, 0
    v_mov_b32 v169, 0
    v_mov_b32 v170, 0
    v_mov_b32 v171, 0
    v_mov_b32 v172, 0
    v_mov_b32 v173, 0
    v_mov_b32 v174, 0
    v_mov_b32 v175, 0
    v_mov_b32 v176, 0
    v_mov_b32 v177, 0
    v_mov_b32 v178, 0
    v_mov_b32 v179, 0
    v_mov_b32 v180, 0
    v_mov_b32 v181, 0
    v_mov_b32 v182, 0
    v_mov_b32 v183, 0
    v_mov_b32 v184, 0
    v_mov_b32 v185, 0
    v_mov_b32 v186, 0
    v_mov_b32 v187, 0
    v_mov_b32 v188, 0
    v_mov_b32 v189, 0
L_walkA2:
    s_cbranch_execz L_comp
    v_mov_b32 v190, 0
    v_mov_b32 v191, 0
    v_mov_b32 v192, 0
    v_mov_b32 v193, 0
    v_mov_b32 v194, 0
    v_mov_b32 v195, 0
    v_mov_b32 v196, 0
    v_mov_b32 v197, 0
    v_mov_b32 v198, 0
    v_mov_b32 v199, 0
    v_mov_b32 v200, 0
    v_mov_b32 v201, 0
    v_mov_b32 v202, 0
    v_mov_b32 v203, 0
    v_mov_b32 v204, 0
    v_mov_b32 v205, 0
    v_mov_b32 v206, 0
    v_mov_b32 v207, 0
    v_mov_b32 v208, 0
    v_mov_b32 v209, 0
    v_mov_b32 v210, 0
    v_mov_b32 v211, 0
    v_mov_b32 v212, 0
    v_mov_b32 v213, 0
    v_mov_b32 v214, 0
    v_mov_b32 v215, 0
    v_mov_b32 v216, 0
    v_mov_b32 v217, 0
    v_mov_b32 v218, 0
    v_mov_b32 v219, 0
    v_mov_b32 v220, 0
    v_mov_b32 v221, 0
    v_mov_b32 v222, 0
    v_mov_b32 v223, 0
    s_mov_b32 s54, 0x358637bd
    s_mov_b32 s55, 0x358637bd
    s_mov_b32 s62, 0
    s_mov_b32 s63, 1
    v_add_u32 v2, 40960, v2
    v_add_u32 v3, 40960, v3
    v_add_u32 v4, 40960, v4
    v_add_u32 v5, 40960, v5
    s_mov_b64 exec, 0
    s_cmp_eq_u32 s3, 0
    s_cbranch_scc1 L_walkB0
    s_cmp_eq_u32 s3, 1
    s_cbranch_scc1 L_walkB1
    s_cmp_eq_u32 s3, 2
    s_cbranch_scc1 L_walkB2
    s_branch L_walkB3
L_walked:
    s_mov_b64 exec, -1
    s_waitcnt lgkmcnt(0)
    s_add_u32 s68, s61, 0x9e3779b9
    s_barrier
    ds_read_b128 v[40:43], v2 offset:0
    ds_read_b128 v[44:47], v2 offset:2048
    ds_read_b128 v[48:51], v2 offset:4096
    ds_read_b128 v[52:55], v2 offset:6144
    ds_read_b64_tr_b16 v[56:57], v4 offset:0
    ds_read_b64_tr_b16 v[58:59], v4 offset:512
    ds_read_b64_tr_b16 v[60:61], v5 offset:0
    ds_read_b64_tr_b16 v[62:63], v5 offset:512
    ds_read_b64_tr_b16 v[64:65], v4 offset:8192
    ds_read_b64_tr_b16 v[66:67], v4 offset:8704
    ds_read_b64_tr_b16 v[68:69], v5 offset:8192
    ds_read_b64_tr_b16 v[70:71], v5 offset:8704
    ds_read_b64_tr_b16 v[72:73], v4 offset:16384
    ds_read_b64_tr_b16 v[74:75], v4 offset:16896
    ds_read_b64_tr_b16 v[76:77], v5 offset:16384
    ds_read_b64_tr_b16 v[78:79], v5 offset:16896
L_cloop:
    s_waitcnt lgkmcnt(0)
    v_mfma_f32_16x16x32_bf16 v[128:131], v[56:59], v[40:43], v[128:131]
    ds_read_b128 v[80:83], v3 offset:0
    v_mfma_f32_16x16x32_bf16 v[144:147], v[60:63], v[40:43], v[144:147]
    ds_read_b128 v[84:87], v3 offset:2048
    v_mfma_f32_16x16x32_bf16 v[148:151], v[60:63], v[44:47], v[148:151]
    ds_read_b128 v[88:91], v3 offset:4096
    v_mfma_f32_16x16x32_bf16 v[132:135], v[56:59], v[44:47], v[132:135]
    ds_read_b128 v[92:95], v3 offset:6144
    v_mfma_f32_16x16x32_bf16 v[136:139], v[56:59], v[48:51], v[136:139]
    ds_read_b64_tr_b16 v[96:97], v4 offset:4096
    v_mfma_f32_16x16x32_bf16 v[152:155], v[60:63], v[48:51], v[152:155]
    ds_read_b64_tr_b16 v[98:99], v4 offset:4608
    v_mfma_f32_16x16x32_bf16 v[156:159], v[60:63], v[52:55], v[156:159]
    ds_read_b64_tr_b16 v[100:101], v5 offset:4096
    v_mfma_f32_16x16x32_bf16 v[140:143], v[56:59], v[52:55], v[140:143]
    ds_read_b64_tr_b16 v[102:103], v5 offset:4608
    v_mfma_f32_16x16x32_bf16 v[172:175], v[52:55], v[64:67], v[172:175]
    ds_read_b64_tr_b16 v[104:105], v4 offset:12288
    v_mfma_f32_16x16x32_bf16 v[188:191], v[52:55], v[68:71], v[188:191]
    ds_read_b64_tr_b16 v[106:107], v4 offset:12800
    v_mfma_f32_16x16x32_bf16 v[184:187], v[48:51], v[68:71], v[184:187]
    ds_read_b64_tr_b16 v[108:109], v5 offset:12288
    v_mfma_f32_16x16x32_bf16 v[168:171], v[48:51], v[64:67], v[168:171]
    ds_read_b64_tr_b16 v[110:111], v5 offset:12800
    v_mfma_f32_16x16x32_bf16 v[164:167], v[44:47], v[64:67], v[164:167]
    ds_read_b64_tr_b16 v[112:113], v4 offset:20480
    v_mfma_f32_16x16x32_bf16 v[180:183], v[44:47], v[68:71], v[180:183]
    ds_read_b64_tr_b16 v[114:115], v4 offset:20992
    v_mfma_f32_16x16x32_bf16 v[176:179], v[40:43], v[68:71], v[176:179]
    ds_read_b64_tr_b16 v[116:117], v5 offset:20480
    v_mfma_f32_16x16x32_bf16 v[160:163], v[40:43], v[64:67], v[160:163]
    ds_read_b64_tr_b16 v[118:119], v5 offset:20992
    v_mfma_f32_16x16x32_bf16 v[192:195], v[40:43], v[72:75], v[192:195]
    s_add_u32 s63, s63, 1
    s_cmp_eq_u32 s63, 4
    s_cselect_b32 s53, 4294803456, 0
    s_cselect_b32 s63, 0, s63
    s_add_u32 s53, s53, 40960
    v_mfma_f32_16x16x32_bf16 v[208:211], v[40:43], v[76:79], v[208:211]
    v_add_u32 v2, s53, v2
    v_mfma_f32_16x16x32_bf16 v[212:215], v[44:47], v[76:79], v[212:215]
    v_add_u32 v4, s53, v4
    v_mfma_f32_16x16x32_bf16 v[196:199], v[44:47], v[72:75], v[196:199]
    v_add_u32 v5, s53, v5
    v_mfma_f32_16x16x32_bf16 v[200:203], v[48:51], v[72:75], v[200:203]
    v_add_u32 v3, s53, v3
    v_mfma_f32_16x16x32_bf16 v[216:219], v[48:51], v[76:79], v[216:219]
    s_cmp_ge_u32 s62, 6
    s_cbranch_scc1 L_cl_none
    buffer_store_dwordx4 v[8:11], v6, s[16:19], 0 offen sc1
    v_add_u32 v6, 1024, v6
    s_cmp_lt_u32 s62, 3
    s_cbranch_scc1 L_cl_none
    v_mov_b32 v6, v16
    v_mov_b32 v16, v17
L_cl_none:
    v_mfma_f32_16x16x32_bf16 v[220:223], v[52:55], v[76:79], v[220:223]
    v_mfma_f32_16x16x32_bf16 v[204:207], v[52:55], v[72:75], v[204:207]
    s_waitcnt lgkmcnt(0)
    v_mfma_f32_16x16x32_bf16 v[128:131], v[96:99], v[80:83], v[128:131]
    s_barrier
    ds_read_b128 v[40:43], v2 offset:0
    v_mfma_f32_16x16x32_bf16 v[144:147], v[100:103], v[80:83], v[144:147]
    ds_read_b128 v[44:47], v2 offset:2048
    v_mfma_f32_16x16x32_bf16 v[148:151], v[100:103], v[84:87], v[148:151]
    ds_read_b128 v[48:51], v2 offset:4096
    v_mfma_f32_16x16x32_bf16 v[132:135], v[96:99], v[84:87], v[132:135]
    ds_read_b128 v[52:55], v2 offset:6144
    v_mfma_f32_16x16x32_bf16 v[136:139], v[96:99], v[88:91], v[136:139]
    ds_read_b64_tr_b16 v[56:57], v4 offset:0
    v_mfma_f32_16x16x32_bf16 v[152:155], v[100:103], v[88:91], v[152:155]
    ds_read_b64_tr_b16 v[58:59], v4 offset:512
    v_mfma_f32_16x16x32_bf16 v[156:159], v[100:103], v[92:95], v[156:159]
    ds_read_b64_tr_b16 v[60:61], v5 offset:0
    v_mfma_f32_16x16x32_bf16 v[140:143], v[96:99], v[92:95], v[140:143]
    ds_read_b64_tr_b16 v[62:63], v5 offset:512
    v_mfma_f32_16x16x32_bf16 v[172:175], v[92:95], v[104:107], v[172:175]
    ds_read_b64_tr_b16 v[64:65], v4 offset:8192
    v_mfma_f32_16x16x32_bf16 v[188:191], v[92:95], v[108:111], v[188:191]
    ds_read_b64_tr_b16 v[66:67], v4 offset:8704
    v_mfma_f32_16x16x32_bf16 v[184:187], v[88:91], v[108:111], v[184:187]
    ds_read_b64_tr_b16 v[68:69], v5 offset:8192
    v_mfma_f32_16x16x32_bf16 v[168:171], v[88:91], v[104:107], v[168:171]
    ds_read_b64_tr_b16 v[70:71], v5 offset:8704
    v_mfma_f32_16x16x32_bf16 v[164:167], v[84:87], v[104:107], v[164:167]
    ds_read_b64_tr_b16 v[72:73], v4 offset:16384
    v_mfma_f32_16x16x32_bf16 v[180:183], v[84:87], v[108:111], v[180:183]
    ds_read_b64_tr_b16 v[74:75], v4 offset:16896
    v_mfma_f32_16x16x32_bf16 v[176:179], v[80:83], v[108:111], v[176:179]
    ds_read_b64_tr_b16 v[76:77], v5 offset:16384
    v_mfma_f32_16x16x32_bf16 v[160:163], v[80:83], v[104:107], v[160:163]
    ds_read_b64_tr_b16 v[78:79], v5 offset:16896
    v_mfma_f32_16x16x32_bf16 v[192:195], v[80:83], v[112:115], v[192:195]
    v_mfma_f32_16x16x32_bf16 v[208:211], v[80:83], v[116:119], v[208:211]
    s_cmp_lg_u32 s62, 8
    s_cbranch_scc1 L_cl_nw
    s_waitcnt vmcnt(0)
L_cl_nw:
    v_mfma_f32_16x16x32_bf16 v[212:215], v[84:87], v[116:119], v[212:215]
    v_mfma_f32_16x16x32_bf16 v[196:199], v[84:87], v[112:115], v[196:199]
L_walkB2:
    s_cbranch_execz L_walk_6
    v_mfma_f32_16x16x32_bf16 v[200:203], v[88:91], v[112:115], v[200:203]
    s_add_u32 s62, s62, 1
    v_mfma_f32_16x16x32_bf16 v[216:219], v[88:91], v[116:119], v[216:219]
    v_mfma_f32_16x16x32_bf16 v[220:223], v[92:95], v[116:119], v[220:223]
    v_mfma_f32_16x16x32_bf16 v[204:207], v[92:95], v[112:115], v[204:207]
    s_cmp_lt_u32 s62, 15
    s_cbranch_scc1 L_cloop
    s_waitcnt lgkmcnt(0)
    v_mfma_f32_16x16x32_bf16 v[128:131], v[56:59], v[40:43], v[128:131]
    ds_read_b128 v[80:83], v3 offset:0
    v_mfma_f32_16x16x32_bf16 v[144:147], v[60:63], v[40:43], v[144:147]
    ds_read_b128 v[84:87], v3 offset:2048
    v_mfma_f32_16x16x32_bf16 v[148:151], v[60:63], v[44:47], v[148:151]
    ds_read_b128 v[88:91], v3 offset:4096
    v_mfma_f32_16x16x32_bf16 v[132:135], v[56:59], v[44:47], v[132:135]
    ds_read_b128 v[92:95], v3 offset:6144
    v_mfma_f32_16x16x32_bf16 v[136:139], v[56:59], v[48:51], v[136:139]
    ds_read_b64_tr_b16 v[96:97], v4 offset:4096
    v_mfma_f32_16x16x32_bf16 v[152:155], v[60:63], v[48:51], v[152:155]
    ds_read_b64_tr_b16 v[98:99], v4 offset:4608
    v_mfma_f32_16x16x32_bf16 v[156:159], v[60:63], v[52:55], v[156:159]
    ds_read_b64_tr_b16 v[100:101], v5 offset:4096
    v_mfma_f32_16x16x32_bf16 v[140:143], v[56:59], v[52:55], v[140:143]
    ds_read_b64_tr_b16 v[102:103], v5 offset:4608
    v_mfma_f32_16x16x32_bf16 v[172:175], v[52:55], v[64:67], v[172:175]
    ds_read_b64_tr_b16 v[104:105], v4 offset:12288
    v_mfma_f32_16x16x32_bf16 v[188:191], v[52:55], v[68:71], v[188:191]
    ds_read_b64_tr_b16 v[106:107], v4 offset:12800
    v_mfma_f32_16x16x32_bf16 v[184:187], v[48:51], v[68:71], v[184:187]
    ds_read_b64_tr_b16 v[108:109], v5 offset:12288
    v_mfma_f32_16x16x32_bf16 v[168:171], v[48:51], v[64:67], v[168:171]
    ds_read_b64_tr_b16 v[110:111], v5 offset:12800
    v_mfma_f32_16x16x32_bf16 v[164:167], v[44:47], v[64:67], v[164:167]
    ds_read_b64_tr_b16 v[112:113], v4 offset:20480
    v_mfma_f32_16x16x32_bf16 v[180:183], v[44:47], v[68:71], v[180:183]
    ds_read_b64_tr_b16 v[114:115], v4 offset:20992
    v_mfma_f32_16x16x32_bf16 v[176:179], v[40:43], v[68:71], v[176:179]
    ds_read_b64_tr_b16 v[116:117], v5 offset:20480
    v_mfma_f32_16x16x32_bf16 v[160:163], v[40:43], v[64:67], v[160:163]
    ds_read_b64_tr_b16 v[118:119], v5 offset:20992
    v_mfma_f32_16x16x32_bf16 v[192:195], v[40:43], v[72:75], v[192:195]
    v_lshrrev_b32 v21, 4, v0
    v_and_b32 v22, 15, v0
    v_mfma_f32_16x16x32_bf16 v[208:211], v[40:43], v[76:79], v[208:211]
    s_lshl_b32 s86, s49, 8
    s_add_u32 s86, s86, 131072
    v_lshl_add_u32 v6, v21, 4, s86
    v_mfma_f32_16x16x32_bf16 v[212:215], v[44:47], v[76:79], v[212:215]
    v_lshl_add_u32 v7, v22, 2, s86
    v_mfma_f32_16x16x32_bf16 v[196:199], v[44:47], v[72:75], v[196:199]
    s_lshl_b32 s86, s50, 7
    s_add_u32 s86, s86, 132608
    v_lshl_add_u32 v8, v22, 2, s86
    v_mfma_f32_16x16x32_bf16 v[200:203], v[48:51], v[72:75], v[200:203]
    v_lshl_add_u32 v9, v21, 4, s86
    v_mfma_f32_16x16x32_bf16 v[216:219], v[48:51], v[76:79], v[216:219]
    s_lshl_b32 s86, s3, 2
    s_add_u32 s86, s86, 135168
    v_mov_b32 v12, s86
    v_mfma_f32_16x16x32_bf16 v[220:223], v[52:55], v[76:79], v[220:223]
    v_xor_b32 v13, 4, v12
    v_mfma_f32_16x16x32_bf16 v[204:207], v[52:55], v[72:75], v[204:207]
    s_waitcnt lgkmcnt(0)
    v_mfma_f32_16x16x32_bf16 v[160:163], v[80:83], v[104:107], v[160:163]
    v_mfma_f32_16x16x32_bf16 v[176:179], v[80:83], v[108:111], v[176:179]
    v_mfma_f32_16x16x32_bf16 v[180:183], v[84:87], v[108:111], v[180:183]
    v_mfma_f32_16x16x32_bf16 v[164:167], v[84:87], v[104:107], v[164:167]
    v_mfma_f32_16x16x32_bf16 v[168:171], v[88:91], v[104:107], v[168:171]
    v_mfma_f32_16x16x32_bf16 v[184:187], v[88:91], v[108:111], v[184:187]
    v_mfma_f32_16x16x32_bf16 v[188:191], v[92:95], v[108:111], v[188:191]
    v_mfma_f32_16x16x32_bf16 v[172:175], v[92:95], v[104:107], v[172:175]
    v_mfma_f32_16x16x32_bf16 v[204:207], v[92:95], v[112:115], v[204:207]
    v_mfma_f32_16x16x32_bf16 v[220:223], v[92:95], v[116:119], v[220:223]
    v_mfma_f32_16x16x32_bf16 v[216:219], v[88:91], v[116:119], v[216:219]
    v_mfma_f32_16x16x32_bf16 v[200:203], v[88:91], v[112:115], v[200:203]
    v_mfma_f32_16x16x32_bf16 v[196:199], v[84:87], v[112:115], v[196:199]
    s_barrier
    ds_read_b128 v[40:43], v6 offset:0
    ds_read_b128 v[44:47], v6 offset:64
    v_mfma_f32_16x16x32_bf16 v[212:215], v[84:87], v[116:119], v[212:215]
    ds_read_b128 v[48:51], v6 offset:128
    ds_read_b128 v[52:55], v6 offset:192
    v_mfma_f32_16x16x32_bf16 v[208:211], v[80:83], v[116:119], v[208:211]
    ds_read_b32 v72, v8 offset:256
    ds_read_b32 v73, v8 offset:320
    v_mfma_f32_16x16x32_bf16 v[192:195], v[80:83], v[112:115], v[192:195]
    ds_read_b32 v74, v8 offset:512
    ds_read_b32 v75, v8 offset:576
    v_mfma_f32_16x16x32_bf16 v[128:131], v[96:99], v[80:83], v[128:131]
    ds_read_b128 v[56:59], v6 offset:512
    ds_read_b128 v[60:63], v6 offset:576
    v_mfma_f32_16x16x32_bf16 v[144:147], v[100:103], v[80:83], v[144:147]
    ds_read_b128 v[64:67], v6 offset:640
    ds_read_b128 v[68:71], v6 offset:704
    v_mfma_f32_16x16x32_bf16 v[148:151], v[100:103], v[84:87], v[148:151]
    ds_read_b128 v[224:227], v6 offset:1024
    ds_read_b128 v[228:231], v6 offset:1088
    v_mfma_f32_16x16x32_bf16 v[132:135], v[96:99], v[84:87], v[132:135]
    ds_read_b128 v[232:235], v6 offset:1152
    ds_read_b128 v[236:239], v6 offset:1216
    v_mfma_f32_16x16x32_bf16 v[136:139], v[96:99], v[88:91], v[136:139]
    ds_read_b128 v[28:31], v9 offset:0
    ds_read_b128 v[32:35], v9 offset:64
    v_mfma_f32_16x16x32_bf16 v[152:155], v[100:103], v[88:91], v[152:155]
    v_mfma_f32_16x16x32_bf16 v[156:159], v[100:103], v[92:95], v[156:159]
    v_mfma_f32_16x16x32_bf16 v[140:143], v[96:99], v[92:95], v[140:143]
    ds_read_b32 v240, v7 offset:0
    ds_read_b32 v244, v7 offset:512
    ds_read_b32 v248, v7 offset:1024
    ds_read_b32 v241, v7 offset:64
    ds_read_b32 v245, v7 offset:576
    ds_read_b32 v249, v7 offset:1088
    ds_read_b32 v242, v7 offset:128
    ds_read_b32 v246, v7 offset:640
    ds_read_b32 v250, v7 offset:1152
    ds_read_b32 v243, v7 offset:192
    ds_read_b32 v247, v7 offset:704
    ds_read_b32 v251, v7 offset:1216
    s_waitcnt lgkmcnt(12)
    v_pk_fma_f32 v[160:161], v[40:41], v[72:73], v[160:161] op_sel_hi:[1,0,1]
    v_pk_mul_f32 v[112:113], v[160:161], v[224:225]
    v_pk_fma_f32 v[160:161], v[160:161], v[56:57], s[54:55]
    v_exp_f32 v112, v112 clamp
    v_exp_f32 v113, v113 clamp
    v_max_f32 v160, s54, v160
    v_max_f32 v161, s54, v161
    v_pk_add_f32 v[160:161], v[160:161], v[112:113]
    v_cvt_pk_bf16_f32 v80, v160, v161
    v_pk_fma_f32 v[162:163], v[42:43], v[72:73], v[162:163] op_sel_hi:[1,0,1]
    v_pk_mul_f32 v[114:115], v[162:163], v[226:227]
    v_pk_fma_f32 v[162:163], v[162:163], v[58:59], s[54:55]
    v_exp_f32 v114, v114 clamp
    v_exp_f32 v115, v115 clamp
    v_max_f32 v162, s54, v162
    v_max_f32 v163, s54, v163
    v_pk_add_f32 v[162:163], v[162:163], v[114:115]
    v_cvt_pk_bf16_f32 v81, v162, v163
    v_pk_fma_f32 v[164:165], v[44:45], v[72:73], v[164:165] op_sel_hi:[1,0,1]
    v_pk_mul_f32 v[116:117], v[164:165], v[228:229]
    v_pk_fma_f32 v[164:165], v[164:165], v[60:61], s[54:55]
    v_exp_f32 v116, v116 clamp
    v_exp_f32 v117, v117 clamp
    v_max_f32 v164, s54, v164
    v_max_f32 v165, s54, v165
    v_pk_add_f32 v[164:165], v[164:165], v[116:117]
L_walkB3:
    s_cbranch_execz L_walk_7
    v_cvt_pk_bf16_f32 v82, v164, v165
    v_pk_fma_f32 v[166:167], v[46:47], v[72:73], v[166:167] op_sel_hi:[1,0,1]
    v_pk_mul_f32 v[118:119], v[166:167], v[230:231]
    v_pk_fma_f32 v[166:167], v[166:167], v[62:63], s[54:55]
    v_exp_f32 v118, v118 clamp
    v_exp_f32 v119, v119 clamp
    v_max_f32 v166, s54, v166
    v_max_f32 v167, s54, v167
    v_pk_add_f32 v[166:167], v[166:167], v[118:119]
    v_cvt_pk_bf16_f32 v83, v166, v167
    v_pk_fma_f32 v[168:169], v[48:49], v[72:73], v[168:169] op_sel_hi:[1,0,1]
    v_pk_mul_f32 v[112:113], v[168:169], v[232:233]
    v_pk_fma_f32 v[168:169], v[168:169], v[64:65], s[54:55]
    v_exp_f32 v112, v112 clamp
    v_exp_f32 v113, v113 clamp
    v_max_f32 v168, s54, v168
    v_max_f32 v169, s54, v169
    v_pk_add_f32 v[168:169], v[168:169], v[112:113]
    v_cvt_pk_bf16_f32 v84, v168, v169
    v_pk_fma_f32 v[170:171], v[50:51], v[72:73], v[170:171] op_sel_hi:[1,0,1]
    v_pk_mul_f32 v[114:115], v[170:171], v[234:235]
    v_pk_fma_f32 v[170:171], v[170:171], v[66:67], s[54:55]
    v_exp_f32 v114, v114 clamp
    v_exp_f32 v115, v115 clamp
    v_max_f32 v170, s54, v170
    v_max_f32 v171, s54, v171
    v_pk_add_f32 v[170:171], v[170:171], v[114:115]
    v_cvt_pk_bf16_f32 v85, v170, v171
    v_pk_fma_f32 v[172:173], v[52:53], v[72:73], v[172:173] op_sel_hi:[1,0,1]
    v_pk_mul_f32 v[116:117], v[172:173], v[236:237]
    v_pk_fma_f32 v[172:173], v[172:173], v[68:69], s[54:55]
    v_exp_f32 v116, v116 clamp
    v_exp_f32 v117, v117 clamp
    v_max_f32 v172, s54, v172
    v_max_f32 v173, s54, v173
    v_pk_add_f32 v[172:173], v[172:173], v[116:117]
    v_cvt_pk_bf16_f32 v86, v172, v173
    v_pk_fma_f32 v[174:175], v[54:55], v[72:73], v[174:175] op_sel_hi:[1,0,1]
    v_pk_mul_f32 v[118:119], v[174:175], v[238:239]
    v_pk_fma_f32 v[174:175], v[174:175], v[70:71], s[54:55]
    v_exp_f32 v118, v118 clamp
    v_exp_f32 v119, v119 clamp
    v_max_f32 v174, s54, v174
    v_max_f32 v175, s54, v175
    v_pk_add_f32 v[174:175], v[174:175], v[118:119]
    v_cvt_pk_bf16_f32 v87, v174, v175
    v_pk_fma_f32 v[176:177], v[40:41], v[72:73], v[176:177] op_sel:[0,1,0] op_sel_hi:[1,1,1]
    v_pk_mul_f32 v[112:113], v[176:177], v[224:225]
    v_pk_fma_f32 v[176:177], v[176:177], v[56:57], s[54:55]
    v_exp_f32 v112, v112 clamp
    v_exp_f32 v113, v113 clamp
    v_max_f32 v176, s54, v176
    v_max_f32 v177, s54, v177
    v_pk_add_f32 v[176:177], v[176:177], v[112:113]
    v_cvt_pk_bf16_f32 v88, v176, v177
    v_pk_fma_f32 v[178:179], v[42:43], v[72:73], v[178:179] op_sel:[0,1,0] op_sel_hi:[1,1,1]
    v_pk_mul_f32 v[114:115], v[178:179], v[226:227]
    v_pk_fma_f32 v[178:179], v[178:179], v[58:59], s[54:55]
    v_exp_f32 v114, v114 clamp
    v_exp_f32 v115, v115 clamp
    v_max_f32 v178, s54, v178
    v_max_f32 v179, s54, v179
    v_pk_add_f32 v[178:179], v[178:179], v[114:115]
    v_cvt_pk_bf16_f32 v89, v178, v179
    v_pk_fma_f32 v[180:181], v[44:45], v[72:73], v[180:181] op_sel:[0,1,0] op_sel_hi:[1,1,1]
    v_pk_mul_f32 v[116:117], v[180:181], v[228:229]
    v_pk_fma_f32 v[180:181], v[180:181], v[60:61], s[54:55]
    v_exp_f32 v116, v116 clamp
    v_exp_f32 v117, v117 clamp
    v_max_f32 v180, s54, v180
    v_max_f32 v181, s54, v181
    v_pk_add_f32 v[180:181], v[180:181], v[116:117]
    v_cvt_pk_bf16_f32 v90, v180, v181
    v_pk_fma_f32 v[182:183], v[46:47], v[72:73], v[182:183] op_sel:[0,1,0] op_sel_hi:[1,1,1]
    v_pk_mul_f32 v[118:119], v[182:183], v[230:231]
    v_pk_fma_f32 v[182:183], v[182:183], v[62:63], s[54:55]
    v_exp_f32 v118, v118 clamp
    v_exp_f32 v119, v119 clamp
    v_max_f32 v182, s54, v182
    v_max_f32 v183, s54, v183
    v_pk_add_f32 v[182:183], v[182:183], v[118:119]
    v_cvt_pk_bf16_f32 v91, v182, v183
    v_pk_fma_f32 v[184:185], v[48:49], v[72:73], v[184:185] op_sel:[0,1,0] op_sel_hi:[1,1,1]
    v_pk_mul_f32 v[112:113], v[184:185], v[232:233]
    v_pk_fma_f32 v[184:185], v[184:185], v[64:65], s[54:55]
    v_exp_f32 v112, v112 clamp
    v_exp_f32 v113, v113 clamp
    v_max_f32 v184, s54, v184
    v_max_f32 v185, s54, v185
    v_pk_add_f32 v[184:185], v[184:185], v[112:113]
    v_cvt_pk_bf16_f32 v92, v184, v185
    v_pk_fma_f32 v[186:187], v[50:51], v[72:73], v[186:187] op_sel:[0,1,0] op_sel_hi:[1,1,1]
    v_pk_mul_f32 v[114:115], v[186:187], v[234:235]
    v_pk_fma_f32 v[186:187], v[186:187], v[66:67], s[54:55]
    v_exp_f32 v114, v114 clamp
    v_exp_f32 v115, v115 clamp
    v_max_f32 v186, s54, v186
    v_max_f32 v187, s54, v187
    v_pk_add_f32 v[186:187], v[186:187], v[114:115]
    v_cvt_pk_bf16_f32 v93, v186, v187
    v_pk_fma_f32 v[188:189], v[52:53], v[72:73], v[188:189] op_sel:[0,1,0] op_sel_hi:[1,1,1]
    v_pk_mul_f32 v[116:117], v[188:189], v[236:237]
    v_pk_fma_f32 v[188:189], v[188:189], v[68:69], s[54:55]
    v_exp_f32 v116, v116 clamp
    v_exp_f32 v117, v117 clamp
    v_max_f32 v188, s54, v188
    v_max_f32 v189, s54, v189
    v_pk_add_f32 v[188:189], v[188:189], v[116:117]
    v_cvt_pk_bf16_f32 v94, v188, v189
    v_pk_fma_f32 v[190:191], v[54:55], v[72:73], v[190:191] op_sel:[0,1,0] op_sel_hi:[1,1,1]
    v_pk_mul_f32 v[118:119], v[190:191], v[238:239]
    v_pk_fma_f32 v[190:191], v[190:191], v[70:71], s[54:55]
    v_exp_f32 v118, v118 clamp
    v_exp_f32 v119, v119 clamp
    v_max_f32 v190, s54, v190
    v_max_f32 v191, s54, v191
    v_pk_add_f32 v[190:191], v[190:191], v[118:119]
    v_cvt_pk_bf16_f32 v95, v190, v191
    v_mov_b32 v120, s95
    v_mov_b32 v121, s95
    v_mov_b32 v122, s95
    v_mov_b32 v123, s95
    v_pk_fma_f32 v[192:193], v[40:41], v[74:75], v[192:193] op_sel_hi:[1,0,1]
    v_pk_mul_f32 v[192:193], v[192:193], v[56:57]
    v_cvt_pk_bf16_f32 v96, v192, v193
    v_pk_fma_f32 v[194:195], v[42:43], v[74:75], v[194:195] op_sel_hi:[1,0,1]
    v_pk_mul_f32 v[194:195], v[194:195], v[58:59]
    v_cvt_pk_bf16_f32 v97, v194, v195
    v_pk_fma_f32 v[196:197], v[44:45], v[74:75], v[196:197] op_sel_hi:[1,0,1]
    v_pk_mul_f32 v[196:197], v[196:197], v[60:61]
    v_cvt_pk_bf16_f32 v98, v196, v197
    v_pk_fma_f32 v[198:199], v[46:47], v[74:75], v[198:199] op_sel_hi:[1,0,1]
    v_pk_mul_f32 v[198:199], v[198:199], v[62:63]
    v_cvt_pk_bf16_f32 v99, v198, v199
    v_pk_fma_f32 v[200:201], v[48:49], v[74:75], v[200:201] op_sel_hi:[1,0,1]
    v_pk_mul_f32 v[200:201], v[200:201], v[64:65]
    v_cvt_pk_bf16_f32 v100, v200, v201
    v_pk_fma_f32 v[202:203], v[50:51], v[74:75], v[202:203] op_sel_hi:[1,0,1]
    v_pk_mul_f32 v[202:203], v[202:203], v[66:67]
    v_cvt_pk_bf16_f32 v101, v202, v203
    v_pk_fma_f32 v[204:205], v[52:53], v[74:75], v[204:205] op_sel_hi:[1,0,1]
    v_pk_mul_f32 v[204:205], v[204:205], v[68:69]
    v_cvt_pk_bf16_f32 v102, v204, v205
    v_pk_fma_f32 v[206:207], v[54:55], v[74:75], v[206:207] op_sel_hi:[1,0,1]
    v_pk_mul_f32 v[206:207], v[206:207], v[70:71]
    v_cvt_pk_bf16_f32 v103, v206, v207
    v_pk_fma_f32 v[208:209], v[40:41], v[74:75], v[208:209] op_sel:[0,1,0] op_sel_hi:[1,1,1]
    v_pk_mul_f32 v[208:209], v[208:209], v[56:57]
    v_cvt_pk_bf16_f32 v104, v208, v209
    v_pk_fma_f32 v[210:211], v[42:43], v[74:75], v[210:211] op_sel:[0,1,0] op_sel_hi:[1,1,1]
    v_pk_mul_f32 v[210:211], v[210:211], v[58:59]
L_walk_12:
    s_cbranch_execz L_walk_16
    v_cvt_pk_bf16_f32 v105, v210, v211
    v_pk_fma_f32 v[212:213], v[44:45], v[74:75], v[212:213] op_sel:[0,1,0] op_sel_hi:[1,1,1]
    v_pk_mul_f32 v[212:213], v[212:213], v[60:61]
    v_cvt_pk_bf16_f32 v106, v212, v213
    v_pk_fma_f32 v[214:215], v[46:47], v[74:75], v[214:215] op_sel:[0,1,0] op_sel_hi:[1,1,1]
    v_pk_mul_f32 v[214:215], v[214:215], v[62:63]
    v_cvt_pk_bf16_f32 v107, v214, v215
    v_pk_fma_f32 v[216:217], v[48:49], v[74:75], v[216:217] op_sel:[0,1,0] op_sel_hi:[1,1,1]
    v_pk_mul_f32 v[216:217], v[216:217], v[64:65]
    v_cvt_pk_bf16_f32 v108, v216, v217
    v_pk_fma_f32 v[218:219], v[50:51], v[74:75], v[218:219] op_sel:[0,1,0] op_sel_hi:[1,1,1]
    v_pk_mul_f32 v[218:219], v[218:219], v[66:67]
    v_cvt_pk_bf16_f32 v109, v218, v219
    v_pk_fma_f32 v[220:221], v[52:53], v[74:75], v[220:221] op_sel:[0,1,0] op_sel_hi:[1,1,1]
    v_pk_mul_f32 v[220:221], v[220:221], v[68:69]
    v_cvt_pk_bf16_f32 v110, v220, v221
    v_pk_fma_f32 v[222:223], v[54:55], v[74:75], v[222:223] op_sel:[0,1,0] op_sel_hi:[1,1,1]
    v_pk_mul_f32 v[222:223], v[222:223], v[70:71]
    v_cvt_pk_bf16_f32 v111, v222, v223
    s_mul_i32 s86, s3, 3072
    s_add_u32 s86, s86, 139264
    v_lshl_add_u32 v6, v0, 4, s86
    s_xor_b32 s86, s3, 1
    s_mul_i32 s86, s86, 3072
    s_add_u32 s86, s86, 139264
    v_lshl_add_u32 v7, v0, 4, s86
    s_cmp_eq_u32 s49, 1
    s_cbranch_scc1 L_kv1
    v_mfma_f32_16x16x32_bf16 v[172:175], v[80:83], v[104:107], 0
    v_mfma_f32_16x16x32_bf16 v[176:179], v[88:91], v[104:107], 0
    v_mfma_f32_16x16x32_bf16 v[180:183], v[88:91], v[120:123], 0
    v_mfma_f32_16x16x32_bf16 v[160:163], v[80:83], v[96:99], 0
    v_mfma_f32_16x16x32_bf16 v[164:167], v[88:91], v[96:99], 0
    v_mfma_f32_16x16x32_bf16 v[168:171], v[80:83], v[120:123], 0
    v_mfma_f32_16x16x32_bf16 v[172:175], v[84:87], v[108:111], v[172:175]
    v_mfma_f32_16x16x32_bf16 v[176:179], v[92:95], v[108:111], v[176:179]
    v_mfma_f32_16x16x32_bf16 v[180:183], v[92:95], v[120:123], v[180:183]
    v_mfma_f32_16x16x32_bf16 v[160:163], v[84:87], v[100:103], v[160:163]
    v_mfma_f32_16x16x32_bf16 v[164:167], v[92:95], v[100:103], v[164:167]
    v_mfma_f32_16x16x32_bf16 v[168:171], v[84:87], v[120:123], v[168:171]
    s_branch L_kvd
L_kv1:
    v_mfma_f32_16x16x32_bf16 v[172:175], v[80:83], v[96:99], 0
    v_mfma_f32_16x16x32_bf16 v[176:179], v[88:91], v[96:99], 0
    v_mfma_f32_16x16x32_bf16 v[180:183], v[80:83], v[120:123], 0
    v_mfma_f32_16x16x32_bf16 v[160:163], v[80:83], v[104:107], 0
    v_mfma_f32_16x16x32_bf16 v[164:167], v[88:91], v[104:107], 0
    v_mfma_f32_16x16x32_bf16 v[168:171], v[88:91], v[120:123], 0
    v_mfma_f32_16x16x32_bf16 v[172:175], v[84:87], v[100:103], v[172:175]
    v_mfma_f32_16x16x32_bf16 v[176:179], v[92:95], v[100:103], v[176:179]
    v_mfma_f32_16x16x32_bf16 v[180:183], v[84:87], v[120:123], v[180:183]
    v_mfma_f32_16x16x32_bf16 v[160:163], v[84:87], v[108:111], v[160:163]
    v_mfma_f32_16x16x32_bf16 v[164:167], v[92:95], v[108:111], v[164:167]
    v_mfma_f32_16x16x32_bf16 v[168:171], v[92:95], v[120:123], v[168:171]
L_kvd:
    s_lshl_b32 s86, s47, 1
    s_add_u32 s86, s86, s50
    s_lshl_b32 s87, s86, 1
    s_add_u32 s87, s87, s49
    s_lshl_b32 s87, s87, 4
    s_add_u32 s87, s87, s46
    s_lshl_b32 s87, s87, 10
    s_add_u32 s87, s87, 5242880
    v_lshl_add_u32 v8, v0, 4, s87
    s_lshl_b32 s87, s86, 4
    s_add_u32 s87, s87, s46
    s_lshl_b32 s87, s87, 7
    s_lshl_b32 s88, s49, 6
    s_add_u32 s87, s87, s88
    s_add_u32 s87, s87, 6881280
    v_add_u32 v9, s87, v0
    s_mov_b32 vcc_lo, 0x00010001
    s_mov_b32 vcc_hi, vcc_lo
    v_mov_b32 v14, 2147483648
    v_cndmask_b32 v9, v14, v9, vcc
    ds_write_b128 v6, v[172:175] offset:0
    ds_write_b128 v6, v[176:179] offset:1024
    ds_write_b128 v6, v[180:183] offset:2048
    ds_write_b32 v12, v12
    s_lshl_b32 s86, s47, 1
    s_add_u32 s86, s86, s50
    s_lshl_b32 s87, s46, 3
    s_lshl_b32 s88, s49, 2
    s_add_u32 s87, s87, s88
    s_lshl_b32 s87, s87, 5
    s_add_u32 s87, s87, s86
    s_lshl_b32 s87, s87, 10
    s_add_u32 s87, s87, 1048576
    v_lshl_add_u32 v10, v0, 4, s87
    s_mul_i32 s87, s50, 3072
    s_add_u32 s87, s87, 151552
    v_lshl_add_u32 v11, v0, 4, s87
    s_lshl_b32 s87, s86, 1
    s_add_u32 s87, s87, s49
    s_lshl_b32 s87, s87, 5
    s_add_u32 s87, s87, s46
    s_lshl2_add_u32 s87, s87, 671744
    v_mov_b32 v16, 2147483648
    v_mov_b32 v18, 2147483648
    v_writelane_b32 v16, s87, 0
    s_lshl_b32 s87, s46, 1
    s_add_u32 s87, s87, s49
    s_lshl_b32 s87, s87, 1
    s_lshr_b32 s88, s86, 4
    s_add_u32 s87, s87, s88
    s_lshl_b32 s87, s87, 6
    s_and_b32 s88, s86, 15
    s_add_u32 s87, s87, s88
    s_lshl2_add_u32 s87, s87, 688128
    v_writelane_b32 v18, s87, 0
    s_add_u32 s87, s87, 128
    v_writelane_b32 v18, s87, 1
    v_mov_b32 v17, s68
L_xkv:
    ds_read_b32 v14, v13
    ds_read_b128 v[172:175], v7 offset:0
    ds_read_b128 v[176:179], v7 offset:1024
    ds_read_b128 v[180:183], v7 offset:2048
    s_waitcnt lgkmcnt(0)
    v_cmp_eq_u32 vcc, 0, v14
    s_cbranch_vccz L_ok_2
    s_sub_u32 s56, s56, 1
    s_cbranch_scc0 L_xkv
    s_mov_b32 s56, 0
L_ok_2:
    v_pk_add_f32 v[160:161], v[160:161], v[172:173]
    v_pk_add_f32 v[162:163], v[162:163], v[174:175]
    v_pk_add_f32 v[164:165], v[164:165], v[176:177]
    v_pk_add_f32 v[166:167], v[166:167], v[178:179]
    v_pk_add_f32 v[168:169], v[168:169], v[180:181]
    v_pk_add_f32 v[170:171], v[170:171], v[182:183]
    v_cvt_pk_bf16_f32 v184, v160, v161
    v_cvt_pk_bf16_f32 v185, v162, v163
    v_cvt_pk_bf16_f32 v186, v164, v165
    v_cvt_pk_bf16_f32 v187, v166, v167
    buffer_store_dwordx4 v[184:187], v8, s[16:19], 0 offen sc1
    buffer_store_dwordx4 v[168:171], v9, s[16:19], 0 offen sc1
    buffer_atomic_swap v17, v16, s[16:19], 0 offen sc1
    v_pk_fma_f32 v[128:129], v[28:29], v[240:241], v[128:129] op_sel_hi:[1,0,1]
    v_pk_mul_f32 v[112:113], v[128:129], v[248:249] op_sel_hi:[1,0]
    v_pk_fma_f32 v[128:129], v[128:129], v[244:245], s[54:55] op_sel_hi:[1,0,1]
    v_exp_f32 v112, v112 clamp
    v_exp_f32 v113, v113 clamp
    v_max_f32 v128, s54, v128
    v_max_f32 v129, s54, v129
    v_pk_add_f32 v[128:129], v[128:129], v[112:113]
    v_cvt_pk_bf16_f32 v192, v128, v129
    v_pk_fma_f32 v[130:131], v[30:31], v[240:241], v[130:131] op_sel_hi:[1,0,1]
    v_pk_mul_f32 v[114:115], v[130:131], v[248:249] op_sel_hi:[1,0]
    v_pk_fma_f32 v[130:131], v[130:131], v[244:245], s[54:55] op_sel_hi:[1,0,1]
    v_exp_f32 v114, v114 clamp
    v_exp_f32 v115, v115 clamp
    v_max_f32 v130, s54, v130
    v_max_f32 v131, s54, v131
    v_pk_add_f32 v[130:131], v[130:131], v[114:115]
    v_cvt_pk_bf16_f32 v193, v130, v131
    v_pk_fma_f32 v[144:145], v[32:33], v[240:241], v[144:145] op_sel_hi:[1,0,1]
    v_pk_mul_f32 v[116:117], v[144:145], v[248:249] op_sel_hi:[1,0]
    v_pk_fma_f32 v[144:145], v[144:145], v[244:245], s[54:55] op_sel_hi:[1,0,1]
    v_exp_f32 v116, v116 clamp
    v_exp_f32 v117, v117 clamp
    v_max_f32 v144, s54, v144
    v_max_f32 v145, s54, v145
    v_pk_add_f32 v[144:145], v[144:145], v[116:117]
    v_cvt_pk_bf16_f32 v194, v144, v145
L_walk_13:
    s_cbranch_execz L_walk_17
    v_pk_fma_f32 v[146:147], v[34:35], v[240:241], v[146:147] op_sel_hi:[1,0,1]
    v_pk_mul_f32 v[118:119], v[146:147], v[248:249] op_sel_hi:[1,0]
    v_pk_fma_f32 v[146:147], v[146:147], v[244:245], s[54:55] op_sel_hi:[1,0,1]
    v_exp_f32 v118, v118 clamp
    v_exp_f32 v119, v119 clamp
    v_max_f32 v146, s54, v146
    v_max_f32 v147, s54, v147
    v_pk_add_f32 v[146:147], v[146:147], v[118:119]
    v_cvt_pk_bf16_f32 v195, v146, v147
    v_pk_fma_f32 v[132:133], v[28:29], v[240:241], v[132:133] op_sel:[0,1,0] op_sel_hi:[1,1,1]
    v_pk_mul_f32 v[112:113], v[132:133], v[248:249] op_sel:[0,1] op_sel_hi:[1,1]
    v_pk_fma_f32 v[132:133], v[132:133], v[244:245], s[54:55] op_sel:[0,1,0] op_sel_hi:[1,1,1]
    v_exp_f32 v112, v112 clamp
    v_exp_f32 v113, v113 clamp
    v_max_f32 v132, s54, v132
    v_max_f32 v133, s54, v133
    v_pk_add_f32 v[132:133], v[132:133], v[112:113]
    v_cvt_pk_bf16_f32 v196, v132, v133
    v_pk_fma_f32 v[134:135], v[30:31], v[240:241], v[134:135] op_sel:[0,1,0] op_sel_hi:[1,1,1]
    v_pk_mul_f32 v[114:115], v[134:135], v[248:249] op_sel:[0,1] op_sel_hi:[1,1]
    v_pk_fma_f32 v[134:135], v[134:135], v[244:245], s[54:55] op_sel:[0,1,0] op_sel_hi:[1,1,1]
    v_exp_f32 v114, v114 clamp
    v_exp_f32 v115, v115 clamp
    v_max_f32 v134, s54, v134
    v_max_f32 v135, s54, v135
    v_pk_add_f32 v[134:135], v[134:135], v[114:115]
    v_cvt_pk_bf16_f32 v197, v134, v135
    v_pk_fma_f32 v[148:149], v[32:33], v[240:241], v[148:149] op_sel:[0,1,0] op_sel_hi:[1,1,1]
    v_pk_mul_f32 v[116:117], v[148:149], v[248:249] op_sel:[0,1] op_sel_hi:[1,1]
    v_pk_fma_f32 v[148:149], v[148:149], v[244:245], s[54:55] op_sel:[0,1,0] op_sel_hi:[1,1,1]
    v_exp_f32 v116, v116 clamp
    v_exp_f32 v117, v117 clamp
    v_max_f32 v148, s54, v148
    v_max_f32 v149, s54, v149
    v_pk_add_f32 v[148:149], v[148:149], v[116:117]
    v_cvt_pk_bf16_f32 v198, v148, v149
    v_pk_fma_f32 v[150:151], v[34:35], v[240:241], v[150:151] op_sel:[0,1,0] op_sel_hi:[1,1,1]
    v_pk_mul_f32 v[118:119], v[150:151], v[248:249] op_sel:[0,1] op_sel_hi:[1,1]
    v_pk_fma_f32 v[150:151], v[150:151], v[244:245], s[54:55] op_sel:[0,1,0] op_sel_hi:[1,1,1]
    v_exp_f32 v118, v118 clamp
    v_exp_f32 v119, v119 clamp
    v_max_f32 v150, s54, v150
    v_max_f32 v151, s54, v151
    v_pk_add_f32 v[150:151], v[150:151], v[118:119]
    v_cvt_pk_bf16_f32 v199, v150, v151
    v_pk_fma_f32 v[136:137], v[28:29], v[242:243], v[136:137] op_sel_hi:[1,0,1]
    v_pk_mul_f32 v[112:113], v[136:137], v[250:251] op_sel_hi:[1,0]
    v_pk_fma_f32 v[136:137], v[136:137], v[246:247], s[54:55] op_sel_hi:[1,0,1]
    v_exp_f32 v112, v112 clamp
    v_exp_f32 v113, v113 clamp
    v_max_f32 v136, s54, v136
    v_max_f32 v137, s54, v137
    v_pk_add_f32 v[136:137], v[136:137], v[112:113]
    v_cvt_pk_bf16_f32 v200, v136, v137
    v_pk_fma_f32 v[138:139], v[30:31], v[242:243], v[138:139] op_sel_hi:[1,0,1]
    v_pk_mul_f32 v[114:115], v[138:139], v[250:251] op_sel_hi:[1,0]
    v_pk_fma_f32 v[138:139], v[138:139], v[246:247], s[54:55] op_sel_hi:[1,0,1]
    v_exp_f32 v114, v114 clamp
    v_exp_f32 v115, v115 clamp
    v_max_f32 v138, s54, v138
    v_max_f32 v139, s54, v139
    v_pk_add_f32 v[138:139], v[138:139], v[114:115]
    v_cvt_pk_bf16_f32 v201, v138, v139
    v_pk_fma_f32 v[152:153], v[32:33], v[242:243], v[152:153] op_sel_hi:[1,0,1]
    v_pk_mul_f32 v[116:117], v[152:153], v[250:251] op_sel_hi:[1,0]
    v_pk_fma_f32 v[152:153], v[152:153], v[246:247], s[54:55] op_sel_hi:[1,0,1]
    v_exp_f32 v116, v116 clamp
    v_exp_f32 v117, v117 clamp
    v_max_f32 v152, s54, v152
    v_max_f32 v153, s54, v153
    v_pk_add_f32 v[152:153], v[152:153], v[116:117]
    v_cvt_pk_bf16_f32 v202, v152, v153
    v_pk_fma_f32 v[154:155], v[34:35], v[242:243], v[154:155] op_sel_hi:[1,0,1]
    v_pk_mul_f32 v[118:119], v[154:155], v[250:251] op_sel_hi:[1,0]
    v_pk_fma_f32 v[154:155], v[154:155], v[246:247], s[54:55] op_sel_hi:[1,0,1]
    v_exp_f32 v118, v118 clamp
    v_exp_f32 v119, v119 clamp
    v_max_f32 v154, s54, v154
    v_max_f32 v155, s54, v155
    v_pk_add_f32 v[154:155], v[154:155], v[118:119]
    v_cvt_pk_bf16_f32 v203, v154, v155
    v_pk_fma_f32 v[140:141], v[28:29], v[242:243], v[140:141] op_sel:[0,1,0] op_sel_hi:[1,1,1]
    v_pk_mul_f32 v[112:113], v[140:141], v[250:251] op_sel:[0,1] op_sel_hi:[1,1]
    v_pk_fma_f32 v[140:141], v[140:141], v[246:247], s[54:55] op_sel:[0,1,0] op_sel_hi:[1,1,1]
    v_exp_f32 v112, v112 clamp
    v_exp_f32 v113, v113 clamp
    v_max_f32 v140, s54, v140
    v_max_f32 v141, s54, v141
    v_pk_add_f32 v[140:141], v[140:141], v[112:113]
    v_cvt_pk_bf16_f32 v204, v140, v141
    v_pk_fma_f32 v[142:143], v[30:31], v[242:243], v[142:143] op_sel:[0,1,0] op_sel_hi:[1,1,1]
    v_pk_mul_f32 v[114:115], v[142:143], v[250:251] op_sel:[0,1] op_sel_hi:[1,1]
    v_pk_fma_f32 v[142:143], v[142:143], v[246:247], s[54:55] op_sel:[0,1,0] op_sel_hi:[1,1,1]
    v_exp_f32 v114, v114 clamp
    v_exp_f32 v115, v115 clamp
    v_max_f32 v142, s54, v142
    v_max_f32 v143, s54, v143
    v_pk_add_f32 v[142:143], v[142:143], v[114:115]
    v_cvt_pk_bf16_f32 v205, v142, v143
    v_pk_fma_f32 v[156:157], v[32:33], v[242:243], v[156:157] op_sel:[0,1,0] op_sel_hi:[1,1,1]
    v_pk_mul_f32 v[116:117], v[156:157], v[250:251] op_sel:[0,1] op_sel_hi:[1,1]
    v_pk_fma_f32 v[156:157], v[156:157], v[246:247], s[54:55] op_sel:[0,1,0] op_sel_hi:[1,1,1]
    v_exp_f32 v116, v116 clamp
    v_exp_f32 v117, v117 clamp
    v_max_f32 v156, s54, v156
    v_max_f32 v157, s54, v157
    v_pk_add_f32 v[156:157], v[156:157], v[116:117]
    v_cvt_pk_bf16_f32 v206, v156, v157
    v_pk_fma_f32 v[158:159], v[34:35], v[242:243], v[158:159] op_sel:[0,1,0] op_sel_hi:[1,1,1]
    v_pk_mul_f32 v[118:119], v[158:159], v[250:251] op_sel:[0,1] op_sel_hi:[1,1]
    v_pk_fma_f32 v[158:159], v[158:159], v[246:247], s[54:55] op_sel:[0,1,0] op_sel_hi:[1,1,1]
    v_exp_f32 v118, v118 clamp
    v_exp_f32 v119, v119 clamp
    v_max_f32 v158, s54, v158
    v_max_f32 v159, s54, v159
    v_pk_add_f32 v[158:159], v[158:159], v[118:119]
    v_cvt_pk_bf16_f32 v207, v158, v159
    s_lshr_b32 s62, s3, 2
    s_lshl_b32 s53, s51, 3
    s_lshl_b32 s86, s48, 1
    s_add_u32 s53, s53, s86
    s_add_u32 s53, s53, s62
    v_lshrrev_b32 v36, 4, v0
    v_and_b32 v37, 15, v0
    s_lshl_b32 s87, s53, 15
    s_lshl_b32 s86, s62, 14
    s_add_u32 s86, s86, s87
    s_add_u32 s86, s86, 1048576
    v_lshl_add_u32 v157, v0, 4, s86
    v_xor_b32 v158, 0x8000, v157
    s_lshl_b32 s86, s51, 1
    s_lshr_b32 s87, s48, 1
    s_add_u32 s86, s86, s87
    s_lshl_b32 s86, s86, 1
    s_add_u32 s86, s86, s62
    s_lshl_b32 s86, s86, 1
    s_and_b32 s87, s48, 1
    s_add_u32 s86, s86, s87
    s_lshl_b32 s86, s86, 7
    s_add_u32 s86, s86, 688128
    v_lshl_add_u32 v159, v0, 2, s86
    v_mov_b32 v38, 2147483648
    v_cmp_gt_u32 vcc, 16, v0
    s_nop 1
    v_cndmask_b32 v159, v38, v159, vcc
    v_bfe_u32 v38, v0, 2, 2
    v_lshl_add_u32 v38, v36, 2, v38
    v_bfe_u32 v39, v38, 1, 2
    v_lshlrev_b32 v38, 7, v38
    v_lshl_add_u32 v38, v39, 5, v38
    v_and_b32 v39, 3, v0
    v_lshl_add_u32 v38, v39, 3, v38
    s_lshl_b32 s86, s62, 16
    s_add_u32 s86, s86, 0
    v_add_u32 v144, s86, v38
    v_xor_b32 v145, 32, v144
    v_xor_b32 v146, 64, v144
    v_xor_b32 v147, 96, v144
    v_cmp_eq_u32 s[4:5], 1, v39
    v_cmp_eq_u32 s[6:7], 2, v39
    v_cmp_eq_u32 s[98:99], 3, v39
    s_lshl_b32 s86, s53, 10
    s_add_u32 s86, s86, 786432
    v_lshl_add_u32 v160, v0, 2, s86
L_walk_14:
    s_cbranch_execz L_walk_18
    v_mul_u32_u24 v161, 192, v36
    v_add_u32 v160, v160, v161
    s_mov_b32 s72, 0x00f0000f
    s_mov_b32 s73, 0xf0000f00
    s_mov_b32 s74, 0x0f00f000
    s_mov_b32 s75, 0x0f00f000
    v_lshrrev_b32 v38, 2, v37
    v_lshl_add_u32 v161, v38, 4, v37
    v_lshlrev_b32 v161, 2, v161
    s_lshl_b32 s86, s3, 12
    s_add_u32 s86, s86, 131072
    v_lshl_add_u32 v162, v0, 4, s86
    v_xor_b32 v163, 0x4000, v162
    s_lshl_b32 s86, s52, 7
    v_lshl_add_u32 v36, v36, 3, s86
    s_lshl_b32 s87, s53, 15
    s_add_u32 s87, s87, s86
    s_lshl_b32 s86, s62, 6
    s_add_u32 s87, s87, s86
    v_lshl_add_u32 v39, v37, 11, s87
    v_and_b32 v38, 48, v0
    v_add_u32 v39, v39, v38
    v_xor_b32 v37, 0x8000, v39
    buffer_load_dwordx4 v[136:139], v39, s[8:11], 0 offen
    buffer_load_dwordx4 v[140:143], v37, s[8:11], 0 offen
    buffer_load_dwordx2 v[148:149], v36, s[40:43], 0 offen offset:0
    buffer_load_dwordx2 v[150:151], v36, s[40:43], 0 offen offset:32
    buffer_load_dwordx2 v[152:153], v36, s[40:43], 0 offen offset:64
    buffer_load_dwordx2 v[154:155], v36, s[40:43], 0 offen offset:96
    s_barrier
    ds_read_b128 v[40:43], v11 offset:0
    ds_read_b128 v[44:47], v11 offset:1024
    ds_read_b128 v[48:51], v11 offset:2048
    v_mov_b32 v38, 135200
    ds_read_b32 v38, v38
    s_mov_b32 s86, 0x8000
    s_mov_b32 s87, 0x10000
    s_mov_b32 s88, 0x18000
    s_waitcnt lgkmcnt(0)
    v_mfma_f32_16x16x32_bf16 v[216:219], v[48:51], v[192:195], 0
    v_mfma_f32_16x16x32_bf16 v[208:211], v[40:43], v[192:195], 0
    v_mfma_f32_16x16x32_bf16 v[212:215], v[44:47], v[192:195], 0
    v_mfma_f32_16x16x32_bf16 v[228:231], v[48:51], v[196:199], 0
    v_mfma_f32_16x16x32_bf16 v[220:223], v[40:43], v[196:199], 0
    v_mfma_f32_16x16x32_bf16 v[224:227], v[44:47], v[196:199], 0
    v_mfma_f32_16x16x32_bf16 v[240:243], v[48:51], v[200:203], 0
    v_mfma_f32_16x16x32_bf16 v[232:235], v[40:43], v[200:203], 0
    v_mfma_f32_16x16x32_bf16 v[236:239], v[44:47], v[200:203], 0
    v_mfma_f32_16x16x32_bf16 v[252:255], v[48:51], v[204:207], 0
    v_mfma_f32_16x16x32_bf16 v[244:247], v[40:43], v[204:207], 0
    v_mfma_f32_16x16x32_bf16 v[248:251], v[44:47], v[204:207], 0
    v_add_f32 v216, s54, v216
    v_rcp_f32 v216, v216
    s_nop 0
    v_pk_mul_f32 v[208:209], v[208:209], v[216:217] op_sel_hi:[1,0]
    v_pk_mul_f32 v[210:211], v[210:211], v[216:217] op_sel_hi:[1,0]
    v_pk_mul_f32 v[212:213], v[212:213], v[216:217] op_sel_hi:[1,0]
    v_pk_mul_f32 v[214:215], v[214:215], v[216:217] op_sel_hi:[1,0]
    v_cvt_pk_bf16_f32 v60, v208, v209
    v_cvt_pk_bf16_f32 v61, v210, v211
    v_cvt_pk_bf16_f32 v62, v212, v213
    v_cvt_pk_bf16_f32 v63, v214, v215
    buffer_store_dwordx4 v[60:63], v10, s[16:19], 0 offen sc1
    v_add_f32 v228, s54, v228
    v_rcp_f32 v228, v228
    s_nop 0
    v_pk_mul_f32 v[220:221], v[220:221], v[228:229] op_sel_hi:[1,0]
    v_pk_mul_f32 v[222:223], v[222:223], v[228:229] op_sel_hi:[1,0]
    v_pk_mul_f32 v[224:225], v[224:225], v[228:229] op_sel_hi:[1,0]
    v_pk_mul_f32 v[226:227], v[226:227], v[228:229] op_sel_hi:[1,0]
    v_cvt_pk_bf16_f32 v64, v220, v221
    v_cvt_pk_bf16_f32 v65, v222, v223
    v_cvt_pk_bf16_f32 v66, v224, v225
    v_cvt_pk_bf16_f32 v67, v226, v227
    buffer_store_dwordx4 v[64:67], v10, s[16:19], s86 offen sc1
    v_add_f32 v240, s54, v240
    v_rcp_f32 v240, v240
    s_nop 0
    v_pk_mul_f32 v[232:233], v[232:233], v[240:241] op_sel_hi:[1,0]
    v_pk_mul_f32 v[234:235], v[234:235], v[240:241] op_sel_hi:[1,0]
    v_pk_mul_f32 v[236:237], v[236:237], v[240:241] op_sel_hi:[1,0]
    v_pk_mul_f32 v[238:239], v[238:239], v[240:241] op_sel_hi:[1,0]
    v_cvt_pk_bf16_f32 v68, v232, v233
    v_cvt_pk_bf16_f32 v69, v234, v235
    v_cvt_pk_bf16_f32 v70, v236, v237
    v_cvt_pk_bf16_f32 v71, v238, v239
    buffer_store_dwordx4 v[68:71], v10, s[16:19], s87 offen sc1
    v_add_f32 v252, s54, v252
    v_rcp_f32 v252, v252
    s_nop 0
    v_pk_mul_f32 v[244:245], v[244:245], v[252:253] op_sel_hi:[1,0]
    v_pk_mul_f32 v[246:247], v[246:247], v[252:253] op_sel_hi:[1,0]
    v_pk_mul_f32 v[248:249], v[248:249], v[252:253] op_sel_hi:[1,0]
    v_pk_mul_f32 v[250:251], v[250:251], v[252:253] op_sel_hi:[1,0]
    v_cvt_pk_bf16_f32 v72, v244, v245
    v_cvt_pk_bf16_f32 v73, v246, v247
    v_cvt_pk_bf16_f32 v74, v248, v249
    v_cvt_pk_bf16_f32 v75, v250, v251
    buffer_store_dwordx4 v[72:75], v10, s[16:19], s88 offen sc1
    buffer_atomic_swap v17, v18, s[16:19], 0 offen sc1
    v_mov_b32 v8, 0
    buffer_atomic_or v8, v159, s[16:19], 0 offen sc0 sc1
    v_mov_b32 v14, 2147483648
    v_mov_b32 v11, 2147483648
    s_waitcnt vmcnt(6)
    v_bfe_u32 v36, v0, 2, 1
    v_cmp_eq_u32 vcc, 1, v36
    v_mov_b32 v36, s95
    s_nop 0
    v_cndmask_b32 v148, v36, v148, vcc
    v_cndmask_b32 v149, v36, v149, vcc
    v_cndmask_b32 v150, v36, v150, vcc
    v_cndmask_b32 v151, v36, v151, vcc
    v_cndmask_b32 v152, v36, v152, vcc
    v_cndmask_b32 v153, v36, v153, vcc
    v_cndmask_b32 v154, v36, v154, vcc
    v_cndmask_b32 v155, v36, v155, vcc
    v_readfirstlane_b32 s57, v38
L_phaseB:
    v_lshrrev_b32 v1, 4, v0
    v_and_b32 v2, 15, v0
    v_mov_b32 v3, 0x3f80
    s_lshl_b32 s87, s53, 4
    v_add_u32 v6, s87, v2
    s_lshl_b32 s86, s52, 7
    v_lshl_add_u32 v5, v6, 11, s86
    v_sub_u32 v6, 2047, v6
    v_mov_b32 v7, v39
    v_lshrrev_b32 v9, 1, v1
    v_lshl_add_u32 v5, v9, 4, v5
    v_and_b32 v9, 1, v1
    v_lshl_add_u32 v5, v9, 5, v5
    s_mov_b32 s67, 0
    s_mov_b32 s66, 0xffffaaaa
    s_mov_b32 s63, 0
L_b_init:
    v_bfe_u32 v9, v0, 3, 1
    v_bfe_u32 v10, v0, 4, 1
    v_xor_b32 v9, v9, v10
    v_bfe_u32 v10, v0, 1, 2
    v_lshl_add_u32 v9, v9, 3, v10
    v_lshrrev_b32 v10, 5, v0
    v_lshl_add_u32 v9, v10, 2, v9
    v_and_b32 v10, 1, v0
    v_lshlrev_b32 v10, 4, v10
    v_lshlrev_b32 v10, v10, v3
    v_cmp_eq_u32 vcc, 0, v9
    s_nop 1
    v_cndmask_b32 v128, 0, v10, vcc
    v_cmp_eq_u32 vcc, 1, v9
    s_nop 1
    v_cndmask_b32 v129, 0, v10, vcc
    v_cmp_eq_u32 vcc, 2, v9
    s_nop 1
    v_cndmask_b32 v130, 0, v10, vcc
    v_cmp_eq_u32 vcc, 3, v9
    s_nop 1
    v_cndmask_b32 v131, 0, v10, vcc
    v_cmp_eq_u32 vcc, 4, v9
    s_nop 1
    v_cndmask_b32 v132, 0, v10, vcc
    v_cmp_eq_u32 vcc, 5, v9
    s_nop 1
    v_cndmask_b32 v133, 0, v10, vcc
    v_cmp_eq_u32 vcc, 6, v9
    s_nop 1
    v_cndmask_b32 v134, 0, v10, vcc
    v_cmp_eq_u32 vcc, 7, v9
    s_nop 1
    v_cndmask_b32 v135, 0, v10, vcc
    v_mov_b32 v80, 0
    v_mov_b32 v81, 0
    v_mov_b32 v82, 0
    v_mov_b32 v83, 0
    v_mov_b32 v84, 0
    v_mov_b32 v85, 0
    v_mov_b32 v86, 0
    v_mov_b32 v87, 0
    v_mov_b32 v88, 0
    v_mov_b32 v89, 0
    v_mov_b32 v90, 0
    v_mov_b32 v91, 0
L_walk_15:
    s_cbranch_execz L_walk_19
    v_mov_b32 v92, 0
    v_mov_b32 v93, 0
    v_mov_b32 v94, 0
    v_mov_b32 v95, 0
    v_mov_b32 v96, 0
    v_mov_b32 v97, 0
    v_mov_b32 v98, 0
    v_mov_b32 v99, 0
    v_mov_b32 v100, 0
    v_mov_b32 v101, 0
    v_mov_b32 v102, 0
    v_mov_b32 v103, 0
    v_mov_b32 v104, 0
    v_mov_b32 v105, 0
    v_mov_b32 v106, 0
    v_mov_b32 v107, 0
    v_mov_b32 v108, 0
    v_mov_b32 v109, 0
    v_mov_b32 v110, 0
    v_mov_b32 v111, 0
    v_mov_b32 v156, 0
    s_branch L_b_w0
L_b_r0:
    s_ff1_i32_b32 s91, s65
    s_bitset0_b32 s65, s91
    s_lshl_b32 s76, s91, 12
    s_lshl_b32 s91, s91, 10
    buffer_load_dwordx4 v[16:19], v157, s[16:19], s91 offen offset:0 sc1
    buffer_load_dwordx4 v[20:23], v158, s[16:19], s91 offen offset:0 sc1
    buffer_load_dwordx4 v[24:27], v157, s[16:19], s91 offen offset:1024 sc1
    buffer_load_dwordx4 v[28:31], v158, s[16:19], s91 offen offset:1024 sc1
    s_cmp_eq_u32 s65, 0
    s_cbranch_scc1 L_b_p1
L_b_r1:
    s_ff1_i32_b32 s91, s65
    s_bitset0_b32 s65, s91
    s_lshl_b32 s77, s91, 12
    s_lshl_b32 s91, s91, 10
    buffer_load_dwordx4 v[32:35], v157, s[16:19], s91 offen offset:0 sc1
    buffer_load_dwordx4 v[36:39], v158, s[16:19], s91 offen offset:0 sc1
    buffer_load_dwordx4 v[40:43], v157, s[16:19], s91 offen offset:1024 sc1
    buffer_load_dwordx4 v[44:47], v158, s[16:19], s91 offen offset:1024 sc1
    s_xor_b32 s89, s67, s76
    s_mov_b32 s67, s76
    v_xor_b32 v144, s89, v144
    ds_read_b64_tr_b16 v[112:113], v144 offset:0
    ds_read_b64_tr_b16 v[114:115], v144 offset:2048
    v_xor_b32 v145, s89, v145
    ds_read_b64_tr_b16 v[116:117], v145 offset:0
    ds_read_b64_tr_b16 v[118:119], v145 offset:2048
    v_xor_b32 v146, s89, v146
    ds_read_b64_tr_b16 v[120:121], v146 offset:0
    ds_read_b64_tr_b16 v[122:123], v146 offset:2048
    v_xor_b32 v147, s89, v147
    ds_read_b64_tr_b16 v[124:125], v147 offset:0
    ds_read_b64_tr_b16 v[126:127], v147 offset:2048
    s_cmp_eq_u32 s62, 0
    s_cbranch_scc0 L_b_x1
    v_mfma_f32_16x16x32_bf16 v[80:83], v[128:131], v[136:139], 0
    v_mfma_f32_16x16x32_bf16 v[96:99], v[128:131], v[140:143], 0
    v_mfma_f32_16x16x32_bf16 v[84:87], v[132:135], v[136:139], 0
    v_mfma_f32_16x16x32_bf16 v[100:103], v[132:135], v[140:143], 0
    s_branch L_b_xd
L_b_x1:
    s_setprio 1
    v_mfma_f32_16x16x32_bf16 v[88:91], v[128:131], v[136:139], 0
    v_mfma_f32_16x16x32_bf16 v[104:107], v[128:131], v[140:143], 0
    v_mfma_f32_16x16x32_bf16 v[92:95], v[132:135], v[136:139], 0
    v_mfma_f32_16x16x32_bf16 v[108:111], v[132:135], v[140:143], 0
L_b_xd:
    s_waitcnt vmcnt(6) lgkmcnt(6)
    v_max3_u32 v156, v156, v19, v23
    v_mfma_f32_16x16x32_bf16 v[80:83], v[112:115], v[16:19], v[80:83]
    ds_read_b64_tr_b16 v[128:129], v144 offset:4096
    v_mfma_f32_16x16x32_bf16 v[96:99], v[112:115], v[20:23], v[96:99]
    ds_read_b64_tr_b16 v[130:131], v144 offset:6144
    s_waitcnt lgkmcnt(6)
    v_mfma_f32_16x16x32_bf16 v[84:87], v[116:119], v[16:19], v[84:87]
    ds_read_b64_tr_b16 v[132:133], v145 offset:4096
    v_mfma_f32_16x16x32_bf16 v[100:103], v[116:119], v[20:23], v[100:103]
    ds_read_b64_tr_b16 v[134:135], v145 offset:6144
    s_waitcnt lgkmcnt(6)
    v_mfma_f32_16x16x32_bf16 v[88:91], v[120:123], v[16:19], v[88:91]
    ds_read_b64_tr_b16 v[136:137], v146 offset:4096
    v_mfma_f32_16x16x32_bf16 v[104:107], v[120:123], v[20:23], v[104:107]
    ds_read_b64_tr_b16 v[138:139], v146 offset:6144
    s_waitcnt lgkmcnt(6)
    v_mfma_f32_16x16x32_bf16 v[92:95], v[124:127], v[16:19], v[92:95]
    ds_read_b64_tr_b16 v[140:141], v147 offset:4096
    v_mfma_f32_16x16x32_bf16 v[108:111], v[124:127], v[20:23], v[108:111]
    ds_read_b64_tr_b16 v[142:143], v147 offset:6144
    s_not_b32 s91, s66
    s_cmp_eq_u32 s65, 0
    s_cselect_b32 s65, s91, s65
    s_cselect_b32 s66, -1, s66
    s_ff1_i32_b32 s91, s65
    s_bitset0_b32 s65, s91
    s_lshl_b32 s78, s91, 12
    s_lshl_b32 s91, s91, 10
    buffer_load_dwordx4 v[48:51], v157, s[16:19], s91 offen offset:0 sc1
    buffer_load_dwordx4 v[52:55], v158, s[16:19], s91 offen offset:0 sc1
    s_waitcnt vmcnt(6) lgkmcnt(6)
    v_max3_u32 v156, v156, v27, v31
    v_mfma_f32_16x16x32_bf16 v[80:83], v[128:131], v[24:27], v[80:83]
    s_xor_b32 s89, s67, s77
    s_mov_b32 s67, s77
    v_xor_b32 v144, s89, v144
    ds_read_b64_tr_b16 v[112:113], v144 offset:0
    v_mfma_f32_16x16x32_bf16 v[96:99], v[128:131], v[28:31], v[96:99]
    ds_read_b64_tr_b16 v[114:115], v144 offset:2048
    s_waitcnt lgkmcnt(6)
    v_mfma_f32_16x16x32_bf16 v[84:87], v[132:135], v[24:27], v[84:87]
    v_xor_b32 v145, s89, v145
    ds_read_b64_tr_b16 v[116:117], v145 offset:0
    v_mfma_f32_16x16x32_bf16 v[100:103], v[132:135], v[28:31], v[100:103]
    ds_read_b64_tr_b16 v[118:119], v145 offset:2048
    s_waitcnt lgkmcnt(6)
    v_mfma_f32_16x16x32_bf16 v[88:91], v[136:139], v[24:27], v[88:91]
    v_xor_b32 v146, s89, v146
    ds_read_b64_tr_b16 v[120:121], v146 offset:0
    v_mfma_f32_16x16x32_bf16 v[104:107], v[136:139], v[28:31], v[104:107]
    ds_read_b64_tr_b16 v[122:123], v146 offset:2048
    s_waitcnt lgkmcnt(6)
    v_mfma_f32_16x16x32_bf16 v[92:95], v[140:143], v[24:27], v[92:95]
    v_xor_b32 v147, s89, v147
    ds_read_b64_tr_b16 v[124:125], v147 offset:0
    v_mfma_f32_16x16x32_bf16 v[108:111], v[140:143], v[28:31], v[108:111]
    ds_read_b64_tr_b16 v[126:127], v147 offset:2048
    buffer_load_dwordx4 v[56:59], v157, s[16:19], s91 offen offset:1024 sc1
    buffer_load_dwordx4 v[60:63], v158, s[16:19], s91 offen offset:1024 sc1
    s_waitcnt vmcnt(6) lgkmcnt(6)
    v_max3_u32 v156, v156, v35, v39
    v_mfma_f32_16x16x32_bf16 v[80:83], v[112:115], v[32:35], v[80:83]
    ds_read_b64_tr_b16 v[128:129], v144 offset:4096
    v_mfma_f32_16x16x32_bf16 v[96:99], v[112:115], v[36:39], v[96:99]
    ds_read_b64_tr_b16 v[130:131], v144 offset:6144
    s_waitcnt lgkmcnt(6)
    v_mfma_f32_16x16x32_bf16 v[84:87], v[116:119], v[32:35], v[84:87]
    ds_read_b64_tr_b16 v[132:133], v145 offset:4096
    v_mfma_f32_16x16x32_bf16 v[100:103], v[116:119], v[36:39], v[100:103]
    ds_read_b64_tr_b16 v[134:135], v145 offset:6144
    s_waitcnt lgkmcnt(6)
    v_mfma_f32_16x16x32_bf16 v[88:91], v[120:123], v[32:35], v[88:91]
    ds_read_b64_tr_b16 v[136:137], v146 offset:4096
    v_mfma_f32_16x16x32_bf16 v[104:107], v[120:123], v[36:39], v[104:107]
    ds_read_b64_tr_b16 v[138:139], v146 offset:6144
    s_waitcnt lgkmcnt(6)
    v_mfma_f32_16x16x32_bf16 v[92:95], v[124:127], v[32:35], v[92:95]
    ds_read_b64_tr_b16 v[140:141], v147 offset:4096
    v_mfma_f32_16x16x32_bf16 v[108:111], v[124:127], v[36:39], v[108:111]
    ds_read_b64_tr_b16 v[142:143], v147 offset:6144
    s_not_b32 s91, s66
    s_cmp_eq_u32 s65, 0
    s_cselect_b32 s65, s91, s65
    s_cselect_b32 s66, -1, s66
    s_ff1_i32_b32 s91, s65
    s_bitset0_b32 s65, s91
    s_lshl_b32 s79, s91, 12
    s_lshl_b32 s91, s91, 10
    buffer_load_dwordx4 v[64:67], v157, s[16:19], s91 offen offset:0 sc1
    buffer_load_dwordx4 v[68:71], v158, s[16:19], s91 offen offset:0 sc1
    s_waitcnt vmcnt(6) lgkmcnt(6)
    v_max3_u32 v156, v156, v43, v47
    v_mfma_f32_16x16x32_bf16 v[80:83], v[128:131], v[40:43], v[80:83]
    s_xor_b32 s89, s67, s78
    s_mov_b32 s67, s78
    v_xor_b32 v144, s89, v144
    ds_read_b64_tr_b16 v[112:113], v144 offset:0
    v_mfma_f32_16x16x32_bf16 v[96:99], v[128:131], v[44:47], v[96:99]
    ds_read_b64_tr_b16 v[114:115], v144 offset:2048
    s_waitcnt lgkmcnt(6)
    v_mfma_f32_16x16x32_bf16 v[84:87], v[132:135], v[40:43], v[84:87]
    v_xor_b32 v145, s89, v145
    ds_read_b64_tr_b16 v[116:117], v145 offset:0
    v_mfma_f32_16x16x32_bf16 v[100:103], v[132:135], v[44:47], v[100:103]
    ds_read_b64_tr_b16 v[118:119], v145 offset:2048
    s_waitcnt lgkmcnt(6)
    v_mfma_f32_16x16x32_bf16 v[88:91], v[136:139], v[40:43], v[88:91]
    v_xor_b32 v146, s89, v146
    ds_read_b64_tr_b16 v[120:121], v146 offset:0
    v_mfma_f32_16x16x32_bf16 v[104:107], v[136:139], v[44:47], v[104:107]
    ds_read_b64_tr_b16 v[122:123], v146 offset:2048
    s_waitcnt lgkmcnt(6)
    v_mfma_f32_16x16x32_bf16 v[92:95], v[140:143], v[40:43], v[92:95]
    v_xor_b32 v147, s89, v147
    ds_read_b64_tr_b16 v[124:125], v147 offset:0
    v_mfma_f32_16x16x32_bf16 v[108:111], v[140:143], v[44:47], v[108:111]
    ds_read_b64_tr_b16 v[126:127], v147 offset:2048
    buffer_load_dwordx4 v[72:75], v157, s[16:19], s91 offen offset:1024 sc1
    buffer_load_dwordx4 v[76:79], v158, s[16:19], s91 offen offset:1024 sc1
L_walk_16:
    s_cbranch_execz L_walk_20
    s_waitcnt vmcnt(6) lgkmcnt(6)
L_b_c4:
    v_max_u32 v4, v51, v55
    v_cmp_eq_u32 vcc, -1, v4
    s_cbranch_vccnz L_b_g4
L_b_d4:
    v_mfma_f32_16x16x32_bf16 v[80:83], v[112:115], v[48:51], v[80:83]
    ds_read_b64_tr_b16 v[128:129], v144 offset:4096
    v_mfma_f32_16x16x32_bf16 v[96:99], v[112:115], v[52:55], v[96:99]
    ds_read_b64_tr_b16 v[130:131], v144 offset:6144
    s_waitcnt lgkmcnt(6)
    v_mfma_f32_16x16x32_bf16 v[84:87], v[116:119], v[48:51], v[84:87]
    ds_read_b64_tr_b16 v[132:133], v145 offset:4096
    v_mfma_f32_16x16x32_bf16 v[100:103], v[116:119], v[52:55], v[100:103]
    ds_read_b64_tr_b16 v[134:135], v145 offset:6144
    s_waitcnt lgkmcnt(6)
    v_mfma_f32_16x16x32_bf16 v[88:91], v[120:123], v[48:51], v[88:91]
    ds_read_b64_tr_b16 v[136:137], v146 offset:4096
    v_mfma_f32_16x16x32_bf16 v[104:107], v[120:123], v[52:55], v[104:107]
    ds_read_b64_tr_b16 v[138:139], v146 offset:6144
    s_waitcnt lgkmcnt(6)
    v_mfma_f32_16x16x32_bf16 v[92:95], v[124:127], v[48:51], v[92:95]
    ds_read_b64_tr_b16 v[140:141], v147 offset:4096
    v_mfma_f32_16x16x32_bf16 v[108:111], v[124:127], v[52:55], v[108:111]
    ds_read_b64_tr_b16 v[142:143], v147 offset:6144
    s_not_b32 s91, s66
    s_cmp_eq_u32 s65, 0
    s_cselect_b32 s65, s91, s65
    s_cselect_b32 s66, -1, s66
    s_ff1_i32_b32 s91, s65
    s_bitset0_b32 s65, s91
    s_lshl_b32 s76, s91, 12
    s_lshl_b32 s91, s91, 10
    buffer_load_dwordx4 v[16:19], v157, s[16:19], s91 offen offset:0 sc1
    buffer_load_dwordx4 v[20:23], v158, s[16:19], s91 offen offset:0 sc1
    s_waitcnt vmcnt(6) lgkmcnt(6)
L_b_c5:
    v_max_u32 v4, v59, v63
    v_cmp_eq_u32 vcc, -1, v4
    s_cbranch_vccnz L_b_g5
L_b_d5:
    v_mfma_f32_16x16x32_bf16 v[80:83], v[128:131], v[56:59], v[80:83]
    s_xor_b32 s89, s67, s79
    s_mov_b32 s67, s79
    v_xor_b32 v144, s89, v144
    ds_read_b64_tr_b16 v[112:113], v144 offset:0
    v_mfma_f32_16x16x32_bf16 v[96:99], v[128:131], v[60:63], v[96:99]
    ds_read_b64_tr_b16 v[114:115], v144 offset:2048
    s_waitcnt lgkmcnt(6)
    v_mfma_f32_16x16x32_bf16 v[84:87], v[132:135], v[56:59], v[84:87]
    v_xor_b32 v145, s89, v145
    ds_read_b64_tr_b16 v[116:117], v145 offset:0
    v_mfma_f32_16x16x32_bf16 v[100:103], v[132:135], v[60:63], v[100:103]
    ds_read_b64_tr_b16 v[118:119], v145 offset:2048
    s_waitcnt lgkmcnt(6)
    v_mfma_f32_16x16x32_bf16 v[88:91], v[136:139], v[56:59], v[88:91]
    v_xor_b32 v146, s89, v146
    ds_read_b64_tr_b16 v[120:121], v146 offset:0
    v_mfma_f32_16x16x32_bf16 v[104:107], v[136:139], v[60:63], v[104:107]
    ds_read_b64_tr_b16 v[122:123], v146 offset:2048
    s_waitcnt lgkmcnt(6)
    v_mfma_f32_16x16x32_bf16 v[92:95], v[140:143], v[56:59], v[92:95]
    v_xor_b32 v147, s89, v147
    ds_read_b64_tr_b16 v[124:125], v147 offset:0
    v_mfma_f32_16x16x32_bf16 v[108:111], v[140:143], v[60:63], v[108:111]
    ds_read_b64_tr_b16 v[126:127], v147 offset:2048
    buffer_load_dwordx4 v[24:27], v157, s[16:19], s91 offen offset:1024 sc1
    buffer_load_dwordx4 v[28:31], v158, s[16:19], s91 offen offset:1024 sc1
    s_setprio 0
    s_waitcnt vmcnt(6) lgkmcnt(6)
L_b_c6:
    v_max_u32 v4, v67, v71
    v_cmp_eq_u32 vcc, -1, v4
    s_cbranch_vccnz L_b_g6
L_b_d6:
    v_mfma_f32_16x16x32_bf16 v[80:83], v[112:115], v[64:67], v[80:83]
    ds_read_b64_tr_b16 v[128:129], v144 offset:4096
    v_mfma_f32_16x16x32_bf16 v[96:99], v[112:115], v[68:71], v[96:99]
    ds_read_b64_tr_b16 v[130:131], v144 offset:6144
    s_waitcnt lgkmcnt(6)
    v_mfma_f32_16x16x32_bf16 v[84:87], v[116:119], v[64:67], v[84:87]
    ds_read_b64_tr_b16 v[132:133], v145 offset:4096
    v_mfma_f32_16x16x32_bf16 v[100:103], v[116:119], v[68:71], v[100:103]
    ds_read_b64_tr_b16 v[134:135], v145 offset:6144
    s_waitcnt lgkmcnt(6)
    v_mfma_f32_16x16x32_bf16 v[88:91], v[120:123], v[64:67], v[88:91]
    ds_read_b64_tr_b16 v[136:137], v146 offset:4096
    v_mfma_f32_16x16x32_bf16 v[104:107], v[120:123], v[68:71], v[104:107]
    ds_read_b64_tr_b16 v[138:139], v146 offset:6144
    s_waitcnt lgkmcnt(6)
    v_mfma_f32_16x16x32_bf16 v[92:95], v[124:127], v[64:67], v[92:95]
    ds_read_b64_tr_b16 v[140:141], v147 offset:4096
    v_mfma_f32_16x16x32_bf16 v[108:111], v[124:127], v[68:71], v[108:111]
    ds_read_b64_tr_b16 v[142:143], v147 offset:6144
    s_not_b32 s91, s66
    s_cmp_eq_u32 s65, 0
    s_cselect_b32 s65, s91, s65
    s_cselect_b32 s66, -1, s66
    s_ff1_i32_b32 s91, s65
    s_bitset0_b32 s65, s91
    s_lshl_b32 s77, s91, 12
    s_lshl_b32 s91, s91, 10
    buffer_load_dwordx4 v[32:35], v157, s[16:19], s91 offen offset:0 sc1
    buffer_load_dwordx4 v[36:39], v158, s[16:19], s91 offen offset:0 sc1
    s_waitcnt vmcnt(6) lgkmcnt(6)
L_b_c7:
    v_max_u32 v4, v75, v79
    v_cmp_eq_u32 vcc, -1, v4
    s_cbranch_vccnz L_b_g7
L_b_d7:
    v_mfma_f32_16x16x32_bf16 v[80:83], v[128:131], v[72:75], v[80:83]
    s_xor_b32 s89, s67, s76
    s_mov_b32 s67, s76
    v_xor_b32 v144, s89, v144
    ds_read_b64_tr_b16 v[112:113], v144 offset:0
    v_mfma_f32_16x16x32_bf16 v[96:99], v[128:131], v[76:79], v[96:99]
    ds_read_b64_tr_b16 v[114:115], v144 offset:2048
    s_waitcnt lgkmcnt(6)
    v_mfma_f32_16x16x32_bf16 v[84:87], v[132:135], v[72:75], v[84:87]
    v_xor_b32 v145, s89, v145
    ds_read_b64_tr_b16 v[116:117], v145 offset:0
    v_mfma_f32_16x16x32_bf16 v[100:103], v[132:135], v[76:79], v[100:103]
    ds_read_b64_tr_b16 v[118:119], v145 offset:2048
    s_waitcnt lgkmcnt(6)
    v_mfma_f32_16x16x32_bf16 v[88:91], v[136:139], v[72:75], v[88:91]
    v_xor_b32 v146, s89, v146
    ds_read_b64_tr_b16 v[120:121], v146 offset:0
    v_mfma_f32_16x16x32_bf16 v[104:107], v[136:139], v[76:79], v[104:107]
    ds_read_b64_tr_b16 v[122:123], v146 offset:2048
    s_waitcnt lgkmcnt(6)
    v_mfma_f32_16x16x32_bf16 v[92:95], v[140:143], v[72:75], v[92:95]
    v_xor_b32 v147, s89, v147
    ds_read_b64_tr_b16 v[124:125], v147 offset:0
    v_mfma_f32_16x16x32_bf16 v[108:111], v[140:143], v[76:79], v[108:111]
    ds_read_b64_tr_b16 v[126:127], v147 offset:2048
    buffer_load_dwordx4 v[40:43], v157, s[16:19], s91 offen offset:1024 sc1
    buffer_load_dwordx4 v[44:47], v158, s[16:19], s91 offen offset:1024 sc1
    s_waitcnt vmcnt(6) lgkmcnt(6)
L_b_c8:
    v_max_u32 v4, v19, v23
    v_cmp_eq_u32 vcc, -1, v4
    s_cbranch_vccnz L_b_g8
L_b_d8:
    v_mfma_f32_16x16x32_bf16 v[80:83], v[112:115], v[16:19], v[80:83]
    ds_read_b64_tr_b16 v[128:129], v144 offset:4096
    v_mfma_f32_16x16x32_bf16 v[96:99], v[112:115], v[20:23], v[96:99]
    ds_read_b64_tr_b16 v[130:131], v144 offset:6144
    s_waitcnt lgkmcnt(6)
    v_mfma_f32_16x16x32_bf16 v[84:87], v[116:119], v[16:19], v[84:87]
    ds_read_b64_tr_b16 v[132:133], v145 offset:4096
    v_mfma_f32_16x16x32_bf16 v[100:103], v[116:119], v[20:23], v[100:103]
    ds_read_b64_tr_b16 v[134:135], v145 offset:6144
    s_waitcnt lgkmcnt(6)
    v_mfma_f32_16x16x32_bf16 v[88:91], v[120:123], v[16:19], v[88:91]
    ds_read_b64_tr_b16 v[136:137], v146 offset:4096
    v_mfma_f32_16x16x32_bf16 v[104:107], v[120:123], v[20:23], v[104:107]
    ds_read_b64_tr_b16 v[138:139], v146 offset:6144
    s_waitcnt lgkmcnt(6)
    v_mfma_f32_16x16x32_bf16 v[92:95], v[124:127], v[16:19], v[92:95]
    ds_read_b64_tr_b16 v[140:141], v147 offset:4096
    v_mfma_f32_16x16x32_bf16 v[108:111], v[124:127], v[20:23], v[108:111]
    ds_read_b64_tr_b16 v[142:143], v147 offset:6144
    s_not_b32 s91, s66
    s_cmp_eq_u32 s65, 0
    s_cselect_b32 s65, s91, s65
    s_cselect_b32 s66, -1, s66
    s_ff1_i32_b32 s91, s65
    s_bitset0_b32 s65, s91
    s_lshl_b32 s78, s91, 12
    s_lshl_b32 s91, s91, 10
    buffer_load_dwordx4 v[48:51], v157, s[16:19], s91 offen offset:0 sc1
    buffer_load_dwordx4 v[52:55], v158, s[16:19], s91 offen offset:0 sc1
    s_waitcnt vmcnt(6) lgkmcnt(6)
L_b_c9:
    v_max_u32 v4, v27, v31
    v_cmp_eq_u32 vcc, -1, v4
    s_cbranch_vccnz L_b_g9
L_walk_17:
    s_cbranch_execz L_walk_21
L_b_d9:
    v_mfma_f32_16x16x32_bf16 v[80:83], v[128:131], v[24:27], v[80:83]
    s_xor_b32 s89, s67, s77
    s_mov_b32 s67, s77
    v_xor_b32 v144, s89, v144
    ds_read_b64_tr_b16 v[112:113], v144 offset:0
    v_mfma_f32_16x16x32_bf16 v[96:99], v[128:131], v[28:31], v[96:99]
    ds_read_b64_tr_b16 v[114:115], v144 offset:2048
    s_waitcnt lgkmcnt(6)
    v_mfma_f32_16x16x32_bf16 v[84:87], v[132:135], v[24:27], v[84:87]
    v_xor_b32 v145, s89, v145
    ds_read_b64_tr_b16 v[116:117], v145 offset:0
    v_mfma_f32_16x16x32_bf16 v[100:103], v[132:135], v[28:31], v[100:103]
    ds_read_b64_tr_b16 v[118:119], v145 offset:2048
    s_waitcnt lgkmcnt(6)
    v_mfma_f32_16x16x32_bf16 v[88:91], v[136:139], v[24:27], v[88:91]
    v_xor_b32 v146, s89, v146
    ds_read_b64_tr_b16 v[120:121], v146 offset:0
    v_mfma_f32_16x16x32_bf16 v[104:107], v[136:139], v[28:31], v[104:107]
    ds_read_b64_tr_b16 v[122:123], v146 offset:2048
    s_waitcnt lgkmcnt(6)
    v_mfma_f32_16x16x32_bf16 v[92:95], v[140:143], v[24:27], v[92:95]
    v_xor_b32 v147, s89, v147
    ds_read_b64_tr_b16 v[124:125], v147 offset:0
    v_mfma_f32_16x16x32_bf16 v[108:111], v[140:143], v[28:31], v[108:111]
    ds_read_b64_tr_b16 v[126:127], v147 offset:2048
    buffer_load_dwordx4 v[56:59], v157, s[16:19], s91 offen offset:1024 sc1
    buffer_load_dwordx4 v[60:63], v158, s[16:19], s91 offen offset:1024 sc1
    s_waitcnt vmcnt(6) lgkmcnt(6)
L_b_c10:
    v_max_u32 v4, v35, v39
    v_cmp_eq_u32 vcc, -1, v4
    s_cbranch_vccnz L_b_g10
L_b_d10:
    v_mfma_f32_16x16x32_bf16 v[80:83], v[112:115], v[32:35], v[80:83]
    ds_read_b64_tr_b16 v[128:129], v144 offset:4096
    v_mfma_f32_16x16x32_bf16 v[96:99], v[112:115], v[36:39], v[96:99]
    ds_read_b64_tr_b16 v[130:131], v144 offset:6144
    s_waitcnt lgkmcnt(6)
    v_mfma_f32_16x16x32_bf16 v[84:87], v[116:119], v[32:35], v[84:87]
    ds_read_b64_tr_b16 v[132:133], v145 offset:4096
    v_mfma_f32_16x16x32_bf16 v[100:103], v[116:119], v[36:39], v[100:103]
    ds_read_b64_tr_b16 v[134:135], v145 offset:6144
    s_waitcnt lgkmcnt(6)
    v_mfma_f32_16x16x32_bf16 v[88:91], v[120:123], v[32:35], v[88:91]
    ds_read_b64_tr_b16 v[136:137], v146 offset:4096
    v_mfma_f32_16x16x32_bf16 v[104:107], v[120:123], v[36:39], v[104:107]
    ds_read_b64_tr_b16 v[138:139], v146 offset:6144
    s_waitcnt lgkmcnt(6)
    v_mfma_f32_16x16x32_bf16 v[92:95], v[124:127], v[32:35], v[92:95]
    ds_read_b64_tr_b16 v[140:141], v147 offset:4096
    v_mfma_f32_16x16x32_bf16 v[108:111], v[124:127], v[36:39], v[108:111]
    ds_read_b64_tr_b16 v[142:143], v147 offset:6144
    s_not_b32 s91, s66
    s_or_b32 s65, s65, s91
    s_ff1_i32_b32 s91, s65
    s_bitset0_b32 s65, s91
    s_lshl_b32 s79, s91, 12
    s_lshl_b32 s91, s91, 10
    buffer_load_dwordx4 v[64:67], v157, s[16:19], s91 offen offset:0 sc1
    buffer_load_dwordx4 v[68:71], v158, s[16:19], s91 offen offset:0 sc1
    s_waitcnt vmcnt(6) lgkmcnt(6)
L_b_c11:
    v_max_u32 v4, v43, v47
    v_cmp_eq_u32 vcc, -1, v4
    s_cbranch_vccnz L_b_g11
L_b_d11:
    v_mfma_f32_16x16x32_bf16 v[80:83], v[128:131], v[40:43], v[80:83]
    s_xor_b32 s89, s67, s78
    s_mov_b32 s67, s78
    v_xor_b32 v144, s89, v144
    ds_read_b64_tr_b16 v[112:113], v144 offset:0
    v_mfma_f32_16x16x32_bf16 v[96:99], v[128:131], v[44:47], v[96:99]
    ds_read_b64_tr_b16 v[114:115], v144 offset:2048
    s_waitcnt lgkmcnt(6)
    v_mfma_f32_16x16x32_bf16 v[84:87], v[132:135], v[40:43], v[84:87]
    v_xor_b32 v145, s89, v145
    ds_read_b64_tr_b16 v[116:117], v145 offset:0
    v_mfma_f32_16x16x32_bf16 v[100:103], v[132:135], v[44:47], v[100:103]
    ds_read_b64_tr_b16 v[118:119], v145 offset:2048
    s_waitcnt lgkmcnt(6)
    v_mfma_f32_16x16x32_bf16 v[88:91], v[136:139], v[40:43], v[88:91]
    v_xor_b32 v146, s89, v146
    ds_read_b64_tr_b16 v[120:121], v146 offset:0
    v_mfma_f32_16x16x32_bf16 v[104:107], v[136:139], v[44:47], v[104:107]
    ds_read_b64_tr_b16 v[122:123], v146 offset:2048
    s_waitcnt lgkmcnt(6)
    v_mfma_f32_16x16x32_bf16 v[92:95], v[140:143], v[40:43], v[92:95]
    v_xor_b32 v147, s89, v147
    ds_read_b64_tr_b16 v[124:125], v147 offset:0
    v_mfma_f32_16x16x32_bf16 v[108:111], v[140:143], v[44:47], v[108:111]
    ds_read_b64_tr_b16 v[126:127], v147 offset:2048
    buffer_load_dwordx4 v[72:75], v157, s[16:19], s91 offen offset:1024 sc1
    buffer_load_dwordx4 v[76:79], v158, s[16:19], s91 offen offset:1024 sc1
    s_waitcnt vmcnt(6) lgkmcnt(6)
L_b_c12:
    v_max_u32 v4, v51, v55
    v_cmp_eq_u32 vcc, -1, v4
    s_cbranch_vccnz L_b_g12
L_b_d12:
    v_mfma_f32_16x16x32_bf16 v[80:83], v[112:115], v[48:51], v[80:83]
    ds_read_b64_tr_b16 v[128:129], v144 offset:4096
    v_mfma_f32_16x16x32_bf16 v[96:99], v[112:115], v[52:55], v[96:99]
    ds_read_b64_tr_b16 v[130:131], v144 offset:6144
    s_waitcnt lgkmcnt(6)
    v_mfma_f32_16x16x32_bf16 v[84:87], v[116:119], v[48:51], v[84:87]
    ds_read_b64_tr_b16 v[132:133], v145 offset:4096
    v_mfma_f32_16x16x32_bf16 v[100:103], v[116:119], v[52:55], v[100:103]
    ds_read_b64_tr_b16 v[134:135], v145 offset:6144
    s_waitcnt lgkmcnt(6)
    v_mfma_f32_16x16x32_bf16 v[88:91], v[120:123], v[48:51], v[88:91]
    ds_read_b64_tr_b16 v[136:137], v146 offset:4096
    v_mfma_f32_16x16x32_bf16 v[104:107], v[120:123], v[52:55], v[104:107]
    ds_read_b64_tr_b16 v[138:139], v146 offset:6144
    s_waitcnt lgkmcnt(6)
    v_mfma_f32_16x16x32_bf16 v[92:95], v[124:127], v[48:51], v[92:95]
    ds_read_b64_tr_b16 v[140:141], v147 offset:4096
    v_mfma_f32_16x16x32_bf16 v[108:111], v[124:127], v[52:55], v[108:111]
    ds_read_b64_tr_b16 v[142:143], v147 offset:6144
    s_waitcnt vmcnt(4) lgkmcnt(6)
L_b_c13:
    v_max_u32 v4, v59, v63
    v_cmp_eq_u32 vcc, -1, v4
    s_cbranch_vccnz L_b_g13
L_b_d13:
    v_mfma_f32_16x16x32_bf16 v[80:83], v[128:131], v[56:59], v[80:83]
    s_xor_b32 s89, s67, s79
    s_mov_b32 s67, s79
    v_xor_b32 v144, s89, v144
    ds_read_b64_tr_b16 v[112:113], v144 offset:0
    v_mfma_f32_16x16x32_bf16 v[96:99], v[128:131], v[60:63], v[96:99]
    ds_read_b64_tr_b16 v[114:115], v144 offset:2048
    s_waitcnt lgkmcnt(6)
    v_mfma_f32_16x16x32_bf16 v[84:87], v[132:135], v[56:59], v[84:87]
    v_xor_b32 v145, s89, v145
    ds_read_b64_tr_b16 v[116:117], v145 offset:0
    v_mfma_f32_16x16x32_bf16 v[100:103], v[132:135], v[60:63], v[100:103]
    ds_read_b64_tr_b16 v[118:119], v145 offset:2048
    s_waitcnt lgkmcnt(6)
    v_mfma_f32_16x16x32_bf16 v[88:91], v[136:139], v[56:59], v[88:91]
    v_xor_b32 v146, s89, v146
    ds_read_b64_tr_b16 v[120:121], v146 offset:0
    v_mfma_f32_16x16x32_bf16 v[104:107], v[136:139], v[60:63], v[104:107]
    ds_read_b64_tr_b16 v[122:123], v146 offset:2048
    s_waitcnt lgkmcnt(6)
    v_mfma_f32_16x16x32_bf16 v[92:95], v[140:143], v[56:59], v[92:95]
    v_xor_b32 v147, s89, v147
    ds_read_b64_tr_b16 v[124:125], v147 offset:0
    v_mfma_f32_16x16x32_bf16 v[108:111], v[140:143], v[60:63], v[108:111]
    ds_read_b64_tr_b16 v[126:127], v147 offset:2048
    s_waitcnt vmcnt(2) lgkmcnt(6)
L_b_c14:
    v_max_u32 v4, v67, v71
    v_cmp_eq_u32 vcc, -1, v4
    s_cbranch_vccnz L_b_g14
L_b_d14:
    v_mfma_f32_16x16x32_bf16 v[80:83], v[112:115], v[64:67], v[80:83]
    ds_read_b64_tr_b16 v[128:129], v144 offset:4096
    v_mfma_f32_16x16x32_bf16 v[96:99], v[112:115], v[68:71], v[96:99]
    ds_read_b64_tr_b16 v[130:131], v144 offset:6144
    s_waitcnt lgkmcnt(6)
    v_mfma_f32_16x16x32_bf16 v[84:87], v[116:119], v[64:67], v[84:87]
    ds_read_b64_tr_b16 v[132:133], v145 offset:4096
    v_mfma_f32_16x16x32_bf16 v[100:103], v[116:119], v[68:71], v[100:103]
    ds_read_b64_tr_b16 v[134:135], v145 offset:6144
    s_waitcnt lgkmcnt(6)
    v_mfma_f32_16x16x32_bf16 v[88:91], v[120:123], v[64:67], v[88:91]
    ds_read_b64_tr_b16 v[136:137], v146 offset:4096
    v_mfma_f32_16x16x32_bf16 v[104:107], v[120:123], v[68:71], v[104:107]
    ds_read_b64_tr_b16 v[138:139], v146 offset:6144
    s_waitcnt lgkmcnt(6)
    v_mfma_f32_16x16x32_bf16 v[92:95], v[124:127], v[64:67], v[92:95]
    ds_read_b64_tr_b16 v[140:141], v147 offset:4096
    v_mfma_f32_16x16x32_bf16 v[108:111], v[124:127], v[68:71], v[108:111]
    ds_read_b64_tr_b16 v[142:143], v147 offset:6144
    s_waitcnt vmcnt(0) lgkmcnt(6)
L_b_c15:
    v_max_u32 v4, v75, v79
    v_cmp_eq_u32 vcc, -1, v4
    s_cbranch_vccnz L_b_g15
L_b_d15:
    v_cmp_eq_u32 vcc, -1, v156
L_walk_18:
    s_cbranch_execz L_walk_22
    s_cbranch_vccz L_ok_3
    s_sub_u32 s56, s56, 1
    s_cbranch_scc0 L_b_restart
    s_mov_b32 s56, 0
L_ok_3:
    v_mfma_f32_16x16x32_bf16 v[80:83], v[128:131], v[72:75], v[80:83]
    s_mov_b32 s90, 71680
    buffer_load_dwordx4 v[204:207], v11, s[32:35], s90 offen
    v_mfma_f32_16x16x32_bf16 v[96:99], v[128:131], v[76:79], v[96:99]
    s_mov_b32 s90, 78848
    buffer_load_dwordx4 v[208:211], v11, s[32:35], s90 offen
    s_waitcnt lgkmcnt(4)
    v_mfma_f32_16x16x32_bf16 v[84:87], v[132:135], v[72:75], v[84:87]
    v_mfma_f32_16x16x32_bf16 v[100:103], v[132:135], v[76:79], v[100:103]
    s_mov_b32 s90, 86016
    buffer_load_dwordx4 v[212:215], v11, s[32:35], s90 offen
    s_waitcnt lgkmcnt(2)
    v_mfma_f32_16x16x32_bf16 v[88:91], v[136:139], v[72:75], v[88:91]
    s_mov_b32 s90, 93184
    buffer_load_dwordx4 v[216:219], v11, s[32:35], s90 offen
    v_mfma_f32_16x16x32_bf16 v[104:107], v[136:139], v[76:79], v[104:107]
    s_mov_b32 s90, 100352
    buffer_load_dwordx4 v[220:223], v11, s[32:35], s90 offen
    s_waitcnt lgkmcnt(0)
    v_mfma_f32_16x16x32_bf16 v[92:95], v[140:143], v[72:75], v[92:95]
    v_mfma_f32_16x16x32_bf16 v[108:111], v[140:143], v[76:79], v[108:111]
    s_mov_b32 s90, 107520
    buffer_load_dwordx4 v[224:227], v11, s[32:35], s90 offen
    ds_write_b128 v162, v[96:99] offset:0
    ds_write_b128 v162, v[100:103] offset:1024
    ds_write_b128 v162, v[104:107] offset:2048
    s_nop 2
    ds_write_b128 v162, v[108:111] offset:3072
    s_waitcnt lgkmcnt(0)
    s_barrier
    ds_read_b128 v[16:19], v163 offset:0
    ds_read_b128 v[20:23], v163 offset:1024
    ds_read_b128 v[24:27], v163 offset:2048
    ds_read_b128 v[28:31], v163 offset:3072
    s_waitcnt lgkmcnt(3)
    v_pk_add_f32 v[80:81], v[80:81], v[16:17]
    v_pk_add_f32 v[82:83], v[82:83], v[18:19]
    v_cvt_pk_bf16_f32 v32, v80, v81
    v_cvt_pk_bf16_f32 v33, v82, v83
    s_waitcnt lgkmcnt(2)
    v_pk_add_f32 v[84:85], v[84:85], v[20:21]
    v_pk_add_f32 v[86:87], v[86:87], v[22:23]
    v_cvt_pk_bf16_f32 v34, v84, v85
    v_cvt_pk_bf16_f32 v35, v86, v87
    s_waitcnt lgkmcnt(1)
    v_pk_add_f32 v[88:89], v[88:89], v[24:25]
    v_pk_add_f32 v[90:91], v[90:91], v[26:27]
    v_cvt_pk_bf16_f32 v36, v88, v89
    v_cvt_pk_bf16_f32 v37, v90, v91
    s_waitcnt lgkmcnt(0)
    v_pk_add_f32 v[92:93], v[92:93], v[28:29]
    v_pk_add_f32 v[94:95], v[94:95], v[30:31]
    v_cvt_pk_bf16_f32 v38, v92, v93
    v_cvt_pk_bf16_f32 v39, v94, v95
    v_mfma_f32_16x16x32_bf16 v[60:63], v[32:35], v[32:35], 0
    v_mfma_f32_16x16x32_bf16 v[56:59], v[32:35], v[148:151], 0
    v_mfma_f32_16x16x32_bf16 v[60:63], v[36:39], v[36:39], v[60:63]
    v_mfma_f32_16x16x32_bf16 v[56:59], v[36:39], v[152:155], v[56:59]
    v_lshlrev_b32 v40, 16, v32
    v_and_b32 v41, 0xffff0000, v32
    v_lshlrev_b32 v42, 16, v33
    v_and_b32 v43, 0xffff0000, v33
    v_lshlrev_b32 v44, 16, v34
    v_and_b32 v45, 0xffff0000, v34
    s_nop 1
    v_cndmask_b32 v56, v56, v60, s[72:73]
    v_cndmask_b32 v57, v57, v61, s[72:73]
    v_cndmask_b32 v58, v58, v62, s[72:73]
    v_cndmask_b32 v59, v59, v63, s[72:73]
    v_cndmask_b32 v56, v56, v57, s[4:5]
    v_cndmask_b32 v58, v58, v59, s[98:99]
    s_or_b64 vcc, s[6:7], s[98:99]
    v_cndmask_b32 v56, v56, v58, vcc
    v_cndmask_b32 v56, v56, 1.0, s[74:75]
    v_mov_b32 v67, v56
    buffer_atomic_add_f32 v67, v160, s[16:19], 0 offen sc0 sc1
    s_mov_b32 s90, 0
    buffer_load_dwordx4 v[228:231], v14, s[36:39], s90 offen
    s_mov_b32 s90, 2048
    buffer_load_dwordx4 v[232:235], v14, s[36:39], s90 offen
    s_mov_b32 s90, 4096
    buffer_load_dwordx4 v[236:239], v14, s[36:39], s90 offen
    s_lshl_b32 s86, s3, 11
    s_add_u32 s86, s86, 69632
    v_lshl_add_u32 v150, v0, 4, s86
    ds_write_b128 v150, v[32:35]
    ds_write_b128 v150, v[36:39] offset:1024
    s_lshl_b32 s86, s3, 7
    s_add_u32 s86, s86, 66560
    v_lshl_add_u32 v151, v2, 3, s86
    s_cmp_eq_u32 s62, 0
    s_cbranch_scc1 L_unp
    v_and_b32 v24, 1, v0
    v_cmp_eq_u32 vcc, 1, v24
    v_mov_b32 v24, 0x0c0c0100
    v_mov_b32 v25, 0x01000c0c
    v_cndmask_b32 v16, v24, v25, vcc
    v_mov_b32 v24, 0x0c0c0302
    v_mov_b32 v25, 0x03020c0c
    v_cndmask_b32 v17, v24, v25, vcc
    v_bfe_u32 v24, v0, 1, 2
    v_mov_b32 v25, 0x0c0c0c0c
    v_cmp_eq_u32 vcc, 0, v24
    s_nop 1
    v_cndmask_b32 v72, v25, v16, vcc
    v_cndmask_b32 v76, v25, v17, vcc
    v_cmp_eq_u32 vcc, 1, v24
    s_nop 1
    v_cndmask_b32 v73, v25, v16, vcc
    v_cndmask_b32 v77, v25, v17, vcc
    v_cmp_eq_u32 vcc, 2, v24
    s_nop 1
    v_cndmask_b32 v74, v25, v16, vcc
    v_cndmask_b32 v78, v25, v17, vcc
    v_cmp_eq_u32 vcc, 3, v24
    s_nop 1
    v_cndmask_b32 v75, v25, v16, vcc
    v_cndmask_b32 v79, v25, v17, vcc
    s_lshl_b32 s86, s48, 10
    s_add_u32 s86, s86, 90112
    v_lshl_add_u32 v18, v0, 4, s86
    s_and_b32 s86, s48, 1
    s_cselect_b32 s87, s81, s80
    s_lshr_b32 s90, s48, 1
    s_and_b32 s88, s82, 1
    s_and_b32 s89, s82, 6
    s_lshl3_add_u32 s88, s88, s89
    s_add_u32 s88, s88, s90
    s_mul_i32 s88, s88, 56
    s_add_u32 s88, s88, s87
    s_lshl_b32 s88, s88, 8
    s_add_u32 s88, s88, 7864320
    s_cmp_lt_u32 s87, 56
    s_cselect_b32 s88, s88, 2147483648
    v_lshl_add_u32 v131, v0, 2, s88
    s_lshl2_add_u32 s86, s90, s86
    s_lshl_b32 s86, s86, 7
    s_add_u32 s86, s86, 90112
    v_lshrrev_b32 v16, 3, v0
    v_lshl_add_u32 v133, v16, 4, s86
    v_bfe_u32 v17, v0, 2, 1
    v_lshl_add_u32 v133, v17, 8, v133
    v_and_b32 v17, 3, v0
    v_lshl_add_u32 v133, v17, 2, v133
    s_lshr_b32 s86, s82, 3
    s_lshl2_add_u32 s86, s86, s48
    s_mul_i32 s86, s86, 112
    s_add_u32 s86, s86, 7864320
    v_mul_u32_u24 v16, 14336, v16
    v_and_b32 v17, 7, v0
    v_lshl_add_u32 v137, v17, 4, s86
    v_add_u32 v137, v137, v16
    v_mov_b32 v16, 2147483648
    v_cmp_eq_u32 vcc, 7, v17
    s_nop 1
    v_cndmask_b32 v137, v137, v16, vcc
    s_branch L_unpd
L_unp:
    v_lshlrev_b32 v46, 16, v35
    v_and_b32 v47, 0xffff0000, v35
    v_lshlrev_b32 v48, 16, v36
    v_and_b32 v49, 0xffff0000, v36
    v_lshlrev_b32 v50, 16, v37
    v_and_b32 v51, 0xffff0000, v37
    v_lshlrev_b32 v52, 16, v38
    v_and_b32 v53, 0xffff0000, v38
    v_lshlrev_b32 v54, 16, v39
    v_and_b32 v55, 0xffff0000, v39
L_unpd:
    v_lshrrev_b32 v8, 2, v2
    v_lshlrev_b32 v9, 4, v8
    v_sub_u32 v9, v161, v9
    v_cmp_eq_u32 vcc, 0, v8
L_walk_19:
    s_cbranch_execz L_walk_23
    s_nop 1
    v_cndmask_b32 v10, 0, 32, vcc
    v_add_u32 v10, v9, v10
    v_cmp_eq_u32 vcc, 1, v8
    s_nop 1
    v_cndmask_b32 v8, 16, 48, vcc
    v_add_u32 v9, v9, v8
    s_lshl_b32 s86, s52, 11
    s_lshr_b32 s87, s51, 3
    s_lshl_b32 s87, s87, 6
    s_add_u32 s86, s86, s87
    s_and_b32 s87, s51, 7
    s_lshl3_add_u32 s86, s87, s86
    s_add_u32 s86, s86, 6684672
    v_lshl_add_u32 v149, v0, 7, s86
    v_mov_b32 v8, 2147483648
    v_cmp_gt_u32 vcc, 16, v0
    s_nop 1
    v_cndmask_b32 v149, v8, v149, vcc
    s_bfe_u32 s67, s82, 0x20001
    s_lshl2_add_u32 s67, s67, s48
    s_and_b32 s87, s2, 15
    s_lshl_b32 s86, s67, 4
    s_add_u32 s86, s86, s87
    s_lshl_b32 s86, s86, 7
    s_add_u32 s86, s86, 6684672
    v_lshl_add_u32 v148, v0, 3, s86
    v_mov_b32 v8, 2147483648
    v_cmp_gt_u32 vcc, 16, v0
    s_nop 1
    v_cndmask_b32 v148, v8, v148, vcc
    s_lshl_b32 s67, s67, 7
    s_add_u32 s67, s67, 6619136
    s_waitcnt vmcnt(3)
    v_add_f32 v67, v67, v56
    s_branch L_h3_chk
L_h3:
    v_mov_b32 v67, 0
    buffer_atomic_or v67, v160, s[16:19], 0 offen sc0 sc1
    s_waitcnt vmcnt(0)
L_h3_chk:
    v_cmp_ne_u32 vcc, 0x41800000, v67
    s_nop 0
    s_and_b64 vcc, vcc, s[74:75]
    s_cbranch_vccz L_ok_4
    s_sub_u32 s56, s56, 1
    s_cbranch_scc0 L_h3
    s_mov_b32 s56, 0
L_ok_4:
    ds_bpermute_b32 v64, v10, v67
    ds_bpermute_b32 v66, v161, v67
    ds_bpermute_b32 v65, v9, v67
    s_cmp_eq_u32 s62, 0
    s_cbranch_scc1 L_nop0
    v_mov_b32 v128, 0
    v_mov_b32 v129, 0
    buffer_atomic_or_x2 v[128:129], v148, s[16:19], 0 offen sc0 sc1
L_nop0:
    s_waitcnt lgkmcnt(0)
    v_mul_f32 v64, 0x3a800000, v64
    v_mul_f32 v66, 0x3a800000, v66
    v_fma_f32 v66, -v64, v64, v66
    v_max_f32 v66, 0, v66
    v_cvt_pk_bf16_f32 v69, v64, v66
    v_lshlrev_b32 v68, 16, v69
    v_and_b32 v69, 0xffff0000, v69
    v_add_f32 v69, 0x3727c5ac, v69
    v_cvt_pk_bf16_f32 v69, v69, v69
    v_lshlrev_b32 v69, 16, v69
    v_sqrt_f32 v69, v69
    s_nop 0
    v_cvt_pk_bf16_f32 v69, v69, v69
    v_lshlrev_b32 v69, 16, v69
    v_rcp_f32 v70, v69
    v_fma_f32 v12, -v68, s57, v65
    v_mul_f32 v12, v12, v70
    v_mul_f32 v71, -v68, v70
    v_cvt_pk_bf16_f32 v12, v12, v12
    v_ashrrev_i32 v8, 31, v12
    v_or_b32 v8, 0x80000000, v8
    v_xor_b32 v8, v8, v12
    v_and_b32 v8, 4294901760, v8
    v_or_b32 v13, v8, v6
    s_lshl_b32 s86, s3, 6
    s_add_u32 s86, s86, 65536
    v_lshl_add_u32 v8, v2, 2, s86
    ds_write_b32 v8, v13
    ds_write_b64 v151, v[70:71]
    v_mov_b32 v152, v8
    s_cmp_lg_u32 s62, 0
    s_cbranch_scc1 L_nohn
    v_pk_fma_f32 v[16:17], v[40:41], v[70:71], v[70:71] op_sel:[0,0,1] op_sel_hi:[1,0,1]
    v_pk_fma_f32 v[18:19], v[42:43], v[70:71], v[70:71] op_sel:[0,0,1] op_sel_hi:[1,0,1]
    v_pk_fma_f32 v[20:21], v[44:45], v[70:71], v[70:71] op_sel:[0,0,1] op_sel_hi:[1,0,1]
    v_pk_fma_f32 v[22:23], v[46:47], v[70:71], v[70:71] op_sel:[0,0,1] op_sel_hi:[1,0,1]
    v_pk_fma_f32 v[24:25], v[48:49], v[70:71], v[70:71] op_sel:[0,0,1] op_sel_hi:[1,0,1]
    v_pk_fma_f32 v[26:27], v[50:51], v[70:71], v[70:71] op_sel:[0,0,1] op_sel_hi:[1,0,1]
    v_pk_fma_f32 v[28:29], v[52:53], v[70:71], v[70:71] op_sel:[0,0,1] op_sel_hi:[1,0,1]
    v_pk_fma_f32 v[30:31], v[54:55], v[70:71], v[70:71] op_sel:[0,0,1] op_sel_hi:[1,0,1]
L_nohn:
    v_lshlrev_b32 v8, 3, v0
    v_add_u32 v8, 65536, v8
    s_waitcnt lgkmcnt(0)
    s_barrier
    ds_read_b64 v[64:65], v8
    s_cmp_lg_u32 s62, 0
    s_cbranch_scc1 L_t3_ld
    ds_read_b32 v144, v152 offset:256
    ds_read_b64 v[142:143], v151 offset:512
    ds_read_b128 v[112:115], v150 offset:8192
    ds_read_b128 v[116:119], v150 offset:9216
    v_cvt_pk_bf16_f32 v96, v16, v17
    v_cvt_pk_bf16_f32 v97, v18, v19
    v_cvt_pk_bf16_f32 v98, v20, v21
    v_cvt_pk_bf16_f32 v99, v22, v23
    v_cvt_pk_bf16_f32 v100, v24, v25
    v_cvt_pk_bf16_f32 v101, v26, v27
    v_cvt_pk_bf16_f32 v102, v28, v29
    v_cvt_pk_bf16_f32 v103, v30, v31
    s_waitcnt lgkmcnt(4)
    v_max_u32 v66, v64, v65
    v_min_u32 v67, v64, v65
    s_nop 0
    v_min_u32_dpp v64, v66, v66 row_ror:8 row_mask:0xf bank_mask:0xf
    v_max_u32_dpp v66, v66, v66 row_ror:8 row_mask:0xf bank_mask:0xf
    v_max_u32_dpp v65, v67, v67 row_ror:8 row_mask:0xf bank_mask:0xf
    v_max_u32 v67, v64, v65
    v_min_u32_dpp v64, v66, v66 row_ror:4 row_mask:0xf bank_mask:0xf
    v_max_u32_dpp v66, v66, v66 row_ror:4 row_mask:0xf bank_mask:0xf
    v_max_u32_dpp v65, v67, v67 row_ror:4 row_mask:0xf bank_mask:0xf
    v_max_u32 v67, v64, v65
    v_min_u32_dpp v64, v66, v66 row_ror:2 row_mask:0xf bank_mask:0xf
    v_max_u32_dpp v66, v66, v66 row_ror:2 row_mask:0xf bank_mask:0xf
    v_max_u32_dpp v65, v67, v67 row_ror:2 row_mask:0xf bank_mask:0xf
    v_max_u32 v67, v64, v65
    v_min_u32_dpp v64, v66, v66 row_ror:1 row_mask:0xf bank_mask:0xf
    v_max_u32_dpp v66, v66, v66 row_ror:1 row_mask:0xf bank_mask:0xf
    v_max_u32_dpp v65, v67, v67 row_ror:1 row_mask:0xf bank_mask:0xf
    v_max_u32 v67, v64, v65
    v_readlane_b32 s58, v66, 0
    v_readlane_b32 s59, v67, 0
    v_readlane_b32 s86, v66, 16
    v_readlane_b32 s87, v67, 16
    s_nop 0
    s_max_u32 s59, s59, s87
    s_min_u32 s87, s58, s86
    s_max_u32 s58, s58, s86
    s_max_u32 s59, s59, s87
    v_readlane_b32 s86, v66, 32
    v_readlane_b32 s87, v67, 32
    s_nop 0
    s_max_u32 s59, s59, s87
    s_min_u32 s87, s58, s86
    s_max_u32 s58, s58, s86
    s_max_u32 s59, s59, s87
    v_readlane_b32 s86, v66, 48
    v_readlane_b32 s87, v67, 48
    s_nop 0
    s_max_u32 s59, s59, s87
    s_min_u32 s87, s58, s86
    s_max_u32 s58, s58, s86
    s_max_u32 s59, s59, s87
    s_cmp_lg_u32 s3, 0
    s_cbranch_scc1 L_nokey
    v_mov_b32 v8, s58
    v_mov_b32 v9, s59
    buffer_atomic_swap_x2 v[8:9], v149, s[16:19], 0 offen sc1
L_nokey:
    v_cmp_eq_u32 s[4:5], s58, v13
    v_cmp_eq_u32 s[6:7], s59, v13
    s_nop 0
    s_or_b64 s[96:97], s[4:5], s[6:7]
    s_cbranch_scc0 L_nocand
    s_lshl_b32 s86, s51, 12
    s_lshl_b32 s87, s52, 7
    s_add_u32 s86, s86, s87
    s_add_u32 s86, s86, 6619136
    v_lshl_add_u32 v8, v1, 3, s86
    v_add_u32 v9, 2048, v8
    v_cndmask_b32 v8, v8, v9, s[6:7]
    v_mov_b32 v9, 2147483648
    v_cndmask_b32 v8, v9, v8, s[96:97]
    buffer_store_dwordx2 v[96:97], v8, s[16:19], 0 offen offset:0 sc1
    buffer_store_dwordx2 v[98:99], v8, s[16:19], 0 offen offset:32 sc1
    buffer_store_dwordx2 v[100:101], v8, s[16:19], 0 offen offset:64 sc1
    buffer_store_dwordx2 v[102:103], v8, s[16:19], 0 offen offset:96 sc1
    v_subrev_u32 v131, 65536, v8
L_nocand:
    s_waitcnt lgkmcnt(0)
L_walk_20:
    s_cbranch_execz L_walk_24
    v_lshlrev_b32 v80, 16, v112
    v_and_b32 v81, 0xffff0000, v112
    v_lshlrev_b32 v82, 16, v113
    v_and_b32 v83, 0xffff0000, v113
    v_lshlrev_b32 v84, 16, v114
    v_and_b32 v85, 0xffff0000, v114
    v_lshlrev_b32 v86, 16, v115
    v_and_b32 v87, 0xffff0000, v115
    v_lshlrev_b32 v88, 16, v116
    v_and_b32 v89, 0xffff0000, v116
    v_lshlrev_b32 v90, 16, v117
    v_and_b32 v91, 0xffff0000, v117
    v_lshlrev_b32 v92, 16, v118
    v_and_b32 v93, 0xffff0000, v118
    v_lshlrev_b32 v94, 16, v119
    v_and_b32 v95, 0xffff0000, v119
    v_pk_fma_f32 v[16:17], v[80:81], v[142:143], v[142:143] op_sel:[0,0,1] op_sel_hi:[1,0,1]
    v_pk_fma_f32 v[18:19], v[82:83], v[142:143], v[142:143] op_sel:[0,0,1] op_sel_hi:[1,0,1]
    v_pk_fma_f32 v[20:21], v[84:85], v[142:143], v[142:143] op_sel:[0,0,1] op_sel_hi:[1,0,1]
    v_pk_fma_f32 v[22:23], v[86:87], v[142:143], v[142:143] op_sel:[0,0,1] op_sel_hi:[1,0,1]
    v_pk_fma_f32 v[24:25], v[88:89], v[142:143], v[142:143] op_sel:[0,0,1] op_sel_hi:[1,0,1]
    v_pk_fma_f32 v[26:27], v[90:91], v[142:143], v[142:143] op_sel:[0,0,1] op_sel_hi:[1,0,1]
    v_pk_fma_f32 v[28:29], v[92:93], v[142:143], v[142:143] op_sel:[0,0,1] op_sel_hi:[1,0,1]
    v_pk_fma_f32 v[30:31], v[94:95], v[142:143], v[142:143] op_sel:[0,0,1] op_sel_hi:[1,0,1]
    v_cvt_pk_bf16_f32 v132, v16, v17
    v_cvt_pk_bf16_f32 v133, v18, v19
    v_cvt_pk_bf16_f32 v134, v20, v21
    v_cvt_pk_bf16_f32 v135, v22, v23
    v_cvt_pk_bf16_f32 v136, v24, v25
    v_cvt_pk_bf16_f32 v137, v26, v27
    v_cvt_pk_bf16_f32 v138, v28, v29
    v_cvt_pk_bf16_f32 v139, v30, v31
    v_cmp_eq_u32 s[4:5], s58, v144
    v_cmp_eq_u32 s[6:7], s59, v144
    s_nop 0
    s_or_b64 s[70:71], s[4:5], s[6:7]
    s_cbranch_scc0 L_nocand2
    s_lshl_b32 s86, s51, 12
    s_lshl_b32 s87, s52, 7
    s_add_u32 s86, s86, s87
    s_add_u32 s86, s86, 6619136
    v_lshl_add_u32 v8, v1, 3, s86
    v_add_u32 v9, 2048, v8
    v_cndmask_b32 v8, v8, v9, s[6:7]
    v_mov_b32 v9, 2147483648
    v_cndmask_b32 v8, v9, v8, s[70:71]
    buffer_store_dwordx2 v[132:133], v8, s[16:19], 0 offen offset:0 sc1
    buffer_store_dwordx2 v[134:135], v8, s[16:19], 0 offen offset:32 sc1
    buffer_store_dwordx2 v[136:137], v8, s[16:19], 0 offen offset:64 sc1
    buffer_store_dwordx2 v[138:139], v8, s[16:19], 0 offen offset:96 sc1
    v_subrev_u32 v140, 65536, v8
L_nocand2:
    v_mov_b32 v9, 2147483648
    v_xor_b32 v6, 0x8000, v5
    v_lshlrev_b32 v16, 16, v96
    v_and_b32 v17, 0xffff0000, v96
    v_lshlrev_b32 v18, 16, v97
    v_and_b32 v19, 0xffff0000, v97
    v_lshlrev_b32 v20, 16, v98
    v_and_b32 v21, 0xffff0000, v98
    v_lshlrev_b32 v22, 16, v99
    v_and_b32 v23, 0xffff0000, v99
    v_lshlrev_b32 v24, 16, v100
    v_and_b32 v25, 0xffff0000, v100
    v_lshlrev_b32 v26, 16, v101
    v_and_b32 v27, 0xffff0000, v101
    v_lshlrev_b32 v28, 16, v102
    v_and_b32 v29, 0xffff0000, v102
    v_lshlrev_b32 v30, 16, v103
    v_and_b32 v31, 0xffff0000, v103
    v_pk_add_f32 v[16:17], v[16:17], v[40:41]
    v_pk_add_f32 v[18:19], v[18:19], v[42:43]
    v_pk_add_f32 v[20:21], v[20:21], v[44:45]
    v_pk_add_f32 v[22:23], v[22:23], v[46:47]
    v_pk_add_f32 v[24:25], v[24:25], v[48:49]
    v_pk_add_f32 v[26:27], v[26:27], v[50:51]
    v_pk_add_f32 v[28:29], v[28:29], v[52:53]
    v_pk_add_f32 v[30:31], v[30:31], v[54:55]
    v_cvt_pk_bf16_f32 v104, v16, v17
    v_cvt_pk_bf16_f32 v105, v18, v19
    v_cvt_pk_bf16_f32 v106, v20, v21
    v_cvt_pk_bf16_f32 v107, v22, v23
    v_cvt_pk_bf16_f32 v108, v24, v25
    v_cvt_pk_bf16_f32 v109, v26, v27
    v_cvt_pk_bf16_f32 v110, v28, v29
    v_cvt_pk_bf16_f32 v111, v30, v31
    v_permlane16_swap_b32 v104, v106
    v_permlane16_swap_b32 v105, v107
    v_permlane16_swap_b32 v108, v110
    v_permlane16_swap_b32 v109, v111
    v_mov_b32 v16, v104
    v_mov_b32 v17, v105
    v_mov_b32 v18, v106
    v_mov_b32 v19, v107
    v_mov_b32_dpp v104, v108 row_ror:8 row_mask:0xf bank_mask:0xc
    v_mov_b32_dpp v105, v109 row_ror:8 row_mask:0xf bank_mask:0xc
    v_mov_b32_dpp v106, v110 row_ror:8 row_mask:0xf bank_mask:0xc
    v_mov_b32_dpp v107, v111 row_ror:8 row_mask:0xf bank_mask:0xc
    v_mov_b32_dpp v108, v16 row_ror:8 row_mask:0xf bank_mask:0x3
    v_mov_b32_dpp v109, v17 row_ror:8 row_mask:0xf bank_mask:0x3
    v_mov_b32_dpp v110, v18 row_ror:8 row_mask:0xf bank_mask:0x3
    v_mov_b32_dpp v111, v19 row_ror:8 row_mask:0xf bank_mask:0x3
    v_cndmask_b32 v8, v5, v9, s[96:97]
    v_lshlrev_b32 v16, 16, v132
    v_and_b32 v17, 0xffff0000, v132
    v_lshlrev_b32 v18, 16, v133
    v_and_b32 v19, 0xffff0000, v133
    v_lshlrev_b32 v20, 16, v134
    v_and_b32 v21, 0xffff0000, v134
    v_lshlrev_b32 v22, 16, v135
    v_and_b32 v23, 0xffff0000, v135
    v_lshlrev_b32 v24, 16, v136
    v_and_b32 v25, 0xffff0000, v136
    v_lshlrev_b32 v26, 16, v137
    v_and_b32 v27, 0xffff0000, v137
    v_lshlrev_b32 v28, 16, v138
    v_and_b32 v29, 0xffff0000, v138
    v_lshlrev_b32 v30, 16, v139
    v_and_b32 v31, 0xffff0000, v139
    v_pk_add_f32 v[16:17], v[16:17], v[80:81]
    v_pk_add_f32 v[18:19], v[18:19], v[82:83]
    v_pk_add_f32 v[20:21], v[20:21], v[84:85]
    v_pk_add_f32 v[22:23], v[22:23], v[86:87]
    v_pk_add_f32 v[24:25], v[24:25], v[88:89]
    v_pk_add_f32 v[26:27], v[26:27], v[90:91]
    v_pk_add_f32 v[28:29], v[28:29], v[92:93]
    v_pk_add_f32 v[30:31], v[30:31], v[94:95]
    v_cvt_pk_bf16_f32 v120, v16, v17
    v_cvt_pk_bf16_f32 v121, v18, v19
    v_cvt_pk_bf16_f32 v122, v20, v21
    v_cvt_pk_bf16_f32 v123, v22, v23
    v_cvt_pk_bf16_f32 v124, v24, v25
    v_cvt_pk_bf16_f32 v125, v26, v27
    v_cvt_pk_bf16_f32 v126, v28, v29
    v_cvt_pk_bf16_f32 v127, v30, v31
    v_permlane16_swap_b32 v120, v122
    v_permlane16_swap_b32 v121, v123
    v_permlane16_swap_b32 v124, v126
    v_permlane16_swap_b32 v125, v127
    v_mov_b32 v16, v120
    v_mov_b32 v17, v121
    v_mov_b32 v18, v122
    v_mov_b32 v19, v123
    v_mov_b32_dpp v120, v124 row_ror:8 row_mask:0xf bank_mask:0xc
    v_mov_b32_dpp v121, v125 row_ror:8 row_mask:0xf bank_mask:0xc
    v_mov_b32_dpp v122, v126 row_ror:8 row_mask:0xf bank_mask:0xc
    v_mov_b32_dpp v123, v127 row_ror:8 row_mask:0xf bank_mask:0xc
    v_mov_b32_dpp v124, v16 row_ror:8 row_mask:0xf bank_mask:0x3
    v_mov_b32_dpp v125, v17 row_ror:8 row_mask:0xf bank_mask:0x3
    v_mov_b32_dpp v126, v18 row_ror:8 row_mask:0xf bank_mask:0x3
    v_mov_b32_dpp v127, v19 row_ror:8 row_mask:0xf bank_mask:0x3
    s_cmp_eq_u64 s[96:97], 0
    s_cbranch_scc1 L_noha
    buffer_store_dwordx2 v[32:33], v131, s[16:19], 0 offen offset:0 sc1
    buffer_store_dwordx2 v[34:35], v131, s[16:19], 0 offen offset:32 sc1
    buffer_store_dwordx2 v[36:37], v131, s[16:19], 0 offen offset:64 sc1
    buffer_store_dwordx2 v[38:39], v131, s[16:19], 0 offen offset:96 sc1
L_noha:
    s_cmp_eq_u64 s[70:71], 0
    s_cbranch_scc1 L_nohb
    buffer_store_dwordx2 v[112:113], v140, s[16:19], 0 offen offset:0 sc1
    buffer_store_dwordx2 v[114:115], v140, s[16:19], 0 offen offset:32 sc1
    buffer_store_dwordx2 v[116:117], v140, s[16:19], 0 offen offset:64 sc1
    buffer_store_dwordx2 v[118:119], v140, s[16:19], 0 offen offset:96 sc1
L_nohb:
    v_mov_b32 v8, 66304
L_walk_21:
    s_cbranch_execz L_walked
    s_barrier
    ds_read_b64 v[10:11], v8
    s_waitcnt lgkmcnt(0)
    v_cmp_ne_u32 s[4:5], v10, v13
    v_cmp_ne_u32 s[6:7], v11, v13
    s_nop 0
    s_and_b64 s[4:5], s[4:5], s[6:7]
    v_cndmask_b32 v8, v9, v5, s[4:5]
    v_add_u32 v17, 64, v8
    v_mov_b32 v16, v8
    s_nop 1
    v_mov_b32_dpp v16, v17 row_ror:8 row_mask:0xf bank_mask:0xc
    v_mov_b32_dpp v17, v8 row_ror:8 row_mask:0xf bank_mask:0x3
    buffer_store_dwordx4 v[104:107], v16, s[24:27], 0 offen sc1
    buffer_store_dwordx4 v[108:111], v17, s[24:27], 0 offen sc1
    v_cmp_ne_u32 s[4:5], v10, v144
    v_cmp_ne_u32 s[6:7], v11, v144
    s_nop 0
    s_and_b64 s[4:5], s[4:5], s[6:7]
    v_cndmask_b32 v8, v9, v6, s[4:5]
    v_add_u32 v19, 64, v8
    v_mov_b32 v18, v8
    s_nop 1
    v_mov_b32_dpp v18, v19 row_ror:8 row_mask:0xf bank_mask:0xc
    v_mov_b32_dpp v19, v8 row_ror:8 row_mask:0xf bank_mask:0x3
    s_barrier
    s_barrier
    s_barrier
    buffer_store_dwordx4 v[120:123], v18, s[24:27], 0 offen sc1
    buffer_store_dwordx4 v[124:127], v19, s[24:27], 0 offen sc1
    s_branch L_fin
L_t3_ld:
    s_mov_b32 s90, 6144
    buffer_load_dwordx4 v[240:243], v14, s[36:39], s90 offen
    s_mov_b32 s90, 8192
    buffer_load_dwordx4 v[244:247], v14, s[36:39], s90 offen
    s_mov_b32 s90, 10240
    buffer_load_dwordx4 v[248:251], v14, s[36:39], s90 offen
    s_mov_b32 s90, 12288
    buffer_load_dwordx4 v[252:255], v14, s[36:39], s90 offen
    v_bfe_u32 v8, v0, 3, 1
    v_lshl_add_u32 v10, v1, 5, s67
    s_mov_b32 s60, 0
    s_mov_b32 s61, 0
    s_lshl_b32 s63, 1, s51
    s_mov_b32 m0, s51
    s_waitcnt lgkmcnt(0)
    v_max_u32 v98, v64, v65
    v_min_u32 v99, v64, v65
    s_nop 0
    v_min_u32_dpp v96, v98, v98 row_ror:8 row_mask:0xf bank_mask:0xf
    v_max_u32_dpp v98, v98, v98 row_ror:8 row_mask:0xf bank_mask:0xf
    v_max_u32_dpp v97, v99, v99 row_ror:8 row_mask:0xf bank_mask:0xf
    v_max_u32 v99, v96, v97
    v_min_u32_dpp v96, v98, v98 row_ror:4 row_mask:0xf bank_mask:0xf
    v_max_u32_dpp v98, v98, v98 row_ror:4 row_mask:0xf bank_mask:0xf
    v_max_u32_dpp v97, v99, v99 row_ror:4 row_mask:0xf bank_mask:0xf
    v_max_u32 v99, v96, v97
    v_min_u32_dpp v96, v98, v98 row_ror:2 row_mask:0xf bank_mask:0xf
    v_max_u32_dpp v98, v98, v98 row_ror:2 row_mask:0xf bank_mask:0xf
    v_max_u32_dpp v97, v99, v99 row_ror:2 row_mask:0xf bank_mask:0xf
    v_max_u32 v99, v96, v97
    v_min_u32_dpp v96, v98, v98 row_ror:1 row_mask:0xf bank_mask:0xf
    v_max_u32_dpp v98, v98, v98 row_ror:1 row_mask:0xf bank_mask:0xf
    v_max_u32_dpp v97, v99, v99 row_ror:1 row_mask:0xf bank_mask:0xf
    v_max_u32 v99, v96, v97
    v_readlane_b32 s58, v98, 0
    v_readlane_b32 s59, v99, 0
    v_readlane_b32 s86, v98, 16
    v_readlane_b32 s87, v99, 16
    s_nop 0
    s_max_u32 s59, s59, s87
    s_min_u32 s87, s58, s86
    s_max_u32 s58, s58, s86
    s_max_u32 s59, s59, s87
    v_readlane_b32 s86, v98, 32
    v_readlane_b32 s87, v99, 32
    s_nop 0
    s_max_u32 s59, s59, s87
    s_min_u32 s87, s58, s86
    s_max_u32 s58, s58, s86
    s_max_u32 s59, s59, s87
    v_readlane_b32 s86, v98, 48
    v_readlane_b32 s87, v99, 48
    s_nop 0
    s_max_u32 s59, s59, s87
    s_min_u32 s87, s58, s86
    s_max_u32 s58, s58, s86
    s_max_u32 s59, s59, s87
    s_waitcnt vmcnt(4)
    s_branch L_h4_chk0
L_h4_w0:
    s_waitcnt vmcnt(0)
L_h4_chk0:
    v_cmp_eq_u32 vcc, -1, v128
    s_nop 0
    s_andn2_b32 s86, vcc_lo, s63
    s_cbranch_scc0 L_h4_all0
    v_cndmask_b32 v96, v128, 0, vcc
    v_cndmask_b32 v97, v129, 0, vcc
    v_mov_b32 v128, 0
    v_mov_b32 v129, 0
    buffer_atomic_or_x2 v[128:129], v148, s[16:19], 0 offen sc0 sc1
    s_sub_u32 s56, s56, 1
    s_cbranch_scc1 L_h4_out
    v_min_u32_dpp v98, v96, v96 row_ror:8 row_mask:0xf bank_mask:0xf
    v_max_u32_dpp v96, v96, v96 row_ror:8 row_mask:0xf bank_mask:0xf
    v_max_u32_dpp v99, v97, v97 row_ror:8 row_mask:0xf bank_mask:0xf
    v_max_u32 v97, v98, v99
    v_min_u32_dpp v98, v96, v96 row_ror:4 row_mask:0xf bank_mask:0xf
    v_max_u32_dpp v96, v96, v96 row_ror:4 row_mask:0xf bank_mask:0xf
    v_max_u32_dpp v99, v97, v97 row_ror:4 row_mask:0xf bank_mask:0xf
    v_max_u32 v97, v98, v99
    v_min_u32_dpp v98, v96, v96 row_ror:2 row_mask:0xf bank_mask:0xf
    v_max_u32_dpp v96, v96, v96 row_ror:2 row_mask:0xf bank_mask:0xf
    v_max_u32_dpp v99, v97, v97 row_ror:2 row_mask:0xf bank_mask:0xf
    v_max_u32 v97, v98, v99
    v_min_u32_dpp v98, v96, v96 row_ror:1 row_mask:0xf bank_mask:0xf
    v_max_u32_dpp v96, v96, v96 row_ror:1 row_mask:0xf bank_mask:0xf
    v_max_u32_dpp v99, v97, v97 row_ror:1 row_mask:0xf bank_mask:0xf
    v_max_u32 v97, v98, v99
    v_readlane_b32 s70, v96, 0
    v_readlane_b32 s71, v97, 0
    s_nop 0
    s_cmp_eq_u64 s[70:71], s[60:61]
    s_cbranch_scc1 L_h4_w0
    s_mov_b64 s[60:61], s[70:71]
    s_bfe_u32 s86, s60, 0x40007
    s_bfe_u32 s87, s61, 0x40007
    s_sub_u32 s87, s86, s87
    s_lshl_b32 s87, s87, 12
    s_cselect_b32 s69, s87, 2048
    v_mad_i32_i24 v130, v8, s69, v10
    s_xor_b32 s86, s86, 15
    s_lshl_b32 s66, s86, 12
    buffer_load_dwordx4 v[64:67], v130, s[16:19], s66 offen sc1
    buffer_load_dwordx4 v[68:71], v130, s[16:19], s66 offen offset:16 sc1
    s_waitcnt vmcnt(2)
    s_branch L_h4_chk0
L_h4_own:
    s_waitcnt vmcnt(0)
    v_mov_b32 v128, 0
    v_mov_b32 v129, 0
    buffer_atomic_or_x2 v[128:129], v148, s[16:19], 0 offen sc0 sc1
    s_sub_u32 s56, s56, 1
    s_cbranch_scc0 L_h4_w0
L_h4_out:
    s_mov_b32 s56, 0
    s_waitcnt vmcnt(0)
    s_mov_b64 vcc, 0
L_h4_all0:
    v_writelane_b32 v128, s58, m0
    v_writelane_b32 v129, s59, m0
    s_nop 0
    v_min_u32_dpp v98, v128, v128 row_ror:8 row_mask:0xf bank_mask:0xf
    v_max_u32_dpp v96, v128, v128 row_ror:8 row_mask:0xf bank_mask:0xf
    v_max_u32_dpp v99, v129, v129 row_ror:8 row_mask:0xf bank_mask:0xf
    v_max_u32 v97, v98, v99
L_h4_all:
    v_min_u32_dpp v98, v96, v96 row_ror:4 row_mask:0xf bank_mask:0xf
    v_max_u32_dpp v96, v96, v96 row_ror:4 row_mask:0xf bank_mask:0xf
    v_max_u32_dpp v99, v97, v97 row_ror:4 row_mask:0xf bank_mask:0xf
    v_max_u32 v97, v98, v99
    v_min_u32_dpp v98, v96, v96 row_ror:2 row_mask:0xf bank_mask:0xf
    v_max_u32_dpp v96, v96, v96 row_ror:2 row_mask:0xf bank_mask:0xf
    v_max_u32_dpp v99, v97, v97 row_ror:2 row_mask:0xf bank_mask:0xf
    v_max_u32 v97, v98, v99
    v_min_u32_dpp v98, v96, v96 row_ror:1 row_mask:0xf bank_mask:0xf
    v_max_u32_dpp v96, v96, v96 row_ror:1 row_mask:0xf bank_mask:0xf
    v_max_u32_dpp v99, v97, v97 row_ror:1 row_mask:0xf bank_mask:0xf
    v_max_u32 v97, v98, v99
    v_readlane_b32 s70, v96, 0
    v_readlane_b32 s71, v97, 0
    s_nop 0
    s_cmp_ge_u32 s58, s71
    s_cselect_b32 s86, vcc_lo, 0
    s_cmp_lg_u32 s86, 0
    s_cbranch_scc1 L_h4_own
    s_cmp_eq_u64 s[70:71], s[60:61]
    s_cbranch_scc1 L_h4_go
    s_mov_b64 s[60:61], s[70:71]
    s_bfe_u32 s86, s60, 0x40007
    s_bfe_u32 s87, s61, 0x40007
    s_sub_u32 s87, s86, s87
    s_lshl_b32 s87, s87, 12
    s_cselect_b32 s69, s87, 2048
L_walk_22:
    s_cbranch_execz L_walked
    v_mad_i32_i24 v130, v8, s69, v10
    s_xor_b32 s86, s86, 15
    s_lshl_b32 s66, s86, 12
    buffer_load_dwordx4 v[64:67], v130, s[16:19], s66 offen sc1
    buffer_load_dwordx4 v[68:71], v130, s[16:19], s66 offen offset:16 sc1
L_h4_go:
    v_mov_b32 v16, 66304
    v_mov_b32 v24, s60
    v_mov_b32 v25, s61
    ds_write_b64 v16, v[24:25]
    s_waitcnt lgkmcnt(0)
    s_barrier
    s_waitcnt vmcnt(0)
    s_branch L_seg_chk
L_seg:
    buffer_load_dwordx4 v[64:67], v130, s[16:19], s66 offen sc1
    buffer_load_dwordx4 v[68:71], v130, s[16:19], s66 offen offset:16 sc1
    s_waitcnt vmcnt(0)
L_seg_chk:
    v_max3_u32 v16, v65, v67, v69
    v_max_u32 v16, v16, v71
    v_cmp_eq_u32 vcc, -1, v16
    s_cbranch_vccz L_ok_5
    s_sub_u32 s56, s56, 1
    s_cbranch_scc0 L_seg
    s_mov_b32 s56, 0
L_ok_5:
    v_perm_b32 v80, v64, v64, v72
    v_perm_b32 v81, v64, v64, v73
    v_perm_b32 v82, v64, v64, v74
    v_perm_b32 v83, v64, v64, v75
    v_perm_b32 v84, v64, v64, v76
    v_perm_b32 v85, v64, v64, v77
    v_perm_b32 v86, v64, v64, v78
    v_perm_b32 v87, v64, v64, v79
    v_mfma_f32_16x16x32_bf16 v[88:91], v[80:83], v[164:167], 0
    v_perm_b32 v92, v65, v65, v72
    v_perm_b32 v93, v65, v65, v73
    v_perm_b32 v94, v65, v65, v74
    v_perm_b32 v95, v65, v65, v75
    v_mfma_f32_16x16x32_bf16 v[88:91], v[84:87], v[168:171], v[88:91]
    v_perm_b32 v80, v65, v65, v76
    v_perm_b32 v81, v65, v65, v77
    v_perm_b32 v82, v65, v65, v78
    v_perm_b32 v83, v65, v65, v79
    v_mfma_f32_16x16x32_bf16 v[88:91], v[92:95], v[172:175], v[88:91]
    v_perm_b32 v84, v66, v66, v72
    v_perm_b32 v85, v66, v66, v73
    v_perm_b32 v86, v66, v66, v74
    v_perm_b32 v87, v66, v66, v75
    v_mfma_f32_16x16x32_bf16 v[88:91], v[80:83], v[176:179], v[88:91]
    v_perm_b32 v92, v66, v66, v76
    v_perm_b32 v93, v66, v66, v77
    v_perm_b32 v94, v66, v66, v78
    v_perm_b32 v95, v66, v66, v79
    v_mfma_f32_16x16x32_bf16 v[88:91], v[84:87], v[180:183], v[88:91]
    v_perm_b32 v80, v67, v67, v72
    v_perm_b32 v81, v67, v67, v73
    v_perm_b32 v82, v67, v67, v74
    v_perm_b32 v83, v67, v67, v75
    v_mfma_f32_16x16x32_bf16 v[88:91], v[92:95], v[184:187], v[88:91]
    v_perm_b32 v84, v67, v67, v76
    v_perm_b32 v85, v67, v67, v77
    v_perm_b32 v86, v67, v67, v78
    v_perm_b32 v87, v67, v67, v79
    v_mfma_f32_16x16x32_bf16 v[88:91], v[80:83], v[188:191], v[88:91]
    v_perm_b32 v92, v68, v68, v72
    v_perm_b32 v93, v68, v68, v73
    v_perm_b32 v94, v68, v68, v74
    v_perm_b32 v95, v68, v68, v75
    v_mfma_f32_16x16x32_bf16 v[88:91], v[84:87], v[192:195], v[88:91]
    v_perm_b32 v80, v68, v68, v76
    v_perm_b32 v81, v68, v68, v77
    v_perm_b32 v82, v68, v68, v78
    v_perm_b32 v83, v68, v68, v79
    v_mfma_f32_16x16x32_bf16 v[88:91], v[92:95], v[196:199], v[88:91]
    v_perm_b32 v84, v69, v69, v72
    v_perm_b32 v85, v69, v69, v73
    v_perm_b32 v86, v69, v69, v74
    v_perm_b32 v87, v69, v69, v75
    v_mfma_f32_16x16x32_bf16 v[88:91], v[80:83], v[200:203], v[88:91]
    v_perm_b32 v92, v69, v69, v76
    v_perm_b32 v93, v69, v69, v77
    v_perm_b32 v94, v69, v69, v78
    v_perm_b32 v95, v69, v69, v79
    v_mfma_f32_16x16x32_bf16 v[88:91], v[84:87], v[204:207], v[88:91]
    v_perm_b32 v80, v70, v70, v72
    v_perm_b32 v81, v70, v70, v73
    v_perm_b32 v82, v70, v70, v74
    v_perm_b32 v83, v70, v70, v75
    v_mfma_f32_16x16x32_bf16 v[88:91], v[92:95], v[208:211], v[88:91]
    v_perm_b32 v84, v70, v70, v76
    v_perm_b32 v85, v70, v70, v77
    v_perm_b32 v86, v70, v70, v78
    v_perm_b32 v87, v70, v70, v79
    v_mfma_f32_16x16x32_bf16 v[88:91], v[80:83], v[212:215], v[88:91]
    v_perm_b32 v92, v71, v71, v72
    v_perm_b32 v93, v71, v71, v73
    v_perm_b32 v94, v71, v71, v74
    v_perm_b32 v95, v71, v71, v75
    v_mfma_f32_16x16x32_bf16 v[88:91], v[84:87], v[216:219], v[88:91]
    v_perm_b32 v80, v71, v71, v76
    v_perm_b32 v81, v71, v71, v77
    v_perm_b32 v82, v71, v71, v78
    v_perm_b32 v83, v71, v71, v79
    v_mfma_f32_16x16x32_bf16 v[88:91], v[92:95], v[220:223], v[88:91]
    s_nop 0
    v_mfma_f32_16x16x32_bf16 v[88:91], v[80:83], v[224:227], v[88:91]
    s_nop 7
    ds_write_b128 v18, v[88:91]
    s_waitcnt lgkmcnt(0)
    s_barrier
    ds_read2st64_b32 v[24:25], v133 offset0:0 offset1:4
    ds_read2st64_b32 v[26:27], v133 offset0:8 offset1:12
    s_mov_b32 s79, 114688
    s_cmp_eq_u32 s83, 0
    s_waitcnt lgkmcnt(0)
    v_pk_add_f32 v[24:25], v[24:25], v[26:27]
    v_add_f32 v24, v24, v25
    s_cbranch_scc1 L_h5_far
    buffer_store_dword v24, v131, s[16:19], 0 offen
L_h5_out:
    s_lshr_b32 s88, s48, 1
    s_cselect_b32 s86, s69, 0
    s_cselect_b32 s63, s61, s60
    s_and_b32 s87, s48, 1
    s_and_b32 s89, s82, 7
    s_lshl1_add_u32 s87, s89, s87
    s_lshl_b32 s87, s87, 7
    s_add_u32 s86, s86, s66
    s_add_u32 s86, s86, s87
    s_add_u32 s86, s86, 6553600
    v_lshl_add_u32 v142, v0, 1, s86
    v_mov_b32 v140, 0
    v_mov_b32 v141, 0
    s_mov_b32 s65, 65536
    buffer_load_short_d16_hi v140, v142, s[16:19], 0 offen sc1
    buffer_load_short_d16_hi v141, v142, s[16:19], s65 offen sc1
    s_and_b32 s86, s63, 0x7ff
    s_sub_u32 s86, 2047, s86
    s_lshl_b32 s86, s86, 11
    s_add_u32 s86, s86, s87
    v_lshl_add_u32 v143, v0, 1, s86
    s_ashr_i32 s86, s63, 31
    s_orn2_b32 s86, 0x80000000, s86
    s_xor_b32 s63, s63, s86
    s_and_b32 s63, s63, 0xffff0000
    s_lshr_b32 s86, s48, 1
    s_and_b32 s87, s48, 1
    s_lshl_b32 s88, s86, 9
    s_lshl_b32 s89, s87, 7
    s_add_u32 s88, s88, s89
    s_add_u32 s88, s88, 94208
    v_lshrrev_b32 v17, 3, v0
    v_lshl_add_u32 v20, v17, 4, s88
    v_bfe_u32 v9, v0, 2, 1
    v_lshl_add_u32 v20, v9, 8, v20
    v_and_b32 v9, 3, v0
    v_lshl_add_u32 v20, v9, 2, v20
    s_and_b32 s89, s82, 7
    s_lshl3_add_u32 s86, s86, s89
    s_lshl1_add_u32 s86, s86, s87
    s_lshl_b32 s86, s86, 11
    s_add_u32 s86, s86, 917504
    v_lshl_add_u32 v9, v17, 8, s86
L_walk_23:
    s_cbranch_execz L_walked
    v_and_b32 v17, 7, v0
    v_lshl_add_u32 v9, v17, 3, v9
    s_mov_b32 s76, 0
    s_mov_b32 s77, 0x41900000
    s_lshl_b32 s86, s48, 7
    s_add_u32 s86, s86, 100352
    v_lshl_add_u32 v11, v8, 6, s86
    v_lshl_add_u32 v11, v1, 4, v11
    v_and_b32 v16, 7, v0
    v_cmp_eq_u32 vcc, 7, v16
    v_lshl_add_u32 v16, v16, 2, v1
    v_mul_u32_u24 v17, 37, v16
    v_lshrrev_b32 v17, 8, v17
    v_add_u32 v16, v16, v17
    v_lshl_or_b32 v17, v1, 3, 7
    v_cndmask_b32 v16, v16, v17, vcc
    v_lshl_add_u32 v16, v8, 5, v16
    v_lshl_add_u32 v10, v16, 1, s86
    v_mov_b32 v144, s63
    v_mul_f32 v144, 0xbfb8aa3b, v144
    v_exp_f32 v144, v144
    s_nop 0
    v_add_f32 v144, 1.0, v144
    v_rcp_f32 v144, v144
    s_nop 0
    v_cvt_pk_bf16_f32 v144, v144, v144
    v_lshlrev_b32 v144, 16, v144
    s_mov_b32 s6, 0x80808080
    s_mov_b32 s7, 0x80808080
    v_mov_b32 v19, v9
    buffer_load_dwordx4 v[112:115], v137, s[16:19], 0 offen sc1
    buffer_load_dwordx4 v[116:119], v137, s[16:19], s79 offen sc1
    s_waitcnt vmcnt(0)
    s_branch L_h5_chk
L_h5:
    v_cmp_eq_u32 vcc, -1, v115
    s_cbranch_vccz L_h5_s0
    s_mov_b64 exec, vcc
    buffer_load_dwordx4 v[112:115], v137, s[16:19], 0 offen sc1
    s_mov_b64 exec, -1
L_h5_s0:
    v_cmp_eq_u32 vcc, -1, v119
    s_cbranch_vccz L_h5_s1
    s_mov_b64 exec, vcc
    buffer_load_dwordx4 v[116:119], v137, s[16:19], s79 offen sc1
    s_mov_b64 exec, -1
L_h5_s1:
    s_waitcnt vmcnt(0)
L_h5_chk:
    v_max_u32 v16, v115, v119
    v_cmp_eq_u32 vcc, -1, v16
    s_cbranch_vccz L_ok_6
    s_sub_u32 s56, s56, 1
    s_cbranch_scc0 L_h5
    s_mov_b32 s56, 0
L_ok_6:
    v_permlane32_swap_b32 v112, v114
    v_permlane32_swap_b32 v113, v115
    v_permlane32_swap_b32 v116, v118
    v_permlane32_swap_b32 v117, v119
    v_add_f32 v112, v112, v114
    v_add_f32 v113, v113, v115
    v_add_f32 v116, v116, v118
    v_add_f32 v117, v117, v119
    v_permlane16_swap_b32 v112, v113
    s_nop 0
    v_permlane16_swap_b32 v116, v117
    v_add_f32 v112, v112, v113
    v_add_f32 v116, v116, v117
    v_cvt_pk_bf16_f32 v25, v112, v116
    v_lshlrev_b32 v24, 16, v25
    v_and_b32 v28, 0xffff0000, v25
    v_mul_f32 v25, 0xbfb8aa3b, v24
    v_exp_f32 v25, v25
    s_nop 0
    v_add_f32 v25, 1.0, v25
    v_rcp_f32 v25, v25
    s_nop 0
    v_mul_f32 v24, v24, v25
    v_cvt_pk_bf16_f32 v24, v24, v24
    v_lshlrev_b32 v24, 16, v24
    v_mul_f32 v24, v24, v28
    v_cvt_pk_bf16_f32 v24, v24, v24
    ds_write_b16 v10, v24
    s_waitcnt lgkmcnt(0)
    ds_read_b128 v[64:67], v11
    s_waitcnt lgkmcnt(0)
    v_perm_b32 v80, v64, v64, v72
    v_perm_b32 v81, v64, v64, v73
    v_perm_b32 v82, v64, v64, v74
    v_perm_b32 v83, v64, v64, v75
    v_perm_b32 v84, v64, v64, v76
    v_perm_b32 v85, v64, v64, v77
    v_perm_b32 v86, v64, v64, v78
    v_perm_b32 v87, v64, v64, v79
    v_mfma_f32_16x16x32_bf16 v[88:91], v[80:83], v[228:231], 0
    v_perm_b32 v92, v65, v65, v72
    v_perm_b32 v93, v65, v65, v73
    v_perm_b32 v94, v65, v65, v74
    v_perm_b32 v95, v65, v65, v75
    v_mfma_f32_16x16x32_bf16 v[88:91], v[84:87], v[232:235], v[88:91]
    v_perm_b32 v80, v65, v65, v76
    v_perm_b32 v81, v65, v65, v77
    v_perm_b32 v82, v65, v65, v78
    v_perm_b32 v83, v65, v65, v79
    v_mfma_f32_16x16x32_bf16 v[88:91], v[92:95], v[236:239], v[88:91]
    v_perm_b32 v84, v66, v66, v72
    v_perm_b32 v85, v66, v66, v73
    v_perm_b32 v86, v66, v66, v74
    v_perm_b32 v87, v66, v66, v75
    v_mfma_f32_16x16x32_bf16 v[88:91], v[80:83], v[240:243], v[88:91]
    v_perm_b32 v92, v66, v66, v76
    v_perm_b32 v93, v66, v66, v77
    v_perm_b32 v94, v66, v66, v78
    v_perm_b32 v95, v66, v66, v79
    v_mfma_f32_16x16x32_bf16 v[88:91], v[84:87], v[244:247], v[88:91]
    v_perm_b32 v80, v67, v67, v72
    v_perm_b32 v81, v67, v67, v73
    v_perm_b32 v82, v67, v67, v74
    v_perm_b32 v83, v67, v67, v75
    v_mfma_f32_16x16x32_bf16 v[88:91], v[92:95], v[248:251], v[88:91]
    s_nop 0
    v_mfma_f32_16x16x32_bf16 v[88:91], v[80:83], v[252:255], v[88:91]
    s_nop 7
    ds_write_b128 v18, v[88:91] offset:4096
    s_waitcnt lgkmcnt(0)
    s_barrier
    ds_read2st64_b32 v[24:25], v20 offset0:0 offset1:4
    ds_read2st64_b32 v[26:27], v20 offset0:8 offset1:12
    s_waitcnt lgkmcnt(0)
    v_pk_add_f32 v[24:25], v[24:25], v[26:27]
    v_add_f32 v24, v24, v25
    v_cvt_f64_f32 v[26:27], v24
    v_add_f64 v[24:25], v[26:27], s[76:77]
    buffer_atomic_add_f64 v[24:25], v19, s[16:19], 0 offen sc0 sc1
    s_barrier
    s_mov_b32 s77, 0xc1df0000
    v_add_f64 v[26:27], v[26:27], s[76:77]
    s_waitcnt vmcnt(1)
    v_max_u32 v16, v140, v141
    v_cmp_eq_u32 vcc, 0xffff0000, v16
    s_cbranch_vccnz L_fin_ld
L_fin_go:
    s_mov_b32 s88, 0x4c000000
    v_mov_b32 v17, 2147483648
    s_waitcnt vmcnt(0)
    v_add_f64 v[24:25], v[24:25], v[26:27]
    v_cvt_f32_f64 v24, v[24:25]
    v_cmp_lt_f32 vcc, |v24|, s88
    v_cvt_pk_bf16_f32 v24, v24, v24
    v_lshlrev_b32 v24, 16, v24
    v_mul_f32 v24, v24, v144
    v_cndmask_b32 v17, v17, v143, vcc
    v_cvt_pk_bf16_f32 v24, v24, v24
    v_lshlrev_b32 v24, 16, v24
    v_add_f32 v24, v24, v141
    v_cvt_pk_bf16_f32 v24, v24, v24
    v_lshlrev_b32 v24, 16, v24
    v_add_f32 v24, v24, v140
    v_cvt_pk_bf16_f32 v24, v24, v24
    buffer_store_short v24, v17, s[24:27], 0 offen
L_fin:
L_end:
    s_endpgm
L_b_restart:
    s_waitcnt vmcnt(0)
    v_xor_b32 v9, 0x8000, v7
    buffer_load_dwordx4 v[136:139], v7, s[8:11], 0 offen
    buffer_load_dwordx4 v[140:143], v9, s[8:11], 0 offen
    v_mov_b32 v8, s68
    s_mov_b32 s66, 0xffffaaaa
    s_mov_b32 s63, 1
    s_branch L_b_init
L_b_g4:
    s_lshr_b32 s86, s78, 2
    buffer_load_dwordx4 v[48:51], v157, s[16:19], s86 offen offset:0 sc1
    buffer_load_dwordx4 v[52:55], v158, s[16:19], s86 offen offset:0 sc1
    s_waitcnt vmcnt(0)
    s_sub_u32 s56, s56, 1
    s_cbranch_scc0 L_b_c4
    s_mov_b32 s56, 0
    s_branch L_b_d4
L_b_g5:
    s_lshr_b32 s86, s78, 2
    buffer_load_dwordx4 v[56:59], v157, s[16:19], s86 offen offset:1024 sc1
    buffer_load_dwordx4 v[60:63], v158, s[16:19], s86 offen offset:1024 sc1
    s_waitcnt vmcnt(0)
    s_sub_u32 s56, s56, 1
    s_cbranch_scc0 L_b_c5
    s_mov_b32 s56, 0
    s_branch L_b_d5
L_b_g6:
    s_lshr_b32 s86, s79, 2
    buffer_load_dwordx4 v[64:67], v157, s[16:19], s86 offen offset:0 sc1
    buffer_load_dwordx4 v[68:71], v158, s[16:19], s86 offen offset:0 sc1
    s_waitcnt vmcnt(0)
    s_sub_u32 s56, s56, 1
    s_cbranch_scc0 L_b_c6
    s_mov_b32 s56, 0
    s_branch L_b_d6
L_walk_24:
    s_cbranch_execz L_walked
L_b_g7:
    s_lshr_b32 s86, s79, 2
    buffer_load_dwordx4 v[72:75], v157, s[16:19], s86 offen offset:1024 sc1
    buffer_load_dwordx4 v[76:79], v158, s[16:19], s86 offen offset:1024 sc1
    s_waitcnt vmcnt(0)
    s_sub_u32 s56, s56, 1
    s_cbranch_scc0 L_b_c7
    s_mov_b32 s56, 0
    s_branch L_b_d7
L_b_g8:
    s_lshr_b32 s86, s76, 2
    buffer_load_dwordx4 v[16:19], v157, s[16:19], s86 offen offset:0 sc1
    buffer_load_dwordx4 v[20:23], v158, s[16:19], s86 offen offset:0 sc1
    s_waitcnt vmcnt(0)
    s_sub_u32 s56, s56, 1
    s_cbranch_scc0 L_b_c8
    s_mov_b32 s56, 0
    s_branch L_b_d8
L_b_g9:
    s_lshr_b32 s86, s76, 2
    buffer_load_dwordx4 v[24:27], v157, s[16:19], s86 offen offset:1024 sc1
    buffer_load_dwordx4 v[28:31], v158, s[16:19], s86 offen offset:1024 sc1
    s_waitcnt vmcnt(0)
    s_sub_u32 s56, s56, 1
    s_cbranch_scc0 L_b_c9
    s_mov_b32 s56, 0
    s_branch L_b_d9
L_b_g10:
    s_lshr_b32 s86, s77, 2
    buffer_load_dwordx4 v[32:35], v157, s[16:19], s86 offen offset:0 sc1
    buffer_load_dwordx4 v[36:39], v158, s[16:19], s86 offen offset:0 sc1
    s_waitcnt vmcnt(0)
    s_sub_u32 s56, s56, 1
    s_cbranch_scc0 L_b_c10
    s_mov_b32 s56, 0
    s_branch L_b_d10
L_b_g11:
    s_lshr_b32 s86, s77, 2
    buffer_load_dwordx4 v[40:43], v157, s[16:19], s86 offen offset:1024 sc1
    buffer_load_dwordx4 v[44:47], v158, s[16:19], s86 offen offset:1024 sc1
    s_waitcnt vmcnt(0)
    s_sub_u32 s56, s56, 1
    s_cbranch_scc0 L_b_c11
    s_mov_b32 s56, 0
    s_branch L_b_d11
L_b_g12:
    s_lshr_b32 s86, s78, 2
    buffer_load_dwordx4 v[48:51], v157, s[16:19], s86 offen offset:0 sc1
    buffer_load_dwordx4 v[52:55], v158, s[16:19], s86 offen offset:0 sc1
    s_waitcnt vmcnt(0)
    s_sub_u32 s56, s56, 1
    s_cbranch_scc0 L_b_c12
    s_mov_b32 s56, 0
    s_branch L_b_d12
L_b_g13:
    s_lshr_b32 s86, s78, 2
    buffer_load_dwordx4 v[56:59], v157, s[16:19], s86 offen offset:1024 sc1
    buffer_load_dwordx4 v[60:63], v158, s[16:19], s86 offen offset:1024 sc1
    s_waitcnt vmcnt(0)
    s_sub_u32 s56, s56, 1
    s_cbranch_scc0 L_b_c13
    s_mov_b32 s56, 0
    s_branch L_b_d13
L_b_g14:
    s_lshr_b32 s86, s79, 2
    buffer_load_dwordx4 v[64:67], v157, s[16:19], s86 offen offset:0 sc1
    buffer_load_dwordx4 v[68:71], v158, s[16:19], s86 offen offset:0 sc1
    s_waitcnt vmcnt(0)
    s_sub_u32 s56, s56, 1
    s_cbranch_scc0 L_b_c14
    s_mov_b32 s56, 0
    s_branch L_b_d14
L_b_g15:
    s_lshr_b32 s86, s79, 2
    buffer_load_dwordx4 v[72:75], v157, s[16:19], s86 offen offset:1024 sc1
    buffer_load_dwordx4 v[76:79], v158, s[16:19], s86 offen offset:1024 sc1
    s_waitcnt vmcnt(0)
    s_sub_u32 s56, s56, 1
    s_cbranch_scc0 L_b_c15
    s_mov_b32 s56, 0
    s_branch L_b_d15
L_b_p0:
    v_mov_b32 v8, 0
    buffer_atomic_or v8, v159, s[16:19], 0 offen sc0 sc1
L_b_w0:
    s_waitcnt vmcnt(0)
    v_cmp_eq_u32 vcc, s68, v8
    s_nop 0
    s_lshr_b32 s65, vcc_lo, 1
    s_and_b32 s65, s65, vcc_lo
    s_andn2_b32 s65, s65, s66
    s_cbranch_scc0 L_b_q0
    s_or_b32 s66, s66, s65
    s_branch L_b_r0
L_b_q0:
    s_sub_u32 s56, s56, 1
    s_cbranch_scc0 L_b_p0
    s_mov_b32 s56, 0
    s_not_b32 s65, s66
    s_branch L_b_r0
L_b_p1:
    v_mov_b32 v8, 0
    buffer_atomic_or v8, v159, s[16:19], 0 offen sc0 sc1
    s_waitcnt vmcnt(0)
    v_cmp_eq_u32 vcc, s68, v8
    s_nop 0
    s_lshr_b32 s65, vcc_lo, 1
    s_and_b32 s65, s65, vcc_lo
    s_andn2_b32 s65, s65, s66
    s_cbranch_scc0 L_b_q1
    s_or_b32 s66, s66, s65
    s_branch L_b_r1
L_b_q1:
    s_sub_u32 s56, s56, 1
    s_cbranch_scc0 L_b_p1
    s_mov_b32 s56, 0
    s_not_b32 s65, s66
    s_branch L_b_r1
L_h5_far:
    buffer_store_dword v24, v131, s[16:19], 0 offen sc1
    s_branch L_h5_out
L_fin_ld:
    buffer_load_short_d16_hi v140, v142, s[16:19], 0 offen sc1
    buffer_load_short_d16_hi v141, v142, s[16:19], s65 offen sc1
    s_waitcnt vmcnt(0)
    v_max_u32 v16, v140, v141
    v_cmp_eq_u32 vcc, 0xffff0000, v16
    s_cbranch_vccz L_fin_go
    s_sub_u32 s56, s56, 1
    s_cbranch_scc0 L_fin_ld
    s_branch L_fin_go
L_last:
    s_endpgm
.section .rodata,"a"
.p2align 6
.amdhsa_kernel sequential_preLN__linear_attn_block__moe_arch_mod__prompt_kernel
  .amdhsa_next_free_vgpr 256
  .amdhsa_next_free_sgpr 102
  .amdhsa_accum_offset 256
  .amdhsa_group_segment_fixed_size 0
  .amdhsa_kernarg_size 88
  .amdhsa_user_sgpr_count 2
  .amdhsa_user_sgpr_kernarg_segment_ptr 1
  .amdhsa_system_sgpr_workgroup_id_x 1
.end_amdhsa_kernel
```

```asm
; @launch grid=(256,1,1) block=(512,1,1) lds=163840
.amdgcn_target "amdgcn-amd-amdhsa--gfx950"
.text
.globl sequential_preLN__linear_attn_block__moe_arch_mod__prompt_kernel
.p2align 8
.type sequential_preLN__linear_attn_block__moe_arch_mod__prompt_kernel,@function
sequential_preLN__linear_attn_block__moe_arch_mod__prompt_kernel:
    s_cmp_ge_u32 s2, 256
    s_cbranch_scc1 L_end
    s_load_dwordx16 s[64:79], s[0:1], 0
    s_load_dwordx4 s[80:83], s[0:1], 64
    s_load_dwordx2 s[84:85], s[0:1], 80
    v_lshrrev_b32 v1, 6, v0
    v_and_b32 v0, 63, v0
    v_readfirstlane_b32 s3, v1
    s_and_b32 s44, s2, 7
    s_lshr_b32 s45, s2, 3
    s_and_b32 s46, s44, 1
    s_lshl_b32 s46, s46, 3
    s_and_b32 s86, s45, 7
    s_add_u32 s46, s46, s86
    s_lshr_b32 s47, s44, 1
    s_lshl_b32 s47, s47, 2
    s_lshr_b32 s86, s45, 3
    s_add_u32 s47, s47, s86
    s_mov_b32 s51, s47
    s_mov_b32 s52, s46
    s_and_b32 s48, s3, 3
    s_and_b32 s49, s3, 1
    s_bfe_u32 s50, s3, 0x10001
    s_mov_b32 s56, 65536
    s_mov_b32 s95, 0x3f803f80
    s_movk_i32 s92, 0x1000
    s_movk_i32 s93, 0x2000
    s_movk_i32 s94, 0x3000
    s_cmp_lt_u32 s3, 4
    s_cbranch_scc1 L_comp0
    v_lshrrev_b32 v20, 3, v0
    v_and_b32 v21, 7, v0
    v_lshrrev_b32 v22, 4, v0
    v_xor_b32 v23, v21, v22
    v_xor_b32 v24, 4, v23
    s_lshl_b32 s86, s48, 5
    v_add_u32 v25, s86, v20
    v_lshlrev_b32 v25, 11, v25
    v_lshl_add_u32 v2, v23, 4, v25
    v_lshl_add_u32 v3, v24, 4, v25
    v_add_u32 v3, 15360, v3
    v_lshl_add_u32 v4, v23, 4, v25
    v_add_u32 v4, 30720, v4
    v_lshl_add_u32 v5, v24, 4, v25
    v_add_u32 v5, 46080, v5
    s_lshl_b32 s86, s48, 4
    v_add_u32 v25, s86, v20
    v_mul_u32_u24 v25, 6144, v25
    s_lshl_b32 s86, s47, 7
    v_add_u32 v25, s86, v25
    v_bfe_u32 v26, v0, 4, 1
    v_lshlrev_b32 v26, 1, v26
    v_xor_b32 v26, v26, v21
    v_xor_b32 v27, 4, v26
    v_lshl_add_u32 v6, v26, 4, v25
    v_lshl_add_u32 v7, v27, 4, v25
    v_add_u32 v7, 48128, v7
    v_lshl_add_u32 v8, v26, 4, v25
    v_add_u32 v8, 2048, v8
    v_lshl_add_u32 v9, v27, 4, v25
    v_add_u32 v9, 50176, v9
    v_lshl_add_u32 v10, v26, 4, v25
    v_add_u32 v10, 4096, v10
    v_lshl_add_u32 v11, v27, 4, v25
    v_add_u32 v11, 52224, v11
    s_lshl_b32 s63, s46, 18
    s_lshl_b32 s53, s48, 12
    s_lshl_b32 s62, s48, 11
    s_add_u32 s62, s62, 16384
    s_setprio 1
    s_lshl_b32 s86, s45, 2
    s_add_u32 s86, s86, s48
    s_mul_i32 s87, s86, 12288
    s_and_b32 s88, s47, 12
    s_lshl_b32 s88, s88, 7
    s_add_u32 s87, s87, s88
    s_add_u32 s87, s87, 384
    s_bitcmp1_b32 s47, 2
    s_cselect_b32 s87, 2147483648, s87
    v_lshl_add_u32 v37, v0, 11, s87
    v_mov_b32 v24, 2147483648
    v_cmp_gt_u32 vcc, 6, v0
    s_nop 1
    v_cndmask_b32 v37, v24, v37, vcc
    s_lshl_b32 s86, s86, 14
    s_and_b32 s88, s52, 8
    s_lshl_b32 s88, s88, 7
    s_add_u32 s86, s86, s88
    s_add_u32 s86, s86, 384
    v_lshl_add_u32 v38, v0, 11, s86
    v_cmp_gt_u32 vcc, 8, v0
    s_nop 1
    v_cndmask_b32 v38, v24, v38, vcc
    s_waitcnt lgkmcnt(0)
    s_mov_b32 s8, s64
    s_and_b32 s9, s65, 0xffff
    s_mov_b32 s10, 4194304
    s_mov_b32 s11, 0x20000
    s_mov_b32 s12, s66
    s_and_b32 s13, s67, 0xffff
    s_mov_b32 s14, 6291456
    s_mov_b32 s15, 0x20000
    s_and_b32 s86, s47, 12
    s_and_b32 s87, s46, 8
    s_add_u32 s64, s86, s87
    s_and_b32 s64, s64, 15
    s_mov_b32 s67, s64
    s_load_dword s61, s[84:85], 524288
    s_lshr_b32 s90, s67, 2
    s_mul_i32 s90, s90, 1572864
    buffer_load_dword v39, v37, s[12:15], s90 offen
    s_add_u32 m0, s53, 40960
    s_lshl_b32 s70, s64, 7
    s_add_u32 s70, s70, s63
    buffer_load_dwordx4 v2, s[8:11], s70 offen offset:0 lds
    buffer_load_dwordx4 v3, s[8:11], s70 offen offset:1024 lds
    buffer_load_dwordx4 v4, s[8:11], s70 offen offset:2048 lds
    buffer_load_dwordx4 v5, s[8:11], s70 offen offset:3072 lds
    s_mul_i32 s91, s64, 393216
    s_add_u32 s64, s64, 1
    s_and_b32 s64, s64, 15
    s_add_u32 m0, s62, 40960
    s_nop 0
    buffer_load_dwordx4 v6, s[12:15], s91 offen offset:0 lds
    buffer_load_dwordx4 v7, s[12:15], s91 offen offset:1024 lds
    s_add_u32 m0, s62, 49152
    s_nop 0
    buffer_load_dwordx4 v8, s[12:15], s91 offen offset:0 lds
    buffer_load_dwordx4 v9, s[12:15], s91 offen offset:1024 lds
    s_add_u32 m0, s62, 57344
    s_nop 0
    buffer_load_dwordx4 v10, s[12:15], s91 offen offset:0 lds
    buffer_load_dwordx4 v11, s[12:15], s91 offen offset:1024 lds
    s_branch L_ld1
L_comp0:
    s_lshl2_add_u32 s86, s45, s3
    s_cmp_ge_u32 s86, 4
    s_cbranch_scc1 L_noipf
    s_getpc_b64 s[4:5]
L_ipf:
    s_sub_u32 s4, s4, L_ipf-sequential_preLN__linear_attn_block__moe_arch_mod__prompt_kernel
    s_subb_u32 s5, s5, 0
    s_lshl_b32 s86, s86, 13
    v_lshl_add_u32 v31, v0, 7, s86
    v_min_u32 v31, L_last-sequential_preLN__linear_attn_block__moe_arch_mod__prompt_kernel, v31
    global_load_dword v30, v31, s[4:5]
L_noipf:
    s_cmp_eq_u32 s3, 3
    s_cbranch_scc1 L_comp
    s_mov_b64 exec, 0
    s_cmp_eq_u32 s3, 2
    s_cbranch_scc1 L_walkA2
    s_cmp_eq_u32 s3, 1
    s_cbranch_scc1 L_walkA1
    s_branch L_walkA0
L_ld1:
    s_mov_b32 s16, s84
    s_and_b32 s17, s85, 0xffff
    s_mov_b32 s18, 268435456
    s_mov_b32 s19, 0x20000
    s_mov_b32 s20, s68
    s_and_b32 s21, s69, 0xffff
    s_mov_b32 s22, 2097152
    s_mov_b32 s23, 0x20000
    s_mov_b32 s24, s80
    s_and_b32 s25, s81, 0xffff
    s_mov_b32 s26, 4194304
    s_mov_b32 s27, 0x20000
    s_mov_b32 s28, s82
    s_and_b32 s29, s83, 0xffff
    s_mov_b32 s30, 256
    s_mov_b32 s31, 0x20000
    s_bitcmp1_b32 s2, 3
    s_cselect_b32 s32, s76, s74
    s_cselect_b32 s33, s77, s75
    s_and_b32 s33, s33, 0xffff
    s_mov_b32 s34, 7340032
    s_mov_b32 s35, 0x20000
    s_mov_b32 s36, s78
    s_and_b32 s37, s79, 0xffff
    s_mov_b32 s38, 7340032
    s_mov_b32 s39, 0x20000
    s_mov_b32 s40, s72
    s_and_b32 s41, s73, 0xffff
    s_mov_b32 s42, 2048
    s_mov_b32 s43, 0x20000
    s_lshl_b32 s82, s44, 5
    s_or_b32 s82, s82, s45
    v_lshrrev_b32 v22, 4, v0
    v_and_b32 v23, 15, v0
    s_lshl_b32 s86, s45, 2
    s_add_u32 s86, s86, s48
L_walkA0:
    s_cbranch_execz L_comp
    s_mul_i32 s87, s86, 6
    v_mul_u32_u24 v24, 43, v0
    v_lshrrev_b32 v24, 8, v24
    v_mul_u32_u24 v25, 6, v24
    v_sub_u32 v25, v0, v25
    v_add_u32 v25, s87, v25
    s_add_u32 s87, s67, 2
    v_add_u32 v24, s87, v24
    v_and_b32 v24, 15, v24
    v_mul_u32_u24 v124, 393216, v24
    v_lshrrev_b32 v24, 2, v25
    v_lshl_add_u32 v124, v24, 11, v124
    v_and_b32 v25, 3, v25
    s_and_b32 s88, s47, 12
    v_add_u32 v25, s88, v25
    v_lshl_add_u32 v124, v25, 7, v124
    v_mov_b32 v24, 2147483648
    v_cmp_gt_u32 vcc, 36, v0
    s_nop 1
    v_cndmask_b32 v124, v24, v124, vcc
    v_add_u32 v24, s87, v20
    v_and_b32 v24, 15, v24
    s_and_b32 s88, s46, 8
    s_lshl4_add_u32 s86, s88, s86
    s_lshl_b32 s86, s86, 14
    v_lshl_add_u32 v123, v21, 11, s86
    v_mov_b32 v125, v123
    v_lshl_add_u32 v123, v24, 7, v123
    v_mov_b32 v24, 2147483648
    v_cmp_gt_u32 vcc, 16, v0
    s_nop 1
    v_cndmask_b32 v123, v24, v123, vcc
    s_add_u32 m0, s53, 81920
    s_lshl_b32 s70, s64, 7
    s_add_u32 s70, s70, s63
    buffer_load_dwordx4 v2, s[8:11], s70 offen offset:0 lds
    buffer_load_dwordx4 v3, s[8:11], s70 offen offset:1024 lds
    buffer_load_dwordx4 v4, s[8:11], s70 offen offset:2048 lds
    buffer_load_dwordx4 v5, s[8:11], s70 offen offset:3072 lds
    s_mul_i32 s91, s64, 393216
    s_add_u32 s64, s64, 1
    s_and_b32 s64, s64, 15
    s_add_u32 m0, s62, 81920
    s_nop 0
    buffer_load_dwordx4 v6, s[12:15], s91 offen offset:0 lds
    buffer_load_dwordx4 v7, s[12:15], s91 offen offset:1024 lds
    s_add_u32 m0, s62, 90112
    s_nop 0
    buffer_load_dwordx4 v8, s[12:15], s91 offen offset:0 lds
    buffer_load_dwordx4 v9, s[12:15], s91 offen offset:1024 lds
    s_add_u32 m0, s62, 98304
    s_nop 0
    buffer_load_dwordx4 v10, s[12:15], s91 offen offset:0 lds
    buffer_load_dwordx4 v11, s[12:15], s91 offen offset:1024 lds
    buffer_load_dword v122, v123, s[8:11], 0 offen
    buffer_load_dword v122, v124, s[12:15], 0 offen
    s_and_b32 s65, s45, 7
    s_lshr_b32 s66, s45, 3
    s_add_u32 s86, s65, 1
    s_and_b32 s86, s86, 3
    s_mul_i32 s86, s86, 40960
    s_lshl_b32 s87, s48, 13
    s_cmp_eq_u32 s48, 3
    s_cselect_b32 s87, 0, s87
    s_add_u32 s86, s86, s87
    s_add_u32 s86, s86, 16384
    v_lshl_add_u32 v25, v20, 7, s86
    v_lshl_add_u32 v28, v26, 4, v25
    v_lshl_add_u32 v29, v27, 4, v25
    s_add_u32 s86, s66, 1
    s_and_b32 s86, s86, 3
    s_mul_i32 s86, s86, 40960
    s_add_u32 s86, s86, s53
    v_lshl_add_u32 v16, v0, 6, s86
    v_bfe_u32 v25, v0, 2, 2
    v_lshl_add_u32 v16, v25, 4, v16
    v_xor_b32 v17, 16, v16
    v_xor_b32 v18, 32, v16
    v_xor_b32 v19, 48, v16
    s_lshl_b32 s86, s46, 14
    s_lshl_b32 s87, s48, 8
    s_add_u32 s86, s86, s87
    s_add_u32 s86, s86, 262144
    v_lshl_add_u32 v33, v23, 4, s86
    v_lshl_add_u32 v33, v22, 10, v33
    s_lshl_b32 s87, s47, 10
    s_add_u32 s86, s86, s87
    v_lshl_add_u32 v13, v0, 2, s86
    v_and_b32 v25, 3, v0
    v_cmp_eq_u32 vcc, 0, v25
    v_mov_b32 v24, 2147483648
    s_nop 0
    v_cndmask_b32 v13, v24, v13, vcc
    s_mul_i32 s86, s47, 12288
    s_add_u32 s86, s86, 65536
    s_lshl_b32 s87, s48, 8
    s_cmp_eq_u32 s48, 3
    s_cselect_b32 s87, 2147483648, s87
    s_mov_b32 s88, 0
    s_add_u32 s86, s86, s87
    v_lshl_add_u32 v32, v23, 4, s86
    v_mul_u32_u24 v25, 768, v22
    v_add_u32 v32, v32, v25
    s_mul_i32 s87, s46, 768
    s_add_u32 s86, s86, s87
    s_add_u32 s86, s86, s88
    v_lshl_add_u32 v34, v23, 5, s86
    v_lshl_add_u32 v34, v22, 4, v34
    v_and_b32 v25, 0x28, v0
    v_cmp_eq_u32 vcc, 0, v25
    s_nop 1
    v_cndmask_b32 v34, v24, v34, vcc
    s_bfe_u32 s86, s82, 0x20001
    s_lshl_b32 s86, s86, 2
    s_add_u32 s86, s86, s48
    s_lshl_b32 s86, s86, 6
    v_lshl_add_u32 v30, v22, 4, s86
    v_mul_u32_u24 v30, 7168, v30
    s_add_u32 s86, s44, 3
    s_and_b32 s86, s86, 7
    s_min_u32 s86, s86, 6
    s_mul_i32 s87, s44, 7
    s_lshr_b32 s88, s45, 3
    s_lshl_b32 s88, s88, 1
    s_sub_u32 s80, s88, 2
    s_cmp_ge_u32 s80, s86
    s_addc_u32 s80, s80, s87
    s_sub_u32 s81, s88, 1
    s_cmp_ge_u32 s81, s86
    s_addc_u32 s81, s81, s87
    s_add_u32 s86, s86, s87
    s_cmp_lt_u32 s45, 8
    s_cselect_b32 s80, s86, s80
    s_cselect_b32 s81, 56, s81
    v_mov_b32 v24, s80
    v_mov_b32 v25, s81
    s_mov_b32 vcc_lo, 4278255360
    s_mov_b32 vcc_hi, vcc_lo
    v_cndmask_b32 v24, v24, v25, vcc
    v_cmp_gt_u32 vcc, 56, v24
    v_and_b32 v25, 7, v0
    v_lshlrev_b32 v24, 7, v24
    v_lshl_add_u32 v24, v25, 4, v24
    v_add_u32 v30, v30, v24
    v_mov_b32 v24, 2147483648
    v_cndmask_b32 v30, v24, v30, vcc
    s_lshr_b32 s86, s82, 3
    s_mul_i32 s86, s86, 112
    s_mul_i32 s87, s48, 28
    s_add_u32 s86, s86, s87
    v_mul_u32_u24 v31, 7, v22
    v_add_u32 v31, s86, v31
    v_lshlrev_b32 v31, 11, v31
    s_and_b32 s86, s82, 7
    s_lshl_b32 s86, s86, 8
    v_lshl_add_u32 v24, v23, 4, s86
    v_add_u32 v31, v31, v24
    v_lshlrev_b32 v24, 1, v22
    v_xor_b32 v24, v24, v21
    s_lshl_b32 s86, s48, 3
    v_add_u32 v12, s86, v20
    v_lshlrev_b32 v12, 11, v12
    s_lshl_b32 s86, s52, 7
    v_lshl_add_u32 v24, v24, 4, s86
    v_add_u32 v12, v12, v24
    s_lshl_b32 s89, s48, 10
    v_and_b32 v24, 1, v0
    v_lshlrev_b32 v24, 4, v24
    v_mov_b32 v25, 0x3f80
    v_lshlrev_b32 v24, v24, v25
    v_bfe_u32 v25, v0, 1, 2
    v_cmp_eq_u32 vcc, 0, v25
    s_nop 1
    v_cndmask_b32 v104, 0, v24, vcc
    v_cmp_eq_u32 vcc, 1, v25
    s_nop 1
    v_cndmask_b32 v105, 0, v24, vcc
    v_cmp_eq_u32 vcc, 2, v25
    s_nop 1
    v_cndmask_b32 v106, 0, v24, vcc
    v_cmp_eq_u32 vcc, 3, v25
    s_nop 1
    v_cndmask_b32 v107, 0, v24, vcc
    s_waitcnt lgkmcnt(0)
    s_add_u32 s68, s61, 0x9e3779b9
    v_mov_b32 v35, s68
    s_lshl_b32 s86, s46, 2
    s_add_u32 s86, s86, s48
    s_lshl_b32 s86, s86, 7
    s_add_u32 s86, s86, 655360
    s_lshl_b32 s87, s47, 2
    s_add_u32 s87, s87, s48
    s_lshl_b32 s87, s87, 7
    s_add_u32 s87, s87, 663552
    s_cmp_eq_u32 s48, 3
    s_cselect_b32 s87, 2147483648, s87
    s_cselect_b32 s76, 0xffff, -1
    s_mov_b32 s77, 0
    v_mov_b32 v24, s86
    v_mov_b32 v25, s87
    v_cmp_gt_u32 vcc, 16, v0
    s_nop 1
    v_cndmask_b32 v117, v25, v24, vcc
    v_lshl_add_u32 v117, v23, 2, v117
    v_mov_b32 v116, 2147483648
    v_cmp_gt_u32 vcc, 32, v0
    s_nop 1
L_walkA1:
    s_cbranch_execz L_comp
    v_cndmask_b32 v117, v116, v117, vcc
    s_lshl2_add_u32 s86, s47, s86
    s_lshl2_add_u32 s87, s46, s87
    v_writelane_b32 v116, s86, 0
    v_writelane_b32 v116, s87, 1
    s_getreg_b32 s83, hwreg(HW_REG_XCC_ID, 0, 4)
    s_add_u32 s83, s83, s68
    v_mov_b32 v121, s83
    s_lshl_b32 s86, s44, 7
    s_add_u32 s86, s86, 753664
    v_lshl_add_u32 v119, v0, 2, s86
    v_mov_b32 v120, 2147483648
    v_cmp_gt_u32 vcc, 32, v0
    s_nop 1
    v_cndmask_b32 v119, v120, v119, vcc
    s_lshl_b32 s86, s48, 6
    s_add_u32 s86, s86, s45
    v_cmp_eq_u32 vcc, s86, v0
    s_nop 1
    v_cndmask_b32 v120, v120, v119, vcc
    s_waitcnt vmcnt(12)
    s_barrier
    buffer_store_dword v121, v120, s[16:19], 0 offen sc1
    s_add_u32 m0, s53, 122880
    s_lshl_b32 s70, s64, 7
    s_add_u32 s70, s70, s63
    buffer_load_dwordx4 v2, s[8:11], s70 offen offset:0 lds
    buffer_load_dwordx4 v3, s[8:11], s70 offen offset:1024 lds
    buffer_load_dwordx4 v4, s[8:11], s70 offen offset:2048 lds
    buffer_load_dwordx4 v5, s[8:11], s70 offen offset:3072 lds
    s_mul_i32 s91, s64, 393216
    s_add_u32 s64, s64, 1
    s_and_b32 s64, s64, 15
    s_add_u32 m0, s62, 122880
    s_nop 0
    buffer_load_dwordx4 v6, s[12:15], s91 offen offset:0 lds
    buffer_load_dwordx4 v7, s[12:15], s91 offen offset:1024 lds
    s_add_u32 m0, s62, 131072
    s_nop 0
    buffer_load_dwordx4 v8, s[12:15], s91 offen offset:0 lds
    buffer_load_dwordx4 v9, s[12:15], s91 offen offset:1024 lds
    s_add_u32 m0, s62, 139264
    s_nop 0
    buffer_load_dwordx4 v10, s[12:15], s91 offen offset:0 lds
    buffer_load_dwordx4 v11, s[12:15], s91 offen offset:1024 lds
    s_add_u32 s87, s67, 4
    v_add_u32 v24, s87, v20
    v_and_b32 v24, 15, v24
    v_lshl_add_u32 v123, v24, 7, v125
    v_mov_b32 v24, 2147483648
    v_cmp_gt_u32 vcc, 32, v0
    s_nop 1
    v_cndmask_b32 v123, v24, v123, vcc
    buffer_load_dword v122, v123, s[8:11], 0 offen
    s_cmp_lg_u32 s65, 0
    s_cbranch_scc1 L_h0c0
    ds_read_b128 v[40:43], v28 offset:0
    ds_read_b128 v[44:47], v29 offset:1024
    ds_read_b128 v[48:51], v28 offset:2048
    ds_read_b128 v[52:55], v29 offset:3072
    ds_read_b128 v[56:59], v28 offset:4096
    ds_read_b128 v[60:63], v29 offset:5120
    ds_read_b128 v[64:67], v28 offset:6144
    ds_read_b128 v[68:71], v29 offset:7168
L_h0c0:
    s_cmp_lg_u32 s66, 0
    s_cbranch_scc1 L_h0r0
    ds_read_b128 v[72:75], v16
    ds_read_b128 v[76:79], v17
    ds_read_b128 v[80:83], v18
    ds_read_b128 v[84:87], v19
L_h0r0:
    s_waitcnt lgkmcnt(0)
    s_waitcnt vmcnt(14)
    s_barrier
    s_add_u32 m0, s53, 0
    s_lshl_b32 s70, s64, 7
    s_add_u32 s70, s70, s63
    buffer_load_dwordx4 v2, s[8:11], s70 offen offset:0 lds
    buffer_load_dwordx4 v3, s[8:11], s70 offen offset:1024 lds
    buffer_load_dwordx4 v4, s[8:11], s70 offen offset:2048 lds
    buffer_load_dwordx4 v5, s[8:11], s70 offen offset:3072 lds
    s_mul_i32 s91, s64, 393216
    s_add_u32 s64, s64, 1
    s_and_b32 s64, s64, 15
    s_add_u32 m0, s62, 0
    s_nop 0
    buffer_load_dwordx4 v6, s[12:15], s91 offen offset:0 lds
    buffer_load_dwordx4 v7, s[12:15], s91 offen offset:1024 lds
    s_add_u32 m0, s62, 8192
    s_nop 0
    buffer_load_dwordx4 v8, s[12:15], s91 offen offset:0 lds
    buffer_load_dwordx4 v9, s[12:15], s91 offen offset:1024 lds
    s_add_u32 m0, s62, 16384
    s_nop 0
    buffer_load_dwordx4 v10, s[12:15], s91 offen offset:0 lds
    buffer_load_dwordx4 v11, s[12:15], s91 offen offset:1024 lds
    s_cmp_lg_u32 s65, 1
    s_cbranch_scc1 L_h0c1
    ds_read_b128 v[40:43], v28 offset:0
    ds_read_b128 v[44:47], v29 offset:1024
    ds_read_b128 v[48:51], v28 offset:2048
    ds_read_b128 v[52:55], v29 offset:3072
    ds_read_b128 v[56:59], v28 offset:4096
    ds_read_b128 v[60:63], v29 offset:5120
    ds_read_b128 v[64:67], v28 offset:6144
    ds_read_b128 v[68:71], v29 offset:7168
L_h0c1:
    s_cmp_lg_u32 s66, 1
    s_cbranch_scc1 L_h0r1
    ds_read_b128 v[72:75], v16
    ds_read_b128 v[76:79], v17
    ds_read_b128 v[80:83], v18
    ds_read_b128 v[84:87], v19
L_h0r1:
    s_waitcnt lgkmcnt(0)
    s_waitcnt vmcnt(11)
    s_barrier
    s_add_u32 m0, s53, 40960
    s_lshl_b32 s70, s64, 7
    s_add_u32 s70, s70, s63
    buffer_load_dwordx4 v2, s[8:11], s70 offen offset:0 lds
    buffer_load_dwordx4 v3, s[8:11], s70 offen offset:1024 lds
    buffer_load_dwordx4 v4, s[8:11], s70 offen offset:2048 lds
    buffer_load_dwordx4 v5, s[8:11], s70 offen offset:3072 lds
    s_mul_i32 s91, s64, 393216
    s_add_u32 s64, s64, 1
    s_and_b32 s64, s64, 15
    s_add_u32 m0, s62, 40960
    s_nop 0
    buffer_load_dwordx4 v6, s[12:15], s91 offen offset:0 lds
    buffer_load_dwordx4 v7, s[12:15], s91 offen offset:1024 lds
    s_add_u32 m0, s62, 49152
    s_nop 0
    buffer_load_dwordx4 v8, s[12:15], s91 offen offset:0 lds
    buffer_load_dwordx4 v9, s[12:15], s91 offen offset:1024 lds
    s_add_u32 m0, s62, 57344
    s_nop 0
    buffer_load_dwordx4 v10, s[12:15], s91 offen offset:0 lds
    buffer_load_dwordx4 v11, s[12:15], s91 offen offset:1024 lds
    s_cmp_lg_u32 s65, 2
    s_cbranch_scc1 L_h0c2
    ds_read_b128 v[40:43], v28 offset:0
    ds_read_b128 v[44:47], v29 offset:1024
    ds_read_b128 v[48:51], v28 offset:2048
    ds_read_b128 v[52:55], v29 offset:3072
    ds_read_b128 v[56:59], v28 offset:4096
    ds_read_b128 v[60:63], v29 offset:5120
    ds_read_b128 v[64:67], v28 offset:6144
    ds_read_b128 v[68:71], v29 offset:7168
L_h0c2:
    s_cmp_lg_u32 s66, 2
    s_cbranch_scc1 L_h0r2
    ds_read_b128 v[72:75], v16
    ds_read_b128 v[76:79], v17
    ds_read_b128 v[80:83], v18
    ds_read_b128 v[84:87], v19
L_h0r2:
    s_waitcnt lgkmcnt(0)
    s_waitcnt vmcnt(10)
    s_barrier
    s_add_u32 m0, s53, 81920
    s_lshl_b32 s70, s64, 7
    s_add_u32 s70, s70, s63
    buffer_load_dwordx4 v2, s[8:11], s70 offen offset:0 lds
    buffer_load_dwordx4 v3, s[8:11], s70 offen offset:1024 lds
    buffer_load_dwordx4 v4, s[8:11], s70 offen offset:2048 lds
    buffer_load_dwordx4 v5, s[8:11], s70 offen offset:3072 lds
    s_mul_i32 s91, s64, 393216
    s_add_u32 s64, s64, 1
    s_and_b32 s64, s64, 15
    s_add_u32 m0, s62, 81920
    s_nop 0
    buffer_load_dwordx4 v6, s[12:15], s91 offen offset:0 lds
    buffer_load_dwordx4 v7, s[12:15], s91 offen offset:1024 lds
    s_add_u32 m0, s62, 90112
    s_nop 0
    buffer_load_dwordx4 v8, s[12:15], s91 offen offset:0 lds
L_walkB0:
    s_cbranch_execz L_walk_4
    buffer_load_dwordx4 v9, s[12:15], s91 offen offset:1024 lds
    s_add_u32 m0, s62, 98304
    s_nop 0
    buffer_load_dwordx4 v10, s[12:15], s91 offen offset:0 lds
    buffer_load_dwordx4 v11, s[12:15], s91 offen offset:1024 lds
    s_lshr_b32 s90, s67, 2
    s_add_u32 s90, s90, 2
    s_and_b32 s90, s90, 3
    s_mul_i32 s90, s90, 1572864
    buffer_load_dword v39, v37, s[12:15], s90 offen
    s_cmp_lg_u32 s65, 3
    s_cbranch_scc1 L_h0c3
    ds_read_b128 v[40:43], v28 offset:0
    ds_read_b128 v[44:47], v29 offset:1024
    ds_read_b128 v[48:51], v28 offset:2048
    ds_read_b128 v[52:55], v29 offset:3072
    ds_read_b128 v[56:59], v28 offset:4096
    ds_read_b128 v[60:63], v29 offset:5120
    ds_read_b128 v[64:67], v28 offset:6144
    ds_read_b128 v[68:71], v29 offset:7168
L_h0c3:
    s_cmp_lg_u32 s66, 3
    s_cbranch_scc1 L_h0r3
    ds_read_b128 v[72:75], v16
    ds_read_b128 v[76:79], v17
    ds_read_b128 v[80:83], v18
    ds_read_b128 v[84:87], v19
L_h0r3:
    s_waitcnt lgkmcnt(0)
    s_waitcnt vmcnt(11)
    s_barrier
    s_add_u32 m0, s53, 122880
    s_lshl_b32 s70, s64, 7
    s_add_u32 s70, s70, s63
    buffer_load_dwordx4 v2, s[8:11], s70 offen offset:0 lds
    buffer_load_dwordx4 v3, s[8:11], s70 offen offset:1024 lds
    buffer_load_dwordx4 v4, s[8:11], s70 offen offset:2048 lds
    buffer_load_dwordx4 v5, s[8:11], s70 offen offset:3072 lds
    s_mul_i32 s91, s64, 393216
    s_add_u32 s64, s64, 1
    s_and_b32 s64, s64, 15
    s_add_u32 m0, s62, 122880
    s_nop 0
    buffer_load_dwordx4 v6, s[12:15], s91 offen offset:0 lds
    buffer_load_dwordx4 v7, s[12:15], s91 offen offset:1024 lds
    s_add_u32 m0, s62, 131072
    s_nop 0
    buffer_load_dwordx4 v8, s[12:15], s91 offen offset:0 lds
    buffer_load_dwordx4 v9, s[12:15], s91 offen offset:1024 lds
    s_add_u32 m0, s62, 139264
    s_nop 0
    buffer_load_dwordx4 v10, s[12:15], s91 offen offset:0 lds
    buffer_load_dwordx4 v11, s[12:15], s91 offen offset:1024 lds
    s_cmp_lg_u32 s65, 4
    s_cbranch_scc1 L_h0c4
    ds_read_b128 v[40:43], v28 offset:0
    ds_read_b128 v[44:47], v29 offset:1024
    ds_read_b128 v[48:51], v28 offset:2048
    ds_read_b128 v[52:55], v29 offset:3072
    ds_read_b128 v[56:59], v28 offset:4096
    ds_read_b128 v[60:63], v29 offset:5120
    ds_read_b128 v[64:67], v28 offset:6144
    ds_read_b128 v[68:71], v29 offset:7168
L_h0c4:
    s_waitcnt lgkmcnt(0)
    v_mov_b32 v88, 0
    v_mov_b32 v89, 0
    v_mov_b32 v90, 0
    v_mov_b32 v91, 0
    v_mov_b32 v92, 0
    v_mov_b32 v93, 0
    v_mov_b32 v94, 0
    v_mov_b32 v95, 0
    v_dot2c_f32_bf16 v88, s95, v72
    v_dot2c_f32_bf16 v89, s95, v73
    v_dot2c_f32_bf16 v90, s95, v74
    v_dot2c_f32_bf16 v91, s95, v75
    v_dot2c_f32_bf16 v92, v72, v72
    v_dot2c_f32_bf16 v93, v73, v73
    v_dot2c_f32_bf16 v94, v74, v74
    v_dot2c_f32_bf16 v95, v75, v75
    v_dot2c_f32_bf16 v88, s95, v76
    v_dot2c_f32_bf16 v89, s95, v77
    v_dot2c_f32_bf16 v90, s95, v78
    v_dot2c_f32_bf16 v91, s95, v79
    v_dot2c_f32_bf16 v92, v76, v76
    v_dot2c_f32_bf16 v93, v77, v77
    v_dot2c_f32_bf16 v94, v78, v78
    v_dot2c_f32_bf16 v95, v79, v79
    v_dot2c_f32_bf16 v88, s95, v80
    v_dot2c_f32_bf16 v89, s95, v81
    v_dot2c_f32_bf16 v90, s95, v82
    v_dot2c_f32_bf16 v91, s95, v83
    v_dot2c_f32_bf16 v92, v80, v80
    v_dot2c_f32_bf16 v93, v81, v81
    v_dot2c_f32_bf16 v94, v82, v82
    v_dot2c_f32_bf16 v95, v83, v83
    v_dot2c_f32_bf16 v88, s95, v84
    v_dot2c_f32_bf16 v89, s95, v85
    v_dot2c_f32_bf16 v90, s95, v86
    v_dot2c_f32_bf16 v91, s95, v87
    v_dot2c_f32_bf16 v92, v84, v84
    v_dot2c_f32_bf16 v93, v85, v85
    v_dot2c_f32_bf16 v94, v86, v86
    v_dot2c_f32_bf16 v95, v87, v87
    s_waitcnt vmcnt(11)
    s_barrier
    s_add_u32 m0, s53, 0
    s_lshl_b32 s70, s64, 7
    s_add_u32 s70, s70, s63
    buffer_load_dwordx4 v2, s[8:11], s70 offen offset:0 lds
    buffer_load_dwordx4 v3, s[8:11], s70 offen offset:1024 lds
    buffer_load_dwordx4 v4, s[8:11], s70 offen offset:2048 lds
    buffer_load_dwordx4 v5, s[8:11], s70 offen offset:3072 lds
    s_mul_i32 s91, s64, 393216
    s_add_u32 s64, s64, 1
    s_and_b32 s64, s64, 15
    s_add_u32 m0, s62, 0
    s_nop 0
    buffer_load_dwordx4 v6, s[12:15], s91 offen offset:0 lds
    buffer_load_dwordx4 v7, s[12:15], s91 offen offset:1024 lds
    s_add_u32 m0, s62, 8192
    s_nop 0
    buffer_load_dwordx4 v8, s[12:15], s91 offen offset:0 lds
    buffer_load_dwordx4 v9, s[12:15], s91 offen offset:1024 lds
    s_add_u32 m0, s62, 16384
    s_nop 0
    buffer_load_dwordx4 v10, s[12:15], s91 offen offset:0 lds
    buffer_load_dwordx4 v11, s[12:15], s91 offen offset:1024 lds
    buffer_load_dword v39, v38, s[20:23], 0 offen
    s_cmp_lg_u32 s65, 5
    s_cbranch_scc1 L_h0c5
    ds_read_b128 v[40:43], v28 offset:0
    ds_read_b128 v[44:47], v29 offset:1024
    ds_read_b128 v[48:51], v28 offset:2048
    ds_read_b128 v[52:55], v29 offset:3072
    ds_read_b128 v[56:59], v28 offset:4096
    ds_read_b128 v[60:63], v29 offset:5120
    ds_read_b128 v[64:67], v28 offset:6144
    ds_read_b128 v[68:71], v29 offset:7168
L_h0c5:
    s_waitcnt lgkmcnt(0)
    v_pk_add_f32 v[88:89], v[88:89], v[90:91]
    v_pk_add_f32 v[92:93], v[92:93], v[94:95]
    v_add_f32 v88, v88, v89
    v_add_f32 v89, v92, v93
    s_nop 0
    v_add_f32_dpp v88, v88, v88 quad_perm:[1,0,3,2] row_mask:0xf bank_mask:0xf
    v_add_f32_dpp v89, v89, v89 quad_perm:[1,0,3,2] row_mask:0xf bank_mask:0xf
    s_nop 0
    v_mov_b32_dpp v90, v88 quad_perm:[2,2,2,2] row_mask:0xf bank_mask:0xf
    v_mov_b32_dpp v91, v89 quad_perm:[2,2,2,2] row_mask:0xf bank_mask:0xf
    buffer_store_dwordx4 v[88:91], v13, s[16:19], 0 offen sc1
    s_lshl_b32 s86, s48, 7
    s_add_u32 s86, s86, 131072
    v_lshl_add_u32 v16, v23, 3, s86
    v_lshrrev_b32 v17, 5, v0
    v_lshl_add_u32 v16, v17, 2, v16
    s_lshl_b32 s86, s48, 8
    s_add_u32 s86, s86, 132608
    v_lshl_add_u32 v17, v23, 4, s86
    v_lshl_add_u32 v17, v22, 2, v17
    s_waitcnt vmcnt(12)
    s_barrier
    s_add_u32 m0, s53, 40960
    s_lshl_b32 s70, s64, 7
    s_add_u32 s70, s70, s63
    buffer_load_dwordx4 v2, s[8:11], s70 offen offset:0 lds
    buffer_load_dwordx4 v3, s[8:11], s70 offen offset:1024 lds
    buffer_load_dwordx4 v4, s[8:11], s70 offen offset:2048 lds
    buffer_load_dwordx4 v5, s[8:11], s70 offen offset:3072 lds
    s_mul_i32 s91, s64, 393216
    s_add_u32 s64, s64, 1
    s_and_b32 s64, s64, 15
    s_add_u32 m0, s62, 40960
    s_nop 0
    buffer_load_dwordx4 v6, s[12:15], s91 offen offset:0 lds
    buffer_load_dwordx4 v7, s[12:15], s91 offen offset:1024 lds
    s_add_u32 m0, s62, 49152
    s_nop 0
    buffer_load_dwordx4 v8, s[12:15], s91 offen offset:0 lds
    buffer_load_dwordx4 v9, s[12:15], s91 offen offset:1024 lds
    s_add_u32 m0, s62, 57344
    s_nop 0
    buffer_load_dwordx4 v10, s[12:15], s91 offen offset:0 lds
L_walkB1:
    s_cbranch_execz L_walk_5
    buffer_load_dwordx4 v11, s[12:15], s91 offen offset:1024 lds
    s_lshr_b32 s90, s67, 2
    s_add_u32 s90, s90, 3
    s_and_b32 s90, s90, 3
    s_mul_i32 s90, s90, 1572864
    buffer_load_dword v39, v37, s[12:15], s90 offen
    s_cmp_lg_u32 s65, 6
    s_cbranch_scc1 L_h0c6
    ds_read_b128 v[40:43], v28 offset:0
    ds_read_b128 v[44:47], v29 offset:1024
    ds_read_b128 v[48:51], v28 offset:2048
    ds_read_b128 v[52:55], v29 offset:3072
    ds_read_b128 v[56:59], v28 offset:4096
    ds_read_b128 v[60:63], v29 offset:5120
    ds_read_b128 v[64:67], v28 offset:6144
    ds_read_b128 v[68:71], v29 offset:7168
L_h0c6:
    s_waitcnt lgkmcnt(0)
    s_waitcnt vmcnt(13)
    s_barrier
    s_add_u32 m0, s53, 81920
    s_lshl_b32 s70, s64, 7
    s_add_u32 s70, s70, s63
    buffer_load_dwordx4 v2, s[8:11], s70 offen offset:0 lds
    buffer_load_dwordx4 v3, s[8:11], s70 offen offset:1024 lds
    buffer_load_dwordx4 v4, s[8:11], s70 offen offset:2048 lds
    buffer_load_dwordx4 v5, s[8:11], s70 offen offset:3072 lds
    s_mul_i32 s91, s64, 393216
    s_add_u32 s64, s64, 1
    s_and_b32 s64, s64, 15
    s_add_u32 m0, s62, 81920
    s_nop 0
    buffer_load_dwordx4 v6, s[12:15], s91 offen offset:0 lds
    buffer_load_dwordx4 v7, s[12:15], s91 offen offset:1024 lds
    s_add_u32 m0, s62, 90112
    s_nop 0
    buffer_load_dwordx4 v8, s[12:15], s91 offen offset:0 lds
    buffer_load_dwordx4 v9, s[12:15], s91 offen offset:1024 lds
    s_add_u32 m0, s62, 98304
    s_nop 0
    buffer_load_dwordx4 v10, s[12:15], s91 offen offset:0 lds
    buffer_load_dwordx4 v11, s[12:15], s91 offen offset:1024 lds
    s_add_u32 m0, s53, 122880
    s_lshl_b32 s70, s64, 7
    s_add_u32 s70, s70, s63
    buffer_load_dwordx4 v2, s[8:11], s70 offen offset:0 lds
    buffer_load_dwordx4 v3, s[8:11], s70 offen offset:1024 lds
    s_cmp_lg_u32 s65, 7
    s_cbranch_scc1 L_h0c7
    ds_read_b128 v[40:43], v28 offset:0
    ds_read_b128 v[44:47], v29 offset:1024
    ds_read_b128 v[48:51], v28 offset:2048
    ds_read_b128 v[52:55], v29 offset:3072
    ds_read_b128 v[56:59], v28 offset:4096
    ds_read_b128 v[60:63], v29 offset:5120
    ds_read_b128 v[64:67], v28 offset:6144
    ds_read_b128 v[68:71], v29 offset:7168
L_h0c7:
    s_waitcnt lgkmcnt(0)
    s_waitcnt vmcnt(13)
    s_barrier
    s_add_u32 m0, s53, 122880
    s_nop 0
    buffer_load_dwordx4 v4, s[8:11], s70 offen offset:2048 lds
    buffer_load_dwordx4 v5, s[8:11], s70 offen offset:3072 lds
    s_mul_i32 s91, s64, 393216
    s_add_u32 s64, s64, 1
    s_and_b32 s64, s64, 15
    s_add_u32 m0, s62, 122880
    s_nop 0
    buffer_load_dwordx4 v6, s[12:15], s91 offen offset:0 lds
    buffer_load_dwordx4 v7, s[12:15], s91 offen offset:1024 lds
    s_add_u32 m0, s62, 131072
    s_nop 0
    buffer_load_dwordx4 v8, s[12:15], s91 offen offset:0 lds
    buffer_load_dwordx4 v9, s[12:15], s91 offen offset:1024 lds
    s_add_u32 m0, s62, 139264
    s_nop 0
    buffer_load_dwordx4 v10, s[12:15], s91 offen offset:0 lds
    buffer_load_dwordx4 v11, s[12:15], s91 offen offset:1024 lds
    s_add_u32 m0, s53, 0
    s_lshl_b32 s70, s64, 7
    s_add_u32 s70, s70, s63
    buffer_load_dwordx4 v2, s[8:11], s70 offen offset:0 lds
    buffer_load_dwordx4 v3, s[8:11], s70 offen offset:1024 lds
    v_mfma_f32_16x16x32_bf16 v[108:111], v[104:107], v[40:43], 0
    v_mfma_f32_16x16x32_bf16 v[108:111], v[104:107], v[44:47], v[108:111]
    v_mfma_f32_16x16x32_bf16 v[108:111], v[104:107], v[48:51], v[108:111]
    v_mfma_f32_16x16x32_bf16 v[108:111], v[104:107], v[52:55], v[108:111]
    v_mfma_f32_16x16x32_bf16 v[108:111], v[104:107], v[56:59], v[108:111]
    v_mfma_f32_16x16x32_bf16 v[108:111], v[104:107], v[60:63], v[108:111]
    v_mfma_f32_16x16x32_bf16 v[108:111], v[104:107], v[64:67], v[108:111]
    v_mfma_f32_16x16x32_bf16 v[108:111], v[104:107], v[68:71], v[108:111]
    s_nop 7
    v_add_f32_dpp v108, v108, v108 row_ror:8 row_mask:0xf bank_mask:0xf
    v_add_f32_dpp v109, v109, v109 row_ror:8 row_mask:0xf bank_mask:0xf
    v_add_f32_dpp v110, v110, v110 row_ror:8 row_mask:0xf bank_mask:0xf
    v_add_f32_dpp v111, v111, v111 row_ror:8 row_mask:0xf bank_mask:0xf
    buffer_store_dwordx4 v[108:111], v34, s[16:19], 0 offen sc1
    s_waitcnt vmcnt(13)
    s_barrier
    s_add_u32 m0, s53, 0
    s_nop 0
    buffer_load_dwordx4 v4, s[8:11], s70 offen offset:2048 lds
    buffer_load_dwordx4 v5, s[8:11], s70 offen offset:3072 lds
    s_mul_i32 s91, s64, 393216
    s_add_u32 s64, s64, 1
    s_and_b32 s64, s64, 15
    s_add_u32 m0, s62, 0
    s_nop 0
    buffer_load_dwordx4 v6, s[12:15], s91 offen offset:0 lds
    buffer_load_dwordx4 v7, s[12:15], s91 offen offset:1024 lds
    s_add_u32 m0, s62, 8192
    s_nop 0
    buffer_load_dwordx4 v8, s[12:15], s91 offen offset:0 lds
    buffer_load_dwordx4 v9, s[12:15], s91 offen offset:1024 lds
    s_add_u32 m0, s62, 16384
    s_nop 0
    buffer_load_dwordx4 v10, s[12:15], s91 offen offset:0 lds
    buffer_load_dwordx4 v11, s[12:15], s91 offen offset:1024 lds
    s_add_u32 m0, s53, 40960
    s_lshl_b32 s70, s64, 7
    s_add_u32 s70, s70, s63
    buffer_load_dwordx4 v2, s[8:11], s70 offen offset:0 lds
    buffer_load_dwordx4 v3, s[8:11], s70 offen offset:1024 lds
    buffer_load_dwordx4 v4, s[8:11], s70 offen offset:2048 lds
    buffer_load_dwordx4 v5, s[8:11], s70 offen offset:3072 lds
    s_mul_i32 s91, s64, 393216
    s_add_u32 s64, s64, 1
    s_and_b32 s64, s64, 15
    s_waitcnt vmcnt(12)
    s_barrier
    buffer_atomic_swap v35, v116, s[16:19], 0 offen sc1
    s_add_u32 m0, s62, 40960
    s_nop 0
    buffer_load_dwordx4 v6, s[12:15], s91 offen offset:0 lds
    buffer_load_dwordx4 v7, s[12:15], s91 offen offset:1024 lds
    s_add_u32 m0, s62, 49152
    s_nop 0
    buffer_load_dwordx4 v8, s[12:15], s91 offen offset:0 lds
    buffer_load_dwordx4 v9, s[12:15], s91 offen offset:1024 lds
    s_add_u32 m0, s62, 57344
    s_nop 0
    buffer_load_dwordx4 v10, s[12:15], s91 offen offset:0 lds
    buffer_load_dwordx4 v11, s[12:15], s91 offen offset:1024 lds
    s_add_u32 m0, s53, 81920
    s_lshl_b32 s70, s64, 7
    s_add_u32 s70, s70, s63
    buffer_load_dwordx4 v2, s[8:11], s70 offen offset:0 lds
    buffer_load_dwordx4 v3, s[8:11], s70 offen offset:1024 lds
    buffer_load_dwordx4 v4, s[8:11], s70 offen offset:2048 lds
    buffer_load_dwordx4 v5, s[8:11], s70 offen offset:3072 lds
    s_mul_i32 s91, s64, 393216
    s_add_u32 s64, s64, 1
    s_and_b32 s64, s64, 15
    s_add_u32 m0, s62, 81920
    s_nop 0
    buffer_load_dwordx4 v6, s[12:15], s91 offen offset:0 lds
    buffer_load_dwordx4 v7, s[12:15], s91 offen offset:1024 lds
    s_waitcnt vmcnt(17)
    s_barrier
    buffer_load_dword v121, v119, s[16:19], 0 offen sc1
    s_add_u32 m0, s62, 90112
    s_nop 0
    buffer_load_dwordx4 v8, s[12:15], s91 offen offset:0 lds
    buffer_load_dwordx4 v9, s[12:15], s91 offen offset:1024 lds
    s_add_u32 m0, s62, 98304
L_walk_4:
    s_cbranch_execz L_walk_8
    s_nop 0
    buffer_load_dwordx4 v10, s[12:15], s91 offen offset:0 lds
    buffer_load_dwordx4 v11, s[12:15], s91 offen offset:1024 lds
    s_add_u32 m0, s53, 122880
    s_lshl_b32 s70, s64, 7
    s_add_u32 s70, s70, s63
    buffer_load_dwordx4 v2, s[8:11], s70 offen offset:0 lds
    buffer_load_dwordx4 v3, s[8:11], s70 offen offset:1024 lds
    buffer_load_dwordx4 v4, s[8:11], s70 offen offset:2048 lds
    buffer_load_dwordx4 v5, s[8:11], s70 offen offset:3072 lds
    s_mul_i32 s91, s64, 393216
    s_add_u32 s64, s64, 1
    s_and_b32 s64, s64, 15
    s_add_u32 m0, s62, 122880
    s_nop 0
    buffer_load_dwordx4 v6, s[12:15], s91 offen offset:0 lds
    buffer_load_dwordx4 v7, s[12:15], s91 offen offset:1024 lds
    s_add_u32 m0, s62, 131072
    s_nop 0
    buffer_load_dwordx4 v8, s[12:15], s91 offen offset:0 lds
    buffer_load_dwordx4 v9, s[12:15], s91 offen offset:1024 lds
    s_waitcnt vmcnt(19)
    s_barrier
    s_add_u32 m0, s62, 139264
    s_nop 0
    buffer_load_dwordx4 v10, s[12:15], s91 offen offset:0 lds
    buffer_load_dwordx4 v11, s[12:15], s91 offen offset:1024 lds
    s_add_u32 m0, s53, 0
    s_lshl_b32 s70, s64, 7
    s_add_u32 s70, s70, s63
    buffer_load_dwordx4 v2, s[8:11], s70 offen offset:0 lds
    buffer_load_dwordx4 v3, s[8:11], s70 offen offset:1024 lds
    buffer_load_dwordx4 v4, s[8:11], s70 offen offset:2048 lds
    buffer_load_dwordx4 v5, s[8:11], s70 offen offset:3072 lds
    s_mul_i32 s91, s64, 393216
    s_add_u32 s64, s64, 1
    s_and_b32 s64, s64, 15
    s_add_u32 m0, s62, 0
    s_nop 0
    buffer_load_dwordx4 v6, s[12:15], s91 offen offset:0 lds
    buffer_load_dwordx4 v7, s[12:15], s91 offen offset:1024 lds
    s_add_u32 m0, s62, 8192
    s_nop 0
    buffer_load_dwordx4 v8, s[12:15], s91 offen offset:0 lds
    buffer_load_dwordx4 v9, s[12:15], s91 offen offset:1024 lds
    s_add_u32 m0, s62, 16384
    s_nop 0
    buffer_load_dwordx4 v10, s[12:15], s91 offen offset:0 lds
    buffer_load_dwordx4 v11, s[12:15], s91 offen offset:1024 lds
    s_waitcnt vmcnt(20)
    s_barrier
    v_mov_b32 v118, 0
    buffer_atomic_or v118, v117, s[16:19], 0 offen sc0 sc1
    s_add_u32 m0, s89, 40960
    s_mov_b32 s90, 655360
    buffer_load_dwordx4 v12, s[20:23], s90 offen lds
    s_add_u32 m0, s89, 45056
    s_mov_b32 s90, 720896
    buffer_load_dwordx4 v12, s[20:23], s90 offen lds
    s_add_u32 m0, s89, 49152
    s_mov_b32 s90, 786432
    buffer_load_dwordx4 v12, s[20:23], s90 offen lds
    s_add_u32 m0, s89, 53248
    s_mov_b32 s90, 851968
    buffer_load_dwordx4 v12, s[20:23], s90 offen lds
    s_mov_b32 s90, 0
    buffer_load_dwordx4 v[164:167], v30, s[32:35], s90 offen
    s_mov_b32 s90, 7168
    buffer_load_dwordx4 v[168:171], v30, s[32:35], s90 offen
    s_mov_b32 s90, 14336
    buffer_load_dwordx4 v[172:175], v30, s[32:35], s90 offen
    s_mov_b32 s90, 21504
    buffer_load_dwordx4 v[176:179], v30, s[32:35], s90 offen
    s_waitcnt vmcnt(19)
    s_barrier
    s_waitcnt vmcnt(8)
    s_branch L_h0_chk0
L_h0_spin:
    v_mov_b32 v118, 0
    buffer_atomic_or v118, v117, s[16:19], 0 offen sc0 sc1
    s_waitcnt vmcnt(0)
L_h0_chk0:
    v_cmp_ne_u32 vcc, s68, v118
    s_nop 0
    s_and_b64 vcc, vcc, s[76:77]
    s_cbranch_vccz L_ok_1
    s_sub_u32 s56, s56, 1
    s_cbranch_scc0 L_h0_spin
    s_mov_b32 s56, 0
L_ok_1:
    v_cmp_eq_u32 vcc, s83, v121
    s_nop 0
    s_cmp_eq_u32 vcc_lo, -1
    s_cselect_b32 s83, 1, 0
    s_mov_b32 s90, 0
    buffer_load_dwordx4 v[40:43], v32, s[16:19], s90 offen sc1
    s_mov_b32 s90, 3072
    buffer_load_dwordx4 v[44:47], v32, s[16:19], s90 offen sc1
    s_mov_b32 s90, 6144
    buffer_load_dwordx4 v[48:51], v32, s[16:19], s90 offen sc1
    s_mov_b32 s90, 9216
    buffer_load_dwordx4 v[52:55], v32, s[16:19], s90 offen sc1
    buffer_load_dwordx4 v[56:59], v33, s[16:19], 0 offen sc1
    buffer_load_dwordx4 v[60:63], v33, s[16:19], s92 offen sc1
    buffer_load_dwordx4 v[64:67], v33, s[16:19], s93 offen sc1
    buffer_load_dwordx4 v[68:71], v33, s[16:19], s94 offen sc1
    s_mov_b32 s90, 28672
    buffer_load_dwordx4 v[180:183], v30, s[32:35], s90 offen
    s_mov_b32 s90, 35840
    buffer_load_dwordx4 v[184:187], v30, s[32:35], s90 offen
    s_mov_b32 s90, 43008
    buffer_load_dwordx4 v[188:191], v30, s[32:35], s90 offen
    s_waitcnt vmcnt(20)
    s_barrier
    v_mov_b32 v24, 135168
    v_lshl_add_u32 v24, v21, 2, v24
    v_mov_b32 v25, 0
    ds_write_b32 v24, v25
    ds_write_b32 v24, v25 offset:28608
    s_add_u32 m0, s89, 57344
    s_mov_b32 s90, 917504
    buffer_load_dwordx4 v12, s[20:23], s90 offen lds
    s_add_u32 m0, s89, 61440
    s_mov_b32 s90, 983040
    buffer_load_dwordx4 v12, s[20:23], s90 offen lds
    s_add_u32 m0, s89, 65536
    s_mov_b32 s90, 1048576
    buffer_load_dwordx4 v12, s[20:23], s90 offen lds
    s_add_u32 m0, s89, 69632
    s_mov_b32 s90, 1114112
    buffer_load_dwordx4 v12, s[20:23], s90 offen lds
    s_add_u32 m0, s89, 73728
    s_mov_b32 s90, 1179648
    buffer_load_dwordx4 v12, s[20:23], s90 offen lds
    s_add_u32 m0, s89, 77824
    s_mov_b32 s90, 1245184
    buffer_load_dwordx4 v12, s[20:23], s90 offen lds
    s_waitcnt vmcnt(9)
    v_add_f32 v40, v40, v44
    v_add_f32 v41, v41, v45
    v_add_f32 v42, v42, v46
    v_add_f32 v43, v43, v47
    v_add_f32 v40, v40, v48
    v_add_f32 v41, v41, v49
    v_add_f32 v42, v42, v50
    v_add_f32 v43, v43, v51
    v_add_f32 v40, v40, v52
    v_add_f32 v41, v41, v53
    v_add_f32 v42, v42, v54
    v_add_f32 v43, v43, v55
    v_add_f32 v56, v56, v60
    v_add_f32 v57, v57, v61
    v_add_f32 v58, v58, v62
    v_add_f32 v59, v59, v63
    v_add_f32 v56, v56, v64
    v_add_f32 v57, v57, v65
    v_add_f32 v58, v58, v66
    v_add_f32 v59, v59, v67
    v_add_f32 v56, v56, v68
    v_add_f32 v57, v57, v69
    v_add_f32 v58, v58, v70
    v_add_f32 v59, v59, v71
    s_nop 0
    v_permlane32_swap_b32 v56, v58
    v_permlane32_swap_b32 v57, v59
    v_permlane32_swap_b32 v40, v42
    v_permlane32_swap_b32 v41, v43
    v_add_f32 v56, v56, v58
    v_add_f32 v57, v57, v59
    v_add_f32 v40, v40, v42
    v_add_f32 v41, v41, v43
    v_mov_b32 v58, v56
    v_mov_b32 v59, v57
    v_permlane16_swap_b32 v40, v41
    v_permlane16_swap_b32 v56, v58
    v_permlane16_swap_b32 v57, v59
    v_add_f32 v40, v40, v41
    v_add_f32 v56, v56, v58
    v_add_f32 v57, v57, v59
    ds_write_b32 v17, v40
    v_mul_f32 v56, 0x3a800000, v56
    v_mul_f32 v57, 0x3a800000, v57
L_walk_5:
    s_cbranch_execz L_walk_9
    v_fma_f32 v57, -v56, v56, v57
    v_max_f32 v57, 0, v57
    v_cvt_pk_bf16_f32 v48, v56, v57
    v_lshlrev_b32 v44, 16, v48
    v_and_b32 v48, 0xffff0000, v48
    v_add_f32 v48, 0x3727c5ac, v48
    v_cvt_pk_bf16_f32 v48, v48, v48
    v_lshlrev_b32 v48, 16, v48
    v_sqrt_f32 v48, v48
    s_nop 0
    v_cvt_pk_bf16_f32 v48, v48, v48
    v_lshlrev_b32 v48, 16, v48
    v_rcp_f32 v46, v48
    v_sub_f32 v44, 0, v44
    v_mul_f32 v48, 0x3fb8aa3b, v46
    ds_write_b32 v16, v44
    ds_write_b32 v16, v46 offset:512
    ds_write_b32 v16, v48 offset:1024
    s_waitcnt lgkmcnt(0)
    s_barrier
    s_setprio 0
    s_add_u32 m0, s89, 81920
    s_mov_b32 s90, 1310720
    buffer_load_dwordx4 v12, s[20:23], s90 offen lds
    s_add_u32 m0, s89, 86016
    s_mov_b32 s90, 1376256
    buffer_load_dwordx4 v12, s[20:23], s90 offen lds
    s_add_u32 m0, s89, 90112
    s_mov_b32 s90, 1441792
    buffer_load_dwordx4 v12, s[20:23], s90 offen lds
    s_add_u32 m0, s89, 94208
    s_mov_b32 s90, 1507328
    buffer_load_dwordx4 v12, s[20:23], s90 offen lds
    s_add_u32 m0, s89, 98304
    s_mov_b32 s90, 1572864
    buffer_load_dwordx4 v12, s[20:23], s90 offen lds
    s_add_u32 m0, s89, 102400
    s_mov_b32 s90, 1638400
    buffer_load_dwordx4 v12, s[20:23], s90 offen lds
    s_add_u32 m0, s89, 0
    s_mov_b32 s90, 0
    buffer_load_dwordx4 v12, s[20:23], s90 offen lds
    s_add_u32 m0, s89, 4096
    s_mov_b32 s90, 65536
    buffer_load_dwordx4 v12, s[20:23], s90 offen lds
    s_add_u32 m0, s89, 8192
    s_mov_b32 s90, 131072
    buffer_load_dwordx4 v12, s[20:23], s90 offen lds
    s_add_u32 m0, s89, 12288
    s_mov_b32 s90, 196608
    buffer_load_dwordx4 v12, s[20:23], s90 offen lds
    s_add_u32 m0, s89, 16384
    s_mov_b32 s90, 262144
    buffer_load_dwordx4 v12, s[20:23], s90 offen lds
    s_add_u32 m0, s89, 20480
    s_mov_b32 s90, 327680
    buffer_load_dwordx4 v12, s[20:23], s90 offen lds
    s_add_u32 m0, s89, 24576
    s_mov_b32 s90, 393216
    buffer_load_dwordx4 v12, s[20:23], s90 offen lds
    s_add_u32 m0, s89, 28672
    s_mov_b32 s90, 458752
    buffer_load_dwordx4 v12, s[20:23], s90 offen lds
    s_add_u32 m0, s89, 32768
    s_mov_b32 s90, 524288
    buffer_load_dwordx4 v12, s[20:23], s90 offen lds
    s_add_u32 m0, s89, 36864
    s_mov_b32 s90, 589824
    buffer_load_dwordx4 v12, s[20:23], s90 offen lds
    s_lshl_b32 s86, s47, 2
    s_add_u32 s86, s86, s48
    s_lshl_b32 s87, s86, 7
    s_add_u32 s87, s87, 671744
    v_lshl_add_u32 v6, v0, 2, s87
    v_mov_b32 v4, 2147483648
    v_cmp_gt_u32 vcc, 16, v0
    s_nop 1
    v_cndmask_b32 v6, v4, v6, vcc
    s_lshl_b32 s86, s86, 14
    s_add_u32 s86, s86, 5242880
    v_lshl_add_u32 v2, v0, 4, s86
    s_lshl_b32 s86, s47, 1
    s_add_u32 s86, s86, s50
    s_lshl_b32 s86, s86, 11
    s_lshl_b32 s87, s49, 6
    s_add_u32 s86, s86, s87
    s_add_u32 s86, s86, 6881280
    v_lshl_add_u32 v3, v23, 7, s86
    v_lshl_add_u32 v3, v22, 4, v3
    v_mov_b32 v112, 0
    v_mov_b32 v113, 0
    v_mov_b32 v114, 0
    v_mov_b32 v115, 0
    v_mov_b32 v116, 0
    v_mov_b32 v117, 0
    v_mov_b32 v118, 0
    v_mov_b32 v119, 0
    s_lshr_b32 s62, s3, 2
    s_lshl_b32 s53, s51, 3
    s_lshl_b32 s86, s48, 1
    s_add_u32 s53, s53, s86
    s_add_u32 s53, s53, s62
    v_lshrrev_b32 v36, 4, v0
    v_and_b32 v37, 15, v0
    s_lshl_b32 s87, s53, 15
    s_lshl_b32 s86, s62, 14
    s_add_u32 s86, s86, s87
    s_add_u32 s86, s86, 1048576
    v_lshl_add_u32 v157, v0, 4, s86
    v_xor_b32 v158, 0x8000, v157
    s_lshl_b32 s86, s51, 1
    s_lshr_b32 s87, s48, 1
    s_add_u32 s86, s86, s87
    s_lshl_b32 s86, s86, 1
    s_add_u32 s86, s86, s62
    s_lshl_b32 s86, s86, 1
    s_and_b32 s87, s48, 1
    s_add_u32 s86, s86, s87
    s_lshl_b32 s86, s86, 7
    s_add_u32 s86, s86, 688128
    v_lshl_add_u32 v159, v0, 2, s86
    v_mov_b32 v38, 2147483648
    v_cmp_gt_u32 vcc, 16, v0
    s_nop 1
    v_cndmask_b32 v159, v38, v159, vcc
    v_bfe_u32 v38, v0, 2, 2
    v_lshl_add_u32 v38, v36, 2, v38
    v_bfe_u32 v39, v38, 1, 2
    v_lshlrev_b32 v38, 7, v38
    v_lshl_add_u32 v38, v39, 5, v38
    v_and_b32 v39, 3, v0
    v_lshl_add_u32 v38, v39, 3, v38
    s_lshl_b32 s86, s62, 16
    s_add_u32 s86, s86, 0
    v_add_u32 v144, s86, v38
    v_xor_b32 v145, 32, v144
    v_xor_b32 v146, 64, v144
    v_xor_b32 v147, 96, v144
    v_cmp_eq_u32 s[4:5], 1, v39
    v_cmp_eq_u32 s[6:7], 2, v39
    v_cmp_eq_u32 s[98:99], 3, v39
    s_lshl_b32 s86, s53, 10
    s_add_u32 s86, s86, 786432
    v_lshl_add_u32 v160, v0, 2, s86
    v_mul_u32_u24 v161, 192, v36
    v_add_u32 v160, v160, v161
    s_mov_b32 s72, 0x00f0000f
    s_mov_b32 s73, 0xf0000f00
    s_mov_b32 s74, 0x0f00f000
    s_mov_b32 s75, 0x0f00f000
    v_lshrrev_b32 v38, 2, v37
    v_lshl_add_u32 v161, v38, 4, v37
    v_lshlrev_b32 v161, 2, v161
    s_lshl_b32 s86, s3, 12
    s_add_u32 s86, s86, 131072
    v_lshl_add_u32 v162, v0, 4, s86
    v_xor_b32 v163, 0x4000, v162
    s_lshl_b32 s86, s52, 7
    v_lshl_add_u32 v36, v36, 3, s86
    s_lshl_b32 s87, s53, 15
    s_add_u32 s87, s87, s86
    s_lshl_b32 s86, s62, 6
    s_add_u32 s87, s87, s86
    v_lshl_add_u32 v39, v37, 11, s87
    v_and_b32 v38, 48, v0
    v_add_u32 v39, v39, v38
    v_xor_b32 v37, 0x8000, v39
    v_lshlrev_b32 v38, 4, v0
    buffer_load_dwordx2 v[148:149], v36, s[40:43], 0 offen offset:0
    buffer_load_dwordx2 v[150:151], v36, s[40:43], 0 offen offset:32
    buffer_load_dwordx2 v[152:153], v36, s[40:43], 0 offen offset:64
    buffer_load_dwordx2 v[154:155], v36, s[40:43], 0 offen offset:96
    buffer_load_dwordx4 v[128:131], v38, s[40:43], 0 offen
L_walk_6:
    s_cbranch_execz L_walk_13
    buffer_load_dwordx4 v[132:135], v38, s[40:43], 0 offen offset:1024
    buffer_load_dwordx4 v[136:139], v39, s[8:11], 0 offen
    buffer_load_dwordx4 v[140:143], v37, s[8:11], 0 offen
    s_mov_b32 s90, 50176
    buffer_load_dwordx4 v[192:195], v30, s[32:35], s90 offen
    s_mov_b32 s90, 57344
    buffer_load_dwordx4 v[196:199], v30, s[32:35], s90 offen
    s_mov_b32 s90, 64512
    buffer_load_dwordx4 v[200:203], v30, s[32:35], s90 offen
    s_waitcnt vmcnt(5)
    v_mov_b32 v4, 0
    buffer_atomic_or v4, v6, s[16:19], 0 offen sc0 sc1
    v_bfe_u32 v36, v0, 2, 1
    v_cmp_eq_u32 vcc, 1, v36
    v_mov_b32 v36, s95
    v_mov_b32 v38, 0
    v_dot2c_f32_bf16 v38, s95, v128
    v_dot2c_f32_bf16 v38, s95, v129
    v_dot2c_f32_bf16 v38, s95, v130
    v_dot2c_f32_bf16 v38, s95, v131
    v_dot2c_f32_bf16 v38, s95, v132
    v_dot2c_f32_bf16 v38, s95, v133
    v_dot2c_f32_bf16 v38, s95, v134
    v_dot2c_f32_bf16 v38, s95, v135
    v_cndmask_b32 v148, v36, v148, vcc
    v_cndmask_b32 v149, v36, v149, vcc
    v_cndmask_b32 v150, v36, v150, vcc
    v_cndmask_b32 v151, v36, v151, vcc
    v_cndmask_b32 v152, v36, v152, vcc
    v_cndmask_b32 v153, v36, v153, vcc
    v_cndmask_b32 v154, v36, v154, vcc
    v_cndmask_b32 v155, v36, v155, vcc
    v_add_f32_dpp v38, v38, v38 row_ror:8 row_mask:0xf bank_mask:0xf
    s_nop 1
    v_add_f32_dpp v38, v38, v38 row_ror:4 row_mask:0xf bank_mask:0xf
    s_nop 1
    v_add_f32_dpp v38, v38, v38 row_ror:2 row_mask:0xf bank_mask:0xf
    s_nop 1
    v_add_f32_dpp v38, v38, v38 row_ror:1 row_mask:0xf bank_mask:0xf
    v_mov_b32 v36, v38
    s_nop 1
    v_permlane32_swap_b32 v38, v36
    v_add_f32 v38, v38, v36
    v_mov_b32 v36, v38
    s_nop 1
    v_permlane16_swap_b32 v38, v36
    v_add_f32 v38, v38, v36
    v_mov_b32 v36, 135200
    v_readfirstlane_b32 s57, v38
    ds_write_b32 v36, v38
    s_mul_i32 s86, s50, 3072
    s_add_u32 s86, s86, 151552
    v_lshl_add_u32 v7, v0, 4, s86
    s_lshl_b32 s86, s49, 10
    v_add_u32 v5, s86, v7
    s_lshl_b32 s86, s49, 3
    v_add_u32 v7, s86, v7
    s_mov_b32 s88, 0xffff0000
    s_mov_b32 s86, 0x00003f80
    s_mov_b32 s87, 0x3f800000
    s_branch L_h1_w0
L_h1_r0:
    s_ff1_i32_b32 s66, s65
    s_bitset0_b32 s65, s66
    s_lshl_b32 s66, s66, 10
    buffer_load_dwordx4 v[40:43], v2, s[16:19], s66 offen sc1
    s_cmp_eq_u32 s65, 0
    s_cbranch_scc1 L_h1_p1
L_h1_r1:
    s_ff1_i32_b32 s66, s65
    s_bitset0_b32 s65, s66
    s_lshl_b32 s66, s66, 10
    buffer_load_dwordx4 v[44:47], v2, s[16:19], s66 offen sc1
    s_cmp_eq_u32 s65, 0
    s_cbranch_scc1 L_h1_p2
L_h1_r2:
    s_ff1_i32_b32 s66, s65
    s_bitset0_b32 s65, s66
    s_lshl_b32 s66, s66, 10
    buffer_load_dwordx4 v[48:51], v2, s[16:19], s66 offen sc1
    s_cmp_eq_u32 s65, 0
    s_cbranch_scc1 L_h1_p3
L_h1_r3:
    s_ff1_i32_b32 s66, s65
    s_bitset0_b32 s65, s66
    s_lshl_b32 s66, s66, 10
    buffer_load_dwordx4 v[52:55], v2, s[16:19], s66 offen sc1
    s_cmp_eq_u32 s65, 0
    s_cbranch_scc1 L_h1_p4
L_h1_r4:
    s_ff1_i32_b32 s66, s65
    s_bitset0_b32 s65, s66
    s_lshl_b32 s66, s66, 10
    buffer_load_dwordx4 v[56:59], v2, s[16:19], s66 offen sc1
    s_cmp_eq_u32 s65, 0
    s_cbranch_scc1 L_h1_p5
L_h1_r5:
    s_ff1_i32_b32 s66, s65
    s_bitset0_b32 s65, s66
    s_lshl_b32 s66, s66, 10
    buffer_load_dwordx4 v[60:63], v2, s[16:19], s66 offen sc1
    s_cmp_eq_u32 s65, 0
    s_cbranch_scc1 L_h1_p6
L_h1_r6:
    s_ff1_i32_b32 s66, s65
    s_bitset0_b32 s65, s66
    s_lshl_b32 s66, s66, 10
    buffer_load_dwordx4 v[64:67], v2, s[16:19], s66 offen sc1
    s_cmp_eq_u32 s65, 0
    s_cbranch_scc1 L_h1_p7
L_h1_r7:
    s_ff1_i32_b32 s66, s65
    s_bitset0_b32 s65, s66
    s_lshl_b32 s66, s66, 10
    buffer_load_dwordx4 v[68:71], v2, s[16:19], s66 offen sc1
    s_cmp_eq_u32 s65, 0
    s_cbranch_scc1 L_h1_p8
L_h1_r8:
    s_ff1_i32_b32 s66, s65
    s_bitset0_b32 s65, s66
    s_lshl_b32 s66, s66, 10
    buffer_load_dwordx4 v[72:75], v2, s[16:19], s66 offen sc1
    s_cmp_eq_u32 s65, 0
    s_cbranch_scc1 L_h1_p9
L_h1_r9:
    s_ff1_i32_b32 s66, s65
    s_bitset0_b32 s65, s66
    s_lshl_b32 s66, s66, 10
    buffer_load_dwordx4 v[76:79], v2, s[16:19], s66 offen sc1
    s_cmp_eq_u32 s65, 0
    s_cbranch_scc1 L_h1_p10
L_h1_r10:
    s_ff1_i32_b32 s66, s65
    s_bitset0_b32 s65, s66
    s_lshl_b32 s66, s66, 10
    buffer_load_dwordx4 v[80:83], v2, s[16:19], s66 offen sc1
    s_cmp_eq_u32 s65, 0
    s_cbranch_scc1 L_h1_p11
L_h1_r11:
    s_ff1_i32_b32 s66, s65
    s_bitset0_b32 s65, s66
    s_lshl_b32 s66, s66, 10
    buffer_load_dwordx4 v[84:87], v2, s[16:19], s66 offen sc1
    s_cmp_eq_u32 s65, 0
    s_cbranch_scc1 L_h1_p12
L_h1_r12:
    s_ff1_i32_b32 s66, s65
    s_bitset0_b32 s65, s66
    s_lshl_b32 s66, s66, 10
    buffer_load_dwordx4 v[88:91], v2, s[16:19], s66 offen sc1
    s_cmp_eq_u32 s65, 0
    s_cbranch_scc1 L_h1_p13
L_h1_r13:
    s_ff1_i32_b32 s66, s65
    s_bitset0_b32 s65, s66
    s_lshl_b32 s66, s66, 10
    buffer_load_dwordx4 v[92:95], v2, s[16:19], s66 offen sc1
    s_cmp_eq_u32 s65, 0
    s_cbranch_scc1 L_h1_p14
L_h1_r14:
    s_ff1_i32_b32 s66, s65
    s_bitset0_b32 s65, s66
    s_lshl_b32 s66, s66, 10
    buffer_load_dwordx4 v[96:99], v2, s[16:19], s66 offen sc1
    s_cmp_eq_u32 s65, 0
    s_cbranch_scc1 L_h1_p15
L_h1_r15:
    s_ff1_i32_b32 s66, s65
    s_bitset0_b32 s65, s66
    s_lshl_b32 s66, s66, 10
    buffer_load_dwordx4 v[100:103], v2, s[16:19], s66 offen sc1
    buffer_load_dwordx4 v[104:107], v3, s[16:19], 0 offen sc1
    s_add_u32 m0, s89, 106496
    s_mov_b32 s90, 1703936
    buffer_load_dwordx4 v12, s[20:23], s90 offen lds
    s_add_u32 m0, s89, 110592
    s_mov_b32 s90, 1769472
    buffer_load_dwordx4 v12, s[20:23], s90 offen lds
    s_add_u32 m0, s89, 114688
    s_mov_b32 s90, 1835008
    buffer_load_dwordx4 v12, s[20:23], s90 offen lds
    s_add_u32 m0, s89, 118784
    s_mov_b32 s90, 1900544
    buffer_load_dwordx4 v12, s[20:23], s90 offen lds
    s_add_u32 m0, s89, 122880
    s_mov_b32 s90, 1966080
    buffer_load_dwordx4 v12, s[20:23], s90 offen lds
    s_add_u32 m0, s89, 126976
    s_mov_b32 s90, 2031616
    buffer_load_dwordx4 v12, s[20:23], s90 offen lds
L_h1_acc:
    s_waitcnt vmcnt(22)
    v_dot2c_f32_bf16 v112, s86, v40
    v_dot2c_f32_bf16 v113, s87, v40
    v_dot2c_f32_bf16 v114, s86, v41
    v_dot2c_f32_bf16 v115, s87, v41
    v_dot2c_f32_bf16 v116, s86, v42
    v_dot2c_f32_bf16 v117, s87, v42
    v_dot2c_f32_bf16 v118, s86, v43
    v_dot2c_f32_bf16 v119, s87, v43
    s_waitcnt vmcnt(21)
    v_dot2c_f32_bf16 v112, s86, v44
    v_dot2c_f32_bf16 v113, s87, v44
    v_dot2c_f32_bf16 v114, s86, v45
    v_dot2c_f32_bf16 v115, s87, v45
    v_dot2c_f32_bf16 v116, s86, v46
    v_dot2c_f32_bf16 v117, s87, v46
    v_dot2c_f32_bf16 v118, s86, v47
    v_dot2c_f32_bf16 v119, s87, v47
    s_waitcnt vmcnt(20)
    v_dot2c_f32_bf16 v112, s86, v48
    v_dot2c_f32_bf16 v113, s87, v48
    v_dot2c_f32_bf16 v114, s86, v49
    v_dot2c_f32_bf16 v115, s87, v49
    v_dot2c_f32_bf16 v116, s86, v50
    v_dot2c_f32_bf16 v117, s87, v50
    v_dot2c_f32_bf16 v118, s86, v51
    v_dot2c_f32_bf16 v119, s87, v51
    v_max3_u32 v4, v43, v47, v51
    s_waitcnt vmcnt(19)
    v_dot2c_f32_bf16 v112, s86, v52
    v_dot2c_f32_bf16 v113, s87, v52
    v_dot2c_f32_bf16 v114, s86, v53
    v_dot2c_f32_bf16 v115, s87, v53
    v_dot2c_f32_bf16 v116, s86, v54
    v_dot2c_f32_bf16 v117, s87, v54
    v_dot2c_f32_bf16 v118, s86, v55
    v_dot2c_f32_bf16 v119, s87, v55
    s_waitcnt vmcnt(18)
    v_dot2c_f32_bf16 v112, s86, v56
    v_dot2c_f32_bf16 v113, s87, v56
    v_dot2c_f32_bf16 v114, s86, v57
    v_dot2c_f32_bf16 v115, s87, v57
    v_dot2c_f32_bf16 v116, s86, v58
    v_dot2c_f32_bf16 v117, s87, v58
    v_dot2c_f32_bf16 v118, s86, v59
    v_dot2c_f32_bf16 v119, s87, v59
    v_max3_u32 v4, v4, v55, v59
L_walk_7:
    s_cbranch_execz L_walk_14
    s_waitcnt vmcnt(17)
    v_dot2c_f32_bf16 v112, s86, v60
    v_dot2c_f32_bf16 v113, s87, v60
    v_dot2c_f32_bf16 v114, s86, v61
    v_dot2c_f32_bf16 v115, s87, v61
    v_dot2c_f32_bf16 v116, s86, v62
    v_dot2c_f32_bf16 v117, s87, v62
    v_dot2c_f32_bf16 v118, s86, v63
    v_dot2c_f32_bf16 v119, s87, v63
    s_waitcnt vmcnt(16)
    v_dot2c_f32_bf16 v112, s86, v64
    v_dot2c_f32_bf16 v113, s87, v64
    v_dot2c_f32_bf16 v114, s86, v65
    v_dot2c_f32_bf16 v115, s87, v65
    v_dot2c_f32_bf16 v116, s86, v66
    v_dot2c_f32_bf16 v117, s87, v66
    v_dot2c_f32_bf16 v118, s86, v67
    v_dot2c_f32_bf16 v119, s87, v67
    v_max3_u32 v4, v4, v63, v67
    s_waitcnt vmcnt(15)
    v_dot2c_f32_bf16 v112, s86, v68
    v_dot2c_f32_bf16 v113, s87, v68
    v_dot2c_f32_bf16 v114, s86, v69
    v_dot2c_f32_bf16 v115, s87, v69
    v_dot2c_f32_bf16 v116, s86, v70
    v_dot2c_f32_bf16 v117, s87, v70
    v_dot2c_f32_bf16 v118, s86, v71
    v_dot2c_f32_bf16 v119, s87, v71
    s_waitcnt vmcnt(14)
    v_dot2c_f32_bf16 v112, s86, v72
    v_dot2c_f32_bf16 v113, s87, v72
    v_dot2c_f32_bf16 v114, s86, v73
    v_dot2c_f32_bf16 v115, s87, v73
    v_dot2c_f32_bf16 v116, s86, v74
    v_dot2c_f32_bf16 v117, s87, v74
    v_dot2c_f32_bf16 v118, s86, v75
    v_dot2c_f32_bf16 v119, s87, v75
    v_max3_u32 v4, v4, v71, v75
    s_waitcnt vmcnt(13)
    v_dot2c_f32_bf16 v112, s86, v76
    v_dot2c_f32_bf16 v113, s87, v76
    v_dot2c_f32_bf16 v114, s86, v77
    v_dot2c_f32_bf16 v115, s87, v77
    v_dot2c_f32_bf16 v116, s86, v78
    v_dot2c_f32_bf16 v117, s87, v78
    v_dot2c_f32_bf16 v118, s86, v79
    v_dot2c_f32_bf16 v119, s87, v79
    s_waitcnt vmcnt(12)
    v_dot2c_f32_bf16 v112, s86, v80
    v_dot2c_f32_bf16 v113, s87, v80
    v_dot2c_f32_bf16 v114, s86, v81
    v_dot2c_f32_bf16 v115, s87, v81
    v_dot2c_f32_bf16 v116, s86, v82
    v_dot2c_f32_bf16 v117, s87, v82
    v_dot2c_f32_bf16 v118, s86, v83
    v_dot2c_f32_bf16 v119, s87, v83
    v_max3_u32 v4, v4, v79, v83
    s_waitcnt vmcnt(11)
    v_dot2c_f32_bf16 v112, s86, v84
    v_dot2c_f32_bf16 v113, s87, v84
    v_dot2c_f32_bf16 v114, s86, v85
    v_dot2c_f32_bf16 v115, s87, v85
    v_dot2c_f32_bf16 v116, s86, v86
    v_dot2c_f32_bf16 v117, s87, v86
    v_dot2c_f32_bf16 v118, s86, v87
    v_dot2c_f32_bf16 v119, s87, v87
    s_waitcnt vmcnt(10)
    v_dot2c_f32_bf16 v112, s86, v88
    v_dot2c_f32_bf16 v113, s87, v88
    v_dot2c_f32_bf16 v114, s86, v89
    v_dot2c_f32_bf16 v115, s87, v89
    v_dot2c_f32_bf16 v116, s86, v90
    v_dot2c_f32_bf16 v117, s87, v90
    v_dot2c_f32_bf16 v118, s86, v91
    v_dot2c_f32_bf16 v119, s87, v91
    v_max3_u32 v4, v4, v87, v91
    s_waitcnt vmcnt(9)
    v_dot2c_f32_bf16 v112, s86, v92
    v_dot2c_f32_bf16 v113, s87, v92
    v_dot2c_f32_bf16 v114, s86, v93
    v_dot2c_f32_bf16 v115, s87, v93
    v_dot2c_f32_bf16 v116, s86, v94
    v_dot2c_f32_bf16 v117, s87, v94
    v_dot2c_f32_bf16 v118, s86, v95
    v_dot2c_f32_bf16 v119, s87, v95
    s_waitcnt vmcnt(8)
    v_dot2c_f32_bf16 v112, s86, v96
    v_dot2c_f32_bf16 v113, s87, v96
    v_dot2c_f32_bf16 v114, s86, v97
    v_dot2c_f32_bf16 v115, s87, v97
    v_dot2c_f32_bf16 v116, s86, v98
    v_dot2c_f32_bf16 v117, s87, v98
    v_dot2c_f32_bf16 v118, s86, v99
    v_dot2c_f32_bf16 v119, s87, v99
    v_max3_u32 v4, v4, v95, v99
    s_waitcnt vmcnt(7)
    v_dot2c_f32_bf16 v112, s86, v100
    v_dot2c_f32_bf16 v113, s87, v100
    v_dot2c_f32_bf16 v114, s86, v101
    v_dot2c_f32_bf16 v115, s87, v101
    v_dot2c_f32_bf16 v116, s86, v102
    v_dot2c_f32_bf16 v117, s87, v102
    v_dot2c_f32_bf16 v118, s86, v103
    v_dot2c_f32_bf16 v119, s87, v103
    s_waitcnt vmcnt(6)
    v_max3_u32 v4, v4, v103, v107
    v_add_f32_dpp v104, v104, v104 row_ror:8 row_mask:0xf bank_mask:0xf
    v_add_f32_dpp v105, v105, v105 row_ror:8 row_mask:0xf bank_mask:0xf
    v_add_f32_dpp v106, v106, v106 row_ror:8 row_mask:0xf bank_mask:0xf
    v_add_f32_dpp v107, v107, v107 row_ror:8 row_mask:0xf bank_mask:0xf
    v_cvt_pk_bf16_f32 v120, v112, v113
    v_cvt_pk_bf16_f32 v121, v114, v115
    v_cvt_pk_bf16_f32 v122, v116, v117
    v_cvt_pk_bf16_f32 v123, v118, v119
    ds_write_b128 v5, v[120:123]
    v_add_f32_dpp v104, v104, v104 row_ror:4 row_mask:0xf bank_mask:0xf
    v_add_f32_dpp v105, v105, v105 row_ror:4 row_mask:0xf bank_mask:0xf
    v_add_f32_dpp v106, v106, v106 row_ror:4 row_mask:0xf bank_mask:0xf
    v_add_f32_dpp v107, v107, v107 row_ror:4 row_mask:0xf bank_mask:0xf
    v_add_f32_dpp v104, v104, v104 row_ror:2 row_mask:0xf bank_mask:0xf
    v_add_f32_dpp v105, v105, v105 row_ror:2 row_mask:0xf bank_mask:0xf
    v_add_f32_dpp v106, v106, v106 row_ror:2 row_mask:0xf bank_mask:0xf
    v_add_f32_dpp v107, v107, v107 row_ror:2 row_mask:0xf bank_mask:0xf
    v_add_f32_dpp v104, v104, v104 row_ror:1 row_mask:0xf bank_mask:0xf
    v_add_f32_dpp v105, v105, v105 row_ror:1 row_mask:0xf bank_mask:0xf
    v_add_f32_dpp v106, v106, v106 row_ror:1 row_mask:0xf bank_mask:0xf
    v_add_f32_dpp v107, v107, v107 row_ror:1 row_mask:0xf bank_mask:0xf
    v_cmp_eq_u32 vcc, -1, v4
    v_cvt_pk_bf16_f32 v124, v104, v105
    v_cvt_pk_bf16_f32 v125, v106, v107
    ds_write_b64 v7, v[124:125] offset:2048
    s_cbranch_vccnz L_h1_again
L_h1_done:
    s_waitcnt lgkmcnt(0)
    s_barrier
    s_or_b32 s86, s2, s48
    s_cmp_eq_u32 s86, 0
    s_cselect_b32 s86, 0, 2147483648
    s_add_u32 s86, s86, 524288
    v_mov_b32 v6, s86
    buffer_store_dword v35, v6, s[16:19], 0 offen sc1
    v_mov_b32 v11, v30
    v_mov_b32 v14, v31
    v_mov_b32 v8, 0
    buffer_atomic_or v8, v159, s[16:19], 0 offen sc0 sc1
    s_branch L_phaseB
L_h1_p0:
L_h1_w0:
    s_waitcnt vmcnt(0)
    v_cmp_eq_u32 vcc, s68, v4
    s_nop 0
    s_andn2_b32 s65, vcc_lo, s88
    s_or_b32 s88, s88, s65
    s_cmp_eq_u32 s88, -1
    s_cbranch_scc1 L_h1_r0
    v_mov_b32 v4, 0
    buffer_atomic_or v4, v6, s[16:19], 0 offen sc0 sc1
    s_mov_b32 s67, 0
    s_cmp_lg_u32 s65, 0
    s_cbranch_scc1 L_h1_r0
    s_sub_u32 s56, s56, 1
    s_cbranch_scc0 L_h1_p0
    s_mov_b32 s56, 0
    s_not_b32 s65, s88
    s_branch L_h1_r0
L_h1_p1:
    s_waitcnt vmcnt(1)
    s_cmp_eq_u32 s67, 0
    s_cbranch_scc1 L_h1_s1
    s_waitcnt vmcnt(0)
L_h1_s1:
    v_cmp_eq_u32 vcc, s68, v4
    s_nop 0
    s_andn2_b32 s65, vcc_lo, s88
    s_or_b32 s88, s88, s65
    s_cmp_eq_u32 s88, -1
    s_cbranch_scc1 L_h1_r1
    v_mov_b32 v4, 0
    buffer_atomic_or v4, v6, s[16:19], 0 offen sc0 sc1
    s_mov_b32 s67, 1
    s_cmp_lg_u32 s65, 0
    s_cbranch_scc1 L_h1_r1
    s_sub_u32 s56, s56, 1
    s_cbranch_scc0 L_h1_p1
    s_mov_b32 s56, 0
    s_not_b32 s65, s88
    s_branch L_h1_r1
L_h1_p2:
    s_waitcnt vmcnt(2)
    s_cmp_eq_u32 s67, 0
    s_cbranch_scc1 L_h1_s2
    s_waitcnt vmcnt(0)
L_h1_s2:
    v_cmp_eq_u32 vcc, s68, v4
    s_nop 0
    s_andn2_b32 s65, vcc_lo, s88
    s_or_b32 s88, s88, s65
    s_cmp_eq_u32 s88, -1
    s_cbranch_scc1 L_h1_r2
    v_mov_b32 v4, 0
    buffer_atomic_or v4, v6, s[16:19], 0 offen sc0 sc1
    s_mov_b32 s67, 2
    s_cmp_lg_u32 s65, 0
    s_cbranch_scc1 L_h1_r2
    s_sub_u32 s56, s56, 1
    s_cbranch_scc0 L_h1_p2
    s_mov_b32 s56, 0
    s_not_b32 s65, s88
    s_branch L_h1_r2
L_h1_p3:
    s_waitcnt vmcnt(3)
    s_cmp_eq_u32 s67, 0
    s_cbranch_scc1 L_h1_s3
    s_waitcnt vmcnt(0)
L_h1_s3:
    v_cmp_eq_u32 vcc, s68, v4
    s_nop 0
    s_andn2_b32 s65, vcc_lo, s88
    s_or_b32 s88, s88, s65
    s_cmp_eq_u32 s88, -1
    s_cbranch_scc1 L_h1_r3
    v_mov_b32 v4, 0
    buffer_atomic_or v4, v6, s[16:19], 0 offen sc0 sc1
    s_mov_b32 s67, 3
    s_cmp_lg_u32 s65, 0
    s_cbranch_scc1 L_h1_r3
    s_sub_u32 s56, s56, 1
    s_cbranch_scc0 L_h1_p3
    s_mov_b32 s56, 0
    s_not_b32 s65, s88
    s_branch L_h1_r3
L_h1_p4:
    s_waitcnt vmcnt(4)
    s_cmp_eq_u32 s67, 0
    s_cbranch_scc1 L_h1_s4
L_walk_8:
    s_cbranch_execz L_walk_15
    s_waitcnt vmcnt(0)
L_h1_s4:
    v_cmp_eq_u32 vcc, s68, v4
    s_nop 0
    s_andn2_b32 s65, vcc_lo, s88
    s_or_b32 s88, s88, s65
    s_cmp_eq_u32 s88, -1
    s_cbranch_scc1 L_h1_r4
    v_mov_b32 v4, 0
    buffer_atomic_or v4, v6, s[16:19], 0 offen sc0 sc1
    s_mov_b32 s67, 4
    s_cmp_lg_u32 s65, 0
    s_cbranch_scc1 L_h1_r4
    s_sub_u32 s56, s56, 1
    s_cbranch_scc0 L_h1_p4
    s_mov_b32 s56, 0
    s_not_b32 s65, s88
    s_branch L_h1_r4
L_h1_p5:
    s_waitcnt vmcnt(5)
    s_cmp_eq_u32 s67, 0
    s_cbranch_scc1 L_h1_s5
    s_waitcnt vmcnt(0)
L_h1_s5:
    v_cmp_eq_u32 vcc, s68, v4
    s_nop 0
    s_andn2_b32 s65, vcc_lo, s88
    s_or_b32 s88, s88, s65
    s_cmp_eq_u32 s88, -1
    s_cbranch_scc1 L_h1_r5
    v_mov_b32 v4, 0
    buffer_atomic_or v4, v6, s[16:19], 0 offen sc0 sc1
    s_mov_b32 s67, 5
    s_cmp_lg_u32 s65, 0
    s_cbranch_scc1 L_h1_r5
    s_sub_u32 s56, s56, 1
    s_cbranch_scc0 L_h1_p5
    s_mov_b32 s56, 0
    s_not_b32 s65, s88
    s_branch L_h1_r5
L_h1_p6:
    s_waitcnt vmcnt(6)
    s_cmp_eq_u32 s67, 0
    s_cbranch_scc1 L_h1_s6
    s_waitcnt vmcnt(0)
L_h1_s6:
    v_cmp_eq_u32 vcc, s68, v4
    s_nop 0
    s_andn2_b32 s65, vcc_lo, s88
    s_or_b32 s88, s88, s65
    s_cmp_eq_u32 s88, -1
    s_cbranch_scc1 L_h1_r6
    v_mov_b32 v4, 0
    buffer_atomic_or v4, v6, s[16:19], 0 offen sc0 sc1
    s_mov_b32 s67, 6
    s_cmp_lg_u32 s65, 0
    s_cbranch_scc1 L_h1_r6
    s_sub_u32 s56, s56, 1
    s_cbranch_scc0 L_h1_p6
    s_mov_b32 s56, 0
    s_not_b32 s65, s88
    s_branch L_h1_r6
L_h1_p7:
    s_waitcnt vmcnt(7)
    s_cmp_eq_u32 s67, 0
    s_cbranch_scc1 L_h1_s7
    s_waitcnt vmcnt(0)
L_h1_s7:
    v_cmp_eq_u32 vcc, s68, v4
    s_nop 0
    s_andn2_b32 s65, vcc_lo, s88
    s_or_b32 s88, s88, s65
    s_cmp_eq_u32 s88, -1
    s_cbranch_scc1 L_h1_r7
    v_mov_b32 v4, 0
    buffer_atomic_or v4, v6, s[16:19], 0 offen sc0 sc1
    s_mov_b32 s67, 7
    s_cmp_lg_u32 s65, 0
    s_cbranch_scc1 L_h1_r7
    s_sub_u32 s56, s56, 1
    s_cbranch_scc0 L_h1_p7
    s_mov_b32 s56, 0
    s_not_b32 s65, s88
    s_branch L_h1_r7
L_h1_p8:
    s_waitcnt vmcnt(8)
    s_cmp_eq_u32 s67, 0
    s_cbranch_scc1 L_h1_s8
    s_waitcnt vmcnt(0)
L_h1_s8:
    v_cmp_eq_u32 vcc, s68, v4
    s_nop 0
    s_andn2_b32 s65, vcc_lo, s88
    s_or_b32 s88, s88, s65
    s_cmp_eq_u32 s88, -1
    s_cbranch_scc1 L_h1_r8
    v_mov_b32 v4, 0
    buffer_atomic_or v4, v6, s[16:19], 0 offen sc0 sc1
    s_mov_b32 s67, 8
    s_cmp_lg_u32 s65, 0
    s_cbranch_scc1 L_h1_r8
    s_sub_u32 s56, s56, 1
    s_cbranch_scc0 L_h1_p8
    s_mov_b32 s56, 0
    s_not_b32 s65, s88
    s_branch L_h1_r8
L_h1_p9:
    s_waitcnt vmcnt(9)
    s_cmp_eq_u32 s67, 0
    s_cbranch_scc1 L_h1_s9
    s_waitcnt vmcnt(0)
L_h1_s9:
    v_cmp_eq_u32 vcc, s68, v4
    s_nop 0
    s_andn2_b32 s65, vcc_lo, s88
    s_or_b32 s88, s88, s65
    s_cmp_eq_u32 s88, -1
    s_cbranch_scc1 L_h1_r9
    v_mov_b32 v4, 0
    buffer_atomic_or v4, v6, s[16:19], 0 offen sc0 sc1
    s_mov_b32 s67, 9
    s_cmp_lg_u32 s65, 0
    s_cbranch_scc1 L_h1_r9
    s_sub_u32 s56, s56, 1
    s_cbranch_scc0 L_h1_p9
    s_mov_b32 s56, 0
    s_not_b32 s65, s88
    s_branch L_h1_r9
L_h1_p10:
    s_waitcnt vmcnt(10)
    s_cmp_eq_u32 s67, 0
    s_cbranch_scc1 L_h1_s10
    s_waitcnt vmcnt(0)
L_h1_s10:
    v_cmp_eq_u32 vcc, s68, v4
    s_nop 0
    s_andn2_b32 s65, vcc_lo, s88
    s_or_b32 s88, s88, s65
    s_cmp_eq_u32 s88, -1
    s_cbranch_scc1 L_h1_r10
    v_mov_b32 v4, 0
    buffer_atomic_or v4, v6, s[16:19], 0 offen sc0 sc1
    s_mov_b32 s67, 10
    s_cmp_lg_u32 s65, 0
    s_cbranch_scc1 L_h1_r10
    s_sub_u32 s56, s56, 1
    s_cbranch_scc0 L_h1_p10
    s_mov_b32 s56, 0
    s_not_b32 s65, s88
    s_branch L_h1_r10
L_h1_p11:
    s_waitcnt vmcnt(11)
    s_cmp_eq_u32 s67, 0
    s_cbranch_scc1 L_h1_s11
    s_waitcnt vmcnt(0)
L_h1_s11:
    v_cmp_eq_u32 vcc, s68, v4
    s_nop 0
    s_andn2_b32 s65, vcc_lo, s88
    s_or_b32 s88, s88, s65
    s_cmp_eq_u32 s88, -1
    s_cbranch_scc1 L_h1_r11
    v_mov_b32 v4, 0
    buffer_atomic_or v4, v6, s[16:19], 0 offen sc0 sc1
    s_mov_b32 s67, 11
    s_cmp_lg_u32 s65, 0
    s_cbranch_scc1 L_h1_r11
    s_sub_u32 s56, s56, 1
    s_cbranch_scc0 L_h1_p11
    s_mov_b32 s56, 0
    s_not_b32 s65, s88
    s_branch L_h1_r11
L_h1_p12:
    s_waitcnt vmcnt(12)
    s_cmp_eq_u32 s67, 0
    s_cbranch_scc1 L_h1_s12
    s_waitcnt vmcnt(0)
L_h1_s12:
    v_cmp_eq_u32 vcc, s68, v4
    s_nop 0
    s_andn2_b32 s65, vcc_lo, s88
    s_or_b32 s88, s88, s65
    s_cmp_eq_u32 s88, -1
    s_cbranch_scc1 L_h1_r12
    v_mov_b32 v4, 0
    buffer_atomic_or v4, v6, s[16:19], 0 offen sc0 sc1
    s_mov_b32 s67, 12
    s_cmp_lg_u32 s65, 0
    s_cbranch_scc1 L_h1_r12
    s_sub_u32 s56, s56, 1
    s_cbranch_scc0 L_h1_p12
    s_mov_b32 s56, 0
    s_not_b32 s65, s88
    s_branch L_h1_r12
L_h1_p13:
    s_waitcnt vmcnt(13)
    s_cmp_eq_u32 s67, 0
    s_cbranch_scc1 L_h1_s13
    s_waitcnt vmcnt(0)
L_h1_s13:
    v_cmp_eq_u32 vcc, s68, v4
    s_nop 0
    s_andn2_b32 s65, vcc_lo, s88
    s_or_b32 s88, s88, s65
    s_cmp_eq_u32 s88, -1
    s_cbranch_scc1 L_h1_r13
    v_mov_b32 v4, 0
    buffer_atomic_or v4, v6, s[16:19], 0 offen sc0 sc1
    s_mov_b32 s67, 13
    s_cmp_lg_u32 s65, 0
    s_cbranch_scc1 L_h1_r13
    s_sub_u32 s56, s56, 1
    s_cbranch_scc0 L_h1_p13
    s_mov_b32 s56, 0
    s_not_b32 s65, s88
    s_branch L_h1_r13
L_h1_p14:
    s_waitcnt vmcnt(14)
    s_cmp_eq_u32 s67, 0
    s_cbranch_scc1 L_h1_s14
    s_waitcnt vmcnt(0)
L_h1_s14:
    v_cmp_eq_u32 vcc, s68, v4
    s_nop 0
    s_andn2_b32 s65, vcc_lo, s88
    s_or_b32 s88, s88, s65
    s_cmp_eq_u32 s88, -1
    s_cbranch_scc1 L_h1_r14
    v_mov_b32 v4, 0
    buffer_atomic_or v4, v6, s[16:19], 0 offen sc0 sc1
    s_mov_b32 s67, 14
    s_cmp_lg_u32 s65, 0
    s_cbranch_scc1 L_h1_r14
    s_sub_u32 s56, s56, 1
    s_cbranch_scc0 L_h1_p14
    s_mov_b32 s56, 0
    s_not_b32 s65, s88
    s_branch L_h1_r14
L_h1_p15:
    s_waitcnt vmcnt(15)
    s_cmp_eq_u32 s67, 0
    s_cbranch_scc1 L_h1_s15
    s_waitcnt vmcnt(0)
L_h1_s15:
    v_cmp_eq_u32 vcc, s68, v4
    s_nop 0
    s_andn2_b32 s65, vcc_lo, s88
    s_or_b32 s88, s88, s65
    s_cmp_eq_u32 s88, -1
    s_cbranch_scc1 L_h1_r15
    v_mov_b32 v4, 0
    buffer_atomic_or v4, v6, s[16:19], 0 offen sc0 sc1
    s_mov_b32 s67, 15
    s_cmp_lg_u32 s65, 0
    s_cbranch_scc1 L_h1_r15
    s_sub_u32 s56, s56, 1
    s_cbranch_scc0 L_h1_p15
    s_mov_b32 s56, 0
    s_not_b32 s65, s88
    s_branch L_h1_r15
L_h1_again:
    s_sub_u32 s56, s56, 1
    s_cbranch_scc0 L_h1_re
    s_mov_b32 s56, 0
    s_branch L_h1_done
L_h1_re:
    buffer_load_dwordx4 v[40:43], v2, s[16:19], 0 offen offset:0 sc1
    buffer_load_dwordx4 v[44:47], v2, s[16:19], 0 offen offset:1024 sc1
    buffer_load_dwordx4 v[48:51], v2, s[16:19], 0 offen offset:2048 sc1
    buffer_load_dwordx4 v[52:55], v2, s[16:19], 0 offen offset:3072 sc1
    buffer_load_dwordx4 v[56:59], v2, s[16:19], s92 offen offset:0 sc1
    buffer_load_dwordx4 v[60:63], v2, s[16:19], s92 offen offset:1024 sc1
    buffer_load_dwordx4 v[64:67], v2, s[16:19], s92 offen offset:2048 sc1
    buffer_load_dwordx4 v[68:71], v2, s[16:19], s92 offen offset:3072 sc1
L_walk_9:
    s_cbranch_execz L_walk_16
    buffer_load_dwordx4 v[72:75], v2, s[16:19], s93 offen offset:0 sc1
    buffer_load_dwordx4 v[76:79], v2, s[16:19], s93 offen offset:1024 sc1
    buffer_load_dwordx4 v[80:83], v2, s[16:19], s93 offen offset:2048 sc1
    buffer_load_dwordx4 v[84:87], v2, s[16:19], s93 offen offset:3072 sc1
    buffer_load_dwordx4 v[88:91], v2, s[16:19], s94 offen offset:0 sc1
    buffer_load_dwordx4 v[92:95], v2, s[16:19], s94 offen offset:1024 sc1
    buffer_load_dwordx4 v[96:99], v2, s[16:19], s94 offen offset:2048 sc1
    buffer_load_dwordx4 v[100:103], v2, s[16:19], s94 offen offset:3072 sc1
    buffer_load_dwordx4 v[104:107], v3, s[16:19], 0 offen sc1
    v_mov_b32 v112, 0
    v_mov_b32 v113, 0
    v_mov_b32 v114, 0
    v_mov_b32 v115, 0
    v_mov_b32 v116, 0
    v_mov_b32 v117, 0
    v_mov_b32 v118, 0
    v_mov_b32 v119, 0
    s_waitcnt vmcnt(0)
    s_branch L_h1_acc
L_comp:
    s_mov_b64 exec, -1
    v_and_b32 v20, 15, v0
    v_lshrrev_b32 v21, 4, v0
    v_bfe_u32 v22, v0, 1, 3
    s_lshl_b32 s86, s49, 13
    v_lshl_add_u32 v20, v20, 7, s86
    v_or_b32 v23, 0, v21
    v_xor_b32 v23, v23, v22
    v_lshl_add_u32 v2, v23, 4, v20
    v_or_b32 v23, 4, v21
    v_xor_b32 v23, v23, v22
    v_lshl_add_u32 v3, v23, 4, v20
    v_bfe_u32 v22, v0, 2, 2
    v_lshl_add_u32 v22, v21, 3, v22
    v_lshlrev_b32 v22, 7, v22
    v_bfe_u32 v23, v0, 3, 2
    s_lshl_b32 s86, s50, 1
    v_xor_b32 v23, s86, v23
    v_lshl_add_u32 v22, v23, 5, v22
    v_and_b32 v23, 3, v0
    v_lshl_add_u32 v22, v23, 3, v22
    v_add_u32 v4, 16384, v22
    v_xor_b32 v5, 32, v4
    s_lshl_b32 s53, s2, 2
    s_add_u32 s53, s53, s3
    s_lshl_b32 s86, s53, 12
    s_add_u32 s86, s86, 1048576
    v_lshl_add_u32 v6, v0, 4, s86
    s_mul_i32 s53, s53, 160
    s_add_u32 s53, s53, 6553600
    v_lshl_add_u32 v17, v0, 4, s53
    v_mov_b32 v16, 2147483648
    v_cmp_gt_u32 vcc, 10, v0
    s_nop 1
    v_cndmask_b32 v17, v16, v17, vcc
    s_lshl2_add_u32 s86, s45, s3
    s_lshr_b32 s87, s86, 3
    s_mul_i32 s87, s87, 14336
    s_and_b32 s86, s86, 7
    s_lshl3_add_u32 s86, s44, s86
    s_mul_i32 s86, s86, 224
    s_add_u32 s86, s86, s87
    s_add_u32 s86, s86, 7864064
    v_lshl_add_u32 v16, v0, 4, s86
    s_mov_b32 vcc_lo, 0x3fff0000
    s_mov_b32 vcc_hi, 0
    v_cndmask_b32 v17, v17, v16, vcc
    s_lshl_b32 s86, s47, 1
    s_add_u32 s86, s86, s50
    s_lshl_b32 s87, s86, 4
    s_add_u32 s87, s87, s46
    s_lshl_b32 s87, s87, 1
    s_add_u32 s87, s87, s49
    s_lshl_b32 s87, s87, 6
    s_add_u32 s87, s87, 6880320
    v_lshl_add_u32 v16, v0, 4, s87
    v_cmp_le_u32 vcc, 60, v0
    s_nop 1
    v_cndmask_b32 v17, v17, v16, vcc
    s_lshl_b32 s87, s86, 1
    s_add_u32 s87, s87, s49
    s_lshl_b32 s87, s87, 4
    s_add_u32 s87, s87, s46
    s_lshl_b32 s87, s87, 10
    s_add_u32 s87, s87, 5242880
    v_lshl_add_u32 v16, v0, 4, s87
    v_mov_b32 v8, -1
    v_mov_b32 v9, -1
    v_mov_b32 v10, -1
    v_mov_b32 v11, -1
    s_waitcnt lgkmcnt(0)
    s_load_dword s61, s[84:85], 524288
    s_mov_b32 s16, s84
    s_and_b32 s17, s85, 0xffff
    s_mov_b32 s18, 268435456
    s_mov_b32 s19, 0x20000
    s_mov_b32 s8, s64
    s_and_b32 s9, s65, 0xffff
    s_mov_b32 s10, 4194304
    s_mov_b32 s11, 0x20000
    s_mov_b32 s20, s68
    s_and_b32 s21, s69, 0xffff
    s_mov_b32 s22, 2097152
    s_mov_b32 s23, 0x20000
    s_mov_b32 s24, s80
    s_and_b32 s25, s81, 0xffff
    s_mov_b32 s26, 4194304
    s_mov_b32 s27, 0x20000
    s_mov_b32 s28, s82
    s_and_b32 s29, s83, 0xffff
    s_mov_b32 s30, 256
    s_mov_b32 s31, 0x20000
    s_bitcmp1_b32 s2, 3
    s_cselect_b32 s32, s76, s74
    s_cselect_b32 s33, s77, s75
    s_and_b32 s33, s33, 0xffff
    s_mov_b32 s34, 7340032
    s_mov_b32 s35, 0x20000
    s_mov_b32 s36, s78
    s_and_b32 s37, s79, 0xffff
    s_mov_b32 s38, 7340032
    s_mov_b32 s39, 0x20000
    s_mov_b32 s40, s72
    s_and_b32 s41, s73, 0xffff
    s_mov_b32 s42, 2048
    s_mov_b32 s43, 0x20000
    s_lshl_b32 s82, s44, 5
    s_or_b32 s82, s82, s45
    s_lshl_b32 s86, s2, 9
    s_add_u32 s86, s86, 786432
    s_cmp_eq_u32 s3, 0
    s_cselect_b32 s86, s86, 2147483648
    v_lshl_add_u32 v7, v0, 2, s86
    v_mul_u32_u24 v12, 192, v21
    v_add_u32 v7, v7, v12
    s_lshl_b32 s86, s2, 8
    s_add_u32 s86, s86, 917376
    s_cmp_eq_u32 s3, 0
    s_cselect_b32 s86, s86, 2147483648
    v_lshl_add_u32 v12, v0, 2, s86
    v_cmp_gt_u32 vcc, 32, v0
    s_nop 1
    v_cndmask_b32 v7, v12, v7, vcc
    v_mov_b32 v12, 2147483648
    v_cmp_gt_u32 vcc, 48, v0
    s_nop 1
    v_cndmask_b32 v7, v12, v7, vcc
    s_lshl_b32 s86, s2, 9
    s_add_u32 s86, s86, 6291456
    v_lshl_add_u32 v13, v0, 2, s86
    v_mul_u32_u24 v12, 64, v21
    v_add_u32 v13, v13, v12
    s_cmp_eq_u32 s3, 1
    s_cselect_b64 vcc, -1, 0
    v_cndmask_b32 v7, v7, v13, vcc
    v_mov_b32 v12, 0
    buffer_store_dword v12, v7, s[16:19], 0 offen sc1
    v_mov_b32 v128, 0
    v_mov_b32 v129, 0
    v_mov_b32 v130, 0
    v_mov_b32 v131, 0
    v_mov_b32 v132, 0
    v_mov_b32 v133, 0
    v_mov_b32 v134, 0
    v_mov_b32 v135, 0
    v_mov_b32 v136, 0
    v_mov_b32 v137, 0
    v_mov_b32 v138, 0
    v_mov_b32 v139, 0
    v_mov_b32 v140, 0
    v_mov_b32 v141, 0
    v_mov_b32 v142, 0
    v_mov_b32 v143, 0
    v_mov_b32 v144, 0
    v_mov_b32 v145, 0
    v_mov_b32 v146, 0
    v_mov_b32 v147, 0
    v_mov_b32 v148, 0
    v_mov_b32 v149, 0
    v_mov_b32 v150, 0
    v_mov_b32 v151, 0
    v_mov_b32 v152, 0
    v_mov_b32 v153, 0
    v_mov_b32 v154, 0
    v_mov_b32 v155, 0
    v_mov_b32 v156, 0
    v_mov_b32 v157, 0
    v_mov_b32 v158, 0
    v_mov_b32 v159, 0
    v_mov_b32 v160, 0
    v_mov_b32 v161, 0
    v_mov_b32 v162, 0
    v_mov_b32 v163, 0
    v_mov_b32 v164, 0
    v_mov_b32 v165, 0
    v_mov_b32 v166, 0
    v_mov_b32 v167, 0
    v_mov_b32 v168, 0
    v_mov_b32 v169, 0
    v_mov_b32 v170, 0
    v_mov_b32 v171, 0
    v_mov_b32 v172, 0
    v_mov_b32 v173, 0
    v_mov_b32 v174, 0
    v_mov_b32 v175, 0
    v_mov_b32 v176, 0
    v_mov_b32 v177, 0
    v_mov_b32 v178, 0
    v_mov_b32 v179, 0
    v_mov_b32 v180, 0
    v_mov_b32 v181, 0
    v_mov_b32 v182, 0
    v_mov_b32 v183, 0
    v_mov_b32 v184, 0
    v_mov_b32 v185, 0
    v_mov_b32 v186, 0
    v_mov_b32 v187, 0
    v_mov_b32 v188, 0
L_walkA2:
    s_cbranch_execz L_comp
    v_mov_b32 v189, 0
    v_mov_b32 v190, 0
    v_mov_b32 v191, 0
    v_mov_b32 v192, 0
    v_mov_b32 v193, 0
    v_mov_b32 v194, 0
    v_mov_b32 v195, 0
    v_mov_b32 v196, 0
    v_mov_b32 v197, 0
    v_mov_b32 v198, 0
    v_mov_b32 v199, 0
    v_mov_b32 v200, 0
    v_mov_b32 v201, 0
    v_mov_b32 v202, 0
    v_mov_b32 v203, 0
    v_mov_b32 v204, 0
    v_mov_b32 v205, 0
    v_mov_b32 v206, 0
    v_mov_b32 v207, 0
    v_mov_b32 v208, 0
    v_mov_b32 v209, 0
    v_mov_b32 v210, 0
    v_mov_b32 v211, 0
    v_mov_b32 v212, 0
    v_mov_b32 v213, 0
    v_mov_b32 v214, 0
    v_mov_b32 v215, 0
    v_mov_b32 v216, 0
    v_mov_b32 v217, 0
    v_mov_b32 v218, 0
    v_mov_b32 v219, 0
    v_mov_b32 v220, 0
    v_mov_b32 v221, 0
    v_mov_b32 v222, 0
    v_mov_b32 v223, 0
    s_mov_b32 s54, 0x358637bd
    s_mov_b32 s55, 0x358637bd
    s_mov_b32 s62, 0
    s_mov_b32 s63, 1
    v_add_u32 v2, 40960, v2
    v_add_u32 v3, 40960, v3
    v_add_u32 v4, 40960, v4
    v_add_u32 v5, 40960, v5
    s_mov_b64 exec, 0
    s_cmp_eq_u32 s3, 0
    s_cbranch_scc1 L_walkB0
    s_cmp_eq_u32 s3, 1
    s_cbranch_scc1 L_walkB1
    s_cmp_eq_u32 s3, 2
    s_cbranch_scc1 L_walkB2
    s_branch L_walkB3
L_walked:
    s_mov_b64 exec, -1
    s_waitcnt lgkmcnt(0)
    s_add_u32 s68, s61, 0x9e3779b9
    s_barrier
    ds_read_b128 v[40:43], v2 offset:0
    ds_read_b128 v[44:47], v2 offset:2048
    ds_read_b128 v[48:51], v2 offset:4096
    ds_read_b128 v[52:55], v2 offset:6144
    ds_read_b64_tr_b16 v[56:57], v4 offset:0
    ds_read_b64_tr_b16 v[58:59], v4 offset:512
    ds_read_b64_tr_b16 v[60:61], v5 offset:0
    ds_read_b64_tr_b16 v[62:63], v5 offset:512
    ds_read_b64_tr_b16 v[64:65], v4 offset:8192
    ds_read_b64_tr_b16 v[66:67], v4 offset:8704
    ds_read_b64_tr_b16 v[68:69], v5 offset:8192
    ds_read_b64_tr_b16 v[70:71], v5 offset:8704
    ds_read_b64_tr_b16 v[72:73], v4 offset:16384
    ds_read_b64_tr_b16 v[74:75], v4 offset:16896
    ds_read_b64_tr_b16 v[76:77], v5 offset:16384
    ds_read_b64_tr_b16 v[78:79], v5 offset:16896
L_cloop:
    s_waitcnt lgkmcnt(0)
    v_mfma_f32_16x16x32_bf16 v[128:131], v[56:59], v[40:43], v[128:131]
    ds_read_b128 v[80:83], v3 offset:0
    v_mfma_f32_16x16x32_bf16 v[144:147], v[60:63], v[40:43], v[144:147]
    ds_read_b128 v[84:87], v3 offset:2048
    v_mfma_f32_16x16x32_bf16 v[148:151], v[60:63], v[44:47], v[148:151]
    ds_read_b128 v[88:91], v3 offset:4096
    v_mfma_f32_16x16x32_bf16 v[132:135], v[56:59], v[44:47], v[132:135]
    ds_read_b128 v[92:95], v3 offset:6144
    v_mfma_f32_16x16x32_bf16 v[136:139], v[56:59], v[48:51], v[136:139]
    ds_read_b64_tr_b16 v[96:97], v4 offset:4096
    v_mfma_f32_16x16x32_bf16 v[152:155], v[60:63], v[48:51], v[152:155]
    ds_read_b64_tr_b16 v[98:99], v4 offset:4608
    v_mfma_f32_16x16x32_bf16 v[156:159], v[60:63], v[52:55], v[156:159]
    ds_read_b64_tr_b16 v[100:101], v5 offset:4096
    v_mfma_f32_16x16x32_bf16 v[140:143], v[56:59], v[52:55], v[140:143]
    ds_read_b64_tr_b16 v[102:103], v5 offset:4608
    v_mfma_f32_16x16x32_bf16 v[172:175], v[52:55], v[64:67], v[172:175]
    ds_read_b64_tr_b16 v[104:105], v4 offset:12288
    v_mfma_f32_16x16x32_bf16 v[188:191], v[52:55], v[68:71], v[188:191]
    ds_read_b64_tr_b16 v[106:107], v4 offset:12800
    v_mfma_f32_16x16x32_bf16 v[184:187], v[48:51], v[68:71], v[184:187]
    ds_read_b64_tr_b16 v[108:109], v5 offset:12288
    v_mfma_f32_16x16x32_bf16 v[168:171], v[48:51], v[64:67], v[168:171]
    ds_read_b64_tr_b16 v[110:111], v5 offset:12800
    v_mfma_f32_16x16x32_bf16 v[164:167], v[44:47], v[64:67], v[164:167]
    ds_read_b64_tr_b16 v[112:113], v4 offset:20480
    v_mfma_f32_16x16x32_bf16 v[180:183], v[44:47], v[68:71], v[180:183]
    ds_read_b64_tr_b16 v[114:115], v4 offset:20992
    v_mfma_f32_16x16x32_bf16 v[176:179], v[40:43], v[68:71], v[176:179]
    ds_read_b64_tr_b16 v[116:117], v5 offset:20480
    v_mfma_f32_16x16x32_bf16 v[160:163], v[40:43], v[64:67], v[160:163]
    ds_read_b64_tr_b16 v[118:119], v5 offset:20992
    v_mfma_f32_16x16x32_bf16 v[192:195], v[40:43], v[72:75], v[192:195]
    s_add_u32 s63, s63, 1
    s_cmp_eq_u32 s63, 4
    s_cselect_b32 s53, 4294803456, 0
    s_cselect_b32 s63, 0, s63
    s_add_u32 s53, s53, 40960
    v_mfma_f32_16x16x32_bf16 v[208:211], v[40:43], v[76:79], v[208:211]
    v_add_u32 v2, s53, v2
    v_mfma_f32_16x16x32_bf16 v[212:215], v[44:47], v[76:79], v[212:215]
    v_add_u32 v4, s53, v4
    v_mfma_f32_16x16x32_bf16 v[196:199], v[44:47], v[72:75], v[196:199]
    v_add_u32 v5, s53, v5
    v_mfma_f32_16x16x32_bf16 v[200:203], v[48:51], v[72:75], v[200:203]
    v_add_u32 v3, s53, v3
    v_mfma_f32_16x16x32_bf16 v[216:219], v[48:51], v[76:79], v[216:219]
    s_cmp_ge_u32 s62, 6
    s_cbranch_scc1 L_cl_none
    buffer_store_dwordx4 v[8:11], v6, s[16:19], 0 offen sc1
    v_add_u32 v6, 1024, v6
    s_cmp_lt_u32 s62, 3
    s_cbranch_scc1 L_cl_none
    v_mov_b32 v6, v16
    v_mov_b32 v16, v17
L_cl_none:
    v_mfma_f32_16x16x32_bf16 v[220:223], v[52:55], v[76:79], v[220:223]
    v_mfma_f32_16x16x32_bf16 v[204:207], v[52:55], v[72:75], v[204:207]
    s_waitcnt lgkmcnt(0)
    v_mfma_f32_16x16x32_bf16 v[128:131], v[96:99], v[80:83], v[128:131]
    s_barrier
    ds_read_b128 v[40:43], v2 offset:0
    v_mfma_f32_16x16x32_bf16 v[144:147], v[100:103], v[80:83], v[144:147]
    ds_read_b128 v[44:47], v2 offset:2048
    v_mfma_f32_16x16x32_bf16 v[148:151], v[100:103], v[84:87], v[148:151]
    ds_read_b128 v[48:51], v2 offset:4096
    v_mfma_f32_16x16x32_bf16 v[132:135], v[96:99], v[84:87], v[132:135]
    ds_read_b128 v[52:55], v2 offset:6144
    v_mfma_f32_16x16x32_bf16 v[136:139], v[96:99], v[88:91], v[136:139]
    ds_read_b64_tr_b16 v[56:57], v4 offset:0
    v_mfma_f32_16x16x32_bf16 v[152:155], v[100:103], v[88:91], v[152:155]
    ds_read_b64_tr_b16 v[58:59], v4 offset:512
    v_mfma_f32_16x16x32_bf16 v[156:159], v[100:103], v[92:95], v[156:159]
    ds_read_b64_tr_b16 v[60:61], v5 offset:0
    v_mfma_f32_16x16x32_bf16 v[140:143], v[96:99], v[92:95], v[140:143]
    ds_read_b64_tr_b16 v[62:63], v5 offset:512
    v_mfma_f32_16x16x32_bf16 v[172:175], v[92:95], v[104:107], v[172:175]
    ds_read_b64_tr_b16 v[64:65], v4 offset:8192
    v_mfma_f32_16x16x32_bf16 v[188:191], v[92:95], v[108:111], v[188:191]
    ds_read_b64_tr_b16 v[66:67], v4 offset:8704
    v_mfma_f32_16x16x32_bf16 v[184:187], v[88:91], v[108:111], v[184:187]
    ds_read_b64_tr_b16 v[68:69], v5 offset:8192
    v_mfma_f32_16x16x32_bf16 v[168:171], v[88:91], v[104:107], v[168:171]
    ds_read_b64_tr_b16 v[70:71], v5 offset:8704
    v_mfma_f32_16x16x32_bf16 v[164:167], v[84:87], v[104:107], v[164:167]
    ds_read_b64_tr_b16 v[72:73], v4 offset:16384
    v_mfma_f32_16x16x32_bf16 v[180:183], v[84:87], v[108:111], v[180:183]
    ds_read_b64_tr_b16 v[74:75], v4 offset:16896
    v_mfma_f32_16x16x32_bf16 v[176:179], v[80:83], v[108:111], v[176:179]
    ds_read_b64_tr_b16 v[76:77], v5 offset:16384
    v_mfma_f32_16x16x32_bf16 v[160:163], v[80:83], v[104:107], v[160:163]
    ds_read_b64_tr_b16 v[78:79], v5 offset:16896
    v_mfma_f32_16x16x32_bf16 v[192:195], v[80:83], v[112:115], v[192:195]
    v_mfma_f32_16x16x32_bf16 v[208:211], v[80:83], v[116:119], v[208:211]
    s_cmp_lg_u32 s62, 8
    s_cbranch_scc1 L_cl_nw
    s_waitcnt vmcnt(0)
L_cl_nw:
    v_mfma_f32_16x16x32_bf16 v[212:215], v[84:87], v[116:119], v[212:215]
L_walkB2:
    s_cbranch_execz L_walk_6
    v_mfma_f32_16x16x32_bf16 v[196:199], v[84:87], v[112:115], v[196:199]
    v_mfma_f32_16x16x32_bf16 v[200:203], v[88:91], v[112:115], v[200:203]
    s_add_u32 s62, s62, 1
    v_mfma_f32_16x16x32_bf16 v[216:219], v[88:91], v[116:119], v[216:219]
    v_mfma_f32_16x16x32_bf16 v[220:223], v[92:95], v[116:119], v[220:223]
    v_mfma_f32_16x16x32_bf16 v[204:207], v[92:95], v[112:115], v[204:207]
    s_cmp_lt_u32 s62, 15
    s_cbranch_scc1 L_cloop
    s_waitcnt lgkmcnt(0)
    v_mfma_f32_16x16x32_bf16 v[160:163], v[40:43], v[64:67], v[160:163]
    ds_read_b128 v[80:83], v3 offset:0
    v_mfma_f32_16x16x32_bf16 v[176:179], v[40:43], v[68:71], v[176:179]
    ds_read_b128 v[84:87], v3 offset:2048
    v_mfma_f32_16x16x32_bf16 v[180:183], v[44:47], v[68:71], v[180:183]
    ds_read_b128 v[88:91], v3 offset:4096
    v_mfma_f32_16x16x32_bf16 v[164:167], v[44:47], v[64:67], v[164:167]
    ds_read_b128 v[92:95], v3 offset:6144
    v_mfma_f32_16x16x32_bf16 v[168:171], v[48:51], v[64:67], v[168:171]
    ds_read_b64_tr_b16 v[104:105], v4 offset:12288
    v_mfma_f32_16x16x32_bf16 v[184:187], v[48:51], v[68:71], v[184:187]
    ds_read_b64_tr_b16 v[106:107], v4 offset:12800
    v_mfma_f32_16x16x32_bf16 v[188:191], v[52:55], v[68:71], v[188:191]
    ds_read_b64_tr_b16 v[108:109], v5 offset:12288
    v_mfma_f32_16x16x32_bf16 v[172:175], v[52:55], v[64:67], v[172:175]
    ds_read_b64_tr_b16 v[110:111], v5 offset:12800
    v_mfma_f32_16x16x32_bf16 v[204:207], v[52:55], v[72:75], v[204:207]
    ds_read_b64_tr_b16 v[112:113], v4 offset:20480
    v_mfma_f32_16x16x32_bf16 v[220:223], v[52:55], v[76:79], v[220:223]
    ds_read_b64_tr_b16 v[114:115], v4 offset:20992
    v_lshrrev_b32 v21, 4, v0
    v_and_b32 v22, 15, v0
    v_mfma_f32_16x16x32_bf16 v[216:219], v[48:51], v[76:79], v[216:219]
    ds_read_b64_tr_b16 v[116:117], v5 offset:20480
    s_lshl_b32 s86, s49, 8
    s_add_u32 s86, s86, 131072
    v_lshl_add_u32 v6, v21, 4, s86
    v_mfma_f32_16x16x32_bf16 v[200:203], v[48:51], v[72:75], v[200:203]
    ds_read_b64_tr_b16 v[118:119], v5 offset:20992
    v_lshl_add_u32 v7, v22, 2, s86
    v_mfma_f32_16x16x32_bf16 v[196:199], v[44:47], v[72:75], v[196:199]
    ds_read_b64_tr_b16 v[96:97], v4 offset:4096
    s_lshl_b32 s86, s50, 7
    s_add_u32 s86, s86, 132608
    v_lshl_add_u32 v8, v22, 2, s86
    v_mfma_f32_16x16x32_bf16 v[212:215], v[44:47], v[76:79], v[212:215]
    ds_read_b64_tr_b16 v[98:99], v4 offset:4608
    v_lshl_add_u32 v9, v21, 4, s86
    v_mfma_f32_16x16x32_bf16 v[208:211], v[40:43], v[76:79], v[208:211]
    ds_read_b64_tr_b16 v[100:101], v5 offset:4096
    s_lshl_b32 s86, s3, 2
    s_add_u32 s86, s86, 135168
    v_mov_b32 v12, s86
    v_mfma_f32_16x16x32_bf16 v[192:195], v[40:43], v[72:75], v[192:195]
    ds_read_b64_tr_b16 v[102:103], v5 offset:4608
    v_xor_b32 v13, 4, v12
    s_waitcnt lgkmcnt(8)
    v_mfma_f32_16x16x32_bf16 v[160:163], v[80:83], v[104:107], v[160:163]
    v_mfma_f32_16x16x32_bf16 v[176:179], v[80:83], v[108:111], v[176:179]
    v_mfma_f32_16x16x32_bf16 v[180:183], v[84:87], v[108:111], v[180:183]
    v_mfma_f32_16x16x32_bf16 v[164:167], v[84:87], v[104:107], v[164:167]
    v_mfma_f32_16x16x32_bf16 v[168:171], v[88:91], v[104:107], v[168:171]
    s_waitcnt lgkmcnt(0)
    s_barrier
    ds_read_b128 v[64:67], v6 offset:0
    ds_read_b128 v[68:71], v6 offset:64
    v_mfma_f32_16x16x32_bf16 v[184:187], v[88:91], v[108:111], v[184:187]
    ds_read_b128 v[72:75], v6 offset:128
    ds_read_b128 v[76:79], v6 offset:192
    v_mfma_f32_16x16x32_bf16 v[188:191], v[92:95], v[108:111], v[188:191]
    ds_read_b32 v28, v8 offset:256
    ds_read_b32 v29, v8 offset:320
    v_mfma_f32_16x16x32_bf16 v[172:175], v[92:95], v[104:107], v[172:175]
    ds_read_b32 v30, v8 offset:512
    ds_read_b32 v31, v8 offset:576
    v_mfma_f32_16x16x32_bf16 v[204:207], v[92:95], v[112:115], v[204:207]
    ds_read_b128 v[224:227], v6 offset:512
    ds_read_b128 v[228:231], v6 offset:576
    v_mfma_f32_16x16x32_bf16 v[220:223], v[92:95], v[116:119], v[220:223]
    ds_read_b128 v[232:235], v6 offset:640
    ds_read_b128 v[236:239], v6 offset:704
    v_mfma_f32_16x16x32_bf16 v[216:219], v[88:91], v[116:119], v[216:219]
    ds_read_b128 v[240:243], v6 offset:1024
    ds_read_b128 v[244:247], v6 offset:1088
    v_mfma_f32_16x16x32_bf16 v[200:203], v[88:91], v[112:115], v[200:203]
    ds_read_b128 v[248:251], v6 offset:1152
    ds_read_b128 v[252:255], v6 offset:1216
    v_mfma_f32_16x16x32_bf16 v[196:199], v[84:87], v[112:115], v[196:199]
    ds_read_b128 v[32:35], v9 offset:0
    ds_read_b128 v[36:39], v9 offset:64
    v_mfma_f32_16x16x32_bf16 v[212:215], v[84:87], v[116:119], v[212:215]
    v_mfma_f32_16x16x32_bf16 v[208:211], v[80:83], v[116:119], v[208:211]
    v_mfma_f32_16x16x32_bf16 v[192:195], v[80:83], v[112:115], v[192:195]
    ds_read_b32 v104, v7 offset:0
    ds_read_b32 v108, v7 offset:512
    ds_read_b32 v124, v7 offset:1024
    ds_read_b32 v105, v7 offset:64
    ds_read_b32 v109, v7 offset:576
    ds_read_b32 v125, v7 offset:1088
    ds_read_b32 v106, v7 offset:128
    ds_read_b32 v110, v7 offset:640
    ds_read_b32 v126, v7 offset:1152
    ds_read_b32 v107, v7 offset:192
    ds_read_b32 v111, v7 offset:704
    ds_read_b32 v127, v7 offset:1216
    s_waitcnt lgkmcnt(12)
    v_pk_fma_f32 v[160:161], v[64:65], v[28:29], v[160:161] op_sel_hi:[1,0,1]
    v_pk_mul_f32 v[112:113], v[160:161], v[240:241]
    v_pk_fma_f32 v[160:161], v[160:161], v[224:225], s[54:55]
    v_exp_f32 v112, v112 clamp
    v_exp_f32 v113, v113 clamp
    v_max_f32 v160, s54, v160
    v_max_f32 v161, s54, v161
    v_pk_add_f32 v[160:161], v[160:161], v[112:113]
    v_cvt_pk_bf16_f32 v160, v160, v161
    v_pk_fma_f32 v[162:163], v[66:67], v[28:29], v[162:163] op_sel_hi:[1,0,1]
    v_pk_mul_f32 v[114:115], v[162:163], v[242:243]
    v_pk_fma_f32 v[162:163], v[162:163], v[226:227], s[54:55]
    v_exp_f32 v114, v114 clamp
    v_exp_f32 v115, v115 clamp
    v_max_f32 v162, s54, v162
    v_max_f32 v163, s54, v163
    v_pk_add_f32 v[162:163], v[162:163], v[114:115]
    v_cvt_pk_bf16_f32 v161, v162, v163
    v_pk_fma_f32 v[164:165], v[68:69], v[28:29], v[164:165] op_sel_hi:[1,0,1]
    v_pk_mul_f32 v[116:117], v[164:165], v[244:245]
    v_pk_fma_f32 v[164:165], v[164:165], v[228:229], s[54:55]
    v_exp_f32 v116, v116 clamp
    v_exp_f32 v117, v117 clamp
    v_max_f32 v164, s54, v164
    v_max_f32 v165, s54, v165
    v_pk_add_f32 v[164:165], v[164:165], v[116:117]
    v_cvt_pk_bf16_f32 v162, v164, v165
    v_pk_fma_f32 v[166:167], v[70:71], v[28:29], v[166:167] op_sel_hi:[1,0,1]
    v_pk_mul_f32 v[118:119], v[166:167], v[246:247]
    v_pk_fma_f32 v[166:167], v[166:167], v[230:231], s[54:55]
    v_exp_f32 v118, v118 clamp
    v_exp_f32 v119, v119 clamp
    v_max_f32 v166, s54, v166
    v_max_f32 v167, s54, v167
    v_pk_add_f32 v[166:167], v[166:167], v[118:119]
    v_cvt_pk_bf16_f32 v163, v166, v167
    v_pk_fma_f32 v[168:169], v[72:73], v[28:29], v[168:169] op_sel_hi:[1,0,1]
    v_pk_mul_f32 v[112:113], v[168:169], v[248:249]
    v_pk_fma_f32 v[168:169], v[168:169], v[232:233], s[54:55]
    v_exp_f32 v112, v112 clamp
    v_exp_f32 v113, v113 clamp
    v_max_f32 v168, s54, v168
    v_max_f32 v169, s54, v169
L_walkB3:
    s_cbranch_execz L_walk_7
    v_pk_add_f32 v[168:169], v[168:169], v[112:113]
    v_cvt_pk_bf16_f32 v168, v168, v169
    v_pk_fma_f32 v[170:171], v[74:75], v[28:29], v[170:171] op_sel_hi:[1,0,1]
    v_pk_mul_f32 v[114:115], v[170:171], v[250:251]
    v_pk_fma_f32 v[170:171], v[170:171], v[234:235], s[54:55]
    v_exp_f32 v114, v114 clamp
    v_exp_f32 v115, v115 clamp
    v_max_f32 v170, s54, v170
    v_max_f32 v171, s54, v171
    v_pk_add_f32 v[170:171], v[170:171], v[114:115]
    v_cvt_pk_bf16_f32 v169, v170, v171
    v_pk_fma_f32 v[172:173], v[76:77], v[28:29], v[172:173] op_sel_hi:[1,0,1]
    v_pk_mul_f32 v[116:117], v[172:173], v[252:253]
    v_pk_fma_f32 v[172:173], v[172:173], v[236:237], s[54:55]
    v_exp_f32 v116, v116 clamp
    v_exp_f32 v117, v117 clamp
    v_max_f32 v172, s54, v172
    v_max_f32 v173, s54, v173
    v_pk_add_f32 v[172:173], v[172:173], v[116:117]
    v_cvt_pk_bf16_f32 v170, v172, v173
    v_pk_fma_f32 v[174:175], v[78:79], v[28:29], v[174:175] op_sel_hi:[1,0,1]
    v_pk_mul_f32 v[118:119], v[174:175], v[254:255]
    v_pk_fma_f32 v[174:175], v[174:175], v[238:239], s[54:55]
    v_exp_f32 v118, v118 clamp
    v_exp_f32 v119, v119 clamp
    v_max_f32 v174, s54, v174
    v_max_f32 v175, s54, v175
    v_pk_add_f32 v[174:175], v[174:175], v[118:119]
    v_cvt_pk_bf16_f32 v171, v174, v175
    v_pk_fma_f32 v[176:177], v[64:65], v[28:29], v[176:177] op_sel:[0,1,0] op_sel_hi:[1,1,1]
    v_pk_mul_f32 v[112:113], v[176:177], v[240:241]
    v_pk_fma_f32 v[176:177], v[176:177], v[224:225], s[54:55]
    v_exp_f32 v112, v112 clamp
    v_exp_f32 v113, v113 clamp
    v_max_f32 v176, s54, v176
    v_max_f32 v177, s54, v177
    v_pk_add_f32 v[176:177], v[176:177], v[112:113]
    v_cvt_pk_bf16_f32 v176, v176, v177
    v_pk_fma_f32 v[178:179], v[66:67], v[28:29], v[178:179] op_sel:[0,1,0] op_sel_hi:[1,1,1]
    v_pk_mul_f32 v[114:115], v[178:179], v[242:243]
    v_pk_fma_f32 v[178:179], v[178:179], v[226:227], s[54:55]
    v_exp_f32 v114, v114 clamp
    v_exp_f32 v115, v115 clamp
    v_max_f32 v178, s54, v178
    v_max_f32 v179, s54, v179
    v_pk_add_f32 v[178:179], v[178:179], v[114:115]
    v_cvt_pk_bf16_f32 v177, v178, v179
    v_pk_fma_f32 v[180:181], v[68:69], v[28:29], v[180:181] op_sel:[0,1,0] op_sel_hi:[1,1,1]
    v_pk_mul_f32 v[116:117], v[180:181], v[244:245]
    v_pk_fma_f32 v[180:181], v[180:181], v[228:229], s[54:55]
    v_exp_f32 v116, v116 clamp
    v_exp_f32 v117, v117 clamp
    v_max_f32 v180, s54, v180
    v_max_f32 v181, s54, v181
    v_pk_add_f32 v[180:181], v[180:181], v[116:117]
    v_cvt_pk_bf16_f32 v178, v180, v181
    v_pk_fma_f32 v[182:183], v[70:71], v[28:29], v[182:183] op_sel:[0,1,0] op_sel_hi:[1,1,1]
    v_pk_mul_f32 v[118:119], v[182:183], v[246:247]
    v_pk_fma_f32 v[182:183], v[182:183], v[230:231], s[54:55]
    v_exp_f32 v118, v118 clamp
    v_exp_f32 v119, v119 clamp
    v_max_f32 v182, s54, v182
    v_max_f32 v183, s54, v183
    v_pk_add_f32 v[182:183], v[182:183], v[118:119]
    v_cvt_pk_bf16_f32 v179, v182, v183
    v_pk_fma_f32 v[184:185], v[72:73], v[28:29], v[184:185] op_sel:[0,1,0] op_sel_hi:[1,1,1]
    v_pk_mul_f32 v[112:113], v[184:185], v[248:249]
    v_pk_fma_f32 v[184:185], v[184:185], v[232:233], s[54:55]
    v_exp_f32 v112, v112 clamp
    v_exp_f32 v113, v113 clamp
    v_max_f32 v184, s54, v184
    v_max_f32 v185, s54, v185
    v_pk_add_f32 v[184:185], v[184:185], v[112:113]
    v_cvt_pk_bf16_f32 v184, v184, v185
    v_pk_fma_f32 v[186:187], v[74:75], v[28:29], v[186:187] op_sel:[0,1,0] op_sel_hi:[1,1,1]
    v_pk_mul_f32 v[114:115], v[186:187], v[250:251]
    v_pk_fma_f32 v[186:187], v[186:187], v[234:235], s[54:55]
    v_exp_f32 v114, v114 clamp
    v_exp_f32 v115, v115 clamp
    v_max_f32 v186, s54, v186
    v_max_f32 v187, s54, v187
    v_pk_add_f32 v[186:187], v[186:187], v[114:115]
    v_cvt_pk_bf16_f32 v185, v186, v187
    v_pk_fma_f32 v[188:189], v[76:77], v[28:29], v[188:189] op_sel:[0,1,0] op_sel_hi:[1,1,1]
    v_pk_mul_f32 v[116:117], v[188:189], v[252:253]
    v_pk_fma_f32 v[188:189], v[188:189], v[236:237], s[54:55]
    v_exp_f32 v116, v116 clamp
    v_exp_f32 v117, v117 clamp
    v_max_f32 v188, s54, v188
    v_max_f32 v189, s54, v189
    v_pk_add_f32 v[188:189], v[188:189], v[116:117]
    v_cvt_pk_bf16_f32 v186, v188, v189
    v_pk_fma_f32 v[190:191], v[78:79], v[28:29], v[190:191] op_sel:[0,1,0] op_sel_hi:[1,1,1]
    v_pk_mul_f32 v[118:119], v[190:191], v[254:255]
    v_pk_fma_f32 v[190:191], v[190:191], v[238:239], s[54:55]
    v_exp_f32 v118, v118 clamp
    v_exp_f32 v119, v119 clamp
    v_max_f32 v190, s54, v190
    v_max_f32 v191, s54, v191
    v_pk_add_f32 v[190:191], v[190:191], v[118:119]
    v_cvt_pk_bf16_f32 v187, v190, v191
    v_mov_b32 v120, s95
    v_mov_b32 v121, s95
    v_mov_b32 v122, s95
    v_mov_b32 v123, s95
    v_pk_fma_f32 v[192:193], v[64:65], v[30:31], v[192:193] op_sel_hi:[1,0,1]
    v_pk_mul_f32 v[192:193], v[192:193], v[224:225]
    v_cvt_pk_bf16_f32 v192, v192, v193
    v_pk_fma_f32 v[194:195], v[66:67], v[30:31], v[194:195] op_sel_hi:[1,0,1]
    v_pk_mul_f32 v[194:195], v[194:195], v[226:227]
    v_cvt_pk_bf16_f32 v193, v194, v195
    v_pk_fma_f32 v[196:197], v[68:69], v[30:31], v[196:197] op_sel_hi:[1,0,1]
    v_pk_mul_f32 v[196:197], v[196:197], v[228:229]
    v_cvt_pk_bf16_f32 v194, v196, v197
    v_pk_fma_f32 v[198:199], v[70:71], v[30:31], v[198:199] op_sel_hi:[1,0,1]
    v_pk_mul_f32 v[198:199], v[198:199], v[230:231]
    v_cvt_pk_bf16_f32 v195, v198, v199
    v_pk_fma_f32 v[200:201], v[72:73], v[30:31], v[200:201] op_sel_hi:[1,0,1]
    v_pk_mul_f32 v[200:201], v[200:201], v[232:233]
    v_cvt_pk_bf16_f32 v200, v200, v201
    v_pk_fma_f32 v[202:203], v[74:75], v[30:31], v[202:203] op_sel_hi:[1,0,1]
    v_pk_mul_f32 v[202:203], v[202:203], v[234:235]
    v_cvt_pk_bf16_f32 v201, v202, v203
    v_pk_fma_f32 v[204:205], v[76:77], v[30:31], v[204:205] op_sel_hi:[1,0,1]
    v_pk_mul_f32 v[204:205], v[204:205], v[236:237]
    v_cvt_pk_bf16_f32 v202, v204, v205
    v_pk_fma_f32 v[206:207], v[78:79], v[30:31], v[206:207] op_sel_hi:[1,0,1]
    v_pk_mul_f32 v[206:207], v[206:207], v[238:239]
    v_cvt_pk_bf16_f32 v203, v206, v207
    v_pk_fma_f32 v[208:209], v[64:65], v[30:31], v[208:209] op_sel:[0,1,0] op_sel_hi:[1,1,1]
    v_pk_mul_f32 v[208:209], v[208:209], v[224:225]
    v_cvt_pk_bf16_f32 v208, v208, v209
    v_pk_fma_f32 v[210:211], v[66:67], v[30:31], v[210:211] op_sel:[0,1,0] op_sel_hi:[1,1,1]
    v_pk_mul_f32 v[210:211], v[210:211], v[226:227]
    v_cvt_pk_bf16_f32 v209, v210, v211
    v_pk_fma_f32 v[212:213], v[68:69], v[30:31], v[212:213] op_sel:[0,1,0] op_sel_hi:[1,1,1]
    v_pk_mul_f32 v[212:213], v[212:213], v[228:229]
    v_cvt_pk_bf16_f32 v210, v212, v213
    v_pk_fma_f32 v[214:215], v[70:71], v[30:31], v[214:215] op_sel:[0,1,0] op_sel_hi:[1,1,1]
    v_pk_mul_f32 v[214:215], v[214:215], v[230:231]
    v_cvt_pk_bf16_f32 v211, v214, v215
    v_pk_fma_f32 v[216:217], v[72:73], v[30:31], v[216:217] op_sel:[0,1,0] op_sel_hi:[1,1,1]
    v_pk_mul_f32 v[216:217], v[216:217], v[232:233]
    v_cvt_pk_bf16_f32 v216, v216, v217
    v_pk_fma_f32 v[218:219], v[74:75], v[30:31], v[218:219] op_sel:[0,1,0] op_sel_hi:[1,1,1]
    v_pk_mul_f32 v[218:219], v[218:219], v[234:235]
    v_cvt_pk_bf16_f32 v217, v218, v219
    v_pk_fma_f32 v[220:221], v[76:77], v[30:31], v[220:221] op_sel:[0,1,0] op_sel_hi:[1,1,1]
    v_pk_mul_f32 v[220:221], v[220:221], v[236:237]
L_walk_13:
    s_cbranch_execz L_walk_17
    v_cvt_pk_bf16_f32 v218, v220, v221
    v_pk_fma_f32 v[222:223], v[78:79], v[30:31], v[222:223] op_sel:[0,1,0] op_sel_hi:[1,1,1]
    v_pk_mul_f32 v[222:223], v[222:223], v[238:239]
    v_cvt_pk_bf16_f32 v219, v222, v223
    s_mul_i32 s86, s3, 3072
    s_add_u32 s86, s86, 139264
    v_lshl_add_u32 v6, v0, 4, s86
    s_xor_b32 s86, s3, 1
    s_mul_i32 s86, s86, 3072
    s_add_u32 s86, s86, 139264
    v_lshl_add_u32 v7, v0, 4, s86
    s_cmp_eq_u32 s49, 1
    s_cbranch_scc1 L_kv1
    v_mfma_f32_16x16x32_bf16 v[236:239], v[160:163], v[208:211], 0
    v_mfma_f32_16x16x32_bf16 v[240:243], v[176:179], v[208:211], 0
    v_mfma_f32_16x16x32_bf16 v[244:247], v[176:179], v[120:123], 0
    v_mfma_f32_16x16x32_bf16 v[224:227], v[160:163], v[192:195], 0
    v_mfma_f32_16x16x32_bf16 v[228:231], v[176:179], v[192:195], 0
    v_mfma_f32_16x16x32_bf16 v[232:235], v[160:163], v[120:123], 0
    v_mfma_f32_16x16x32_bf16 v[236:239], v[168:171], v[216:219], v[236:239]
    v_mfma_f32_16x16x32_bf16 v[240:243], v[184:187], v[216:219], v[240:243]
    v_mfma_f32_16x16x32_bf16 v[244:247], v[184:187], v[120:123], v[244:247]
    v_mfma_f32_16x16x32_bf16 v[224:227], v[168:171], v[200:203], v[224:227]
    v_mfma_f32_16x16x32_bf16 v[228:231], v[184:187], v[200:203], v[228:231]
    v_mfma_f32_16x16x32_bf16 v[232:235], v[168:171], v[120:123], v[232:235]
    s_branch L_kvd
L_kv1:
    v_mfma_f32_16x16x32_bf16 v[236:239], v[160:163], v[192:195], 0
    v_mfma_f32_16x16x32_bf16 v[240:243], v[176:179], v[192:195], 0
    v_mfma_f32_16x16x32_bf16 v[244:247], v[160:163], v[120:123], 0
    v_mfma_f32_16x16x32_bf16 v[224:227], v[160:163], v[208:211], 0
    v_mfma_f32_16x16x32_bf16 v[228:231], v[176:179], v[208:211], 0
    v_mfma_f32_16x16x32_bf16 v[232:235], v[176:179], v[120:123], 0
    v_mfma_f32_16x16x32_bf16 v[236:239], v[168:171], v[200:203], v[236:239]
    v_mfma_f32_16x16x32_bf16 v[240:243], v[184:187], v[200:203], v[240:243]
    v_mfma_f32_16x16x32_bf16 v[244:247], v[168:171], v[120:123], v[244:247]
    v_mfma_f32_16x16x32_bf16 v[224:227], v[168:171], v[216:219], v[224:227]
    v_mfma_f32_16x16x32_bf16 v[228:231], v[184:187], v[216:219], v[228:231]
    v_mfma_f32_16x16x32_bf16 v[232:235], v[184:187], v[120:123], v[232:235]
L_kvd:
    s_lshl_b32 s86, s47, 1
    s_add_u32 s86, s86, s50
    s_lshl_b32 s87, s86, 1
    s_add_u32 s87, s87, s49
    s_lshl_b32 s87, s87, 4
    s_add_u32 s87, s87, s46
    s_lshl_b32 s87, s87, 10
    s_add_u32 s87, s87, 5242880
    v_lshl_add_u32 v8, v0, 4, s87
    s_lshl_b32 s87, s86, 4
    s_add_u32 s87, s87, s46
    s_lshl_b32 s87, s87, 7
    s_lshl_b32 s88, s49, 6
    s_add_u32 s87, s87, s88
    s_add_u32 s87, s87, 6881280
    v_add_u32 v9, s87, v0
    s_mov_b32 vcc_lo, 0x00010001
    s_mov_b32 vcc_hi, vcc_lo
    v_mov_b32 v14, 2147483648
    v_cndmask_b32 v9, v14, v9, vcc
    ds_write_b128 v6, v[236:239] offset:0
    ds_write_b128 v6, v[240:243] offset:1024
    ds_write_b128 v6, v[244:247] offset:2048
    ds_write_b32 v12, v12
    s_lshl_b32 s86, s47, 1
    s_add_u32 s86, s86, s50
    s_lshl_b32 s87, s46, 3
    s_lshl_b32 s88, s49, 2
    s_add_u32 s87, s87, s88
    s_lshl_b32 s87, s87, 5
    s_add_u32 s87, s87, s86
    s_lshl_b32 s87, s87, 10
    s_add_u32 s87, s87, 1048576
    v_lshl_add_u32 v10, v0, 4, s87
    s_mul_i32 s87, s50, 3072
    s_add_u32 s87, s87, 151552
    v_lshl_add_u32 v11, v0, 4, s87
    s_lshl_b32 s87, s86, 1
    s_add_u32 s87, s87, s49
    s_lshl_b32 s87, s87, 5
    s_add_u32 s87, s87, s46
    s_lshl2_add_u32 s87, s87, 671744
    v_mov_b32 v16, 2147483648
    v_mov_b32 v18, 2147483648
    v_writelane_b32 v16, s87, 0
    s_lshl_b32 s87, s46, 1
    s_add_u32 s87, s87, s49
    s_lshl_b32 s87, s87, 1
    s_lshr_b32 s88, s86, 4
    s_add_u32 s87, s87, s88
    s_lshl_b32 s87, s87, 6
    s_and_b32 s88, s86, 15
    s_add_u32 s87, s87, s88
    s_lshl2_add_u32 s87, s87, 688128
    v_writelane_b32 v18, s87, 0
    s_add_u32 s87, s87, 128
    v_writelane_b32 v18, s87, 1
    v_mov_b32 v17, s68
L_xkv:
    ds_read_b32 v14, v13
    ds_read_b128 v[236:239], v7 offset:0
    ds_read_b128 v[240:243], v7 offset:1024
    ds_read_b128 v[244:247], v7 offset:2048
    s_waitcnt lgkmcnt(0)
    v_cmp_eq_u32 vcc, 0, v14
    s_cbranch_vccz L_ok_2
    s_sub_u32 s56, s56, 1
    s_cbranch_scc0 L_xkv
    s_mov_b32 s56, 0
L_ok_2:
    v_pk_add_f32 v[224:225], v[224:225], v[236:237]
    v_pk_add_f32 v[226:227], v[226:227], v[238:239]
    v_pk_add_f32 v[228:229], v[228:229], v[240:241]
    v_pk_add_f32 v[230:231], v[230:231], v[242:243]
    v_pk_add_f32 v[232:233], v[232:233], v[244:245]
    v_pk_add_f32 v[234:235], v[234:235], v[246:247]
    v_cvt_pk_bf16_f32 v248, v224, v225
    v_cvt_pk_bf16_f32 v249, v226, v227
    v_cvt_pk_bf16_f32 v250, v228, v229
    v_cvt_pk_bf16_f32 v251, v230, v231
    buffer_store_dwordx4 v[248:251], v8, s[16:19], 0 offen sc1
    buffer_store_dwordx4 v[232:235], v9, s[16:19], 0 offen sc1
    buffer_atomic_swap v17, v16, s[16:19], 0 offen sc1
    v_mfma_f32_16x16x32_bf16 v[128:131], v[56:59], v[40:43], v[128:131]
    v_mfma_f32_16x16x32_bf16 v[144:147], v[60:63], v[40:43], v[144:147]
    v_mfma_f32_16x16x32_bf16 v[148:151], v[60:63], v[44:47], v[148:151]
    v_mfma_f32_16x16x32_bf16 v[132:135], v[56:59], v[44:47], v[132:135]
    v_mfma_f32_16x16x32_bf16 v[136:139], v[56:59], v[48:51], v[136:139]
    v_mfma_f32_16x16x32_bf16 v[152:155], v[60:63], v[48:51], v[152:155]
    v_mfma_f32_16x16x32_bf16 v[156:159], v[60:63], v[52:55], v[156:159]
    v_mfma_f32_16x16x32_bf16 v[140:143], v[56:59], v[52:55], v[140:143]
    v_mfma_f32_16x16x32_bf16 v[128:131], v[96:99], v[80:83], v[128:131]
    v_mfma_f32_16x16x32_bf16 v[144:147], v[100:103], v[80:83], v[144:147]
    v_mfma_f32_16x16x32_bf16 v[148:151], v[100:103], v[84:87], v[148:151]
    v_mfma_f32_16x16x32_bf16 v[132:135], v[96:99], v[84:87], v[132:135]
    v_mfma_f32_16x16x32_bf16 v[136:139], v[96:99], v[88:91], v[136:139]
    v_mfma_f32_16x16x32_bf16 v[152:155], v[100:103], v[88:91], v[152:155]
    v_mfma_f32_16x16x32_bf16 v[156:159], v[100:103], v[92:95], v[156:159]
    v_mfma_f32_16x16x32_bf16 v[140:143], v[96:99], v[92:95], v[140:143]
    s_nop 0
    v_pk_fma_f32 v[128:129], v[32:33], v[104:105], v[128:129] op_sel_hi:[1,0,1]
    v_pk_mul_f32 v[112:113], v[128:129], v[124:125] op_sel_hi:[1,0]
    v_pk_fma_f32 v[128:129], v[128:129], v[108:109], s[54:55] op_sel_hi:[1,0,1]
    v_exp_f32 v112, v112 clamp
    v_exp_f32 v113, v113 clamp
    v_max_f32 v128, s54, v128
    v_max_f32 v129, s54, v129
    v_pk_add_f32 v[128:129], v[128:129], v[112:113]
    v_cvt_pk_bf16_f32 v192, v128, v129
    v_pk_fma_f32 v[130:131], v[34:35], v[104:105], v[130:131] op_sel_hi:[1,0,1]
    v_pk_mul_f32 v[114:115], v[130:131], v[124:125] op_sel_hi:[1,0]
    v_pk_fma_f32 v[130:131], v[130:131], v[108:109], s[54:55] op_sel_hi:[1,0,1]
    v_exp_f32 v114, v114 clamp
    v_exp_f32 v115, v115 clamp
    v_max_f32 v130, s54, v130
    v_max_f32 v131, s54, v131
    v_pk_add_f32 v[130:131], v[130:131], v[114:115]
    v_cvt_pk_bf16_f32 v193, v130, v131
    v_pk_fma_f32 v[144:145], v[36:37], v[104:105], v[144:145] op_sel_hi:[1,0,1]
    v_pk_mul_f32 v[116:117], v[144:145], v[124:125] op_sel_hi:[1,0]
    v_pk_fma_f32 v[144:145], v[144:145], v[108:109], s[54:55] op_sel_hi:[1,0,1]
    v_exp_f32 v116, v116 clamp
    v_exp_f32 v117, v117 clamp
    v_max_f32 v144, s54, v144
    v_max_f32 v145, s54, v145
    v_pk_add_f32 v[144:145], v[144:145], v[116:117]
L_walk_14:
    s_cbranch_execz L_walk_18
    v_cvt_pk_bf16_f32 v194, v144, v145
    v_pk_fma_f32 v[146:147], v[38:39], v[104:105], v[146:147] op_sel_hi:[1,0,1]
    v_pk_mul_f32 v[118:119], v[146:147], v[124:125] op_sel_hi:[1,0]
    v_pk_fma_f32 v[146:147], v[146:147], v[108:109], s[54:55] op_sel_hi:[1,0,1]
    v_exp_f32 v118, v118 clamp
    v_exp_f32 v119, v119 clamp
    v_max_f32 v146, s54, v146
    v_max_f32 v147, s54, v147
    v_pk_add_f32 v[146:147], v[146:147], v[118:119]
    v_cvt_pk_bf16_f32 v195, v146, v147
    v_pk_fma_f32 v[132:133], v[32:33], v[104:105], v[132:133] op_sel:[0,1,0] op_sel_hi:[1,1,1]
    v_pk_mul_f32 v[112:113], v[132:133], v[124:125] op_sel:[0,1] op_sel_hi:[1,1]
    v_pk_fma_f32 v[132:133], v[132:133], v[108:109], s[54:55] op_sel:[0,1,0] op_sel_hi:[1,1,1]
    v_exp_f32 v112, v112 clamp
    v_exp_f32 v113, v113 clamp
    v_max_f32 v132, s54, v132
    v_max_f32 v133, s54, v133
    v_pk_add_f32 v[132:133], v[132:133], v[112:113]
    v_cvt_pk_bf16_f32 v196, v132, v133
    v_pk_fma_f32 v[134:135], v[34:35], v[104:105], v[134:135] op_sel:[0,1,0] op_sel_hi:[1,1,1]
    v_pk_mul_f32 v[114:115], v[134:135], v[124:125] op_sel:[0,1] op_sel_hi:[1,1]
    v_pk_fma_f32 v[134:135], v[134:135], v[108:109], s[54:55] op_sel:[0,1,0] op_sel_hi:[1,1,1]
    v_exp_f32 v114, v114 clamp
    v_exp_f32 v115, v115 clamp
    v_max_f32 v134, s54, v134
    v_max_f32 v135, s54, v135
    v_pk_add_f32 v[134:135], v[134:135], v[114:115]
    v_cvt_pk_bf16_f32 v197, v134, v135
    v_pk_fma_f32 v[148:149], v[36:37], v[104:105], v[148:149] op_sel:[0,1,0] op_sel_hi:[1,1,1]
    v_pk_mul_f32 v[116:117], v[148:149], v[124:125] op_sel:[0,1] op_sel_hi:[1,1]
    v_pk_fma_f32 v[148:149], v[148:149], v[108:109], s[54:55] op_sel:[0,1,0] op_sel_hi:[1,1,1]
    v_exp_f32 v116, v116 clamp
    v_exp_f32 v117, v117 clamp
    v_max_f32 v148, s54, v148
    v_max_f32 v149, s54, v149
    v_pk_add_f32 v[148:149], v[148:149], v[116:117]
    v_cvt_pk_bf16_f32 v198, v148, v149
    v_pk_fma_f32 v[150:151], v[38:39], v[104:105], v[150:151] op_sel:[0,1,0] op_sel_hi:[1,1,1]
    v_pk_mul_f32 v[118:119], v[150:151], v[124:125] op_sel:[0,1] op_sel_hi:[1,1]
    v_pk_fma_f32 v[150:151], v[150:151], v[108:109], s[54:55] op_sel:[0,1,0] op_sel_hi:[1,1,1]
    v_exp_f32 v118, v118 clamp
    v_exp_f32 v119, v119 clamp
    v_max_f32 v150, s54, v150
    v_max_f32 v151, s54, v151
    v_pk_add_f32 v[150:151], v[150:151], v[118:119]
    v_cvt_pk_bf16_f32 v199, v150, v151
    v_pk_fma_f32 v[136:137], v[32:33], v[106:107], v[136:137] op_sel_hi:[1,0,1]
    v_pk_mul_f32 v[112:113], v[136:137], v[126:127] op_sel_hi:[1,0]
    v_pk_fma_f32 v[136:137], v[136:137], v[110:111], s[54:55] op_sel_hi:[1,0,1]
    v_exp_f32 v112, v112 clamp
    v_exp_f32 v113, v113 clamp
    v_max_f32 v136, s54, v136
    v_max_f32 v137, s54, v137
    v_pk_add_f32 v[136:137], v[136:137], v[112:113]
    v_cvt_pk_bf16_f32 v200, v136, v137
    v_pk_fma_f32 v[138:139], v[34:35], v[106:107], v[138:139] op_sel_hi:[1,0,1]
    v_pk_mul_f32 v[114:115], v[138:139], v[126:127] op_sel_hi:[1,0]
    v_pk_fma_f32 v[138:139], v[138:139], v[110:111], s[54:55] op_sel_hi:[1,0,1]
    v_exp_f32 v114, v114 clamp
    v_exp_f32 v115, v115 clamp
    v_max_f32 v138, s54, v138
    v_max_f32 v139, s54, v139
    v_pk_add_f32 v[138:139], v[138:139], v[114:115]
    v_cvt_pk_bf16_f32 v201, v138, v139
    v_pk_fma_f32 v[152:153], v[36:37], v[106:107], v[152:153] op_sel_hi:[1,0,1]
    v_pk_mul_f32 v[116:117], v[152:153], v[126:127] op_sel_hi:[1,0]
    v_pk_fma_f32 v[152:153], v[152:153], v[110:111], s[54:55] op_sel_hi:[1,0,1]
    v_exp_f32 v116, v116 clamp
    v_exp_f32 v117, v117 clamp
    v_max_f32 v152, s54, v152
    v_max_f32 v153, s54, v153
    v_pk_add_f32 v[152:153], v[152:153], v[116:117]
    v_cvt_pk_bf16_f32 v202, v152, v153
    v_pk_fma_f32 v[154:155], v[38:39], v[106:107], v[154:155] op_sel_hi:[1,0,1]
    v_pk_mul_f32 v[118:119], v[154:155], v[126:127] op_sel_hi:[1,0]
    v_pk_fma_f32 v[154:155], v[154:155], v[110:111], s[54:55] op_sel_hi:[1,0,1]
    v_exp_f32 v118, v118 clamp
    v_exp_f32 v119, v119 clamp
    v_max_f32 v154, s54, v154
    v_max_f32 v155, s54, v155
    v_pk_add_f32 v[154:155], v[154:155], v[118:119]
    v_cvt_pk_bf16_f32 v203, v154, v155
    v_pk_fma_f32 v[140:141], v[32:33], v[106:107], v[140:141] op_sel:[0,1,0] op_sel_hi:[1,1,1]
    v_pk_mul_f32 v[112:113], v[140:141], v[126:127] op_sel:[0,1] op_sel_hi:[1,1]
    v_pk_fma_f32 v[140:141], v[140:141], v[110:111], s[54:55] op_sel:[0,1,0] op_sel_hi:[1,1,1]
    v_exp_f32 v112, v112 clamp
    v_exp_f32 v113, v113 clamp
    v_max_f32 v140, s54, v140
    v_max_f32 v141, s54, v141
    v_pk_add_f32 v[140:141], v[140:141], v[112:113]
    v_cvt_pk_bf16_f32 v204, v140, v141
    v_pk_fma_f32 v[142:143], v[34:35], v[106:107], v[142:143] op_sel:[0,1,0] op_sel_hi:[1,1,1]
    v_pk_mul_f32 v[114:115], v[142:143], v[126:127] op_sel:[0,1] op_sel_hi:[1,1]
    v_pk_fma_f32 v[142:143], v[142:143], v[110:111], s[54:55] op_sel:[0,1,0] op_sel_hi:[1,1,1]
    v_exp_f32 v114, v114 clamp
    v_exp_f32 v115, v115 clamp
    v_max_f32 v142, s54, v142
    v_max_f32 v143, s54, v143
    v_pk_add_f32 v[142:143], v[142:143], v[114:115]
    v_cvt_pk_bf16_f32 v205, v142, v143
    v_pk_fma_f32 v[156:157], v[36:37], v[106:107], v[156:157] op_sel:[0,1,0] op_sel_hi:[1,1,1]
    v_pk_mul_f32 v[116:117], v[156:157], v[126:127] op_sel:[0,1] op_sel_hi:[1,1]
    v_pk_fma_f32 v[156:157], v[156:157], v[110:111], s[54:55] op_sel:[0,1,0] op_sel_hi:[1,1,1]
    v_exp_f32 v116, v116 clamp
    v_exp_f32 v117, v117 clamp
    v_max_f32 v156, s54, v156
    v_max_f32 v157, s54, v157
    v_pk_add_f32 v[156:157], v[156:157], v[116:117]
    v_cvt_pk_bf16_f32 v206, v156, v157
    v_pk_fma_f32 v[158:159], v[38:39], v[106:107], v[158:159] op_sel:[0,1,0] op_sel_hi:[1,1,1]
    v_pk_mul_f32 v[118:119], v[158:159], v[126:127] op_sel:[0,1] op_sel_hi:[1,1]
    v_pk_fma_f32 v[158:159], v[158:159], v[110:111], s[54:55] op_sel:[0,1,0] op_sel_hi:[1,1,1]
    v_exp_f32 v118, v118 clamp
    v_exp_f32 v119, v119 clamp
    v_max_f32 v158, s54, v158
    v_max_f32 v159, s54, v159
    v_pk_add_f32 v[158:159], v[158:159], v[118:119]
    v_cvt_pk_bf16_f32 v207, v158, v159
    s_lshr_b32 s62, s3, 2
    s_lshl_b32 s53, s51, 3
    s_lshl_b32 s86, s48, 1
    s_add_u32 s53, s53, s86
    s_add_u32 s53, s53, s62
    v_lshrrev_b32 v36, 4, v0
    v_and_b32 v37, 15, v0
    s_lshl_b32 s87, s53, 15
    s_lshl_b32 s86, s62, 14
    s_add_u32 s86, s86, s87
    s_add_u32 s86, s86, 1048576
    v_lshl_add_u32 v157, v0, 4, s86
    v_xor_b32 v158, 0x8000, v157
    s_lshl_b32 s86, s51, 1
    s_lshr_b32 s87, s48, 1
    s_add_u32 s86, s86, s87
    s_lshl_b32 s86, s86, 1
    s_add_u32 s86, s86, s62
    s_lshl_b32 s86, s86, 1
    s_and_b32 s87, s48, 1
    s_add_u32 s86, s86, s87
    s_lshl_b32 s86, s86, 7
    s_add_u32 s86, s86, 688128
    v_lshl_add_u32 v159, v0, 2, s86
    v_mov_b32 v38, 2147483648
    v_cmp_gt_u32 vcc, 16, v0
    s_nop 1
    v_cndmask_b32 v159, v38, v159, vcc
    v_bfe_u32 v38, v0, 2, 2
    v_lshl_add_u32 v38, v36, 2, v38
    v_bfe_u32 v39, v38, 1, 2
    v_lshlrev_b32 v38, 7, v38
    v_lshl_add_u32 v38, v39, 5, v38
    v_and_b32 v39, 3, v0
    v_lshl_add_u32 v38, v39, 3, v38
    s_lshl_b32 s86, s62, 16
    s_add_u32 s86, s86, 0
    v_add_u32 v144, s86, v38
    v_xor_b32 v145, 32, v144
    v_xor_b32 v146, 64, v144
    v_xor_b32 v147, 96, v144
    v_cmp_eq_u32 s[4:5], 1, v39
    v_cmp_eq_u32 s[6:7], 2, v39
    v_cmp_eq_u32 s[98:99], 3, v39
    s_lshl_b32 s86, s53, 10
L_walk_15:
    s_cbranch_execz L_walk_19
    s_add_u32 s86, s86, 786432
    v_lshl_add_u32 v160, v0, 2, s86
    v_mul_u32_u24 v161, 192, v36
    v_add_u32 v160, v160, v161
    s_mov_b32 s72, 0x00f0000f
    s_mov_b32 s73, 0xf0000f00
    s_mov_b32 s74, 0x0f00f000
    s_mov_b32 s75, 0x0f00f000
    v_lshrrev_b32 v38, 2, v37
    v_lshl_add_u32 v161, v38, 4, v37
    v_lshlrev_b32 v161, 2, v161
    s_lshl_b32 s86, s3, 12
    s_add_u32 s86, s86, 131072
    v_lshl_add_u32 v162, v0, 4, s86
    v_xor_b32 v163, 0x4000, v162
    s_lshl_b32 s86, s52, 7
    v_lshl_add_u32 v36, v36, 3, s86
    s_lshl_b32 s87, s53, 15
    s_add_u32 s87, s87, s86
    s_lshl_b32 s86, s62, 6
    s_add_u32 s87, s87, s86
    v_lshl_add_u32 v39, v37, 11, s87
    v_and_b32 v38, 48, v0
    v_add_u32 v39, v39, v38
    v_xor_b32 v37, 0x8000, v39
    buffer_load_dwordx4 v[136:139], v39, s[8:11], 0 offen
    buffer_load_dwordx4 v[140:143], v37, s[8:11], 0 offen
    buffer_load_dwordx2 v[148:149], v36, s[40:43], 0 offen offset:0
    buffer_load_dwordx2 v[150:151], v36, s[40:43], 0 offen offset:32
    buffer_load_dwordx2 v[152:153], v36, s[40:43], 0 offen offset:64
    buffer_load_dwordx2 v[154:155], v36, s[40:43], 0 offen offset:96
    s_barrier
    ds_read_b128 v[40:43], v11 offset:0
    ds_read_b128 v[44:47], v11 offset:1024
    ds_read_b128 v[48:51], v11 offset:2048
    v_mov_b32 v38, 135200
    ds_read_b32 v38, v38
    s_mov_b32 s86, 0x8000
    s_mov_b32 s87, 0x10000
    s_mov_b32 s88, 0x18000
    s_waitcnt lgkmcnt(0)
    v_mfma_f32_16x16x32_bf16 v[216:219], v[48:51], v[192:195], 0
    v_mfma_f32_16x16x32_bf16 v[208:211], v[40:43], v[192:195], 0
    v_mfma_f32_16x16x32_bf16 v[212:215], v[44:47], v[192:195], 0
    v_mfma_f32_16x16x32_bf16 v[228:231], v[48:51], v[196:199], 0
    v_mfma_f32_16x16x32_bf16 v[220:223], v[40:43], v[196:199], 0
    v_mfma_f32_16x16x32_bf16 v[224:227], v[44:47], v[196:199], 0
    v_mfma_f32_16x16x32_bf16 v[240:243], v[48:51], v[200:203], 0
    v_mfma_f32_16x16x32_bf16 v[232:235], v[40:43], v[200:203], 0
    v_mfma_f32_16x16x32_bf16 v[236:239], v[44:47], v[200:203], 0
    v_mfma_f32_16x16x32_bf16 v[252:255], v[48:51], v[204:207], 0
    v_mfma_f32_16x16x32_bf16 v[244:247], v[40:43], v[204:207], 0
    v_mfma_f32_16x16x32_bf16 v[248:251], v[44:47], v[204:207], 0
    v_add_f32 v216, s54, v216
    v_rcp_f32 v216, v216
    s_nop 0
    v_pk_mul_f32 v[208:209], v[208:209], v[216:217] op_sel_hi:[1,0]
    v_pk_mul_f32 v[210:211], v[210:211], v[216:217] op_sel_hi:[1,0]
    v_pk_mul_f32 v[212:213], v[212:213], v[216:217] op_sel_hi:[1,0]
    v_pk_mul_f32 v[214:215], v[214:215], v[216:217] op_sel_hi:[1,0]
    v_cvt_pk_bf16_f32 v60, v208, v209
    v_cvt_pk_bf16_f32 v61, v210, v211
    v_cvt_pk_bf16_f32 v62, v212, v213
    v_cvt_pk_bf16_f32 v63, v214, v215
    buffer_store_dwordx4 v[60:63], v10, s[16:19], 0 offen sc1
    v_add_f32 v228, s54, v228
    v_rcp_f32 v228, v228
    s_nop 0
    v_pk_mul_f32 v[220:221], v[220:221], v[228:229] op_sel_hi:[1,0]
    v_pk_mul_f32 v[222:223], v[222:223], v[228:229] op_sel_hi:[1,0]
    v_pk_mul_f32 v[224:225], v[224:225], v[228:229] op_sel_hi:[1,0]
    v_pk_mul_f32 v[226:227], v[226:227], v[228:229] op_sel_hi:[1,0]
    v_cvt_pk_bf16_f32 v64, v220, v221
    v_cvt_pk_bf16_f32 v65, v222, v223
    v_cvt_pk_bf16_f32 v66, v224, v225
    v_cvt_pk_bf16_f32 v67, v226, v227
    buffer_store_dwordx4 v[64:67], v10, s[16:19], s86 offen sc1
    v_add_f32 v240, s54, v240
    v_rcp_f32 v240, v240
    s_nop 0
    v_pk_mul_f32 v[232:233], v[232:233], v[240:241] op_sel_hi:[1,0]
    v_pk_mul_f32 v[234:235], v[234:235], v[240:241] op_sel_hi:[1,0]
    v_pk_mul_f32 v[236:237], v[236:237], v[240:241] op_sel_hi:[1,0]
    v_pk_mul_f32 v[238:239], v[238:239], v[240:241] op_sel_hi:[1,0]
    v_cvt_pk_bf16_f32 v68, v232, v233
    v_cvt_pk_bf16_f32 v69, v234, v235
    v_cvt_pk_bf16_f32 v70, v236, v237
    v_cvt_pk_bf16_f32 v71, v238, v239
    buffer_store_dwordx4 v[68:71], v10, s[16:19], s87 offen sc1
    v_add_f32 v252, s54, v252
    v_rcp_f32 v252, v252
    s_nop 0
    v_pk_mul_f32 v[244:245], v[244:245], v[252:253] op_sel_hi:[1,0]
    v_pk_mul_f32 v[246:247], v[246:247], v[252:253] op_sel_hi:[1,0]
    v_pk_mul_f32 v[248:249], v[248:249], v[252:253] op_sel_hi:[1,0]
    v_pk_mul_f32 v[250:251], v[250:251], v[252:253] op_sel_hi:[1,0]
    v_cvt_pk_bf16_f32 v72, v244, v245
    v_cvt_pk_bf16_f32 v73, v246, v247
    v_cvt_pk_bf16_f32 v74, v248, v249
    v_cvt_pk_bf16_f32 v75, v250, v251
    buffer_store_dwordx4 v[72:75], v10, s[16:19], s88 offen sc1
    buffer_atomic_swap v17, v18, s[16:19], 0 offen sc1
    v_mov_b32 v8, 0
    buffer_atomic_or v8, v159, s[16:19], 0 offen sc0 sc1
    v_mov_b32 v14, 2147483648
    v_mov_b32 v11, 2147483648
    s_waitcnt vmcnt(6)
    v_bfe_u32 v36, v0, 2, 1
    v_cmp_eq_u32 vcc, 1, v36
    v_mov_b32 v36, s95
    s_nop 0
    v_cndmask_b32 v148, v36, v148, vcc
    v_cndmask_b32 v149, v36, v149, vcc
    v_cndmask_b32 v150, v36, v150, vcc
    v_cndmask_b32 v151, v36, v151, vcc
    v_cndmask_b32 v152, v36, v152, vcc
    v_cndmask_b32 v153, v36, v153, vcc
    v_cndmask_b32 v154, v36, v154, vcc
    v_cndmask_b32 v155, v36, v155, vcc
    v_readfirstlane_b32 s57, v38
L_phaseB:
    v_lshrrev_b32 v1, 4, v0
    v_and_b32 v2, 15, v0
    v_mov_b32 v3, 0x3f80
    s_lshl_b32 s87, s53, 4
    v_add_u32 v6, s87, v2
    s_lshl_b32 s86, s52, 7
    v_lshl_add_u32 v5, v6, 11, s86
    v_sub_u32 v6, 2047, v6
    v_mov_b32 v7, v39
    v_lshrrev_b32 v9, 1, v1
    v_lshl_add_u32 v5, v9, 4, v5
    v_and_b32 v9, 1, v1
    v_lshl_add_u32 v5, v9, 5, v5
    s_mov_b32 s67, 0
    s_mov_b32 s66, 0xffffaaaa
    s_mov_b32 s63, 0
    s_lshl2_add_u32 s86, s3, 163776
    v_mov_b32 v12, s86
    s_cmp_eq_u32 s62, 0
    s_cselect_b64 vcc, -1, 0
    v_cndmask_b32 v12, v12, v162, vcc
    v_mov_b32 v13, 163792
L_b_init:
    v_bfe_u32 v9, v0, 3, 1
    v_bfe_u32 v10, v0, 4, 1
    v_xor_b32 v9, v9, v10
    v_bfe_u32 v10, v0, 1, 2
    v_lshl_add_u32 v9, v9, 3, v10
    v_lshrrev_b32 v10, 5, v0
    v_lshl_add_u32 v9, v10, 2, v9
    v_and_b32 v10, 1, v0
    v_lshlrev_b32 v10, 4, v10
    v_lshlrev_b32 v10, v10, v3
    v_cmp_eq_u32 vcc, 0, v9
    s_nop 1
    v_cndmask_b32 v128, 0, v10, vcc
    v_cmp_eq_u32 vcc, 1, v9
    s_nop 1
    v_cndmask_b32 v129, 0, v10, vcc
    v_cmp_eq_u32 vcc, 2, v9
    s_nop 1
    v_cndmask_b32 v130, 0, v10, vcc
    v_cmp_eq_u32 vcc, 3, v9
    s_nop 1
    v_cndmask_b32 v131, 0, v10, vcc
    v_cmp_eq_u32 vcc, 4, v9
    s_nop 1
    v_cndmask_b32 v132, 0, v10, vcc
    v_cmp_eq_u32 vcc, 5, v9
    s_nop 1
    v_cndmask_b32 v133, 0, v10, vcc
    v_cmp_eq_u32 vcc, 6, v9
    s_nop 1
    v_cndmask_b32 v134, 0, v10, vcc
    v_cmp_eq_u32 vcc, 7, v9
    s_nop 1
    v_cndmask_b32 v135, 0, v10, vcc
    v_mov_b32 v80, 0
L_walk_16:
    s_cbranch_execz L_walk_20
    v_mov_b32 v81, 0
    v_mov_b32 v82, 0
    v_mov_b32 v83, 0
    v_mov_b32 v84, 0
    v_mov_b32 v85, 0
    v_mov_b32 v86, 0
    v_mov_b32 v87, 0
    v_mov_b32 v88, 0
    v_mov_b32 v89, 0
    v_mov_b32 v90, 0
    v_mov_b32 v91, 0
    v_mov_b32 v92, 0
    v_mov_b32 v93, 0
    v_mov_b32 v94, 0
    v_mov_b32 v95, 0
    v_mov_b32 v96, 0
    v_mov_b32 v97, 0
    v_mov_b32 v98, 0
    v_mov_b32 v99, 0
    v_mov_b32 v100, 0
    v_mov_b32 v101, 0
    v_mov_b32 v102, 0
    v_mov_b32 v103, 0
    v_mov_b32 v104, 0
    v_mov_b32 v105, 0
    v_mov_b32 v106, 0
    v_mov_b32 v107, 0
    v_mov_b32 v108, 0
    v_mov_b32 v109, 0
    v_mov_b32 v110, 0
    v_mov_b32 v111, 0
    v_mov_b32 v156, 0
    s_branch L_b_w0
L_b_r0:
    s_ff1_i32_b32 s91, s65
    s_bitset0_b32 s65, s91
    s_lshl_b32 s76, s91, 12
    s_lshl_b32 s91, s91, 10
    buffer_load_dwordx4 v[16:19], v157, s[16:19], s91 offen offset:0 sc1
    buffer_load_dwordx4 v[20:23], v158, s[16:19], s91 offen offset:0 sc1
    buffer_load_dwordx4 v[24:27], v157, s[16:19], s91 offen offset:1024 sc1
    buffer_load_dwordx4 v[28:31], v158, s[16:19], s91 offen offset:1024 sc1
    s_cmp_eq_u32 s65, 0
    s_cbranch_scc1 L_b_p1
L_b_r1:
    s_ff1_i32_b32 s91, s65
    s_bitset0_b32 s65, s91
    s_lshl_b32 s77, s91, 12
    s_lshl_b32 s91, s91, 10
    buffer_load_dwordx4 v[32:35], v157, s[16:19], s91 offen offset:0 sc1
    buffer_load_dwordx4 v[36:39], v158, s[16:19], s91 offen offset:0 sc1
    buffer_load_dwordx4 v[40:43], v157, s[16:19], s91 offen offset:1024 sc1
    buffer_load_dwordx4 v[44:47], v158, s[16:19], s91 offen offset:1024 sc1
    s_cmp_le_u32 s62, s63
    s_cbranch_scc1 L_b_wok
L_b_wf:
    ds_read_b128 v[112:115], v13
    s_waitcnt lgkmcnt(0)
    v_min3_u32 v112, v112, v113, v114
    v_min_u32 v112, v112, v115
    v_cmp_eq_u32 vcc, 0, v112
    s_cbranch_vccz L_ok_3
    s_sub_u32 s56, s56, 1
    s_cbranch_scc0 L_b_wf
    s_mov_b32 s56, 0
L_ok_3:
L_b_wok:
    s_xor_b32 s89, s67, s76
    s_mov_b32 s67, s76
    v_xor_b32 v144, s89, v144
    ds_read_b64_tr_b16 v[112:113], v144 offset:0
    ds_read_b64_tr_b16 v[114:115], v144 offset:2048
    v_xor_b32 v145, s89, v145
    ds_read_b64_tr_b16 v[116:117], v145 offset:0
    ds_read_b64_tr_b16 v[118:119], v145 offset:2048
    v_xor_b32 v146, s89, v146
    ds_read_b64_tr_b16 v[120:121], v146 offset:0
    ds_read_b64_tr_b16 v[122:123], v146 offset:2048
    v_xor_b32 v147, s89, v147
    ds_read_b64_tr_b16 v[124:125], v147 offset:0
    ds_read_b64_tr_b16 v[126:127], v147 offset:2048
    s_cmp_eq_u32 s62, 0
    s_cbranch_scc0 L_b_x1
    v_mfma_f32_16x16x32_bf16 v[80:83], v[128:131], v[136:139], 0
    v_mfma_f32_16x16x32_bf16 v[96:99], v[128:131], v[140:143], 0
    v_mfma_f32_16x16x32_bf16 v[84:87], v[132:135], v[136:139], 0
    v_mfma_f32_16x16x32_bf16 v[100:103], v[132:135], v[140:143], 0
    s_branch L_b_xd
L_b_x1:
    s_setprio 1
    v_mfma_f32_16x16x32_bf16 v[88:91], v[128:131], v[136:139], 0
    v_mfma_f32_16x16x32_bf16 v[104:107], v[128:131], v[140:143], 0
    v_mfma_f32_16x16x32_bf16 v[92:95], v[132:135], v[136:139], 0
    v_mfma_f32_16x16x32_bf16 v[108:111], v[132:135], v[140:143], 0
L_b_xd:
    s_waitcnt vmcnt(6) lgkmcnt(6)
    v_max3_u32 v156, v156, v19, v23
    v_mfma_f32_16x16x32_bf16 v[80:83], v[112:115], v[16:19], v[80:83]
    ds_read_b64_tr_b16 v[128:129], v144 offset:4096
    v_mfma_f32_16x16x32_bf16 v[96:99], v[112:115], v[20:23], v[96:99]
    ds_read_b64_tr_b16 v[130:131], v144 offset:6144
    s_waitcnt lgkmcnt(6)
    v_mfma_f32_16x16x32_bf16 v[84:87], v[116:119], v[16:19], v[84:87]
    ds_read_b64_tr_b16 v[132:133], v145 offset:4096
    v_mfma_f32_16x16x32_bf16 v[100:103], v[116:119], v[20:23], v[100:103]
    ds_read_b64_tr_b16 v[134:135], v145 offset:6144
    s_waitcnt lgkmcnt(6)
    v_mfma_f32_16x16x32_bf16 v[88:91], v[120:123], v[16:19], v[88:91]
    ds_read_b64_tr_b16 v[136:137], v146 offset:4096
    v_mfma_f32_16x16x32_bf16 v[104:107], v[120:123], v[20:23], v[104:107]
    ds_read_b64_tr_b16 v[138:139], v146 offset:6144
    s_waitcnt lgkmcnt(6)
    v_mfma_f32_16x16x32_bf16 v[92:95], v[124:127], v[16:19], v[92:95]
    ds_read_b64_tr_b16 v[140:141], v147 offset:4096
    v_mfma_f32_16x16x32_bf16 v[108:111], v[124:127], v[20:23], v[108:111]
    ds_read_b64_tr_b16 v[142:143], v147 offset:6144
    s_not_b32 s91, s66
    s_cmp_eq_u32 s65, 0
    s_cselect_b32 s65, s91, s65
    s_cselect_b32 s66, -1, s66
    s_ff1_i32_b32 s91, s65
    s_bitset0_b32 s65, s91
    s_lshl_b32 s78, s91, 12
    s_lshl_b32 s91, s91, 10
    buffer_load_dwordx4 v[48:51], v157, s[16:19], s91 offen offset:0 sc1
    buffer_load_dwordx4 v[52:55], v158, s[16:19], s91 offen offset:0 sc1
    s_waitcnt vmcnt(6) lgkmcnt(6)
    v_max3_u32 v156, v156, v27, v31
    v_mfma_f32_16x16x32_bf16 v[80:83], v[128:131], v[24:27], v[80:83]
    s_xor_b32 s89, s67, s77
    s_mov_b32 s67, s77
    v_xor_b32 v144, s89, v144
    ds_read_b64_tr_b16 v[112:113], v144 offset:0
    v_mfma_f32_16x16x32_bf16 v[96:99], v[128:131], v[28:31], v[96:99]
    ds_read_b64_tr_b16 v[114:115], v144 offset:2048
    s_waitcnt lgkmcnt(6)
    v_mfma_f32_16x16x32_bf16 v[84:87], v[132:135], v[24:27], v[84:87]
    v_xor_b32 v145, s89, v145
    ds_read_b64_tr_b16 v[116:117], v145 offset:0
    v_mfma_f32_16x16x32_bf16 v[100:103], v[132:135], v[28:31], v[100:103]
    ds_read_b64_tr_b16 v[118:119], v145 offset:2048
    s_waitcnt lgkmcnt(6)
    v_mfma_f32_16x16x32_bf16 v[88:91], v[136:139], v[24:27], v[88:91]
    v_xor_b32 v146, s89, v146
    ds_read_b64_tr_b16 v[120:121], v146 offset:0
    v_mfma_f32_16x16x32_bf16 v[104:107], v[136:139], v[28:31], v[104:107]
    ds_read_b64_tr_b16 v[122:123], v146 offset:2048
    s_waitcnt lgkmcnt(6)
    v_mfma_f32_16x16x32_bf16 v[92:95], v[140:143], v[24:27], v[92:95]
    v_xor_b32 v147, s89, v147
    ds_read_b64_tr_b16 v[124:125], v147 offset:0
    v_mfma_f32_16x16x32_bf16 v[108:111], v[140:143], v[28:31], v[108:111]
    ds_read_b64_tr_b16 v[126:127], v147 offset:2048
    buffer_load_dwordx4 v[56:59], v157, s[16:19], s91 offen offset:1024 sc1
    buffer_load_dwordx4 v[60:63], v158, s[16:19], s91 offen offset:1024 sc1
    s_waitcnt vmcnt(6) lgkmcnt(6)
    v_max3_u32 v156, v156, v35, v39
    v_mfma_f32_16x16x32_bf16 v[80:83], v[112:115], v[32:35], v[80:83]
    ds_read_b64_tr_b16 v[128:129], v144 offset:4096
    v_mfma_f32_16x16x32_bf16 v[96:99], v[112:115], v[36:39], v[96:99]
    ds_read_b64_tr_b16 v[130:131], v144 offset:6144
    s_waitcnt lgkmcnt(6)
    v_mfma_f32_16x16x32_bf16 v[84:87], v[116:119], v[32:35], v[84:87]
    ds_read_b64_tr_b16 v[132:133], v145 offset:4096
    v_mfma_f32_16x16x32_bf16 v[100:103], v[116:119], v[36:39], v[100:103]
    ds_read_b64_tr_b16 v[134:135], v145 offset:6144
    s_waitcnt lgkmcnt(6)
    v_mfma_f32_16x16x32_bf16 v[88:91], v[120:123], v[32:35], v[88:91]
    ds_read_b64_tr_b16 v[136:137], v146 offset:4096
    v_mfma_f32_16x16x32_bf16 v[104:107], v[120:123], v[36:39], v[104:107]
    ds_read_b64_tr_b16 v[138:139], v146 offset:6144
    s_waitcnt lgkmcnt(6)
    v_mfma_f32_16x16x32_bf16 v[92:95], v[124:127], v[32:35], v[92:95]
    ds_read_b64_tr_b16 v[140:141], v147 offset:4096
    v_mfma_f32_16x16x32_bf16 v[108:111], v[124:127], v[36:39], v[108:111]
    ds_read_b64_tr_b16 v[142:143], v147 offset:6144
    s_not_b32 s91, s66
    s_cmp_eq_u32 s65, 0
    s_cselect_b32 s65, s91, s65
    s_cselect_b32 s66, -1, s66
    s_ff1_i32_b32 s91, s65
    s_bitset0_b32 s65, s91
    s_lshl_b32 s79, s91, 12
    s_lshl_b32 s91, s91, 10
    buffer_load_dwordx4 v[64:67], v157, s[16:19], s91 offen offset:0 sc1
    buffer_load_dwordx4 v[68:71], v158, s[16:19], s91 offen offset:0 sc1
    s_waitcnt vmcnt(6) lgkmcnt(6)
    v_max3_u32 v156, v156, v43, v47
    v_mfma_f32_16x16x32_bf16 v[80:83], v[128:131], v[40:43], v[80:83]
    s_xor_b32 s89, s67, s78
    s_mov_b32 s67, s78
    v_xor_b32 v144, s89, v144
    ds_read_b64_tr_b16 v[112:113], v144 offset:0
L_walk_17:
    s_cbranch_execz L_walk_21
    v_mfma_f32_16x16x32_bf16 v[96:99], v[128:131], v[44:47], v[96:99]
    ds_read_b64_tr_b16 v[114:115], v144 offset:2048
    s_waitcnt lgkmcnt(6)
    v_mfma_f32_16x16x32_bf16 v[84:87], v[132:135], v[40:43], v[84:87]
    v_xor_b32 v145, s89, v145
    ds_read_b64_tr_b16 v[116:117], v145 offset:0
    v_mfma_f32_16x16x32_bf16 v[100:103], v[132:135], v[44:47], v[100:103]
    ds_read_b64_tr_b16 v[118:119], v145 offset:2048
    s_waitcnt lgkmcnt(6)
    v_mfma_f32_16x16x32_bf16 v[88:91], v[136:139], v[40:43], v[88:91]
    v_xor_b32 v146, s89, v146
    ds_read_b64_tr_b16 v[120:121], v146 offset:0
    v_mfma_f32_16x16x32_bf16 v[104:107], v[136:139], v[44:47], v[104:107]
    ds_read_b64_tr_b16 v[122:123], v146 offset:2048
    s_waitcnt lgkmcnt(6)
    v_mfma_f32_16x16x32_bf16 v[92:95], v[140:143], v[40:43], v[92:95]
    v_xor_b32 v147, s89, v147
    ds_read_b64_tr_b16 v[124:125], v147 offset:0
    v_mfma_f32_16x16x32_bf16 v[108:111], v[140:143], v[44:47], v[108:111]
    ds_read_b64_tr_b16 v[126:127], v147 offset:2048
    buffer_load_dwordx4 v[72:75], v157, s[16:19], s91 offen offset:1024 sc1
    buffer_load_dwordx4 v[76:79], v158, s[16:19], s91 offen offset:1024 sc1
    s_waitcnt vmcnt(6) lgkmcnt(6)
L_b_c4:
    v_max_u32 v4, v51, v55
    v_cmp_eq_u32 vcc, -1, v4
    s_cbranch_vccnz L_b_g4
L_b_d4:
    v_mfma_f32_16x16x32_bf16 v[80:83], v[112:115], v[48:51], v[80:83]
    ds_read_b64_tr_b16 v[128:129], v144 offset:4096
    v_mfma_f32_16x16x32_bf16 v[96:99], v[112:115], v[52:55], v[96:99]
    ds_read_b64_tr_b16 v[130:131], v144 offset:6144
    s_waitcnt lgkmcnt(6)
    v_mfma_f32_16x16x32_bf16 v[84:87], v[116:119], v[48:51], v[84:87]
    ds_read_b64_tr_b16 v[132:133], v145 offset:4096
    v_mfma_f32_16x16x32_bf16 v[100:103], v[116:119], v[52:55], v[100:103]
    ds_read_b64_tr_b16 v[134:135], v145 offset:6144
    s_waitcnt lgkmcnt(6)
    v_mfma_f32_16x16x32_bf16 v[88:91], v[120:123], v[48:51], v[88:91]
    ds_read_b64_tr_b16 v[136:137], v146 offset:4096
    v_mfma_f32_16x16x32_bf16 v[104:107], v[120:123], v[52:55], v[104:107]
    ds_read_b64_tr_b16 v[138:139], v146 offset:6144
    s_waitcnt lgkmcnt(6)
    v_mfma_f32_16x16x32_bf16 v[92:95], v[124:127], v[48:51], v[92:95]
    ds_read_b64_tr_b16 v[140:141], v147 offset:4096
    v_mfma_f32_16x16x32_bf16 v[108:111], v[124:127], v[52:55], v[108:111]
    ds_read_b64_tr_b16 v[142:143], v147 offset:6144
    s_not_b32 s91, s66
    s_cmp_eq_u32 s65, 0
    s_cselect_b32 s65, s91, s65
    s_cselect_b32 s66, -1, s66
    s_ff1_i32_b32 s91, s65
    s_bitset0_b32 s65, s91
    s_lshl_b32 s76, s91, 12
    s_lshl_b32 s91, s91, 10
    buffer_load_dwordx4 v[16:19], v157, s[16:19], s91 offen offset:0 sc1
    buffer_load_dwordx4 v[20:23], v158, s[16:19], s91 offen offset:0 sc1
    s_waitcnt vmcnt(6) lgkmcnt(6)
L_b_c5:
    v_max_u32 v4, v59, v63
    v_cmp_eq_u32 vcc, -1, v4
    s_cbranch_vccnz L_b_g5
L_b_d5:
    v_mfma_f32_16x16x32_bf16 v[80:83], v[128:131], v[56:59], v[80:83]
    s_xor_b32 s89, s67, s79
    s_mov_b32 s67, s79
    v_xor_b32 v144, s89, v144
    ds_read_b64_tr_b16 v[112:113], v144 offset:0
    v_mfma_f32_16x16x32_bf16 v[96:99], v[128:131], v[60:63], v[96:99]
    ds_read_b64_tr_b16 v[114:115], v144 offset:2048
    s_waitcnt lgkmcnt(6)
    v_mfma_f32_16x16x32_bf16 v[84:87], v[132:135], v[56:59], v[84:87]
    v_xor_b32 v145, s89, v145
    ds_read_b64_tr_b16 v[116:117], v145 offset:0
    v_mfma_f32_16x16x32_bf16 v[100:103], v[132:135], v[60:63], v[100:103]
    ds_read_b64_tr_b16 v[118:119], v145 offset:2048
    s_waitcnt lgkmcnt(6)
    v_mfma_f32_16x16x32_bf16 v[88:91], v[136:139], v[56:59], v[88:91]
    v_xor_b32 v146, s89, v146
    ds_read_b64_tr_b16 v[120:121], v146 offset:0
    v_mfma_f32_16x16x32_bf16 v[104:107], v[136:139], v[60:63], v[104:107]
    ds_read_b64_tr_b16 v[122:123], v146 offset:2048
    s_waitcnt lgkmcnt(6)
    v_mfma_f32_16x16x32_bf16 v[92:95], v[140:143], v[56:59], v[92:95]
    v_xor_b32 v147, s89, v147
    ds_read_b64_tr_b16 v[124:125], v147 offset:0
    v_mfma_f32_16x16x32_bf16 v[108:111], v[140:143], v[60:63], v[108:111]
    ds_read_b64_tr_b16 v[126:127], v147 offset:2048
    buffer_load_dwordx4 v[24:27], v157, s[16:19], s91 offen offset:1024 sc1
    buffer_load_dwordx4 v[28:31], v158, s[16:19], s91 offen offset:1024 sc1
    s_setprio 0
    s_waitcnt vmcnt(6) lgkmcnt(6)
L_b_c6:
    v_max_u32 v4, v67, v71
    v_cmp_eq_u32 vcc, -1, v4
    s_cbranch_vccnz L_b_g6
L_b_d6:
    v_mfma_f32_16x16x32_bf16 v[80:83], v[112:115], v[64:67], v[80:83]
    ds_read_b64_tr_b16 v[128:129], v144 offset:4096
    v_mfma_f32_16x16x32_bf16 v[96:99], v[112:115], v[68:71], v[96:99]
    ds_read_b64_tr_b16 v[130:131], v144 offset:6144
    s_waitcnt lgkmcnt(6)
    v_mfma_f32_16x16x32_bf16 v[84:87], v[116:119], v[64:67], v[84:87]
    ds_read_b64_tr_b16 v[132:133], v145 offset:4096
    v_mfma_f32_16x16x32_bf16 v[100:103], v[116:119], v[68:71], v[100:103]
    ds_read_b64_tr_b16 v[134:135], v145 offset:6144
    s_waitcnt lgkmcnt(6)
    v_mfma_f32_16x16x32_bf16 v[88:91], v[120:123], v[64:67], v[88:91]
    ds_read_b64_tr_b16 v[136:137], v146 offset:4096
    v_mfma_f32_16x16x32_bf16 v[104:107], v[120:123], v[68:71], v[104:107]
    ds_read_b64_tr_b16 v[138:139], v146 offset:6144
    s_waitcnt lgkmcnt(6)
    v_mfma_f32_16x16x32_bf16 v[92:95], v[124:127], v[64:67], v[92:95]
    ds_read_b64_tr_b16 v[140:141], v147 offset:4096
    v_mfma_f32_16x16x32_bf16 v[108:111], v[124:127], v[68:71], v[108:111]
    ds_read_b64_tr_b16 v[142:143], v147 offset:6144
    s_not_b32 s91, s66
    s_cmp_eq_u32 s65, 0
    s_cselect_b32 s65, s91, s65
    s_cselect_b32 s66, -1, s66
    s_ff1_i32_b32 s91, s65
    s_bitset0_b32 s65, s91
    s_lshl_b32 s77, s91, 12
    s_lshl_b32 s91, s91, 10
    buffer_load_dwordx4 v[32:35], v157, s[16:19], s91 offen offset:0 sc1
    buffer_load_dwordx4 v[36:39], v158, s[16:19], s91 offen offset:0 sc1
    s_waitcnt vmcnt(6) lgkmcnt(6)
L_b_c7:
    v_max_u32 v4, v75, v79
    v_cmp_eq_u32 vcc, -1, v4
    s_cbranch_vccnz L_b_g7
L_b_d7:
    v_mfma_f32_16x16x32_bf16 v[80:83], v[128:131], v[72:75], v[80:83]
    s_xor_b32 s89, s67, s76
    s_mov_b32 s67, s76
    v_xor_b32 v144, s89, v144
    ds_read_b64_tr_b16 v[112:113], v144 offset:0
    v_mfma_f32_16x16x32_bf16 v[96:99], v[128:131], v[76:79], v[96:99]
    ds_read_b64_tr_b16 v[114:115], v144 offset:2048
    s_waitcnt lgkmcnt(6)
    v_mfma_f32_16x16x32_bf16 v[84:87], v[132:135], v[72:75], v[84:87]
    v_xor_b32 v145, s89, v145
    ds_read_b64_tr_b16 v[116:117], v145 offset:0
    v_mfma_f32_16x16x32_bf16 v[100:103], v[132:135], v[76:79], v[100:103]
    ds_read_b64_tr_b16 v[118:119], v145 offset:2048
    s_waitcnt lgkmcnt(6)
    v_mfma_f32_16x16x32_bf16 v[88:91], v[136:139], v[72:75], v[88:91]
    v_xor_b32 v146, s89, v146
    ds_read_b64_tr_b16 v[120:121], v146 offset:0
    v_mfma_f32_16x16x32_bf16 v[104:107], v[136:139], v[76:79], v[104:107]
    ds_read_b64_tr_b16 v[122:123], v146 offset:2048
    s_waitcnt lgkmcnt(6)
    v_mfma_f32_16x16x32_bf16 v[92:95], v[140:143], v[72:75], v[92:95]
    v_xor_b32 v147, s89, v147
    ds_read_b64_tr_b16 v[124:125], v147 offset:0
    v_mfma_f32_16x16x32_bf16 v[108:111], v[140:143], v[76:79], v[108:111]
    ds_read_b64_tr_b16 v[126:127], v147 offset:2048
    buffer_load_dwordx4 v[40:43], v157, s[16:19], s91 offen offset:1024 sc1
    buffer_load_dwordx4 v[44:47], v158, s[16:19], s91 offen offset:1024 sc1
    s_waitcnt vmcnt(6) lgkmcnt(6)
L_b_c8:
    v_max_u32 v4, v19, v23
    v_cmp_eq_u32 vcc, -1, v4
    s_cbranch_vccnz L_b_g8
L_b_d8:
    v_mfma_f32_16x16x32_bf16 v[80:83], v[112:115], v[16:19], v[80:83]
    ds_read_b64_tr_b16 v[128:129], v144 offset:4096
    v_mfma_f32_16x16x32_bf16 v[96:99], v[112:115], v[20:23], v[96:99]
    ds_read_b64_tr_b16 v[130:131], v144 offset:6144
    s_waitcnt lgkmcnt(6)
    v_mfma_f32_16x16x32_bf16 v[84:87], v[116:119], v[16:19], v[84:87]
    ds_read_b64_tr_b16 v[132:133], v145 offset:4096
    v_mfma_f32_16x16x32_bf16 v[100:103], v[116:119], v[20:23], v[100:103]
    ds_read_b64_tr_b16 v[134:135], v145 offset:6144
    s_waitcnt lgkmcnt(6)
    v_mfma_f32_16x16x32_bf16 v[88:91], v[120:123], v[16:19], v[88:91]
    ds_read_b64_tr_b16 v[136:137], v146 offset:4096
    v_mfma_f32_16x16x32_bf16 v[104:107], v[120:123], v[20:23], v[104:107]
    ds_read_b64_tr_b16 v[138:139], v146 offset:6144
    s_waitcnt lgkmcnt(6)
L_walk_18:
    s_cbranch_execz L_walk_22
    v_mfma_f32_16x16x32_bf16 v[92:95], v[124:127], v[16:19], v[92:95]
    ds_read_b64_tr_b16 v[140:141], v147 offset:4096
    v_mfma_f32_16x16x32_bf16 v[108:111], v[124:127], v[20:23], v[108:111]
    ds_read_b64_tr_b16 v[142:143], v147 offset:6144
    s_not_b32 s91, s66
    s_cmp_eq_u32 s65, 0
    s_cselect_b32 s65, s91, s65
    s_cselect_b32 s66, -1, s66
    s_ff1_i32_b32 s91, s65
    s_bitset0_b32 s65, s91
    s_lshl_b32 s78, s91, 12
    s_lshl_b32 s91, s91, 10
    buffer_load_dwordx4 v[48:51], v157, s[16:19], s91 offen offset:0 sc1
    buffer_load_dwordx4 v[52:55], v158, s[16:19], s91 offen offset:0 sc1
    s_waitcnt vmcnt(6) lgkmcnt(6)
L_b_c9:
    v_max_u32 v4, v27, v31
    v_cmp_eq_u32 vcc, -1, v4
    s_cbranch_vccnz L_b_g9
L_b_d9:
    v_mfma_f32_16x16x32_bf16 v[80:83], v[128:131], v[24:27], v[80:83]
    s_xor_b32 s89, s67, s77
    s_mov_b32 s67, s77
    v_xor_b32 v144, s89, v144
    ds_read_b64_tr_b16 v[112:113], v144 offset:0
    v_mfma_f32_16x16x32_bf16 v[96:99], v[128:131], v[28:31], v[96:99]
    ds_read_b64_tr_b16 v[114:115], v144 offset:2048
    s_waitcnt lgkmcnt(6)
    v_mfma_f32_16x16x32_bf16 v[84:87], v[132:135], v[24:27], v[84:87]
    v_xor_b32 v145, s89, v145
    ds_read_b64_tr_b16 v[116:117], v145 offset:0
    v_mfma_f32_16x16x32_bf16 v[100:103], v[132:135], v[28:31], v[100:103]
    ds_read_b64_tr_b16 v[118:119], v145 offset:2048
    s_waitcnt lgkmcnt(6)
    v_mfma_f32_16x16x32_bf16 v[88:91], v[136:139], v[24:27], v[88:91]
    v_xor_b32 v146, s89, v146
    ds_read_b64_tr_b16 v[120:121], v146 offset:0
    v_mfma_f32_16x16x32_bf16 v[104:107], v[136:139], v[28:31], v[104:107]
    ds_read_b64_tr_b16 v[122:123], v146 offset:2048
    s_waitcnt lgkmcnt(6)
    v_mfma_f32_16x16x32_bf16 v[92:95], v[140:143], v[24:27], v[92:95]
    v_xor_b32 v147, s89, v147
    ds_read_b64_tr_b16 v[124:125], v147 offset:0
    v_mfma_f32_16x16x32_bf16 v[108:111], v[140:143], v[28:31], v[108:111]
    ds_read_b64_tr_b16 v[126:127], v147 offset:2048
    buffer_load_dwordx4 v[56:59], v157, s[16:19], s91 offen offset:1024 sc1
    buffer_load_dwordx4 v[60:63], v158, s[16:19], s91 offen offset:1024 sc1
    s_waitcnt vmcnt(6) lgkmcnt(6)
L_b_c10:
    v_max_u32 v4, v35, v39
    v_cmp_eq_u32 vcc, -1, v4
    s_cbranch_vccnz L_b_g10
L_b_d10:
    v_mfma_f32_16x16x32_bf16 v[80:83], v[112:115], v[32:35], v[80:83]
    ds_read_b64_tr_b16 v[128:129], v144 offset:4096
    v_mfma_f32_16x16x32_bf16 v[96:99], v[112:115], v[36:39], v[96:99]
    ds_read_b64_tr_b16 v[130:131], v144 offset:6144
    s_waitcnt lgkmcnt(6)
    v_mfma_f32_16x16x32_bf16 v[84:87], v[116:119], v[32:35], v[84:87]
    ds_read_b64_tr_b16 v[132:133], v145 offset:4096
    v_mfma_f32_16x16x32_bf16 v[100:103], v[116:119], v[36:39], v[100:103]
    ds_read_b64_tr_b16 v[134:135], v145 offset:6144
    s_waitcnt lgkmcnt(6)
    v_mfma_f32_16x16x32_bf16 v[88:91], v[120:123], v[32:35], v[88:91]
    ds_read_b64_tr_b16 v[136:137], v146 offset:4096
    v_mfma_f32_16x16x32_bf16 v[104:107], v[120:123], v[36:39], v[104:107]
    ds_read_b64_tr_b16 v[138:139], v146 offset:6144
    s_waitcnt lgkmcnt(6)
    v_mfma_f32_16x16x32_bf16 v[92:95], v[124:127], v[32:35], v[92:95]
    ds_read_b64_tr_b16 v[140:141], v147 offset:4096
    v_mfma_f32_16x16x32_bf16 v[108:111], v[124:127], v[36:39], v[108:111]
    ds_read_b64_tr_b16 v[142:143], v147 offset:6144
    s_not_b32 s91, s66
    s_or_b32 s65, s65, s91
    s_ff1_i32_b32 s91, s65
    s_bitset0_b32 s65, s91
    s_lshl_b32 s79, s91, 12
    s_lshl_b32 s91, s91, 10
    buffer_load_dwordx4 v[64:67], v157, s[16:19], s91 offen offset:0 sc1
    buffer_load_dwordx4 v[68:71], v158, s[16:19], s91 offen offset:0 sc1
    s_waitcnt vmcnt(6) lgkmcnt(6)
L_b_c11:
    v_max_u32 v4, v43, v47
    v_cmp_eq_u32 vcc, -1, v4
    s_cbranch_vccnz L_b_g11
L_b_d11:
    v_mfma_f32_16x16x32_bf16 v[80:83], v[128:131], v[40:43], v[80:83]
    s_xor_b32 s89, s67, s78
    s_mov_b32 s67, s78
    v_xor_b32 v144, s89, v144
    ds_read_b64_tr_b16 v[112:113], v144 offset:0
    v_mfma_f32_16x16x32_bf16 v[96:99], v[128:131], v[44:47], v[96:99]
    ds_read_b64_tr_b16 v[114:115], v144 offset:2048
    s_waitcnt lgkmcnt(6)
    v_mfma_f32_16x16x32_bf16 v[84:87], v[132:135], v[40:43], v[84:87]
    v_xor_b32 v145, s89, v145
    ds_read_b64_tr_b16 v[116:117], v145 offset:0
    v_mfma_f32_16x16x32_bf16 v[100:103], v[132:135], v[44:47], v[100:103]
    ds_read_b64_tr_b16 v[118:119], v145 offset:2048
    s_waitcnt lgkmcnt(6)
    v_mfma_f32_16x16x32_bf16 v[88:91], v[136:139], v[40:43], v[88:91]
    v_xor_b32 v146, s89, v146
    ds_read_b64_tr_b16 v[120:121], v146 offset:0
    v_mfma_f32_16x16x32_bf16 v[104:107], v[136:139], v[44:47], v[104:107]
    ds_read_b64_tr_b16 v[122:123], v146 offset:2048
    s_waitcnt lgkmcnt(6)
    v_mfma_f32_16x16x32_bf16 v[92:95], v[140:143], v[40:43], v[92:95]
    v_xor_b32 v147, s89, v147
    ds_read_b64_tr_b16 v[124:125], v147 offset:0
    v_mfma_f32_16x16x32_bf16 v[108:111], v[140:143], v[44:47], v[108:111]
    ds_read_b64_tr_b16 v[126:127], v147 offset:2048
    buffer_load_dwordx4 v[72:75], v157, s[16:19], s91 offen offset:1024 sc1
    buffer_load_dwordx4 v[76:79], v158, s[16:19], s91 offen offset:1024 sc1
    s_waitcnt vmcnt(6) lgkmcnt(6)
L_b_c12:
    v_max_u32 v4, v51, v55
    v_cmp_eq_u32 vcc, -1, v4
    s_cbranch_vccnz L_b_g12
L_b_d12:
    v_mfma_f32_16x16x32_bf16 v[80:83], v[112:115], v[48:51], v[80:83]
    ds_read_b64_tr_b16 v[128:129], v144 offset:4096
    v_mfma_f32_16x16x32_bf16 v[96:99], v[112:115], v[52:55], v[96:99]
    ds_read_b64_tr_b16 v[130:131], v144 offset:6144
    s_waitcnt lgkmcnt(6)
    v_mfma_f32_16x16x32_bf16 v[84:87], v[116:119], v[48:51], v[84:87]
    ds_read_b64_tr_b16 v[132:133], v145 offset:4096
    v_mfma_f32_16x16x32_bf16 v[100:103], v[116:119], v[52:55], v[100:103]
    ds_read_b64_tr_b16 v[134:135], v145 offset:6144
    s_waitcnt lgkmcnt(6)
    v_mfma_f32_16x16x32_bf16 v[88:91], v[120:123], v[48:51], v[88:91]
    ds_read_b64_tr_b16 v[136:137], v146 offset:4096
    v_mfma_f32_16x16x32_bf16 v[104:107], v[120:123], v[52:55], v[104:107]
    ds_read_b64_tr_b16 v[138:139], v146 offset:6144
    s_waitcnt lgkmcnt(6)
    v_mfma_f32_16x16x32_bf16 v[92:95], v[124:127], v[48:51], v[92:95]
    ds_read_b64_tr_b16 v[140:141], v147 offset:4096
    v_mfma_f32_16x16x32_bf16 v[108:111], v[124:127], v[52:55], v[108:111]
    ds_read_b64_tr_b16 v[142:143], v147 offset:6144
    s_waitcnt vmcnt(4) lgkmcnt(6)
L_b_c13:
    v_max_u32 v4, v59, v63
    v_cmp_eq_u32 vcc, -1, v4
    s_cbranch_vccnz L_b_g13
L_b_d13:
    v_mfma_f32_16x16x32_bf16 v[80:83], v[128:131], v[56:59], v[80:83]
    s_xor_b32 s89, s67, s79
    s_mov_b32 s67, s79
    v_xor_b32 v144, s89, v144
    ds_read_b64_tr_b16 v[112:113], v144 offset:0
    v_mfma_f32_16x16x32_bf16 v[96:99], v[128:131], v[60:63], v[96:99]
    ds_read_b64_tr_b16 v[114:115], v144 offset:2048
    s_waitcnt lgkmcnt(6)
    v_mfma_f32_16x16x32_bf16 v[84:87], v[132:135], v[56:59], v[84:87]
    v_xor_b32 v145, s89, v145
    ds_read_b64_tr_b16 v[116:117], v145 offset:0
    v_mfma_f32_16x16x32_bf16 v[100:103], v[132:135], v[60:63], v[100:103]
    ds_read_b64_tr_b16 v[118:119], v145 offset:2048
    s_waitcnt lgkmcnt(6)
    v_mfma_f32_16x16x32_bf16 v[88:91], v[136:139], v[56:59], v[88:91]
    v_xor_b32 v146, s89, v146
    ds_read_b64_tr_b16 v[120:121], v146 offset:0
    v_mfma_f32_16x16x32_bf16 v[104:107], v[136:139], v[60:63], v[104:107]
    ds_read_b64_tr_b16 v[122:123], v146 offset:2048
    s_waitcnt lgkmcnt(6)
    v_mfma_f32_16x16x32_bf16 v[92:95], v[140:143], v[56:59], v[92:95]
    v_xor_b32 v147, s89, v147
    ds_read_b64_tr_b16 v[124:125], v147 offset:0
    v_mfma_f32_16x16x32_bf16 v[108:111], v[140:143], v[60:63], v[108:111]
    ds_read_b64_tr_b16 v[126:127], v147 offset:2048
    s_waitcnt vmcnt(2) lgkmcnt(6)
L_b_c14:
    v_max_u32 v4, v67, v71
    v_cmp_eq_u32 vcc, -1, v4
    s_cbranch_vccnz L_b_g14
L_b_d14:
    v_mfma_f32_16x16x32_bf16 v[80:83], v[112:115], v[64:67], v[80:83]
    ds_read_b64_tr_b16 v[128:129], v144 offset:4096
    v_mfma_f32_16x16x32_bf16 v[96:99], v[112:115], v[68:71], v[96:99]
    ds_read_b64_tr_b16 v[130:131], v144 offset:6144
    s_waitcnt lgkmcnt(6)
    v_mfma_f32_16x16x32_bf16 v[84:87], v[116:119], v[64:67], v[84:87]
    ds_read_b64_tr_b16 v[132:133], v145 offset:4096
    v_mfma_f32_16x16x32_bf16 v[100:103], v[116:119], v[68:71], v[100:103]
    ds_read_b64_tr_b16 v[134:135], v145 offset:6144
L_walk_19:
    s_cbranch_execz L_walk_23
    s_waitcnt lgkmcnt(6)
    v_mfma_f32_16x16x32_bf16 v[88:91], v[120:123], v[64:67], v[88:91]
    ds_read_b64_tr_b16 v[136:137], v146 offset:4096
    v_mfma_f32_16x16x32_bf16 v[104:107], v[120:123], v[68:71], v[104:107]
    ds_read_b64_tr_b16 v[138:139], v146 offset:6144
    s_waitcnt lgkmcnt(6)
    v_mfma_f32_16x16x32_bf16 v[92:95], v[124:127], v[64:67], v[92:95]
    ds_read_b64_tr_b16 v[140:141], v147 offset:4096
    v_mfma_f32_16x16x32_bf16 v[108:111], v[124:127], v[68:71], v[108:111]
    ds_read_b64_tr_b16 v[142:143], v147 offset:6144
    s_waitcnt vmcnt(0) lgkmcnt(6)
L_b_c15:
    v_max_u32 v4, v75, v79
    v_cmp_eq_u32 vcc, -1, v4
    s_cbranch_vccnz L_b_g15
L_b_d15:
    v_cmp_eq_u32 vcc, -1, v156
    s_cbranch_vccz L_ok_4
    s_sub_u32 s56, s56, 1
    s_cbranch_scc0 L_b_restart
    s_mov_b32 s56, 0
L_ok_4:
    v_mfma_f32_16x16x32_bf16 v[80:83], v[128:131], v[72:75], v[80:83]
    s_mov_b32 s90, 71680
    buffer_load_dwordx4 v[204:207], v11, s[32:35], s90 offen
    v_mfma_f32_16x16x32_bf16 v[96:99], v[128:131], v[76:79], v[96:99]
    s_mov_b32 s90, 78848
    buffer_load_dwordx4 v[208:211], v11, s[32:35], s90 offen
    s_waitcnt lgkmcnt(4)
    v_mfma_f32_16x16x32_bf16 v[84:87], v[132:135], v[72:75], v[84:87]
    v_mfma_f32_16x16x32_bf16 v[100:103], v[132:135], v[76:79], v[100:103]
    s_mov_b32 s90, 86016
    buffer_load_dwordx4 v[212:215], v11, s[32:35], s90 offen
    s_waitcnt lgkmcnt(2)
    v_mfma_f32_16x16x32_bf16 v[88:91], v[136:139], v[72:75], v[88:91]
    s_mov_b32 s90, 93184
    buffer_load_dwordx4 v[216:219], v11, s[32:35], s90 offen
    v_mfma_f32_16x16x32_bf16 v[104:107], v[136:139], v[76:79], v[104:107]
    s_mov_b32 s90, 100352
    buffer_load_dwordx4 v[220:223], v11, s[32:35], s90 offen
    s_waitcnt lgkmcnt(0)
    v_mfma_f32_16x16x32_bf16 v[92:95], v[140:143], v[72:75], v[92:95]
    v_mfma_f32_16x16x32_bf16 v[108:111], v[140:143], v[76:79], v[108:111]
    s_mov_b32 s90, 107520
    buffer_load_dwordx4 v[224:227], v11, s[32:35], s90 offen
    ds_write_b128 v162, v[96:99] offset:0
    ds_write_b128 v162, v[100:103] offset:1024
    ds_write_b128 v162, v[104:107] offset:2048
    s_nop 2
    ds_write_b128 v162, v[108:111] offset:3072
    s_waitcnt lgkmcnt(0)
    s_barrier
    ds_read_b128 v[16:19], v163 offset:0
    ds_read_b128 v[20:23], v163 offset:1024
    ds_read_b128 v[24:27], v163 offset:2048
    ds_read_b128 v[28:31], v163 offset:3072
    s_waitcnt lgkmcnt(3)
    v_pk_add_f32 v[80:81], v[80:81], v[16:17]
    v_pk_add_f32 v[82:83], v[82:83], v[18:19]
    v_cvt_pk_bf16_f32 v32, v80, v81
    v_cvt_pk_bf16_f32 v33, v82, v83
    s_waitcnt lgkmcnt(2)
    v_pk_add_f32 v[84:85], v[84:85], v[20:21]
    v_pk_add_f32 v[86:87], v[86:87], v[22:23]
    v_cvt_pk_bf16_f32 v34, v84, v85
    v_cvt_pk_bf16_f32 v35, v86, v87
    s_waitcnt lgkmcnt(1)
    v_pk_add_f32 v[88:89], v[88:89], v[24:25]
    v_pk_add_f32 v[90:91], v[90:91], v[26:27]
    v_cvt_pk_bf16_f32 v36, v88, v89
    v_cvt_pk_bf16_f32 v37, v90, v91
    s_waitcnt lgkmcnt(0)
    v_pk_add_f32 v[92:93], v[92:93], v[28:29]
    v_pk_add_f32 v[94:95], v[94:95], v[30:31]
    v_cvt_pk_bf16_f32 v38, v92, v93
    v_cvt_pk_bf16_f32 v39, v94, v95
    v_mfma_f32_16x16x32_bf16 v[60:63], v[32:35], v[32:35], 0
    v_mfma_f32_16x16x32_bf16 v[56:59], v[32:35], v[148:151], 0
    v_mfma_f32_16x16x32_bf16 v[60:63], v[36:39], v[36:39], v[60:63]
    v_mfma_f32_16x16x32_bf16 v[56:59], v[36:39], v[152:155], v[56:59]
    v_lshlrev_b32 v40, 16, v32
    v_and_b32 v41, 0xffff0000, v32
    v_lshlrev_b32 v42, 16, v33
    v_and_b32 v43, 0xffff0000, v33
    v_lshlrev_b32 v44, 16, v34
    v_and_b32 v45, 0xffff0000, v34
    s_nop 1
    v_cndmask_b32 v56, v56, v60, s[72:73]
    v_cndmask_b32 v57, v57, v61, s[72:73]
    v_cndmask_b32 v58, v58, v62, s[72:73]
    v_cndmask_b32 v59, v59, v63, s[72:73]
    v_cndmask_b32 v56, v56, v57, s[4:5]
    v_cndmask_b32 v58, v58, v59, s[98:99]
    s_or_b64 vcc, s[6:7], s[98:99]
    v_cndmask_b32 v56, v56, v58, vcc
    v_cndmask_b32 v56, v56, 1.0, s[74:75]
    v_mov_b32 v67, v56
    buffer_atomic_add_f32 v67, v160, s[16:19], 0 offen sc0 sc1
    s_mov_b32 s90, 0
    buffer_load_dwordx4 v[228:231], v14, s[36:39], s90 offen
    s_mov_b32 s90, 2048
    buffer_load_dwordx4 v[232:235], v14, s[36:39], s90 offen
    s_mov_b32 s90, 4096
    buffer_load_dwordx4 v[236:239], v14, s[36:39], s90 offen
    s_lshl_b32 s86, s3, 11
    s_add_u32 s86, s86, 69632
    v_lshl_add_u32 v150, v0, 4, s86
    ds_write_b128 v150, v[32:35]
    ds_write_b128 v150, v[36:39] offset:1024
    s_lshl_b32 s86, s3, 7
    s_add_u32 s86, s86, 66560
    v_lshl_add_u32 v151, v2, 3, s86
    s_cmp_eq_u32 s62, 0
    s_cbranch_scc1 L_unp
    v_and_b32 v24, 1, v0
    v_cmp_eq_u32 vcc, 1, v24
    v_mov_b32 v24, 0x0c0c0100
    v_mov_b32 v25, 0x01000c0c
    v_cndmask_b32 v16, v24, v25, vcc
    v_mov_b32 v24, 0x0c0c0302
    v_mov_b32 v25, 0x03020c0c
    v_cndmask_b32 v17, v24, v25, vcc
    v_bfe_u32 v24, v0, 1, 2
    v_mov_b32 v25, 0x0c0c0c0c
    v_cmp_eq_u32 vcc, 0, v24
    s_nop 1
    v_cndmask_b32 v72, v25, v16, vcc
    v_cndmask_b32 v76, v25, v17, vcc
    v_cmp_eq_u32 vcc, 1, v24
    s_nop 1
    v_cndmask_b32 v73, v25, v16, vcc
    v_cndmask_b32 v77, v25, v17, vcc
    v_cmp_eq_u32 vcc, 2, v24
    s_nop 1
    v_cndmask_b32 v74, v25, v16, vcc
    v_cndmask_b32 v78, v25, v17, vcc
    v_cmp_eq_u32 vcc, 3, v24
    s_nop 1
    v_cndmask_b32 v75, v25, v16, vcc
    v_cndmask_b32 v79, v25, v17, vcc
    s_lshl_b32 s86, s48, 10
    s_add_u32 s86, s86, 90112
    v_lshl_add_u32 v18, v0, 4, s86
    s_and_b32 s86, s48, 1
    s_cselect_b32 s87, s81, s80
    s_lshr_b32 s90, s48, 1
    s_and_b32 s88, s82, 1
    s_and_b32 s89, s82, 6
    s_lshl3_add_u32 s88, s88, s89
    s_add_u32 s88, s88, s90
    s_mul_i32 s88, s88, 56
    s_add_u32 s88, s88, s87
    s_lshl_b32 s88, s88, 8
    s_add_u32 s88, s88, 7864320
    s_cmp_lt_u32 s87, 56
    s_cselect_b32 s88, s88, 2147483648
    v_lshl_add_u32 v131, v0, 2, s88
    s_lshl2_add_u32 s86, s90, s86
    s_lshl_b32 s86, s86, 7
    s_add_u32 s86, s86, 90112
    v_lshrrev_b32 v16, 3, v0
    v_lshl_add_u32 v133, v16, 4, s86
    v_bfe_u32 v17, v0, 2, 1
    v_lshl_add_u32 v133, v17, 8, v133
    v_and_b32 v17, 3, v0
    v_lshl_add_u32 v133, v17, 2, v133
    s_lshr_b32 s86, s82, 3
    s_lshl2_add_u32 s86, s86, s48
    s_mul_i32 s86, s86, 112
    s_add_u32 s86, s86, 7864320
    v_mul_u32_u24 v16, 14336, v16
    v_and_b32 v17, 7, v0
    v_lshl_add_u32 v137, v17, 4, s86
    v_add_u32 v137, v137, v16
    v_mov_b32 v16, 2147483648
    v_cmp_eq_u32 vcc, 7, v17
    s_nop 1
    v_cndmask_b32 v137, v137, v16, vcc
    s_branch L_unpd
L_walk_20:
    s_cbranch_execz L_walk_24
L_unp:
    v_lshlrev_b32 v46, 16, v35
    v_and_b32 v47, 0xffff0000, v35
    v_lshlrev_b32 v48, 16, v36
    v_and_b32 v49, 0xffff0000, v36
    v_lshlrev_b32 v50, 16, v37
    v_and_b32 v51, 0xffff0000, v37
    v_lshlrev_b32 v52, 16, v38
    v_and_b32 v53, 0xffff0000, v38
    v_lshlrev_b32 v54, 16, v39
    v_and_b32 v55, 0xffff0000, v39
L_unpd:
    v_lshrrev_b32 v8, 2, v2
    v_lshlrev_b32 v9, 4, v8
    v_sub_u32 v9, v161, v9
    v_cmp_eq_u32 vcc, 0, v8
    s_nop 1
    v_cndmask_b32 v10, 0, 32, vcc
    v_add_u32 v10, v9, v10
    v_cmp_eq_u32 vcc, 1, v8
    s_nop 1
    v_cndmask_b32 v8, 16, 48, vcc
    v_add_u32 v9, v9, v8
    s_lshl_b32 s86, s52, 11
    s_lshr_b32 s87, s51, 3
    s_lshl_b32 s87, s87, 6
    s_add_u32 s86, s86, s87
    s_and_b32 s87, s51, 7
    s_lshl3_add_u32 s86, s87, s86
    s_add_u32 s86, s86, 6684672
    v_lshl_add_u32 v149, v0, 7, s86
    v_mov_b32 v8, 2147483648
    v_cmp_gt_u32 vcc, 16, v0
    s_nop 1
    v_cndmask_b32 v149, v8, v149, vcc
    s_bfe_u32 s67, s82, 0x20001
    s_lshl2_add_u32 s67, s67, s48
    s_and_b32 s87, s2, 15
    s_lshl_b32 s86, s67, 4
    s_add_u32 s86, s86, s87
    s_lshl_b32 s86, s86, 7
    s_add_u32 s86, s86, 6684672
    v_lshl_add_u32 v148, v0, 3, s86
    v_mov_b32 v8, 2147483648
    v_cmp_gt_u32 vcc, 16, v0
    s_nop 1
    v_cndmask_b32 v148, v8, v148, vcc
    s_lshl_b32 s67, s67, 7
    s_add_u32 s67, s67, 6619136
    s_waitcnt vmcnt(3)
    v_add_f32 v67, v67, v56
    s_branch L_h3_chk
L_h3:
    v_mov_b32 v67, 0
    buffer_atomic_or v67, v160, s[16:19], 0 offen sc0 sc1
    s_waitcnt vmcnt(0)
L_h3_chk:
    v_cmp_ne_u32 vcc, 0x41800000, v67
    s_nop 0
    s_and_b64 vcc, vcc, s[74:75]
    s_cbranch_vccz L_ok_5
    s_sub_u32 s56, s56, 1
    s_cbranch_scc0 L_h3
    s_mov_b32 s56, 0
L_ok_5:
    ds_bpermute_b32 v64, v10, v67
    ds_bpermute_b32 v66, v161, v67
    ds_bpermute_b32 v65, v9, v67
    s_cmp_eq_u32 s62, 0
    s_cbranch_scc1 L_nop0
    v_mov_b32 v128, 0
    v_mov_b32 v129, 0
    buffer_atomic_or_x2 v[128:129], v148, s[16:19], 0 offen sc0 sc1
L_nop0:
    s_waitcnt lgkmcnt(0)
    v_mul_f32 v64, 0x3a800000, v64
    v_mul_f32 v66, 0x3a800000, v66
    v_fma_f32 v66, -v64, v64, v66
    v_max_f32 v66, 0, v66
    v_cvt_pk_bf16_f32 v69, v64, v66
    v_lshlrev_b32 v68, 16, v69
    v_and_b32 v69, 0xffff0000, v69
    v_add_f32 v69, 0x3727c5ac, v69
    v_cvt_pk_bf16_f32 v69, v69, v69
    v_lshlrev_b32 v69, 16, v69
    v_sqrt_f32 v69, v69
    s_nop 0
    v_cvt_pk_bf16_f32 v69, v69, v69
    v_lshlrev_b32 v69, 16, v69
    v_rcp_f32 v70, v69
    v_fma_f32 v12, -v68, s57, v65
    v_mul_f32 v12, v12, v70
    v_mul_f32 v71, -v68, v70
    v_cvt_pk_bf16_f32 v12, v12, v12
    v_ashrrev_i32 v8, 31, v12
    v_or_b32 v8, 0x80000000, v8
    v_xor_b32 v8, v8, v12
    v_and_b32 v8, 4294901760, v8
    v_or_b32 v13, v8, v6
    s_lshl_b32 s86, s3, 6
    s_add_u32 s86, s86, 65536
    v_lshl_add_u32 v8, v2, 2, s86
    ds_write_b32 v8, v13
    ds_write_b64 v151, v[70:71]
    v_mov_b32 v152, v8
    s_cmp_lg_u32 s62, 0
    s_cbranch_scc1 L_nohn
    v_pk_fma_f32 v[16:17], v[40:41], v[70:71], v[70:71] op_sel:[0,0,1] op_sel_hi:[1,0,1]
    v_pk_fma_f32 v[18:19], v[42:43], v[70:71], v[70:71] op_sel:[0,0,1] op_sel_hi:[1,0,1]
    v_pk_fma_f32 v[20:21], v[44:45], v[70:71], v[70:71] op_sel:[0,0,1] op_sel_hi:[1,0,1]
    v_pk_fma_f32 v[22:23], v[46:47], v[70:71], v[70:71] op_sel:[0,0,1] op_sel_hi:[1,0,1]
    v_pk_fma_f32 v[24:25], v[48:49], v[70:71], v[70:71] op_sel:[0,0,1] op_sel_hi:[1,0,1]
    v_pk_fma_f32 v[26:27], v[50:51], v[70:71], v[70:71] op_sel:[0,0,1] op_sel_hi:[1,0,1]
    v_pk_fma_f32 v[28:29], v[52:53], v[70:71], v[70:71] op_sel:[0,0,1] op_sel_hi:[1,0,1]
    v_pk_fma_f32 v[30:31], v[54:55], v[70:71], v[70:71] op_sel:[0,0,1] op_sel_hi:[1,0,1]
L_nohn:
    v_lshlrev_b32 v8, 3, v0
    v_add_u32 v8, 65536, v8
    s_waitcnt lgkmcnt(0)
    s_barrier
    ds_read_b64 v[64:65], v8
    s_cmp_lg_u32 s62, 0
    s_cbranch_scc1 L_t3_ld
    ds_read_b32 v144, v152 offset:256
    ds_read_b64 v[142:143], v151 offset:512
    ds_read_b128 v[112:115], v150 offset:8192
    ds_read_b128 v[116:119], v150 offset:9216
    v_cvt_pk_bf16_f32 v96, v16, v17
    v_cvt_pk_bf16_f32 v97, v18, v19
    v_cvt_pk_bf16_f32 v98, v20, v21
    v_cvt_pk_bf16_f32 v99, v22, v23
    v_cvt_pk_bf16_f32 v100, v24, v25
    v_cvt_pk_bf16_f32 v101, v26, v27
    v_cvt_pk_bf16_f32 v102, v28, v29
    v_cvt_pk_bf16_f32 v103, v30, v31
    s_waitcnt lgkmcnt(4)
    v_max_u32 v66, v64, v65
    v_min_u32 v67, v64, v65
    s_nop 0
    v_min_u32_dpp v64, v66, v66 row_ror:8 row_mask:0xf bank_mask:0xf
    v_max_u32_dpp v66, v66, v66 row_ror:8 row_mask:0xf bank_mask:0xf
    v_max_u32_dpp v65, v67, v67 row_ror:8 row_mask:0xf bank_mask:0xf
    v_max_u32 v67, v64, v65
    v_min_u32_dpp v64, v66, v66 row_ror:4 row_mask:0xf bank_mask:0xf
    v_max_u32_dpp v66, v66, v66 row_ror:4 row_mask:0xf bank_mask:0xf
    v_max_u32_dpp v65, v67, v67 row_ror:4 row_mask:0xf bank_mask:0xf
    v_max_u32 v67, v64, v65
    v_min_u32_dpp v64, v66, v66 row_ror:2 row_mask:0xf bank_mask:0xf
    v_max_u32_dpp v66, v66, v66 row_ror:2 row_mask:0xf bank_mask:0xf
    v_max_u32_dpp v65, v67, v67 row_ror:2 row_mask:0xf bank_mask:0xf
    v_max_u32 v67, v64, v65
    v_min_u32_dpp v64, v66, v66 row_ror:1 row_mask:0xf bank_mask:0xf
    v_max_u32_dpp v66, v66, v66 row_ror:1 row_mask:0xf bank_mask:0xf
    v_max_u32_dpp v65, v67, v67 row_ror:1 row_mask:0xf bank_mask:0xf
    v_max_u32 v67, v64, v65
    v_readlane_b32 s58, v66, 0
    v_readlane_b32 s59, v67, 0
    v_readlane_b32 s86, v66, 16
    v_readlane_b32 s87, v67, 16
    s_nop 0
    s_max_u32 s59, s59, s87
    s_min_u32 s87, s58, s86
    s_max_u32 s58, s58, s86
    s_max_u32 s59, s59, s87
    v_readlane_b32 s86, v66, 32
    v_readlane_b32 s87, v67, 32
    s_nop 0
    s_max_u32 s59, s59, s87
    s_min_u32 s87, s58, s86
    s_max_u32 s58, s58, s86
    s_max_u32 s59, s59, s87
    v_readlane_b32 s86, v66, 48
    v_readlane_b32 s87, v67, 48
    s_nop 0
    s_max_u32 s59, s59, s87
    s_min_u32 s87, s58, s86
    s_max_u32 s58, s58, s86
    s_max_u32 s59, s59, s87
    s_cmp_lg_u32 s3, 0
    s_cbranch_scc1 L_nokey
    v_mov_b32 v8, s58
    v_mov_b32 v9, s59
    buffer_atomic_swap_x2 v[8:9], v149, s[16:19], 0 offen sc1
L_nokey:
    v_cmp_eq_u32 s[4:5], s58, v13
    v_cmp_eq_u32 s[6:7], s59, v13
    s_nop 0
    s_or_b64 s[96:97], s[4:5], s[6:7]
    s_cbranch_scc0 L_nocand
    s_lshl_b32 s86, s51, 12
    s_lshl_b32 s87, s52, 7
L_walk_21:
    s_cbranch_execz L_walk_25
    s_add_u32 s86, s86, s87
    s_add_u32 s86, s86, 6619136
    v_lshl_add_u32 v8, v1, 3, s86
    v_add_u32 v9, 2048, v8
    v_cndmask_b32 v8, v8, v9, s[6:7]
    v_mov_b32 v9, 2147483648
    v_cndmask_b32 v8, v9, v8, s[96:97]
    buffer_store_dwordx2 v[96:97], v8, s[16:19], 0 offen offset:0 sc1
    buffer_store_dwordx2 v[98:99], v8, s[16:19], 0 offen offset:32 sc1
    buffer_store_dwordx2 v[100:101], v8, s[16:19], 0 offen offset:64 sc1
    buffer_store_dwordx2 v[102:103], v8, s[16:19], 0 offen offset:96 sc1
    v_subrev_u32 v131, 65536, v8
L_nocand:
    s_waitcnt lgkmcnt(0)
    v_lshlrev_b32 v80, 16, v112
    v_and_b32 v81, 0xffff0000, v112
    v_lshlrev_b32 v82, 16, v113
    v_and_b32 v83, 0xffff0000, v113
    v_lshlrev_b32 v84, 16, v114
    v_and_b32 v85, 0xffff0000, v114
    v_lshlrev_b32 v86, 16, v115
    v_and_b32 v87, 0xffff0000, v115
    v_lshlrev_b32 v88, 16, v116
    v_and_b32 v89, 0xffff0000, v116
    v_lshlrev_b32 v90, 16, v117
    v_and_b32 v91, 0xffff0000, v117
    v_lshlrev_b32 v92, 16, v118
    v_and_b32 v93, 0xffff0000, v118
    v_lshlrev_b32 v94, 16, v119
    v_and_b32 v95, 0xffff0000, v119
    v_pk_fma_f32 v[16:17], v[80:81], v[142:143], v[142:143] op_sel:[0,0,1] op_sel_hi:[1,0,1]
    v_pk_fma_f32 v[18:19], v[82:83], v[142:143], v[142:143] op_sel:[0,0,1] op_sel_hi:[1,0,1]
    v_pk_fma_f32 v[20:21], v[84:85], v[142:143], v[142:143] op_sel:[0,0,1] op_sel_hi:[1,0,1]
    v_pk_fma_f32 v[22:23], v[86:87], v[142:143], v[142:143] op_sel:[0,0,1] op_sel_hi:[1,0,1]
    v_pk_fma_f32 v[24:25], v[88:89], v[142:143], v[142:143] op_sel:[0,0,1] op_sel_hi:[1,0,1]
    v_pk_fma_f32 v[26:27], v[90:91], v[142:143], v[142:143] op_sel:[0,0,1] op_sel_hi:[1,0,1]
    v_pk_fma_f32 v[28:29], v[92:93], v[142:143], v[142:143] op_sel:[0,0,1] op_sel_hi:[1,0,1]
    v_pk_fma_f32 v[30:31], v[94:95], v[142:143], v[142:143] op_sel:[0,0,1] op_sel_hi:[1,0,1]
    v_cvt_pk_bf16_f32 v132, v16, v17
    v_cvt_pk_bf16_f32 v133, v18, v19
    v_cvt_pk_bf16_f32 v134, v20, v21
    v_cvt_pk_bf16_f32 v135, v22, v23
    v_cvt_pk_bf16_f32 v136, v24, v25
    v_cvt_pk_bf16_f32 v137, v26, v27
    v_cvt_pk_bf16_f32 v138, v28, v29
    v_cvt_pk_bf16_f32 v139, v30, v31
    v_cmp_eq_u32 s[4:5], s58, v144
    v_cmp_eq_u32 s[6:7], s59, v144
    s_nop 0
    s_or_b64 s[70:71], s[4:5], s[6:7]
    s_cbranch_scc0 L_nocand2
    s_lshl_b32 s86, s51, 12
    s_lshl_b32 s87, s52, 7
    s_add_u32 s86, s86, s87
    s_add_u32 s86, s86, 6619136
    v_lshl_add_u32 v8, v1, 3, s86
    v_add_u32 v9, 2048, v8
    v_cndmask_b32 v8, v8, v9, s[6:7]
    v_mov_b32 v9, 2147483648
    v_cndmask_b32 v8, v9, v8, s[70:71]
    buffer_store_dwordx2 v[132:133], v8, s[16:19], 0 offen offset:0 sc1
    buffer_store_dwordx2 v[134:135], v8, s[16:19], 0 offen offset:32 sc1
    buffer_store_dwordx2 v[136:137], v8, s[16:19], 0 offen offset:64 sc1
    buffer_store_dwordx2 v[138:139], v8, s[16:19], 0 offen offset:96 sc1
    v_subrev_u32 v140, 65536, v8
L_nocand2:
    v_mov_b32 v9, 2147483648
    v_xor_b32 v6, 0x8000, v5
    v_lshlrev_b32 v16, 16, v96
    v_and_b32 v17, 0xffff0000, v96
    v_lshlrev_b32 v18, 16, v97
    v_and_b32 v19, 0xffff0000, v97
    v_lshlrev_b32 v20, 16, v98
    v_and_b32 v21, 0xffff0000, v98
    v_lshlrev_b32 v22, 16, v99
    v_and_b32 v23, 0xffff0000, v99
    v_lshlrev_b32 v24, 16, v100
    v_and_b32 v25, 0xffff0000, v100
    v_lshlrev_b32 v26, 16, v101
    v_and_b32 v27, 0xffff0000, v101
    v_lshlrev_b32 v28, 16, v102
    v_and_b32 v29, 0xffff0000, v102
    v_lshlrev_b32 v30, 16, v103
    v_and_b32 v31, 0xffff0000, v103
    v_pk_add_f32 v[16:17], v[16:17], v[40:41]
    v_pk_add_f32 v[18:19], v[18:19], v[42:43]
    v_pk_add_f32 v[20:21], v[20:21], v[44:45]
    v_pk_add_f32 v[22:23], v[22:23], v[46:47]
    v_pk_add_f32 v[24:25], v[24:25], v[48:49]
    v_pk_add_f32 v[26:27], v[26:27], v[50:51]
    v_pk_add_f32 v[28:29], v[28:29], v[52:53]
    v_pk_add_f32 v[30:31], v[30:31], v[54:55]
    v_cvt_pk_bf16_f32 v104, v16, v17
    v_cvt_pk_bf16_f32 v105, v18, v19
    v_cvt_pk_bf16_f32 v106, v20, v21
    v_cvt_pk_bf16_f32 v107, v22, v23
    v_cvt_pk_bf16_f32 v108, v24, v25
    v_cvt_pk_bf16_f32 v109, v26, v27
    v_cvt_pk_bf16_f32 v110, v28, v29
    v_cvt_pk_bf16_f32 v111, v30, v31
    v_permlane16_swap_b32 v104, v106
    v_permlane16_swap_b32 v105, v107
    v_permlane16_swap_b32 v108, v110
    v_permlane16_swap_b32 v109, v111
    v_mov_b32 v16, v104
    v_mov_b32 v17, v105
    v_mov_b32 v18, v106
    v_mov_b32 v19, v107
    v_mov_b32_dpp v104, v108 row_ror:8 row_mask:0xf bank_mask:0xc
    v_mov_b32_dpp v105, v109 row_ror:8 row_mask:0xf bank_mask:0xc
    v_mov_b32_dpp v106, v110 row_ror:8 row_mask:0xf bank_mask:0xc
    v_mov_b32_dpp v107, v111 row_ror:8 row_mask:0xf bank_mask:0xc
    v_mov_b32_dpp v108, v16 row_ror:8 row_mask:0xf bank_mask:0x3
    v_mov_b32_dpp v109, v17 row_ror:8 row_mask:0xf bank_mask:0x3
    v_mov_b32_dpp v110, v18 row_ror:8 row_mask:0xf bank_mask:0x3
    v_mov_b32_dpp v111, v19 row_ror:8 row_mask:0xf bank_mask:0x3
    v_cndmask_b32 v8, v5, v9, s[96:97]
    v_lshlrev_b32 v16, 16, v132
    v_and_b32 v17, 0xffff0000, v132
    v_lshlrev_b32 v18, 16, v133
    v_and_b32 v19, 0xffff0000, v133
    v_lshlrev_b32 v20, 16, v134
    v_and_b32 v21, 0xffff0000, v134
    v_lshlrev_b32 v22, 16, v135
    v_and_b32 v23, 0xffff0000, v135
    v_lshlrev_b32 v24, 16, v136
    v_and_b32 v25, 0xffff0000, v136
    v_lshlrev_b32 v26, 16, v137
    v_and_b32 v27, 0xffff0000, v137
    v_lshlrev_b32 v28, 16, v138
    v_and_b32 v29, 0xffff0000, v138
    v_lshlrev_b32 v30, 16, v139
    v_and_b32 v31, 0xffff0000, v139
    v_pk_add_f32 v[16:17], v[16:17], v[80:81]
    v_pk_add_f32 v[18:19], v[18:19], v[82:83]
    v_pk_add_f32 v[20:21], v[20:21], v[84:85]
    v_pk_add_f32 v[22:23], v[22:23], v[86:87]
    v_pk_add_f32 v[24:25], v[24:25], v[88:89]
    v_pk_add_f32 v[26:27], v[26:27], v[90:91]
    v_pk_add_f32 v[28:29], v[28:29], v[92:93]
    v_pk_add_f32 v[30:31], v[30:31], v[94:95]
    v_cvt_pk_bf16_f32 v120, v16, v17
    v_cvt_pk_bf16_f32 v121, v18, v19
    v_cvt_pk_bf16_f32 v122, v20, v21
    v_cvt_pk_bf16_f32 v123, v22, v23
    v_cvt_pk_bf16_f32 v124, v24, v25
    v_cvt_pk_bf16_f32 v125, v26, v27
    v_cvt_pk_bf16_f32 v126, v28, v29
    v_cvt_pk_bf16_f32 v127, v30, v31
    v_permlane16_swap_b32 v120, v122
    v_permlane16_swap_b32 v121, v123
    v_permlane16_swap_b32 v124, v126
    v_permlane16_swap_b32 v125, v127
    v_mov_b32 v16, v120
    v_mov_b32 v17, v121
    v_mov_b32 v18, v122
    v_mov_b32 v19, v123
    v_mov_b32_dpp v120, v124 row_ror:8 row_mask:0xf bank_mask:0xc
    v_mov_b32_dpp v121, v125 row_ror:8 row_mask:0xf bank_mask:0xc
    v_mov_b32_dpp v122, v126 row_ror:8 row_mask:0xf bank_mask:0xc
    v_mov_b32_dpp v123, v127 row_ror:8 row_mask:0xf bank_mask:0xc
    v_mov_b32_dpp v124, v16 row_ror:8 row_mask:0xf bank_mask:0x3
L_walk_22:
    s_cbranch_execz L_walked
    v_mov_b32_dpp v125, v17 row_ror:8 row_mask:0xf bank_mask:0x3
    v_mov_b32_dpp v126, v18 row_ror:8 row_mask:0xf bank_mask:0x3
    v_mov_b32_dpp v127, v19 row_ror:8 row_mask:0xf bank_mask:0x3
    s_cmp_eq_u64 s[96:97], 0
    s_cbranch_scc1 L_noha
    buffer_store_dwordx2 v[32:33], v131, s[16:19], 0 offen offset:0 sc1
    buffer_store_dwordx2 v[34:35], v131, s[16:19], 0 offen offset:32 sc1
    buffer_store_dwordx2 v[36:37], v131, s[16:19], 0 offen offset:64 sc1
    buffer_store_dwordx2 v[38:39], v131, s[16:19], 0 offen offset:96 sc1
L_noha:
    s_cmp_eq_u64 s[70:71], 0
    s_cbranch_scc1 L_nohb
    buffer_store_dwordx2 v[112:113], v140, s[16:19], 0 offen offset:0 sc1
    buffer_store_dwordx2 v[114:115], v140, s[16:19], 0 offen offset:32 sc1
    buffer_store_dwordx2 v[116:117], v140, s[16:19], 0 offen offset:64 sc1
    buffer_store_dwordx2 v[118:119], v140, s[16:19], 0 offen offset:96 sc1
L_nohb:
    v_mov_b32 v8, 66304
    s_barrier
    ds_read_b64 v[10:11], v8
    s_waitcnt lgkmcnt(0)
    v_cmp_ne_u32 s[4:5], v10, v13
    v_cmp_ne_u32 s[6:7], v11, v13
    s_nop 0
    s_and_b64 s[4:5], s[4:5], s[6:7]
    v_cndmask_b32 v8, v9, v5, s[4:5]
    v_add_u32 v17, 64, v8
    v_mov_b32 v16, v8
    s_nop 1
    v_mov_b32_dpp v16, v17 row_ror:8 row_mask:0xf bank_mask:0xc
    v_mov_b32_dpp v17, v8 row_ror:8 row_mask:0xf bank_mask:0x3
    buffer_store_dwordx4 v[104:107], v16, s[24:27], 0 offen sc1
    buffer_store_dwordx4 v[108:111], v17, s[24:27], 0 offen sc1
    v_cmp_ne_u32 s[4:5], v10, v144
    v_cmp_ne_u32 s[6:7], v11, v144
    s_nop 0
    s_and_b64 s[4:5], s[4:5], s[6:7]
    v_cndmask_b32 v8, v9, v6, s[4:5]
    v_add_u32 v19, 64, v8
    v_mov_b32 v18, v8
    s_nop 1
    v_mov_b32_dpp v18, v19 row_ror:8 row_mask:0xf bank_mask:0xc
    v_mov_b32_dpp v19, v8 row_ror:8 row_mask:0xf bank_mask:0x3
    s_barrier
    s_barrier
    s_barrier
    buffer_store_dwordx4 v[120:123], v18, s[24:27], 0 offen sc1
    buffer_store_dwordx4 v[124:127], v19, s[24:27], 0 offen sc1
    s_branch L_fin
L_t3_ld:
    s_mov_b32 s90, 6144
    buffer_load_dwordx4 v[240:243], v14, s[36:39], s90 offen
    s_mov_b32 s90, 8192
    buffer_load_dwordx4 v[244:247], v14, s[36:39], s90 offen
    s_mov_b32 s90, 10240
    buffer_load_dwordx4 v[248:251], v14, s[36:39], s90 offen
    s_mov_b32 s90, 12288
    buffer_load_dwordx4 v[252:255], v14, s[36:39], s90 offen
    v_bfe_u32 v8, v0, 3, 1
    v_lshl_add_u32 v10, v1, 5, s67
    s_mov_b32 s60, 0
    s_mov_b32 s61, 0
    s_lshl_b32 s63, 1, s51
    s_mov_b32 m0, s51
    s_waitcnt lgkmcnt(0)
    v_max_u32 v98, v64, v65
    v_min_u32 v99, v64, v65
    s_nop 0
    v_min_u32_dpp v96, v98, v98 row_ror:8 row_mask:0xf bank_mask:0xf
    v_max_u32_dpp v98, v98, v98 row_ror:8 row_mask:0xf bank_mask:0xf
    v_max_u32_dpp v97, v99, v99 row_ror:8 row_mask:0xf bank_mask:0xf
    v_max_u32 v99, v96, v97
    v_min_u32_dpp v96, v98, v98 row_ror:4 row_mask:0xf bank_mask:0xf
    v_max_u32_dpp v98, v98, v98 row_ror:4 row_mask:0xf bank_mask:0xf
    v_max_u32_dpp v97, v99, v99 row_ror:4 row_mask:0xf bank_mask:0xf
    v_max_u32 v99, v96, v97
    v_min_u32_dpp v96, v98, v98 row_ror:2 row_mask:0xf bank_mask:0xf
    v_max_u32_dpp v98, v98, v98 row_ror:2 row_mask:0xf bank_mask:0xf
    v_max_u32_dpp v97, v99, v99 row_ror:2 row_mask:0xf bank_mask:0xf
    v_max_u32 v99, v96, v97
    v_min_u32_dpp v96, v98, v98 row_ror:1 row_mask:0xf bank_mask:0xf
    v_max_u32_dpp v98, v98, v98 row_ror:1 row_mask:0xf bank_mask:0xf
    v_max_u32_dpp v97, v99, v99 row_ror:1 row_mask:0xf bank_mask:0xf
    v_max_u32 v99, v96, v97
    v_readlane_b32 s58, v98, 0
    v_readlane_b32 s59, v99, 0
    v_readlane_b32 s86, v98, 16
    v_readlane_b32 s87, v99, 16
    s_nop 0
    s_max_u32 s59, s59, s87
    s_min_u32 s87, s58, s86
    s_max_u32 s58, s58, s86
    s_max_u32 s59, s59, s87
    v_readlane_b32 s86, v98, 32
    v_readlane_b32 s87, v99, 32
    s_nop 0
    s_max_u32 s59, s59, s87
    s_min_u32 s87, s58, s86
    s_max_u32 s58, s58, s86
    s_max_u32 s59, s59, s87
    v_readlane_b32 s86, v98, 48
    v_readlane_b32 s87, v99, 48
    s_nop 0
    s_max_u32 s59, s59, s87
    s_min_u32 s87, s58, s86
    s_max_u32 s58, s58, s86
    s_max_u32 s59, s59, s87
    s_waitcnt vmcnt(4)
    s_branch L_h4_chk0
L_h4_w0:
    s_waitcnt vmcnt(0)
L_h4_chk0:
    v_cmp_eq_u32 vcc, -1, v128
    s_nop 0
    s_andn2_b32 s86, vcc_lo, s63
    s_cbranch_scc0 L_h4_all0
    v_cndmask_b32 v96, v128, 0, vcc
    v_cndmask_b32 v97, v129, 0, vcc
    v_mov_b32 v128, 0
    v_mov_b32 v129, 0
    buffer_atomic_or_x2 v[128:129], v148, s[16:19], 0 offen sc0 sc1
    s_sub_u32 s56, s56, 1
    s_cbranch_scc1 L_h4_out
    v_min_u32_dpp v98, v96, v96 row_ror:8 row_mask:0xf bank_mask:0xf
    v_max_u32_dpp v96, v96, v96 row_ror:8 row_mask:0xf bank_mask:0xf
    v_max_u32_dpp v99, v97, v97 row_ror:8 row_mask:0xf bank_mask:0xf
    v_max_u32 v97, v98, v99
    v_min_u32_dpp v98, v96, v96 row_ror:4 row_mask:0xf bank_mask:0xf
    v_max_u32_dpp v96, v96, v96 row_ror:4 row_mask:0xf bank_mask:0xf
    v_max_u32_dpp v99, v97, v97 row_ror:4 row_mask:0xf bank_mask:0xf
    v_max_u32 v97, v98, v99
    v_min_u32_dpp v98, v96, v96 row_ror:2 row_mask:0xf bank_mask:0xf
    v_max_u32_dpp v96, v96, v96 row_ror:2 row_mask:0xf bank_mask:0xf
    v_max_u32_dpp v99, v97, v97 row_ror:2 row_mask:0xf bank_mask:0xf
    v_max_u32 v97, v98, v99
    v_min_u32_dpp v98, v96, v96 row_ror:1 row_mask:0xf bank_mask:0xf
    v_max_u32_dpp v96, v96, v96 row_ror:1 row_mask:0xf bank_mask:0xf
    v_max_u32_dpp v99, v97, v97 row_ror:1 row_mask:0xf bank_mask:0xf
    v_max_u32 v97, v98, v99
    v_readlane_b32 s70, v96, 0
    v_readlane_b32 s71, v97, 0
    s_nop 0
    s_cmp_eq_u64 s[70:71], s[60:61]
    s_cbranch_scc1 L_h4_w0
    s_mov_b64 s[60:61], s[70:71]
    s_bfe_u32 s86, s60, 0x40007
    s_bfe_u32 s87, s61, 0x40007
    s_sub_u32 s87, s86, s87
    s_lshl_b32 s87, s87, 12
    s_cselect_b32 s69, s87, 2048
    v_mad_i32_i24 v130, v8, s69, v10
    s_xor_b32 s86, s86, 15
    s_lshl_b32 s66, s86, 12
    buffer_load_dwordx4 v[64:67], v130, s[16:19], s66 offen sc1
    buffer_load_dwordx4 v[68:71], v130, s[16:19], s66 offen offset:16 sc1
    s_waitcnt vmcnt(2)
    s_branch L_h4_chk0
L_h4_own:
    s_waitcnt vmcnt(0)
    v_mov_b32 v128, 0
    v_mov_b32 v129, 0
    buffer_atomic_or_x2 v[128:129], v148, s[16:19], 0 offen sc0 sc1
    s_sub_u32 s56, s56, 1
    s_cbranch_scc0 L_h4_w0
L_h4_out:
    s_mov_b32 s56, 0
    s_waitcnt vmcnt(0)
    s_mov_b64 vcc, 0
L_h4_all0:
    v_writelane_b32 v128, s58, m0
    v_writelane_b32 v129, s59, m0
    s_nop 0
    v_min_u32_dpp v98, v128, v128 row_ror:8 row_mask:0xf bank_mask:0xf
    v_max_u32_dpp v96, v128, v128 row_ror:8 row_mask:0xf bank_mask:0xf
    v_max_u32_dpp v99, v129, v129 row_ror:8 row_mask:0xf bank_mask:0xf
    v_max_u32 v97, v98, v99
L_h4_all:
    v_min_u32_dpp v98, v96, v96 row_ror:4 row_mask:0xf bank_mask:0xf
    v_max_u32_dpp v96, v96, v96 row_ror:4 row_mask:0xf bank_mask:0xf
    v_max_u32_dpp v99, v97, v97 row_ror:4 row_mask:0xf bank_mask:0xf
    v_max_u32 v97, v98, v99
    v_min_u32_dpp v98, v96, v96 row_ror:2 row_mask:0xf bank_mask:0xf
    v_max_u32_dpp v96, v96, v96 row_ror:2 row_mask:0xf bank_mask:0xf
    v_max_u32_dpp v99, v97, v97 row_ror:2 row_mask:0xf bank_mask:0xf
    v_max_u32 v97, v98, v99
    v_min_u32_dpp v98, v96, v96 row_ror:1 row_mask:0xf bank_mask:0xf
L_walk_23:
    s_cbranch_execz L_walked
    v_max_u32_dpp v96, v96, v96 row_ror:1 row_mask:0xf bank_mask:0xf
    v_max_u32_dpp v99, v97, v97 row_ror:1 row_mask:0xf bank_mask:0xf
    v_max_u32 v97, v98, v99
    v_readlane_b32 s70, v96, 0
    v_readlane_b32 s71, v97, 0
    s_nop 0
    s_cmp_ge_u32 s58, s71
    s_cselect_b32 s86, vcc_lo, 0
    s_cmp_lg_u32 s86, 0
    s_cbranch_scc1 L_h4_own
    s_cmp_eq_u64 s[70:71], s[60:61]
    s_cbranch_scc1 L_h4_go
    s_mov_b64 s[60:61], s[70:71]
    s_bfe_u32 s86, s60, 0x40007
    s_bfe_u32 s87, s61, 0x40007
    s_sub_u32 s87, s86, s87
    s_lshl_b32 s87, s87, 12
    s_cselect_b32 s69, s87, 2048
    v_mad_i32_i24 v130, v8, s69, v10
    s_xor_b32 s86, s86, 15
    s_lshl_b32 s66, s86, 12
    buffer_load_dwordx4 v[64:67], v130, s[16:19], s66 offen sc1
    buffer_load_dwordx4 v[68:71], v130, s[16:19], s66 offen offset:16 sc1
L_h4_go:
    v_mov_b32 v16, 66304
    v_mov_b32 v24, s60
    v_mov_b32 v25, s61
    ds_write_b64 v16, v[24:25]
    s_waitcnt lgkmcnt(0)
    s_barrier
    s_waitcnt vmcnt(0)
    s_branch L_seg_chk
L_seg:
    buffer_load_dwordx4 v[64:67], v130, s[16:19], s66 offen sc1
    buffer_load_dwordx4 v[68:71], v130, s[16:19], s66 offen offset:16 sc1
    s_waitcnt vmcnt(0)
L_seg_chk:
    v_max3_u32 v16, v65, v67, v69
    v_max_u32 v16, v16, v71
    v_cmp_eq_u32 vcc, -1, v16
    s_cbranch_vccz L_ok_6
    s_sub_u32 s56, s56, 1
    s_cbranch_scc0 L_seg
    s_mov_b32 s56, 0
L_ok_6:
    v_perm_b32 v80, v64, v64, v72
    v_perm_b32 v81, v64, v64, v73
    v_perm_b32 v82, v64, v64, v74
    v_perm_b32 v83, v64, v64, v75
    v_perm_b32 v84, v64, v64, v76
    v_perm_b32 v85, v64, v64, v77
    v_perm_b32 v86, v64, v64, v78
    v_perm_b32 v87, v64, v64, v79
    v_mfma_f32_16x16x32_bf16 v[88:91], v[80:83], v[164:167], 0
    v_perm_b32 v92, v65, v65, v72
    v_perm_b32 v93, v65, v65, v73
    v_perm_b32 v94, v65, v65, v74
    v_perm_b32 v95, v65, v65, v75
    v_mfma_f32_16x16x32_bf16 v[88:91], v[84:87], v[168:171], v[88:91]
    v_perm_b32 v80, v65, v65, v76
    v_perm_b32 v81, v65, v65, v77
    v_perm_b32 v82, v65, v65, v78
    v_perm_b32 v83, v65, v65, v79
    v_mfma_f32_16x16x32_bf16 v[88:91], v[92:95], v[172:175], v[88:91]
    v_perm_b32 v84, v66, v66, v72
    v_perm_b32 v85, v66, v66, v73
    v_perm_b32 v86, v66, v66, v74
    v_perm_b32 v87, v66, v66, v75
    v_mfma_f32_16x16x32_bf16 v[88:91], v[80:83], v[176:179], v[88:91]
    v_perm_b32 v92, v66, v66, v76
    v_perm_b32 v93, v66, v66, v77
    v_perm_b32 v94, v66, v66, v78
    v_perm_b32 v95, v66, v66, v79
    v_mfma_f32_16x16x32_bf16 v[88:91], v[84:87], v[180:183], v[88:91]
    v_perm_b32 v80, v67, v67, v72
    v_perm_b32 v81, v67, v67, v73
    v_perm_b32 v82, v67, v67, v74
    v_perm_b32 v83, v67, v67, v75
    v_mfma_f32_16x16x32_bf16 v[88:91], v[92:95], v[184:187], v[88:91]
    v_perm_b32 v84, v67, v67, v76
    v_perm_b32 v85, v67, v67, v77
    v_perm_b32 v86, v67, v67, v78
    v_perm_b32 v87, v67, v67, v79
    v_mfma_f32_16x16x32_bf16 v[88:91], v[80:83], v[188:191], v[88:91]
    v_perm_b32 v92, v68, v68, v72
    v_perm_b32 v93, v68, v68, v73
    v_perm_b32 v94, v68, v68, v74
    v_perm_b32 v95, v68, v68, v75
    v_mfma_f32_16x16x32_bf16 v[88:91], v[84:87], v[192:195], v[88:91]
    v_perm_b32 v80, v68, v68, v76
    v_perm_b32 v81, v68, v68, v77
    v_perm_b32 v82, v68, v68, v78
    v_perm_b32 v83, v68, v68, v79
    v_mfma_f32_16x16x32_bf16 v[88:91], v[92:95], v[196:199], v[88:91]
    v_perm_b32 v84, v69, v69, v72
    v_perm_b32 v85, v69, v69, v73
    v_perm_b32 v86, v69, v69, v74
    v_perm_b32 v87, v69, v69, v75
    v_mfma_f32_16x16x32_bf16 v[88:91], v[80:83], v[200:203], v[88:91]
    v_perm_b32 v92, v69, v69, v76
    v_perm_b32 v93, v69, v69, v77
    v_perm_b32 v94, v69, v69, v78
    v_perm_b32 v95, v69, v69, v79
    v_mfma_f32_16x16x32_bf16 v[88:91], v[84:87], v[204:207], v[88:91]
    v_perm_b32 v80, v70, v70, v72
    v_perm_b32 v81, v70, v70, v73
    v_perm_b32 v82, v70, v70, v74
    v_perm_b32 v83, v70, v70, v75
    v_mfma_f32_16x16x32_bf16 v[88:91], v[92:95], v[208:211], v[88:91]
    v_perm_b32 v84, v70, v70, v76
    v_perm_b32 v85, v70, v70, v77
    v_perm_b32 v86, v70, v70, v78
    v_perm_b32 v87, v70, v70, v79
    v_mfma_f32_16x16x32_bf16 v[88:91], v[80:83], v[212:215], v[88:91]
    v_perm_b32 v92, v71, v71, v72
    v_perm_b32 v93, v71, v71, v73
    v_perm_b32 v94, v71, v71, v74
    v_perm_b32 v95, v71, v71, v75
    v_mfma_f32_16x16x32_bf16 v[88:91], v[84:87], v[216:219], v[88:91]
    v_perm_b32 v80, v71, v71, v76
    v_perm_b32 v81, v71, v71, v77
    v_perm_b32 v82, v71, v71, v78
    v_perm_b32 v83, v71, v71, v79
    v_mfma_f32_16x16x32_bf16 v[88:91], v[92:95], v[220:223], v[88:91]
    s_nop 0
    v_mfma_f32_16x16x32_bf16 v[88:91], v[80:83], v[224:227], v[88:91]
    s_nop 7
    ds_write_b128 v18, v[88:91]
    s_waitcnt lgkmcnt(0)
    s_barrier
    ds_read2st64_b32 v[24:25], v133 offset0:0 offset1:4
    ds_read2st64_b32 v[26:27], v133 offset0:8 offset1:12
    s_mov_b32 s79, 114688
    s_cmp_eq_u32 s83, 0
    s_waitcnt lgkmcnt(0)
    v_pk_add_f32 v[24:25], v[24:25], v[26:27]
    v_add_f32 v24, v24, v25
    s_cbranch_scc1 L_h5_far
    buffer_store_dword v24, v131, s[16:19], 0 offen
L_h5_out:
    s_lshr_b32 s88, s48, 1
    s_cselect_b32 s86, s69, 0
    s_cselect_b32 s63, s61, s60
    s_and_b32 s87, s48, 1
    s_and_b32 s89, s82, 7
    s_lshl1_add_u32 s87, s89, s87
    s_lshl_b32 s87, s87, 7
    s_add_u32 s86, s86, s66
    s_add_u32 s86, s86, s87
    s_add_u32 s86, s86, 6553600
    v_lshl_add_u32 v142, v0, 1, s86
    v_mov_b32 v140, 0
    v_mov_b32 v141, 0
    s_mov_b32 s65, 65536
    buffer_load_short_d16_hi v140, v142, s[16:19], 0 offen sc1
    buffer_load_short_d16_hi v141, v142, s[16:19], s65 offen sc1
    s_and_b32 s86, s63, 0x7ff
    s_sub_u32 s86, 2047, s86
    s_lshl_b32 s86, s86, 11
    s_add_u32 s86, s86, s87
    v_lshl_add_u32 v143, v0, 1, s86
    s_ashr_i32 s86, s63, 31
    s_orn2_b32 s86, 0x80000000, s86
    s_xor_b32 s63, s63, s86
    s_and_b32 s63, s63, 0xffff0000
L_walk_24:
    s_cbranch_execz L_walked
    s_lshr_b32 s86, s48, 1
    s_and_b32 s87, s48, 1
    s_lshl_b32 s88, s86, 9
    s_lshl_b32 s89, s87, 7
    s_add_u32 s88, s88, s89
    s_add_u32 s88, s88, 94208
    v_lshrrev_b32 v17, 3, v0
    v_lshl_add_u32 v20, v17, 4, s88
    v_bfe_u32 v9, v0, 2, 1
    v_lshl_add_u32 v20, v9, 8, v20
    v_and_b32 v9, 3, v0
    v_lshl_add_u32 v20, v9, 2, v20
    s_and_b32 s89, s82, 7
    s_lshl3_add_u32 s86, s86, s89
    s_lshl1_add_u32 s86, s86, s87
    s_lshl_b32 s86, s86, 11
    s_add_u32 s86, s86, 917504
    v_lshl_add_u32 v9, v17, 8, s86
    v_and_b32 v17, 7, v0
    v_lshl_add_u32 v9, v17, 3, v9
    s_mov_b32 s76, 0
    s_mov_b32 s77, 0x41900000
    s_lshl_b32 s86, s48, 7
    s_add_u32 s86, s86, 100352
    v_lshl_add_u32 v11, v8, 6, s86
    v_lshl_add_u32 v11, v1, 4, v11
    v_and_b32 v16, 7, v0
    v_cmp_eq_u32 vcc, 7, v16
    v_lshl_add_u32 v16, v16, 2, v1
    v_mul_u32_u24 v17, 37, v16
    v_lshrrev_b32 v17, 8, v17
    v_add_u32 v16, v16, v17
    v_lshl_or_b32 v17, v1, 3, 7
    v_cndmask_b32 v16, v16, v17, vcc
    v_lshl_add_u32 v16, v8, 5, v16
    v_lshl_add_u32 v10, v16, 1, s86
    v_mov_b32 v144, s63
    v_mul_f32 v144, 0xbfb8aa3b, v144
    v_exp_f32 v144, v144
    s_nop 0
    v_add_f32 v144, 1.0, v144
    v_rcp_f32 v144, v144
    s_nop 0
    v_cvt_pk_bf16_f32 v144, v144, v144
    v_lshlrev_b32 v144, 16, v144
    s_mov_b32 s6, 0x80808080
    s_mov_b32 s7, 0x80808080
    v_mov_b32 v19, v9
    buffer_load_dwordx4 v[112:115], v137, s[16:19], 0 offen sc1
    buffer_load_dwordx4 v[116:119], v137, s[16:19], s79 offen sc1
    s_waitcnt vmcnt(0)
    s_branch L_h5_chk
L_h5:
    v_cmp_eq_u32 vcc, -1, v115
    s_cbranch_vccz L_h5_s0
    s_mov_b64 exec, vcc
    buffer_load_dwordx4 v[112:115], v137, s[16:19], 0 offen sc1
    s_mov_b64 exec, -1
L_h5_s0:
    v_cmp_eq_u32 vcc, -1, v119
    s_cbranch_vccz L_h5_s1
    s_mov_b64 exec, vcc
    buffer_load_dwordx4 v[116:119], v137, s[16:19], s79 offen sc1
    s_mov_b64 exec, -1
L_h5_s1:
    s_waitcnt vmcnt(0)
L_h5_chk:
    v_max_u32 v16, v115, v119
    v_cmp_eq_u32 vcc, -1, v16
    s_cbranch_vccz L_ok_7
    s_sub_u32 s56, s56, 1
    s_cbranch_scc0 L_h5
    s_mov_b32 s56, 0
L_ok_7:
    v_permlane32_swap_b32 v112, v114
    v_permlane32_swap_b32 v113, v115
    v_permlane32_swap_b32 v116, v118
    v_permlane32_swap_b32 v117, v119
    v_add_f32 v112, v112, v114
    v_add_f32 v113, v113, v115
    v_add_f32 v116, v116, v118
    v_add_f32 v117, v117, v119
    v_permlane16_swap_b32 v112, v113
    s_nop 0
    v_permlane16_swap_b32 v116, v117
    v_add_f32 v112, v112, v113
    v_add_f32 v116, v116, v117
    v_cvt_pk_bf16_f32 v25, v112, v116
    v_lshlrev_b32 v24, 16, v25
    v_and_b32 v28, 0xffff0000, v25
    v_mul_f32 v25, 0xbfb8aa3b, v24
    v_exp_f32 v25, v25
    s_nop 0
    v_add_f32 v25, 1.0, v25
    v_rcp_f32 v25, v25
    s_nop 0
    v_mul_f32 v24, v24, v25
    v_cvt_pk_bf16_f32 v24, v24, v24
    v_lshlrev_b32 v24, 16, v24
    v_mul_f32 v24, v24, v28
    v_cvt_pk_bf16_f32 v24, v24, v24
    ds_write_b16 v10, v24
    s_waitcnt lgkmcnt(0)
    ds_read_b128 v[64:67], v11
    s_waitcnt lgkmcnt(0)
    v_perm_b32 v80, v64, v64, v72
    v_perm_b32 v81, v64, v64, v73
    v_perm_b32 v82, v64, v64, v74
    v_perm_b32 v83, v64, v64, v75
    v_perm_b32 v84, v64, v64, v76
    v_perm_b32 v85, v64, v64, v77
    v_perm_b32 v86, v64, v64, v78
    v_perm_b32 v87, v64, v64, v79
    v_mfma_f32_16x16x32_bf16 v[88:91], v[80:83], v[228:231], 0
    v_perm_b32 v92, v65, v65, v72
    v_perm_b32 v93, v65, v65, v73
    v_perm_b32 v94, v65, v65, v74
    v_perm_b32 v95, v65, v65, v75
    v_mfma_f32_16x16x32_bf16 v[88:91], v[84:87], v[232:235], v[88:91]
    v_perm_b32 v80, v65, v65, v76
    v_perm_b32 v81, v65, v65, v77
    v_perm_b32 v82, v65, v65, v78
    v_perm_b32 v83, v65, v65, v79
    v_mfma_f32_16x16x32_bf16 v[88:91], v[92:95], v[236:239], v[88:91]
    v_perm_b32 v84, v66, v66, v72
    v_perm_b32 v85, v66, v66, v73
    v_perm_b32 v86, v66, v66, v74
    v_perm_b32 v87, v66, v66, v75
    v_mfma_f32_16x16x32_bf16 v[88:91], v[80:83], v[240:243], v[88:91]
    v_perm_b32 v92, v66, v66, v76
    v_perm_b32 v93, v66, v66, v77
    v_perm_b32 v94, v66, v66, v78
    v_perm_b32 v95, v66, v66, v79
    v_mfma_f32_16x16x32_bf16 v[88:91], v[84:87], v[244:247], v[88:91]
    v_perm_b32 v80, v67, v67, v72
    v_perm_b32 v81, v67, v67, v73
    v_perm_b32 v82, v67, v67, v74
    v_perm_b32 v83, v67, v67, v75
    v_mfma_f32_16x16x32_bf16 v[88:91], v[92:95], v[248:251], v[88:91]
    s_nop 0
    v_mfma_f32_16x16x32_bf16 v[88:91], v[80:83], v[252:255], v[88:91]
    s_nop 7
    ds_write_b128 v18, v[88:91] offset:4096
    s_waitcnt lgkmcnt(0)
    s_barrier
    ds_read2st64_b32 v[24:25], v20 offset0:0 offset1:4
    ds_read2st64_b32 v[26:27], v20 offset0:8 offset1:12
    s_waitcnt lgkmcnt(0)
    v_pk_add_f32 v[24:25], v[24:25], v[26:27]
    v_add_f32 v24, v24, v25
    v_cvt_f64_f32 v[26:27], v24
    v_add_f64 v[24:25], v[26:27], s[76:77]
    buffer_atomic_add_f64 v[24:25], v19, s[16:19], 0 offen sc0 sc1
    s_barrier
    s_mov_b32 s77, 0xc1df0000
    v_add_f64 v[26:27], v[26:27], s[76:77]
    s_waitcnt vmcnt(1)
    v_max_u32 v16, v140, v141
    v_cmp_eq_u32 vcc, 0xffff0000, v16
    s_cbranch_vccnz L_fin_ld
L_fin_go:
    s_mov_b32 s88, 0x4c000000
    v_mov_b32 v17, 2147483648
    s_waitcnt vmcnt(0)
    v_add_f64 v[24:25], v[24:25], v[26:27]
    v_cvt_f32_f64 v24, v[24:25]
    v_cmp_lt_f32 vcc, |v24|, s88
    v_cvt_pk_bf16_f32 v24, v24, v24
    v_lshlrev_b32 v24, 16, v24
    v_mul_f32 v24, v24, v144
    v_cndmask_b32 v17, v17, v143, vcc
    v_cvt_pk_bf16_f32 v24, v24, v24
    v_lshlrev_b32 v24, 16, v24
    v_add_f32 v24, v24, v141
    v_cvt_pk_bf16_f32 v24, v24, v24
    v_lshlrev_b32 v24, 16, v24
    v_add_f32 v24, v24, v140
    v_cvt_pk_bf16_f32 v24, v24, v24
    buffer_store_short v24, v17, s[24:27], 0 offen
L_fin:
L_end:
    s_endpgm
L_b_restart:
    s_waitcnt vmcnt(0)
    v_xor_b32 v9, 0x8000, v7
    buffer_load_dwordx4 v[136:139], v7, s[8:11], 0 offen
    buffer_load_dwordx4 v[140:143], v9, s[8:11], 0 offen
    v_mov_b32 v8, s68
    s_mov_b32 s66, 0xffffaaaa
    s_mov_b32 s63, 1
    s_branch L_b_init
L_b_g4:
    s_lshr_b32 s86, s78, 2
    buffer_load_dwordx4 v[48:51], v157, s[16:19], s86 offen offset:0 sc1
    buffer_load_dwordx4 v[52:55], v158, s[16:19], s86 offen offset:0 sc1
    s_waitcnt vmcnt(0)
    s_sub_u32 s56, s56, 1
    s_cbranch_scc0 L_b_c4
    s_mov_b32 s56, 0
    s_branch L_b_d4
L_walk_25:
    s_cbranch_execz L_walked
L_b_g5:
    s_lshr_b32 s86, s78, 2
    buffer_load_dwordx4 v[56:59], v157, s[16:19], s86 offen offset:1024 sc1
    buffer_load_dwordx4 v[60:63], v158, s[16:19], s86 offen offset:1024 sc1
    s_waitcnt vmcnt(0)
    s_sub_u32 s56, s56, 1
    s_cbranch_scc0 L_b_c5
    s_mov_b32 s56, 0
    s_branch L_b_d5
L_b_g6:
    s_lshr_b32 s86, s79, 2
    buffer_load_dwordx4 v[64:67], v157, s[16:19], s86 offen offset:0 sc1
    buffer_load_dwordx4 v[68:71], v158, s[16:19], s86 offen offset:0 sc1
    s_waitcnt vmcnt(0)
    s_sub_u32 s56, s56, 1
    s_cbranch_scc0 L_b_c6
    s_mov_b32 s56, 0
    s_branch L_b_d6
L_b_g7:
    s_lshr_b32 s86, s79, 2
    buffer_load_dwordx4 v[72:75], v157, s[16:19], s86 offen offset:1024 sc1
    buffer_load_dwordx4 v[76:79], v158, s[16:19], s86 offen offset:1024 sc1
    s_waitcnt vmcnt(0)
    s_sub_u32 s56, s56, 1
    s_cbranch_scc0 L_b_c7
    s_mov_b32 s56, 0
    s_branch L_b_d7
L_b_g8:
    s_lshr_b32 s86, s76, 2
    buffer_load_dwordx4 v[16:19], v157, s[16:19], s86 offen offset:0 sc1
    buffer_load_dwordx4 v[20:23], v158, s[16:19], s86 offen offset:0 sc1
    s_waitcnt vmcnt(0)
    s_sub_u32 s56, s56, 1
    s_cbranch_scc0 L_b_c8
    s_mov_b32 s56, 0
    s_branch L_b_d8
L_b_g9:
    s_lshr_b32 s86, s76, 2
    buffer_load_dwordx4 v[24:27], v157, s[16:19], s86 offen offset:1024 sc1
    buffer_load_dwordx4 v[28:31], v158, s[16:19], s86 offen offset:1024 sc1
    s_waitcnt vmcnt(0)
    s_sub_u32 s56, s56, 1
    s_cbranch_scc0 L_b_c9
    s_mov_b32 s56, 0
    s_branch L_b_d9
L_b_g10:
    s_lshr_b32 s86, s77, 2
    buffer_load_dwordx4 v[32:35], v157, s[16:19], s86 offen offset:0 sc1
    buffer_load_dwordx4 v[36:39], v158, s[16:19], s86 offen offset:0 sc1
    s_waitcnt vmcnt(0)
    s_sub_u32 s56, s56, 1
    s_cbranch_scc0 L_b_c10
    s_mov_b32 s56, 0
    s_branch L_b_d10
L_b_g11:
    s_lshr_b32 s86, s77, 2
    buffer_load_dwordx4 v[40:43], v157, s[16:19], s86 offen offset:1024 sc1
    buffer_load_dwordx4 v[44:47], v158, s[16:19], s86 offen offset:1024 sc1
    s_waitcnt vmcnt(0)
    s_sub_u32 s56, s56, 1
    s_cbranch_scc0 L_b_c11
    s_mov_b32 s56, 0
    s_branch L_b_d11
L_b_g12:
    s_lshr_b32 s86, s78, 2
    buffer_load_dwordx4 v[48:51], v157, s[16:19], s86 offen offset:0 sc1
    buffer_load_dwordx4 v[52:55], v158, s[16:19], s86 offen offset:0 sc1
    s_waitcnt vmcnt(0)
    s_sub_u32 s56, s56, 1
    s_cbranch_scc0 L_b_c12
    s_mov_b32 s56, 0
    s_branch L_b_d12
L_b_g13:
    s_lshr_b32 s86, s78, 2
    buffer_load_dwordx4 v[56:59], v157, s[16:19], s86 offen offset:1024 sc1
    buffer_load_dwordx4 v[60:63], v158, s[16:19], s86 offen offset:1024 sc1
    s_waitcnt vmcnt(0)
    s_sub_u32 s56, s56, 1
    s_cbranch_scc0 L_b_c13
    s_mov_b32 s56, 0
    s_branch L_b_d13
L_b_g14:
    s_lshr_b32 s86, s79, 2
    buffer_load_dwordx4 v[64:67], v157, s[16:19], s86 offen offset:0 sc1
    buffer_load_dwordx4 v[68:71], v158, s[16:19], s86 offen offset:0 sc1
    s_waitcnt vmcnt(0)
    s_sub_u32 s56, s56, 1
    s_cbranch_scc0 L_b_c14
    s_mov_b32 s56, 0
    s_branch L_b_d14
L_b_g15:
    s_lshr_b32 s86, s79, 2
    buffer_load_dwordx4 v[72:75], v157, s[16:19], s86 offen offset:1024 sc1
    buffer_load_dwordx4 v[76:79], v158, s[16:19], s86 offen offset:1024 sc1
    s_waitcnt vmcnt(0)
    s_sub_u32 s56, s56, 1
    s_cbranch_scc0 L_b_c15
    s_mov_b32 s56, 0
    s_branch L_b_d15
L_b_p0:
    v_mov_b32 v8, 0
    buffer_atomic_or v8, v159, s[16:19], 0 offen sc0 sc1
L_b_w0:
    s_waitcnt vmcnt(0)
    ds_write_b32 v12, v12
    v_mov_b32 v12, v162
    v_cmp_eq_u32 vcc, s68, v8
    s_nop 0
    s_lshr_b32 s65, vcc_lo, 1
    s_and_b32 s65, s65, vcc_lo
    s_andn2_b32 s65, s65, s66
    s_cbranch_scc0 L_b_q0
    s_or_b32 s66, s66, s65
    s_branch L_b_r0
L_b_q0:
    s_sub_u32 s56, s56, 1
    s_cbranch_scc0 L_b_p0
    s_mov_b32 s56, 0
    s_not_b32 s65, s66
    s_branch L_b_r0
L_b_p1:
    v_mov_b32 v8, 0
    buffer_atomic_or v8, v159, s[16:19], 0 offen sc0 sc1
    s_waitcnt vmcnt(0)
    v_cmp_eq_u32 vcc, s68, v8
    s_nop 0
    s_lshr_b32 s65, vcc_lo, 1
    s_and_b32 s65, s65, vcc_lo
    s_andn2_b32 s65, s65, s66
    s_cbranch_scc0 L_b_q1
    s_or_b32 s66, s66, s65
    s_branch L_b_r1
L_b_q1:
    s_sub_u32 s56, s56, 1
    s_cbranch_scc0 L_b_p1
    s_mov_b32 s56, 0
    s_not_b32 s65, s66
    s_branch L_b_r1
L_h5_far:
    buffer_store_dword v24, v131, s[16:19], 0 offen sc1
    s_branch L_h5_out
L_fin_ld:
    buffer_load_short_d16_hi v140, v142, s[16:19], 0 offen sc1
    buffer_load_short_d16_hi v141, v142, s[16:19], s65 offen sc1
    s_waitcnt vmcnt(0)
    v_max_u32 v16, v140, v141
    v_cmp_eq_u32 vcc, 0xffff0000, v16
    s_cbranch_vccz L_fin_go
    s_sub_u32 s56, s56, 1
    s_cbranch_scc0 L_fin_ld
    s_branch L_fin_go
L_last:
    s_endpgm
.section .rodata,"a"
.p2align 6
.amdhsa_kernel sequential_preLN__linear_attn_block__moe_arch_mod__prompt_kernel
  .amdhsa_next_free_vgpr 256
  .amdhsa_next_free_sgpr 102
  .amdhsa_accum_offset 256
  .amdhsa_group_segment_fixed_size 0
  .amdhsa_kernarg_size 88
  .amdhsa_user_sgpr_count 2
  .amdhsa_user_sgpr_kernarg_segment_ptr 1
  .amdhsa_system_sgpr_workgroup_id_x 1
.end_amdhsa_kernel
```

```asm
; @launch grid=(256,1,1) block=(512,1,1) lds=163840
.amdgcn_target "amdgcn-amd-amdhsa--gfx950"
.text
.globl sequential_preLN__linear_attn_block__moe_arch_mod__prompt_kernel
.p2align 8
.type sequential_preLN__linear_attn_block__moe_arch_mod__prompt_kernel,@function
sequential_preLN__linear_attn_block__moe_arch_mod__prompt_kernel:
    s_cmp_ge_u32 s2, 256
    s_cbranch_scc1 L_end
    s_load_dwordx16 s[64:79], s[0:1], 0
    s_load_dwordx4 s[80:83], s[0:1], 64
    s_load_dwordx2 s[84:85], s[0:1], 80
    v_lshrrev_b32 v1, 6, v0
    v_and_b32 v0, 63, v0
    v_readfirstlane_b32 s3, v1
    s_and_b32 s44, s2, 7
    s_lshr_b32 s45, s2, 3
    s_and_b32 s46, s44, 1
    s_lshl_b32 s46, s46, 3
    s_and_b32 s86, s45, 7
    s_add_u32 s46, s46, s86
    s_lshr_b32 s47, s44, 1
    s_lshl_b32 s47, s47, 2
    s_lshr_b32 s86, s45, 3
    s_add_u32 s47, s47, s86
    s_mov_b32 s51, s47
    s_mov_b32 s52, s46
    s_and_b32 s48, s3, 3
    s_and_b32 s49, s3, 1
    s_bfe_u32 s50, s3, 0x10001
    s_mov_b32 s56, 65536
    s_mov_b32 s95, 0x3f803f80
    s_movk_i32 s92, 0x1000
    s_movk_i32 s93, 0x2000
    s_movk_i32 s94, 0x3000
    s_cmp_lt_u32 s3, 4
    s_cbranch_scc1 L_comp0
    v_lshrrev_b32 v20, 3, v0
    v_and_b32 v21, 7, v0
    v_lshrrev_b32 v22, 4, v0
    v_xor_b32 v23, v21, v22
    v_xor_b32 v24, 4, v23
    s_lshl_b32 s86, s48, 5
    v_add_u32 v25, s86, v20
    v_lshlrev_b32 v25, 11, v25
    v_lshl_add_u32 v2, v23, 4, v25
    v_lshl_add_u32 v3, v24, 4, v25
    v_add_u32 v3, 15360, v3
    v_lshl_add_u32 v4, v23, 4, v25
    v_add_u32 v4, 30720, v4
    v_lshl_add_u32 v5, v24, 4, v25
    v_add_u32 v5, 46080, v5
    s_lshl_b32 s86, s48, 4
    v_add_u32 v25, s86, v20
    v_mul_u32_u24 v25, 6144, v25
    s_lshl_b32 s86, s47, 7
    v_add_u32 v25, s86, v25
    v_bfe_u32 v26, v0, 4, 1
    v_lshlrev_b32 v26, 1, v26
    v_xor_b32 v26, v26, v21
    v_xor_b32 v27, 4, v26
    v_lshl_add_u32 v6, v26, 4, v25
    v_lshl_add_u32 v7, v27, 4, v25
    v_add_u32 v7, 48128, v7
    v_lshl_add_u32 v8, v26, 4, v25
    v_add_u32 v8, 2048, v8
    v_lshl_add_u32 v9, v27, 4, v25
    v_add_u32 v9, 50176, v9
    v_lshl_add_u32 v10, v26, 4, v25
    v_add_u32 v10, 4096, v10
    v_lshl_add_u32 v11, v27, 4, v25
    v_add_u32 v11, 52224, v11
    s_lshl_b32 s63, s46, 18
    s_lshl_b32 s53, s48, 12
    s_lshl_b32 s62, s48, 11
    s_add_u32 s62, s62, 16384
    s_setprio 1
    s_lshl_b32 s86, s45, 2
    s_add_u32 s86, s86, s48
    s_mul_i32 s87, s86, 12288
    s_and_b32 s88, s47, 12
    s_lshl_b32 s88, s88, 7
    s_add_u32 s87, s87, s88
    s_add_u32 s87, s87, 384
    s_bitcmp1_b32 s47, 2
    s_cselect_b32 s87, 2147483648, s87
    v_lshl_add_u32 v37, v0, 11, s87
    v_mov_b32 v24, 2147483648
    v_cmp_gt_u32 vcc, 6, v0
    s_nop 1
    v_cndmask_b32 v37, v24, v37, vcc
    s_lshl_b32 s86, s86, 14
    s_and_b32 s88, s52, 8
    s_lshl_b32 s88, s88, 7
    s_add_u32 s86, s86, s88
    s_add_u32 s86, s86, 384
    v_lshl_add_u32 v38, v0, 11, s86
    v_cmp_gt_u32 vcc, 8, v0
    s_nop 1
    v_cndmask_b32 v38, v24, v38, vcc
    s_waitcnt lgkmcnt(0)
    s_mov_b32 s8, s64
    s_and_b32 s9, s65, 0xffff
    s_mov_b32 s10, 4194304
    s_mov_b32 s11, 0x20000
    s_mov_b32 s12, s66
    s_and_b32 s13, s67, 0xffff
    s_mov_b32 s14, 6291456
    s_mov_b32 s15, 0x20000
    s_and_b32 s86, s47, 12
    s_and_b32 s87, s46, 8
    s_add_u32 s64, s86, s87
    s_and_b32 s64, s64, 15
    s_mov_b32 s67, s64
    s_load_dword s61, s[84:85], 524288
    s_lshr_b32 s90, s67, 2
    s_mul_i32 s90, s90, 1572864
    buffer_load_dword v39, v37, s[12:15], s90 offen
    s_add_u32 m0, s53, 40960
    s_lshl_b32 s70, s64, 7
    s_add_u32 s70, s70, s63
    buffer_load_dwordx4 v2, s[8:11], s70 offen offset:0 lds
    buffer_load_dwordx4 v3, s[8:11], s70 offen offset:1024 lds
    buffer_load_dwordx4 v4, s[8:11], s70 offen offset:2048 lds
    buffer_load_dwordx4 v5, s[8:11], s70 offen offset:3072 lds
    s_mul_i32 s91, s64, 393216
    s_add_u32 s64, s64, 1
    s_and_b32 s64, s64, 15
    s_add_u32 m0, s62, 40960
    s_nop 0
    buffer_load_dwordx4 v6, s[12:15], s91 offen offset:0 lds
    buffer_load_dwordx4 v7, s[12:15], s91 offen offset:1024 lds
    s_add_u32 m0, s62, 49152
    s_nop 0
    buffer_load_dwordx4 v8, s[12:15], s91 offen offset:0 lds
    buffer_load_dwordx4 v9, s[12:15], s91 offen offset:1024 lds
    s_add_u32 m0, s62, 57344
    s_nop 0
    buffer_load_dwordx4 v10, s[12:15], s91 offen offset:0 lds
    buffer_load_dwordx4 v11, s[12:15], s91 offen offset:1024 lds
    s_branch L_ld1
L_comp0:
    s_lshl2_add_u32 s86, s45, s3
    s_cmp_ge_u32 s86, 4
    s_cbranch_scc1 L_noipf
    s_getpc_b64 s[4:5]
L_ipf:
    s_sub_u32 s4, s4, L_ipf-sequential_preLN__linear_attn_block__moe_arch_mod__prompt_kernel
    s_subb_u32 s5, s5, 0
    s_lshl_b32 s86, s86, 13
    v_lshl_add_u32 v31, v0, 7, s86
    v_min_u32 v31, L_last-sequential_preLN__linear_attn_block__moe_arch_mod__prompt_kernel, v31
    global_load_dword v30, v31, s[4:5]
L_noipf:
    s_cmp_eq_u32 s3, 3
    s_cbranch_scc1 L_comp
    s_mov_b64 exec, 0
    s_cmp_eq_u32 s3, 2
    s_cbranch_scc1 L_walkA2
    s_cmp_eq_u32 s3, 1
    s_cbranch_scc1 L_walkA1
    s_branch L_walkA0
L_ld1:
    s_mov_b32 s16, s84
    s_and_b32 s17, s85, 0xffff
    s_mov_b32 s18, 268435456
    s_mov_b32 s19, 0x20000
    s_mov_b32 s20, s68
    s_and_b32 s21, s69, 0xffff
    s_mov_b32 s22, 2097152
    s_mov_b32 s23, 0x20000
    s_mov_b32 s24, s80
    s_and_b32 s25, s81, 0xffff
    s_mov_b32 s26, 4194304
    s_mov_b32 s27, 0x20000
    s_mov_b32 s28, s82
    s_and_b32 s29, s83, 0xffff
    s_mov_b32 s30, 256
    s_mov_b32 s31, 0x20000
    s_bitcmp1_b32 s2, 3
    s_cselect_b32 s32, s76, s74
    s_cselect_b32 s33, s77, s75
    s_and_b32 s33, s33, 0xffff
    s_mov_b32 s34, 7340032
    s_mov_b32 s35, 0x20000
    s_mov_b32 s36, s78
    s_and_b32 s37, s79, 0xffff
    s_mov_b32 s38, 7340032
    s_mov_b32 s39, 0x20000
    s_mov_b32 s40, s72
    s_and_b32 s41, s73, 0xffff
    s_mov_b32 s42, 2048
    s_mov_b32 s43, 0x20000
    s_lshl_b32 s82, s44, 5
    s_or_b32 s82, s82, s45
    v_lshrrev_b32 v22, 4, v0
    v_and_b32 v23, 15, v0
    s_lshl_b32 s86, s45, 2
    s_add_u32 s86, s86, s48
L_walkA0:
    s_cbranch_execz L_comp
    s_mul_i32 s87, s86, 6
    v_mul_u32_u24 v24, 43, v0
    v_lshrrev_b32 v24, 8, v24
    v_mul_u32_u24 v25, 6, v24
    v_sub_u32 v25, v0, v25
    v_add_u32 v25, s87, v25
    s_add_u32 s87, s67, 2
    v_add_u32 v24, s87, v24
    v_and_b32 v24, 15, v24
    v_mul_u32_u24 v124, 393216, v24
    v_lshrrev_b32 v24, 2, v25
    v_lshl_add_u32 v124, v24, 11, v124
    v_and_b32 v25, 3, v25
    s_and_b32 s88, s47, 12
    v_add_u32 v25, s88, v25
    v_lshl_add_u32 v124, v25, 7, v124
    v_mov_b32 v24, 2147483648
    v_cmp_gt_u32 vcc, 36, v0
    s_nop 1
    v_cndmask_b32 v124, v24, v124, vcc
    v_add_u32 v24, s87, v20
    v_and_b32 v24, 15, v24
    s_and_b32 s88, s46, 8
    s_lshl4_add_u32 s86, s88, s86
    s_lshl_b32 s86, s86, 14
    v_lshl_add_u32 v123, v21, 11, s86
    v_mov_b32 v125, v123
    v_lshl_add_u32 v123, v24, 7, v123
    v_mov_b32 v24, 2147483648
    v_cmp_gt_u32 vcc, 16, v0
    s_nop 1
    v_cndmask_b32 v123, v24, v123, vcc
    s_add_u32 m0, s53, 81920
    s_lshl_b32 s70, s64, 7
    s_add_u32 s70, s70, s63
    buffer_load_dwordx4 v2, s[8:11], s70 offen offset:0 lds
    buffer_load_dwordx4 v3, s[8:11], s70 offen offset:1024 lds
    buffer_load_dwordx4 v4, s[8:11], s70 offen offset:2048 lds
    buffer_load_dwordx4 v5, s[8:11], s70 offen offset:3072 lds
    s_mul_i32 s91, s64, 393216
    s_add_u32 s64, s64, 1
    s_and_b32 s64, s64, 15
    s_add_u32 m0, s62, 81920
    s_nop 0
    buffer_load_dwordx4 v6, s[12:15], s91 offen offset:0 lds
    buffer_load_dwordx4 v7, s[12:15], s91 offen offset:1024 lds
    s_add_u32 m0, s62, 90112
    s_nop 0
    buffer_load_dwordx4 v8, s[12:15], s91 offen offset:0 lds
    buffer_load_dwordx4 v9, s[12:15], s91 offen offset:1024 lds
    s_add_u32 m0, s62, 98304
    s_nop 0
    buffer_load_dwordx4 v10, s[12:15], s91 offen offset:0 lds
    buffer_load_dwordx4 v11, s[12:15], s91 offen offset:1024 lds
    buffer_load_dword v122, v123, s[8:11], 0 offen
    buffer_load_dword v122, v124, s[12:15], 0 offen
    s_and_b32 s65, s45, 7
    s_lshr_b32 s66, s45, 3
    s_add_u32 s86, s65, 1
    s_and_b32 s86, s86, 3
    s_mul_i32 s86, s86, 40960
    s_lshl_b32 s87, s48, 13
    s_cmp_eq_u32 s48, 3
    s_cselect_b32 s87, 0, s87
    s_add_u32 s86, s86, s87
    s_add_u32 s86, s86, 16384
    v_lshl_add_u32 v25, v20, 7, s86
    v_lshl_add_u32 v28, v26, 4, v25
    v_lshl_add_u32 v29, v27, 4, v25
    s_add_u32 s86, s66, 1
    s_and_b32 s86, s86, 3
    s_mul_i32 s86, s86, 40960
    s_add_u32 s86, s86, s53
    v_lshl_add_u32 v16, v0, 6, s86
    v_bfe_u32 v25, v0, 2, 2
    v_lshl_add_u32 v16, v25, 4, v16
    v_xor_b32 v17, 16, v16
    v_xor_b32 v18, 32, v16
    v_xor_b32 v19, 48, v16
    s_lshl_b32 s86, s46, 14
    s_lshl_b32 s87, s48, 8
    s_add_u32 s86, s86, s87
    s_add_u32 s86, s86, 262144
    v_lshl_add_u32 v33, v23, 4, s86
    v_lshl_add_u32 v33, v22, 10, v33
    s_lshl_b32 s87, s47, 10
    s_add_u32 s86, s86, s87
    v_lshl_add_u32 v13, v0, 2, s86
    v_and_b32 v25, 3, v0
    v_cmp_eq_u32 vcc, 0, v25
    v_mov_b32 v24, 2147483648
    s_nop 0
    v_cndmask_b32 v13, v24, v13, vcc
    s_mul_i32 s86, s47, 12288
    s_add_u32 s86, s86, 65536
    s_lshl_b32 s87, s48, 8
    s_cmp_eq_u32 s48, 3
    s_cselect_b32 s87, 2147483648, s87
    s_mov_b32 s88, 0
    s_add_u32 s86, s86, s87
    v_lshl_add_u32 v32, v23, 4, s86
    v_mul_u32_u24 v25, 768, v22
    v_add_u32 v32, v32, v25
    s_mul_i32 s87, s46, 768
    s_add_u32 s86, s86, s87
    s_add_u32 s86, s86, s88
    v_lshl_add_u32 v34, v23, 5, s86
    v_lshl_add_u32 v34, v22, 4, v34
    v_and_b32 v25, 0x28, v0
    v_cmp_eq_u32 vcc, 0, v25
    s_nop 1
    v_cndmask_b32 v34, v24, v34, vcc
    s_bfe_u32 s86, s82, 0x20001
    s_lshl_b32 s86, s86, 2
    s_add_u32 s86, s86, s48
    s_lshl_b32 s86, s86, 6
    v_lshl_add_u32 v30, v22, 4, s86
    v_mul_u32_u24 v30, 7168, v30
    s_add_u32 s86, s44, 3
    s_and_b32 s86, s86, 7
    s_min_u32 s86, s86, 6
    s_mul_i32 s87, s44, 7
    s_lshr_b32 s88, s45, 3
    s_lshl_b32 s88, s88, 1
    s_sub_u32 s80, s88, 2
    s_cmp_ge_u32 s80, s86
    s_addc_u32 s80, s80, s87
    s_sub_u32 s81, s88, 1
    s_cmp_ge_u32 s81, s86
    s_addc_u32 s81, s81, s87
    s_add_u32 s86, s86, s87
    s_cmp_lt_u32 s45, 8
    s_cselect_b32 s80, s86, s80
    s_cselect_b32 s81, 56, s81
    v_mov_b32 v24, s80
    v_mov_b32 v25, s81
    s_mov_b32 vcc_lo, 4278255360
    s_mov_b32 vcc_hi, vcc_lo
    v_cndmask_b32 v24, v24, v25, vcc
    v_cmp_gt_u32 vcc, 56, v24
    v_and_b32 v25, 7, v0
    v_lshlrev_b32 v24, 7, v24
    v_lshl_add_u32 v24, v25, 4, v24
    v_add_u32 v30, v30, v24
    v_mov_b32 v24, 2147483648
    v_cndmask_b32 v30, v24, v30, vcc
    s_lshr_b32 s86, s82, 3
    s_mul_i32 s86, s86, 112
    s_mul_i32 s87, s48, 28
    s_add_u32 s86, s86, s87
    v_mul_u32_u24 v31, 7, v22
    v_add_u32 v31, s86, v31
    v_lshlrev_b32 v31, 11, v31
    s_and_b32 s86, s82, 7
    s_lshl_b32 s86, s86, 8
    v_lshl_add_u32 v24, v23, 4, s86
    v_add_u32 v31, v31, v24
    v_lshlrev_b32 v24, 1, v22
    v_xor_b32 v24, v24, v21
    s_lshl_b32 s86, s48, 3
    v_add_u32 v12, s86, v20
    v_lshlrev_b32 v12, 11, v12
    s_lshl_b32 s86, s52, 7
    v_lshl_add_u32 v24, v24, 4, s86
    v_add_u32 v12, v12, v24
    s_lshl_b32 s89, s48, 10
    v_and_b32 v24, 1, v0
    v_lshlrev_b32 v24, 4, v24
    v_mov_b32 v25, 0x3f80
    v_lshlrev_b32 v24, v24, v25
    v_bfe_u32 v25, v0, 1, 2
    v_cmp_eq_u32 vcc, 0, v25
    s_nop 1
    v_cndmask_b32 v104, 0, v24, vcc
    v_cmp_eq_u32 vcc, 1, v25
    s_nop 1
    v_cndmask_b32 v105, 0, v24, vcc
    v_cmp_eq_u32 vcc, 2, v25
    s_nop 1
    v_cndmask_b32 v106, 0, v24, vcc
    v_cmp_eq_u32 vcc, 3, v25
    s_nop 1
    v_cndmask_b32 v107, 0, v24, vcc
    s_waitcnt lgkmcnt(0)
    s_add_u32 s68, s61, 0x9e3779b9
    v_mov_b32 v35, s68
    s_lshl_b32 s86, s46, 2
    s_add_u32 s86, s86, s48
    s_lshl_b32 s86, s86, 7
    s_add_u32 s86, s86, 655360
    s_lshl_b32 s87, s47, 2
    s_add_u32 s87, s87, s48
    s_lshl_b32 s87, s87, 7
    s_add_u32 s87, s87, 663552
    s_cmp_eq_u32 s48, 3
    s_cselect_b32 s87, 2147483648, s87
    s_cselect_b32 s76, 0xffff, -1
    s_mov_b32 s77, 0
    v_mov_b32 v24, s86
    v_mov_b32 v25, s87
    v_cmp_gt_u32 vcc, 16, v0
    s_nop 1
    v_cndmask_b32 v117, v25, v24, vcc
    v_lshl_add_u32 v117, v23, 2, v117
    v_mov_b32 v116, 2147483648
    v_cmp_gt_u32 vcc, 32, v0
    s_nop 1
L_walkA1:
    s_cbranch_execz L_comp
    v_cndmask_b32 v117, v116, v117, vcc
    s_lshl2_add_u32 s86, s47, s86
    s_lshl2_add_u32 s87, s46, s87
    v_writelane_b32 v116, s86, 0
    v_writelane_b32 v116, s87, 1
    s_getreg_b32 s83, hwreg(HW_REG_XCC_ID, 0, 4)
    s_add_u32 s83, s83, s68
    v_mov_b32 v121, s83
    s_lshl_b32 s86, s44, 7
    s_add_u32 s86, s86, 753664
    v_lshl_add_u32 v119, v0, 2, s86
    v_mov_b32 v120, 2147483648
    v_cmp_gt_u32 vcc, 32, v0
    s_nop 1
    v_cndmask_b32 v119, v120, v119, vcc
    s_lshl_b32 s86, s48, 6
    s_add_u32 s86, s86, s45
    v_cmp_eq_u32 vcc, s86, v0
    s_nop 1
    v_cndmask_b32 v120, v120, v119, vcc
    s_mov_b64 exec, 0
    s_cmp_eq_u32 s48, 0
    s_cbranch_scc1 L_walkB4
    s_cmp_eq_u32 s48, 1
    s_cbranch_scc1 L_walkB5
    s_cmp_eq_u32 s48, 2
    s_cbranch_scc1 L_walkB6
    s_branch L_walkB7
L_walked2:
    s_mov_b64 exec, -1
    s_waitcnt vmcnt(12)
    s_barrier
    buffer_store_dword v121, v120, s[16:19], 0 offen sc1
    s_add_u32 m0, s53, 122880
    s_lshl_b32 s70, s64, 7
    s_add_u32 s70, s70, s63
    buffer_load_dwordx4 v2, s[8:11], s70 offen offset:0 lds
    buffer_load_dwordx4 v3, s[8:11], s70 offen offset:1024 lds
    buffer_load_dwordx4 v4, s[8:11], s70 offen offset:2048 lds
    buffer_load_dwordx4 v5, s[8:11], s70 offen offset:3072 lds
    s_mul_i32 s91, s64, 393216
    s_add_u32 s64, s64, 1
    s_and_b32 s64, s64, 15
    s_add_u32 m0, s62, 122880
    s_nop 0
    buffer_load_dwordx4 v6, s[12:15], s91 offen offset:0 lds
    buffer_load_dwordx4 v7, s[12:15], s91 offen offset:1024 lds
    s_add_u32 m0, s62, 131072
    s_nop 0
    buffer_load_dwordx4 v8, s[12:15], s91 offen offset:0 lds
    buffer_load_dwordx4 v9, s[12:15], s91 offen offset:1024 lds
    s_add_u32 m0, s62, 139264
    s_nop 0
    buffer_load_dwordx4 v10, s[12:15], s91 offen offset:0 lds
    buffer_load_dwordx4 v11, s[12:15], s91 offen offset:1024 lds
    s_add_u32 s87, s67, 4
    v_add_u32 v24, s87, v20
    v_and_b32 v24, 15, v24
    v_lshl_add_u32 v123, v24, 7, v125
    v_mov_b32 v24, 2147483648
    v_cmp_gt_u32 vcc, 32, v0
    s_nop 1
    v_cndmask_b32 v123, v24, v123, vcc
    buffer_load_dword v122, v123, s[8:11], 0 offen
    s_cmp_lg_u32 s65, 0
    s_cbranch_scc1 L_h0c0
    ds_read_b128 v[40:43], v28 offset:0
    ds_read_b128 v[44:47], v29 offset:1024
    ds_read_b128 v[48:51], v28 offset:2048
    ds_read_b128 v[52:55], v29 offset:3072
    ds_read_b128 v[56:59], v28 offset:4096
    ds_read_b128 v[60:63], v29 offset:5120
    ds_read_b128 v[64:67], v28 offset:6144
    ds_read_b128 v[68:71], v29 offset:7168
L_h0c0:
    s_cmp_lg_u32 s66, 0
    s_cbranch_scc1 L_h0r0
    ds_read_b128 v[72:75], v16
    ds_read_b128 v[76:79], v17
    ds_read_b128 v[80:83], v18
    ds_read_b128 v[84:87], v19
L_h0r0:
    s_waitcnt lgkmcnt(0)
    s_waitcnt vmcnt(14)
    s_barrier
    s_add_u32 m0, s53, 0
    s_lshl_b32 s70, s64, 7
    s_add_u32 s70, s70, s63
    buffer_load_dwordx4 v2, s[8:11], s70 offen offset:0 lds
    buffer_load_dwordx4 v3, s[8:11], s70 offen offset:1024 lds
    buffer_load_dwordx4 v4, s[8:11], s70 offen offset:2048 lds
    buffer_load_dwordx4 v5, s[8:11], s70 offen offset:3072 lds
    s_mul_i32 s91, s64, 393216
    s_add_u32 s64, s64, 1
    s_and_b32 s64, s64, 15
    s_add_u32 m0, s62, 0
    s_nop 0
    buffer_load_dwordx4 v6, s[12:15], s91 offen offset:0 lds
    buffer_load_dwordx4 v7, s[12:15], s91 offen offset:1024 lds
    s_add_u32 m0, s62, 8192
    s_nop 0
    buffer_load_dwordx4 v8, s[12:15], s91 offen offset:0 lds
    buffer_load_dwordx4 v9, s[12:15], s91 offen offset:1024 lds
    s_add_u32 m0, s62, 16384
    s_nop 0
    buffer_load_dwordx4 v10, s[12:15], s91 offen offset:0 lds
    buffer_load_dwordx4 v11, s[12:15], s91 offen offset:1024 lds
    s_cmp_lg_u32 s65, 1
    s_cbranch_scc1 L_h0c1
    ds_read_b128 v[40:43], v28 offset:0
    ds_read_b128 v[44:47], v29 offset:1024
    ds_read_b128 v[48:51], v28 offset:2048
    ds_read_b128 v[52:55], v29 offset:3072
    ds_read_b128 v[56:59], v28 offset:4096
    ds_read_b128 v[60:63], v29 offset:5120
    ds_read_b128 v[64:67], v28 offset:6144
    ds_read_b128 v[68:71], v29 offset:7168
L_h0c1:
    s_cmp_lg_u32 s66, 1
    s_cbranch_scc1 L_h0r1
    ds_read_b128 v[72:75], v16
    ds_read_b128 v[76:79], v17
    ds_read_b128 v[80:83], v18
    ds_read_b128 v[84:87], v19
L_h0r1:
    s_waitcnt lgkmcnt(0)
    s_waitcnt vmcnt(11)
    s_barrier
    s_add_u32 m0, s53, 40960
    s_lshl_b32 s70, s64, 7
    s_add_u32 s70, s70, s63
    buffer_load_dwordx4 v2, s[8:11], s70 offen offset:0 lds
    buffer_load_dwordx4 v3, s[8:11], s70 offen offset:1024 lds
    buffer_load_dwordx4 v4, s[8:11], s70 offen offset:2048 lds
    buffer_load_dwordx4 v5, s[8:11], s70 offen offset:3072 lds
    s_mul_i32 s91, s64, 393216
    s_add_u32 s64, s64, 1
    s_and_b32 s64, s64, 15
    s_add_u32 m0, s62, 40960
    s_nop 0
    buffer_load_dwordx4 v6, s[12:15], s91 offen offset:0 lds
    buffer_load_dwordx4 v7, s[12:15], s91 offen offset:1024 lds
    s_add_u32 m0, s62, 49152
    s_nop 0
    buffer_load_dwordx4 v8, s[12:15], s91 offen offset:0 lds
    buffer_load_dwordx4 v9, s[12:15], s91 offen offset:1024 lds
    s_add_u32 m0, s62, 57344
    s_nop 0
    buffer_load_dwordx4 v10, s[12:15], s91 offen offset:0 lds
    buffer_load_dwordx4 v11, s[12:15], s91 offen offset:1024 lds
    s_cmp_lg_u32 s65, 2
    s_cbranch_scc1 L_h0c2
    ds_read_b128 v[40:43], v28 offset:0
    ds_read_b128 v[44:47], v29 offset:1024
    ds_read_b128 v[48:51], v28 offset:2048
    ds_read_b128 v[52:55], v29 offset:3072
    ds_read_b128 v[56:59], v28 offset:4096
    ds_read_b128 v[60:63], v29 offset:5120
    ds_read_b128 v[64:67], v28 offset:6144
    ds_read_b128 v[68:71], v29 offset:7168
L_h0c2:
    s_cmp_lg_u32 s66, 2
    s_cbranch_scc1 L_h0r2
    ds_read_b128 v[72:75], v16
    ds_read_b128 v[76:79], v17
    ds_read_b128 v[80:83], v18
    ds_read_b128 v[84:87], v19
L_h0r2:
    s_waitcnt lgkmcnt(0)
    s_waitcnt vmcnt(10)
    s_barrier
    s_add_u32 m0, s53, 81920
    s_lshl_b32 s70, s64, 7
    s_add_u32 s70, s70, s63
    buffer_load_dwordx4 v2, s[8:11], s70 offen offset:0 lds
    buffer_load_dwordx4 v3, s[8:11], s70 offen offset:1024 lds
    buffer_load_dwordx4 v4, s[8:11], s70 offen offset:2048 lds
    buffer_load_dwordx4 v5, s[8:11], s70 offen offset:3072 lds
    s_mul_i32 s91, s64, 393216
    s_add_u32 s64, s64, 1
    s_and_b32 s64, s64, 15
    s_add_u32 m0, s62, 81920
    s_nop 0
L_walkB0:
    s_cbranch_execz L_walk_4
    buffer_load_dwordx4 v6, s[12:15], s91 offen offset:0 lds
    buffer_load_dwordx4 v7, s[12:15], s91 offen offset:1024 lds
    s_add_u32 m0, s62, 90112
    s_nop 0
    buffer_load_dwordx4 v8, s[12:15], s91 offen offset:0 lds
    buffer_load_dwordx4 v9, s[12:15], s91 offen offset:1024 lds
    s_add_u32 m0, s62, 98304
    s_nop 0
    buffer_load_dwordx4 v10, s[12:15], s91 offen offset:0 lds
    buffer_load_dwordx4 v11, s[12:15], s91 offen offset:1024 lds
    s_lshr_b32 s90, s67, 2
    s_add_u32 s90, s90, 2
    s_and_b32 s90, s90, 3
    s_mul_i32 s90, s90, 1572864
    buffer_load_dword v39, v37, s[12:15], s90 offen
    s_cmp_lg_u32 s65, 3
    s_cbranch_scc1 L_h0c3
    ds_read_b128 v[40:43], v28 offset:0
    ds_read_b128 v[44:47], v29 offset:1024
    ds_read_b128 v[48:51], v28 offset:2048
    ds_read_b128 v[52:55], v29 offset:3072
    ds_read_b128 v[56:59], v28 offset:4096
    ds_read_b128 v[60:63], v29 offset:5120
    ds_read_b128 v[64:67], v28 offset:6144
    ds_read_b128 v[68:71], v29 offset:7168
L_h0c3:
    s_cmp_lg_u32 s66, 3
    s_cbranch_scc1 L_h0r3
    ds_read_b128 v[72:75], v16
    ds_read_b128 v[76:79], v17
    ds_read_b128 v[80:83], v18
    ds_read_b128 v[84:87], v19
L_h0r3:
    s_waitcnt lgkmcnt(0)
    s_waitcnt vmcnt(11)
    s_barrier
    s_add_u32 m0, s53, 122880
    s_lshl_b32 s70, s64, 7
    s_add_u32 s70, s70, s63
    buffer_load_dwordx4 v2, s[8:11], s70 offen offset:0 lds
    buffer_load_dwordx4 v3, s[8:11], s70 offen offset:1024 lds
    buffer_load_dwordx4 v4, s[8:11], s70 offen offset:2048 lds
    buffer_load_dwordx4 v5, s[8:11], s70 offen offset:3072 lds
    s_mul_i32 s91, s64, 393216
    s_add_u32 s64, s64, 1
    s_and_b32 s64, s64, 15
    s_add_u32 m0, s62, 122880
    s_nop 0
    buffer_load_dwordx4 v6, s[12:15], s91 offen offset:0 lds
    buffer_load_dwordx4 v7, s[12:15], s91 offen offset:1024 lds
    s_add_u32 m0, s62, 131072
    s_nop 0
    buffer_load_dwordx4 v8, s[12:15], s91 offen offset:0 lds
    buffer_load_dwordx4 v9, s[12:15], s91 offen offset:1024 lds
    s_add_u32 m0, s62, 139264
    s_nop 0
    buffer_load_dwordx4 v10, s[12:15], s91 offen offset:0 lds
    buffer_load_dwordx4 v11, s[12:15], s91 offen offset:1024 lds
    s_cmp_lg_u32 s65, 4
    s_cbranch_scc1 L_h0c4
    ds_read_b128 v[40:43], v28 offset:0
    ds_read_b128 v[44:47], v29 offset:1024
    ds_read_b128 v[48:51], v28 offset:2048
    ds_read_b128 v[52:55], v29 offset:3072
    ds_read_b128 v[56:59], v28 offset:4096
    ds_read_b128 v[60:63], v29 offset:5120
    ds_read_b128 v[64:67], v28 offset:6144
    ds_read_b128 v[68:71], v29 offset:7168
L_h0c4:
    s_waitcnt lgkmcnt(0)
    v_mov_b32 v88, 0
    v_mov_b32 v89, 0
    v_mov_b32 v90, 0
    v_mov_b32 v91, 0
    v_mov_b32 v92, 0
    v_mov_b32 v93, 0
    v_mov_b32 v94, 0
    v_mov_b32 v95, 0
    v_dot2c_f32_bf16 v88, s95, v72
    v_dot2c_f32_bf16 v89, s95, v73
    v_dot2c_f32_bf16 v90, s95, v74
    v_dot2c_f32_bf16 v91, s95, v75
    v_dot2c_f32_bf16 v92, v72, v72
    v_dot2c_f32_bf16 v93, v73, v73
    v_dot2c_f32_bf16 v94, v74, v74
    v_dot2c_f32_bf16 v95, v75, v75
    v_dot2c_f32_bf16 v88, s95, v76
    v_dot2c_f32_bf16 v89, s95, v77
    v_dot2c_f32_bf16 v90, s95, v78
    v_dot2c_f32_bf16 v91, s95, v79
    v_dot2c_f32_bf16 v92, v76, v76
    v_dot2c_f32_bf16 v93, v77, v77
    v_dot2c_f32_bf16 v94, v78, v78
    v_dot2c_f32_bf16 v95, v79, v79
    v_dot2c_f32_bf16 v88, s95, v80
    v_dot2c_f32_bf16 v89, s95, v81
    v_dot2c_f32_bf16 v90, s95, v82
    v_dot2c_f32_bf16 v91, s95, v83
    v_dot2c_f32_bf16 v92, v80, v80
    v_dot2c_f32_bf16 v93, v81, v81
    v_dot2c_f32_bf16 v94, v82, v82
    v_dot2c_f32_bf16 v95, v83, v83
    v_dot2c_f32_bf16 v88, s95, v84
    v_dot2c_f32_bf16 v89, s95, v85
    v_dot2c_f32_bf16 v90, s95, v86
    v_dot2c_f32_bf16 v91, s95, v87
    v_dot2c_f32_bf16 v92, v84, v84
    v_dot2c_f32_bf16 v93, v85, v85
    v_dot2c_f32_bf16 v94, v86, v86
    v_dot2c_f32_bf16 v95, v87, v87
    s_waitcnt vmcnt(11)
    s_barrier
    s_add_u32 m0, s53, 0
    s_lshl_b32 s70, s64, 7
    s_add_u32 s70, s70, s63
    buffer_load_dwordx4 v2, s[8:11], s70 offen offset:0 lds
    buffer_load_dwordx4 v3, s[8:11], s70 offen offset:1024 lds
    buffer_load_dwordx4 v4, s[8:11], s70 offen offset:2048 lds
    buffer_load_dwordx4 v5, s[8:11], s70 offen offset:3072 lds
    s_mul_i32 s91, s64, 393216
    s_add_u32 s64, s64, 1
    s_and_b32 s64, s64, 15
    s_add_u32 m0, s62, 0
    s_nop 0
    buffer_load_dwordx4 v6, s[12:15], s91 offen offset:0 lds
    buffer_load_dwordx4 v7, s[12:15], s91 offen offset:1024 lds
    s_add_u32 m0, s62, 8192
    s_nop 0
    buffer_load_dwordx4 v8, s[12:15], s91 offen offset:0 lds
    buffer_load_dwordx4 v9, s[12:15], s91 offen offset:1024 lds
    s_add_u32 m0, s62, 16384
    s_nop 0
    buffer_load_dwordx4 v10, s[12:15], s91 offen offset:0 lds
    buffer_load_dwordx4 v11, s[12:15], s91 offen offset:1024 lds
    buffer_load_dword v39, v38, s[20:23], 0 offen
    s_cmp_lg_u32 s65, 5
    s_cbranch_scc1 L_h0c5
    ds_read_b128 v[40:43], v28 offset:0
    ds_read_b128 v[44:47], v29 offset:1024
    ds_read_b128 v[48:51], v28 offset:2048
    ds_read_b128 v[52:55], v29 offset:3072
    ds_read_b128 v[56:59], v28 offset:4096
    ds_read_b128 v[60:63], v29 offset:5120
    ds_read_b128 v[64:67], v28 offset:6144
    ds_read_b128 v[68:71], v29 offset:7168
L_h0c5:
    s_waitcnt lgkmcnt(0)
    v_pk_add_f32 v[88:89], v[88:89], v[90:91]
    v_pk_add_f32 v[92:93], v[92:93], v[94:95]
    v_add_f32 v88, v88, v89
    v_add_f32 v89, v92, v93
    s_nop 0
    v_add_f32_dpp v88, v88, v88 quad_perm:[1,0,3,2] row_mask:0xf bank_mask:0xf
    v_add_f32_dpp v89, v89, v89 quad_perm:[1,0,3,2] row_mask:0xf bank_mask:0xf
    s_nop 0
    v_mov_b32_dpp v90, v88 quad_perm:[2,2,2,2] row_mask:0xf bank_mask:0xf
    v_mov_b32_dpp v91, v89 quad_perm:[2,2,2,2] row_mask:0xf bank_mask:0xf
    buffer_store_dwordx4 v[88:91], v13, s[16:19], 0 offen sc1
    s_lshl_b32 s86, s48, 7
    s_add_u32 s86, s86, 131072
    v_lshl_add_u32 v16, v23, 3, s86
    v_lshrrev_b32 v17, 5, v0
    v_lshl_add_u32 v16, v17, 2, v16
    s_lshl_b32 s86, s48, 8
    s_add_u32 s86, s86, 132608
    v_lshl_add_u32 v17, v23, 4, s86
    v_lshl_add_u32 v17, v22, 2, v17
    s_waitcnt vmcnt(12)
    s_barrier
    s_add_u32 m0, s53, 40960
    s_lshl_b32 s70, s64, 7
    s_add_u32 s70, s70, s63
    buffer_load_dwordx4 v2, s[8:11], s70 offen offset:0 lds
    buffer_load_dwordx4 v3, s[8:11], s70 offen offset:1024 lds
    buffer_load_dwordx4 v4, s[8:11], s70 offen offset:2048 lds
    buffer_load_dwordx4 v5, s[8:11], s70 offen offset:3072 lds
    s_mul_i32 s91, s64, 393216
    s_add_u32 s64, s64, 1
    s_and_b32 s64, s64, 15
    s_add_u32 m0, s62, 40960
    s_nop 0
    buffer_load_dwordx4 v6, s[12:15], s91 offen offset:0 lds
    buffer_load_dwordx4 v7, s[12:15], s91 offen offset:1024 lds
    s_add_u32 m0, s62, 49152
    s_nop 0
L_walkB1:
    s_cbranch_execz L_walk_5
    buffer_load_dwordx4 v8, s[12:15], s91 offen offset:0 lds
    buffer_load_dwordx4 v9, s[12:15], s91 offen offset:1024 lds
    s_add_u32 m0, s62, 57344
    s_nop 0
    buffer_load_dwordx4 v10, s[12:15], s91 offen offset:0 lds
    buffer_load_dwordx4 v11, s[12:15], s91 offen offset:1024 lds
    s_lshr_b32 s90, s67, 2
    s_add_u32 s90, s90, 3
    s_and_b32 s90, s90, 3
    s_mul_i32 s90, s90, 1572864
    buffer_load_dword v39, v37, s[12:15], s90 offen
    s_cmp_lg_u32 s65, 6
    s_cbranch_scc1 L_h0c6
    ds_read_b128 v[40:43], v28 offset:0
    ds_read_b128 v[44:47], v29 offset:1024
    ds_read_b128 v[48:51], v28 offset:2048
    ds_read_b128 v[52:55], v29 offset:3072
    ds_read_b128 v[56:59], v28 offset:4096
    ds_read_b128 v[60:63], v29 offset:5120
    ds_read_b128 v[64:67], v28 offset:6144
    ds_read_b128 v[68:71], v29 offset:7168
L_h0c6:
    s_waitcnt lgkmcnt(0)
    s_waitcnt vmcnt(13)
    s_barrier
    s_add_u32 m0, s53, 81920
    s_lshl_b32 s70, s64, 7
    s_add_u32 s70, s70, s63
    buffer_load_dwordx4 v2, s[8:11], s70 offen offset:0 lds
    buffer_load_dwordx4 v3, s[8:11], s70 offen offset:1024 lds
    buffer_load_dwordx4 v4, s[8:11], s70 offen offset:2048 lds
    buffer_load_dwordx4 v5, s[8:11], s70 offen offset:3072 lds
    s_mul_i32 s91, s64, 393216
    s_add_u32 s64, s64, 1
    s_and_b32 s64, s64, 15
    s_add_u32 m0, s62, 81920
    s_nop 0
    buffer_load_dwordx4 v6, s[12:15], s91 offen offset:0 lds
    buffer_load_dwordx4 v7, s[12:15], s91 offen offset:1024 lds
    s_add_u32 m0, s62, 90112
    s_nop 0
    buffer_load_dwordx4 v8, s[12:15], s91 offen offset:0 lds
    buffer_load_dwordx4 v9, s[12:15], s91 offen offset:1024 lds
    s_add_u32 m0, s62, 98304
    s_nop 0
    buffer_load_dwordx4 v10, s[12:15], s91 offen offset:0 lds
    buffer_load_dwordx4 v11, s[12:15], s91 offen offset:1024 lds
    s_add_u32 m0, s53, 122880
    s_lshl_b32 s70, s64, 7
    s_add_u32 s70, s70, s63
    buffer_load_dwordx4 v2, s[8:11], s70 offen offset:0 lds
    buffer_load_dwordx4 v3, s[8:11], s70 offen offset:1024 lds
    s_cmp_lg_u32 s65, 7
    s_cbranch_scc1 L_h0c7
    ds_read_b128 v[40:43], v28 offset:0
    ds_read_b128 v[44:47], v29 offset:1024
    ds_read_b128 v[48:51], v28 offset:2048
    ds_read_b128 v[52:55], v29 offset:3072
    ds_read_b128 v[56:59], v28 offset:4096
    ds_read_b128 v[60:63], v29 offset:5120
    ds_read_b128 v[64:67], v28 offset:6144
    ds_read_b128 v[68:71], v29 offset:7168
L_h0c7:
    s_waitcnt lgkmcnt(0)
    v_mfma_f32_16x16x32_bf16 v[108:111], v[104:107], v[40:43], 0
    v_mfma_f32_16x16x32_bf16 v[108:111], v[104:107], v[44:47], v[108:111]
    v_mfma_f32_16x16x32_bf16 v[108:111], v[104:107], v[48:51], v[108:111]
    v_mfma_f32_16x16x32_bf16 v[108:111], v[104:107], v[52:55], v[108:111]
    v_mfma_f32_16x16x32_bf16 v[108:111], v[104:107], v[56:59], v[108:111]
    v_mfma_f32_16x16x32_bf16 v[108:111], v[104:107], v[60:63], v[108:111]
    v_mfma_f32_16x16x32_bf16 v[108:111], v[104:107], v[64:67], v[108:111]
    v_mfma_f32_16x16x32_bf16 v[108:111], v[104:107], v[68:71], v[108:111]
    s_nop 7
    v_add_f32_dpp v108, v108, v108 row_ror:8 row_mask:0xf bank_mask:0xf
    v_add_f32_dpp v109, v109, v109 row_ror:8 row_mask:0xf bank_mask:0xf
    v_add_f32_dpp v110, v110, v110 row_ror:8 row_mask:0xf bank_mask:0xf
    v_add_f32_dpp v111, v111, v111 row_ror:8 row_mask:0xf bank_mask:0xf
    buffer_store_dwordx4 v[108:111], v34, s[16:19], 0 offen sc1
    s_waitcnt vmcnt(14)
    s_barrier
    s_add_u32 m0, s53, 122880
    s_nop 0
    buffer_load_dwordx4 v4, s[8:11], s70 offen offset:2048 lds
    buffer_load_dwordx4 v5, s[8:11], s70 offen offset:3072 lds
    s_mul_i32 s91, s64, 393216
    s_add_u32 s64, s64, 1
    s_and_b32 s64, s64, 15
    s_add_u32 m0, s62, 122880
    s_nop 0
    buffer_load_dwordx4 v6, s[12:15], s91 offen offset:0 lds
    buffer_load_dwordx4 v7, s[12:15], s91 offen offset:1024 lds
    s_add_u32 m0, s62, 131072
    s_nop 0
    buffer_load_dwordx4 v8, s[12:15], s91 offen offset:0 lds
    buffer_load_dwordx4 v9, s[12:15], s91 offen offset:1024 lds
    s_add_u32 m0, s62, 139264
    s_nop 0
    buffer_load_dwordx4 v10, s[12:15], s91 offen offset:0 lds
    buffer_load_dwordx4 v11, s[12:15], s91 offen offset:1024 lds
    s_add_u32 m0, s53, 0
    s_lshl_b32 s70, s64, 7
    s_add_u32 s70, s70, s63
    buffer_load_dwordx4 v2, s[8:11], s70 offen offset:0 lds
    buffer_load_dwordx4 v3, s[8:11], s70 offen offset:1024 lds
    s_waitcnt vmcnt(10)
    s_barrier
    buffer_atomic_swap v35, v116, s[16:19], 0 offen sc1
    s_add_u32 m0, s53, 0
    s_nop 0
    buffer_load_dwordx4 v4, s[8:11], s70 offen offset:2048 lds
    buffer_load_dwordx4 v5, s[8:11], s70 offen offset:3072 lds
    s_mul_i32 s91, s64, 393216
    s_add_u32 s64, s64, 1
    s_and_b32 s64, s64, 15
    s_add_u32 m0, s62, 0
    s_nop 0
    buffer_load_dwordx4 v6, s[12:15], s91 offen offset:0 lds
    buffer_load_dwordx4 v7, s[12:15], s91 offen offset:1024 lds
    s_add_u32 m0, s62, 8192
    s_nop 0
    buffer_load_dwordx4 v8, s[12:15], s91 offen offset:0 lds
    buffer_load_dwordx4 v9, s[12:15], s91 offen offset:1024 lds
    s_add_u32 m0, s62, 16384
    s_nop 0
    buffer_load_dwordx4 v10, s[12:15], s91 offen offset:0 lds
    buffer_load_dwordx4 v11, s[12:15], s91 offen offset:1024 lds
    s_add_u32 m0, s53, 40960
    s_lshl_b32 s70, s64, 7
    s_add_u32 s70, s70, s63
    buffer_load_dwordx4 v2, s[8:11], s70 offen offset:0 lds
    buffer_load_dwordx4 v3, s[8:11], s70 offen offset:1024 lds
    buffer_load_dwordx4 v4, s[8:11], s70 offen offset:2048 lds
    buffer_load_dwordx4 v5, s[8:11], s70 offen offset:3072 lds
    s_mul_i32 s91, s64, 393216
    s_add_u32 s64, s64, 1
    s_and_b32 s64, s64, 15
    s_waitcnt vmcnt(15)
    s_barrier
    s_add_u32 m0, s62, 40960
    s_nop 0
    buffer_load_dwordx4 v6, s[12:15], s91 offen offset:0 lds
    buffer_load_dwordx4 v7, s[12:15], s91 offen offset:1024 lds
    s_add_u32 m0, s62, 49152
    s_nop 0
    buffer_load_dwordx4 v8, s[12:15], s91 offen offset:0 lds
    buffer_load_dwordx4 v9, s[12:15], s91 offen offset:1024 lds
    s_add_u32 m0, s62, 57344
    s_nop 0
    buffer_load_dwordx4 v10, s[12:15], s91 offen offset:0 lds
    buffer_load_dwordx4 v11, s[12:15], s91 offen offset:1024 lds
    s_add_u32 m0, s53, 81920
    s_lshl_b32 s70, s64, 7
    s_add_u32 s70, s70, s63
    buffer_load_dwordx4 v2, s[8:11], s70 offen offset:0 lds
    buffer_load_dwordx4 v3, s[8:11], s70 offen offset:1024 lds
    buffer_load_dwordx4 v4, s[8:11], s70 offen offset:2048 lds
    buffer_load_dwordx4 v5, s[8:11], s70 offen offset:3072 lds
    s_mul_i32 s91, s64, 393216
    s_add_u32 s64, s64, 1
    s_and_b32 s64, s64, 15
    s_add_u32 m0, s62, 81920
    s_nop 0
    buffer_load_dwordx4 v6, s[12:15], s91 offen offset:0 lds
    buffer_load_dwordx4 v7, s[12:15], s91 offen offset:1024 lds
    s_waitcnt vmcnt(16)
    s_barrier
    buffer_load_dword v121, v119, s[16:19], 0 offen sc1
L_walk_4:
    s_cbranch_execz L_walk_8
    s_add_u32 m0, s62, 90112
    s_nop 0
    buffer_load_dwordx4 v8, s[12:15], s91 offen offset:0 lds
    buffer_load_dwordx4 v9, s[12:15], s91 offen offset:1024 lds
    s_add_u32 m0, s62, 98304
    s_nop 0
    buffer_load_dwordx4 v10, s[12:15], s91 offen offset:0 lds
    buffer_load_dwordx4 v11, s[12:15], s91 offen offset:1024 lds
    s_add_u32 m0, s53, 122880
    s_lshl_b32 s70, s64, 7
    s_add_u32 s70, s70, s63
    buffer_load_dwordx4 v2, s[8:11], s70 offen offset:0 lds
    buffer_load_dwordx4 v3, s[8:11], s70 offen offset:1024 lds
    buffer_load_dwordx4 v4, s[8:11], s70 offen offset:2048 lds
    buffer_load_dwordx4 v5, s[8:11], s70 offen offset:3072 lds
    s_mul_i32 s91, s64, 393216
    s_add_u32 s64, s64, 1
    s_and_b32 s64, s64, 15
    s_add_u32 m0, s62, 122880
    s_nop 0
    buffer_load_dwordx4 v6, s[12:15], s91 offen offset:0 lds
    buffer_load_dwordx4 v7, s[12:15], s91 offen offset:1024 lds
    s_add_u32 m0, s62, 131072
    s_nop 0
    buffer_load_dwordx4 v8, s[12:15], s91 offen offset:0 lds
    buffer_load_dwordx4 v9, s[12:15], s91 offen offset:1024 lds
    s_lshr_b32 s60, s3, 2
    s_lshl_b32 s69, s51, 3
    s_lshl_b32 s86, s48, 1
    s_add_u32 s69, s69, s86
    s_add_u32 s69, s69, s60
    v_lshrrev_b32 v36, 4, v0
    v_and_b32 v37, 15, v0
    s_lshl_b32 s87, s69, 15
    s_lshl_b32 s86, s60, 14
    s_add_u32 s86, s86, s87
    s_add_u32 s86, s86, 1048576
    v_lshl_add_u32 v157, v0, 4, s86
    v_xor_b32 v158, 0x8000, v157
    s_lshl_b32 s86, s51, 1
    s_lshr_b32 s87, s48, 1
    s_add_u32 s86, s86, s87
    s_lshl_b32 s86, s86, 1
    s_add_u32 s86, s86, s60
    s_lshl_b32 s86, s86, 1
    s_and_b32 s87, s48, 1
    s_add_u32 s86, s86, s87
    s_lshl_b32 s86, s86, 7
    s_add_u32 s86, s86, 688128
    v_lshl_add_u32 v159, v0, 2, s86
    v_mov_b32 v38, 2147483648
    v_cmp_gt_u32 vcc, 16, v0
    s_nop 1
    v_cndmask_b32 v159, v38, v159, vcc
    v_bfe_u32 v38, v0, 2, 2
    v_lshl_add_u32 v38, v36, 2, v38
    v_bfe_u32 v39, v38, 1, 2
    v_lshlrev_b32 v38, 7, v38
    v_lshl_add_u32 v38, v39, 5, v38
    v_and_b32 v39, 3, v0
    v_lshl_add_u32 v38, v39, 3, v38
    s_lshl_b32 s86, s60, 16
    s_add_u32 s86, s86, 0
    v_add_u32 v144, s86, v38
    v_xor_b32 v145, 32, v144
    v_xor_b32 v146, 64, v144
    v_xor_b32 v147, 96, v144
    v_cmp_eq_u32 s[4:5], 1, v39
    v_cmp_eq_u32 s[6:7], 2, v39
    v_cmp_eq_u32 s[98:99], 3, v39
    s_lshl_b32 s86, s69, 10
    s_add_u32 s86, s86, 786432
    v_lshl_add_u32 v160, v0, 2, s86
    v_mul_u32_u24 v161, 192, v36
    v_add_u32 v160, v160, v161
    s_mov_b32 s72, 0x00f0000f
    s_mov_b32 s73, 0xf0000f00
    s_mov_b32 s74, 0x0f00f000
    s_mov_b32 s75, 0x0f00f000
    v_lshrrev_b32 v38, 2, v37
    v_lshl_add_u32 v161, v38, 4, v37
    v_lshlrev_b32 v161, 2, v161
    s_lshl_b32 s86, s3, 12
    s_add_u32 s86, s86, 131072
    v_lshl_add_u32 v162, v0, 4, s86
    v_xor_b32 v163, 0x4000, v162
    s_lshl_b32 s86, s52, 7
    v_lshl_add_u32 v36, v36, 3, s86
    s_lshl_b32 s87, s69, 15
    s_add_u32 s87, s87, s86
    s_lshl_b32 s86, s60, 6
    s_add_u32 s87, s87, s86
    v_lshl_add_u32 v39, v37, 11, s87
    v_and_b32 v38, 48, v0
    v_add_u32 v39, v39, v38
    v_xor_b32 v37, 0x8000, v39
    v_lshlrev_b32 v38, 4, v0
    s_waitcnt vmcnt(19)
    s_barrier
    v_mov_b32 v118, 0
    buffer_atomic_or v118, v117, s[16:19], 0 offen sc0 sc1
    s_add_u32 m0, s62, 139264
    s_nop 0
    buffer_load_dwordx4 v10, s[12:15], s91 offen offset:0 lds
    buffer_load_dwordx4 v11, s[12:15], s91 offen offset:1024 lds
    s_add_u32 m0, s53, 0
    s_lshl_b32 s70, s64, 7
    s_add_u32 s70, s70, s63
    buffer_load_dwordx4 v2, s[8:11], s70 offen offset:0 lds
    buffer_load_dwordx4 v3, s[8:11], s70 offen offset:1024 lds
    buffer_load_dwordx4 v4, s[8:11], s70 offen offset:2048 lds
    buffer_load_dwordx4 v5, s[8:11], s70 offen offset:3072 lds
    s_mul_i32 s91, s64, 393216
    s_add_u32 s64, s64, 1
    s_and_b32 s64, s64, 15
    s_add_u32 m0, s62, 0
    s_nop 0
    buffer_load_dwordx4 v6, s[12:15], s91 offen offset:0 lds
    buffer_load_dwordx4 v7, s[12:15], s91 offen offset:1024 lds
    s_add_u32 m0, s62, 8192
    s_nop 0
    buffer_load_dwordx4 v8, s[12:15], s91 offen offset:0 lds
    buffer_load_dwordx4 v9, s[12:15], s91 offen offset:1024 lds
    s_add_u32 m0, s62, 16384
    s_nop 0
    buffer_load_dwordx4 v10, s[12:15], s91 offen offset:0 lds
    buffer_load_dwordx4 v11, s[12:15], s91 offen offset:1024 lds
    s_waitcnt vmcnt(21)
    s_barrier
    s_waitcnt vmcnt(12)
    s_branch L_h0_chk0
L_h0_spin:
    v_mov_b32 v118, 0
    buffer_atomic_or v118, v117, s[16:19], 0 offen sc0 sc1
    s_waitcnt vmcnt(0)
L_h0_chk0:
    v_cmp_ne_u32 vcc, s68, v118
    s_nop 0
    s_and_b64 vcc, vcc, s[76:77]
    s_cbranch_vccz L_ok_1
    s_sub_u32 s56, s56, 1
    s_cbranch_scc0 L_h0_spin
    s_mov_b32 s56, 0
L_ok_1:
    buffer_load_dwordx4 v[56:59], v33, s[16:19], 0 offen sc1
    buffer_load_dwordx4 v[60:63], v33, s[16:19], s92 offen sc1
    buffer_load_dwordx4 v[64:67], v33, s[16:19], s93 offen sc1
    buffer_load_dwordx4 v[68:71], v33, s[16:19], s94 offen sc1
    buffer_load_dwordx4 v[40:43], v32, s[16:19], 0 offen offset:0 sc1
    buffer_load_dwordx4 v[44:47], v32, s[16:19], 0 offen offset:3072 sc1
    buffer_load_dwordx4 v[48:51], v32, s[16:19], s92 offen offset:2048 sc1
    buffer_load_dwordx4 v[52:55], v32, s[16:19], s93 offen offset:1024 sc1
    v_cmp_eq_u32 vcc, s83, v121
    s_nop 0
    s_cmp_eq_u32 vcc_lo, -1
    s_cselect_b32 s83, 1, 0
    s_mov_b32 s90, 0
    buffer_load_dwordx4 v[164:167], v30, s[32:35], s90 offen
    s_mov_b32 s90, 7168
    buffer_load_dwordx4 v[168:171], v30, s[32:35], s90 offen
    s_mov_b32 s90, 14336
    buffer_load_dwordx4 v[172:175], v30, s[32:35], s90 offen
    s_mov_b32 s90, 21504
    buffer_load_dwordx4 v[176:179], v30, s[32:35], s90 offen
    s_waitcnt vmcnt(22)
    s_barrier
    s_add_u32 m0, s89, 40960
    s_mov_b32 s90, 655360
    buffer_load_dwordx4 v12, s[20:23], s90 offen lds
    s_add_u32 m0, s89, 45056
    s_mov_b32 s90, 720896
    buffer_load_dwordx4 v12, s[20:23], s90 offen lds
    s_add_u32 m0, s89, 49152
    s_mov_b32 s90, 786432
    buffer_load_dwordx4 v12, s[20:23], s90 offen lds
    s_add_u32 m0, s89, 53248
    s_mov_b32 s90, 851968
    buffer_load_dwordx4 v12, s[20:23], s90 offen lds
    s_mov_b32 s90, 28672
    buffer_load_dwordx4 v[180:183], v30, s[32:35], s90 offen
    s_mov_b32 s90, 35840
    buffer_load_dwordx4 v[184:187], v30, s[32:35], s90 offen
    s_mov_b32 s90, 43008
    buffer_load_dwordx4 v[188:191], v30, s[32:35], s90 offen
L_walk_5:
    s_cbranch_execz L_walk_9
    s_waitcnt vmcnt(11)
    v_add_f32 v40, v40, v44
    v_add_f32 v41, v41, v45
    v_add_f32 v42, v42, v46
    v_add_f32 v43, v43, v47
    v_add_f32 v40, v40, v48
    v_add_f32 v41, v41, v49
    v_add_f32 v42, v42, v50
    v_add_f32 v43, v43, v51
    v_add_f32 v40, v40, v52
    v_add_f32 v41, v41, v53
    v_add_f32 v42, v42, v54
    v_add_f32 v43, v43, v55
    v_add_f32 v56, v56, v60
    v_add_f32 v57, v57, v61
    v_add_f32 v58, v58, v62
    v_add_f32 v59, v59, v63
    v_add_f32 v56, v56, v64
    v_add_f32 v57, v57, v65
    v_add_f32 v58, v58, v66
    v_add_f32 v59, v59, v67
    v_add_f32 v56, v56, v68
    v_add_f32 v57, v57, v69
    v_add_f32 v58, v58, v70
    v_add_f32 v59, v59, v71
    s_nop 0
    v_permlane32_swap_b32 v56, v58
    v_permlane32_swap_b32 v57, v59
    v_permlane32_swap_b32 v40, v42
    v_permlane32_swap_b32 v41, v43
    v_add_f32 v56, v56, v58
    v_add_f32 v57, v57, v59
    v_add_f32 v40, v40, v42
    v_add_f32 v41, v41, v43
    v_mov_b32 v58, v56
    v_mov_b32 v59, v57
    v_permlane16_swap_b32 v40, v41
    v_permlane16_swap_b32 v56, v58
    v_permlane16_swap_b32 v57, v59
    v_add_f32 v40, v40, v41
    v_add_f32 v56, v56, v58
    v_add_f32 v57, v57, v59
    v_mul_f32 v56, 0x3a800000, v56
    v_mul_f32 v57, 0x3a800000, v57
    v_fma_f32 v57, -v56, v56, v57
    v_max_f32 v57, 0, v57
    v_cvt_pk_bf16_f32 v48, v56, v57
    v_lshlrev_b32 v44, 16, v48
    v_and_b32 v48, 0xffff0000, v48
    v_add_f32 v48, 0x3727c5ac, v48
    v_cvt_pk_bf16_f32 v48, v48, v48
    v_lshlrev_b32 v48, 16, v48
    v_sqrt_f32 v48, v48
    s_nop 0
    v_cvt_pk_bf16_f32 v48, v48, v48
    v_lshlrev_b32 v48, 16, v48
    v_rcp_f32 v46, v48
    v_sub_f32 v44, 0, v44
    v_mul_f32 v48, 0x3fb8aa3b, v46
    s_waitcnt vmcnt(19)
    s_barrier
    v_mov_b32 v24, 135168
    v_lshl_add_u32 v24, v21, 2, v24
    v_mov_b32 v25, 0
    ds_write_b32 v24, v25
    ds_write_b32 v24, v25 offset:28608
    ds_write_b32 v17, v40
    ds_write_b32 v16, v44
    ds_write_b32 v16, v46 offset:512
    ds_write_b32 v16, v48 offset:1024
    s_waitcnt lgkmcnt(0)
    s_add_u32 m0, s89, 57344
    s_mov_b32 s90, 917504
    buffer_load_dwordx4 v12, s[20:23], s90 offen lds
    s_add_u32 m0, s89, 61440
    s_mov_b32 s90, 983040
    buffer_load_dwordx4 v12, s[20:23], s90 offen lds
    s_add_u32 m0, s89, 65536
    s_mov_b32 s90, 1048576
    buffer_load_dwordx4 v12, s[20:23], s90 offen lds
    s_add_u32 m0, s89, 69632
    s_mov_b32 s90, 1114112
    buffer_load_dwordx4 v12, s[20:23], s90 offen lds
    s_add_u32 m0, s89, 73728
    s_mov_b32 s90, 1179648
    buffer_load_dwordx4 v12, s[20:23], s90 offen lds
    s_add_u32 m0, s89, 77824
    s_mov_b32 s90, 1245184
    buffer_load_dwordx4 v12, s[20:23], s90 offen lds
    s_barrier
    s_setprio 0
    s_add_u32 m0, s89, 81920
    s_mov_b32 s90, 1310720
    buffer_load_dwordx4 v12, s[20:23], s90 offen lds
    s_add_u32 m0, s89, 86016
    s_mov_b32 s90, 1376256
    buffer_load_dwordx4 v12, s[20:23], s90 offen lds
    s_add_u32 m0, s89, 90112
    s_mov_b32 s90, 1441792
    buffer_load_dwordx4 v12, s[20:23], s90 offen lds
    s_add_u32 m0, s89, 94208
    s_mov_b32 s90, 1507328
    buffer_load_dwordx4 v12, s[20:23], s90 offen lds
    s_add_u32 m0, s89, 98304
    s_mov_b32 s90, 1572864
    buffer_load_dwordx4 v12, s[20:23], s90 offen lds
    s_add_u32 m0, s89, 102400
    s_mov_b32 s90, 1638400
    buffer_load_dwordx4 v12, s[20:23], s90 offen lds
    s_add_u32 m0, s89, 0
    s_mov_b32 s90, 0
    buffer_load_dwordx4 v12, s[20:23], s90 offen lds
    s_add_u32 m0, s89, 4096
    s_mov_b32 s90, 65536
    buffer_load_dwordx4 v12, s[20:23], s90 offen lds
    s_add_u32 m0, s89, 8192
    s_mov_b32 s90, 131072
    buffer_load_dwordx4 v12, s[20:23], s90 offen lds
    s_add_u32 m0, s89, 12288
    s_mov_b32 s90, 196608
    buffer_load_dwordx4 v12, s[20:23], s90 offen lds
    s_add_u32 m0, s89, 16384
    s_mov_b32 s90, 262144
    buffer_load_dwordx4 v12, s[20:23], s90 offen lds
    s_add_u32 m0, s89, 20480
    s_mov_b32 s90, 327680
    buffer_load_dwordx4 v12, s[20:23], s90 offen lds
    s_add_u32 m0, s89, 24576
    s_mov_b32 s90, 393216
    buffer_load_dwordx4 v12, s[20:23], s90 offen lds
    s_add_u32 m0, s89, 28672
    s_mov_b32 s90, 458752
    buffer_load_dwordx4 v12, s[20:23], s90 offen lds
    s_add_u32 m0, s89, 32768
    s_mov_b32 s90, 524288
    buffer_load_dwordx4 v12, s[20:23], s90 offen lds
    s_add_u32 m0, s89, 36864
    s_mov_b32 s90, 589824
    buffer_load_dwordx4 v12, s[20:23], s90 offen lds
    s_lshl_b32 s86, s47, 2
    s_add_u32 s86, s86, s48
    s_lshl_b32 s87, s86, 7
    s_add_u32 s87, s87, 671744
    v_lshl_add_u32 v6, v0, 2, s87
    v_mov_b32 v4, 2147483648
    v_cmp_gt_u32 vcc, 16, v0
    s_nop 1
    v_cndmask_b32 v6, v4, v6, vcc
    s_lshl_b32 s86, s86, 14
    s_add_u32 s86, s86, 5242880
    v_lshl_add_u32 v2, v0, 4, s86
    s_lshl_b32 s86, s47, 1
    s_add_u32 s86, s86, s50
    s_lshl_b32 s86, s86, 11
    s_lshl_b32 s87, s49, 10
    s_add_u32 s86, s86, s87
    s_add_u32 s86, s86, 6881280
    v_lshl_add_u32 v3, v23, 6, s86
    v_lshl_add_u32 v3, v22, 4, v3
    v_mov_b32 v112, 0
    v_mov_b32 v113, 0
    v_mov_b32 v114, 0
    v_mov_b32 v115, 0
    v_mov_b32 v116, 0
    v_mov_b32 v117, 0
    v_mov_b32 v118, 0
    v_mov_b32 v119, 0
    s_mov_b32 s53, s69
    s_mov_b32 s62, s60
    buffer_load_dwordx2 v[148:149], v36, s[40:43], 0 offen offset:0
    buffer_load_dwordx2 v[150:151], v36, s[40:43], 0 offen offset:32
    buffer_load_dwordx2 v[152:153], v36, s[40:43], 0 offen offset:64
L_walk_6:
    s_cbranch_execz L_walk_13
    buffer_load_dwordx2 v[154:155], v36, s[40:43], 0 offen offset:96
    buffer_load_dwordx4 v[128:131], v38, s[40:43], 0 offen
    buffer_load_dwordx4 v[132:135], v38, s[40:43], 0 offen offset:1024
    buffer_load_dwordx4 v[136:139], v39, s[8:11], 0 offen
    buffer_load_dwordx4 v[140:143], v37, s[8:11], 0 offen
    s_mov_b32 s90, 50176
    buffer_load_dwordx4 v[192:195], v30, s[32:35], s90 offen
    s_mov_b32 s90, 57344
    buffer_load_dwordx4 v[196:199], v30, s[32:35], s90 offen
    s_mov_b32 s90, 64512
    buffer_load_dwordx4 v[200:203], v30, s[32:35], s90 offen
    s_waitcnt vmcnt(5)
    v_mov_b32 v4, 0
    buffer_atomic_or v4, v6, s[16:19], 0 offen sc0 sc1
    v_bfe_u32 v36, v0, 2, 1
    v_cmp_eq_u32 vcc, 1, v36
    v_mov_b32 v36, s95
    v_mov_b32 v38, 0
    v_dot2c_f32_bf16 v38, s95, v128
    v_dot2c_f32_bf16 v38, s95, v129
    v_dot2c_f32_bf16 v38, s95, v130
    v_dot2c_f32_bf16 v38, s95, v131
    v_dot2c_f32_bf16 v38, s95, v132
    v_dot2c_f32_bf16 v38, s95, v133
    v_dot2c_f32_bf16 v38, s95, v134
    v_dot2c_f32_bf16 v38, s95, v135
    v_cndmask_b32 v148, v36, v148, vcc
    v_cndmask_b32 v149, v36, v149, vcc
    v_cndmask_b32 v150, v36, v150, vcc
    v_cndmask_b32 v151, v36, v151, vcc
    v_cndmask_b32 v152, v36, v152, vcc
    v_cndmask_b32 v153, v36, v153, vcc
    v_cndmask_b32 v154, v36, v154, vcc
    v_cndmask_b32 v155, v36, v155, vcc
    v_add_f32_dpp v38, v38, v38 row_ror:8 row_mask:0xf bank_mask:0xf
    s_nop 1
    v_add_f32_dpp v38, v38, v38 row_ror:4 row_mask:0xf bank_mask:0xf
    s_nop 1
    v_add_f32_dpp v38, v38, v38 row_ror:2 row_mask:0xf bank_mask:0xf
    s_nop 1
    v_add_f32_dpp v38, v38, v38 row_ror:1 row_mask:0xf bank_mask:0xf
    v_mov_b32 v36, v38
    s_nop 1
    v_permlane32_swap_b32 v38, v36
    v_add_f32 v38, v38, v36
    v_mov_b32 v36, v38
    s_nop 1
    v_permlane16_swap_b32 v38, v36
    v_add_f32 v38, v38, v36
    v_mov_b32 v36, 135200
    v_readfirstlane_b32 s57, v38
    ds_write_b32 v36, v38
    s_mul_i32 s86, s50, 3072
    s_add_u32 s86, s86, 151552
    v_lshl_add_u32 v7, v0, 4, s86
    s_lshl_b32 s86, s49, 10
    v_add_u32 v5, s86, v7
    s_lshl_b32 s86, s49, 3
    v_add_u32 v7, s86, v7
    s_mov_b32 s88, 0xffff0000
    s_mov_b32 s86, 0x00003f80
    s_mov_b32 s87, 0x3f800000
    s_branch L_h1_w0
L_h1_r0:
    s_ff1_i32_b32 s66, s65
    s_bitset0_b32 s65, s66
    s_lshl_b32 s66, s66, 10
    buffer_load_dwordx4 v[40:43], v2, s[16:19], s66 offen sc1
    s_cmp_eq_u32 s65, 0
    s_cbranch_scc1 L_h1_p1
L_h1_r1:
    s_ff1_i32_b32 s66, s65
    s_bitset0_b32 s65, s66
    s_lshl_b32 s66, s66, 10
    buffer_load_dwordx4 v[44:47], v2, s[16:19], s66 offen sc1
    s_cmp_eq_u32 s65, 0
    s_cbranch_scc1 L_h1_p2
L_h1_r2:
    s_ff1_i32_b32 s66, s65
    s_bitset0_b32 s65, s66
    s_lshl_b32 s66, s66, 10
    buffer_load_dwordx4 v[48:51], v2, s[16:19], s66 offen sc1
    s_cmp_eq_u32 s65, 0
    s_cbranch_scc1 L_h1_p3
L_h1_r3:
    s_ff1_i32_b32 s66, s65
    s_bitset0_b32 s65, s66
    s_lshl_b32 s66, s66, 10
    buffer_load_dwordx4 v[52:55], v2, s[16:19], s66 offen sc1
    s_cmp_eq_u32 s65, 0
    s_cbranch_scc1 L_h1_p4
L_h1_r4:
    s_ff1_i32_b32 s66, s65
    s_bitset0_b32 s65, s66
    s_lshl_b32 s66, s66, 10
    buffer_load_dwordx4 v[56:59], v2, s[16:19], s66 offen sc1
    s_cmp_eq_u32 s65, 0
    s_cbranch_scc1 L_h1_p5
L_h1_r5:
    s_ff1_i32_b32 s66, s65
    s_bitset0_b32 s65, s66
    s_lshl_b32 s66, s66, 10
    buffer_load_dwordx4 v[60:63], v2, s[16:19], s66 offen sc1
    s_cmp_eq_u32 s65, 0
    s_cbranch_scc1 L_h1_p6
L_h1_r6:
    s_ff1_i32_b32 s66, s65
    s_bitset0_b32 s65, s66
    s_lshl_b32 s66, s66, 10
    buffer_load_dwordx4 v[64:67], v2, s[16:19], s66 offen sc1
    s_cmp_eq_u32 s65, 0
    s_cbranch_scc1 L_h1_p7
L_h1_r7:
    s_ff1_i32_b32 s66, s65
    s_bitset0_b32 s65, s66
    s_lshl_b32 s66, s66, 10
    buffer_load_dwordx4 v[68:71], v2, s[16:19], s66 offen sc1
    s_cmp_eq_u32 s65, 0
    s_cbranch_scc1 L_h1_p8
L_h1_r8:
    s_ff1_i32_b32 s66, s65
    s_bitset0_b32 s65, s66
    s_lshl_b32 s66, s66, 10
    buffer_load_dwordx4 v[72:75], v2, s[16:19], s66 offen sc1
    s_cmp_eq_u32 s65, 0
    s_cbranch_scc1 L_h1_p9
L_h1_r9:
    s_ff1_i32_b32 s66, s65
    s_bitset0_b32 s65, s66
    s_lshl_b32 s66, s66, 10
    buffer_load_dwordx4 v[76:79], v2, s[16:19], s66 offen sc1
    s_cmp_eq_u32 s65, 0
    s_cbranch_scc1 L_h1_p10
L_h1_r10:
    s_ff1_i32_b32 s66, s65
    s_bitset0_b32 s65, s66
    s_lshl_b32 s66, s66, 10
    buffer_load_dwordx4 v[80:83], v2, s[16:19], s66 offen sc1
    s_cmp_eq_u32 s65, 0
    s_cbranch_scc1 L_h1_p11
L_h1_r11:
    s_ff1_i32_b32 s66, s65
    s_bitset0_b32 s65, s66
    s_lshl_b32 s66, s66, 10
    buffer_load_dwordx4 v[84:87], v2, s[16:19], s66 offen sc1
    s_cmp_eq_u32 s65, 0
    s_cbranch_scc1 L_h1_p12
L_h1_r12:
    s_ff1_i32_b32 s66, s65
    s_bitset0_b32 s65, s66
    s_lshl_b32 s66, s66, 10
    buffer_load_dwordx4 v[88:91], v2, s[16:19], s66 offen sc1
    s_cmp_eq_u32 s65, 0
    s_cbranch_scc1 L_h1_p13
L_h1_r13:
    s_ff1_i32_b32 s66, s65
    s_bitset0_b32 s65, s66
    s_lshl_b32 s66, s66, 10
    buffer_load_dwordx4 v[92:95], v2, s[16:19], s66 offen sc1
    s_cmp_eq_u32 s65, 0
    s_cbranch_scc1 L_h1_p14
L_h1_r14:
    s_ff1_i32_b32 s76, s65
    s_bitset0_b32 s65, s76
    s_lshl_b32 s76, s76, 10
    buffer_load_dwordx4 v[96:99], v2, s[16:19], s76 offen sc1
    s_cmp_eq_u32 s65, 0
    s_cbranch_scc1 L_h1_p15
L_h1_r15:
    s_ff1_i32_b32 s77, s65
    s_bitset0_b32 s65, s77
    s_lshl_b32 s77, s77, 10
    buffer_load_dwordx4 v[100:103], v2, s[16:19], s77 offen sc1
    buffer_load_dwordx4 v[104:107], v3, s[16:19], 0 offen sc1
L_h1_acc:
    s_waitcnt vmcnt(16)
    v_dot2c_f32_bf16 v112, s86, v40
    v_dot2c_f32_bf16 v113, s87, v40
    v_dot2c_f32_bf16 v114, s86, v41
    v_dot2c_f32_bf16 v115, s87, v41
    v_dot2c_f32_bf16 v116, s86, v42
    v_dot2c_f32_bf16 v117, s87, v42
    v_dot2c_f32_bf16 v118, s86, v43
    v_dot2c_f32_bf16 v119, s87, v43
    s_waitcnt vmcnt(15)
    v_dot2c_f32_bf16 v112, s86, v44
    v_dot2c_f32_bf16 v113, s87, v44
    v_dot2c_f32_bf16 v114, s86, v45
    v_dot2c_f32_bf16 v115, s87, v45
    v_dot2c_f32_bf16 v116, s86, v46
    v_dot2c_f32_bf16 v117, s87, v46
    v_dot2c_f32_bf16 v118, s86, v47
    v_dot2c_f32_bf16 v119, s87, v47
    s_waitcnt vmcnt(14)
    v_dot2c_f32_bf16 v112, s86, v48
    v_dot2c_f32_bf16 v113, s87, v48
    v_dot2c_f32_bf16 v114, s86, v49
    v_dot2c_f32_bf16 v115, s87, v49
    v_dot2c_f32_bf16 v116, s86, v50
    v_dot2c_f32_bf16 v117, s87, v50
    v_dot2c_f32_bf16 v118, s86, v51
    v_dot2c_f32_bf16 v119, s87, v51
    v_max3_u32 v4, v43, v47, v51
    s_waitcnt vmcnt(13)
    v_dot2c_f32_bf16 v112, s86, v52
    v_dot2c_f32_bf16 v113, s87, v52
    v_dot2c_f32_bf16 v114, s86, v53
    v_dot2c_f32_bf16 v115, s87, v53
    v_dot2c_f32_bf16 v116, s86, v54
    v_dot2c_f32_bf16 v117, s87, v54
    v_dot2c_f32_bf16 v118, s86, v55
    v_dot2c_f32_bf16 v119, s87, v55
    s_waitcnt vmcnt(12)
    v_dot2c_f32_bf16 v112, s86, v56
    v_dot2c_f32_bf16 v113, s87, v56
    v_dot2c_f32_bf16 v114, s86, v57
    v_dot2c_f32_bf16 v115, s87, v57
    v_dot2c_f32_bf16 v116, s86, v58
    v_dot2c_f32_bf16 v117, s87, v58
    v_dot2c_f32_bf16 v118, s86, v59
    v_dot2c_f32_bf16 v119, s87, v59
    v_max3_u32 v4, v4, v55, v59
    s_waitcnt vmcnt(11)
    v_dot2c_f32_bf16 v112, s86, v60
    v_dot2c_f32_bf16 v113, s87, v60
    v_dot2c_f32_bf16 v114, s86, v61
    v_dot2c_f32_bf16 v115, s87, v61
    v_dot2c_f32_bf16 v116, s86, v62
    v_dot2c_f32_bf16 v117, s87, v62
    v_dot2c_f32_bf16 v118, s86, v63
    v_dot2c_f32_bf16 v119, s87, v63
    s_waitcnt vmcnt(10)
    v_dot2c_f32_bf16 v112, s86, v64
    v_dot2c_f32_bf16 v113, s87, v64
    v_dot2c_f32_bf16 v114, s86, v65
    v_dot2c_f32_bf16 v115, s87, v65
    v_dot2c_f32_bf16 v116, s86, v66
    v_dot2c_f32_bf16 v117, s87, v66
    v_dot2c_f32_bf16 v118, s86, v67
    v_dot2c_f32_bf16 v119, s87, v67
    v_max3_u32 v4, v4, v63, v67
    s_waitcnt vmcnt(9)
    v_dot2c_f32_bf16 v112, s86, v68
    v_dot2c_f32_bf16 v113, s87, v68
    v_dot2c_f32_bf16 v114, s86, v69
    v_dot2c_f32_bf16 v115, s87, v69
    v_dot2c_f32_bf16 v116, s86, v70
    v_dot2c_f32_bf16 v117, s87, v70
    v_dot2c_f32_bf16 v118, s86, v71
    v_dot2c_f32_bf16 v119, s87, v71
L_walk_7:
    s_cbranch_execz L_walk_14
    s_waitcnt vmcnt(8)
    v_dot2c_f32_bf16 v112, s86, v72
    v_dot2c_f32_bf16 v113, s87, v72
    v_dot2c_f32_bf16 v114, s86, v73
    v_dot2c_f32_bf16 v115, s87, v73
    v_dot2c_f32_bf16 v116, s86, v74
    v_dot2c_f32_bf16 v117, s87, v74
    v_dot2c_f32_bf16 v118, s86, v75
    v_dot2c_f32_bf16 v119, s87, v75
    v_max3_u32 v4, v4, v71, v75
    s_waitcnt vmcnt(7)
    v_dot2c_f32_bf16 v112, s86, v76
    v_dot2c_f32_bf16 v113, s87, v76
    v_dot2c_f32_bf16 v114, s86, v77
    v_dot2c_f32_bf16 v115, s87, v77
    v_dot2c_f32_bf16 v116, s86, v78
    v_dot2c_f32_bf16 v117, s87, v78
    v_dot2c_f32_bf16 v118, s86, v79
    v_dot2c_f32_bf16 v119, s87, v79
    s_waitcnt vmcnt(6)
    v_dot2c_f32_bf16 v112, s86, v80
    v_dot2c_f32_bf16 v113, s87, v80
    v_dot2c_f32_bf16 v114, s86, v81
    v_dot2c_f32_bf16 v115, s87, v81
    v_dot2c_f32_bf16 v116, s86, v82
    v_dot2c_f32_bf16 v117, s87, v82
    v_dot2c_f32_bf16 v118, s86, v83
    v_dot2c_f32_bf16 v119, s87, v83
    v_max3_u32 v4, v4, v79, v83
    s_waitcnt vmcnt(5)
    v_dot2c_f32_bf16 v112, s86, v84
    v_dot2c_f32_bf16 v113, s87, v84
    v_dot2c_f32_bf16 v114, s86, v85
    v_dot2c_f32_bf16 v115, s87, v85
    v_dot2c_f32_bf16 v116, s86, v86
    v_dot2c_f32_bf16 v117, s87, v86
    v_dot2c_f32_bf16 v118, s86, v87
    v_dot2c_f32_bf16 v119, s87, v87
    s_waitcnt vmcnt(4)
    v_dot2c_f32_bf16 v112, s86, v88
    v_dot2c_f32_bf16 v113, s87, v88
    v_dot2c_f32_bf16 v114, s86, v89
    v_dot2c_f32_bf16 v115, s87, v89
    v_dot2c_f32_bf16 v116, s86, v90
    v_dot2c_f32_bf16 v117, s87, v90
    v_dot2c_f32_bf16 v118, s86, v91
    v_dot2c_f32_bf16 v119, s87, v91
    v_max3_u32 v4, v4, v87, v91
    s_waitcnt vmcnt(3)
    v_dot2c_f32_bf16 v112, s86, v92
    v_dot2c_f32_bf16 v113, s87, v92
    v_dot2c_f32_bf16 v114, s86, v93
    v_dot2c_f32_bf16 v115, s87, v93
    v_dot2c_f32_bf16 v116, s86, v94
    v_dot2c_f32_bf16 v117, s87, v94
    v_dot2c_f32_bf16 v118, s86, v95
    v_dot2c_f32_bf16 v119, s87, v95
    v_max_u32 v4, v4, v95
L_h1_chk:
    s_waitcnt vmcnt(0)
    v_max3_u32 v8, v4, v99, v103
    v_max3_u32 v8, v8, v107, v107
    v_cmp_eq_u32 vcc, -1, v8
    s_cbranch_vccnz L_h1_again
L_h1_ok:
    s_add_u32 m0, s89, 106496
    s_mov_b32 s90, 1703936
    buffer_load_dwordx4 v12, s[20:23], s90 offen lds
    s_add_u32 m0, s89, 110592
    s_mov_b32 s90, 1769472
    buffer_load_dwordx4 v12, s[20:23], s90 offen lds
    s_add_u32 m0, s89, 114688
    s_mov_b32 s90, 1835008
    buffer_load_dwordx4 v12, s[20:23], s90 offen lds
    s_add_u32 m0, s89, 118784
    s_mov_b32 s90, 1900544
    buffer_load_dwordx4 v12, s[20:23], s90 offen lds
    s_add_u32 m0, s89, 122880
    s_mov_b32 s90, 1966080
    buffer_load_dwordx4 v12, s[20:23], s90 offen lds
    s_add_u32 m0, s89, 126976
    s_mov_b32 s90, 2031616
    buffer_load_dwordx4 v12, s[20:23], s90 offen lds
    v_dot2c_f32_bf16 v112, s86, v96
    v_dot2c_f32_bf16 v113, s87, v96
    v_dot2c_f32_bf16 v114, s86, v97
    v_dot2c_f32_bf16 v115, s87, v97
    v_dot2c_f32_bf16 v116, s86, v98
    v_dot2c_f32_bf16 v117, s87, v98
    v_dot2c_f32_bf16 v118, s86, v99
    v_dot2c_f32_bf16 v119, s87, v99
    v_dot2c_f32_bf16 v112, s86, v100
    v_dot2c_f32_bf16 v113, s87, v100
    v_dot2c_f32_bf16 v114, s86, v101
    v_dot2c_f32_bf16 v115, s87, v101
    v_dot2c_f32_bf16 v116, s86, v102
    v_dot2c_f32_bf16 v117, s87, v102
    v_dot2c_f32_bf16 v118, s86, v103
    v_dot2c_f32_bf16 v119, s87, v103
    v_add_f32_dpp v104, v104, v104 row_ror:8 row_mask:0xf bank_mask:0xf
    v_add_f32_dpp v105, v105, v105 row_ror:8 row_mask:0xf bank_mask:0xf
    v_add_f32_dpp v106, v106, v106 row_ror:8 row_mask:0xf bank_mask:0xf
    v_add_f32_dpp v107, v107, v107 row_ror:8 row_mask:0xf bank_mask:0xf
    v_cvt_pk_bf16_f32 v120, v112, v113
    v_cvt_pk_bf16_f32 v121, v114, v115
    v_cvt_pk_bf16_f32 v122, v116, v117
    v_cvt_pk_bf16_f32 v123, v118, v119
    ds_write_b128 v5, v[120:123]
    v_add_f32_dpp v104, v104, v104 row_ror:4 row_mask:0xf bank_mask:0xf
    v_add_f32_dpp v105, v105, v105 row_ror:4 row_mask:0xf bank_mask:0xf
    v_add_f32_dpp v106, v106, v106 row_ror:4 row_mask:0xf bank_mask:0xf
    v_add_f32_dpp v107, v107, v107 row_ror:4 row_mask:0xf bank_mask:0xf
    v_add_f32_dpp v104, v104, v104 row_ror:2 row_mask:0xf bank_mask:0xf
    v_add_f32_dpp v105, v105, v105 row_ror:2 row_mask:0xf bank_mask:0xf
    v_add_f32_dpp v106, v106, v106 row_ror:2 row_mask:0xf bank_mask:0xf
    v_add_f32_dpp v107, v107, v107 row_ror:2 row_mask:0xf bank_mask:0xf
    v_add_f32_dpp v104, v104, v104 row_ror:1 row_mask:0xf bank_mask:0xf
    v_add_f32_dpp v105, v105, v105 row_ror:1 row_mask:0xf bank_mask:0xf
    v_add_f32_dpp v106, v106, v106 row_ror:1 row_mask:0xf bank_mask:0xf
    v_add_f32_dpp v107, v107, v107 row_ror:1 row_mask:0xf bank_mask:0xf
    v_cvt_pk_bf16_f32 v124, v104, v105
    v_cvt_pk_bf16_f32 v125, v106, v107
    ds_write_b64 v7, v[124:125] offset:2048
L_h1_done:
    s_waitcnt lgkmcnt(0)
    s_barrier
    s_or_b32 s86, s2, s48
    s_cmp_eq_u32 s86, 0
    s_cselect_b32 s86, 0, 2147483648
    s_add_u32 s86, s86, 524288
    v_mov_b32 v6, s86
    buffer_store_dword v35, v6, s[16:19], 0 offen sc1
    v_mov_b32 v11, v30
    v_mov_b32 v14, v31
    v_mov_b32 v8, 0
    buffer_atomic_or v8, v159, s[16:19], 0 offen sc0 sc1
    s_branch L_phaseB
L_h1_p0:
L_h1_w0:
    s_waitcnt vmcnt(0)
    v_cmp_eq_u32 vcc, s68, v4
    s_nop 0
    s_andn2_b32 s65, vcc_lo, s88
    s_or_b32 s88, s88, s65
    s_bcnt0_i32_b32 s90, s88
    s_cmp_le_u32 s90, 2
    s_cbranch_scc1 L_h1_r0
    v_mov_b32 v4, 0
    buffer_atomic_or v4, v6, s[16:19], 0 offen sc0 sc1
    s_mov_b32 s67, 0
    s_cmp_lg_u32 s65, 0
    s_cbranch_scc1 L_h1_r0
    s_sub_u32 s56, s56, 1
    s_cbranch_scc0 L_h1_p0
    s_mov_b32 s56, 0
    s_not_b32 s65, s88
    s_branch L_h1_r0
L_h1_p1:
    s_waitcnt vmcnt(1)
    s_cmp_eq_u32 s67, 0
    s_cbranch_scc1 L_h1_s1
    s_waitcnt vmcnt(0)
L_h1_s1:
    v_cmp_eq_u32 vcc, s68, v4
    s_nop 0
    s_andn2_b32 s65, vcc_lo, s88
    s_or_b32 s88, s88, s65
    s_bcnt0_i32_b32 s90, s88
    s_cmp_le_u32 s90, 2
    s_cbranch_scc1 L_h1_r1
    v_mov_b32 v4, 0
    buffer_atomic_or v4, v6, s[16:19], 0 offen sc0 sc1
    s_mov_b32 s67, 1
    s_cmp_lg_u32 s65, 0
    s_cbranch_scc1 L_h1_r1
    s_sub_u32 s56, s56, 1
    s_cbranch_scc0 L_h1_p1
    s_mov_b32 s56, 0
    s_not_b32 s65, s88
    s_branch L_h1_r1
L_h1_p2:
    s_waitcnt vmcnt(2)
    s_cmp_eq_u32 s67, 0
    s_cbranch_scc1 L_h1_s2
    s_waitcnt vmcnt(0)
L_h1_s2:
    v_cmp_eq_u32 vcc, s68, v4
    s_nop 0
    s_andn2_b32 s65, vcc_lo, s88
    s_or_b32 s88, s88, s65
    s_bcnt0_i32_b32 s90, s88
    s_cmp_le_u32 s90, 2
    s_cbranch_scc1 L_h1_r2
    v_mov_b32 v4, 0
    buffer_atomic_or v4, v6, s[16:19], 0 offen sc0 sc1
    s_mov_b32 s67, 2
    s_cmp_lg_u32 s65, 0
    s_cbranch_scc1 L_h1_r2
    s_sub_u32 s56, s56, 1
    s_cbranch_scc0 L_h1_p2
    s_mov_b32 s56, 0
    s_not_b32 s65, s88
    s_branch L_h1_r2
L_h1_p3:
    s_waitcnt vmcnt(3)
    s_cmp_eq_u32 s67, 0
    s_cbranch_scc1 L_h1_s3
    s_waitcnt vmcnt(0)
L_h1_s3:
    v_cmp_eq_u32 vcc, s68, v4
    s_nop 0
    s_andn2_b32 s65, vcc_lo, s88
    s_or_b32 s88, s88, s65
    s_bcnt0_i32_b32 s90, s88
    s_cmp_le_u32 s90, 2
    s_cbranch_scc1 L_h1_r3
    v_mov_b32 v4, 0
    buffer_atomic_or v4, v6, s[16:19], 0 offen sc0 sc1
    s_mov_b32 s67, 3
    s_cmp_lg_u32 s65, 0
    s_cbranch_scc1 L_h1_r3
    s_sub_u32 s56, s56, 1
    s_cbranch_scc0 L_h1_p3
    s_mov_b32 s56, 0
    s_not_b32 s65, s88
    s_branch L_h1_r3
L_walk_8:
    s_cbranch_execz L_walked
L_h1_p4:
    s_waitcnt vmcnt(4)
    s_cmp_eq_u32 s67, 0
    s_cbranch_scc1 L_h1_s4
    s_waitcnt vmcnt(0)
L_h1_s4:
    v_cmp_eq_u32 vcc, s68, v4
    s_nop 0
    s_andn2_b32 s65, vcc_lo, s88
    s_or_b32 s88, s88, s65
    s_bcnt0_i32_b32 s90, s88
    s_cmp_le_u32 s90, 2
    s_cbranch_scc1 L_h1_r4
    v_mov_b32 v4, 0
    buffer_atomic_or v4, v6, s[16:19], 0 offen sc0 sc1
    s_mov_b32 s67, 4
    s_cmp_lg_u32 s65, 0
    s_cbranch_scc1 L_h1_r4
    s_sub_u32 s56, s56, 1
    s_cbranch_scc0 L_h1_p4
    s_mov_b32 s56, 0
    s_not_b32 s65, s88
    s_branch L_h1_r4
L_h1_p5:
    s_waitcnt vmcnt(5)
    s_cmp_eq_u32 s67, 0
    s_cbranch_scc1 L_h1_s5
    s_waitcnt vmcnt(0)
L_h1_s5:
    v_cmp_eq_u32 vcc, s68, v4
    s_nop 0
    s_andn2_b32 s65, vcc_lo, s88
    s_or_b32 s88, s88, s65
    s_bcnt0_i32_b32 s90, s88
    s_cmp_le_u32 s90, 2
    s_cbranch_scc1 L_h1_r5
    v_mov_b32 v4, 0
    buffer_atomic_or v4, v6, s[16:19], 0 offen sc0 sc1
    s_mov_b32 s67, 5
    s_cmp_lg_u32 s65, 0
    s_cbranch_scc1 L_h1_r5
    s_sub_u32 s56, s56, 1
    s_cbranch_scc0 L_h1_p5
    s_mov_b32 s56, 0
    s_not_b32 s65, s88
    s_branch L_h1_r5
L_h1_p6:
    s_waitcnt vmcnt(6)
    s_cmp_eq_u32 s67, 0
    s_cbranch_scc1 L_h1_s6
    s_waitcnt vmcnt(0)
L_h1_s6:
    v_cmp_eq_u32 vcc, s68, v4
    s_nop 0
    s_andn2_b32 s65, vcc_lo, s88
    s_or_b32 s88, s88, s65
    s_bcnt0_i32_b32 s90, s88
    s_cmp_le_u32 s90, 2
    s_cbranch_scc1 L_h1_r6
    v_mov_b32 v4, 0
    buffer_atomic_or v4, v6, s[16:19], 0 offen sc0 sc1
    s_mov_b32 s67, 6
    s_cmp_lg_u32 s65, 0
    s_cbranch_scc1 L_h1_r6
    s_sub_u32 s56, s56, 1
    s_cbranch_scc0 L_h1_p6
    s_mov_b32 s56, 0
    s_not_b32 s65, s88
    s_branch L_h1_r6
L_h1_p7:
    s_waitcnt vmcnt(7)
    s_cmp_eq_u32 s67, 0
    s_cbranch_scc1 L_h1_s7
    s_waitcnt vmcnt(0)
L_h1_s7:
    v_cmp_eq_u32 vcc, s68, v4
    s_nop 0
    s_andn2_b32 s65, vcc_lo, s88
    s_or_b32 s88, s88, s65
    s_bcnt0_i32_b32 s90, s88
    s_cmp_le_u32 s90, 2
    s_cbranch_scc1 L_h1_r7
    v_mov_b32 v4, 0
    buffer_atomic_or v4, v6, s[16:19], 0 offen sc0 sc1
    s_mov_b32 s67, 7
    s_cmp_lg_u32 s65, 0
    s_cbranch_scc1 L_h1_r7
    s_sub_u32 s56, s56, 1
    s_cbranch_scc0 L_h1_p7
    s_mov_b32 s56, 0
    s_not_b32 s65, s88
    s_branch L_h1_r7
L_h1_p8:
    s_waitcnt vmcnt(8)
    s_cmp_eq_u32 s67, 0
    s_cbranch_scc1 L_h1_s8
    s_waitcnt vmcnt(0)
L_h1_s8:
    v_cmp_eq_u32 vcc, s68, v4
    s_nop 0
    s_andn2_b32 s65, vcc_lo, s88
    s_or_b32 s88, s88, s65
    s_bcnt0_i32_b32 s90, s88
    s_cmp_le_u32 s90, 2
    s_cbranch_scc1 L_h1_r8
    v_mov_b32 v4, 0
    buffer_atomic_or v4, v6, s[16:19], 0 offen sc0 sc1
    s_mov_b32 s67, 8
    s_cmp_lg_u32 s65, 0
    s_cbranch_scc1 L_h1_r8
    s_sub_u32 s56, s56, 1
    s_cbranch_scc0 L_h1_p8
    s_mov_b32 s56, 0
    s_not_b32 s65, s88
    s_branch L_h1_r8
L_h1_p9:
    s_waitcnt vmcnt(9)
    s_cmp_eq_u32 s67, 0
    s_cbranch_scc1 L_h1_s9
    s_waitcnt vmcnt(0)
L_h1_s9:
    v_cmp_eq_u32 vcc, s68, v4
    s_nop 0
    s_andn2_b32 s65, vcc_lo, s88
    s_or_b32 s88, s88, s65
    s_bcnt0_i32_b32 s90, s88
    s_cmp_le_u32 s90, 2
    s_cbranch_scc1 L_h1_r9
    v_mov_b32 v4, 0
    buffer_atomic_or v4, v6, s[16:19], 0 offen sc0 sc1
    s_mov_b32 s67, 9
    s_cmp_lg_u32 s65, 0
    s_cbranch_scc1 L_h1_r9
    s_sub_u32 s56, s56, 1
    s_cbranch_scc0 L_h1_p9
    s_mov_b32 s56, 0
    s_not_b32 s65, s88
    s_branch L_h1_r9
L_h1_p10:
    s_waitcnt vmcnt(10)
    s_cmp_eq_u32 s67, 0
    s_cbranch_scc1 L_h1_s10
    s_waitcnt vmcnt(0)
L_h1_s10:
    v_cmp_eq_u32 vcc, s68, v4
    s_nop 0
    s_andn2_b32 s65, vcc_lo, s88
    s_or_b32 s88, s88, s65
    s_bcnt0_i32_b32 s90, s88
    s_cmp_le_u32 s90, 2
    s_cbranch_scc1 L_h1_r10
    v_mov_b32 v4, 0
    buffer_atomic_or v4, v6, s[16:19], 0 offen sc0 sc1
    s_mov_b32 s67, 10
    s_cmp_lg_u32 s65, 0
    s_cbranch_scc1 L_h1_r10
    s_sub_u32 s56, s56, 1
    s_cbranch_scc0 L_h1_p10
    s_mov_b32 s56, 0
    s_not_b32 s65, s88
    s_branch L_h1_r10
L_h1_p11:
    s_waitcnt vmcnt(11)
    s_cmp_eq_u32 s67, 0
    s_cbranch_scc1 L_h1_s11
    s_waitcnt vmcnt(0)
L_h1_s11:
    v_cmp_eq_u32 vcc, s68, v4
    s_nop 0
    s_andn2_b32 s65, vcc_lo, s88
    s_or_b32 s88, s88, s65
    s_bcnt0_i32_b32 s90, s88
    s_cmp_le_u32 s90, 2
    s_cbranch_scc1 L_h1_r11
    v_mov_b32 v4, 0
    buffer_atomic_or v4, v6, s[16:19], 0 offen sc0 sc1
    s_mov_b32 s67, 11
    s_cmp_lg_u32 s65, 0
    s_cbranch_scc1 L_h1_r11
    s_sub_u32 s56, s56, 1
    s_cbranch_scc0 L_h1_p11
    s_mov_b32 s56, 0
    s_not_b32 s65, s88
    s_branch L_h1_r11
L_h1_p12:
    s_waitcnt vmcnt(12)
    s_cmp_eq_u32 s67, 0
    s_cbranch_scc1 L_h1_s12
    s_waitcnt vmcnt(0)
L_h1_s12:
    v_cmp_eq_u32 vcc, s68, v4
    s_nop 0
    s_andn2_b32 s65, vcc_lo, s88
    s_or_b32 s88, s88, s65
    s_bcnt0_i32_b32 s90, s88
    s_cmp_le_u32 s90, 2
    s_cbranch_scc1 L_h1_r12
    v_mov_b32 v4, 0
    buffer_atomic_or v4, v6, s[16:19], 0 offen sc0 sc1
    s_mov_b32 s67, 12
    s_cmp_lg_u32 s65, 0
    s_cbranch_scc1 L_h1_r12
    s_sub_u32 s56, s56, 1
    s_cbranch_scc0 L_h1_p12
    s_mov_b32 s56, 0
    s_not_b32 s65, s88
    s_branch L_h1_r12
L_h1_p13:
    s_waitcnt vmcnt(13)
    s_cmp_eq_u32 s67, 0
    s_cbranch_scc1 L_h1_s13
    s_waitcnt vmcnt(0)
L_h1_s13:
    v_cmp_eq_u32 vcc, s68, v4
    s_nop 0
    s_andn2_b32 s65, vcc_lo, s88
    s_or_b32 s88, s88, s65
    s_bcnt0_i32_b32 s90, s88
    s_cmp_le_u32 s90, 2
    s_cbranch_scc1 L_h1_r13
    v_mov_b32 v4, 0
    buffer_atomic_or v4, v6, s[16:19], 0 offen sc0 sc1
    s_mov_b32 s67, 13
    s_cmp_lg_u32 s65, 0
    s_cbranch_scc1 L_h1_r13
    s_sub_u32 s56, s56, 1
    s_cbranch_scc0 L_h1_p13
    s_mov_b32 s56, 0
    s_not_b32 s65, s88
    s_branch L_h1_r13
L_h1_p14:
    s_not_b32 s65, s88
    s_branch L_h1_r14
L_h1_p15:
    s_not_b32 s65, s88
    s_branch L_h1_r15
L_h1_again:
    s_sub_u32 s56, s56, 1
    s_cbranch_scc0 L_h1_re
    s_mov_b32 s56, 0
    s_branch L_h1_ok
L_h1_re:
    v_cmp_eq_u32 vcc, -1, v4
    s_cbranch_vccnz L_h1_all
    v_cmp_eq_u32 vcc, -1, v99
    s_cbranch_vccz L_h1_n14
    s_mov_b64 exec, vcc
    buffer_load_dwordx4 v[96:99], v2, s[16:19], s76 offen sc1
    s_mov_b64 exec, -1
L_h1_n14:
    v_cmp_eq_u32 vcc, -1, v103
    s_cbranch_vccz L_h1_n15
    s_mov_b64 exec, vcc
    buffer_load_dwordx4 v[100:103], v2, s[16:19], s77 offen sc1
    s_mov_b64 exec, -1
L_h1_n15:
    v_cmp_eq_u32 vcc, -1, v107
    s_cbranch_vccz L_h1_n16
    s_mov_b64 exec, vcc
    buffer_load_dwordx4 v[104:107], v3, s[16:19], 0 offen sc1
    s_mov_b64 exec, -1
L_h1_n16:
    s_branch L_h1_chk
L_h1_all:
    s_mov_b32 s76, 14336
    s_mov_b32 s77, 15360
    buffer_load_dwordx4 v[40:43], v2, s[16:19], 0 offen offset:0 sc1
    buffer_load_dwordx4 v[44:47], v2, s[16:19], 0 offen offset:1024 sc1
    buffer_load_dwordx4 v[48:51], v2, s[16:19], 0 offen offset:2048 sc1
    buffer_load_dwordx4 v[52:55], v2, s[16:19], 0 offen offset:3072 sc1
    buffer_load_dwordx4 v[56:59], v2, s[16:19], s92 offen offset:0 sc1
    buffer_load_dwordx4 v[60:63], v2, s[16:19], s92 offen offset:1024 sc1
L_walk_9:
    s_cbranch_execz L_walked
    buffer_load_dwordx4 v[64:67], v2, s[16:19], s92 offen offset:2048 sc1
    buffer_load_dwordx4 v[68:71], v2, s[16:19], s92 offen offset:3072 sc1
    buffer_load_dwordx4 v[72:75], v2, s[16:19], s93 offen offset:0 sc1
    buffer_load_dwordx4 v[76:79], v2, s[16:19], s93 offen offset:1024 sc1
    buffer_load_dwordx4 v[80:83], v2, s[16:19], s93 offen offset:2048 sc1
    buffer_load_dwordx4 v[84:87], v2, s[16:19], s93 offen offset:3072 sc1
    buffer_load_dwordx4 v[88:91], v2, s[16:19], s94 offen offset:0 sc1
    buffer_load_dwordx4 v[92:95], v2, s[16:19], s94 offen offset:1024 sc1
    buffer_load_dwordx4 v[96:99], v2, s[16:19], s94 offen offset:2048 sc1
    buffer_load_dwordx4 v[100:103], v2, s[16:19], s94 offen offset:3072 sc1
    buffer_load_dwordx4 v[104:107], v3, s[16:19], 0 offen sc1
    v_mov_b32 v112, 0
    v_mov_b32 v113, 0
    v_mov_b32 v114, 0
    v_mov_b32 v115, 0
    v_mov_b32 v116, 0
    v_mov_b32 v117, 0
    v_mov_b32 v118, 0
    v_mov_b32 v119, 0
    s_branch L_h1_acc
L_comp:
    s_mov_b64 exec, -1
    v_and_b32 v20, 15, v0
    v_lshrrev_b32 v21, 4, v0
    v_bfe_u32 v22, v0, 1, 3
    s_lshl_b32 s86, s49, 13
    v_lshl_add_u32 v20, v20, 7, s86
    v_or_b32 v23, 0, v21
    v_xor_b32 v23, v23, v22
    v_lshl_add_u32 v2, v23, 4, v20
    v_or_b32 v23, 4, v21
    v_xor_b32 v23, v23, v22
    v_lshl_add_u32 v3, v23, 4, v20
    v_bfe_u32 v22, v0, 2, 2
    v_lshl_add_u32 v22, v21, 3, v22
    v_lshlrev_b32 v22, 7, v22
    v_bfe_u32 v23, v0, 3, 2
    s_lshl_b32 s86, s50, 1
    v_xor_b32 v23, s86, v23
    v_lshl_add_u32 v22, v23, 5, v22
    v_and_b32 v23, 3, v0
    v_lshl_add_u32 v22, v23, 3, v22
    v_add_u32 v4, 16384, v22
    v_xor_b32 v5, 32, v4
    s_lshl_b32 s53, s2, 2
    s_add_u32 s53, s53, s3
    s_lshl_b32 s86, s53, 12
    s_add_u32 s86, s86, 1048576
    v_lshl_add_u32 v6, v0, 4, s86
    s_mul_i32 s53, s53, 160
    s_add_u32 s53, s53, 6553600
    v_lshl_add_u32 v17, v0, 4, s53
    v_mov_b32 v16, 2147483648
    v_cmp_gt_u32 vcc, 10, v0
    s_nop 1
    v_cndmask_b32 v17, v16, v17, vcc
    s_lshl2_add_u32 s86, s45, s3
    s_lshr_b32 s87, s86, 3
    s_mul_i32 s87, s87, 14336
    s_and_b32 s86, s86, 7
    s_lshl3_add_u32 s86, s44, s86
    s_mul_i32 s86, s86, 224
    s_add_u32 s86, s86, s87
    s_add_u32 s86, s86, 7864064
    v_lshl_add_u32 v16, v0, 4, s86
    s_mov_b32 vcc_lo, 0x3fff0000
    s_mov_b32 vcc_hi, 0
    v_cndmask_b32 v17, v17, v16, vcc
    s_lshl_b32 s86, s47, 1
    s_add_u32 s86, s86, s50
    s_lshl1_add_u32 s87, s86, s49
    s_lshl4_add_u32 s87, s87, s46
    s_lshl_b32 s87, s87, 6
    s_add_u32 s87, s87, 6880320
    v_lshl_add_u32 v16, v0, 4, s87
    v_cmp_le_u32 vcc, 60, v0
    s_nop 1
    v_cndmask_b32 v17, v17, v16, vcc
    s_lshl_b32 s87, s86, 1
    s_add_u32 s87, s87, s49
    s_lshl_b32 s87, s87, 4
    s_add_u32 s87, s87, s46
    s_lshl_b32 s87, s87, 10
    s_add_u32 s87, s87, 5242880
    v_lshl_add_u32 v16, v0, 4, s87
    v_mov_b32 v8, -1
    v_mov_b32 v9, -1
    v_mov_b32 v10, -1
    v_mov_b32 v11, -1
    s_waitcnt lgkmcnt(0)
    s_load_dword s61, s[84:85], 524288
    s_mov_b32 s16, s84
    s_and_b32 s17, s85, 0xffff
    s_mov_b32 s18, 268435456
    s_mov_b32 s19, 0x20000
    s_mov_b32 s8, s64
    s_and_b32 s9, s65, 0xffff
    s_mov_b32 s10, 4194304
    s_mov_b32 s11, 0x20000
    s_mov_b32 s20, s68
    s_and_b32 s21, s69, 0xffff
    s_mov_b32 s22, 2097152
    s_mov_b32 s23, 0x20000
    s_mov_b32 s24, s80
    s_and_b32 s25, s81, 0xffff
    s_mov_b32 s26, 4194304
    s_mov_b32 s27, 0x20000
    s_mov_b32 s28, s82
    s_and_b32 s29, s83, 0xffff
    s_mov_b32 s30, 256
    s_mov_b32 s31, 0x20000
    s_bitcmp1_b32 s2, 3
    s_cselect_b32 s32, s76, s74
    s_cselect_b32 s33, s77, s75
    s_and_b32 s33, s33, 0xffff
    s_mov_b32 s34, 7340032
    s_mov_b32 s35, 0x20000
    s_mov_b32 s36, s78
    s_and_b32 s37, s79, 0xffff
    s_mov_b32 s38, 7340032
    s_mov_b32 s39, 0x20000
    s_mov_b32 s40, s72
    s_and_b32 s41, s73, 0xffff
    s_mov_b32 s42, 2048
    s_mov_b32 s43, 0x20000
    s_lshl_b32 s82, s44, 5
    s_or_b32 s82, s82, s45
    s_lshl_b32 s86, s2, 9
    s_add_u32 s86, s86, 786432
    s_cmp_eq_u32 s3, 0
    s_cselect_b32 s86, s86, 2147483648
    v_lshl_add_u32 v7, v0, 2, s86
    v_mul_u32_u24 v12, 192, v21
    v_add_u32 v7, v7, v12
    s_lshl_b32 s86, s2, 8
    s_add_u32 s86, s86, 917376
    s_cmp_eq_u32 s3, 0
    s_cselect_b32 s86, s86, 2147483648
    v_lshl_add_u32 v12, v0, 2, s86
    v_cmp_gt_u32 vcc, 32, v0
    s_nop 1
    v_cndmask_b32 v7, v12, v7, vcc
    v_mov_b32 v12, 2147483648
    v_cmp_gt_u32 vcc, 48, v0
    s_nop 1
    v_cndmask_b32 v7, v12, v7, vcc
    s_lshl_b32 s86, s2, 9
    s_add_u32 s86, s86, 6291456
    v_lshl_add_u32 v13, v0, 2, s86
    v_mul_u32_u24 v12, 64, v21
    v_add_u32 v13, v13, v12
    s_cmp_eq_u32 s3, 1
    s_cselect_b64 vcc, -1, 0
    v_cndmask_b32 v7, v7, v13, vcc
    v_mov_b32 v12, 0
    buffer_store_dword v12, v7, s[16:19], 0 offen sc1
    v_mov_b32 v128, 0
    v_mov_b32 v129, 0
    v_mov_b32 v130, 0
    v_mov_b32 v131, 0
    v_mov_b32 v132, 0
    v_mov_b32 v133, 0
    v_mov_b32 v134, 0
    v_mov_b32 v135, 0
    v_mov_b32 v136, 0
    v_mov_b32 v137, 0
    v_mov_b32 v138, 0
    v_mov_b32 v139, 0
    v_mov_b32 v140, 0
    v_mov_b32 v141, 0
    v_mov_b32 v142, 0
    v_mov_b32 v143, 0
    v_mov_b32 v144, 0
    v_mov_b32 v145, 0
    v_mov_b32 v146, 0
    v_mov_b32 v147, 0
    v_mov_b32 v148, 0
    v_mov_b32 v149, 0
    v_mov_b32 v150, 0
    v_mov_b32 v151, 0
    v_mov_b32 v152, 0
    v_mov_b32 v153, 0
    v_mov_b32 v154, 0
    v_mov_b32 v155, 0
    v_mov_b32 v156, 0
    v_mov_b32 v157, 0
    v_mov_b32 v158, 0
    v_mov_b32 v159, 0
    v_mov_b32 v160, 0
    v_mov_b32 v161, 0
    v_mov_b32 v162, 0
    v_mov_b32 v163, 0
    v_mov_b32 v164, 0
    v_mov_b32 v165, 0
    v_mov_b32 v166, 0
    v_mov_b32 v167, 0
    v_mov_b32 v168, 0
    v_mov_b32 v169, 0
    v_mov_b32 v170, 0
    v_mov_b32 v171, 0
    v_mov_b32 v172, 0
    v_mov_b32 v173, 0
    v_mov_b32 v174, 0
    v_mov_b32 v175, 0
    v_mov_b32 v176, 0
    v_mov_b32 v177, 0
    v_mov_b32 v178, 0
    v_mov_b32 v179, 0
    v_mov_b32 v180, 0
    v_mov_b32 v181, 0
    v_mov_b32 v182, 0
    v_mov_b32 v183, 0
    v_mov_b32 v184, 0
    v_mov_b32 v185, 0
    v_mov_b32 v186, 0
    v_mov_b32 v187, 0
    v_mov_b32 v188, 0
    v_mov_b32 v189, 0
    v_mov_b32 v190, 0
    v_mov_b32 v191, 0
    v_mov_b32 v192, 0
    v_mov_b32 v193, 0
    v_mov_b32 v194, 0
    v_mov_b32 v195, 0
    v_mov_b32 v196, 0
    v_mov_b32 v197, 0
    v_mov_b32 v198, 0
    v_mov_b32 v199, 0
    v_mov_b32 v200, 0
    v_mov_b32 v201, 0
    v_mov_b32 v202, 0
    v_mov_b32 v203, 0
L_walkA2:
    s_cbranch_execz L_comp
    v_mov_b32 v204, 0
    v_mov_b32 v205, 0
    v_mov_b32 v206, 0
    v_mov_b32 v207, 0
    v_mov_b32 v208, 0
    v_mov_b32 v209, 0
    v_mov_b32 v210, 0
    v_mov_b32 v211, 0
    v_mov_b32 v212, 0
    v_mov_b32 v213, 0
    v_mov_b32 v214, 0
    v_mov_b32 v215, 0
    v_mov_b32 v216, 0
    v_mov_b32 v217, 0
    v_mov_b32 v218, 0
    v_mov_b32 v219, 0
    v_mov_b32 v220, 0
    v_mov_b32 v221, 0
    v_mov_b32 v222, 0
    v_mov_b32 v223, 0
    s_mov_b32 s54, 0x358637bd
    s_mov_b32 s55, 0x358637bd
    s_mul_i32 s86, s3, 3072
    s_add_u32 s86, s86, 139264
    v_lshl_add_u32 v24, v0, 4, s86
    s_xor_b32 s86, s3, 1
    s_mul_i32 s86, s86, 3072
    s_add_u32 s86, s86, 139264
    v_lshl_add_u32 v25, v0, 4, s86
    s_lshl_b32 s86, s47, 1
    s_add_u32 s86, s86, s50
    s_lshl_b32 s87, s86, 1
    s_add_u32 s87, s87, s49
    s_lshl_b32 s87, s87, 4
    s_add_u32 s87, s87, s46
    s_lshl_b32 s87, s87, 10
    s_add_u32 s87, s87, 5242880
    v_lshl_add_u32 v26, v0, 4, s87
    s_lshl1_add_u32 s87, s86, s49
    s_lshl4_add_u32 s87, s87, s46
    s_lshl_b32 s87, s87, 6
    s_add_u32 s87, s87, 6881280
    v_add_u32 v27, s87, v0
    s_mov_b32 vcc_lo, 0x00010001
    s_mov_b32 vcc_hi, vcc_lo
    v_mov_b32 v14, 2147483648
    v_cndmask_b32 v27, v14, v27, vcc
    s_lshl_b32 s87, s46, 3
    s_lshl_b32 s88, s49, 2
    s_add_u32 s87, s87, s88
    s_lshl_b32 s87, s87, 5
    s_add_u32 s87, s87, s86
    s_lshl_b32 s87, s87, 10
    s_add_u32 s87, s87, 1048576
    v_lshl_add_u32 v23, v0, 4, s87
    s_mul_i32 s87, s50, 3072
    s_add_u32 s87, s87, 151552
    v_lshl_add_u32 v20, v0, 4, s87
    s_lshl_b32 s87, s86, 1
    s_add_u32 s87, s87, s49
    s_lshl_b32 s87, s87, 5
    s_add_u32 s87, s87, s46
    s_lshl2_add_u32 s87, s87, 671744
    v_mov_b32 v19, 2147483648
    v_mov_b32 v18, 2147483648
    v_writelane_b32 v19, s87, 0
    s_lshl_b32 s87, s46, 1
    s_add_u32 s87, s87, s49
    s_lshl_b32 s87, s87, 1
    s_lshr_b32 s88, s86, 4
    s_add_u32 s87, s87, s88
    s_lshl_b32 s87, s87, 6
    s_and_b32 s88, s86, 15
    s_add_u32 s87, s87, s88
    s_lshl2_add_u32 s87, s87, 688128
    v_writelane_b32 v18, s87, 0
    s_add_u32 s87, s87, 128
    v_writelane_b32 v18, s87, 1
    v_mov_b32 v120, s95
    v_mov_b32 v121, s95
    v_mov_b32 v122, s95
    v_mov_b32 v123, s95
    s_mov_b32 s4, 0x3f317218
    s_mov_b32 s5, 0x3f317218
    s_mov_b32 s6, 0x35c1a2c6
    s_mov_b32 s62, 0
    s_mov_b32 s63, 1
    v_add_u32 v2, 40960, v2
    v_add_u32 v3, 40960, v3
    v_add_u32 v4, 40960, v4
    v_add_u32 v5, 40960, v5
    s_mov_b64 exec, 0
    s_cmp_eq_u32 s3, 0
    s_cbranch_scc1 L_walkB0
    s_cmp_eq_u32 s3, 1
    s_cbranch_scc1 L_walkB1
    s_cmp_eq_u32 s3, 2
    s_cbranch_scc1 L_walkB2
    s_branch L_walkB3
L_walked:
    s_mov_b64 exec, -1
    s_waitcnt lgkmcnt(0)
    s_add_u32 s68, s61, 0x9e3779b9
    s_barrier
    ds_read_b128 v[40:43], v2 offset:0
    ds_read_b128 v[44:47], v2 offset:2048
    ds_read_b128 v[48:51], v2 offset:4096
    ds_read_b128 v[52:55], v2 offset:6144
    ds_read_b64_tr_b16 v[56:57], v4 offset:0
    ds_read_b64_tr_b16 v[58:59], v4 offset:512
    ds_read_b64_tr_b16 v[60:61], v5 offset:0
    ds_read_b64_tr_b16 v[62:63], v5 offset:512
    ds_read_b64_tr_b16 v[64:65], v4 offset:8192
    ds_read_b64_tr_b16 v[66:67], v4 offset:8704
    ds_read_b64_tr_b16 v[68:69], v5 offset:8192
    ds_read_b64_tr_b16 v[70:71], v5 offset:8704
    ds_read_b64_tr_b16 v[72:73], v4 offset:16384
    ds_read_b64_tr_b16 v[74:75], v4 offset:16896
    ds_read_b64_tr_b16 v[76:77], v5 offset:16384
    ds_read_b64_tr_b16 v[78:79], v5 offset:16896
L_cloop:
    s_waitcnt lgkmcnt(0)
    v_mfma_f32_16x16x32_bf16 v[128:131], v[56:59], v[40:43], v[128:131]
    ds_read_b128 v[80:83], v3 offset:0
    v_mfma_f32_16x16x32_bf16 v[144:147], v[60:63], v[40:43], v[144:147]
    ds_read_b128 v[84:87], v3 offset:2048
    v_mfma_f32_16x16x32_bf16 v[148:151], v[60:63], v[44:47], v[148:151]
    ds_read_b128 v[88:91], v3 offset:4096
    v_mfma_f32_16x16x32_bf16 v[132:135], v[56:59], v[44:47], v[132:135]
    ds_read_b128 v[92:95], v3 offset:6144
    v_mfma_f32_16x16x32_bf16 v[136:139], v[56:59], v[48:51], v[136:139]
    ds_read_b64_tr_b16 v[96:97], v4 offset:4096
    v_mfma_f32_16x16x32_bf16 v[152:155], v[60:63], v[48:51], v[152:155]
    ds_read_b64_tr_b16 v[98:99], v4 offset:4608
    v_mfma_f32_16x16x32_bf16 v[156:159], v[60:63], v[52:55], v[156:159]
    ds_read_b64_tr_b16 v[100:101], v5 offset:4096
    v_mfma_f32_16x16x32_bf16 v[140:143], v[56:59], v[52:55], v[140:143]
    ds_read_b64_tr_b16 v[102:103], v5 offset:4608
    v_mfma_f32_16x16x32_bf16 v[172:175], v[52:55], v[64:67], v[172:175]
    ds_read_b64_tr_b16 v[104:105], v4 offset:12288
    v_mfma_f32_16x16x32_bf16 v[188:191], v[52:55], v[68:71], v[188:191]
    ds_read_b64_tr_b16 v[106:107], v4 offset:12800
    v_mfma_f32_16x16x32_bf16 v[184:187], v[48:51], v[68:71], v[184:187]
    ds_read_b64_tr_b16 v[108:109], v5 offset:12288
    v_mfma_f32_16x16x32_bf16 v[168:171], v[48:51], v[64:67], v[168:171]
    ds_read_b64_tr_b16 v[110:111], v5 offset:12800
    v_mfma_f32_16x16x32_bf16 v[164:167], v[44:47], v[64:67], v[164:167]
    ds_read_b64_tr_b16 v[112:113], v4 offset:20480
    v_mfma_f32_16x16x32_bf16 v[180:183], v[44:47], v[68:71], v[180:183]
    ds_read_b64_tr_b16 v[114:115], v4 offset:20992
    v_mfma_f32_16x16x32_bf16 v[176:179], v[40:43], v[68:71], v[176:179]
    ds_read_b64_tr_b16 v[116:117], v5 offset:20480
    v_mfma_f32_16x16x32_bf16 v[160:163], v[40:43], v[64:67], v[160:163]
    ds_read_b64_tr_b16 v[118:119], v5 offset:20992
    v_mfma_f32_16x16x32_bf16 v[192:195], v[40:43], v[72:75], v[192:195]
    s_add_u32 s63, s63, 1
    s_cmp_eq_u32 s63, 4
    s_cselect_b32 s53, 4294803456, 0
    s_cselect_b32 s63, 0, s63
    s_add_u32 s53, s53, 40960
    v_mfma_f32_16x16x32_bf16 v[208:211], v[40:43], v[76:79], v[208:211]
    v_add_u32 v2, s53, v2
    v_mfma_f32_16x16x32_bf16 v[212:215], v[44:47], v[76:79], v[212:215]
    v_add_u32 v4, s53, v4
    v_mfma_f32_16x16x32_bf16 v[196:199], v[44:47], v[72:75], v[196:199]
    v_add_u32 v5, s53, v5
    v_mfma_f32_16x16x32_bf16 v[200:203], v[48:51], v[72:75], v[200:203]
    v_add_u32 v3, s53, v3
    v_mfma_f32_16x16x32_bf16 v[216:219], v[48:51], v[76:79], v[216:219]
    s_cmp_ge_u32 s62, 6
    s_cbranch_scc1 L_cl_none
    buffer_store_dwordx4 v[8:11], v6, s[16:19], 0 offen sc1
    v_add_u32 v6, 1024, v6
    s_cmp_lt_u32 s62, 3
    s_cbranch_scc1 L_cl_none
    v_mov_b32 v6, v16
    v_mov_b32 v16, v17
L_cl_none:
    v_mfma_f32_16x16x32_bf16 v[220:223], v[52:55], v[76:79], v[220:223]
    v_mfma_f32_16x16x32_bf16 v[204:207], v[52:55], v[72:75], v[204:207]
    s_waitcnt lgkmcnt(0)
    v_mfma_f32_16x16x32_bf16 v[128:131], v[96:99], v[80:83], v[128:131]
L_walkB2:
    s_cbranch_execz L_walk_6
    s_barrier
    ds_read_b128 v[40:43], v2 offset:0
    v_mfma_f32_16x16x32_bf16 v[144:147], v[100:103], v[80:83], v[144:147]
    ds_read_b128 v[44:47], v2 offset:2048
    v_mfma_f32_16x16x32_bf16 v[148:151], v[100:103], v[84:87], v[148:151]
    ds_read_b128 v[48:51], v2 offset:4096
    v_mfma_f32_16x16x32_bf16 v[132:135], v[96:99], v[84:87], v[132:135]
    ds_read_b128 v[52:55], v2 offset:6144
    v_mfma_f32_16x16x32_bf16 v[136:139], v[96:99], v[88:91], v[136:139]
    ds_read_b64_tr_b16 v[56:57], v4 offset:0
    v_mfma_f32_16x16x32_bf16 v[152:155], v[100:103], v[88:91], v[152:155]
    ds_read_b64_tr_b16 v[58:59], v4 offset:512
    v_mfma_f32_16x16x32_bf16 v[156:159], v[100:103], v[92:95], v[156:159]
    ds_read_b64_tr_b16 v[60:61], v5 offset:0
    v_mfma_f32_16x16x32_bf16 v[140:143], v[96:99], v[92:95], v[140:143]
    ds_read_b64_tr_b16 v[62:63], v5 offset:512
    v_mfma_f32_16x16x32_bf16 v[172:175], v[92:95], v[104:107], v[172:175]
    ds_read_b64_tr_b16 v[64:65], v4 offset:8192
    v_mfma_f32_16x16x32_bf16 v[188:191], v[92:95], v[108:111], v[188:191]
    ds_read_b64_tr_b16 v[66:67], v4 offset:8704
    v_mfma_f32_16x16x32_bf16 v[184:187], v[88:91], v[108:111], v[184:187]
    ds_read_b64_tr_b16 v[68:69], v5 offset:8192
    v_mfma_f32_16x16x32_bf16 v[168:171], v[88:91], v[104:107], v[168:171]
    ds_read_b64_tr_b16 v[70:71], v5 offset:8704
    v_mfma_f32_16x16x32_bf16 v[164:167], v[84:87], v[104:107], v[164:167]
    ds_read_b64_tr_b16 v[72:73], v4 offset:16384
    v_mfma_f32_16x16x32_bf16 v[180:183], v[84:87], v[108:111], v[180:183]
    ds_read_b64_tr_b16 v[74:75], v4 offset:16896
    v_mfma_f32_16x16x32_bf16 v[176:179], v[80:83], v[108:111], v[176:179]
    ds_read_b64_tr_b16 v[76:77], v5 offset:16384
    v_mfma_f32_16x16x32_bf16 v[160:163], v[80:83], v[104:107], v[160:163]
    ds_read_b64_tr_b16 v[78:79], v5 offset:16896
    v_mfma_f32_16x16x32_bf16 v[192:195], v[80:83], v[112:115], v[192:195]
    v_mfma_f32_16x16x32_bf16 v[208:211], v[80:83], v[116:119], v[208:211]
    s_cmp_lg_u32 s62, 7
    s_cbranch_scc1 L_cl_nw
    s_waitcnt vmcnt(0)
L_cl_nw:
    v_mfma_f32_16x16x32_bf16 v[212:215], v[84:87], v[116:119], v[212:215]
    v_mfma_f32_16x16x32_bf16 v[196:199], v[84:87], v[112:115], v[196:199]
    v_mfma_f32_16x16x32_bf16 v[200:203], v[88:91], v[112:115], v[200:203]
    s_add_u32 s62, s62, 1
    v_mfma_f32_16x16x32_bf16 v[216:219], v[88:91], v[116:119], v[216:219]
    v_mfma_f32_16x16x32_bf16 v[220:223], v[92:95], v[116:119], v[220:223]
    v_mfma_f32_16x16x32_bf16 v[204:207], v[92:95], v[112:115], v[204:207]
    s_cmp_lt_u32 s62, 15
    s_cbranch_scc1 L_cloop
    s_waitcnt lgkmcnt(0)
    v_mfma_f32_16x16x32_bf16 v[160:163], v[40:43], v[64:67], v[160:163]
    ds_read_b128 v[80:83], v3 offset:0
    v_mfma_f32_16x16x32_bf16 v[176:179], v[40:43], v[68:71], v[176:179]
    ds_read_b128 v[84:87], v3 offset:2048
    v_mfma_f32_16x16x32_bf16 v[180:183], v[44:47], v[68:71], v[180:183]
    ds_read_b128 v[88:91], v3 offset:4096
    v_mfma_f32_16x16x32_bf16 v[164:167], v[44:47], v[64:67], v[164:167]
    ds_read_b128 v[92:95], v3 offset:6144
    v_mfma_f32_16x16x32_bf16 v[168:171], v[48:51], v[64:67], v[168:171]
    ds_read_b64_tr_b16 v[104:105], v4 offset:12288
    v_mfma_f32_16x16x32_bf16 v[184:187], v[48:51], v[68:71], v[184:187]
    ds_read_b64_tr_b16 v[106:107], v4 offset:12800
    v_mfma_f32_16x16x32_bf16 v[188:191], v[52:55], v[68:71], v[188:191]
    ds_read_b64_tr_b16 v[108:109], v5 offset:12288
    v_mfma_f32_16x16x32_bf16 v[172:175], v[52:55], v[64:67], v[172:175]
    ds_read_b64_tr_b16 v[110:111], v5 offset:12800
    v_mfma_f32_16x16x32_bf16 v[204:207], v[52:55], v[72:75], v[204:207]
    ds_read_b64_tr_b16 v[112:113], v4 offset:20480
    v_mfma_f32_16x16x32_bf16 v[220:223], v[52:55], v[76:79], v[220:223]
    ds_read_b64_tr_b16 v[114:115], v4 offset:20992
    v_lshrrev_b32 v21, 4, v0
    v_and_b32 v22, 15, v0
    v_mfma_f32_16x16x32_bf16 v[216:219], v[48:51], v[76:79], v[216:219]
    ds_read_b64_tr_b16 v[116:117], v5 offset:20480
    s_lshl_b32 s86, s49, 8
    s_add_u32 s86, s86, 131072
    v_lshl_add_u32 v6, v21, 4, s86
    v_mfma_f32_16x16x32_bf16 v[200:203], v[48:51], v[72:75], v[200:203]
    ds_read_b64_tr_b16 v[118:119], v5 offset:20992
    v_lshl_add_u32 v7, v22, 2, s86
    v_mfma_f32_16x16x32_bf16 v[196:199], v[44:47], v[72:75], v[196:199]
    ds_read_b64_tr_b16 v[96:97], v4 offset:4096
    s_lshl_b32 s86, s50, 7
    s_add_u32 s86, s86, 132608
    v_lshl_add_u32 v8, v22, 2, s86
    v_mfma_f32_16x16x32_bf16 v[212:215], v[44:47], v[76:79], v[212:215]
    ds_read_b64_tr_b16 v[98:99], v4 offset:4608
    v_lshl_add_u32 v9, v21, 4, s86
    v_mfma_f32_16x16x32_bf16 v[208:211], v[40:43], v[76:79], v[208:211]
    ds_read_b64_tr_b16 v[100:101], v5 offset:4096
    s_lshl_b32 s86, s3, 2
    s_add_u32 s86, s86, 135168
    v_mov_b32 v12, s86
    v_mfma_f32_16x16x32_bf16 v[192:195], v[40:43], v[72:75], v[192:195]
    ds_read_b64_tr_b16 v[102:103], v5 offset:4608
    v_xor_b32 v13, 4, v12
    v_mov_b32 v17, s68
    s_waitcnt lgkmcnt(8)
    v_mfma_f32_16x16x32_bf16 v[160:163], v[80:83], v[104:107], v[160:163]
    v_mfma_f32_16x16x32_bf16 v[176:179], v[80:83], v[108:111], v[176:179]
    v_mfma_f32_16x16x32_bf16 v[180:183], v[84:87], v[108:111], v[180:183]
    v_mfma_f32_16x16x32_bf16 v[164:167], v[84:87], v[104:107], v[164:167]
    v_mfma_f32_16x16x32_bf16 v[168:171], v[88:91], v[104:107], v[168:171]
    s_waitcnt lgkmcnt(0)
    s_barrier
    ds_read_b128 v[64:67], v6 offset:0
    ds_read_b128 v[68:71], v6 offset:64
    v_mfma_f32_16x16x32_bf16 v[184:187], v[88:91], v[108:111], v[184:187]
    ds_read_b128 v[72:75], v6 offset:128
    ds_read_b128 v[76:79], v6 offset:192
    v_mfma_f32_16x16x32_bf16 v[188:191], v[92:95], v[108:111], v[188:191]
    ds_read_b32 v28, v8 offset:256
    ds_read_b32 v29, v8 offset:320
    v_mfma_f32_16x16x32_bf16 v[172:175], v[92:95], v[104:107], v[172:175]
    ds_read_b32 v30, v8 offset:512
    ds_read_b32 v31, v8 offset:576
    v_mfma_f32_16x16x32_bf16 v[204:207], v[92:95], v[112:115], v[204:207]
    ds_read_b128 v[224:227], v6 offset:512
    ds_read_b128 v[228:231], v6 offset:576
    v_mfma_f32_16x16x32_bf16 v[220:223], v[92:95], v[116:119], v[220:223]
    ds_read_b128 v[232:235], v6 offset:640
    ds_read_b128 v[236:239], v6 offset:704
    v_mfma_f32_16x16x32_bf16 v[216:219], v[88:91], v[116:119], v[216:219]
    ds_read_b128 v[240:243], v6 offset:1024
    ds_read_b128 v[244:247], v6 offset:1088
    v_mfma_f32_16x16x32_bf16 v[200:203], v[88:91], v[112:115], v[200:203]
    ds_read_b128 v[248:251], v6 offset:1152
    ds_read_b128 v[252:255], v6 offset:1216
    v_mfma_f32_16x16x32_bf16 v[196:199], v[84:87], v[112:115], v[196:199]
    ds_read_b128 v[32:35], v9 offset:0
    ds_read_b128 v[36:39], v9 offset:64
    v_mfma_f32_16x16x32_bf16 v[212:215], v[84:87], v[116:119], v[212:215]
    v_mfma_f32_16x16x32_bf16 v[208:211], v[80:83], v[116:119], v[208:211]
    v_mfma_f32_16x16x32_bf16 v[192:195], v[80:83], v[112:115], v[192:195]
    ds_read_b32 v104, v7 offset:0
    ds_read_b32 v124, v7 offset:1024
    ds_read_b32 v105, v7 offset:64
    ds_read_b32 v125, v7 offset:1088
    ds_read_b32 v106, v7 offset:128
    ds_read_b32 v126, v7 offset:1152
    ds_read_b32 v107, v7 offset:192
    ds_read_b32 v127, v7 offset:1216
    s_waitcnt lgkmcnt(8)
    v_pk_fma_f32 v[160:161], v[64:65], v[28:29], v[160:161] op_sel_hi:[1,0,1]
    v_pk_fma_f32 v[162:163], v[66:67], v[28:29], v[162:163] op_sel_hi:[1,0,1]
    v_pk_mul_f32 v[160:161], v[160:161], v[240:241]
    v_pk_mul_f32 v[162:163], v[162:163], v[242:243]
L_walkB3:
    s_cbranch_execz L_walk_7
    v_exp_f32 v112, v160 clamp
    v_exp_f32 v114, v162 clamp
    v_exp_f32 v113, v161 clamp
    v_exp_f32 v115, v163 clamp
    v_max_f32 v160, s6, v160
    v_max_f32 v162, s6, v162
    v_max_f32 v161, s6, v161
    v_max_f32 v163, s6, v163
    v_pk_fma_f32 v[160:161], v[160:161], s[4:5], v[112:113]
    v_pk_fma_f32 v[162:163], v[162:163], s[4:5], v[114:115]
    v_cvt_pk_bf16_f32 v160, v160, v161
    v_cvt_pk_bf16_f32 v161, v162, v163
    v_pk_fma_f32 v[164:165], v[68:69], v[28:29], v[164:165] op_sel_hi:[1,0,1]
    v_pk_fma_f32 v[166:167], v[70:71], v[28:29], v[166:167] op_sel_hi:[1,0,1]
    v_pk_mul_f32 v[164:165], v[164:165], v[244:245]
    v_pk_mul_f32 v[166:167], v[166:167], v[246:247]
    v_exp_f32 v116, v164 clamp
    v_exp_f32 v118, v166 clamp
    v_exp_f32 v117, v165 clamp
    v_exp_f32 v119, v167 clamp
    v_max_f32 v164, s6, v164
    v_max_f32 v166, s6, v166
    v_max_f32 v165, s6, v165
    v_max_f32 v167, s6, v167
    v_pk_fma_f32 v[164:165], v[164:165], s[4:5], v[116:117]
    v_pk_fma_f32 v[166:167], v[166:167], s[4:5], v[118:119]
    v_cvt_pk_bf16_f32 v162, v164, v165
    v_cvt_pk_bf16_f32 v163, v166, v167
    v_pk_fma_f32 v[168:169], v[72:73], v[28:29], v[168:169] op_sel_hi:[1,0,1]
    v_pk_fma_f32 v[170:171], v[74:75], v[28:29], v[170:171] op_sel_hi:[1,0,1]
    v_pk_mul_f32 v[168:169], v[168:169], v[248:249]
    v_pk_mul_f32 v[170:171], v[170:171], v[250:251]
    v_exp_f32 v112, v168 clamp
    v_exp_f32 v114, v170 clamp
    v_exp_f32 v113, v169 clamp
    v_exp_f32 v115, v171 clamp
    v_max_f32 v168, s6, v168
    v_max_f32 v170, s6, v170
    v_max_f32 v169, s6, v169
    v_max_f32 v171, s6, v171
    v_pk_fma_f32 v[168:169], v[168:169], s[4:5], v[112:113]
    v_pk_fma_f32 v[170:171], v[170:171], s[4:5], v[114:115]
    v_cvt_pk_bf16_f32 v168, v168, v169
    v_cvt_pk_bf16_f32 v169, v170, v171
    v_pk_fma_f32 v[172:173], v[76:77], v[28:29], v[172:173] op_sel_hi:[1,0,1]
    v_pk_fma_f32 v[174:175], v[78:79], v[28:29], v[174:175] op_sel_hi:[1,0,1]
    v_pk_mul_f32 v[172:173], v[172:173], v[252:253]
    v_pk_mul_f32 v[174:175], v[174:175], v[254:255]
    v_exp_f32 v116, v172 clamp
    v_exp_f32 v118, v174 clamp
    v_exp_f32 v117, v173 clamp
    v_exp_f32 v119, v175 clamp
    v_max_f32 v172, s6, v172
    v_max_f32 v174, s6, v174
    v_max_f32 v173, s6, v173
    v_max_f32 v175, s6, v175
    v_pk_fma_f32 v[172:173], v[172:173], s[4:5], v[116:117]
    v_pk_fma_f32 v[174:175], v[174:175], s[4:5], v[118:119]
    v_cvt_pk_bf16_f32 v170, v172, v173
    v_cvt_pk_bf16_f32 v171, v174, v175
    v_pk_fma_f32 v[176:177], v[64:65], v[28:29], v[176:177] op_sel:[0,1,0] op_sel_hi:[1,1,1]
    v_pk_fma_f32 v[178:179], v[66:67], v[28:29], v[178:179] op_sel:[0,1,0] op_sel_hi:[1,1,1]
    v_pk_mul_f32 v[176:177], v[176:177], v[240:241]
    v_pk_mul_f32 v[178:179], v[178:179], v[242:243]
    v_exp_f32 v112, v176 clamp
    v_exp_f32 v114, v178 clamp
    v_exp_f32 v113, v177 clamp
    v_exp_f32 v115, v179 clamp
    v_max_f32 v176, s6, v176
    v_max_f32 v178, s6, v178
    v_max_f32 v177, s6, v177
    v_max_f32 v179, s6, v179
    v_pk_fma_f32 v[176:177], v[176:177], s[4:5], v[112:113]
    v_pk_fma_f32 v[178:179], v[178:179], s[4:5], v[114:115]
    v_cvt_pk_bf16_f32 v176, v176, v177
    v_cvt_pk_bf16_f32 v177, v178, v179
    v_pk_fma_f32 v[180:181], v[68:69], v[28:29], v[180:181] op_sel:[0,1,0] op_sel_hi:[1,1,1]
    v_pk_fma_f32 v[182:183], v[70:71], v[28:29], v[182:183] op_sel:[0,1,0] op_sel_hi:[1,1,1]
    v_pk_mul_f32 v[180:181], v[180:181], v[244:245]
    v_pk_mul_f32 v[182:183], v[182:183], v[246:247]
    v_exp_f32 v116, v180 clamp
    v_exp_f32 v118, v182 clamp
    v_exp_f32 v117, v181 clamp
    v_exp_f32 v119, v183 clamp
    v_max_f32 v180, s6, v180
    v_max_f32 v182, s6, v182
    v_max_f32 v181, s6, v181
    v_max_f32 v183, s6, v183
    v_pk_fma_f32 v[180:181], v[180:181], s[4:5], v[116:117]
    v_pk_fma_f32 v[182:183], v[182:183], s[4:5], v[118:119]
    v_cvt_pk_bf16_f32 v178, v180, v181
    v_cvt_pk_bf16_f32 v179, v182, v183
    v_pk_fma_f32 v[184:185], v[72:73], v[28:29], v[184:185] op_sel:[0,1,0] op_sel_hi:[1,1,1]
    v_pk_fma_f32 v[186:187], v[74:75], v[28:29], v[186:187] op_sel:[0,1,0] op_sel_hi:[1,1,1]
    v_pk_mul_f32 v[184:185], v[184:185], v[248:249]
    v_pk_mul_f32 v[186:187], v[186:187], v[250:251]
    v_exp_f32 v112, v184 clamp
    v_exp_f32 v114, v186 clamp
    v_exp_f32 v113, v185 clamp
    v_exp_f32 v115, v187 clamp
    v_max_f32 v184, s6, v184
    v_max_f32 v186, s6, v186
    v_max_f32 v185, s6, v185
    v_max_f32 v187, s6, v187
    v_pk_fma_f32 v[184:185], v[184:185], s[4:5], v[112:113]
    v_pk_fma_f32 v[186:187], v[186:187], s[4:5], v[114:115]
    v_cvt_pk_bf16_f32 v184, v184, v185
    v_cvt_pk_bf16_f32 v185, v186, v187
    v_pk_fma_f32 v[188:189], v[76:77], v[28:29], v[188:189] op_sel:[0,1,0] op_sel_hi:[1,1,1]
    v_pk_fma_f32 v[190:191], v[78:79], v[28:29], v[190:191] op_sel:[0,1,0] op_sel_hi:[1,1,1]
    v_pk_mul_f32 v[188:189], v[188:189], v[252:253]
    v_pk_mul_f32 v[190:191], v[190:191], v[254:255]
    v_exp_f32 v116, v188 clamp
    v_exp_f32 v118, v190 clamp
    v_exp_f32 v117, v189 clamp
    v_exp_f32 v119, v191 clamp
    v_max_f32 v188, s6, v188
    v_max_f32 v190, s6, v190
    v_max_f32 v189, s6, v189
    v_max_f32 v191, s6, v191
    v_pk_fma_f32 v[188:189], v[188:189], s[4:5], v[116:117]
    v_pk_fma_f32 v[190:191], v[190:191], s[4:5], v[118:119]
    v_cvt_pk_bf16_f32 v186, v188, v189
    v_cvt_pk_bf16_f32 v187, v190, v191
    v_pk_fma_f32 v[192:193], v[64:65], v[30:31], v[192:193] op_sel_hi:[1,0,1]
    v_pk_mul_f32 v[192:193], v[192:193], v[224:225]
    v_cvt_pk_bf16_f32 v192, v192, v193
    v_pk_fma_f32 v[194:195], v[66:67], v[30:31], v[194:195] op_sel_hi:[1,0,1]
    v_pk_mul_f32 v[194:195], v[194:195], v[226:227]
    v_cvt_pk_bf16_f32 v193, v194, v195
    v_pk_fma_f32 v[196:197], v[68:69], v[30:31], v[196:197] op_sel_hi:[1,0,1]
    v_pk_mul_f32 v[196:197], v[196:197], v[228:229]
    v_cvt_pk_bf16_f32 v194, v196, v197
    v_pk_fma_f32 v[198:199], v[70:71], v[30:31], v[198:199] op_sel_hi:[1,0,1]
    v_pk_mul_f32 v[198:199], v[198:199], v[230:231]
    v_cvt_pk_bf16_f32 v195, v198, v199
    v_pk_fma_f32 v[200:201], v[72:73], v[30:31], v[200:201] op_sel_hi:[1,0,1]
    v_pk_mul_f32 v[200:201], v[200:201], v[232:233]
    v_cvt_pk_bf16_f32 v200, v200, v201
    v_pk_fma_f32 v[202:203], v[74:75], v[30:31], v[202:203] op_sel_hi:[1,0,1]
    v_pk_mul_f32 v[202:203], v[202:203], v[234:235]
    v_cvt_pk_bf16_f32 v201, v202, v203
    v_pk_fma_f32 v[204:205], v[76:77], v[30:31], v[204:205] op_sel_hi:[1,0,1]
    v_pk_mul_f32 v[204:205], v[204:205], v[236:237]
    v_cvt_pk_bf16_f32 v202, v204, v205
    v_pk_fma_f32 v[206:207], v[78:79], v[30:31], v[206:207] op_sel_hi:[1,0,1]
    v_pk_mul_f32 v[206:207], v[206:207], v[238:239]
    v_cvt_pk_bf16_f32 v203, v206, v207
    v_pk_fma_f32 v[208:209], v[64:65], v[30:31], v[208:209] op_sel:[0,1,0] op_sel_hi:[1,1,1]
    v_pk_mul_f32 v[208:209], v[208:209], v[224:225]
    v_cvt_pk_bf16_f32 v208, v208, v209
    v_pk_fma_f32 v[210:211], v[66:67], v[30:31], v[210:211] op_sel:[0,1,0] op_sel_hi:[1,1,1]
L_walk_13:
    s_cbranch_execz L_walked
    v_pk_mul_f32 v[210:211], v[210:211], v[226:227]
    v_cvt_pk_bf16_f32 v209, v210, v211
    v_pk_fma_f32 v[212:213], v[68:69], v[30:31], v[212:213] op_sel:[0,1,0] op_sel_hi:[1,1,1]
    v_pk_mul_f32 v[212:213], v[212:213], v[228:229]
    v_cvt_pk_bf16_f32 v210, v212, v213
    v_pk_fma_f32 v[214:215], v[70:71], v[30:31], v[214:215] op_sel:[0,1,0] op_sel_hi:[1,1,1]
    v_pk_mul_f32 v[214:215], v[214:215], v[230:231]
    v_cvt_pk_bf16_f32 v211, v214, v215
    v_pk_fma_f32 v[216:217], v[72:73], v[30:31], v[216:217] op_sel:[0,1,0] op_sel_hi:[1,1,1]
    v_pk_mul_f32 v[216:217], v[216:217], v[232:233]
    v_cvt_pk_bf16_f32 v216, v216, v217
    v_pk_fma_f32 v[218:219], v[74:75], v[30:31], v[218:219] op_sel:[0,1,0] op_sel_hi:[1,1,1]
    v_pk_mul_f32 v[218:219], v[218:219], v[234:235]
    v_cvt_pk_bf16_f32 v217, v218, v219
    v_pk_fma_f32 v[220:221], v[76:77], v[30:31], v[220:221] op_sel:[0,1,0] op_sel_hi:[1,1,1]
    v_pk_mul_f32 v[220:221], v[220:221], v[236:237]
    v_cvt_pk_bf16_f32 v218, v220, v221
    v_pk_fma_f32 v[222:223], v[78:79], v[30:31], v[222:223] op_sel:[0,1,0] op_sel_hi:[1,1,1]
    v_pk_mul_f32 v[222:223], v[222:223], v[238:239]
    v_cvt_pk_bf16_f32 v219, v222, v223
    s_cmp_eq_u32 s49, 1
    s_cbranch_scc1 L_kv1
    v_mfma_f32_16x16x32_bf16 v[236:239], v[160:163], v[208:211], 0
    v_mfma_f32_16x16x32_bf16 v[240:243], v[176:179], v[208:211], 0
    v_mfma_f32_16x16x32_bf16 v[244:247], v[176:179], v[120:123], 0
    v_mfma_f32_16x16x32_bf16 v[224:227], v[160:163], v[192:195], 0
    v_mfma_f32_16x16x32_bf16 v[228:231], v[176:179], v[192:195], 0
    v_mfma_f32_16x16x32_bf16 v[232:235], v[160:163], v[120:123], 0
    v_mfma_f32_16x16x32_bf16 v[236:239], v[168:171], v[216:219], v[236:239]
    v_mfma_f32_16x16x32_bf16 v[240:243], v[184:187], v[216:219], v[240:243]
    v_mfma_f32_16x16x32_bf16 v[244:247], v[184:187], v[120:123], v[244:247]
    v_mfma_f32_16x16x32_bf16 v[224:227], v[168:171], v[200:203], v[224:227]
    v_mfma_f32_16x16x32_bf16 v[228:231], v[184:187], v[200:203], v[228:231]
    v_mfma_f32_16x16x32_bf16 v[232:235], v[168:171], v[120:123], v[232:235]
    s_branch L_kvd
L_kv1:
    v_mfma_f32_16x16x32_bf16 v[236:239], v[160:163], v[192:195], 0
    v_mfma_f32_16x16x32_bf16 v[240:243], v[176:179], v[192:195], 0
    v_mfma_f32_16x16x32_bf16 v[244:247], v[160:163], v[120:123], 0
    v_mfma_f32_16x16x32_bf16 v[224:227], v[160:163], v[208:211], 0
    v_mfma_f32_16x16x32_bf16 v[228:231], v[176:179], v[208:211], 0
    v_mfma_f32_16x16x32_bf16 v[232:235], v[176:179], v[120:123], 0
    v_mfma_f32_16x16x32_bf16 v[236:239], v[168:171], v[200:203], v[236:239]
    v_mfma_f32_16x16x32_bf16 v[240:243], v[184:187], v[200:203], v[240:243]
    v_mfma_f32_16x16x32_bf16 v[244:247], v[168:171], v[120:123], v[244:247]
    v_mfma_f32_16x16x32_bf16 v[224:227], v[168:171], v[216:219], v[224:227]
    v_mfma_f32_16x16x32_bf16 v[228:231], v[184:187], v[216:219], v[228:231]
    v_mfma_f32_16x16x32_bf16 v[232:235], v[184:187], v[120:123], v[232:235]
L_kvd:
    s_nop 2
    ds_write_b128 v24, v[236:239] offset:0
    ds_write_b128 v24, v[240:243] offset:1024
    ds_write_b128 v24, v[244:247] offset:2048
    ds_write_b32 v12, v12
L_xkv:
    ds_read_b32 v14, v13
    ds_read_b128 v[236:239], v25 offset:0
    ds_read_b128 v[240:243], v25 offset:1024
    ds_read_b128 v[244:247], v25 offset:2048
    s_waitcnt lgkmcnt(0)
    v_cmp_eq_u32 vcc, 0, v14
    s_cbranch_vccz L_ok_2
    s_sub_u32 s56, s56, 1
    s_cbranch_scc0 L_xkv
    s_mov_b32 s56, 0
L_ok_2:
    v_pk_add_f32 v[224:225], v[224:225], v[236:237]
    v_pk_add_f32 v[226:227], v[226:227], v[238:239]
    v_pk_add_f32 v[228:229], v[228:229], v[240:241]
    v_pk_add_f32 v[230:231], v[230:231], v[242:243]
    v_pk_add_f32 v[232:233], v[232:233], v[244:245]
    v_pk_add_f32 v[234:235], v[234:235], v[246:247]
    v_cvt_pk_bf16_f32 v248, v224, v225
    v_cvt_pk_bf16_f32 v249, v226, v227
    v_cvt_pk_bf16_f32 v250, v228, v229
    v_cvt_pk_bf16_f32 v251, v230, v231
    buffer_store_dwordx4 v[248:251], v26, s[16:19], 0 offen sc1
    buffer_store_dwordx4 v[232:235], v27, s[16:19], 0 offen sc1
    buffer_atomic_swap v17, v19, s[16:19], 0 offen sc1
    v_mfma_f32_16x16x32_bf16 v[128:131], v[56:59], v[40:43], v[128:131]
    v_mfma_f32_16x16x32_bf16 v[144:147], v[60:63], v[40:43], v[144:147]
    v_mfma_f32_16x16x32_bf16 v[148:151], v[60:63], v[44:47], v[148:151]
    v_mfma_f32_16x16x32_bf16 v[132:135], v[56:59], v[44:47], v[132:135]
    v_mfma_f32_16x16x32_bf16 v[136:139], v[56:59], v[48:51], v[136:139]
    v_mfma_f32_16x16x32_bf16 v[152:155], v[60:63], v[48:51], v[152:155]
    v_mfma_f32_16x16x32_bf16 v[156:159], v[60:63], v[52:55], v[156:159]
    v_mfma_f32_16x16x32_bf16 v[140:143], v[56:59], v[52:55], v[140:143]
    v_mfma_f32_16x16x32_bf16 v[128:131], v[96:99], v[80:83], v[128:131]
    v_mfma_f32_16x16x32_bf16 v[144:147], v[100:103], v[80:83], v[144:147]
    v_mfma_f32_16x16x32_bf16 v[148:151], v[100:103], v[84:87], v[148:151]
    v_mfma_f32_16x16x32_bf16 v[132:135], v[96:99], v[84:87], v[132:135]
    v_mfma_f32_16x16x32_bf16 v[136:139], v[96:99], v[88:91], v[136:139]
    v_mfma_f32_16x16x32_bf16 v[152:155], v[100:103], v[88:91], v[152:155]
    v_mfma_f32_16x16x32_bf16 v[156:159], v[100:103], v[92:95], v[156:159]
    v_mfma_f32_16x16x32_bf16 v[140:143], v[96:99], v[92:95], v[140:143]
    s_nop 0
    v_pk_fma_f32 v[128:129], v[32:33], v[104:105], v[128:129] op_sel_hi:[1,0,1]
    v_pk_fma_f32 v[130:131], v[34:35], v[104:105], v[130:131] op_sel_hi:[1,0,1]
    v_pk_mul_f32 v[128:129], v[128:129], v[124:125] op_sel_hi:[1,0]
    v_pk_mul_f32 v[130:131], v[130:131], v[124:125] op_sel_hi:[1,0]
    v_exp_f32 v112, v128 clamp
    v_exp_f32 v114, v130 clamp
    v_exp_f32 v113, v129 clamp
    v_exp_f32 v115, v131 clamp
    v_max_f32 v128, s6, v128
    v_max_f32 v130, s6, v130
    v_max_f32 v129, s6, v129
    v_max_f32 v131, s6, v131
    v_pk_fma_f32 v[128:129], v[128:129], s[4:5], v[112:113]
    v_pk_fma_f32 v[130:131], v[130:131], s[4:5], v[114:115]
    v_cvt_pk_bf16_f32 v192, v128, v129
    v_cvt_pk_bf16_f32 v193, v130, v131
    v_pk_fma_f32 v[144:145], v[36:37], v[104:105], v[144:145] op_sel_hi:[1,0,1]
    v_pk_fma_f32 v[146:147], v[38:39], v[104:105], v[146:147] op_sel_hi:[1,0,1]
    v_pk_mul_f32 v[144:145], v[144:145], v[124:125] op_sel_hi:[1,0]
    v_pk_mul_f32 v[146:147], v[146:147], v[124:125] op_sel_hi:[1,0]
    v_exp_f32 v116, v144 clamp
    v_exp_f32 v118, v146 clamp
    v_exp_f32 v117, v145 clamp
    v_exp_f32 v119, v147 clamp
    v_max_f32 v144, s6, v144
    v_max_f32 v146, s6, v146
    v_max_f32 v145, s6, v145
    v_max_f32 v147, s6, v147
    v_pk_fma_f32 v[144:145], v[144:145], s[4:5], v[116:117]
    v_pk_fma_f32 v[146:147], v[146:147], s[4:5], v[118:119]
    v_cvt_pk_bf16_f32 v194, v144, v145
    v_cvt_pk_bf16_f32 v195, v146, v147
    v_pk_fma_f32 v[132:133], v[32:33], v[104:105], v[132:133] op_sel:[0,1,0] op_sel_hi:[1,1,1]
    v_pk_fma_f32 v[134:135], v[34:35], v[104:105], v[134:135] op_sel:[0,1,0] op_sel_hi:[1,1,1]
    v_pk_mul_f32 v[132:133], v[132:133], v[124:125] op_sel:[0,1] op_sel_hi:[1,1]
    v_pk_mul_f32 v[134:135], v[134:135], v[124:125] op_sel:[0,1] op_sel_hi:[1,1]
    v_exp_f32 v112, v132 clamp
    v_exp_f32 v114, v134 clamp
    v_exp_f32 v113, v133 clamp
    v_exp_f32 v115, v135 clamp
    v_max_f32 v132, s6, v132
    v_max_f32 v134, s6, v134
    v_max_f32 v133, s6, v133
    v_max_f32 v135, s6, v135
    v_pk_fma_f32 v[132:133], v[132:133], s[4:5], v[112:113]
    v_pk_fma_f32 v[134:135], v[134:135], s[4:5], v[114:115]
    v_cvt_pk_bf16_f32 v196, v132, v133
    v_cvt_pk_bf16_f32 v197, v134, v135
    v_pk_fma_f32 v[148:149], v[36:37], v[104:105], v[148:149] op_sel:[0,1,0] op_sel_hi:[1,1,1]
    v_pk_fma_f32 v[150:151], v[38:39], v[104:105], v[150:151] op_sel:[0,1,0] op_sel_hi:[1,1,1]
    v_pk_mul_f32 v[148:149], v[148:149], v[124:125] op_sel:[0,1] op_sel_hi:[1,1]
    v_pk_mul_f32 v[150:151], v[150:151], v[124:125] op_sel:[0,1] op_sel_hi:[1,1]
    v_exp_f32 v116, v148 clamp
    v_exp_f32 v118, v150 clamp
    v_exp_f32 v117, v149 clamp
L_walk_14:
    s_cbranch_execz L_walked
    v_exp_f32 v119, v151 clamp
    v_max_f32 v148, s6, v148
    v_max_f32 v150, s6, v150
    v_max_f32 v149, s6, v149
    v_max_f32 v151, s6, v151
    v_pk_fma_f32 v[148:149], v[148:149], s[4:5], v[116:117]
    v_pk_fma_f32 v[150:151], v[150:151], s[4:5], v[118:119]
    v_cvt_pk_bf16_f32 v198, v148, v149
    v_cvt_pk_bf16_f32 v199, v150, v151
    v_pk_fma_f32 v[136:137], v[32:33], v[106:107], v[136:137] op_sel_hi:[1,0,1]
    v_pk_fma_f32 v[138:139], v[34:35], v[106:107], v[138:139] op_sel_hi:[1,0,1]
    v_pk_mul_f32 v[136:137], v[136:137], v[126:127] op_sel_hi:[1,0]
    v_pk_mul_f32 v[138:139], v[138:139], v[126:127] op_sel_hi:[1,0]
    v_exp_f32 v112, v136 clamp
    v_exp_f32 v114, v138 clamp
    v_exp_f32 v113, v137 clamp
    v_exp_f32 v115, v139 clamp
    v_max_f32 v136, s6, v136
    v_max_f32 v138, s6, v138
    v_max_f32 v137, s6, v137
    v_max_f32 v139, s6, v139
    v_pk_fma_f32 v[136:137], v[136:137], s[4:5], v[112:113]
    v_pk_fma_f32 v[138:139], v[138:139], s[4:5], v[114:115]
    v_cvt_pk_bf16_f32 v200, v136, v137
    v_cvt_pk_bf16_f32 v201, v138, v139
    v_pk_fma_f32 v[152:153], v[36:37], v[106:107], v[152:153] op_sel_hi:[1,0,1]
    v_pk_fma_f32 v[154:155], v[38:39], v[106:107], v[154:155] op_sel_hi:[1,0,1]
    v_pk_mul_f32 v[152:153], v[152:153], v[126:127] op_sel_hi:[1,0]
    v_pk_mul_f32 v[154:155], v[154:155], v[126:127] op_sel_hi:[1,0]
    v_exp_f32 v116, v152 clamp
    v_exp_f32 v118, v154 clamp
    v_exp_f32 v117, v153 clamp
    v_exp_f32 v119, v155 clamp
    v_max_f32 v152, s6, v152
    v_max_f32 v154, s6, v154
    v_max_f32 v153, s6, v153
    v_max_f32 v155, s6, v155
    v_pk_fma_f32 v[152:153], v[152:153], s[4:5], v[116:117]
    v_pk_fma_f32 v[154:155], v[154:155], s[4:5], v[118:119]
    v_cvt_pk_bf16_f32 v202, v152, v153
    v_cvt_pk_bf16_f32 v203, v154, v155
    v_pk_fma_f32 v[140:141], v[32:33], v[106:107], v[140:141] op_sel:[0,1,0] op_sel_hi:[1,1,1]
    v_pk_fma_f32 v[142:143], v[34:35], v[106:107], v[142:143] op_sel:[0,1,0] op_sel_hi:[1,1,1]
    v_pk_mul_f32 v[140:141], v[140:141], v[126:127] op_sel:[0,1] op_sel_hi:[1,1]
    v_pk_mul_f32 v[142:143], v[142:143], v[126:127] op_sel:[0,1] op_sel_hi:[1,1]
    v_exp_f32 v112, v140 clamp
    v_exp_f32 v114, v142 clamp
    v_exp_f32 v113, v141 clamp
    v_exp_f32 v115, v143 clamp
    v_max_f32 v140, s6, v140
    v_max_f32 v142, s6, v142
    v_max_f32 v141, s6, v141
    v_max_f32 v143, s6, v143
    v_pk_fma_f32 v[140:141], v[140:141], s[4:5], v[112:113]
    v_pk_fma_f32 v[142:143], v[142:143], s[4:5], v[114:115]
    v_cvt_pk_bf16_f32 v204, v140, v141
    v_cvt_pk_bf16_f32 v205, v142, v143
    v_pk_fma_f32 v[156:157], v[36:37], v[106:107], v[156:157] op_sel:[0,1,0] op_sel_hi:[1,1,1]
    v_pk_fma_f32 v[158:159], v[38:39], v[106:107], v[158:159] op_sel:[0,1,0] op_sel_hi:[1,1,1]
    v_pk_mul_f32 v[156:157], v[156:157], v[126:127] op_sel:[0,1] op_sel_hi:[1,1]
    v_pk_mul_f32 v[158:159], v[158:159], v[126:127] op_sel:[0,1] op_sel_hi:[1,1]
    v_exp_f32 v116, v156 clamp
    v_exp_f32 v118, v158 clamp
    v_exp_f32 v117, v157 clamp
    v_exp_f32 v119, v159 clamp
    v_max_f32 v156, s6, v156
    v_max_f32 v158, s6, v158
    v_max_f32 v157, s6, v157
    v_max_f32 v159, s6, v159
    v_pk_fma_f32 v[156:157], v[156:157], s[4:5], v[116:117]
    v_pk_fma_f32 v[158:159], v[158:159], s[4:5], v[118:119]
    v_cvt_pk_bf16_f32 v206, v156, v157
    v_cvt_pk_bf16_f32 v207, v158, v159
    s_lshr_b32 s62, s3, 2
    s_lshl_b32 s53, s51, 3
    s_lshl_b32 s86, s48, 1
    s_add_u32 s53, s53, s86
    s_add_u32 s53, s53, s62
    v_lshrrev_b32 v36, 4, v0
    v_and_b32 v37, 15, v0
    s_lshl_b32 s87, s53, 15
    s_lshl_b32 s86, s62, 14
    s_add_u32 s86, s86, s87
    s_add_u32 s86, s86, 1048576
    v_lshl_add_u32 v157, v0, 4, s86
    v_xor_b32 v158, 0x8000, v157
    s_lshl_b32 s86, s51, 1
    s_lshr_b32 s87, s48, 1
    s_add_u32 s86, s86, s87
    s_lshl_b32 s86, s86, 1
    s_add_u32 s86, s86, s62
    s_lshl_b32 s86, s86, 1
    s_and_b32 s87, s48, 1
    s_add_u32 s86, s86, s87
    s_lshl_b32 s86, s86, 7
    s_add_u32 s86, s86, 688128
    v_lshl_add_u32 v159, v0, 2, s86
    v_mov_b32 v38, 2147483648
    v_cmp_gt_u32 vcc, 16, v0
    s_nop 1
    v_cndmask_b32 v159, v38, v159, vcc
    v_bfe_u32 v38, v0, 2, 2
    v_lshl_add_u32 v38, v36, 2, v38
    v_bfe_u32 v39, v38, 1, 2
    v_lshlrev_b32 v38, 7, v38
    v_lshl_add_u32 v38, v39, 5, v38
    v_and_b32 v39, 3, v0
    v_lshl_add_u32 v38, v39, 3, v38
    s_lshl_b32 s86, s62, 16
    s_add_u32 s86, s86, 0
    v_add_u32 v144, s86, v38
    v_xor_b32 v145, 32, v144
    v_xor_b32 v146, 64, v144
    v_xor_b32 v147, 96, v144
    v_cmp_eq_u32 s[4:5], 1, v39
    v_cmp_eq_u32 s[6:7], 2, v39
    v_cmp_eq_u32 s[98:99], 3, v39
    s_lshl_b32 s86, s53, 10
    s_add_u32 s86, s86, 786432
    v_lshl_add_u32 v160, v0, 2, s86
    v_mul_u32_u24 v161, 192, v36
    v_add_u32 v160, v160, v161
    s_mov_b32 s72, 0x00f0000f
    s_mov_b32 s73, 0xf0000f00
    s_mov_b32 s74, 0x0f00f000
    s_mov_b32 s75, 0x0f00f000
    v_lshrrev_b32 v38, 2, v37
    v_lshl_add_u32 v161, v38, 4, v37
    v_lshlrev_b32 v161, 2, v161
    s_lshl_b32 s86, s3, 12
    s_add_u32 s86, s86, 131072
    v_lshl_add_u32 v162, v0, 4, s86
    v_xor_b32 v163, 0x4000, v162
    s_lshl_b32 s86, s52, 7
    v_lshl_add_u32 v36, v36, 3, s86
    s_lshl_b32 s87, s53, 15
    s_add_u32 s87, s87, s86
    s_lshl_b32 s86, s62, 6
    s_add_u32 s87, s87, s86
    v_lshl_add_u32 v39, v37, 11, s87
    v_and_b32 v38, 48, v0
    v_add_u32 v39, v39, v38
    v_xor_b32 v37, 0x8000, v39
    buffer_load_dwordx4 v[136:139], v39, s[8:11], 0 offen
    buffer_load_dwordx4 v[140:143], v37, s[8:11], 0 offen
    buffer_load_dwordx2 v[148:149], v36, s[40:43], 0 offen offset:0
    buffer_load_dwordx2 v[150:151], v36, s[40:43], 0 offen offset:32
    buffer_load_dwordx2 v[152:153], v36, s[40:43], 0 offen offset:64
    buffer_load_dwordx2 v[154:155], v36, s[40:43], 0 offen offset:96
    s_barrier
    ds_read_b128 v[40:43], v20 offset:0
    ds_read_b128 v[44:47], v20 offset:1024
    ds_read_b128 v[48:51], v20 offset:2048
    v_mov_b32 v38, 135200
    ds_read_b32 v38, v38
    s_mov_b32 s86, 0x8000
    s_mov_b32 s87, 0x10000
    s_mov_b32 s88, 0x18000
    s_waitcnt lgkmcnt(0)
    v_mfma_f32_16x16x32_bf16 v[216:219], v[48:51], v[192:195], 0
    v_mfma_f32_16x16x32_bf16 v[208:211], v[40:43], v[192:195], 0
    v_mfma_f32_16x16x32_bf16 v[212:215], v[44:47], v[192:195], 0
    v_mfma_f32_16x16x32_bf16 v[228:231], v[48:51], v[196:199], 0
    v_mfma_f32_16x16x32_bf16 v[220:223], v[40:43], v[196:199], 0
    v_mfma_f32_16x16x32_bf16 v[224:227], v[44:47], v[196:199], 0
    v_mfma_f32_16x16x32_bf16 v[240:243], v[48:51], v[200:203], 0
    v_mfma_f32_16x16x32_bf16 v[232:235], v[40:43], v[200:203], 0
L_walkB4:
    s_cbranch_execz L_walk_19
    v_mfma_f32_16x16x32_bf16 v[236:239], v[44:47], v[200:203], 0
    v_mfma_f32_16x16x32_bf16 v[252:255], v[48:51], v[204:207], 0
    v_mfma_f32_16x16x32_bf16 v[244:247], v[40:43], v[204:207], 0
    v_mfma_f32_16x16x32_bf16 v[248:251], v[44:47], v[204:207], 0
    v_add_f32 v216, s54, v216
    v_rcp_f32 v216, v216
    s_nop 0
    v_pk_mul_f32 v[208:209], v[208:209], v[216:217] op_sel_hi:[1,0]
    v_pk_mul_f32 v[210:211], v[210:211], v[216:217] op_sel_hi:[1,0]
    v_pk_mul_f32 v[212:213], v[212:213], v[216:217] op_sel_hi:[1,0]
    v_pk_mul_f32 v[214:215], v[214:215], v[216:217] op_sel_hi:[1,0]
    v_cvt_pk_bf16_f32 v60, v208, v209
    v_cvt_pk_bf16_f32 v61, v210, v211
    v_cvt_pk_bf16_f32 v62, v212, v213
    v_cvt_pk_bf16_f32 v63, v214, v215
    buffer_store_dwordx4 v[60:63], v23, s[16:19], 0 offen sc1
    v_add_f32 v228, s54, v228
    v_rcp_f32 v228, v228
    s_nop 0
    v_pk_mul_f32 v[220:221], v[220:221], v[228:229] op_sel_hi:[1,0]
    v_pk_mul_f32 v[222:223], v[222:223], v[228:229] op_sel_hi:[1,0]
    v_pk_mul_f32 v[224:225], v[224:225], v[228:229] op_sel_hi:[1,0]
    v_pk_mul_f32 v[226:227], v[226:227], v[228:229] op_sel_hi:[1,0]
    v_cvt_pk_bf16_f32 v64, v220, v221
    v_cvt_pk_bf16_f32 v65, v222, v223
    v_cvt_pk_bf16_f32 v66, v224, v225
    v_cvt_pk_bf16_f32 v67, v226, v227
    buffer_store_dwordx4 v[64:67], v23, s[16:19], s86 offen sc1
    v_add_f32 v240, s54, v240
    v_rcp_f32 v240, v240
    s_nop 0
    v_pk_mul_f32 v[232:233], v[232:233], v[240:241] op_sel_hi:[1,0]
    v_pk_mul_f32 v[234:235], v[234:235], v[240:241] op_sel_hi:[1,0]
    v_pk_mul_f32 v[236:237], v[236:237], v[240:241] op_sel_hi:[1,0]
    v_pk_mul_f32 v[238:239], v[238:239], v[240:241] op_sel_hi:[1,0]
    v_cvt_pk_bf16_f32 v68, v232, v233
    v_cvt_pk_bf16_f32 v69, v234, v235
    v_cvt_pk_bf16_f32 v70, v236, v237
    v_cvt_pk_bf16_f32 v71, v238, v239
    buffer_store_dwordx4 v[68:71], v23, s[16:19], s87 offen sc1
    v_add_f32 v252, s54, v252
    v_rcp_f32 v252, v252
    s_nop 0
    v_pk_mul_f32 v[244:245], v[244:245], v[252:253] op_sel_hi:[1,0]
    v_pk_mul_f32 v[246:247], v[246:247], v[252:253] op_sel_hi:[1,0]
    v_pk_mul_f32 v[248:249], v[248:249], v[252:253] op_sel_hi:[1,0]
    v_pk_mul_f32 v[250:251], v[250:251], v[252:253] op_sel_hi:[1,0]
    v_cvt_pk_bf16_f32 v72, v244, v245
    v_cvt_pk_bf16_f32 v73, v246, v247
    v_cvt_pk_bf16_f32 v74, v248, v249
    v_cvt_pk_bf16_f32 v75, v250, v251
    buffer_store_dwordx4 v[72:75], v23, s[16:19], s88 offen sc1
    buffer_atomic_swap v17, v18, s[16:19], 0 offen sc1
    v_mov_b32 v8, 0
    buffer_atomic_or v8, v159, s[16:19], 0 offen sc0 sc1
    v_mov_b32 v14, 2147483648
    v_mov_b32 v11, 2147483648
    s_waitcnt vmcnt(6)
    v_bfe_u32 v36, v0, 2, 1
    v_cmp_eq_u32 vcc, 1, v36
    v_mov_b32 v36, s95
    s_nop 0
    v_cndmask_b32 v148, v36, v148, vcc
    v_cndmask_b32 v149, v36, v149, vcc
    v_cndmask_b32 v150, v36, v150, vcc
    v_cndmask_b32 v151, v36, v151, vcc
    v_cndmask_b32 v152, v36, v152, vcc
    v_cndmask_b32 v153, v36, v153, vcc
    v_cndmask_b32 v154, v36, v154, vcc
    v_cndmask_b32 v155, v36, v155, vcc
    v_readfirstlane_b32 s57, v38
L_phaseB:
    v_lshrrev_b32 v1, 4, v0
    v_and_b32 v2, 15, v0
    v_mov_b32 v3, 0x3f80
    s_lshl_b32 s87, s53, 4
    v_add_u32 v6, s87, v2
    s_lshl_b32 s86, s52, 7
    v_lshl_add_u32 v5, v6, 11, s86
    v_sub_u32 v6, 2047, v6
    v_mov_b32 v7, v39
    v_lshrrev_b32 v9, 1, v1
    v_lshl_add_u32 v5, v9, 4, v5
    v_and_b32 v9, 1, v1
    v_lshl_add_u32 v5, v9, 5, v5
    s_mov_b32 s67, 0
    s_mov_b32 s66, 0xffffaaaa
    s_mov_b32 s63, 0
    s_lshl2_add_u32 s86, s3, 163776
    v_mov_b32 v12, s86
    s_cmp_eq_u32 s62, 0
    s_cselect_b64 vcc, -1, 0
    v_cndmask_b32 v12, v12, v162, vcc
    v_mov_b32 v13, 163792
L_b_init:
    v_bfe_u32 v9, v0, 3, 1
    v_bfe_u32 v10, v0, 4, 1
    v_xor_b32 v9, v9, v10
    v_bfe_u32 v10, v0, 1, 2
    v_lshl_add_u32 v9, v9, 3, v10
    v_lshrrev_b32 v10, 5, v0
    v_lshl_add_u32 v9, v10, 2, v9
    v_and_b32 v10, 1, v0
    v_lshlrev_b32 v10, 4, v10
    v_lshlrev_b32 v10, v10, v3
    v_cmp_eq_u32 vcc, 0, v9
    s_nop 1
    v_cndmask_b32 v128, 0, v10, vcc
    v_cmp_eq_u32 vcc, 1, v9
    s_nop 1
    v_cndmask_b32 v129, 0, v10, vcc
    v_cmp_eq_u32 vcc, 2, v9
    s_nop 1
    v_cndmask_b32 v130, 0, v10, vcc
    v_cmp_eq_u32 vcc, 3, v9
    s_nop 1
    v_cndmask_b32 v131, 0, v10, vcc
    v_cmp_eq_u32 vcc, 4, v9
    s_nop 1
    v_cndmask_b32 v132, 0, v10, vcc
    v_cmp_eq_u32 vcc, 5, v9
    s_nop 1
    v_cndmask_b32 v133, 0, v10, vcc
    v_cmp_eq_u32 vcc, 6, v9
    s_nop 1
    v_cndmask_b32 v134, 0, v10, vcc
    v_cmp_eq_u32 vcc, 7, v9
    s_nop 1
    v_cndmask_b32 v135, 0, v10, vcc
    v_mov_b32 v80, 0
    v_mov_b32 v81, 0
    v_mov_b32 v82, 0
    v_mov_b32 v83, 0
    v_mov_b32 v84, 0
    v_mov_b32 v85, 0
    v_mov_b32 v86, 0
    v_mov_b32 v87, 0
    v_mov_b32 v88, 0
    v_mov_b32 v89, 0
    v_mov_b32 v90, 0
    v_mov_b32 v91, 0
    v_mov_b32 v92, 0
    v_mov_b32 v93, 0
    v_mov_b32 v94, 0
    v_mov_b32 v95, 0
    v_mov_b32 v96, 0
    v_mov_b32 v97, 0
    v_mov_b32 v98, 0
    v_mov_b32 v99, 0
    v_mov_b32 v100, 0
    v_mov_b32 v101, 0
    v_mov_b32 v102, 0
    v_mov_b32 v103, 0
    v_mov_b32 v104, 0
    v_mov_b32 v105, 0
    v_mov_b32 v106, 0
    v_mov_b32 v107, 0
    v_mov_b32 v108, 0
    v_mov_b32 v109, 0
    v_mov_b32 v110, 0
    v_mov_b32 v111, 0
    v_mov_b32 v156, 0
    s_branch L_b_w0
L_b_r0:
    s_ff1_i32_b32 s91, s65
    s_bitset0_b32 s65, s91
    s_lshl_b32 s76, s91, 12
    s_lshl_b32 s91, s91, 10
    buffer_load_dwordx4 v[16:19], v157, s[16:19], s91 offen offset:0 sc1
    buffer_load_dwordx4 v[20:23], v158, s[16:19], s91 offen offset:0 sc1
    buffer_load_dwordx4 v[24:27], v157, s[16:19], s91 offen offset:1024 sc1
    buffer_load_dwordx4 v[28:31], v158, s[16:19], s91 offen offset:1024 sc1
    s_cmp_eq_u32 s65, 0
    s_cbranch_scc1 L_b_p1
L_b_r1:
    s_ff1_i32_b32 s91, s65
    s_bitset0_b32 s65, s91
    s_lshl_b32 s77, s91, 12
    s_lshl_b32 s91, s91, 10
    buffer_load_dwordx4 v[32:35], v157, s[16:19], s91 offen offset:0 sc1
    buffer_load_dwordx4 v[36:39], v158, s[16:19], s91 offen offset:0 sc1
    buffer_load_dwordx4 v[40:43], v157, s[16:19], s91 offen offset:1024 sc1
    buffer_load_dwordx4 v[44:47], v158, s[16:19], s91 offen offset:1024 sc1
    s_cmp_le_u32 s62, s63
    s_cbranch_scc1 L_b_wok
L_b_wf:
    ds_read_b128 v[112:115], v13
    s_waitcnt lgkmcnt(0)
    v_min3_u32 v112, v112, v113, v114
    v_min_u32 v112, v112, v115
    v_cmp_eq_u32 vcc, 0, v112
    s_cbranch_vccz L_ok_3
    s_sub_u32 s56, s56, 1
    s_cbranch_scc0 L_b_wf
    s_mov_b32 s56, 0
L_ok_3:
L_b_wok:
    s_xor_b32 s89, s67, s76
    s_mov_b32 s67, s76
    v_xor_b32 v144, s89, v144
    ds_read_b64_tr_b16 v[112:113], v144 offset:0
    ds_read_b64_tr_b16 v[114:115], v144 offset:2048
    v_xor_b32 v145, s89, v145
    ds_read_b64_tr_b16 v[116:117], v145 offset:0
    ds_read_b64_tr_b16 v[118:119], v145 offset:2048
L_walkB5:
    s_cbranch_execz L_walk_20
    v_xor_b32 v146, s89, v146
    ds_read_b64_tr_b16 v[120:121], v146 offset:0
    ds_read_b64_tr_b16 v[122:123], v146 offset:2048
    v_xor_b32 v147, s89, v147
    ds_read_b64_tr_b16 v[124:125], v147 offset:0
    ds_read_b64_tr_b16 v[126:127], v147 offset:2048
    s_cmp_eq_u32 s62, 0
    s_cbranch_scc0 L_b_x1
    v_mfma_f32_16x16x32_bf16 v[80:83], v[128:131], v[136:139], 0
    v_mfma_f32_16x16x32_bf16 v[96:99], v[128:131], v[140:143], 0
    v_mfma_f32_16x16x32_bf16 v[84:87], v[132:135], v[136:139], 0
    v_mfma_f32_16x16x32_bf16 v[100:103], v[132:135], v[140:143], 0
    s_branch L_b_xd
L_b_x1:
    s_setprio 1
    v_mfma_f32_16x16x32_bf16 v[88:91], v[128:131], v[136:139], 0
    v_mfma_f32_16x16x32_bf16 v[104:107], v[128:131], v[140:143], 0
    v_mfma_f32_16x16x32_bf16 v[92:95], v[132:135], v[136:139], 0
    v_mfma_f32_16x16x32_bf16 v[108:111], v[132:135], v[140:143], 0
L_b_xd:
    s_waitcnt vmcnt(6) lgkmcnt(6)
    v_max3_u32 v156, v156, v19, v23
    v_mfma_f32_16x16x32_bf16 v[80:83], v[112:115], v[16:19], v[80:83]
    ds_read_b64_tr_b16 v[128:129], v144 offset:4096
    v_mfma_f32_16x16x32_bf16 v[96:99], v[112:115], v[20:23], v[96:99]
    ds_read_b64_tr_b16 v[130:131], v144 offset:6144
    s_waitcnt lgkmcnt(6)
    v_mfma_f32_16x16x32_bf16 v[84:87], v[116:119], v[16:19], v[84:87]
    ds_read_b64_tr_b16 v[132:133], v145 offset:4096
    v_mfma_f32_16x16x32_bf16 v[100:103], v[116:119], v[20:23], v[100:103]
    ds_read_b64_tr_b16 v[134:135], v145 offset:6144
    s_waitcnt lgkmcnt(6)
    v_mfma_f32_16x16x32_bf16 v[88:91], v[120:123], v[16:19], v[88:91]
    ds_read_b64_tr_b16 v[136:137], v146 offset:4096
    v_mfma_f32_16x16x32_bf16 v[104:107], v[120:123], v[20:23], v[104:107]
    ds_read_b64_tr_b16 v[138:139], v146 offset:6144
    s_waitcnt lgkmcnt(6)
    v_mfma_f32_16x16x32_bf16 v[92:95], v[124:127], v[16:19], v[92:95]
    ds_read_b64_tr_b16 v[140:141], v147 offset:4096
    v_mfma_f32_16x16x32_bf16 v[108:111], v[124:127], v[20:23], v[108:111]
    ds_read_b64_tr_b16 v[142:143], v147 offset:6144
    s_not_b32 s91, s66
    s_cmp_eq_u32 s65, 0
    s_cselect_b32 s65, s91, s65
    s_cselect_b32 s66, -1, s66
    s_ff1_i32_b32 s91, s65
    s_bitset0_b32 s65, s91
    s_lshl_b32 s78, s91, 12
    s_lshl_b32 s91, s91, 10
    buffer_load_dwordx4 v[48:51], v157, s[16:19], s91 offen offset:0 sc1
    buffer_load_dwordx4 v[52:55], v158, s[16:19], s91 offen offset:0 sc1
    s_waitcnt vmcnt(6) lgkmcnt(6)
    v_max3_u32 v156, v156, v27, v31
    v_mfma_f32_16x16x32_bf16 v[80:83], v[128:131], v[24:27], v[80:83]
    s_xor_b32 s89, s67, s77
    s_mov_b32 s67, s77
    v_xor_b32 v144, s89, v144
    ds_read_b64_tr_b16 v[112:113], v144 offset:0
    v_mfma_f32_16x16x32_bf16 v[96:99], v[128:131], v[28:31], v[96:99]
    ds_read_b64_tr_b16 v[114:115], v144 offset:2048
    s_waitcnt lgkmcnt(6)
    v_mfma_f32_16x16x32_bf16 v[84:87], v[132:135], v[24:27], v[84:87]
    v_xor_b32 v145, s89, v145
    ds_read_b64_tr_b16 v[116:117], v145 offset:0
    v_mfma_f32_16x16x32_bf16 v[100:103], v[132:135], v[28:31], v[100:103]
    ds_read_b64_tr_b16 v[118:119], v145 offset:2048
    s_waitcnt lgkmcnt(6)
    v_mfma_f32_16x16x32_bf16 v[88:91], v[136:139], v[24:27], v[88:91]
    v_xor_b32 v146, s89, v146
    ds_read_b64_tr_b16 v[120:121], v146 offset:0
    v_mfma_f32_16x16x32_bf16 v[104:107], v[136:139], v[28:31], v[104:107]
    ds_read_b64_tr_b16 v[122:123], v146 offset:2048
    s_waitcnt lgkmcnt(6)
    v_mfma_f32_16x16x32_bf16 v[92:95], v[140:143], v[24:27], v[92:95]
    v_xor_b32 v147, s89, v147
    ds_read_b64_tr_b16 v[124:125], v147 offset:0
    v_mfma_f32_16x16x32_bf16 v[108:111], v[140:143], v[28:31], v[108:111]
    ds_read_b64_tr_b16 v[126:127], v147 offset:2048
    buffer_load_dwordx4 v[56:59], v157, s[16:19], s91 offen offset:1024 sc1
    buffer_load_dwordx4 v[60:63], v158, s[16:19], s91 offen offset:1024 sc1
    s_waitcnt vmcnt(6) lgkmcnt(6)
    v_max3_u32 v156, v156, v35, v39
    v_mfma_f32_16x16x32_bf16 v[80:83], v[112:115], v[32:35], v[80:83]
    ds_read_b64_tr_b16 v[128:129], v144 offset:4096
    v_mfma_f32_16x16x32_bf16 v[96:99], v[112:115], v[36:39], v[96:99]
    ds_read_b64_tr_b16 v[130:131], v144 offset:6144
    s_waitcnt lgkmcnt(6)
    v_mfma_f32_16x16x32_bf16 v[84:87], v[116:119], v[32:35], v[84:87]
    ds_read_b64_tr_b16 v[132:133], v145 offset:4096
    v_mfma_f32_16x16x32_bf16 v[100:103], v[116:119], v[36:39], v[100:103]
    ds_read_b64_tr_b16 v[134:135], v145 offset:6144
    s_waitcnt lgkmcnt(6)
    v_mfma_f32_16x16x32_bf16 v[88:91], v[120:123], v[32:35], v[88:91]
    ds_read_b64_tr_b16 v[136:137], v146 offset:4096
    v_mfma_f32_16x16x32_bf16 v[104:107], v[120:123], v[36:39], v[104:107]
    ds_read_b64_tr_b16 v[138:139], v146 offset:6144
    s_waitcnt lgkmcnt(6)
    v_mfma_f32_16x16x32_bf16 v[92:95], v[124:127], v[32:35], v[92:95]
    ds_read_b64_tr_b16 v[140:141], v147 offset:4096
    v_mfma_f32_16x16x32_bf16 v[108:111], v[124:127], v[36:39], v[108:111]
    ds_read_b64_tr_b16 v[142:143], v147 offset:6144
    s_not_b32 s91, s66
    s_cmp_eq_u32 s65, 0
    s_cselect_b32 s65, s91, s65
    s_cselect_b32 s66, -1, s66
    s_ff1_i32_b32 s91, s65
    s_bitset0_b32 s65, s91
    s_lshl_b32 s79, s91, 12
    s_lshl_b32 s91, s91, 10
    buffer_load_dwordx4 v[64:67], v157, s[16:19], s91 offen offset:0 sc1
    buffer_load_dwordx4 v[68:71], v158, s[16:19], s91 offen offset:0 sc1
    s_waitcnt vmcnt(6) lgkmcnt(6)
    v_max3_u32 v156, v156, v43, v47
    v_mfma_f32_16x16x32_bf16 v[80:83], v[128:131], v[40:43], v[80:83]
    s_xor_b32 s89, s67, s78
    s_mov_b32 s67, s78
    v_xor_b32 v144, s89, v144
    ds_read_b64_tr_b16 v[112:113], v144 offset:0
    v_mfma_f32_16x16x32_bf16 v[96:99], v[128:131], v[44:47], v[96:99]
    ds_read_b64_tr_b16 v[114:115], v144 offset:2048
    s_waitcnt lgkmcnt(6)
    v_mfma_f32_16x16x32_bf16 v[84:87], v[132:135], v[40:43], v[84:87]
    v_xor_b32 v145, s89, v145
    ds_read_b64_tr_b16 v[116:117], v145 offset:0
    v_mfma_f32_16x16x32_bf16 v[100:103], v[132:135], v[44:47], v[100:103]
    ds_read_b64_tr_b16 v[118:119], v145 offset:2048
    s_waitcnt lgkmcnt(6)
    v_mfma_f32_16x16x32_bf16 v[88:91], v[136:139], v[40:43], v[88:91]
    v_xor_b32 v146, s89, v146
    ds_read_b64_tr_b16 v[120:121], v146 offset:0
    v_mfma_f32_16x16x32_bf16 v[104:107], v[136:139], v[44:47], v[104:107]
    ds_read_b64_tr_b16 v[122:123], v146 offset:2048
    s_waitcnt lgkmcnt(6)
    v_mfma_f32_16x16x32_bf16 v[92:95], v[140:143], v[40:43], v[92:95]
    v_xor_b32 v147, s89, v147
    ds_read_b64_tr_b16 v[124:125], v147 offset:0
    v_mfma_f32_16x16x32_bf16 v[108:111], v[140:143], v[44:47], v[108:111]
    ds_read_b64_tr_b16 v[126:127], v147 offset:2048
    buffer_load_dwordx4 v[72:75], v157, s[16:19], s91 offen offset:1024 sc1
    buffer_load_dwordx4 v[76:79], v158, s[16:19], s91 offen offset:1024 sc1
    s_waitcnt vmcnt(6) lgkmcnt(6)
L_b_c4:
    v_max_u32 v4, v51, v55
    v_cmp_eq_u32 vcc, -1, v4
    s_cbranch_vccnz L_b_g4
L_b_d4:
    v_mfma_f32_16x16x32_bf16 v[80:83], v[112:115], v[48:51], v[80:83]
    ds_read_b64_tr_b16 v[128:129], v144 offset:4096
    v_mfma_f32_16x16x32_bf16 v[96:99], v[112:115], v[52:55], v[96:99]
    ds_read_b64_tr_b16 v[130:131], v144 offset:6144
    s_waitcnt lgkmcnt(6)
    v_mfma_f32_16x16x32_bf16 v[84:87], v[116:119], v[48:51], v[84:87]
    ds_read_b64_tr_b16 v[132:133], v145 offset:4096
    v_mfma_f32_16x16x32_bf16 v[100:103], v[116:119], v[52:55], v[100:103]
    ds_read_b64_tr_b16 v[134:135], v145 offset:6144
    s_waitcnt lgkmcnt(6)
    v_mfma_f32_16x16x32_bf16 v[88:91], v[120:123], v[48:51], v[88:91]
    ds_read_b64_tr_b16 v[136:137], v146 offset:4096
    v_mfma_f32_16x16x32_bf16 v[104:107], v[120:123], v[52:55], v[104:107]
    ds_read_b64_tr_b16 v[138:139], v146 offset:6144
    s_waitcnt lgkmcnt(6)
    v_mfma_f32_16x16x32_bf16 v[92:95], v[124:127], v[48:51], v[92:95]
    ds_read_b64_tr_b16 v[140:141], v147 offset:4096
    v_mfma_f32_16x16x32_bf16 v[108:111], v[124:127], v[52:55], v[108:111]
    ds_read_b64_tr_b16 v[142:143], v147 offset:6144
    s_not_b32 s91, s66
    s_cmp_eq_u32 s65, 0
    s_cselect_b32 s65, s91, s65
    s_cselect_b32 s66, -1, s66
    s_ff1_i32_b32 s91, s65
    s_bitset0_b32 s65, s91
    s_lshl_b32 s76, s91, 12
    s_lshl_b32 s91, s91, 10
    buffer_load_dwordx4 v[16:19], v157, s[16:19], s91 offen offset:0 sc1
    buffer_load_dwordx4 v[20:23], v158, s[16:19], s91 offen offset:0 sc1
L_walkB6:
    s_cbranch_execz L_walk_21
    s_waitcnt vmcnt(6) lgkmcnt(6)
L_b_c5:
    v_max_u32 v4, v59, v63
    v_cmp_eq_u32 vcc, -1, v4
    s_cbranch_vccnz L_b_g5
L_b_d5:
    v_mfma_f32_16x16x32_bf16 v[80:83], v[128:131], v[56:59], v[80:83]
    s_xor_b32 s89, s67, s79
    s_mov_b32 s67, s79
    v_xor_b32 v144, s89, v144
    ds_read_b64_tr_b16 v[112:113], v144 offset:0
    v_mfma_f32_16x16x32_bf16 v[96:99], v[128:131], v[60:63], v[96:99]
    ds_read_b64_tr_b16 v[114:115], v144 offset:2048
    s_waitcnt lgkmcnt(6)
    v_mfma_f32_16x16x32_bf16 v[84:87], v[132:135], v[56:59], v[84:87]
    v_xor_b32 v145, s89, v145
    ds_read_b64_tr_b16 v[116:117], v145 offset:0
    v_mfma_f32_16x16x32_bf16 v[100:103], v[132:135], v[60:63], v[100:103]
    ds_read_b64_tr_b16 v[118:119], v145 offset:2048
    s_waitcnt lgkmcnt(6)
    v_mfma_f32_16x16x32_bf16 v[88:91], v[136:139], v[56:59], v[88:91]
    v_xor_b32 v146, s89, v146
    ds_read_b64_tr_b16 v[120:121], v146 offset:0
    v_mfma_f32_16x16x32_bf16 v[104:107], v[136:139], v[60:63], v[104:107]
    ds_read_b64_tr_b16 v[122:123], v146 offset:2048
    s_waitcnt lgkmcnt(6)
    v_mfma_f32_16x16x32_bf16 v[92:95], v[140:143], v[56:59], v[92:95]
    v_xor_b32 v147, s89, v147
    ds_read_b64_tr_b16 v[124:125], v147 offset:0
    v_mfma_f32_16x16x32_bf16 v[108:111], v[140:143], v[60:63], v[108:111]
    ds_read_b64_tr_b16 v[126:127], v147 offset:2048
    buffer_load_dwordx4 v[24:27], v157, s[16:19], s91 offen offset:1024 sc1
    buffer_load_dwordx4 v[28:31], v158, s[16:19], s91 offen offset:1024 sc1
    s_setprio 0
    s_waitcnt vmcnt(6) lgkmcnt(6)
L_b_c6:
    v_max_u32 v4, v67, v71
    v_cmp_eq_u32 vcc, -1, v4
    s_cbranch_vccnz L_b_g6
L_b_d6:
    v_mfma_f32_16x16x32_bf16 v[80:83], v[112:115], v[64:67], v[80:83]
    ds_read_b64_tr_b16 v[128:129], v144 offset:4096
    v_mfma_f32_16x16x32_bf16 v[96:99], v[112:115], v[68:71], v[96:99]
    ds_read_b64_tr_b16 v[130:131], v144 offset:6144
    s_waitcnt lgkmcnt(6)
    v_mfma_f32_16x16x32_bf16 v[84:87], v[116:119], v[64:67], v[84:87]
    ds_read_b64_tr_b16 v[132:133], v145 offset:4096
    v_mfma_f32_16x16x32_bf16 v[100:103], v[116:119], v[68:71], v[100:103]
    ds_read_b64_tr_b16 v[134:135], v145 offset:6144
    s_waitcnt lgkmcnt(6)
    v_mfma_f32_16x16x32_bf16 v[88:91], v[120:123], v[64:67], v[88:91]
    ds_read_b64_tr_b16 v[136:137], v146 offset:4096
    v_mfma_f32_16x16x32_bf16 v[104:107], v[120:123], v[68:71], v[104:107]
    ds_read_b64_tr_b16 v[138:139], v146 offset:6144
    s_waitcnt lgkmcnt(6)
    v_mfma_f32_16x16x32_bf16 v[92:95], v[124:127], v[64:67], v[92:95]
    ds_read_b64_tr_b16 v[140:141], v147 offset:4096
    v_mfma_f32_16x16x32_bf16 v[108:111], v[124:127], v[68:71], v[108:111]
    ds_read_b64_tr_b16 v[142:143], v147 offset:6144
    s_not_b32 s91, s66
    s_cmp_eq_u32 s65, 0
    s_cselect_b32 s65, s91, s65
    s_cselect_b32 s66, -1, s66
    s_ff1_i32_b32 s91, s65
    s_bitset0_b32 s65, s91
    s_lshl_b32 s77, s91, 12
    s_lshl_b32 s91, s91, 10
    buffer_load_dwordx4 v[32:35], v157, s[16:19], s91 offen offset:0 sc1
    buffer_load_dwordx4 v[36:39], v158, s[16:19], s91 offen offset:0 sc1
    s_waitcnt vmcnt(6) lgkmcnt(6)
L_b_c7:
    v_max_u32 v4, v75, v79
    v_cmp_eq_u32 vcc, -1, v4
    s_cbranch_vccnz L_b_g7
L_b_d7:
    v_mfma_f32_16x16x32_bf16 v[80:83], v[128:131], v[72:75], v[80:83]
    s_xor_b32 s89, s67, s76
    s_mov_b32 s67, s76
    v_xor_b32 v144, s89, v144
    ds_read_b64_tr_b16 v[112:113], v144 offset:0
    v_mfma_f32_16x16x32_bf16 v[96:99], v[128:131], v[76:79], v[96:99]
    ds_read_b64_tr_b16 v[114:115], v144 offset:2048
    s_waitcnt lgkmcnt(6)
    v_mfma_f32_16x16x32_bf16 v[84:87], v[132:135], v[72:75], v[84:87]
    v_xor_b32 v145, s89, v145
    ds_read_b64_tr_b16 v[116:117], v145 offset:0
    v_mfma_f32_16x16x32_bf16 v[100:103], v[132:135], v[76:79], v[100:103]
    ds_read_b64_tr_b16 v[118:119], v145 offset:2048
    s_waitcnt lgkmcnt(6)
    v_mfma_f32_16x16x32_bf16 v[88:91], v[136:139], v[72:75], v[88:91]
    v_xor_b32 v146, s89, v146
    ds_read_b64_tr_b16 v[120:121], v146 offset:0
    v_mfma_f32_16x16x32_bf16 v[104:107], v[136:139], v[76:79], v[104:107]
    ds_read_b64_tr_b16 v[122:123], v146 offset:2048
    s_waitcnt lgkmcnt(6)
    v_mfma_f32_16x16x32_bf16 v[92:95], v[140:143], v[72:75], v[92:95]
    v_xor_b32 v147, s89, v147
    ds_read_b64_tr_b16 v[124:125], v147 offset:0
    v_mfma_f32_16x16x32_bf16 v[108:111], v[140:143], v[76:79], v[108:111]
    ds_read_b64_tr_b16 v[126:127], v147 offset:2048
    buffer_load_dwordx4 v[40:43], v157, s[16:19], s91 offen offset:1024 sc1
    buffer_load_dwordx4 v[44:47], v158, s[16:19], s91 offen offset:1024 sc1
    s_waitcnt vmcnt(6) lgkmcnt(6)
L_b_c8:
    v_max_u32 v4, v19, v23
    v_cmp_eq_u32 vcc, -1, v4
    s_cbranch_vccnz L_b_g8
L_b_d8:
    v_mfma_f32_16x16x32_bf16 v[80:83], v[112:115], v[16:19], v[80:83]
    ds_read_b64_tr_b16 v[128:129], v144 offset:4096
    v_mfma_f32_16x16x32_bf16 v[96:99], v[112:115], v[20:23], v[96:99]
    ds_read_b64_tr_b16 v[130:131], v144 offset:6144
    s_waitcnt lgkmcnt(6)
    v_mfma_f32_16x16x32_bf16 v[84:87], v[116:119], v[16:19], v[84:87]
    ds_read_b64_tr_b16 v[132:133], v145 offset:4096
    v_mfma_f32_16x16x32_bf16 v[100:103], v[116:119], v[20:23], v[100:103]
    ds_read_b64_tr_b16 v[134:135], v145 offset:6144
    s_waitcnt lgkmcnt(6)
    v_mfma_f32_16x16x32_bf16 v[88:91], v[120:123], v[16:19], v[88:91]
    ds_read_b64_tr_b16 v[136:137], v146 offset:4096
    v_mfma_f32_16x16x32_bf16 v[104:107], v[120:123], v[20:23], v[104:107]
    ds_read_b64_tr_b16 v[138:139], v146 offset:6144
    s_waitcnt lgkmcnt(6)
    v_mfma_f32_16x16x32_bf16 v[92:95], v[124:127], v[16:19], v[92:95]
    ds_read_b64_tr_b16 v[140:141], v147 offset:4096
    v_mfma_f32_16x16x32_bf16 v[108:111], v[124:127], v[20:23], v[108:111]
    ds_read_b64_tr_b16 v[142:143], v147 offset:6144
    s_not_b32 s91, s66
    s_cmp_eq_u32 s65, 0
    s_cselect_b32 s65, s91, s65
    s_cselect_b32 s66, -1, s66
    s_ff1_i32_b32 s91, s65
    s_bitset0_b32 s65, s91
    s_lshl_b32 s78, s91, 12
    s_lshl_b32 s91, s91, 10
    buffer_load_dwordx4 v[48:51], v157, s[16:19], s91 offen offset:0 sc1
    buffer_load_dwordx4 v[52:55], v158, s[16:19], s91 offen offset:0 sc1
    s_waitcnt vmcnt(6) lgkmcnt(6)
L_b_c9:
    v_max_u32 v4, v27, v31
    v_cmp_eq_u32 vcc, -1, v4
    s_cbranch_vccnz L_b_g9
L_b_d9:
    v_mfma_f32_16x16x32_bf16 v[80:83], v[128:131], v[24:27], v[80:83]
    s_xor_b32 s89, s67, s77
    s_mov_b32 s67, s77
    v_xor_b32 v144, s89, v144
    ds_read_b64_tr_b16 v[112:113], v144 offset:0
    v_mfma_f32_16x16x32_bf16 v[96:99], v[128:131], v[28:31], v[96:99]
    ds_read_b64_tr_b16 v[114:115], v144 offset:2048
    s_waitcnt lgkmcnt(6)
    v_mfma_f32_16x16x32_bf16 v[84:87], v[132:135], v[24:27], v[84:87]
    v_xor_b32 v145, s89, v145
    ds_read_b64_tr_b16 v[116:117], v145 offset:0
    v_mfma_f32_16x16x32_bf16 v[100:103], v[132:135], v[28:31], v[100:103]
    ds_read_b64_tr_b16 v[118:119], v145 offset:2048
    s_waitcnt lgkmcnt(6)
    v_mfma_f32_16x16x32_bf16 v[88:91], v[136:139], v[24:27], v[88:91]
    v_xor_b32 v146, s89, v146
    ds_read_b64_tr_b16 v[120:121], v146 offset:0
    v_mfma_f32_16x16x32_bf16 v[104:107], v[136:139], v[28:31], v[104:107]
    ds_read_b64_tr_b16 v[122:123], v146 offset:2048
    s_waitcnt lgkmcnt(6)
    v_mfma_f32_16x16x32_bf16 v[92:95], v[140:143], v[24:27], v[92:95]
    v_xor_b32 v147, s89, v147
    ds_read_b64_tr_b16 v[124:125], v147 offset:0
    v_mfma_f32_16x16x32_bf16 v[108:111], v[140:143], v[28:31], v[108:111]
    ds_read_b64_tr_b16 v[126:127], v147 offset:2048
    buffer_load_dwordx4 v[56:59], v157, s[16:19], s91 offen offset:1024 sc1
    buffer_load_dwordx4 v[60:63], v158, s[16:19], s91 offen offset:1024 sc1
    s_waitcnt vmcnt(6) lgkmcnt(6)
L_b_c10:
    v_max_u32 v4, v35, v39
    v_cmp_eq_u32 vcc, -1, v4
    s_cbranch_vccnz L_b_g10
L_b_d10:
    v_mfma_f32_16x16x32_bf16 v[80:83], v[112:115], v[32:35], v[80:83]
    ds_read_b64_tr_b16 v[128:129], v144 offset:4096
    v_mfma_f32_16x16x32_bf16 v[96:99], v[112:115], v[36:39], v[96:99]
    ds_read_b64_tr_b16 v[130:131], v144 offset:6144
    s_waitcnt lgkmcnt(6)
    v_mfma_f32_16x16x32_bf16 v[84:87], v[116:119], v[32:35], v[84:87]
L_walkB7:
    s_cbranch_execz L_walk_22
    ds_read_b64_tr_b16 v[132:133], v145 offset:4096
    v_mfma_f32_16x16x32_bf16 v[100:103], v[116:119], v[36:39], v[100:103]
    ds_read_b64_tr_b16 v[134:135], v145 offset:6144
    s_waitcnt lgkmcnt(6)
    v_mfma_f32_16x16x32_bf16 v[88:91], v[120:123], v[32:35], v[88:91]
    ds_read_b64_tr_b16 v[136:137], v146 offset:4096
    v_mfma_f32_16x16x32_bf16 v[104:107], v[120:123], v[36:39], v[104:107]
    ds_read_b64_tr_b16 v[138:139], v146 offset:6144
    s_waitcnt lgkmcnt(6)
    v_mfma_f32_16x16x32_bf16 v[92:95], v[124:127], v[32:35], v[92:95]
    ds_read_b64_tr_b16 v[140:141], v147 offset:4096
    v_mfma_f32_16x16x32_bf16 v[108:111], v[124:127], v[36:39], v[108:111]
    ds_read_b64_tr_b16 v[142:143], v147 offset:6144
    s_not_b32 s91, s66
    s_or_b32 s65, s65, s91
    s_ff1_i32_b32 s91, s65
    s_bitset0_b32 s65, s91
    s_lshl_b32 s79, s91, 12
    s_lshl_b32 s91, s91, 10
    buffer_load_dwordx4 v[64:67], v157, s[16:19], s91 offen offset:0 sc1
    buffer_load_dwordx4 v[68:71], v158, s[16:19], s91 offen offset:0 sc1
    s_waitcnt vmcnt(6) lgkmcnt(6)
L_b_c11:
    v_max_u32 v4, v43, v47
    v_cmp_eq_u32 vcc, -1, v4
    s_cbranch_vccnz L_b_g11
L_b_d11:
    v_mfma_f32_16x16x32_bf16 v[80:83], v[128:131], v[40:43], v[80:83]
    s_xor_b32 s89, s67, s78
    s_mov_b32 s67, s78
    v_xor_b32 v144, s89, v144
    ds_read_b64_tr_b16 v[112:113], v144 offset:0
    v_mfma_f32_16x16x32_bf16 v[96:99], v[128:131], v[44:47], v[96:99]
    ds_read_b64_tr_b16 v[114:115], v144 offset:2048
    s_waitcnt lgkmcnt(6)
    v_mfma_f32_16x16x32_bf16 v[84:87], v[132:135], v[40:43], v[84:87]
    v_xor_b32 v145, s89, v145
    ds_read_b64_tr_b16 v[116:117], v145 offset:0
    v_mfma_f32_16x16x32_bf16 v[100:103], v[132:135], v[44:47], v[100:103]
    ds_read_b64_tr_b16 v[118:119], v145 offset:2048
    s_waitcnt lgkmcnt(6)
    v_mfma_f32_16x16x32_bf16 v[88:91], v[136:139], v[40:43], v[88:91]
    v_xor_b32 v146, s89, v146
    ds_read_b64_tr_b16 v[120:121], v146 offset:0
    v_mfma_f32_16x16x32_bf16 v[104:107], v[136:139], v[44:47], v[104:107]
    ds_read_b64_tr_b16 v[122:123], v146 offset:2048
    s_waitcnt lgkmcnt(6)
    v_mfma_f32_16x16x32_bf16 v[92:95], v[140:143], v[40:43], v[92:95]
    v_xor_b32 v147, s89, v147
    ds_read_b64_tr_b16 v[124:125], v147 offset:0
    v_mfma_f32_16x16x32_bf16 v[108:111], v[140:143], v[44:47], v[108:111]
    ds_read_b64_tr_b16 v[126:127], v147 offset:2048
    buffer_load_dwordx4 v[72:75], v157, s[16:19], s91 offen offset:1024 sc1
    buffer_load_dwordx4 v[76:79], v158, s[16:19], s91 offen offset:1024 sc1
    s_waitcnt vmcnt(6) lgkmcnt(6)
L_b_c12:
    v_max_u32 v4, v51, v55
    v_cmp_eq_u32 vcc, -1, v4
    s_cbranch_vccnz L_b_g12
L_b_d12:
    v_mfma_f32_16x16x32_bf16 v[80:83], v[112:115], v[48:51], v[80:83]
    ds_read_b64_tr_b16 v[128:129], v144 offset:4096
    v_mfma_f32_16x16x32_bf16 v[96:99], v[112:115], v[52:55], v[96:99]
    ds_read_b64_tr_b16 v[130:131], v144 offset:6144
    s_waitcnt lgkmcnt(6)
    v_mfma_f32_16x16x32_bf16 v[84:87], v[116:119], v[48:51], v[84:87]
    ds_read_b64_tr_b16 v[132:133], v145 offset:4096
    v_mfma_f32_16x16x32_bf16 v[100:103], v[116:119], v[52:55], v[100:103]
    ds_read_b64_tr_b16 v[134:135], v145 offset:6144
    s_waitcnt lgkmcnt(6)
    v_mfma_f32_16x16x32_bf16 v[88:91], v[120:123], v[48:51], v[88:91]
    ds_read_b64_tr_b16 v[136:137], v146 offset:4096
    v_mfma_f32_16x16x32_bf16 v[104:107], v[120:123], v[52:55], v[104:107]
    ds_read_b64_tr_b16 v[138:139], v146 offset:6144
    s_waitcnt lgkmcnt(6)
    v_mfma_f32_16x16x32_bf16 v[92:95], v[124:127], v[48:51], v[92:95]
    ds_read_b64_tr_b16 v[140:141], v147 offset:4096
    v_mfma_f32_16x16x32_bf16 v[108:111], v[124:127], v[52:55], v[108:111]
    ds_read_b64_tr_b16 v[142:143], v147 offset:6144
    s_waitcnt vmcnt(4) lgkmcnt(6)
L_b_c13:
    v_max_u32 v4, v59, v63
    v_cmp_eq_u32 vcc, -1, v4
    s_cbranch_vccnz L_b_g13
L_b_d13:
    v_mfma_f32_16x16x32_bf16 v[80:83], v[128:131], v[56:59], v[80:83]
    s_xor_b32 s89, s67, s79
    s_mov_b32 s67, s79
    v_xor_b32 v144, s89, v144
    ds_read_b64_tr_b16 v[112:113], v144 offset:0
    v_mfma_f32_16x16x32_bf16 v[96:99], v[128:131], v[60:63], v[96:99]
    ds_read_b64_tr_b16 v[114:115], v144 offset:2048
    s_waitcnt lgkmcnt(6)
    v_mfma_f32_16x16x32_bf16 v[84:87], v[132:135], v[56:59], v[84:87]
    v_xor_b32 v145, s89, v145
    ds_read_b64_tr_b16 v[116:117], v145 offset:0
    v_mfma_f32_16x16x32_bf16 v[100:103], v[132:135], v[60:63], v[100:103]
    ds_read_b64_tr_b16 v[118:119], v145 offset:2048
    s_waitcnt lgkmcnt(6)
    v_mfma_f32_16x16x32_bf16 v[88:91], v[136:139], v[56:59], v[88:91]
    v_xor_b32 v146, s89, v146
    ds_read_b64_tr_b16 v[120:121], v146 offset:0
    v_mfma_f32_16x16x32_bf16 v[104:107], v[136:139], v[60:63], v[104:107]
    ds_read_b64_tr_b16 v[122:123], v146 offset:2048
    s_waitcnt lgkmcnt(6)
    v_mfma_f32_16x16x32_bf16 v[92:95], v[140:143], v[56:59], v[92:95]
    v_xor_b32 v147, s89, v147
    ds_read_b64_tr_b16 v[124:125], v147 offset:0
    v_mfma_f32_16x16x32_bf16 v[108:111], v[140:143], v[60:63], v[108:111]
    ds_read_b64_tr_b16 v[126:127], v147 offset:2048
    s_waitcnt vmcnt(2) lgkmcnt(6)
L_b_c14:
    v_max_u32 v4, v67, v71
    v_cmp_eq_u32 vcc, -1, v4
    s_cbranch_vccnz L_b_g14
L_b_d14:
    v_mfma_f32_16x16x32_bf16 v[80:83], v[112:115], v[64:67], v[80:83]
    ds_read_b64_tr_b16 v[128:129], v144 offset:4096
    v_mfma_f32_16x16x32_bf16 v[96:99], v[112:115], v[68:71], v[96:99]
    ds_read_b64_tr_b16 v[130:131], v144 offset:6144
    s_waitcnt lgkmcnt(6)
    v_mfma_f32_16x16x32_bf16 v[84:87], v[116:119], v[64:67], v[84:87]
    ds_read_b64_tr_b16 v[132:133], v145 offset:4096
    v_mfma_f32_16x16x32_bf16 v[100:103], v[116:119], v[68:71], v[100:103]
    ds_read_b64_tr_b16 v[134:135], v145 offset:6144
    s_waitcnt lgkmcnt(6)
    v_mfma_f32_16x16x32_bf16 v[88:91], v[120:123], v[64:67], v[88:91]
    ds_read_b64_tr_b16 v[136:137], v146 offset:4096
    v_mfma_f32_16x16x32_bf16 v[104:107], v[120:123], v[68:71], v[104:107]
    ds_read_b64_tr_b16 v[138:139], v146 offset:6144
    s_waitcnt lgkmcnt(6)
    v_mfma_f32_16x16x32_bf16 v[92:95], v[124:127], v[64:67], v[92:95]
    ds_read_b64_tr_b16 v[140:141], v147 offset:4096
    v_mfma_f32_16x16x32_bf16 v[108:111], v[124:127], v[68:71], v[108:111]
    ds_read_b64_tr_b16 v[142:143], v147 offset:6144
    s_waitcnt vmcnt(0) lgkmcnt(6)
L_b_c15:
    v_max_u32 v4, v75, v79
    v_cmp_eq_u32 vcc, -1, v4
    s_cbranch_vccnz L_b_g15
L_b_d15:
    v_cmp_eq_u32 vcc, -1, v156
    s_cbranch_vccz L_ok_4
    s_sub_u32 s56, s56, 1
    s_cbranch_scc0 L_b_restart
    s_mov_b32 s56, 0
L_ok_4:
    v_mfma_f32_16x16x32_bf16 v[80:83], v[128:131], v[72:75], v[80:83]
    s_mov_b32 s90, 71680
    buffer_load_dwordx4 v[204:207], v11, s[32:35], s90 offen
    v_mfma_f32_16x16x32_bf16 v[96:99], v[128:131], v[76:79], v[96:99]
    s_mov_b32 s90, 78848
    buffer_load_dwordx4 v[208:211], v11, s[32:35], s90 offen
    s_waitcnt lgkmcnt(4)
    v_mfma_f32_16x16x32_bf16 v[84:87], v[132:135], v[72:75], v[84:87]
    v_mfma_f32_16x16x32_bf16 v[100:103], v[132:135], v[76:79], v[100:103]
    s_mov_b32 s90, 86016
    buffer_load_dwordx4 v[212:215], v11, s[32:35], s90 offen
    s_waitcnt lgkmcnt(2)
    v_mfma_f32_16x16x32_bf16 v[88:91], v[136:139], v[72:75], v[88:91]
    s_mov_b32 s90, 93184
    buffer_load_dwordx4 v[216:219], v11, s[32:35], s90 offen
    v_mfma_f32_16x16x32_bf16 v[104:107], v[136:139], v[76:79], v[104:107]
    s_mov_b32 s90, 100352
    buffer_load_dwordx4 v[220:223], v11, s[32:35], s90 offen
    s_waitcnt lgkmcnt(0)
    v_mfma_f32_16x16x32_bf16 v[92:95], v[140:143], v[72:75], v[92:95]
    v_mfma_f32_16x16x32_bf16 v[108:111], v[140:143], v[76:79], v[108:111]
    s_mov_b32 s90, 107520
    buffer_load_dwordx4 v[224:227], v11, s[32:35], s90 offen
    ds_write_b128 v162, v[96:99] offset:0
    ds_write_b128 v162, v[100:103] offset:1024
    ds_write_b128 v162, v[104:107] offset:2048
    s_nop 2
    ds_write_b128 v162, v[108:111] offset:3072
    s_waitcnt lgkmcnt(0)
    s_barrier
    ds_read_b128 v[16:19], v163 offset:0
L_walk_19:
    s_cbranch_execz L_walk_23
    ds_read_b128 v[20:23], v163 offset:1024
    ds_read_b128 v[24:27], v163 offset:2048
    ds_read_b128 v[28:31], v163 offset:3072
    s_waitcnt lgkmcnt(3)
    v_pk_add_f32 v[80:81], v[80:81], v[16:17]
    v_pk_add_f32 v[82:83], v[82:83], v[18:19]
    v_cvt_pk_bf16_f32 v32, v80, v81
    v_cvt_pk_bf16_f32 v33, v82, v83
    s_waitcnt lgkmcnt(2)
    v_pk_add_f32 v[84:85], v[84:85], v[20:21]
    v_pk_add_f32 v[86:87], v[86:87], v[22:23]
    v_cvt_pk_bf16_f32 v34, v84, v85
    v_cvt_pk_bf16_f32 v35, v86, v87
    s_waitcnt lgkmcnt(1)
    v_pk_add_f32 v[88:89], v[88:89], v[24:25]
    v_pk_add_f32 v[90:91], v[90:91], v[26:27]
    v_cvt_pk_bf16_f32 v36, v88, v89
    v_cvt_pk_bf16_f32 v37, v90, v91
    s_waitcnt lgkmcnt(0)
    v_pk_add_f32 v[92:93], v[92:93], v[28:29]
    v_pk_add_f32 v[94:95], v[94:95], v[30:31]
    v_cvt_pk_bf16_f32 v38, v92, v93
    v_cvt_pk_bf16_f32 v39, v94, v95
    v_mfma_f32_16x16x32_bf16 v[60:63], v[32:35], v[32:35], 0
    v_mfma_f32_16x16x32_bf16 v[56:59], v[32:35], v[148:151], 0
    v_mfma_f32_16x16x32_bf16 v[60:63], v[36:39], v[36:39], v[60:63]
    v_mfma_f32_16x16x32_bf16 v[56:59], v[36:39], v[152:155], v[56:59]
    v_lshlrev_b32 v40, 16, v32
    v_and_b32 v41, 0xffff0000, v32
    v_lshlrev_b32 v42, 16, v33
    v_and_b32 v43, 0xffff0000, v33
    v_lshlrev_b32 v44, 16, v34
    v_and_b32 v45, 0xffff0000, v34
    s_nop 1
    v_cndmask_b32 v56, v56, v60, s[72:73]
    v_cndmask_b32 v57, v57, v61, s[72:73]
    v_cndmask_b32 v58, v58, v62, s[72:73]
    v_cndmask_b32 v59, v59, v63, s[72:73]
    v_cndmask_b32 v56, v56, v57, s[4:5]
    v_cndmask_b32 v58, v58, v59, s[98:99]
    s_or_b64 vcc, s[6:7], s[98:99]
    v_cndmask_b32 v56, v56, v58, vcc
    v_cndmask_b32 v56, v56, 1.0, s[74:75]
    v_mov_b32 v67, v56
    buffer_atomic_add_f32 v67, v160, s[16:19], 0 offen sc0 sc1
    s_mov_b32 s90, 0
    buffer_load_dwordx4 v[228:231], v14, s[36:39], s90 offen
    s_mov_b32 s90, 2048
    buffer_load_dwordx4 v[232:235], v14, s[36:39], s90 offen
    s_mov_b32 s90, 4096
    buffer_load_dwordx4 v[236:239], v14, s[36:39], s90 offen
    s_lshl_b32 s86, s3, 11
    s_add_u32 s86, s86, 69632
    v_lshl_add_u32 v150, v0, 4, s86
    ds_write_b128 v150, v[32:35]
    ds_write_b128 v150, v[36:39] offset:1024
    s_lshl_b32 s86, s3, 7
    s_add_u32 s86, s86, 66560
    v_lshl_add_u32 v151, v2, 3, s86
    s_cmp_eq_u32 s62, 0
    s_cbranch_scc1 L_unp
    v_and_b32 v24, 1, v0
    v_cmp_eq_u32 vcc, 1, v24
    v_mov_b32 v24, 0x0c0c0100
    v_mov_b32 v25, 0x01000c0c
    v_cndmask_b32 v16, v24, v25, vcc
    v_mov_b32 v24, 0x0c0c0302
    v_mov_b32 v25, 0x03020c0c
    v_cndmask_b32 v17, v24, v25, vcc
    v_bfe_u32 v24, v0, 1, 2
    v_mov_b32 v25, 0x0c0c0c0c
    v_cmp_eq_u32 vcc, 0, v24
    s_nop 1
    v_cndmask_b32 v72, v25, v16, vcc
    v_cndmask_b32 v76, v25, v17, vcc
    v_cmp_eq_u32 vcc, 1, v24
    s_nop 1
    v_cndmask_b32 v73, v25, v16, vcc
    v_cndmask_b32 v77, v25, v17, vcc
    v_cmp_eq_u32 vcc, 2, v24
    s_nop 1
    v_cndmask_b32 v74, v25, v16, vcc
    v_cndmask_b32 v78, v25, v17, vcc
    v_cmp_eq_u32 vcc, 3, v24
    s_nop 1
    v_cndmask_b32 v75, v25, v16, vcc
    v_cndmask_b32 v79, v25, v17, vcc
    s_lshl_b32 s86, s48, 10
    s_add_u32 s86, s86, 90112
    v_lshl_add_u32 v18, v0, 4, s86
    s_and_b32 s86, s48, 1
    s_cselect_b32 s87, s81, s80
    s_lshr_b32 s90, s48, 1
    s_and_b32 s88, s82, 1
    s_and_b32 s89, s82, 6
    s_lshl3_add_u32 s88, s88, s89
    s_add_u32 s88, s88, s90
    s_mul_i32 s88, s88, 56
    s_add_u32 s88, s88, s87
    s_lshl_b32 s88, s88, 8
    s_add_u32 s88, s88, 7864320
    s_cmp_lt_u32 s87, 56
    s_cselect_b32 s88, s88, 2147483648
    v_lshl_add_u32 v131, v0, 2, s88
    s_lshl2_add_u32 s86, s90, s86
    s_lshl_b32 s86, s86, 7
    s_add_u32 s86, s86, 90112
    v_lshrrev_b32 v16, 3, v0
    v_lshl_add_u32 v133, v16, 4, s86
    v_bfe_u32 v17, v0, 2, 1
    v_lshl_add_u32 v133, v17, 8, v133
    v_and_b32 v17, 3, v0
    v_lshl_add_u32 v133, v17, 2, v133
    s_lshr_b32 s86, s82, 3
    s_lshl2_add_u32 s86, s86, s48
    s_mul_i32 s86, s86, 112
    s_add_u32 s86, s86, 7864320
    v_mul_u32_u24 v16, 14336, v16
    v_and_b32 v17, 7, v0
    v_lshl_add_u32 v137, v17, 4, s86
    v_add_u32 v137, v137, v16
    v_mov_b32 v16, 2147483648
    v_cmp_eq_u32 vcc, 7, v17
    s_nop 1
    v_cndmask_b32 v137, v137, v16, vcc
    s_branch L_unpd
L_unp:
    v_lshlrev_b32 v46, 16, v35
    v_and_b32 v47, 0xffff0000, v35
    v_lshlrev_b32 v48, 16, v36
    v_and_b32 v49, 0xffff0000, v36
    v_lshlrev_b32 v50, 16, v37
    v_and_b32 v51, 0xffff0000, v37
    v_lshlrev_b32 v52, 16, v38
    v_and_b32 v53, 0xffff0000, v38
    v_lshlrev_b32 v54, 16, v39
    v_and_b32 v55, 0xffff0000, v39
L_unpd:
    v_lshrrev_b32 v8, 2, v2
    v_lshlrev_b32 v9, 4, v8
    v_sub_u32 v9, v161, v9
    v_cmp_eq_u32 vcc, 0, v8
    s_nop 1
    v_cndmask_b32 v10, 0, 32, vcc
    v_add_u32 v10, v9, v10
    v_cmp_eq_u32 vcc, 1, v8
    s_nop 1
    v_cndmask_b32 v8, 16, 48, vcc
    v_add_u32 v9, v9, v8
    s_lshl_b32 s86, s52, 11
    s_lshr_b32 s87, s51, 3
    s_lshl_b32 s87, s87, 6
    s_add_u32 s86, s86, s87
    s_and_b32 s87, s51, 7
    s_lshl3_add_u32 s86, s87, s86
    s_add_u32 s86, s86, 6684672
    v_lshl_add_u32 v149, v0, 7, s86
    v_mov_b32 v8, 2147483648
    v_cmp_gt_u32 vcc, 16, v0
    s_nop 1
    v_cndmask_b32 v149, v8, v149, vcc
    s_bfe_u32 s67, s82, 0x20001
    s_lshl2_add_u32 s67, s67, s48
    s_and_b32 s87, s2, 15
    s_lshl_b32 s86, s67, 4
    s_add_u32 s86, s86, s87
    s_lshl_b32 s86, s86, 7
    s_add_u32 s86, s86, 6684672
    v_lshl_add_u32 v148, v0, 3, s86
    v_mov_b32 v8, 2147483648
    v_cmp_gt_u32 vcc, 16, v0
    s_nop 1
    v_cndmask_b32 v148, v8, v148, vcc
    s_lshl_b32 s67, s67, 7
    s_add_u32 s67, s67, 6619136
    s_waitcnt vmcnt(3)
    v_add_f32 v67, v67, v56
    s_branch L_h3_chk
L_h3:
    v_mov_b32 v67, 0
    buffer_atomic_or v67, v160, s[16:19], 0 offen sc0 sc1
    s_waitcnt vmcnt(0)
L_h3_chk:
    v_cmp_ne_u32 vcc, 0x41800000, v67
    s_nop 0
    s_and_b64 vcc, vcc, s[74:75]
    s_cbranch_vccz L_ok_5
    s_sub_u32 s56, s56, 1
    s_cbranch_scc0 L_h3
    s_mov_b32 s56, 0
L_ok_5:
    ds_bpermute_b32 v64, v10, v67
L_walk_20:
    s_cbranch_execz L_walk_24
    ds_bpermute_b32 v66, v161, v67
    ds_bpermute_b32 v65, v9, v67
    s_cmp_eq_u32 s62, 0
    s_cbranch_scc1 L_nop0
    v_mov_b32 v128, 0
    v_mov_b32 v129, 0
    buffer_atomic_or_x2 v[128:129], v148, s[16:19], 0 offen sc0 sc1
L_nop0:
    s_waitcnt lgkmcnt(0)
    v_mul_f32 v64, 0x3a800000, v64
    v_mul_f32 v66, 0x3a800000, v66
    v_fma_f32 v66, -v64, v64, v66
    v_max_f32 v66, 0, v66
    v_cvt_pk_bf16_f32 v69, v64, v66
    v_lshlrev_b32 v68, 16, v69
    v_and_b32 v69, 0xffff0000, v69
    v_add_f32 v69, 0x3727c5ac, v69
    v_cvt_pk_bf16_f32 v69, v69, v69
    v_lshlrev_b32 v69, 16, v69
    v_sqrt_f32 v69, v69
    s_nop 0
    v_cvt_pk_bf16_f32 v69, v69, v69
    v_lshlrev_b32 v69, 16, v69
    v_rcp_f32 v70, v69
    v_fma_f32 v12, -v68, s57, v65
    v_mul_f32 v12, v12, v70
    v_mul_f32 v71, -v68, v70
    v_cvt_pk_bf16_f32 v12, v12, v12
    v_ashrrev_i32 v8, 31, v12
    v_or_b32 v8, 0x80000000, v8
    v_xor_b32 v8, v8, v12
    v_and_b32 v8, 4294901760, v8
    v_or_b32 v13, v8, v6
    s_lshl_b32 s86, s3, 6
    s_add_u32 s86, s86, 65536
    v_lshl_add_u32 v8, v2, 2, s86
    ds_write_b32 v8, v13
    ds_write_b64 v151, v[70:71]
    v_mov_b32 v152, v8
    s_cmp_lg_u32 s62, 0
    s_cbranch_scc1 L_nohn
    v_pk_fma_f32 v[16:17], v[40:41], v[70:71], v[70:71] op_sel:[0,0,1] op_sel_hi:[1,0,1]
    v_pk_fma_f32 v[18:19], v[42:43], v[70:71], v[70:71] op_sel:[0,0,1] op_sel_hi:[1,0,1]
    v_pk_fma_f32 v[20:21], v[44:45], v[70:71], v[70:71] op_sel:[0,0,1] op_sel_hi:[1,0,1]
    v_pk_fma_f32 v[22:23], v[46:47], v[70:71], v[70:71] op_sel:[0,0,1] op_sel_hi:[1,0,1]
    v_pk_fma_f32 v[24:25], v[48:49], v[70:71], v[70:71] op_sel:[0,0,1] op_sel_hi:[1,0,1]
    v_pk_fma_f32 v[26:27], v[50:51], v[70:71], v[70:71] op_sel:[0,0,1] op_sel_hi:[1,0,1]
    v_pk_fma_f32 v[28:29], v[52:53], v[70:71], v[70:71] op_sel:[0,0,1] op_sel_hi:[1,0,1]
    v_pk_fma_f32 v[30:31], v[54:55], v[70:71], v[70:71] op_sel:[0,0,1] op_sel_hi:[1,0,1]
L_nohn:
    v_lshlrev_b32 v8, 3, v0
    v_add_u32 v8, 65536, v8
    s_waitcnt lgkmcnt(0)
    s_barrier
    ds_read_b64 v[64:65], v8
    s_cmp_lg_u32 s62, 0
    s_cbranch_scc1 L_t3_ld
    ds_read_b32 v144, v152 offset:256
    ds_read_b64 v[142:143], v151 offset:512
    ds_read_b128 v[112:115], v150 offset:8192
    ds_read_b128 v[116:119], v150 offset:9216
    v_cvt_pk_bf16_f32 v96, v16, v17
    v_cvt_pk_bf16_f32 v97, v18, v19
    v_cvt_pk_bf16_f32 v98, v20, v21
    v_cvt_pk_bf16_f32 v99, v22, v23
    v_cvt_pk_bf16_f32 v100, v24, v25
    v_cvt_pk_bf16_f32 v101, v26, v27
    v_cvt_pk_bf16_f32 v102, v28, v29
    v_cvt_pk_bf16_f32 v103, v30, v31
    s_waitcnt lgkmcnt(4)
    v_max_u32 v66, v64, v65
    v_min_u32 v67, v64, v65
    s_nop 0
    v_min_u32_dpp v64, v66, v66 row_ror:8 row_mask:0xf bank_mask:0xf
    v_max_u32_dpp v66, v66, v66 row_ror:8 row_mask:0xf bank_mask:0xf
    v_max_u32_dpp v65, v67, v67 row_ror:8 row_mask:0xf bank_mask:0xf
    v_max_u32 v67, v64, v65
    v_min_u32_dpp v64, v66, v66 row_ror:4 row_mask:0xf bank_mask:0xf
    v_max_u32_dpp v66, v66, v66 row_ror:4 row_mask:0xf bank_mask:0xf
    v_max_u32_dpp v65, v67, v67 row_ror:4 row_mask:0xf bank_mask:0xf
    v_max_u32 v67, v64, v65
    v_min_u32_dpp v64, v66, v66 row_ror:2 row_mask:0xf bank_mask:0xf
    v_max_u32_dpp v66, v66, v66 row_ror:2 row_mask:0xf bank_mask:0xf
    v_max_u32_dpp v65, v67, v67 row_ror:2 row_mask:0xf bank_mask:0xf
    v_max_u32 v67, v64, v65
    v_min_u32_dpp v64, v66, v66 row_ror:1 row_mask:0xf bank_mask:0xf
    v_max_u32_dpp v66, v66, v66 row_ror:1 row_mask:0xf bank_mask:0xf
    v_max_u32_dpp v65, v67, v67 row_ror:1 row_mask:0xf bank_mask:0xf
    v_max_u32 v67, v64, v65
    v_readlane_b32 s58, v66, 0
    v_readlane_b32 s59, v67, 0
    v_readlane_b32 s86, v66, 16
    v_readlane_b32 s87, v67, 16
    s_nop 0
    s_max_u32 s59, s59, s87
    s_min_u32 s87, s58, s86
    s_max_u32 s58, s58, s86
    s_max_u32 s59, s59, s87
    v_readlane_b32 s86, v66, 32
    v_readlane_b32 s87, v67, 32
    s_nop 0
    s_max_u32 s59, s59, s87
    s_min_u32 s87, s58, s86
    s_max_u32 s58, s58, s86
    s_max_u32 s59, s59, s87
    v_readlane_b32 s86, v66, 48
    v_readlane_b32 s87, v67, 48
    s_nop 0
    s_max_u32 s59, s59, s87
    s_min_u32 s87, s58, s86
    s_max_u32 s58, s58, s86
    s_max_u32 s59, s59, s87
    s_cmp_lg_u32 s3, 0
    s_cbranch_scc1 L_nokey
    v_mov_b32 v8, s58
    v_mov_b32 v9, s59
    buffer_atomic_swap_x2 v[8:9], v149, s[16:19], 0 offen sc1
L_nokey:
    v_cmp_eq_u32 s[4:5], s58, v13
    v_cmp_eq_u32 s[6:7], s59, v13
    s_nop 0
    s_or_b64 s[96:97], s[4:5], s[6:7]
    s_cbranch_scc0 L_nocand
    s_lshl_b32 s86, s51, 12
    s_lshl_b32 s87, s52, 7
    s_add_u32 s86, s86, s87
    s_add_u32 s86, s86, 6619136
    v_lshl_add_u32 v8, v1, 3, s86
    v_add_u32 v9, 2048, v8
    v_cndmask_b32 v8, v8, v9, s[6:7]
    v_mov_b32 v9, 2147483648
    v_cndmask_b32 v8, v9, v8, s[96:97]
    buffer_store_dwordx2 v[96:97], v8, s[16:19], 0 offen offset:0 sc1
    buffer_store_dwordx2 v[98:99], v8, s[16:19], 0 offen offset:32 sc1
    buffer_store_dwordx2 v[100:101], v8, s[16:19], 0 offen offset:64 sc1
    buffer_store_dwordx2 v[102:103], v8, s[16:19], 0 offen offset:96 sc1
    v_subrev_u32 v131, 65536, v8
L_nocand:
    s_waitcnt lgkmcnt(0)
    v_lshlrev_b32 v80, 16, v112
    v_and_b32 v81, 0xffff0000, v112
    v_lshlrev_b32 v82, 16, v113
    v_and_b32 v83, 0xffff0000, v113
    v_lshlrev_b32 v84, 16, v114
    v_and_b32 v85, 0xffff0000, v114
    v_lshlrev_b32 v86, 16, v115
    v_and_b32 v87, 0xffff0000, v115
    v_lshlrev_b32 v88, 16, v116
    v_and_b32 v89, 0xffff0000, v116
    v_lshlrev_b32 v90, 16, v117
    v_and_b32 v91, 0xffff0000, v117
    v_lshlrev_b32 v92, 16, v118
    v_and_b32 v93, 0xffff0000, v118
    v_lshlrev_b32 v94, 16, v119
    v_and_b32 v95, 0xffff0000, v119
    v_pk_fma_f32 v[16:17], v[80:81], v[142:143], v[142:143] op_sel:[0,0,1] op_sel_hi:[1,0,1]
    v_pk_fma_f32 v[18:19], v[82:83], v[142:143], v[142:143] op_sel:[0,0,1] op_sel_hi:[1,0,1]
    v_pk_fma_f32 v[20:21], v[84:85], v[142:143], v[142:143] op_sel:[0,0,1] op_sel_hi:[1,0,1]
    v_pk_fma_f32 v[22:23], v[86:87], v[142:143], v[142:143] op_sel:[0,0,1] op_sel_hi:[1,0,1]
    v_pk_fma_f32 v[24:25], v[88:89], v[142:143], v[142:143] op_sel:[0,0,1] op_sel_hi:[1,0,1]
    v_pk_fma_f32 v[26:27], v[90:91], v[142:143], v[142:143] op_sel:[0,0,1] op_sel_hi:[1,0,1]
    v_pk_fma_f32 v[28:29], v[92:93], v[142:143], v[142:143] op_sel:[0,0,1] op_sel_hi:[1,0,1]
    v_pk_fma_f32 v[30:31], v[94:95], v[142:143], v[142:143] op_sel:[0,0,1] op_sel_hi:[1,0,1]
    v_cvt_pk_bf16_f32 v132, v16, v17
    v_cvt_pk_bf16_f32 v133, v18, v19
    v_cvt_pk_bf16_f32 v134, v20, v21
    v_cvt_pk_bf16_f32 v135, v22, v23
    v_cvt_pk_bf16_f32 v136, v24, v25
    v_cvt_pk_bf16_f32 v137, v26, v27
    v_cvt_pk_bf16_f32 v138, v28, v29
    v_cvt_pk_bf16_f32 v139, v30, v31
    v_cmp_eq_u32 s[4:5], s58, v144
    v_cmp_eq_u32 s[6:7], s59, v144
L_walk_21:
    s_cbranch_execz L_walk_25
    s_nop 0
    s_or_b64 s[70:71], s[4:5], s[6:7]
    s_cbranch_scc0 L_nocand2
    s_lshl_b32 s86, s51, 12
    s_lshl_b32 s87, s52, 7
    s_add_u32 s86, s86, s87
    s_add_u32 s86, s86, 6619136
    v_lshl_add_u32 v8, v1, 3, s86
    v_add_u32 v9, 2048, v8
    v_cndmask_b32 v8, v8, v9, s[6:7]
    v_mov_b32 v9, 2147483648
    v_cndmask_b32 v8, v9, v8, s[70:71]
    buffer_store_dwordx2 v[132:133], v8, s[16:19], 0 offen offset:0 sc1
    buffer_store_dwordx2 v[134:135], v8, s[16:19], 0 offen offset:32 sc1
    buffer_store_dwordx2 v[136:137], v8, s[16:19], 0 offen offset:64 sc1
    buffer_store_dwordx2 v[138:139], v8, s[16:19], 0 offen offset:96 sc1
    v_subrev_u32 v140, 65536, v8
L_nocand2:
    v_mov_b32 v9, 2147483648
    v_xor_b32 v6, 0x8000, v5
    v_lshlrev_b32 v16, 16, v96
    v_and_b32 v17, 0xffff0000, v96
    v_lshlrev_b32 v18, 16, v97
    v_and_b32 v19, 0xffff0000, v97
    v_lshlrev_b32 v20, 16, v98
    v_and_b32 v21, 0xffff0000, v98
    v_lshlrev_b32 v22, 16, v99
    v_and_b32 v23, 0xffff0000, v99
    v_lshlrev_b32 v24, 16, v100
    v_and_b32 v25, 0xffff0000, v100
    v_lshlrev_b32 v26, 16, v101
    v_and_b32 v27, 0xffff0000, v101
    v_lshlrev_b32 v28, 16, v102
    v_and_b32 v29, 0xffff0000, v102
    v_lshlrev_b32 v30, 16, v103
    v_and_b32 v31, 0xffff0000, v103
    v_pk_add_f32 v[16:17], v[16:17], v[40:41]
    v_pk_add_f32 v[18:19], v[18:19], v[42:43]
    v_pk_add_f32 v[20:21], v[20:21], v[44:45]
    v_pk_add_f32 v[22:23], v[22:23], v[46:47]
    v_pk_add_f32 v[24:25], v[24:25], v[48:49]
    v_pk_add_f32 v[26:27], v[26:27], v[50:51]
    v_pk_add_f32 v[28:29], v[28:29], v[52:53]
    v_pk_add_f32 v[30:31], v[30:31], v[54:55]
    v_cvt_pk_bf16_f32 v104, v16, v17
    v_cvt_pk_bf16_f32 v105, v18, v19
    v_cvt_pk_bf16_f32 v106, v20, v21
    v_cvt_pk_bf16_f32 v107, v22, v23
    v_cvt_pk_bf16_f32 v108, v24, v25
    v_cvt_pk_bf16_f32 v109, v26, v27
    v_cvt_pk_bf16_f32 v110, v28, v29
    v_cvt_pk_bf16_f32 v111, v30, v31
    v_permlane16_swap_b32 v104, v106
    v_permlane16_swap_b32 v105, v107
    v_permlane16_swap_b32 v108, v110
    v_permlane16_swap_b32 v109, v111
    v_mov_b32 v16, v104
    v_mov_b32 v17, v105
    v_mov_b32 v18, v106
    v_mov_b32 v19, v107
    v_mov_b32_dpp v104, v108 row_ror:8 row_mask:0xf bank_mask:0xc
    v_mov_b32_dpp v105, v109 row_ror:8 row_mask:0xf bank_mask:0xc
    v_mov_b32_dpp v106, v110 row_ror:8 row_mask:0xf bank_mask:0xc
    v_mov_b32_dpp v107, v111 row_ror:8 row_mask:0xf bank_mask:0xc
    v_mov_b32_dpp v108, v16 row_ror:8 row_mask:0xf bank_mask:0x3
    v_mov_b32_dpp v109, v17 row_ror:8 row_mask:0xf bank_mask:0x3
    v_mov_b32_dpp v110, v18 row_ror:8 row_mask:0xf bank_mask:0x3
    v_mov_b32_dpp v111, v19 row_ror:8 row_mask:0xf bank_mask:0x3
    v_cndmask_b32 v8, v5, v9, s[96:97]
    v_lshlrev_b32 v16, 16, v132
    v_and_b32 v17, 0xffff0000, v132
    v_lshlrev_b32 v18, 16, v133
    v_and_b32 v19, 0xffff0000, v133
    v_lshlrev_b32 v20, 16, v134
    v_and_b32 v21, 0xffff0000, v134
    v_lshlrev_b32 v22, 16, v135
    v_and_b32 v23, 0xffff0000, v135
    v_lshlrev_b32 v24, 16, v136
    v_and_b32 v25, 0xffff0000, v136
    v_lshlrev_b32 v26, 16, v137
    v_and_b32 v27, 0xffff0000, v137
    v_lshlrev_b32 v28, 16, v138
    v_and_b32 v29, 0xffff0000, v138
    v_lshlrev_b32 v30, 16, v139
    v_and_b32 v31, 0xffff0000, v139
    v_pk_add_f32 v[16:17], v[16:17], v[80:81]
    v_pk_add_f32 v[18:19], v[18:19], v[82:83]
    v_pk_add_f32 v[20:21], v[20:21], v[84:85]
    v_pk_add_f32 v[22:23], v[22:23], v[86:87]
    v_pk_add_f32 v[24:25], v[24:25], v[88:89]
    v_pk_add_f32 v[26:27], v[26:27], v[90:91]
    v_pk_add_f32 v[28:29], v[28:29], v[92:93]
    v_pk_add_f32 v[30:31], v[30:31], v[94:95]
    v_cvt_pk_bf16_f32 v120, v16, v17
    v_cvt_pk_bf16_f32 v121, v18, v19
    v_cvt_pk_bf16_f32 v122, v20, v21
    v_cvt_pk_bf16_f32 v123, v22, v23
    v_cvt_pk_bf16_f32 v124, v24, v25
    v_cvt_pk_bf16_f32 v125, v26, v27
    v_cvt_pk_bf16_f32 v126, v28, v29
    v_cvt_pk_bf16_f32 v127, v30, v31
    v_permlane16_swap_b32 v120, v122
    v_permlane16_swap_b32 v121, v123
    v_permlane16_swap_b32 v124, v126
    v_permlane16_swap_b32 v125, v127
    v_mov_b32 v16, v120
    v_mov_b32 v17, v121
    v_mov_b32 v18, v122
    v_mov_b32 v19, v123
    v_mov_b32_dpp v120, v124 row_ror:8 row_mask:0xf bank_mask:0xc
    v_mov_b32_dpp v121, v125 row_ror:8 row_mask:0xf bank_mask:0xc
    v_mov_b32_dpp v122, v126 row_ror:8 row_mask:0xf bank_mask:0xc
    v_mov_b32_dpp v123, v127 row_ror:8 row_mask:0xf bank_mask:0xc
    v_mov_b32_dpp v124, v16 row_ror:8 row_mask:0xf bank_mask:0x3
    v_mov_b32_dpp v125, v17 row_ror:8 row_mask:0xf bank_mask:0x3
    v_mov_b32_dpp v126, v18 row_ror:8 row_mask:0xf bank_mask:0x3
    v_mov_b32_dpp v127, v19 row_ror:8 row_mask:0xf bank_mask:0x3
    s_cmp_eq_u64 s[96:97], 0
    s_cbranch_scc1 L_noha
    buffer_store_dwordx2 v[32:33], v131, s[16:19], 0 offen offset:0 sc1
    buffer_store_dwordx2 v[34:35], v131, s[16:19], 0 offen offset:32 sc1
    buffer_store_dwordx2 v[36:37], v131, s[16:19], 0 offen offset:64 sc1
    buffer_store_dwordx2 v[38:39], v131, s[16:19], 0 offen offset:96 sc1
L_noha:
    s_cmp_eq_u64 s[70:71], 0
    s_cbranch_scc1 L_nohb
    buffer_store_dwordx2 v[112:113], v140, s[16:19], 0 offen offset:0 sc1
    buffer_store_dwordx2 v[114:115], v140, s[16:19], 0 offen offset:32 sc1
    buffer_store_dwordx2 v[116:117], v140, s[16:19], 0 offen offset:64 sc1
    buffer_store_dwordx2 v[118:119], v140, s[16:19], 0 offen offset:96 sc1
L_nohb:
    v_mov_b32 v8, 66304
    s_barrier
    ds_read_b64 v[10:11], v8
    s_waitcnt lgkmcnt(0)
    v_cmp_ne_u32 s[4:5], v10, v13
    v_cmp_ne_u32 s[6:7], v11, v13
    s_nop 0
    s_and_b64 s[4:5], s[4:5], s[6:7]
    v_cndmask_b32 v8, v9, v5, s[4:5]
    v_add_u32 v17, 64, v8
    v_mov_b32 v16, v8
    s_nop 1
    v_mov_b32_dpp v16, v17 row_ror:8 row_mask:0xf bank_mask:0xc
    v_mov_b32_dpp v17, v8 row_ror:8 row_mask:0xf bank_mask:0x3
    buffer_store_dwordx4 v[104:107], v16, s[24:27], 0 offen sc1
    buffer_store_dwordx4 v[108:111], v17, s[24:27], 0 offen sc1
    v_cmp_ne_u32 s[4:5], v10, v144
    v_cmp_ne_u32 s[6:7], v11, v144
    s_nop 0
    s_and_b64 s[4:5], s[4:5], s[6:7]
    v_cndmask_b32 v8, v9, v6, s[4:5]
    v_add_u32 v19, 64, v8
    v_mov_b32 v18, v8
    s_nop 1
    v_mov_b32_dpp v18, v19 row_ror:8 row_mask:0xf bank_mask:0xc
    v_mov_b32_dpp v19, v8 row_ror:8 row_mask:0xf bank_mask:0x3
    s_barrier
    s_barrier
    s_barrier
    buffer_store_dwordx4 v[120:123], v18, s[24:27], 0 offen sc1
    buffer_store_dwordx4 v[124:127], v19, s[24:27], 0 offen sc1
    s_branch L_fin
L_t3_ld:
    s_mov_b32 s90, 6144
    buffer_load_dwordx4 v[240:243], v14, s[36:39], s90 offen
    s_mov_b32 s90, 8192
    buffer_load_dwordx4 v[244:247], v14, s[36:39], s90 offen
    s_mov_b32 s90, 10240
L_walk_22:
    s_cbranch_execz L_walked2
    buffer_load_dwordx4 v[248:251], v14, s[36:39], s90 offen
    s_mov_b32 s90, 12288
    buffer_load_dwordx4 v[252:255], v14, s[36:39], s90 offen
    v_bfe_u32 v8, v0, 3, 1
    v_lshl_add_u32 v10, v1, 5, s67
    s_mov_b32 s60, 0
    s_mov_b32 s61, 0
    s_lshl_b32 s63, 1, s51
    s_mov_b32 m0, s51
    s_waitcnt lgkmcnt(0)
    v_max_u32 v98, v64, v65
    v_min_u32 v99, v64, v65
    s_nop 0
    v_min_u32_dpp v96, v98, v98 row_ror:8 row_mask:0xf bank_mask:0xf
    v_max_u32_dpp v98, v98, v98 row_ror:8 row_mask:0xf bank_mask:0xf
    v_max_u32_dpp v97, v99, v99 row_ror:8 row_mask:0xf bank_mask:0xf
    v_max_u32 v99, v96, v97
    v_min_u32_dpp v96, v98, v98 row_ror:4 row_mask:0xf bank_mask:0xf
    v_max_u32_dpp v98, v98, v98 row_ror:4 row_mask:0xf bank_mask:0xf
    v_max_u32_dpp v97, v99, v99 row_ror:4 row_mask:0xf bank_mask:0xf
    v_max_u32 v99, v96, v97
    v_min_u32_dpp v96, v98, v98 row_ror:2 row_mask:0xf bank_mask:0xf
    v_max_u32_dpp v98, v98, v98 row_ror:2 row_mask:0xf bank_mask:0xf
    v_max_u32_dpp v97, v99, v99 row_ror:2 row_mask:0xf bank_mask:0xf
    v_max_u32 v99, v96, v97
    v_min_u32_dpp v96, v98, v98 row_ror:1 row_mask:0xf bank_mask:0xf
    v_max_u32_dpp v98, v98, v98 row_ror:1 row_mask:0xf bank_mask:0xf
    v_max_u32_dpp v97, v99, v99 row_ror:1 row_mask:0xf bank_mask:0xf
    v_max_u32 v99, v96, v97
    v_readlane_b32 s58, v98, 0
    v_readlane_b32 s59, v99, 0
    v_readlane_b32 s86, v98, 16
    v_readlane_b32 s87, v99, 16
    s_nop 0
    s_max_u32 s59, s59, s87
    s_min_u32 s87, s58, s86
    s_max_u32 s58, s58, s86
    s_max_u32 s59, s59, s87
    v_readlane_b32 s86, v98, 32
    v_readlane_b32 s87, v99, 32
    s_nop 0
    s_max_u32 s59, s59, s87
    s_min_u32 s87, s58, s86
    s_max_u32 s58, s58, s86
    s_max_u32 s59, s59, s87
    v_readlane_b32 s86, v98, 48
    v_readlane_b32 s87, v99, 48
    s_nop 0
    s_max_u32 s59, s59, s87
    s_min_u32 s87, s58, s86
    s_max_u32 s58, s58, s86
    s_max_u32 s59, s59, s87
    s_waitcnt vmcnt(4)
    s_branch L_h4_chk0
L_h4_w0:
    s_waitcnt vmcnt(0)
L_h4_chk0:
    v_cmp_eq_u32 vcc, -1, v128
    s_nop 0
    s_andn2_b32 s86, vcc_lo, s63
    s_cbranch_scc0 L_h4_all0
    v_cndmask_b32 v96, v128, 0, vcc
    v_cndmask_b32 v97, v129, 0, vcc
    v_mov_b32 v128, 0
    v_mov_b32 v129, 0
    buffer_atomic_or_x2 v[128:129], v148, s[16:19], 0 offen sc0 sc1
    s_sub_u32 s56, s56, 1
    s_cbranch_scc1 L_h4_out
    v_min_u32_dpp v98, v96, v96 row_ror:8 row_mask:0xf bank_mask:0xf
    v_max_u32_dpp v96, v96, v96 row_ror:8 row_mask:0xf bank_mask:0xf
    v_max_u32_dpp v99, v97, v97 row_ror:8 row_mask:0xf bank_mask:0xf
    v_max_u32 v97, v98, v99
    v_min_u32_dpp v98, v96, v96 row_ror:4 row_mask:0xf bank_mask:0xf
    v_max_u32_dpp v96, v96, v96 row_ror:4 row_mask:0xf bank_mask:0xf
    v_max_u32_dpp v99, v97, v97 row_ror:4 row_mask:0xf bank_mask:0xf
    v_max_u32 v97, v98, v99
    v_min_u32_dpp v98, v96, v96 row_ror:2 row_mask:0xf bank_mask:0xf
    v_max_u32_dpp v96, v96, v96 row_ror:2 row_mask:0xf bank_mask:0xf
    v_max_u32_dpp v99, v97, v97 row_ror:2 row_mask:0xf bank_mask:0xf
    v_max_u32 v97, v98, v99
    v_min_u32_dpp v98, v96, v96 row_ror:1 row_mask:0xf bank_mask:0xf
    v_max_u32_dpp v96, v96, v96 row_ror:1 row_mask:0xf bank_mask:0xf
    v_max_u32_dpp v99, v97, v97 row_ror:1 row_mask:0xf bank_mask:0xf
    v_max_u32 v97, v98, v99
    v_readlane_b32 s70, v96, 0
    v_readlane_b32 s71, v97, 0
    s_nop 0
    s_cmp_eq_u64 s[70:71], s[60:61]
    s_cbranch_scc1 L_h4_w0
    s_mov_b64 s[60:61], s[70:71]
    s_bfe_u32 s86, s60, 0x40007
    s_bfe_u32 s87, s61, 0x40007
    s_sub_u32 s87, s86, s87
    s_lshl_b32 s87, s87, 12
    s_cselect_b32 s69, s87, 2048
    v_mad_i32_i24 v130, v8, s69, v10
    s_xor_b32 s86, s86, 15
    s_lshl_b32 s66, s86, 12
    buffer_load_dwordx4 v[64:67], v130, s[16:19], s66 offen sc1
    buffer_load_dwordx4 v[68:71], v130, s[16:19], s66 offen offset:16 sc1
    s_waitcnt vmcnt(2)
    s_branch L_h4_chk0
L_h4_own:
    s_waitcnt vmcnt(0)
    v_mov_b32 v128, 0
    v_mov_b32 v129, 0
    buffer_atomic_or_x2 v[128:129], v148, s[16:19], 0 offen sc0 sc1
    s_sub_u32 s56, s56, 1
    s_cbranch_scc0 L_h4_w0
L_h4_out:
    s_mov_b32 s56, 0
    s_waitcnt vmcnt(0)
    s_mov_b64 vcc, 0
L_h4_all0:
    v_writelane_b32 v128, s58, m0
    v_writelane_b32 v129, s59, m0
    s_nop 0
    v_min_u32_dpp v98, v128, v128 row_ror:8 row_mask:0xf bank_mask:0xf
    v_max_u32_dpp v96, v128, v128 row_ror:8 row_mask:0xf bank_mask:0xf
    v_max_u32_dpp v99, v129, v129 row_ror:8 row_mask:0xf bank_mask:0xf
    v_max_u32 v97, v98, v99
L_h4_all:
    v_min_u32_dpp v98, v96, v96 row_ror:4 row_mask:0xf bank_mask:0xf
    v_max_u32_dpp v96, v96, v96 row_ror:4 row_mask:0xf bank_mask:0xf
    v_max_u32_dpp v99, v97, v97 row_ror:4 row_mask:0xf bank_mask:0xf
    v_max_u32 v97, v98, v99
    v_min_u32_dpp v98, v96, v96 row_ror:2 row_mask:0xf bank_mask:0xf
    v_max_u32_dpp v96, v96, v96 row_ror:2 row_mask:0xf bank_mask:0xf
    v_max_u32_dpp v99, v97, v97 row_ror:2 row_mask:0xf bank_mask:0xf
    v_max_u32 v97, v98, v99
    v_min_u32_dpp v98, v96, v96 row_ror:1 row_mask:0xf bank_mask:0xf
    v_max_u32_dpp v96, v96, v96 row_ror:1 row_mask:0xf bank_mask:0xf
    v_max_u32_dpp v99, v97, v97 row_ror:1 row_mask:0xf bank_mask:0xf
    v_max_u32 v97, v98, v99
    v_readlane_b32 s70, v96, 0
    v_readlane_b32 s71, v97, 0
    s_nop 0
    s_cmp_ge_u32 s58, s71
    s_cselect_b32 s86, vcc_lo, 0
    s_cmp_lg_u32 s86, 0
    s_cbranch_scc1 L_h4_own
    s_cmp_eq_u64 s[70:71], s[60:61]
    s_cbranch_scc1 L_h4_go
    s_mov_b64 s[60:61], s[70:71]
    s_bfe_u32 s86, s60, 0x40007
    s_bfe_u32 s87, s61, 0x40007
    s_sub_u32 s87, s86, s87
    s_lshl_b32 s87, s87, 12
    s_cselect_b32 s69, s87, 2048
    v_mad_i32_i24 v130, v8, s69, v10
    s_xor_b32 s86, s86, 15
    s_lshl_b32 s66, s86, 12
    buffer_load_dwordx4 v[64:67], v130, s[16:19], s66 offen sc1
    buffer_load_dwordx4 v[68:71], v130, s[16:19], s66 offen offset:16 sc1
L_h4_go:
    v_mov_b32 v16, 66304
    v_mov_b32 v24, s60
    v_mov_b32 v25, s61
    ds_write_b64 v16, v[24:25]
    s_waitcnt lgkmcnt(0)
    s_barrier
    s_waitcnt vmcnt(0)
    s_branch L_seg_chk
L_seg:
    buffer_load_dwordx4 v[64:67], v130, s[16:19], s66 offen sc1
    buffer_load_dwordx4 v[68:71], v130, s[16:19], s66 offen offset:16 sc1
    s_waitcnt vmcnt(0)
L_seg_chk:
    v_max3_u32 v16, v65, v67, v69
    v_max_u32 v16, v16, v71
    v_cmp_eq_u32 vcc, -1, v16
    s_cbranch_vccz L_ok_6
    s_sub_u32 s56, s56, 1
    s_cbranch_scc0 L_seg
    s_mov_b32 s56, 0
L_ok_6:
    v_perm_b32 v80, v64, v64, v72
    v_perm_b32 v81, v64, v64, v73
    v_perm_b32 v82, v64, v64, v74
    v_perm_b32 v83, v64, v64, v75
    v_perm_b32 v84, v64, v64, v76
    v_perm_b32 v85, v64, v64, v77
    v_perm_b32 v86, v64, v64, v78
    v_perm_b32 v87, v64, v64, v79
    v_mfma_f32_16x16x32_bf16 v[88:91], v[80:83], v[164:167], 0
    v_perm_b32 v92, v65, v65, v72
    v_perm_b32 v93, v65, v65, v73
    v_perm_b32 v94, v65, v65, v74
    v_perm_b32 v95, v65, v65, v75
    v_mfma_f32_16x16x32_bf16 v[88:91], v[84:87], v[168:171], v[88:91]
L_walk_23:
    s_cbranch_execz L_walked2
    v_perm_b32 v80, v65, v65, v76
    v_perm_b32 v81, v65, v65, v77
    v_perm_b32 v82, v65, v65, v78
    v_perm_b32 v83, v65, v65, v79
    v_mfma_f32_16x16x32_bf16 v[88:91], v[92:95], v[172:175], v[88:91]
    v_perm_b32 v84, v66, v66, v72
    v_perm_b32 v85, v66, v66, v73
    v_perm_b32 v86, v66, v66, v74
    v_perm_b32 v87, v66, v66, v75
    v_mfma_f32_16x16x32_bf16 v[88:91], v[80:83], v[176:179], v[88:91]
    v_perm_b32 v92, v66, v66, v76
    v_perm_b32 v93, v66, v66, v77
    v_perm_b32 v94, v66, v66, v78
    v_perm_b32 v95, v66, v66, v79
    v_mfma_f32_16x16x32_bf16 v[88:91], v[84:87], v[180:183], v[88:91]
    v_perm_b32 v80, v67, v67, v72
    v_perm_b32 v81, v67, v67, v73
    v_perm_b32 v82, v67, v67, v74
    v_perm_b32 v83, v67, v67, v75
    v_mfma_f32_16x16x32_bf16 v[88:91], v[92:95], v[184:187], v[88:91]
    v_perm_b32 v84, v67, v67, v76
    v_perm_b32 v85, v67, v67, v77
    v_perm_b32 v86, v67, v67, v78
    v_perm_b32 v87, v67, v67, v79
    v_mfma_f32_16x16x32_bf16 v[88:91], v[80:83], v[188:191], v[88:91]
    v_perm_b32 v92, v68, v68, v72
    v_perm_b32 v93, v68, v68, v73
    v_perm_b32 v94, v68, v68, v74
    v_perm_b32 v95, v68, v68, v75
    v_mfma_f32_16x16x32_bf16 v[88:91], v[84:87], v[192:195], v[88:91]
    v_perm_b32 v80, v68, v68, v76
    v_perm_b32 v81, v68, v68, v77
    v_perm_b32 v82, v68, v68, v78
    v_perm_b32 v83, v68, v68, v79
    v_mfma_f32_16x16x32_bf16 v[88:91], v[92:95], v[196:199], v[88:91]
    v_perm_b32 v84, v69, v69, v72
    v_perm_b32 v85, v69, v69, v73
    v_perm_b32 v86, v69, v69, v74
    v_perm_b32 v87, v69, v69, v75
    v_mfma_f32_16x16x32_bf16 v[88:91], v[80:83], v[200:203], v[88:91]
    v_perm_b32 v92, v69, v69, v76
    v_perm_b32 v93, v69, v69, v77
    v_perm_b32 v94, v69, v69, v78
    v_perm_b32 v95, v69, v69, v79
    v_mfma_f32_16x16x32_bf16 v[88:91], v[84:87], v[204:207], v[88:91]
    v_perm_b32 v80, v70, v70, v72
    v_perm_b32 v81, v70, v70, v73
    v_perm_b32 v82, v70, v70, v74
    v_perm_b32 v83, v70, v70, v75
    v_mfma_f32_16x16x32_bf16 v[88:91], v[92:95], v[208:211], v[88:91]
    v_perm_b32 v84, v70, v70, v76
    v_perm_b32 v85, v70, v70, v77
    v_perm_b32 v86, v70, v70, v78
    v_perm_b32 v87, v70, v70, v79
    v_mfma_f32_16x16x32_bf16 v[88:91], v[80:83], v[212:215], v[88:91]
    v_perm_b32 v92, v71, v71, v72
    v_perm_b32 v93, v71, v71, v73
    v_perm_b32 v94, v71, v71, v74
    v_perm_b32 v95, v71, v71, v75
    v_mfma_f32_16x16x32_bf16 v[88:91], v[84:87], v[216:219], v[88:91]
    v_perm_b32 v80, v71, v71, v76
    v_perm_b32 v81, v71, v71, v77
    v_perm_b32 v82, v71, v71, v78
    v_perm_b32 v83, v71, v71, v79
    v_mfma_f32_16x16x32_bf16 v[88:91], v[92:95], v[220:223], v[88:91]
    s_nop 0
    v_mfma_f32_16x16x32_bf16 v[88:91], v[80:83], v[224:227], v[88:91]
    s_nop 7
    ds_write_b128 v18, v[88:91]
    s_waitcnt lgkmcnt(0)
    s_barrier
    ds_read2st64_b32 v[24:25], v133 offset0:0 offset1:4
    ds_read2st64_b32 v[26:27], v133 offset0:8 offset1:12
    s_mov_b32 s79, 114688
    s_cmp_eq_u32 s83, 0
    s_waitcnt lgkmcnt(0)
    v_pk_add_f32 v[24:25], v[24:25], v[26:27]
    v_add_f32 v24, v24, v25
    s_cbranch_scc1 L_h5_far
    buffer_store_dword v24, v131, s[16:19], 0 offen
L_h5_out:
    s_lshr_b32 s88, s48, 1
    s_cselect_b32 s86, s69, 0
    s_cselect_b32 s63, s61, s60
    s_and_b32 s87, s48, 1
    s_and_b32 s89, s82, 7
    s_lshl1_add_u32 s87, s89, s87
    s_lshl_b32 s87, s87, 7
    s_add_u32 s86, s86, s66
    s_add_u32 s86, s86, s87
    s_add_u32 s86, s86, 6553600
    v_lshl_add_u32 v142, v0, 1, s86
    v_mov_b32 v140, 0
    v_mov_b32 v141, 0
    s_mov_b32 s65, 65536
    buffer_load_short_d16_hi v140, v142, s[16:19], 0 offen sc1
    buffer_load_short_d16_hi v141, v142, s[16:19], s65 offen sc1
    s_and_b32 s86, s63, 0x7ff
    s_sub_u32 s86, 2047, s86
    s_lshl_b32 s86, s86, 11
    s_add_u32 s86, s86, s87
    v_lshl_add_u32 v143, v0, 1, s86
    s_ashr_i32 s86, s63, 31
    s_orn2_b32 s86, 0x80000000, s86
    s_xor_b32 s63, s63, s86
    s_and_b32 s63, s63, 0xffff0000
    s_lshr_b32 s86, s48, 1
    s_and_b32 s87, s48, 1
    s_lshl_b32 s88, s86, 9
    s_lshl_b32 s89, s87, 7
    s_add_u32 s88, s88, s89
    s_add_u32 s88, s88, 94208
    v_lshrrev_b32 v17, 3, v0
    v_lshl_add_u32 v20, v17, 4, s88
    v_bfe_u32 v9, v0, 2, 1
    v_lshl_add_u32 v20, v9, 8, v20
    v_and_b32 v9, 3, v0
    v_lshl_add_u32 v20, v9, 2, v20
    s_and_b32 s89, s82, 7
    s_lshl3_add_u32 s86, s86, s89
    s_lshl1_add_u32 s86, s86, s87
    s_lshl_b32 s86, s86, 11
    s_add_u32 s86, s86, 917504
    v_lshl_add_u32 v9, v17, 8, s86
    v_and_b32 v17, 7, v0
    v_lshl_add_u32 v9, v17, 3, v9
    s_mov_b32 s76, 0
    s_mov_b32 s77, 0x41900000
    s_lshl_b32 s86, s48, 7
    s_add_u32 s86, s86, 100352
    v_lshl_add_u32 v11, v8, 6, s86
    v_lshl_add_u32 v11, v1, 4, v11
    v_and_b32 v16, 7, v0
    v_cmp_eq_u32 vcc, 7, v16
    v_lshl_add_u32 v16, v16, 2, v1
    v_mul_u32_u24 v17, 37, v16
    v_lshrrev_b32 v17, 8, v17
    v_add_u32 v16, v16, v17
    v_lshl_or_b32 v17, v1, 3, 7
    v_cndmask_b32 v16, v16, v17, vcc
    v_lshl_add_u32 v16, v8, 5, v16
    v_lshl_add_u32 v10, v16, 1, s86
    v_mov_b32 v144, s63
    v_mul_f32 v144, 0xbfb8aa3b, v144
    v_exp_f32 v144, v144
    s_nop 0
    v_add_f32 v144, 1.0, v144
    v_rcp_f32 v144, v144
    s_nop 0
    v_cvt_pk_bf16_f32 v144, v144, v144
    v_lshlrev_b32 v144, 16, v144
    s_mov_b32 s6, 0x80808080
    s_mov_b32 s7, 0x80808080
    v_mov_b32 v19, v9
    buffer_load_dwordx4 v[112:115], v137, s[16:19], 0 offen sc1
    buffer_load_dwordx4 v[116:119], v137, s[16:19], s79 offen sc1
    s_waitcnt vmcnt(0)
    s_branch L_h5_chk
L_h5:
    v_cmp_eq_u32 vcc, -1, v115
    s_cbranch_vccz L_h5_s0
    s_mov_b64 exec, vcc
    buffer_load_dwordx4 v[112:115], v137, s[16:19], 0 offen sc1
    s_mov_b64 exec, -1
L_h5_s0:
    v_cmp_eq_u32 vcc, -1, v119
    s_cbranch_vccz L_h5_s1
    s_mov_b64 exec, vcc
    buffer_load_dwordx4 v[116:119], v137, s[16:19], s79 offen sc1
    s_mov_b64 exec, -1
L_walk_24:
    s_cbranch_execz L_walked2
L_h5_s1:
    s_waitcnt vmcnt(0)
L_h5_chk:
    v_max_u32 v16, v115, v119
    v_cmp_eq_u32 vcc, -1, v16
    s_cbranch_vccz L_ok_7
    s_sub_u32 s56, s56, 1
    s_cbranch_scc0 L_h5
    s_mov_b32 s56, 0
L_ok_7:
    v_permlane32_swap_b32 v112, v114
    v_permlane32_swap_b32 v113, v115
    v_permlane32_swap_b32 v116, v118
    v_permlane32_swap_b32 v117, v119
    v_add_f32 v112, v112, v114
    v_add_f32 v113, v113, v115
    v_add_f32 v116, v116, v118
    v_add_f32 v117, v117, v119
    v_permlane16_swap_b32 v112, v113
    s_nop 0
    v_permlane16_swap_b32 v116, v117
    v_add_f32 v112, v112, v113
    v_add_f32 v116, v116, v117
    v_cvt_pk_bf16_f32 v25, v112, v116
    v_lshlrev_b32 v24, 16, v25
    v_and_b32 v28, 0xffff0000, v25
    v_mul_f32 v25, 0xbfb8aa3b, v24
    v_exp_f32 v25, v25
    s_nop 0
    v_add_f32 v25, 1.0, v25
    v_rcp_f32 v25, v25
    s_nop 0
    v_mul_f32 v24, v24, v25
    v_cvt_pk_bf16_f32 v24, v24, v24
    v_lshlrev_b32 v24, 16, v24
    v_mul_f32 v24, v24, v28
    v_cvt_pk_bf16_f32 v24, v24, v24
    ds_write_b16 v10, v24
    s_waitcnt lgkmcnt(0)
    ds_read_b128 v[64:67], v11
    s_waitcnt lgkmcnt(0)
    v_perm_b32 v80, v64, v64, v72
    v_perm_b32 v81, v64, v64, v73
    v_perm_b32 v82, v64, v64, v74
    v_perm_b32 v83, v64, v64, v75
    v_perm_b32 v84, v64, v64, v76
    v_perm_b32 v85, v64, v64, v77
    v_perm_b32 v86, v64, v64, v78
    v_perm_b32 v87, v64, v64, v79
    v_mfma_f32_16x16x32_bf16 v[88:91], v[80:83], v[228:231], 0
    v_perm_b32 v92, v65, v65, v72
    v_perm_b32 v93, v65, v65, v73
    v_perm_b32 v94, v65, v65, v74
    v_perm_b32 v95, v65, v65, v75
    v_mfma_f32_16x16x32_bf16 v[88:91], v[84:87], v[232:235], v[88:91]
    v_perm_b32 v80, v65, v65, v76
    v_perm_b32 v81, v65, v65, v77
    v_perm_b32 v82, v65, v65, v78
    v_perm_b32 v83, v65, v65, v79
    v_mfma_f32_16x16x32_bf16 v[88:91], v[92:95], v[236:239], v[88:91]
    v_perm_b32 v84, v66, v66, v72
    v_perm_b32 v85, v66, v66, v73
    v_perm_b32 v86, v66, v66, v74
    v_perm_b32 v87, v66, v66, v75
    v_mfma_f32_16x16x32_bf16 v[88:91], v[80:83], v[240:243], v[88:91]
    v_perm_b32 v92, v66, v66, v76
    v_perm_b32 v93, v66, v66, v77
    v_perm_b32 v94, v66, v66, v78
    v_perm_b32 v95, v66, v66, v79
    v_mfma_f32_16x16x32_bf16 v[88:91], v[84:87], v[244:247], v[88:91]
    v_perm_b32 v80, v67, v67, v72
    v_perm_b32 v81, v67, v67, v73
    v_perm_b32 v82, v67, v67, v74
    v_perm_b32 v83, v67, v67, v75
    v_mfma_f32_16x16x32_bf16 v[88:91], v[92:95], v[248:251], v[88:91]
    s_nop 0
    v_mfma_f32_16x16x32_bf16 v[88:91], v[80:83], v[252:255], v[88:91]
    s_nop 7
    ds_write_b128 v18, v[88:91] offset:4096
    s_waitcnt lgkmcnt(0)
    s_barrier
    ds_read2st64_b32 v[24:25], v20 offset0:0 offset1:4
    ds_read2st64_b32 v[26:27], v20 offset0:8 offset1:12
    s_waitcnt lgkmcnt(0)
    v_pk_add_f32 v[24:25], v[24:25], v[26:27]
    v_add_f32 v24, v24, v25
    v_cvt_f64_f32 v[26:27], v24
    v_add_f64 v[24:25], v[26:27], s[76:77]
    buffer_atomic_add_f64 v[24:25], v19, s[16:19], 0 offen sc0 sc1
    s_barrier
    s_mov_b32 s77, 0xc1df0000
    v_add_f64 v[26:27], v[26:27], s[76:77]
    s_waitcnt vmcnt(1)
    v_max_u32 v16, v140, v141
    v_cmp_eq_u32 vcc, 0xffff0000, v16
    s_cbranch_vccnz L_fin_ld
L_fin_go:
    s_mov_b32 s88, 0x4c000000
    v_mov_b32 v17, 2147483648
    s_waitcnt vmcnt(0)
    v_add_f64 v[24:25], v[24:25], v[26:27]
    v_cvt_f32_f64 v24, v[24:25]
    v_cmp_lt_f32 vcc, |v24|, s88
    v_cvt_pk_bf16_f32 v24, v24, v24
    v_lshlrev_b32 v24, 16, v24
    v_mul_f32 v24, v24, v144
    v_cndmask_b32 v17, v17, v143, vcc
    v_cvt_pk_bf16_f32 v24, v24, v24
    v_lshlrev_b32 v24, 16, v24
    v_add_f32 v24, v24, v141
    v_cvt_pk_bf16_f32 v24, v24, v24
    v_lshlrev_b32 v24, 16, v24
    v_add_f32 v24, v24, v140
    v_cvt_pk_bf16_f32 v24, v24, v24
    buffer_store_short v24, v17, s[24:27], 0 offen
L_fin:
L_end:
    s_endpgm
L_b_restart:
    s_waitcnt vmcnt(0)
    v_xor_b32 v9, 0x8000, v7
    buffer_load_dwordx4 v[136:139], v7, s[8:11], 0 offen
    buffer_load_dwordx4 v[140:143], v9, s[8:11], 0 offen
    v_mov_b32 v8, s68
    s_mov_b32 s66, 0xffffaaaa
    s_mov_b32 s63, 1
    s_branch L_b_init
L_b_g4:
    s_lshr_b32 s86, s78, 2
    buffer_load_dwordx4 v[48:51], v157, s[16:19], s86 offen offset:0 sc1
    buffer_load_dwordx4 v[52:55], v158, s[16:19], s86 offen offset:0 sc1
    s_waitcnt vmcnt(0)
    s_sub_u32 s56, s56, 1
    s_cbranch_scc0 L_b_c4
    s_mov_b32 s56, 0
    s_branch L_b_d4
L_b_g5:
    s_lshr_b32 s86, s78, 2
    buffer_load_dwordx4 v[56:59], v157, s[16:19], s86 offen offset:1024 sc1
    buffer_load_dwordx4 v[60:63], v158, s[16:19], s86 offen offset:1024 sc1
    s_waitcnt vmcnt(0)
    s_sub_u32 s56, s56, 1
    s_cbranch_scc0 L_b_c5
    s_mov_b32 s56, 0
    s_branch L_b_d5
L_b_g6:
    s_lshr_b32 s86, s79, 2
    buffer_load_dwordx4 v[64:67], v157, s[16:19], s86 offen offset:0 sc1
    buffer_load_dwordx4 v[68:71], v158, s[16:19], s86 offen offset:0 sc1
    s_waitcnt vmcnt(0)
    s_sub_u32 s56, s56, 1
    s_cbranch_scc0 L_b_c6
    s_mov_b32 s56, 0
    s_branch L_b_d6
L_b_g7:
    s_lshr_b32 s86, s79, 2
    buffer_load_dwordx4 v[72:75], v157, s[16:19], s86 offen offset:1024 sc1
    buffer_load_dwordx4 v[76:79], v158, s[16:19], s86 offen offset:1024 sc1
    s_waitcnt vmcnt(0)
    s_sub_u32 s56, s56, 1
    s_cbranch_scc0 L_b_c7
    s_mov_b32 s56, 0
    s_branch L_b_d7
L_b_g8:
    s_lshr_b32 s86, s76, 2
    buffer_load_dwordx4 v[16:19], v157, s[16:19], s86 offen offset:0 sc1
    buffer_load_dwordx4 v[20:23], v158, s[16:19], s86 offen offset:0 sc1
    s_waitcnt vmcnt(0)
    s_sub_u32 s56, s56, 1
    s_cbranch_scc0 L_b_c8
    s_mov_b32 s56, 0
    s_branch L_b_d8
L_b_g9:
    s_lshr_b32 s86, s76, 2
    buffer_load_dwordx4 v[24:27], v157, s[16:19], s86 offen offset:1024 sc1
    buffer_load_dwordx4 v[28:31], v158, s[16:19], s86 offen offset:1024 sc1
    s_waitcnt vmcnt(0)
    s_sub_u32 s56, s56, 1
    s_cbranch_scc0 L_b_c9
    s_mov_b32 s56, 0
    s_branch L_b_d9
L_b_g10:
    s_lshr_b32 s86, s77, 2
    buffer_load_dwordx4 v[32:35], v157, s[16:19], s86 offen offset:0 sc1
    buffer_load_dwordx4 v[36:39], v158, s[16:19], s86 offen offset:0 sc1
    s_waitcnt vmcnt(0)
    s_sub_u32 s56, s56, 1
    s_cbranch_scc0 L_b_c10
    s_mov_b32 s56, 0
    s_branch L_b_d10
L_b_g11:
    s_lshr_b32 s86, s77, 2
    buffer_load_dwordx4 v[40:43], v157, s[16:19], s86 offen offset:1024 sc1
    buffer_load_dwordx4 v[44:47], v158, s[16:19], s86 offen offset:1024 sc1
    s_waitcnt vmcnt(0)
    s_sub_u32 s56, s56, 1
    s_cbranch_scc0 L_b_c11
    s_mov_b32 s56, 0
    s_branch L_b_d11
L_b_g12:
    s_lshr_b32 s86, s78, 2
    buffer_load_dwordx4 v[48:51], v157, s[16:19], s86 offen offset:0 sc1
    buffer_load_dwordx4 v[52:55], v158, s[16:19], s86 offen offset:0 sc1
    s_waitcnt vmcnt(0)
    s_sub_u32 s56, s56, 1
    s_cbranch_scc0 L_b_c12
    s_mov_b32 s56, 0
    s_branch L_b_d12
L_walk_25:
    s_cbranch_execz L_walked2
L_b_g13:
    s_lshr_b32 s86, s78, 2
    buffer_load_dwordx4 v[56:59], v157, s[16:19], s86 offen offset:1024 sc1
    buffer_load_dwordx4 v[60:63], v158, s[16:19], s86 offen offset:1024 sc1
    s_waitcnt vmcnt(0)
    s_sub_u32 s56, s56, 1
    s_cbranch_scc0 L_b_c13
    s_mov_b32 s56, 0
    s_branch L_b_d13
L_b_g14:
    s_lshr_b32 s86, s79, 2
    buffer_load_dwordx4 v[64:67], v157, s[16:19], s86 offen offset:0 sc1
    buffer_load_dwordx4 v[68:71], v158, s[16:19], s86 offen offset:0 sc1
    s_waitcnt vmcnt(0)
    s_sub_u32 s56, s56, 1
    s_cbranch_scc0 L_b_c14
    s_mov_b32 s56, 0
    s_branch L_b_d14
L_b_g15:
    s_lshr_b32 s86, s79, 2
    buffer_load_dwordx4 v[72:75], v157, s[16:19], s86 offen offset:1024 sc1
    buffer_load_dwordx4 v[76:79], v158, s[16:19], s86 offen offset:1024 sc1
    s_waitcnt vmcnt(0)
    s_sub_u32 s56, s56, 1
    s_cbranch_scc0 L_b_c15
    s_mov_b32 s56, 0
    s_branch L_b_d15
L_b_p0:
    v_mov_b32 v8, 0
    buffer_atomic_or v8, v159, s[16:19], 0 offen sc0 sc1
L_b_w0:
    s_waitcnt vmcnt(0)
    ds_write_b32 v12, v12
    v_mov_b32 v12, v162
    v_cmp_eq_u32 vcc, s68, v8
    s_nop 0
    s_lshr_b32 s65, vcc_lo, 1
    s_and_b32 s65, s65, vcc_lo
    s_andn2_b32 s65, s65, s66
    s_cbranch_scc0 L_b_q0
    s_or_b32 s66, s66, s65
    s_branch L_b_r0
L_b_q0:
    s_sub_u32 s56, s56, 1
    s_cbranch_scc0 L_b_p0
    s_mov_b32 s56, 0
    s_not_b32 s65, s66
    s_branch L_b_r0
L_b_p1:
    v_mov_b32 v8, 0
    buffer_atomic_or v8, v159, s[16:19], 0 offen sc0 sc1
    s_waitcnt vmcnt(0)
    v_cmp_eq_u32 vcc, s68, v8
    s_nop 0
    s_lshr_b32 s65, vcc_lo, 1
    s_and_b32 s65, s65, vcc_lo
    s_andn2_b32 s65, s65, s66
    s_cbranch_scc0 L_b_q1
    s_or_b32 s66, s66, s65
    s_branch L_b_r1
L_b_q1:
    s_sub_u32 s56, s56, 1
    s_cbranch_scc0 L_b_p1
    s_mov_b32 s56, 0
    s_not_b32 s65, s66
    s_branch L_b_r1
L_h5_far:
    buffer_store_dword v24, v131, s[16:19], 0 offen sc1
    s_branch L_h5_out
L_fin_ld:
    buffer_load_short_d16_hi v140, v142, s[16:19], 0 offen sc1
    buffer_load_short_d16_hi v141, v142, s[16:19], s65 offen sc1
    s_waitcnt vmcnt(0)
    v_max_u32 v16, v140, v141
    v_cmp_eq_u32 vcc, 0xffff0000, v16
    s_cbranch_vccz L_fin_go
    s_sub_u32 s56, s56, 1
    s_cbranch_scc0 L_fin_ld
    s_branch L_fin_go
L_last:
    s_endpgm
.section .rodata,"a"
.p2align 6
.amdhsa_kernel sequential_preLN__linear_attn_block__moe_arch_mod__prompt_kernel
  .amdhsa_next_free_vgpr 256
  .amdhsa_next_free_sgpr 102
  .amdhsa_accum_offset 256
  .amdhsa_group_segment_fixed_size 0
  .amdhsa_kernarg_size 88
  .amdhsa_user_sgpr_count 2
  .amdhsa_user_sgpr_kernarg_segment_ptr 1
  .amdhsa_system_sgpr_workgroup_id_x 1
.end_amdhsa_kernel
```

```asm
; @launch grid=(256,1,1) block=(512,1,1) lds=163840
.amdgcn_target "amdgcn-amd-amdhsa--gfx950"
.text
.globl sequential_preLN__linear_attn_block__moe_arch_mod__prompt_kernel
.p2align 8
.type sequential_preLN__linear_attn_block__moe_arch_mod__prompt_kernel,@function
sequential_preLN__linear_attn_block__moe_arch_mod__prompt_kernel:
    s_cmp_ge_u32 s2, 256
    s_cbranch_scc1 L_end
    s_load_dwordx16 s[64:79], s[0:1], 0
    s_load_dwordx4 s[80:83], s[0:1], 64
    s_load_dwordx2 s[84:85], s[0:1], 80
    v_lshrrev_b32 v1, 6, v0
    v_and_b32 v0, 63, v0
    v_readfirstlane_b32 s3, v1
    s_and_b32 s44, s2, 7
    s_lshr_b32 s45, s2, 3
    s_and_b32 s46, s44, 1
    s_lshl_b32 s46, s46, 3
    s_and_b32 s86, s45, 7
    s_add_u32 s46, s46, s86
    s_lshr_b32 s47, s44, 1
    s_lshl_b32 s47, s47, 2
    s_lshr_b32 s86, s45, 3
    s_add_u32 s47, s47, s86
    s_mov_b32 s51, s47
    s_mov_b32 s52, s46
    s_and_b32 s48, s3, 3
    s_and_b32 s49, s3, 1
    s_bfe_u32 s50, s3, 0x10001
    s_mov_b32 s56, 65536
    s_mov_b32 s95, 0x3f803f80
    s_movk_i32 s92, 0x1000
    s_movk_i32 s93, 0x2000
    s_movk_i32 s94, 0x3000
    s_cmp_lt_u32 s3, 4
    s_cbranch_scc1 L_comp0
    v_lshrrev_b32 v20, 3, v0
    v_and_b32 v21, 7, v0
    v_lshrrev_b32 v22, 4, v0
    v_xor_b32 v23, v21, v22
    v_xor_b32 v24, 4, v23
    s_lshl_b32 s86, s48, 5
    v_add_u32 v25, s86, v20
    v_lshlrev_b32 v25, 11, v25
    v_lshl_add_u32 v2, v23, 4, v25
    v_lshl_add_u32 v3, v24, 4, v25
    v_add_u32 v3, 15360, v3
    v_lshl_add_u32 v4, v23, 4, v25
    v_add_u32 v4, 30720, v4
    v_lshl_add_u32 v5, v24, 4, v25
    v_add_u32 v5, 46080, v5
    s_lshl_b32 s86, s48, 4
    v_add_u32 v25, s86, v20
    v_mul_u32_u24 v25, 6144, v25
    s_lshl_b32 s86, s47, 7
    v_add_u32 v25, s86, v25
    v_bfe_u32 v26, v0, 4, 1
    v_lshlrev_b32 v26, 1, v26
    v_xor_b32 v26, v26, v21
    v_xor_b32 v27, 4, v26
    v_lshl_add_u32 v6, v26, 4, v25
    v_lshl_add_u32 v7, v27, 4, v25
    v_add_u32 v7, 48128, v7
    v_lshl_add_u32 v8, v26, 4, v25
    v_add_u32 v8, 2048, v8
    v_lshl_add_u32 v9, v27, 4, v25
    v_add_u32 v9, 50176, v9
    v_lshl_add_u32 v10, v26, 4, v25
    v_add_u32 v10, 4096, v10
    v_lshl_add_u32 v11, v27, 4, v25
    v_add_u32 v11, 52224, v11
    s_lshl_b32 s63, s46, 18
    s_lshl_b32 s53, s48, 12
    s_lshl_b32 s62, s48, 11
    s_add_u32 s62, s62, 16384
    s_setprio 1
    s_lshl_b32 s86, s45, 2
    s_add_u32 s86, s86, s48
    s_mul_i32 s87, s86, 12288
    s_and_b32 s88, s47, 12
    s_lshl_b32 s88, s88, 7
    s_add_u32 s87, s87, s88
    s_add_u32 s87, s87, 384
    s_bitcmp1_b32 s47, 2
    s_cselect_b32 s87, 2147483648, s87
    v_lshl_add_u32 v37, v0, 11, s87
    v_mov_b32 v24, 2147483648
    v_cmp_gt_u32 vcc, 6, v0
    s_nop 1
    v_cndmask_b32 v37, v24, v37, vcc
    s_lshl_b32 s86, s86, 14
    s_and_b32 s88, s52, 8
    s_lshl_b32 s88, s88, 7
    s_add_u32 s86, s86, s88
    s_add_u32 s86, s86, 384
    v_lshl_add_u32 v38, v0, 11, s86
    v_cmp_gt_u32 vcc, 8, v0
    s_nop 1
    v_cndmask_b32 v38, v24, v38, vcc
    s_waitcnt lgkmcnt(0)
    s_mov_b32 s8, s64
    s_and_b32 s9, s65, 0xffff
    s_mov_b32 s10, 4194304
    s_mov_b32 s11, 0x20000
    s_mov_b32 s12, s66
    s_and_b32 s13, s67, 0xffff
    s_mov_b32 s14, 6291456
    s_mov_b32 s15, 0x20000
    s_and_b32 s86, s47, 12
    s_and_b32 s87, s46, 8
    s_add_u32 s64, s86, s87
    s_and_b32 s64, s64, 15
    s_mov_b32 s67, s64
    s_load_dword s61, s[84:85], 524288
    s_lshr_b32 s90, s67, 2
    s_mul_i32 s90, s90, 1572864
    buffer_load_dword v39, v37, s[12:15], s90 offen
    s_add_u32 m0, s53, 40960
    s_lshl_b32 s70, s64, 7
    s_add_u32 s70, s70, s63
    buffer_load_dwordx4 v2, s[8:11], s70 offen offset:0 lds
    buffer_load_dwordx4 v3, s[8:11], s70 offen offset:1024 lds
    buffer_load_dwordx4 v4, s[8:11], s70 offen offset:2048 lds
    buffer_load_dwordx4 v5, s[8:11], s70 offen offset:3072 lds
    s_mul_i32 s91, s64, 393216
    s_add_u32 s64, s64, 1
    s_and_b32 s64, s64, 15
    s_add_u32 m0, s62, 40960
    s_nop 0
    buffer_load_dwordx4 v6, s[12:15], s91 offen offset:0 lds
    buffer_load_dwordx4 v7, s[12:15], s91 offen offset:1024 lds
    s_add_u32 m0, s62, 49152
    s_nop 0
    buffer_load_dwordx4 v8, s[12:15], s91 offen offset:0 lds
    buffer_load_dwordx4 v9, s[12:15], s91 offen offset:1024 lds
    s_add_u32 m0, s62, 57344
    s_nop 0
    buffer_load_dwordx4 v10, s[12:15], s91 offen offset:0 lds
    buffer_load_dwordx4 v11, s[12:15], s91 offen offset:1024 lds
    s_branch L_ld1
L_comp0:
    s_lshl2_add_u32 s86, s45, s3
    s_cmp_ge_u32 s86, 4
    s_cbranch_scc1 L_noipf
    s_getpc_b64 s[4:5]
L_ipf:
    s_sub_u32 s4, s4, L_ipf-sequential_preLN__linear_attn_block__moe_arch_mod__prompt_kernel
    s_subb_u32 s5, s5, 0
    s_lshl_b32 s86, s86, 13
    v_lshl_add_u32 v31, v0, 7, s86
    v_min_u32 v31, L_last-sequential_preLN__linear_attn_block__moe_arch_mod__prompt_kernel, v31
    global_load_dword v30, v31, s[4:5]
L_noipf:
    s_cmp_eq_u32 s3, 3
    s_cbranch_scc1 L_comp
    s_mov_b64 exec, 0
    s_cmp_eq_u32 s3, 2
    s_cbranch_scc1 L_walkA2
    s_cmp_eq_u32 s3, 1
    s_cbranch_scc1 L_walkA1
    s_branch L_walkA0
L_ld1:
    s_mov_b32 s16, s84
    s_and_b32 s17, s85, 0xffff
    s_mov_b32 s18, 268435456
    s_mov_b32 s19, 0x20000
    s_mov_b32 s20, s68
    s_and_b32 s21, s69, 0xffff
    s_mov_b32 s22, 2097152
    s_mov_b32 s23, 0x20000
    s_mov_b32 s24, s80
    s_and_b32 s25, s81, 0xffff
    s_mov_b32 s26, 4194304
    s_mov_b32 s27, 0x20000
    s_mov_b32 s28, s82
    s_and_b32 s29, s83, 0xffff
    s_mov_b32 s30, 256
    s_mov_b32 s31, 0x20000
    s_bitcmp1_b32 s2, 3
    s_cselect_b32 s32, s76, s74
    s_cselect_b32 s33, s77, s75
    s_and_b32 s33, s33, 0xffff
    s_mov_b32 s34, 7340032
    s_mov_b32 s35, 0x20000
    s_mov_b32 s36, s78
    s_and_b32 s37, s79, 0xffff
    s_mov_b32 s38, 7340032
    s_mov_b32 s39, 0x20000
    s_mov_b32 s40, s72
    s_and_b32 s41, s73, 0xffff
    s_mov_b32 s42, 2048
    s_mov_b32 s43, 0x20000
    s_lshl_b32 s82, s44, 5
    s_or_b32 s82, s82, s45
    v_lshrrev_b32 v22, 4, v0
    v_and_b32 v23, 15, v0
    s_lshl_b32 s86, s45, 2
    s_add_u32 s86, s86, s48
L_walkA0:
    s_cbranch_execz L_comp
    s_mul_i32 s87, s86, 6
    v_mul_u32_u24 v24, 43, v0
    v_lshrrev_b32 v24, 8, v24
    v_mul_u32_u24 v25, 6, v24
    v_sub_u32 v25, v0, v25
    v_add_u32 v25, s87, v25
    s_add_u32 s87, s67, 2
    v_add_u32 v24, s87, v24
    v_and_b32 v24, 15, v24
    v_mul_u32_u24 v124, 393216, v24
    v_lshrrev_b32 v24, 2, v25
    v_lshl_add_u32 v124, v24, 11, v124
    v_and_b32 v25, 3, v25
    s_and_b32 s88, s47, 12
    v_add_u32 v25, s88, v25
    v_lshl_add_u32 v124, v25, 7, v124
    v_mov_b32 v24, 2147483648
    v_cmp_gt_u32 vcc, 36, v0
    s_nop 1
    v_cndmask_b32 v124, v24, v124, vcc
    v_add_u32 v24, s87, v20
    v_and_b32 v24, 15, v24
    s_and_b32 s88, s46, 8
    s_lshl4_add_u32 s86, s88, s86
    s_lshl_b32 s86, s86, 14
    v_lshl_add_u32 v123, v21, 11, s86
    v_mov_b32 v125, v123
    v_lshl_add_u32 v123, v24, 7, v123
    v_mov_b32 v24, 2147483648
    v_cmp_gt_u32 vcc, 16, v0
    s_nop 1
    v_cndmask_b32 v123, v24, v123, vcc
    s_add_u32 m0, s53, 81920
    s_lshl_b32 s70, s64, 7
    s_add_u32 s70, s70, s63
    buffer_load_dwordx4 v2, s[8:11], s70 offen offset:0 lds
    buffer_load_dwordx4 v3, s[8:11], s70 offen offset:1024 lds
    buffer_load_dwordx4 v4, s[8:11], s70 offen offset:2048 lds
    buffer_load_dwordx4 v5, s[8:11], s70 offen offset:3072 lds
    s_mul_i32 s91, s64, 393216
    s_add_u32 s64, s64, 1
    s_and_b32 s64, s64, 15
    s_add_u32 m0, s62, 81920
    s_nop 0
    buffer_load_dwordx4 v6, s[12:15], s91 offen offset:0 lds
    buffer_load_dwordx4 v7, s[12:15], s91 offen offset:1024 lds
    s_add_u32 m0, s62, 90112
    s_nop 0
    buffer_load_dwordx4 v8, s[12:15], s91 offen offset:0 lds
    buffer_load_dwordx4 v9, s[12:15], s91 offen offset:1024 lds
    s_add_u32 m0, s62, 98304
    s_nop 0
    buffer_load_dwordx4 v10, s[12:15], s91 offen offset:0 lds
    buffer_load_dwordx4 v11, s[12:15], s91 offen offset:1024 lds
    buffer_load_dword v122, v123, s[8:11], 0 offen
    buffer_load_dword v122, v124, s[12:15], 0 offen
    s_and_b32 s65, s45, 7
    s_lshr_b32 s66, s45, 3
    s_add_u32 s86, s65, 1
    s_and_b32 s86, s86, 3
    s_mul_i32 s86, s86, 40960
    s_lshl_b32 s87, s48, 13
    s_cmp_eq_u32 s48, 3
    s_cselect_b32 s87, 0, s87
    s_add_u32 s86, s86, s87
    s_add_u32 s86, s86, 16384
    v_lshl_add_u32 v25, v20, 7, s86
    v_lshl_add_u32 v28, v26, 4, v25
    v_lshl_add_u32 v29, v27, 4, v25
    s_add_u32 s86, s66, 1
    s_and_b32 s86, s86, 3
    s_mul_i32 s86, s86, 40960
    s_add_u32 s86, s86, s53
    v_lshl_add_u32 v16, v0, 6, s86
    v_bfe_u32 v25, v0, 2, 2
    v_lshl_add_u32 v16, v25, 4, v16
    v_xor_b32 v17, 16, v16
    v_xor_b32 v18, 32, v16
    v_xor_b32 v19, 48, v16
    s_lshl_b32 s86, s46, 14
    s_lshl_b32 s87, s48, 8
    s_add_u32 s86, s86, s87
    s_add_u32 s86, s86, 262144
    v_lshl_add_u32 v33, v23, 4, s86
    v_lshl_add_u32 v33, v22, 10, v33
    s_lshl_b32 s87, s47, 10
    s_add_u32 s86, s86, s87
    v_lshl_add_u32 v13, v0, 2, s86
    v_and_b32 v25, 3, v0
    v_cmp_eq_u32 vcc, 0, v25
    v_mov_b32 v24, 2147483648
    s_nop 0
    v_cndmask_b32 v13, v24, v13, vcc
    s_mul_i32 s86, s47, 12288
    s_add_u32 s86, s86, 65536
    s_lshl_b32 s87, s48, 8
    s_cmp_eq_u32 s48, 3
    s_cselect_b32 s87, 2147483648, s87
    s_mov_b32 s88, 0
    s_add_u32 s86, s86, s87
    v_lshl_add_u32 v32, v23, 4, s86
    v_mul_u32_u24 v25, 768, v22
    v_add_u32 v32, v32, v25
    s_mul_i32 s87, s46, 768
    s_add_u32 s86, s86, s87
    s_add_u32 s86, s86, s88
    v_lshl_add_u32 v34, v23, 5, s86
    v_lshl_add_u32 v34, v22, 4, v34
    v_and_b32 v25, 0x28, v0
    v_cmp_eq_u32 vcc, 0, v25
    s_nop 1
    v_cndmask_b32 v34, v24, v34, vcc
    s_bfe_u32 s86, s82, 0x20001
    s_lshl_b32 s86, s86, 2
    s_add_u32 s86, s86, s48
    s_lshl_b32 s86, s86, 6
    v_lshl_add_u32 v30, v22, 4, s86
    v_mul_u32_u24 v30, 7168, v30
    s_add_u32 s86, s44, 3
    s_and_b32 s86, s86, 7
    s_min_u32 s86, s86, 6
    s_mul_i32 s87, s44, 7
    s_lshr_b32 s88, s45, 3
    s_lshl_b32 s88, s88, 1
    s_sub_u32 s80, s88, 2
    s_cmp_ge_u32 s80, s86
    s_addc_u32 s80, s80, s87
    s_sub_u32 s81, s88, 1
    s_cmp_ge_u32 s81, s86
    s_addc_u32 s81, s81, s87
    s_add_u32 s86, s86, s87
    s_cmp_lt_u32 s45, 8
    s_cselect_b32 s80, s86, s80
    s_cselect_b32 s81, 56, s81
    v_mov_b32 v24, s80
    v_mov_b32 v25, s81
    s_mov_b32 vcc_lo, 4278255360
    s_mov_b32 vcc_hi, vcc_lo
    v_cndmask_b32 v24, v24, v25, vcc
    v_cmp_gt_u32 vcc, 56, v24
    v_and_b32 v25, 7, v0
    v_lshlrev_b32 v24, 7, v24
    v_lshl_add_u32 v24, v25, 4, v24
    v_add_u32 v30, v30, v24
    v_mov_b32 v24, 2147483648
    v_cndmask_b32 v30, v24, v30, vcc
    s_lshr_b32 s86, s82, 3
    s_mul_i32 s86, s86, 112
    s_mul_i32 s87, s48, 28
    s_add_u32 s86, s86, s87
    v_mul_u32_u24 v31, 7, v22
    v_add_u32 v31, s86, v31
    v_lshlrev_b32 v31, 11, v31
    s_and_b32 s86, s82, 7
    s_lshl_b32 s86, s86, 8
    v_lshl_add_u32 v24, v23, 4, s86
    v_add_u32 v31, v31, v24
    v_lshlrev_b32 v24, 1, v22
    v_xor_b32 v24, v24, v21
    s_lshl_b32 s86, s48, 3
    v_add_u32 v12, s86, v20
    v_lshlrev_b32 v12, 11, v12
    s_lshl_b32 s86, s52, 7
    v_lshl_add_u32 v24, v24, 4, s86
    v_add_u32 v12, v12, v24
    s_lshl_b32 s89, s48, 10
    v_and_b32 v24, 1, v0
    v_lshlrev_b32 v24, 4, v24
    v_mov_b32 v25, 0x3f80
    v_lshlrev_b32 v24, v24, v25
    v_bfe_u32 v25, v0, 1, 2
    v_cmp_eq_u32 vcc, 0, v25
    s_nop 1
    v_cndmask_b32 v104, 0, v24, vcc
    v_cmp_eq_u32 vcc, 1, v25
    s_nop 1
    v_cndmask_b32 v105, 0, v24, vcc
    v_cmp_eq_u32 vcc, 2, v25
    s_nop 1
    v_cndmask_b32 v106, 0, v24, vcc
    v_cmp_eq_u32 vcc, 3, v25
    s_nop 1
    v_cndmask_b32 v107, 0, v24, vcc
    s_waitcnt lgkmcnt(0)
    s_add_u32 s68, s61, 0x9e3779b9
    v_mov_b32 v35, s68
    s_lshl_b32 s86, s46, 2
    s_add_u32 s86, s86, s48
    s_lshl_b32 s86, s86, 7
    s_add_u32 s86, s86, 655360
    s_lshl_b32 s87, s47, 2
    s_add_u32 s87, s87, s48
    s_lshl_b32 s87, s87, 7
    s_add_u32 s87, s87, 663552
    s_cmp_eq_u32 s48, 3
    s_cselect_b32 s87, 2147483648, s87
    s_cselect_b32 s76, 0xffff, -1
    s_mov_b32 s77, 0
    v_mov_b32 v24, s86
    v_mov_b32 v25, s87
    v_cmp_gt_u32 vcc, 16, v0
    s_nop 1
    v_cndmask_b32 v117, v25, v24, vcc
    v_lshl_add_u32 v117, v23, 2, v117
    v_mov_b32 v116, 2147483648
    v_cmp_gt_u32 vcc, 32, v0
    s_nop 1
L_walkA1:
    s_cbranch_execz L_comp
    v_cndmask_b32 v117, v116, v117, vcc
    s_lshl2_add_u32 s86, s47, s86
    s_lshl2_add_u32 s87, s46, s87
    v_writelane_b32 v116, s86, 0
    v_writelane_b32 v116, s87, 1
    s_getreg_b32 s83, hwreg(HW_REG_XCC_ID, 0, 4)
    s_add_u32 s83, s83, s68
    v_mov_b32 v121, s83
    s_lshl_b32 s86, s44, 7
    s_add_u32 s86, s86, 753664
    v_lshl_add_u32 v119, v0, 2, s86
    v_mov_b32 v120, 2147483648
    v_cmp_gt_u32 vcc, 32, v0
    s_nop 1
    v_cndmask_b32 v119, v120, v119, vcc
    s_lshl_b32 s86, s48, 6
    s_add_u32 s86, s86, s45
    v_cmp_eq_u32 vcc, s86, v0
    s_nop 1
    v_cndmask_b32 v120, v120, v119, vcc
    s_mov_b64 exec, 0
    s_cmp_eq_u32 s48, 0
    s_cbranch_scc1 L_walkB4
    s_cmp_eq_u32 s48, 1
    s_cbranch_scc1 L_walkB5
    s_cmp_eq_u32 s48, 2
    s_cbranch_scc1 L_walkB6
    s_branch L_walkB7
L_walked2:
    s_mov_b64 exec, -1
    s_waitcnt vmcnt(12)
    s_barrier
    buffer_store_dword v121, v120, s[16:19], 0 offen sc1
    s_add_u32 m0, s53, 122880
    s_lshl_b32 s70, s64, 7
    s_add_u32 s70, s70, s63
    buffer_load_dwordx4 v2, s[8:11], s70 offen offset:0 lds
    buffer_load_dwordx4 v3, s[8:11], s70 offen offset:1024 lds
    buffer_load_dwordx4 v4, s[8:11], s70 offen offset:2048 lds
    buffer_load_dwordx4 v5, s[8:11], s70 offen offset:3072 lds
    s_mul_i32 s91, s64, 393216
    s_add_u32 s64, s64, 1
    s_and_b32 s64, s64, 15
    s_add_u32 m0, s62, 122880
    s_nop 0
    buffer_load_dwordx4 v6, s[12:15], s91 offen offset:0 lds
    buffer_load_dwordx4 v7, s[12:15], s91 offen offset:1024 lds
    s_add_u32 m0, s62, 131072
    s_nop 0
    buffer_load_dwordx4 v8, s[12:15], s91 offen offset:0 lds
    buffer_load_dwordx4 v9, s[12:15], s91 offen offset:1024 lds
    s_add_u32 m0, s62, 139264
    s_nop 0
    buffer_load_dwordx4 v10, s[12:15], s91 offen offset:0 lds
    buffer_load_dwordx4 v11, s[12:15], s91 offen offset:1024 lds
    s_add_u32 s87, s67, 4
    v_add_u32 v24, s87, v20
    v_and_b32 v24, 15, v24
    v_lshl_add_u32 v123, v24, 7, v125
    v_mov_b32 v24, 2147483648
    v_cmp_gt_u32 vcc, 32, v0
    s_nop 1
    v_cndmask_b32 v123, v24, v123, vcc
    buffer_load_dword v122, v123, s[8:11], 0 offen
    s_cmp_lg_u32 s65, 0
    s_cbranch_scc1 L_h0c0
    ds_read_b128 v[40:43], v28 offset:0
    ds_read_b128 v[44:47], v29 offset:1024
    ds_read_b128 v[48:51], v28 offset:2048
    ds_read_b128 v[52:55], v29 offset:3072
    ds_read_b128 v[56:59], v28 offset:4096
    ds_read_b128 v[60:63], v29 offset:5120
    ds_read_b128 v[64:67], v28 offset:6144
    ds_read_b128 v[68:71], v29 offset:7168
L_h0c0:
    s_cmp_lg_u32 s66, 0
    s_cbranch_scc1 L_h0r0
    ds_read_b128 v[72:75], v16
    ds_read_b128 v[76:79], v17
    ds_read_b128 v[80:83], v18
    ds_read_b128 v[84:87], v19
L_h0r0:
    s_waitcnt lgkmcnt(0)
    s_waitcnt vmcnt(14)
    s_barrier
    s_add_u32 m0, s53, 0
    s_lshl_b32 s70, s64, 7
    s_add_u32 s70, s70, s63
    buffer_load_dwordx4 v2, s[8:11], s70 offen offset:0 lds
    buffer_load_dwordx4 v3, s[8:11], s70 offen offset:1024 lds
    buffer_load_dwordx4 v4, s[8:11], s70 offen offset:2048 lds
    buffer_load_dwordx4 v5, s[8:11], s70 offen offset:3072 lds
    s_mul_i32 s91, s64, 393216
    s_add_u32 s64, s64, 1
    s_and_b32 s64, s64, 15
    s_add_u32 m0, s62, 0
    s_nop 0
    buffer_load_dwordx4 v6, s[12:15], s91 offen offset:0 lds
    buffer_load_dwordx4 v7, s[12:15], s91 offen offset:1024 lds
    s_add_u32 m0, s62, 8192
    s_nop 0
    buffer_load_dwordx4 v8, s[12:15], s91 offen offset:0 lds
    buffer_load_dwordx4 v9, s[12:15], s91 offen offset:1024 lds
    s_add_u32 m0, s62, 16384
    s_nop 0
    buffer_load_dwordx4 v10, s[12:15], s91 offen offset:0 lds
    buffer_load_dwordx4 v11, s[12:15], s91 offen offset:1024 lds
    s_cmp_lg_u32 s65, 1
    s_cbranch_scc1 L_h0c1
    ds_read_b128 v[40:43], v28 offset:0
    ds_read_b128 v[44:47], v29 offset:1024
    ds_read_b128 v[48:51], v28 offset:2048
    ds_read_b128 v[52:55], v29 offset:3072
    ds_read_b128 v[56:59], v28 offset:4096
    ds_read_b128 v[60:63], v29 offset:5120
    ds_read_b128 v[64:67], v28 offset:6144
    ds_read_b128 v[68:71], v29 offset:7168
L_h0c1:
    s_cmp_lg_u32 s66, 1
    s_cbranch_scc1 L_h0r1
    ds_read_b128 v[72:75], v16
    ds_read_b128 v[76:79], v17
    ds_read_b128 v[80:83], v18
    ds_read_b128 v[84:87], v19
L_h0r1:
    s_waitcnt lgkmcnt(0)
    s_waitcnt vmcnt(11)
    s_barrier
    s_add_u32 m0, s53, 40960
    s_lshl_b32 s70, s64, 7
    s_add_u32 s70, s70, s63
    buffer_load_dwordx4 v2, s[8:11], s70 offen offset:0 lds
    buffer_load_dwordx4 v3, s[8:11], s70 offen offset:1024 lds
    buffer_load_dwordx4 v4, s[8:11], s70 offen offset:2048 lds
    buffer_load_dwordx4 v5, s[8:11], s70 offen offset:3072 lds
    s_mul_i32 s91, s64, 393216
    s_add_u32 s64, s64, 1
    s_and_b32 s64, s64, 15
    s_add_u32 m0, s62, 40960
    s_nop 0
    buffer_load_dwordx4 v6, s[12:15], s91 offen offset:0 lds
    buffer_load_dwordx4 v7, s[12:15], s91 offen offset:1024 lds
    s_add_u32 m0, s62, 49152
    s_nop 0
    buffer_load_dwordx4 v8, s[12:15], s91 offen offset:0 lds
    buffer_load_dwordx4 v9, s[12:15], s91 offen offset:1024 lds
    s_add_u32 m0, s62, 57344
    s_nop 0
    buffer_load_dwordx4 v10, s[12:15], s91 offen offset:0 lds
    buffer_load_dwordx4 v11, s[12:15], s91 offen offset:1024 lds
    s_cmp_lg_u32 s65, 2
    s_cbranch_scc1 L_h0c2
    ds_read_b128 v[40:43], v28 offset:0
    ds_read_b128 v[44:47], v29 offset:1024
    ds_read_b128 v[48:51], v28 offset:2048
    ds_read_b128 v[52:55], v29 offset:3072
    ds_read_b128 v[56:59], v28 offset:4096
    ds_read_b128 v[60:63], v29 offset:5120
    ds_read_b128 v[64:67], v28 offset:6144
    ds_read_b128 v[68:71], v29 offset:7168
L_h0c2:
    s_cmp_lg_u32 s66, 2
    s_cbranch_scc1 L_h0r2
    ds_read_b128 v[72:75], v16
    ds_read_b128 v[76:79], v17
    ds_read_b128 v[80:83], v18
    ds_read_b128 v[84:87], v19
L_h0r2:
    s_waitcnt lgkmcnt(0)
    s_waitcnt vmcnt(10)
    s_barrier
    s_add_u32 m0, s53, 81920
    s_lshl_b32 s70, s64, 7
    s_add_u32 s70, s70, s63
    buffer_load_dwordx4 v2, s[8:11], s70 offen offset:0 lds
    buffer_load_dwordx4 v3, s[8:11], s70 offen offset:1024 lds
    buffer_load_dwordx4 v4, s[8:11], s70 offen offset:2048 lds
    buffer_load_dwordx4 v5, s[8:11], s70 offen offset:3072 lds
    s_mul_i32 s91, s64, 393216
    s_add_u32 s64, s64, 1
    s_and_b32 s64, s64, 15
    s_add_u32 m0, s62, 81920
    s_nop 0
L_walkB0:
    s_cbranch_execz L_walk_4
    buffer_load_dwordx4 v6, s[12:15], s91 offen offset:0 lds
    buffer_load_dwordx4 v7, s[12:15], s91 offen offset:1024 lds
    s_add_u32 m0, s62, 90112
    s_nop 0
    buffer_load_dwordx4 v8, s[12:15], s91 offen offset:0 lds
    buffer_load_dwordx4 v9, s[12:15], s91 offen offset:1024 lds
    s_add_u32 m0, s62, 98304
    s_nop 0
    buffer_load_dwordx4 v10, s[12:15], s91 offen offset:0 lds
    buffer_load_dwordx4 v11, s[12:15], s91 offen offset:1024 lds
    s_lshr_b32 s90, s67, 2
    s_add_u32 s90, s90, 2
    s_and_b32 s90, s90, 3
    s_mul_i32 s90, s90, 1572864
    buffer_load_dword v39, v37, s[12:15], s90 offen
    s_cmp_lg_u32 s65, 3
    s_cbranch_scc1 L_h0c3
    ds_read_b128 v[40:43], v28 offset:0
    ds_read_b128 v[44:47], v29 offset:1024
    ds_read_b128 v[48:51], v28 offset:2048
    ds_read_b128 v[52:55], v29 offset:3072
    ds_read_b128 v[56:59], v28 offset:4096
    ds_read_b128 v[60:63], v29 offset:5120
    ds_read_b128 v[64:67], v28 offset:6144
    ds_read_b128 v[68:71], v29 offset:7168
L_h0c3:
    s_cmp_lg_u32 s66, 3
    s_cbranch_scc1 L_h0r3
    ds_read_b128 v[72:75], v16
    ds_read_b128 v[76:79], v17
    ds_read_b128 v[80:83], v18
    ds_read_b128 v[84:87], v19
L_h0r3:
    s_waitcnt lgkmcnt(0)
    s_waitcnt vmcnt(11)
    s_barrier
    s_add_u32 m0, s53, 122880
    s_lshl_b32 s70, s64, 7
    s_add_u32 s70, s70, s63
    buffer_load_dwordx4 v2, s[8:11], s70 offen offset:0 lds
    buffer_load_dwordx4 v3, s[8:11], s70 offen offset:1024 lds
    buffer_load_dwordx4 v4, s[8:11], s70 offen offset:2048 lds
    buffer_load_dwordx4 v5, s[8:11], s70 offen offset:3072 lds
    s_mul_i32 s91, s64, 393216
    s_add_u32 s64, s64, 1
    s_and_b32 s64, s64, 15
    s_add_u32 m0, s62, 122880
    s_nop 0
    buffer_load_dwordx4 v6, s[12:15], s91 offen offset:0 lds
    buffer_load_dwordx4 v7, s[12:15], s91 offen offset:1024 lds
    s_add_u32 m0, s62, 131072
    s_nop 0
    buffer_load_dwordx4 v8, s[12:15], s91 offen offset:0 lds
    buffer_load_dwordx4 v9, s[12:15], s91 offen offset:1024 lds
    s_add_u32 m0, s62, 139264
    s_nop 0
    buffer_load_dwordx4 v10, s[12:15], s91 offen offset:0 lds
    buffer_load_dwordx4 v11, s[12:15], s91 offen offset:1024 lds
    s_cmp_lg_u32 s65, 4
    s_cbranch_scc1 L_h0c4
    ds_read_b128 v[40:43], v28 offset:0
    ds_read_b128 v[44:47], v29 offset:1024
    ds_read_b128 v[48:51], v28 offset:2048
    ds_read_b128 v[52:55], v29 offset:3072
    ds_read_b128 v[56:59], v28 offset:4096
    ds_read_b128 v[60:63], v29 offset:5120
    ds_read_b128 v[64:67], v28 offset:6144
    ds_read_b128 v[68:71], v29 offset:7168
L_h0c4:
    s_waitcnt lgkmcnt(0)
    v_mov_b32 v88, 0
    v_mov_b32 v89, 0
    v_mov_b32 v90, 0
    v_mov_b32 v91, 0
    v_mov_b32 v92, 0
    v_mov_b32 v93, 0
    v_mov_b32 v94, 0
    v_mov_b32 v95, 0
    v_dot2c_f32_bf16 v88, s95, v72
    v_dot2c_f32_bf16 v89, s95, v73
    v_dot2c_f32_bf16 v90, s95, v74
    v_dot2c_f32_bf16 v91, s95, v75
    v_dot2c_f32_bf16 v92, v72, v72
    v_dot2c_f32_bf16 v93, v73, v73
    v_dot2c_f32_bf16 v94, v74, v74
    v_dot2c_f32_bf16 v95, v75, v75
    v_dot2c_f32_bf16 v88, s95, v76
    v_dot2c_f32_bf16 v89, s95, v77
    v_dot2c_f32_bf16 v90, s95, v78
    v_dot2c_f32_bf16 v91, s95, v79
    v_dot2c_f32_bf16 v92, v76, v76
    v_dot2c_f32_bf16 v93, v77, v77
    v_dot2c_f32_bf16 v94, v78, v78
    v_dot2c_f32_bf16 v95, v79, v79
    v_dot2c_f32_bf16 v88, s95, v80
    v_dot2c_f32_bf16 v89, s95, v81
    v_dot2c_f32_bf16 v90, s95, v82
    v_dot2c_f32_bf16 v91, s95, v83
    v_dot2c_f32_bf16 v92, v80, v80
    v_dot2c_f32_bf16 v93, v81, v81
    v_dot2c_f32_bf16 v94, v82, v82
    v_dot2c_f32_bf16 v95, v83, v83
    v_dot2c_f32_bf16 v88, s95, v84
    v_dot2c_f32_bf16 v89, s95, v85
    v_dot2c_f32_bf16 v90, s95, v86
    v_dot2c_f32_bf16 v91, s95, v87
    v_dot2c_f32_bf16 v92, v84, v84
    v_dot2c_f32_bf16 v93, v85, v85
    v_dot2c_f32_bf16 v94, v86, v86
    v_dot2c_f32_bf16 v95, v87, v87
    s_waitcnt vmcnt(11)
    s_barrier
    s_add_u32 m0, s53, 0
    s_lshl_b32 s70, s64, 7
    s_add_u32 s70, s70, s63
    buffer_load_dwordx4 v2, s[8:11], s70 offen offset:0 lds
    buffer_load_dwordx4 v3, s[8:11], s70 offen offset:1024 lds
    buffer_load_dwordx4 v4, s[8:11], s70 offen offset:2048 lds
    buffer_load_dwordx4 v5, s[8:11], s70 offen offset:3072 lds
    s_mul_i32 s91, s64, 393216
    s_add_u32 s64, s64, 1
    s_and_b32 s64, s64, 15
    s_add_u32 m0, s62, 0
    s_nop 0
    buffer_load_dwordx4 v6, s[12:15], s91 offen offset:0 lds
    buffer_load_dwordx4 v7, s[12:15], s91 offen offset:1024 lds
    s_add_u32 m0, s62, 8192
    s_nop 0
    buffer_load_dwordx4 v8, s[12:15], s91 offen offset:0 lds
    buffer_load_dwordx4 v9, s[12:15], s91 offen offset:1024 lds
    s_add_u32 m0, s62, 16384
    s_nop 0
    buffer_load_dwordx4 v10, s[12:15], s91 offen offset:0 lds
    buffer_load_dwordx4 v11, s[12:15], s91 offen offset:1024 lds
    buffer_load_dword v39, v38, s[20:23], 0 offen
    s_cmp_lg_u32 s65, 5
    s_cbranch_scc1 L_h0c5
    ds_read_b128 v[40:43], v28 offset:0
    ds_read_b128 v[44:47], v29 offset:1024
    ds_read_b128 v[48:51], v28 offset:2048
    ds_read_b128 v[52:55], v29 offset:3072
    ds_read_b128 v[56:59], v28 offset:4096
    ds_read_b128 v[60:63], v29 offset:5120
    ds_read_b128 v[64:67], v28 offset:6144
    ds_read_b128 v[68:71], v29 offset:7168
L_h0c5:
    s_waitcnt lgkmcnt(0)
    v_pk_add_f32 v[88:89], v[88:89], v[90:91]
    v_pk_add_f32 v[92:93], v[92:93], v[94:95]
    v_add_f32 v88, v88, v89
    v_add_f32 v89, v92, v93
    s_nop 0
    v_add_f32_dpp v88, v88, v88 quad_perm:[1,0,3,2] row_mask:0xf bank_mask:0xf
    v_add_f32_dpp v89, v89, v89 quad_perm:[1,0,3,2] row_mask:0xf bank_mask:0xf
    s_nop 0
    v_mov_b32_dpp v90, v88 quad_perm:[2,2,2,2] row_mask:0xf bank_mask:0xf
    v_mov_b32_dpp v91, v89 quad_perm:[2,2,2,2] row_mask:0xf bank_mask:0xf
    buffer_store_dwordx4 v[88:91], v13, s[16:19], 0 offen sc1
    s_lshl_b32 s86, s48, 7
    s_add_u32 s86, s86, 131072
    v_lshl_add_u32 v16, v23, 3, s86
    v_lshrrev_b32 v17, 5, v0
    v_lshl_add_u32 v16, v17, 2, v16
    s_lshl_b32 s86, s48, 8
    s_add_u32 s86, s86, 132608
    v_lshl_add_u32 v17, v23, 4, s86
    v_lshl_add_u32 v17, v22, 2, v17
    s_waitcnt vmcnt(12)
    s_barrier
    s_add_u32 m0, s53, 40960
    s_lshl_b32 s70, s64, 7
    s_add_u32 s70, s70, s63
    buffer_load_dwordx4 v2, s[8:11], s70 offen offset:0 lds
    buffer_load_dwordx4 v3, s[8:11], s70 offen offset:1024 lds
    buffer_load_dwordx4 v4, s[8:11], s70 offen offset:2048 lds
    buffer_load_dwordx4 v5, s[8:11], s70 offen offset:3072 lds
    s_mul_i32 s91, s64, 393216
    s_add_u32 s64, s64, 1
    s_and_b32 s64, s64, 15
    s_add_u32 m0, s62, 40960
    s_nop 0
    buffer_load_dwordx4 v6, s[12:15], s91 offen offset:0 lds
    buffer_load_dwordx4 v7, s[12:15], s91 offen offset:1024 lds
    s_add_u32 m0, s62, 49152
    s_nop 0
L_walkB1:
    s_cbranch_execz L_walk_5
    buffer_load_dwordx4 v8, s[12:15], s91 offen offset:0 lds
    buffer_load_dwordx4 v9, s[12:15], s91 offen offset:1024 lds
    s_add_u32 m0, s62, 57344
    s_nop 0
    buffer_load_dwordx4 v10, s[12:15], s91 offen offset:0 lds
    buffer_load_dwordx4 v11, s[12:15], s91 offen offset:1024 lds
    s_lshr_b32 s90, s67, 2
    s_add_u32 s90, s90, 3
    s_and_b32 s90, s90, 3
    s_mul_i32 s90, s90, 1572864
    buffer_load_dword v39, v37, s[12:15], s90 offen
    s_cmp_lg_u32 s65, 6
    s_cbranch_scc1 L_h0c6
    ds_read_b128 v[40:43], v28 offset:0
    ds_read_b128 v[44:47], v29 offset:1024
    ds_read_b128 v[48:51], v28 offset:2048
    ds_read_b128 v[52:55], v29 offset:3072
    ds_read_b128 v[56:59], v28 offset:4096
    ds_read_b128 v[60:63], v29 offset:5120
    ds_read_b128 v[64:67], v28 offset:6144
    ds_read_b128 v[68:71], v29 offset:7168
L_h0c6:
    s_waitcnt lgkmcnt(0)
    s_waitcnt vmcnt(13)
    s_barrier
    s_add_u32 m0, s53, 81920
    s_lshl_b32 s70, s64, 7
    s_add_u32 s70, s70, s63
    buffer_load_dwordx4 v2, s[8:11], s70 offen offset:0 lds
    buffer_load_dwordx4 v3, s[8:11], s70 offen offset:1024 lds
    buffer_load_dwordx4 v4, s[8:11], s70 offen offset:2048 lds
    buffer_load_dwordx4 v5, s[8:11], s70 offen offset:3072 lds
    s_mul_i32 s91, s64, 393216
    s_add_u32 s64, s64, 1
    s_and_b32 s64, s64, 15
    s_add_u32 m0, s62, 81920
    s_nop 0
    buffer_load_dwordx4 v6, s[12:15], s91 offen offset:0 lds
    buffer_load_dwordx4 v7, s[12:15], s91 offen offset:1024 lds
    s_add_u32 m0, s62, 90112
    s_nop 0
    buffer_load_dwordx4 v8, s[12:15], s91 offen offset:0 lds
    buffer_load_dwordx4 v9, s[12:15], s91 offen offset:1024 lds
    s_add_u32 m0, s62, 98304
    s_nop 0
    buffer_load_dwordx4 v10, s[12:15], s91 offen offset:0 lds
    buffer_load_dwordx4 v11, s[12:15], s91 offen offset:1024 lds
    s_add_u32 m0, s53, 122880
    s_lshl_b32 s70, s64, 7
    s_add_u32 s70, s70, s63
    buffer_load_dwordx4 v2, s[8:11], s70 offen offset:0 lds
    buffer_load_dwordx4 v3, s[8:11], s70 offen offset:1024 lds
    s_cmp_lg_u32 s65, 7
    s_cbranch_scc1 L_h0c7
    ds_read_b128 v[40:43], v28 offset:0
    ds_read_b128 v[44:47], v29 offset:1024
    ds_read_b128 v[48:51], v28 offset:2048
    ds_read_b128 v[52:55], v29 offset:3072
    ds_read_b128 v[56:59], v28 offset:4096
    ds_read_b128 v[60:63], v29 offset:5120
    ds_read_b128 v[64:67], v28 offset:6144
    ds_read_b128 v[68:71], v29 offset:7168
L_h0c7:
    s_waitcnt lgkmcnt(0)
    v_mfma_f32_16x16x32_bf16 v[108:111], v[104:107], v[40:43], 0
    v_mfma_f32_16x16x32_bf16 v[108:111], v[104:107], v[44:47], v[108:111]
    v_mfma_f32_16x16x32_bf16 v[108:111], v[104:107], v[48:51], v[108:111]
    v_mfma_f32_16x16x32_bf16 v[108:111], v[104:107], v[52:55], v[108:111]
    v_mfma_f32_16x16x32_bf16 v[108:111], v[104:107], v[56:59], v[108:111]
    v_mfma_f32_16x16x32_bf16 v[108:111], v[104:107], v[60:63], v[108:111]
    v_mfma_f32_16x16x32_bf16 v[108:111], v[104:107], v[64:67], v[108:111]
    v_mfma_f32_16x16x32_bf16 v[108:111], v[104:107], v[68:71], v[108:111]
    s_nop 7
    v_add_f32_dpp v108, v108, v108 row_ror:8 row_mask:0xf bank_mask:0xf
    v_add_f32_dpp v109, v109, v109 row_ror:8 row_mask:0xf bank_mask:0xf
    v_add_f32_dpp v110, v110, v110 row_ror:8 row_mask:0xf bank_mask:0xf
    v_add_f32_dpp v111, v111, v111 row_ror:8 row_mask:0xf bank_mask:0xf
    buffer_store_dwordx4 v[108:111], v34, s[16:19], 0 offen sc1
    s_waitcnt vmcnt(14)
    s_barrier
    s_add_u32 m0, s53, 122880
    s_nop 0
    buffer_load_dwordx4 v4, s[8:11], s70 offen offset:2048 lds
    buffer_load_dwordx4 v5, s[8:11], s70 offen offset:3072 lds
    s_mul_i32 s91, s64, 393216
    s_add_u32 s64, s64, 1
    s_and_b32 s64, s64, 15
    s_add_u32 m0, s62, 122880
    s_nop 0
    buffer_load_dwordx4 v6, s[12:15], s91 offen offset:0 lds
    buffer_load_dwordx4 v7, s[12:15], s91 offen offset:1024 lds
    s_add_u32 m0, s62, 131072
    s_nop 0
    buffer_load_dwordx4 v8, s[12:15], s91 offen offset:0 lds
    buffer_load_dwordx4 v9, s[12:15], s91 offen offset:1024 lds
    s_add_u32 m0, s62, 139264
    s_nop 0
    buffer_load_dwordx4 v10, s[12:15], s91 offen offset:0 lds
    buffer_load_dwordx4 v11, s[12:15], s91 offen offset:1024 lds
    s_add_u32 m0, s53, 0
    s_lshl_b32 s70, s64, 7
    s_add_u32 s70, s70, s63
    buffer_load_dwordx4 v2, s[8:11], s70 offen offset:0 lds
    buffer_load_dwordx4 v3, s[8:11], s70 offen offset:1024 lds
    s_waitcnt vmcnt(10)
    s_barrier
    buffer_atomic_swap v35, v116, s[16:19], 0 offen sc1
    s_add_u32 m0, s53, 0
    s_nop 0
    buffer_load_dwordx4 v4, s[8:11], s70 offen offset:2048 lds
    buffer_load_dwordx4 v5, s[8:11], s70 offen offset:3072 lds
    s_mul_i32 s91, s64, 393216
    s_add_u32 s64, s64, 1
    s_and_b32 s64, s64, 15
    s_add_u32 m0, s62, 0
    s_nop 0
    buffer_load_dwordx4 v6, s[12:15], s91 offen offset:0 lds
    buffer_load_dwordx4 v7, s[12:15], s91 offen offset:1024 lds
    s_add_u32 m0, s62, 8192
    s_nop 0
    buffer_load_dwordx4 v8, s[12:15], s91 offen offset:0 lds
    buffer_load_dwordx4 v9, s[12:15], s91 offen offset:1024 lds
    s_add_u32 m0, s62, 16384
    s_nop 0
    buffer_load_dwordx4 v10, s[12:15], s91 offen offset:0 lds
    buffer_load_dwordx4 v11, s[12:15], s91 offen offset:1024 lds
    s_add_u32 m0, s53, 40960
    s_lshl_b32 s70, s64, 7
    s_add_u32 s70, s70, s63
    buffer_load_dwordx4 v2, s[8:11], s70 offen offset:0 lds
    buffer_load_dwordx4 v3, s[8:11], s70 offen offset:1024 lds
    buffer_load_dwordx4 v4, s[8:11], s70 offen offset:2048 lds
    buffer_load_dwordx4 v5, s[8:11], s70 offen offset:3072 lds
    s_mul_i32 s91, s64, 393216
    s_add_u32 s64, s64, 1
    s_and_b32 s64, s64, 15
    s_waitcnt vmcnt(15)
    s_barrier
    s_add_u32 m0, s62, 40960
    s_nop 0
    buffer_load_dwordx4 v6, s[12:15], s91 offen offset:0 lds
    buffer_load_dwordx4 v7, s[12:15], s91 offen offset:1024 lds
    s_add_u32 m0, s62, 49152
    s_nop 0
    buffer_load_dwordx4 v8, s[12:15], s91 offen offset:0 lds
    buffer_load_dwordx4 v9, s[12:15], s91 offen offset:1024 lds
    s_add_u32 m0, s62, 57344
    s_nop 0
    buffer_load_dwordx4 v10, s[12:15], s91 offen offset:0 lds
    buffer_load_dwordx4 v11, s[12:15], s91 offen offset:1024 lds
    s_add_u32 m0, s53, 81920
    s_lshl_b32 s70, s64, 7
    s_add_u32 s70, s70, s63
    buffer_load_dwordx4 v2, s[8:11], s70 offen offset:0 lds
    buffer_load_dwordx4 v3, s[8:11], s70 offen offset:1024 lds
    buffer_load_dwordx4 v4, s[8:11], s70 offen offset:2048 lds
    buffer_load_dwordx4 v5, s[8:11], s70 offen offset:3072 lds
    s_mul_i32 s91, s64, 393216
    s_add_u32 s64, s64, 1
    s_and_b32 s64, s64, 15
    s_add_u32 m0, s62, 81920
    s_nop 0
    buffer_load_dwordx4 v6, s[12:15], s91 offen offset:0 lds
    buffer_load_dwordx4 v7, s[12:15], s91 offen offset:1024 lds
    s_waitcnt vmcnt(16)
    s_barrier
    buffer_load_dword v121, v119, s[16:19], 0 offen sc1
L_walk_4:
    s_cbranch_execz L_walk_8
    s_add_u32 m0, s62, 90112
    s_nop 0
    buffer_load_dwordx4 v8, s[12:15], s91 offen offset:0 lds
    buffer_load_dwordx4 v9, s[12:15], s91 offen offset:1024 lds
    s_add_u32 m0, s62, 98304
    s_nop 0
    buffer_load_dwordx4 v10, s[12:15], s91 offen offset:0 lds
    buffer_load_dwordx4 v11, s[12:15], s91 offen offset:1024 lds
    s_add_u32 m0, s53, 122880
    s_lshl_b32 s70, s64, 7
    s_add_u32 s70, s70, s63
    buffer_load_dwordx4 v2, s[8:11], s70 offen offset:0 lds
    buffer_load_dwordx4 v3, s[8:11], s70 offen offset:1024 lds
    buffer_load_dwordx4 v4, s[8:11], s70 offen offset:2048 lds
    buffer_load_dwordx4 v5, s[8:11], s70 offen offset:3072 lds
    s_mul_i32 s91, s64, 393216
    s_add_u32 s64, s64, 1
    s_and_b32 s64, s64, 15
    s_add_u32 m0, s62, 122880
    s_nop 0
    buffer_load_dwordx4 v6, s[12:15], s91 offen offset:0 lds
    buffer_load_dwordx4 v7, s[12:15], s91 offen offset:1024 lds
    s_add_u32 m0, s62, 131072
    s_nop 0
    buffer_load_dwordx4 v8, s[12:15], s91 offen offset:0 lds
    buffer_load_dwordx4 v9, s[12:15], s91 offen offset:1024 lds
    s_lshr_b32 s60, s3, 2
    s_lshl_b32 s69, s51, 3
    s_lshl_b32 s86, s48, 1
    s_add_u32 s69, s69, s86
    s_add_u32 s69, s69, s60
    v_lshrrev_b32 v36, 4, v0
    v_and_b32 v37, 15, v0
    s_lshl_b32 s87, s69, 15
    s_lshl_b32 s86, s60, 14
    s_add_u32 s86, s86, s87
    s_add_u32 s86, s86, 1048576
    v_lshl_add_u32 v157, v0, 4, s86
    v_xor_b32 v158, 0x8000, v157
    s_lshl_b32 s86, s51, 1
    s_lshr_b32 s87, s48, 1
    s_add_u32 s86, s86, s87
    s_lshl_b32 s86, s86, 1
    s_add_u32 s86, s86, s60
    s_lshl_b32 s86, s86, 1
    s_and_b32 s87, s48, 1
    s_add_u32 s86, s86, s87
    s_lshl_b32 s86, s86, 7
    s_add_u32 s86, s86, 688128
    v_lshl_add_u32 v159, v0, 2, s86
    v_mov_b32 v38, 2147483648
    v_cmp_gt_u32 vcc, 16, v0
    s_nop 1
    v_cndmask_b32 v159, v38, v159, vcc
    v_bfe_u32 v38, v0, 2, 2
    v_lshl_add_u32 v38, v36, 2, v38
    v_bfe_u32 v39, v38, 1, 2
    v_lshlrev_b32 v38, 7, v38
    v_lshl_add_u32 v38, v39, 5, v38
    v_and_b32 v39, 3, v0
    v_lshl_add_u32 v38, v39, 3, v38
    s_lshl_b32 s86, s60, 16
    s_add_u32 s86, s86, 0
    v_add_u32 v144, s86, v38
    v_xor_b32 v145, 32, v144
    v_xor_b32 v146, 64, v144
    v_xor_b32 v147, 96, v144
    v_cmp_eq_u32 s[4:5], 1, v39
    v_cmp_eq_u32 s[6:7], 2, v39
    v_cmp_eq_u32 s[98:99], 3, v39
    s_lshl_b32 s86, s69, 10
    s_add_u32 s86, s86, 786432
    v_lshl_add_u32 v160, v0, 2, s86
    v_mul_u32_u24 v161, 192, v36
    v_add_u32 v160, v160, v161
    s_mov_b32 s72, 0x00f0000f
    s_mov_b32 s73, 0xf0000f00
    s_mov_b32 s74, 0x000ff000
    s_mov_b32 s75, 0x0f0000f0
    v_lshrrev_b32 v38, 2, v37
    v_lshl_add_u32 v161, v38, 4, v37
    v_lshlrev_b32 v161, 2, v161
    s_lshl_b32 s86, s3, 12
    s_add_u32 s86, s86, 131072
    v_lshl_add_u32 v162, v0, 4, s86
    v_xor_b32 v163, 0x4000, v162
    s_lshl_b32 s86, s52, 7
    v_lshl_add_u32 v36, v36, 3, s86
    s_lshl_b32 s87, s69, 15
    s_add_u32 s87, s87, s86
    s_lshl_b32 s86, s60, 6
    s_add_u32 s87, s87, s86
    v_lshl_add_u32 v39, v37, 11, s87
    v_and_b32 v38, 48, v0
    v_add_u32 v39, v39, v38
    v_xor_b32 v37, 0x8000, v39
    v_lshlrev_b32 v38, 4, v0
    s_waitcnt vmcnt(19)
    s_barrier
    v_mov_b32 v118, 0
    buffer_atomic_or v118, v117, s[16:19], 0 offen sc0 sc1
    s_add_u32 m0, s62, 139264
    s_nop 0
    buffer_load_dwordx4 v10, s[12:15], s91 offen offset:0 lds
    buffer_load_dwordx4 v11, s[12:15], s91 offen offset:1024 lds
    s_add_u32 m0, s53, 0
    s_lshl_b32 s70, s64, 7
    s_add_u32 s70, s70, s63
    buffer_load_dwordx4 v2, s[8:11], s70 offen offset:0 lds
    buffer_load_dwordx4 v3, s[8:11], s70 offen offset:1024 lds
    buffer_load_dwordx4 v4, s[8:11], s70 offen offset:2048 lds
    buffer_load_dwordx4 v5, s[8:11], s70 offen offset:3072 lds
    s_mul_i32 s91, s64, 393216
    s_add_u32 s64, s64, 1
    s_and_b32 s64, s64, 15
    s_add_u32 m0, s62, 0
    s_nop 0
    buffer_load_dwordx4 v6, s[12:15], s91 offen offset:0 lds
    buffer_load_dwordx4 v7, s[12:15], s91 offen offset:1024 lds
    s_add_u32 m0, s62, 8192
    s_nop 0
    buffer_load_dwordx4 v8, s[12:15], s91 offen offset:0 lds
    buffer_load_dwordx4 v9, s[12:15], s91 offen offset:1024 lds
    s_add_u32 m0, s62, 16384
    s_nop 0
    buffer_load_dwordx4 v10, s[12:15], s91 offen offset:0 lds
    buffer_load_dwordx4 v11, s[12:15], s91 offen offset:1024 lds
    s_waitcnt vmcnt(21)
    s_barrier
    s_waitcnt vmcnt(12)
    s_branch L_h0_chk0
L_h0_spin:
    v_mov_b32 v118, 0
    buffer_atomic_or v118, v117, s[16:19], 0 offen sc0 sc1
    s_waitcnt vmcnt(0)
L_h0_chk0:
    v_cmp_ne_u32 vcc, s68, v118
    s_nop 0
    s_and_b64 vcc, vcc, s[76:77]
    s_cbranch_vccz L_ok_1
    s_sub_u32 s56, s56, 1
    s_cbranch_scc0 L_h0_spin
    s_mov_b32 s56, 0
L_ok_1:
    buffer_load_dwordx4 v[56:59], v33, s[16:19], 0 offen sc1
    buffer_load_dwordx4 v[60:63], v33, s[16:19], s92 offen sc1
    buffer_load_dwordx4 v[64:67], v33, s[16:19], s93 offen sc1
    buffer_load_dwordx4 v[68:71], v33, s[16:19], s94 offen sc1
    buffer_load_dwordx4 v[40:43], v32, s[16:19], 0 offen offset:0 sc1
    buffer_load_dwordx4 v[44:47], v32, s[16:19], 0 offen offset:3072 sc1
    buffer_load_dwordx4 v[48:51], v32, s[16:19], s92 offen offset:2048 sc1
    buffer_load_dwordx4 v[52:55], v32, s[16:19], s93 offen offset:1024 sc1
    v_cmp_eq_u32 vcc, s83, v121
    s_nop 0
    s_cmp_eq_u32 vcc_lo, -1
    s_cselect_b32 s83, 1, 0
    s_mov_b32 s90, 0
    buffer_load_dwordx4 v[164:167], v30, s[32:35], s90 offen
    s_mov_b32 s90, 7168
    buffer_load_dwordx4 v[168:171], v30, s[32:35], s90 offen
    s_mov_b32 s90, 14336
    buffer_load_dwordx4 v[172:175], v30, s[32:35], s90 offen
    s_mov_b32 s90, 21504
    buffer_load_dwordx4 v[176:179], v30, s[32:35], s90 offen
    s_waitcnt vmcnt(22)
    s_barrier
    s_add_u32 m0, s89, 40960
    s_mov_b32 s90, 655360
    buffer_load_dwordx4 v12, s[20:23], s90 offen lds
    s_add_u32 m0, s89, 45056
    s_mov_b32 s90, 720896
    buffer_load_dwordx4 v12, s[20:23], s90 offen lds
    s_add_u32 m0, s89, 49152
    s_mov_b32 s90, 786432
    buffer_load_dwordx4 v12, s[20:23], s90 offen lds
    s_add_u32 m0, s89, 53248
    s_mov_b32 s90, 851968
    buffer_load_dwordx4 v12, s[20:23], s90 offen lds
    s_mov_b32 s90, 28672
    buffer_load_dwordx4 v[180:183], v30, s[32:35], s90 offen
    s_mov_b32 s90, 35840
    buffer_load_dwordx4 v[184:187], v30, s[32:35], s90 offen
    s_mov_b32 s90, 43008
    buffer_load_dwordx4 v[188:191], v30, s[32:35], s90 offen
L_walk_5:
    s_cbranch_execz L_walk_9
    s_waitcnt vmcnt(11)
    v_add_f32 v40, v40, v44
    v_add_f32 v41, v41, v45
    v_add_f32 v42, v42, v46
    v_add_f32 v43, v43, v47
    v_add_f32 v40, v40, v48
    v_add_f32 v41, v41, v49
    v_add_f32 v42, v42, v50
    v_add_f32 v43, v43, v51
    v_add_f32 v40, v40, v52
    v_add_f32 v41, v41, v53
    v_add_f32 v42, v42, v54
    v_add_f32 v43, v43, v55
    v_add_f32 v56, v56, v60
    v_add_f32 v57, v57, v61
    v_add_f32 v58, v58, v62
    v_add_f32 v59, v59, v63
    v_add_f32 v56, v56, v64
    v_add_f32 v57, v57, v65
    v_add_f32 v58, v58, v66
    v_add_f32 v59, v59, v67
    v_add_f32 v56, v56, v68
    v_add_f32 v57, v57, v69
    v_add_f32 v58, v58, v70
    v_add_f32 v59, v59, v71
    s_nop 0
    v_permlane32_swap_b32 v56, v58
    v_permlane32_swap_b32 v57, v59
    v_permlane32_swap_b32 v40, v42
    v_permlane32_swap_b32 v41, v43
    v_add_f32 v56, v56, v58
    v_add_f32 v57, v57, v59
    v_add_f32 v40, v40, v42
    v_add_f32 v41, v41, v43
    v_mov_b32 v58, v56
    v_mov_b32 v59, v57
    v_permlane16_swap_b32 v40, v41
    v_permlane16_swap_b32 v56, v58
    v_permlane16_swap_b32 v57, v59
    v_add_f32 v40, v40, v41
    v_add_f32 v56, v56, v58
    v_add_f32 v57, v57, v59
    v_mul_f32 v56, 0x3a800000, v56
    v_mul_f32 v57, 0x3a800000, v57
    v_fma_f32 v57, -v56, v56, v57
    v_max_f32 v57, 0, v57
    v_cvt_pk_bf16_f32 v48, v56, v57
    v_lshlrev_b32 v44, 16, v48
    v_and_b32 v48, 0xffff0000, v48
    v_add_f32 v48, 0x3727c5ac, v48
    v_cvt_pk_bf16_f32 v48, v48, v48
    v_lshlrev_b32 v48, 16, v48
    v_sqrt_f32 v48, v48
    s_nop 0
    v_cvt_pk_bf16_f32 v48, v48, v48
    v_lshlrev_b32 v48, 16, v48
    v_rcp_f32 v46, v48
    v_sub_f32 v44, 0, v44
    v_mul_f32 v48, 0x3fb8aa3b, v46
    s_waitcnt vmcnt(19)
    s_barrier
    v_mov_b32 v24, 135168
    v_lshl_add_u32 v24, v21, 2, v24
    v_mov_b32 v25, 0
    ds_write_b32 v24, v25
    ds_write_b32 v24, v25 offset:28608
    ds_write_b32 v17, v40
    ds_write_b32 v16, v44
    ds_write_b32 v16, v46 offset:512
    ds_write_b32 v16, v48 offset:1024
    s_waitcnt lgkmcnt(0)
    s_add_u32 m0, s89, 57344
    s_mov_b32 s90, 917504
    buffer_load_dwordx4 v12, s[20:23], s90 offen lds
    s_add_u32 m0, s89, 61440
    s_mov_b32 s90, 983040
    buffer_load_dwordx4 v12, s[20:23], s90 offen lds
    s_add_u32 m0, s89, 65536
    s_mov_b32 s90, 1048576
    buffer_load_dwordx4 v12, s[20:23], s90 offen lds
    s_add_u32 m0, s89, 69632
    s_mov_b32 s90, 1114112
    buffer_load_dwordx4 v12, s[20:23], s90 offen lds
    s_add_u32 m0, s89, 73728
    s_mov_b32 s90, 1179648
    buffer_load_dwordx4 v12, s[20:23], s90 offen lds
    s_add_u32 m0, s89, 77824
    s_mov_b32 s90, 1245184
    buffer_load_dwordx4 v12, s[20:23], s90 offen lds
    s_barrier
    s_setprio 0
    s_add_u32 m0, s89, 81920
    s_mov_b32 s90, 1310720
    buffer_load_dwordx4 v12, s[20:23], s90 offen lds
    s_add_u32 m0, s89, 86016
    s_mov_b32 s90, 1376256
    buffer_load_dwordx4 v12, s[20:23], s90 offen lds
    s_add_u32 m0, s89, 90112
    s_mov_b32 s90, 1441792
    buffer_load_dwordx4 v12, s[20:23], s90 offen lds
    s_add_u32 m0, s89, 94208
    s_mov_b32 s90, 1507328
    buffer_load_dwordx4 v12, s[20:23], s90 offen lds
    s_add_u32 m0, s89, 98304
    s_mov_b32 s90, 1572864
    buffer_load_dwordx4 v12, s[20:23], s90 offen lds
    s_add_u32 m0, s89, 102400
    s_mov_b32 s90, 1638400
    buffer_load_dwordx4 v12, s[20:23], s90 offen lds
    s_add_u32 m0, s89, 0
    s_mov_b32 s90, 0
    buffer_load_dwordx4 v12, s[20:23], s90 offen lds
    s_add_u32 m0, s89, 4096
    s_mov_b32 s90, 65536
    buffer_load_dwordx4 v12, s[20:23], s90 offen lds
    s_add_u32 m0, s89, 8192
    s_mov_b32 s90, 131072
    buffer_load_dwordx4 v12, s[20:23], s90 offen lds
    s_add_u32 m0, s89, 12288
    s_mov_b32 s90, 196608
    buffer_load_dwordx4 v12, s[20:23], s90 offen lds
    s_add_u32 m0, s89, 16384
    s_mov_b32 s90, 262144
    buffer_load_dwordx4 v12, s[20:23], s90 offen lds
    s_add_u32 m0, s89, 20480
    s_mov_b32 s90, 327680
    buffer_load_dwordx4 v12, s[20:23], s90 offen lds
    s_add_u32 m0, s89, 24576
    s_mov_b32 s90, 393216
    buffer_load_dwordx4 v12, s[20:23], s90 offen lds
    s_add_u32 m0, s89, 28672
    s_mov_b32 s90, 458752
    buffer_load_dwordx4 v12, s[20:23], s90 offen lds
    s_add_u32 m0, s89, 32768
    s_mov_b32 s90, 524288
    buffer_load_dwordx4 v12, s[20:23], s90 offen lds
    s_add_u32 m0, s89, 36864
    s_mov_b32 s90, 589824
    buffer_load_dwordx4 v12, s[20:23], s90 offen lds
    s_lshl_b32 s86, s47, 2
    s_add_u32 s86, s86, s48
    s_lshl_b32 s87, s86, 7
    s_add_u32 s87, s87, 671744
    v_lshl_add_u32 v6, v0, 2, s87
    v_mov_b32 v4, 2147483648
    v_cmp_gt_u32 vcc, 16, v0
    s_nop 1
    v_cndmask_b32 v6, v4, v6, vcc
    s_lshl_b32 s86, s86, 14
    s_add_u32 s86, s86, 5242880
    v_lshl_add_u32 v2, v0, 4, s86
    s_lshl_b32 s86, s47, 1
    s_add_u32 s86, s86, s50
    s_lshl_b32 s86, s86, 11
    s_lshl_b32 s87, s49, 10
    s_add_u32 s86, s86, s87
    s_add_u32 s86, s86, 6881280
    v_lshl_add_u32 v3, v23, 6, s86
    v_lshl_add_u32 v3, v22, 4, v3
    v_mov_b32 v112, 0
    v_mov_b32 v113, 0
    v_mov_b32 v114, 0
    v_mov_b32 v115, 0
    v_mov_b32 v116, 0
    v_mov_b32 v117, 0
    v_mov_b32 v118, 0
    v_mov_b32 v119, 0
    s_mov_b32 s53, s69
    s_mov_b32 s62, s60
    buffer_load_dwordx2 v[148:149], v36, s[40:43], 0 offen offset:0
    buffer_load_dwordx2 v[150:151], v36, s[40:43], 0 offen offset:32
    buffer_load_dwordx2 v[152:153], v36, s[40:43], 0 offen offset:64
L_walk_6:
    s_cbranch_execz L_walk_13
    buffer_load_dwordx2 v[154:155], v36, s[40:43], 0 offen offset:96
    buffer_load_dwordx4 v[128:131], v38, s[40:43], 0 offen
    buffer_load_dwordx4 v[132:135], v38, s[40:43], 0 offen offset:1024
    buffer_load_dwordx4 v[136:139], v39, s[8:11], 0 offen
    buffer_load_dwordx4 v[140:143], v37, s[8:11], 0 offen
    s_mov_b32 s90, 50176
    buffer_load_dwordx4 v[192:195], v30, s[32:35], s90 offen
    s_mov_b32 s90, 57344
    buffer_load_dwordx4 v[196:199], v30, s[32:35], s90 offen
    s_mov_b32 s90, 64512
    buffer_load_dwordx4 v[200:203], v30, s[32:35], s90 offen
    s_waitcnt vmcnt(5)
    v_mov_b32 v4, 0
    buffer_atomic_or v4, v6, s[16:19], 0 offen sc0 sc1
    v_bfe_u32 v36, v0, 2, 1
    v_cmp_eq_u32 vcc, 1, v36
    v_mov_b32 v36, s95
    v_mov_b32 v38, 0
    v_dot2c_f32_bf16 v38, s95, v128
    v_dot2c_f32_bf16 v38, s95, v129
    v_dot2c_f32_bf16 v38, s95, v130
    v_dot2c_f32_bf16 v38, s95, v131
    v_dot2c_f32_bf16 v38, s95, v132
    v_dot2c_f32_bf16 v38, s95, v133
    v_dot2c_f32_bf16 v38, s95, v134
    v_dot2c_f32_bf16 v38, s95, v135
    v_cndmask_b32 v148, v36, v148, vcc
    v_cndmask_b32 v149, v36, v149, vcc
    v_cndmask_b32 v150, v36, v150, vcc
    v_cndmask_b32 v151, v36, v151, vcc
    v_cndmask_b32 v152, v36, v152, vcc
    v_cndmask_b32 v153, v36, v153, vcc
    v_cndmask_b32 v154, v36, v154, vcc
    v_cndmask_b32 v155, v36, v155, vcc
    v_add_f32_dpp v38, v38, v38 row_ror:8 row_mask:0xf bank_mask:0xf
    s_nop 1
    v_add_f32_dpp v38, v38, v38 row_ror:4 row_mask:0xf bank_mask:0xf
    s_nop 1
    v_add_f32_dpp v38, v38, v38 row_ror:2 row_mask:0xf bank_mask:0xf
    s_nop 1
    v_add_f32_dpp v38, v38, v38 row_ror:1 row_mask:0xf bank_mask:0xf
    v_mov_b32 v36, v38
    s_nop 1
    v_permlane32_swap_b32 v38, v36
    v_add_f32 v38, v38, v36
    v_mov_b32 v36, v38
    s_nop 1
    v_permlane16_swap_b32 v38, v36
    v_add_f32 v38, v38, v36
    v_mov_b32 v36, 135200
    v_readfirstlane_b32 s57, v38
    ds_write_b32 v36, v38
    s_mul_i32 s86, s50, 3072
    s_add_u32 s86, s86, 151552
    v_lshl_add_u32 v7, v0, 4, s86
    s_lshl_b32 s86, s49, 10
    v_add_u32 v5, s86, v7
    s_lshl_b32 s86, s49, 3
    v_add_u32 v7, s86, v7
    s_mov_b32 s88, 0xffff0000
    s_mov_b32 s86, 0x00003f80
    s_mov_b32 s87, 0x3f800000
    s_branch L_h1_w0
L_h1_r0:
    s_ff1_i32_b32 s66, s65
    s_bitset0_b32 s65, s66
    s_lshl_b32 s66, s66, 10
    buffer_load_dwordx4 v[40:43], v2, s[16:19], s66 offen sc1
    s_cmp_eq_u32 s65, 0
    s_cbranch_scc1 L_h1_p1
L_h1_r1:
    s_ff1_i32_b32 s66, s65
    s_bitset0_b32 s65, s66
    s_lshl_b32 s66, s66, 10
    buffer_load_dwordx4 v[44:47], v2, s[16:19], s66 offen sc1
    s_cmp_eq_u32 s65, 0
    s_cbranch_scc1 L_h1_p2
L_h1_r2:
    s_ff1_i32_b32 s66, s65
    s_bitset0_b32 s65, s66
    s_lshl_b32 s66, s66, 10
    buffer_load_dwordx4 v[48:51], v2, s[16:19], s66 offen sc1
    s_cmp_eq_u32 s65, 0
    s_cbranch_scc1 L_h1_p3
L_h1_r3:
    s_ff1_i32_b32 s66, s65
    s_bitset0_b32 s65, s66
    s_lshl_b32 s66, s66, 10
    buffer_load_dwordx4 v[52:55], v2, s[16:19], s66 offen sc1
    s_cmp_eq_u32 s65, 0
    s_cbranch_scc1 L_h1_p4
L_h1_r4:
    s_ff1_i32_b32 s66, s65
    s_bitset0_b32 s65, s66
    s_lshl_b32 s66, s66, 10
    buffer_load_dwordx4 v[56:59], v2, s[16:19], s66 offen sc1
    s_cmp_eq_u32 s65, 0
    s_cbranch_scc1 L_h1_p5
L_h1_r5:
    s_ff1_i32_b32 s66, s65
    s_bitset0_b32 s65, s66
    s_lshl_b32 s66, s66, 10
    buffer_load_dwordx4 v[60:63], v2, s[16:19], s66 offen sc1
    s_cmp_eq_u32 s65, 0
    s_cbranch_scc1 L_h1_p6
L_h1_r6:
    s_ff1_i32_b32 s66, s65
    s_bitset0_b32 s65, s66
    s_lshl_b32 s66, s66, 10
    buffer_load_dwordx4 v[64:67], v2, s[16:19], s66 offen sc1
    s_cmp_eq_u32 s65, 0
    s_cbranch_scc1 L_h1_p7
L_h1_r7:
    s_ff1_i32_b32 s66, s65
    s_bitset0_b32 s65, s66
    s_lshl_b32 s66, s66, 10
    buffer_load_dwordx4 v[68:71], v2, s[16:19], s66 offen sc1
    s_cmp_eq_u32 s65, 0
    s_cbranch_scc1 L_h1_p8
L_h1_r8:
    s_ff1_i32_b32 s66, s65
    s_bitset0_b32 s65, s66
    s_lshl_b32 s66, s66, 10
    buffer_load_dwordx4 v[72:75], v2, s[16:19], s66 offen sc1
    s_cmp_eq_u32 s65, 0
    s_cbranch_scc1 L_h1_p9
L_h1_r9:
    s_ff1_i32_b32 s66, s65
    s_bitset0_b32 s65, s66
    s_lshl_b32 s66, s66, 10
    buffer_load_dwordx4 v[76:79], v2, s[16:19], s66 offen sc1
    s_cmp_eq_u32 s65, 0
    s_cbranch_scc1 L_h1_p10
L_h1_r10:
    s_ff1_i32_b32 s66, s65
    s_bitset0_b32 s65, s66
    s_lshl_b32 s66, s66, 10
    buffer_load_dwordx4 v[80:83], v2, s[16:19], s66 offen sc1
    s_cmp_eq_u32 s65, 0
    s_cbranch_scc1 L_h1_p11
L_h1_r11:
    s_ff1_i32_b32 s66, s65
    s_bitset0_b32 s65, s66
    s_lshl_b32 s66, s66, 10
    buffer_load_dwordx4 v[84:87], v2, s[16:19], s66 offen sc1
    s_cmp_eq_u32 s65, 0
    s_cbranch_scc1 L_h1_p12
L_h1_r12:
    s_ff1_i32_b32 s66, s65
    s_bitset0_b32 s65, s66
    s_lshl_b32 s66, s66, 10
    buffer_load_dwordx4 v[88:91], v2, s[16:19], s66 offen sc1
    s_cmp_eq_u32 s65, 0
    s_cbranch_scc1 L_h1_p13
L_h1_r13:
    s_ff1_i32_b32 s66, s65
    s_bitset0_b32 s65, s66
    s_lshl_b32 s66, s66, 10
    buffer_load_dwordx4 v[92:95], v2, s[16:19], s66 offen sc1
    s_cmp_eq_u32 s65, 0
    s_cbranch_scc1 L_h1_p14
L_h1_r14:
    s_ff1_i32_b32 s76, s65
    s_bitset0_b32 s65, s76
    s_lshl_b32 s76, s76, 10
    buffer_load_dwordx4 v[96:99], v2, s[16:19], s76 offen sc1
    s_cmp_eq_u32 s65, 0
    s_cbranch_scc1 L_h1_p15
L_h1_r15:
    s_ff1_i32_b32 s77, s65
    s_bitset0_b32 s65, s77
    s_lshl_b32 s77, s77, 10
    buffer_load_dwordx4 v[100:103], v2, s[16:19], s77 offen sc1
    buffer_load_dwordx4 v[104:107], v3, s[16:19], 0 offen sc1
L_h1_acc:
    s_waitcnt vmcnt(16)
    v_dot2c_f32_bf16 v112, s86, v40
    v_dot2c_f32_bf16 v113, s87, v40
    v_dot2c_f32_bf16 v114, s86, v41
    v_dot2c_f32_bf16 v115, s87, v41
    v_dot2c_f32_bf16 v116, s86, v42
    v_dot2c_f32_bf16 v117, s87, v42
    v_dot2c_f32_bf16 v118, s86, v43
    v_dot2c_f32_bf16 v119, s87, v43
    s_waitcnt vmcnt(15)
    v_dot2c_f32_bf16 v112, s86, v44
    v_dot2c_f32_bf16 v113, s87, v44
    v_dot2c_f32_bf16 v114, s86, v45
    v_dot2c_f32_bf16 v115, s87, v45
    v_dot2c_f32_bf16 v116, s86, v46
    v_dot2c_f32_bf16 v117, s87, v46
    v_dot2c_f32_bf16 v118, s86, v47
    v_dot2c_f32_bf16 v119, s87, v47
    s_waitcnt vmcnt(14)
    v_dot2c_f32_bf16 v112, s86, v48
    v_dot2c_f32_bf16 v113, s87, v48
    v_dot2c_f32_bf16 v114, s86, v49
    v_dot2c_f32_bf16 v115, s87, v49
    v_dot2c_f32_bf16 v116, s86, v50
    v_dot2c_f32_bf16 v117, s87, v50
    v_dot2c_f32_bf16 v118, s86, v51
    v_dot2c_f32_bf16 v119, s87, v51
    v_max3_u32 v4, v43, v47, v51
    s_waitcnt vmcnt(13)
    v_dot2c_f32_bf16 v112, s86, v52
    v_dot2c_f32_bf16 v113, s87, v52
    v_dot2c_f32_bf16 v114, s86, v53
    v_dot2c_f32_bf16 v115, s87, v53
    v_dot2c_f32_bf16 v116, s86, v54
    v_dot2c_f32_bf16 v117, s87, v54
    v_dot2c_f32_bf16 v118, s86, v55
    v_dot2c_f32_bf16 v119, s87, v55
    s_waitcnt vmcnt(12)
    v_dot2c_f32_bf16 v112, s86, v56
    v_dot2c_f32_bf16 v113, s87, v56
    v_dot2c_f32_bf16 v114, s86, v57
    v_dot2c_f32_bf16 v115, s87, v57
    v_dot2c_f32_bf16 v116, s86, v58
    v_dot2c_f32_bf16 v117, s87, v58
    v_dot2c_f32_bf16 v118, s86, v59
    v_dot2c_f32_bf16 v119, s87, v59
    v_max3_u32 v4, v4, v55, v59
    s_waitcnt vmcnt(11)
    v_dot2c_f32_bf16 v112, s86, v60
    v_dot2c_f32_bf16 v113, s87, v60
    v_dot2c_f32_bf16 v114, s86, v61
    v_dot2c_f32_bf16 v115, s87, v61
    v_dot2c_f32_bf16 v116, s86, v62
    v_dot2c_f32_bf16 v117, s87, v62
    v_dot2c_f32_bf16 v118, s86, v63
    v_dot2c_f32_bf16 v119, s87, v63
    s_waitcnt vmcnt(10)
    v_dot2c_f32_bf16 v112, s86, v64
    v_dot2c_f32_bf16 v113, s87, v64
    v_dot2c_f32_bf16 v114, s86, v65
    v_dot2c_f32_bf16 v115, s87, v65
    v_dot2c_f32_bf16 v116, s86, v66
    v_dot2c_f32_bf16 v117, s87, v66
    v_dot2c_f32_bf16 v118, s86, v67
    v_dot2c_f32_bf16 v119, s87, v67
    v_max3_u32 v4, v4, v63, v67
    s_waitcnt vmcnt(9)
    v_dot2c_f32_bf16 v112, s86, v68
    v_dot2c_f32_bf16 v113, s87, v68
    v_dot2c_f32_bf16 v114, s86, v69
    v_dot2c_f32_bf16 v115, s87, v69
    v_dot2c_f32_bf16 v116, s86, v70
    v_dot2c_f32_bf16 v117, s87, v70
    v_dot2c_f32_bf16 v118, s86, v71
    v_dot2c_f32_bf16 v119, s87, v71
L_walk_7:
    s_cbranch_execz L_walk_14
    s_waitcnt vmcnt(8)
    v_dot2c_f32_bf16 v112, s86, v72
    v_dot2c_f32_bf16 v113, s87, v72
    v_dot2c_f32_bf16 v114, s86, v73
    v_dot2c_f32_bf16 v115, s87, v73
    v_dot2c_f32_bf16 v116, s86, v74
    v_dot2c_f32_bf16 v117, s87, v74
    v_dot2c_f32_bf16 v118, s86, v75
    v_dot2c_f32_bf16 v119, s87, v75
    v_max3_u32 v4, v4, v71, v75
    s_waitcnt vmcnt(7)
    v_dot2c_f32_bf16 v112, s86, v76
    v_dot2c_f32_bf16 v113, s87, v76
    v_dot2c_f32_bf16 v114, s86, v77
    v_dot2c_f32_bf16 v115, s87, v77
    v_dot2c_f32_bf16 v116, s86, v78
    v_dot2c_f32_bf16 v117, s87, v78
    v_dot2c_f32_bf16 v118, s86, v79
    v_dot2c_f32_bf16 v119, s87, v79
    s_waitcnt vmcnt(6)
    v_dot2c_f32_bf16 v112, s86, v80
    v_dot2c_f32_bf16 v113, s87, v80
    v_dot2c_f32_bf16 v114, s86, v81
    v_dot2c_f32_bf16 v115, s87, v81
    v_dot2c_f32_bf16 v116, s86, v82
    v_dot2c_f32_bf16 v117, s87, v82
    v_dot2c_f32_bf16 v118, s86, v83
    v_dot2c_f32_bf16 v119, s87, v83
    v_max3_u32 v4, v4, v79, v83
    s_waitcnt vmcnt(5)
    v_dot2c_f32_bf16 v112, s86, v84
    v_dot2c_f32_bf16 v113, s87, v84
    v_dot2c_f32_bf16 v114, s86, v85
    v_dot2c_f32_bf16 v115, s87, v85
    v_dot2c_f32_bf16 v116, s86, v86
    v_dot2c_f32_bf16 v117, s87, v86
    v_dot2c_f32_bf16 v118, s86, v87
    v_dot2c_f32_bf16 v119, s87, v87
    s_waitcnt vmcnt(4)
    v_dot2c_f32_bf16 v112, s86, v88
    v_dot2c_f32_bf16 v113, s87, v88
    v_dot2c_f32_bf16 v114, s86, v89
    v_dot2c_f32_bf16 v115, s87, v89
    v_dot2c_f32_bf16 v116, s86, v90
    v_dot2c_f32_bf16 v117, s87, v90
    v_dot2c_f32_bf16 v118, s86, v91
    v_dot2c_f32_bf16 v119, s87, v91
    v_max3_u32 v4, v4, v87, v91
    s_waitcnt vmcnt(3)
    v_dot2c_f32_bf16 v112, s86, v92
    v_dot2c_f32_bf16 v113, s87, v92
    v_dot2c_f32_bf16 v114, s86, v93
    v_dot2c_f32_bf16 v115, s87, v93
    v_dot2c_f32_bf16 v116, s86, v94
    v_dot2c_f32_bf16 v117, s87, v94
    v_dot2c_f32_bf16 v118, s86, v95
    v_dot2c_f32_bf16 v119, s87, v95
    v_max_u32 v4, v4, v95
L_h1_chk:
    s_waitcnt vmcnt(0)
    v_max3_u32 v8, v4, v99, v103
    v_max3_u32 v8, v8, v107, v107
    v_cmp_eq_u32 vcc, -1, v8
    s_cbranch_vccnz L_h1_again
L_h1_ok:
    s_add_u32 m0, s89, 106496
    s_mov_b32 s90, 1703936
    buffer_load_dwordx4 v12, s[20:23], s90 offen lds
    s_add_u32 m0, s89, 110592
    s_mov_b32 s90, 1769472
    buffer_load_dwordx4 v12, s[20:23], s90 offen lds
    s_add_u32 m0, s89, 114688
    s_mov_b32 s90, 1835008
    buffer_load_dwordx4 v12, s[20:23], s90 offen lds
    s_add_u32 m0, s89, 118784
    s_mov_b32 s90, 1900544
    buffer_load_dwordx4 v12, s[20:23], s90 offen lds
    s_add_u32 m0, s89, 122880
    s_mov_b32 s90, 1966080
    buffer_load_dwordx4 v12, s[20:23], s90 offen lds
    s_add_u32 m0, s89, 126976
    s_mov_b32 s90, 2031616
    buffer_load_dwordx4 v12, s[20:23], s90 offen lds
    v_dot2c_f32_bf16 v112, s86, v96
    v_dot2c_f32_bf16 v113, s87, v96
    v_dot2c_f32_bf16 v114, s86, v97
    v_dot2c_f32_bf16 v115, s87, v97
    v_dot2c_f32_bf16 v116, s86, v98
    v_dot2c_f32_bf16 v117, s87, v98
    v_dot2c_f32_bf16 v118, s86, v99
    v_dot2c_f32_bf16 v119, s87, v99
    v_dot2c_f32_bf16 v112, s86, v100
    v_dot2c_f32_bf16 v113, s87, v100
    v_dot2c_f32_bf16 v114, s86, v101
    v_dot2c_f32_bf16 v115, s87, v101
    v_dot2c_f32_bf16 v116, s86, v102
    v_dot2c_f32_bf16 v117, s87, v102
    v_dot2c_f32_bf16 v118, s86, v103
    v_dot2c_f32_bf16 v119, s87, v103
    v_add_f32_dpp v104, v104, v104 row_ror:8 row_mask:0xf bank_mask:0xf
    v_add_f32_dpp v105, v105, v105 row_ror:8 row_mask:0xf bank_mask:0xf
    v_add_f32_dpp v106, v106, v106 row_ror:8 row_mask:0xf bank_mask:0xf
    v_add_f32_dpp v107, v107, v107 row_ror:8 row_mask:0xf bank_mask:0xf
    v_cvt_pk_bf16_f32 v120, v112, v113
    v_cvt_pk_bf16_f32 v121, v114, v115
    v_cvt_pk_bf16_f32 v122, v116, v117
    v_cvt_pk_bf16_f32 v123, v118, v119
    ds_write_b128 v5, v[120:123]
    v_add_f32_dpp v104, v104, v104 row_ror:4 row_mask:0xf bank_mask:0xf
    v_add_f32_dpp v105, v105, v105 row_ror:4 row_mask:0xf bank_mask:0xf
    v_add_f32_dpp v106, v106, v106 row_ror:4 row_mask:0xf bank_mask:0xf
    v_add_f32_dpp v107, v107, v107 row_ror:4 row_mask:0xf bank_mask:0xf
    v_add_f32_dpp v104, v104, v104 row_ror:2 row_mask:0xf bank_mask:0xf
    v_add_f32_dpp v105, v105, v105 row_ror:2 row_mask:0xf bank_mask:0xf
    v_add_f32_dpp v106, v106, v106 row_ror:2 row_mask:0xf bank_mask:0xf
    v_add_f32_dpp v107, v107, v107 row_ror:2 row_mask:0xf bank_mask:0xf
    v_add_f32_dpp v104, v104, v104 row_ror:1 row_mask:0xf bank_mask:0xf
    v_add_f32_dpp v105, v105, v105 row_ror:1 row_mask:0xf bank_mask:0xf
    v_add_f32_dpp v106, v106, v106 row_ror:1 row_mask:0xf bank_mask:0xf
    v_add_f32_dpp v107, v107, v107 row_ror:1 row_mask:0xf bank_mask:0xf
    v_cvt_pk_bf16_f32 v124, v104, v105
    v_cvt_pk_bf16_f32 v125, v106, v107
    ds_write_b64 v7, v[124:125] offset:2048
L_h1_done:
    s_waitcnt lgkmcnt(0)
    s_barrier
    s_or_b32 s86, s2, s48
    s_cmp_eq_u32 s86, 0
    s_cselect_b32 s86, 0, 2147483648
    s_add_u32 s86, s86, 524288
    v_mov_b32 v6, s86
    buffer_store_dword v35, v6, s[16:19], 0 offen sc1
    v_mov_b32 v11, v30
    v_mov_b32 v14, v31
    v_mov_b32 v8, 0
    buffer_atomic_or v8, v159, s[16:19], 0 offen sc0 sc1
    s_branch L_phaseB
L_h1_p0:
L_h1_w0:
    s_waitcnt vmcnt(0)
    v_cmp_eq_u32 vcc, s68, v4
    s_nop 0
    s_andn2_b32 s65, vcc_lo, s88
    s_or_b32 s88, s88, s65
    s_bcnt0_i32_b32 s90, s88
    s_cmp_le_u32 s90, 2
    s_cbranch_scc1 L_h1_r0
    v_mov_b32 v4, 0
    buffer_atomic_or v4, v6, s[16:19], 0 offen sc0 sc1
    s_mov_b32 s67, 0
    s_cmp_lg_u32 s65, 0
    s_cbranch_scc1 L_h1_r0
    s_sub_u32 s56, s56, 1
    s_cbranch_scc0 L_h1_p0
    s_mov_b32 s56, 0
    s_not_b32 s65, s88
    s_branch L_h1_r0
L_h1_p1:
    s_waitcnt vmcnt(1)
    s_cmp_eq_u32 s67, 0
    s_cbranch_scc1 L_h1_s1
    s_waitcnt vmcnt(0)
L_h1_s1:
    v_cmp_eq_u32 vcc, s68, v4
    s_nop 0
    s_andn2_b32 s65, vcc_lo, s88
    s_or_b32 s88, s88, s65
    s_bcnt0_i32_b32 s90, s88
    s_cmp_le_u32 s90, 2
    s_cbranch_scc1 L_h1_r1
    v_mov_b32 v4, 0
    buffer_atomic_or v4, v6, s[16:19], 0 offen sc0 sc1
    s_mov_b32 s67, 1
    s_cmp_lg_u32 s65, 0
    s_cbranch_scc1 L_h1_r1
    s_sub_u32 s56, s56, 1
    s_cbranch_scc0 L_h1_p1
    s_mov_b32 s56, 0
    s_not_b32 s65, s88
    s_branch L_h1_r1
L_h1_p2:
    s_waitcnt vmcnt(2)
    s_cmp_eq_u32 s67, 0
    s_cbranch_scc1 L_h1_s2
    s_waitcnt vmcnt(0)
L_h1_s2:
    v_cmp_eq_u32 vcc, s68, v4
    s_nop 0
    s_andn2_b32 s65, vcc_lo, s88
    s_or_b32 s88, s88, s65
    s_bcnt0_i32_b32 s90, s88
    s_cmp_le_u32 s90, 2
    s_cbranch_scc1 L_h1_r2
    v_mov_b32 v4, 0
    buffer_atomic_or v4, v6, s[16:19], 0 offen sc0 sc1
    s_mov_b32 s67, 2
    s_cmp_lg_u32 s65, 0
    s_cbranch_scc1 L_h1_r2
    s_sub_u32 s56, s56, 1
    s_cbranch_scc0 L_h1_p2
    s_mov_b32 s56, 0
    s_not_b32 s65, s88
    s_branch L_h1_r2
L_h1_p3:
    s_waitcnt vmcnt(3)
    s_cmp_eq_u32 s67, 0
    s_cbranch_scc1 L_h1_s3
    s_waitcnt vmcnt(0)
L_h1_s3:
    v_cmp_eq_u32 vcc, s68, v4
    s_nop 0
    s_andn2_b32 s65, vcc_lo, s88
    s_or_b32 s88, s88, s65
    s_bcnt0_i32_b32 s90, s88
    s_cmp_le_u32 s90, 2
    s_cbranch_scc1 L_h1_r3
    v_mov_b32 v4, 0
    buffer_atomic_or v4, v6, s[16:19], 0 offen sc0 sc1
    s_mov_b32 s67, 3
    s_cmp_lg_u32 s65, 0
    s_cbranch_scc1 L_h1_r3
    s_sub_u32 s56, s56, 1
    s_cbranch_scc0 L_h1_p3
    s_mov_b32 s56, 0
    s_not_b32 s65, s88
    s_branch L_h1_r3
L_walk_8:
    s_cbranch_execz L_walked
L_h1_p4:
    s_waitcnt vmcnt(4)
    s_cmp_eq_u32 s67, 0
    s_cbranch_scc1 L_h1_s4
    s_waitcnt vmcnt(0)
L_h1_s4:
    v_cmp_eq_u32 vcc, s68, v4
    s_nop 0
    s_andn2_b32 s65, vcc_lo, s88
    s_or_b32 s88, s88, s65
    s_bcnt0_i32_b32 s90, s88
    s_cmp_le_u32 s90, 2
    s_cbranch_scc1 L_h1_r4
    v_mov_b32 v4, 0
    buffer_atomic_or v4, v6, s[16:19], 0 offen sc0 sc1
    s_mov_b32 s67, 4
    s_cmp_lg_u32 s65, 0
    s_cbranch_scc1 L_h1_r4
    s_sub_u32 s56, s56, 1
    s_cbranch_scc0 L_h1_p4
    s_mov_b32 s56, 0
    s_not_b32 s65, s88
    s_branch L_h1_r4
L_h1_p5:
    s_waitcnt vmcnt(5)
    s_cmp_eq_u32 s67, 0
    s_cbranch_scc1 L_h1_s5
    s_waitcnt vmcnt(0)
L_h1_s5:
    v_cmp_eq_u32 vcc, s68, v4
    s_nop 0
    s_andn2_b32 s65, vcc_lo, s88
    s_or_b32 s88, s88, s65
    s_bcnt0_i32_b32 s90, s88
    s_cmp_le_u32 s90, 2
    s_cbranch_scc1 L_h1_r5
    v_mov_b32 v4, 0
    buffer_atomic_or v4, v6, s[16:19], 0 offen sc0 sc1
    s_mov_b32 s67, 5
    s_cmp_lg_u32 s65, 0
    s_cbranch_scc1 L_h1_r5
    s_sub_u32 s56, s56, 1
    s_cbranch_scc0 L_h1_p5
    s_mov_b32 s56, 0
    s_not_b32 s65, s88
    s_branch L_h1_r5
L_h1_p6:
    s_waitcnt vmcnt(6)
    s_cmp_eq_u32 s67, 0
    s_cbranch_scc1 L_h1_s6
    s_waitcnt vmcnt(0)
L_h1_s6:
    v_cmp_eq_u32 vcc, s68, v4
    s_nop 0
    s_andn2_b32 s65, vcc_lo, s88
    s_or_b32 s88, s88, s65
    s_bcnt0_i32_b32 s90, s88
    s_cmp_le_u32 s90, 2
    s_cbranch_scc1 L_h1_r6
    v_mov_b32 v4, 0
    buffer_atomic_or v4, v6, s[16:19], 0 offen sc0 sc1
    s_mov_b32 s67, 6
    s_cmp_lg_u32 s65, 0
    s_cbranch_scc1 L_h1_r6
    s_sub_u32 s56, s56, 1
    s_cbranch_scc0 L_h1_p6
    s_mov_b32 s56, 0
    s_not_b32 s65, s88
    s_branch L_h1_r6
L_h1_p7:
    s_waitcnt vmcnt(7)
    s_cmp_eq_u32 s67, 0
    s_cbranch_scc1 L_h1_s7
    s_waitcnt vmcnt(0)
L_h1_s7:
    v_cmp_eq_u32 vcc, s68, v4
    s_nop 0
    s_andn2_b32 s65, vcc_lo, s88
    s_or_b32 s88, s88, s65
    s_bcnt0_i32_b32 s90, s88
    s_cmp_le_u32 s90, 2
    s_cbranch_scc1 L_h1_r7
    v_mov_b32 v4, 0
    buffer_atomic_or v4, v6, s[16:19], 0 offen sc0 sc1
    s_mov_b32 s67, 7
    s_cmp_lg_u32 s65, 0
    s_cbranch_scc1 L_h1_r7
    s_sub_u32 s56, s56, 1
    s_cbranch_scc0 L_h1_p7
    s_mov_b32 s56, 0
    s_not_b32 s65, s88
    s_branch L_h1_r7
L_h1_p8:
    s_waitcnt vmcnt(8)
    s_cmp_eq_u32 s67, 0
    s_cbranch_scc1 L_h1_s8
    s_waitcnt vmcnt(0)
L_h1_s8:
    v_cmp_eq_u32 vcc, s68, v4
    s_nop 0
    s_andn2_b32 s65, vcc_lo, s88
    s_or_b32 s88, s88, s65
    s_bcnt0_i32_b32 s90, s88
    s_cmp_le_u32 s90, 2
    s_cbranch_scc1 L_h1_r8
    v_mov_b32 v4, 0
    buffer_atomic_or v4, v6, s[16:19], 0 offen sc0 sc1
    s_mov_b32 s67, 8
    s_cmp_lg_u32 s65, 0
    s_cbranch_scc1 L_h1_r8
    s_sub_u32 s56, s56, 1
    s_cbranch_scc0 L_h1_p8
    s_mov_b32 s56, 0
    s_not_b32 s65, s88
    s_branch L_h1_r8
L_h1_p9:
    s_waitcnt vmcnt(9)
    s_cmp_eq_u32 s67, 0
    s_cbranch_scc1 L_h1_s9
    s_waitcnt vmcnt(0)
L_h1_s9:
    v_cmp_eq_u32 vcc, s68, v4
    s_nop 0
    s_andn2_b32 s65, vcc_lo, s88
    s_or_b32 s88, s88, s65
    s_bcnt0_i32_b32 s90, s88
    s_cmp_le_u32 s90, 2
    s_cbranch_scc1 L_h1_r9
    v_mov_b32 v4, 0
    buffer_atomic_or v4, v6, s[16:19], 0 offen sc0 sc1
    s_mov_b32 s67, 9
    s_cmp_lg_u32 s65, 0
    s_cbranch_scc1 L_h1_r9
    s_sub_u32 s56, s56, 1
    s_cbranch_scc0 L_h1_p9
    s_mov_b32 s56, 0
    s_not_b32 s65, s88
    s_branch L_h1_r9
L_h1_p10:
    s_waitcnt vmcnt(10)
    s_cmp_eq_u32 s67, 0
    s_cbranch_scc1 L_h1_s10
    s_waitcnt vmcnt(0)
L_h1_s10:
    v_cmp_eq_u32 vcc, s68, v4
    s_nop 0
    s_andn2_b32 s65, vcc_lo, s88
    s_or_b32 s88, s88, s65
    s_bcnt0_i32_b32 s90, s88
    s_cmp_le_u32 s90, 2
    s_cbranch_scc1 L_h1_r10
    v_mov_b32 v4, 0
    buffer_atomic_or v4, v6, s[16:19], 0 offen sc0 sc1
    s_mov_b32 s67, 10
    s_cmp_lg_u32 s65, 0
    s_cbranch_scc1 L_h1_r10
    s_sub_u32 s56, s56, 1
    s_cbranch_scc0 L_h1_p10
    s_mov_b32 s56, 0
    s_not_b32 s65, s88
    s_branch L_h1_r10
L_h1_p11:
    s_waitcnt vmcnt(11)
    s_cmp_eq_u32 s67, 0
    s_cbranch_scc1 L_h1_s11
    s_waitcnt vmcnt(0)
L_h1_s11:
    v_cmp_eq_u32 vcc, s68, v4
    s_nop 0
    s_andn2_b32 s65, vcc_lo, s88
    s_or_b32 s88, s88, s65
    s_bcnt0_i32_b32 s90, s88
    s_cmp_le_u32 s90, 2
    s_cbranch_scc1 L_h1_r11
    v_mov_b32 v4, 0
    buffer_atomic_or v4, v6, s[16:19], 0 offen sc0 sc1
    s_mov_b32 s67, 11
    s_cmp_lg_u32 s65, 0
    s_cbranch_scc1 L_h1_r11
    s_sub_u32 s56, s56, 1
    s_cbranch_scc0 L_h1_p11
    s_mov_b32 s56, 0
    s_not_b32 s65, s88
    s_branch L_h1_r11
L_h1_p12:
    s_waitcnt vmcnt(12)
    s_cmp_eq_u32 s67, 0
    s_cbranch_scc1 L_h1_s12
    s_waitcnt vmcnt(0)
L_h1_s12:
    v_cmp_eq_u32 vcc, s68, v4
    s_nop 0
    s_andn2_b32 s65, vcc_lo, s88
    s_or_b32 s88, s88, s65
    s_bcnt0_i32_b32 s90, s88
    s_cmp_le_u32 s90, 2
    s_cbranch_scc1 L_h1_r12
    v_mov_b32 v4, 0
    buffer_atomic_or v4, v6, s[16:19], 0 offen sc0 sc1
    s_mov_b32 s67, 12
    s_cmp_lg_u32 s65, 0
    s_cbranch_scc1 L_h1_r12
    s_sub_u32 s56, s56, 1
    s_cbranch_scc0 L_h1_p12
    s_mov_b32 s56, 0
    s_not_b32 s65, s88
    s_branch L_h1_r12
L_h1_p13:
    s_waitcnt vmcnt(13)
    s_cmp_eq_u32 s67, 0
    s_cbranch_scc1 L_h1_s13
    s_waitcnt vmcnt(0)
L_h1_s13:
    v_cmp_eq_u32 vcc, s68, v4
    s_nop 0
    s_andn2_b32 s65, vcc_lo, s88
    s_or_b32 s88, s88, s65
    s_bcnt0_i32_b32 s90, s88
    s_cmp_le_u32 s90, 2
    s_cbranch_scc1 L_h1_r13
    v_mov_b32 v4, 0
    buffer_atomic_or v4, v6, s[16:19], 0 offen sc0 sc1
    s_mov_b32 s67, 13
    s_cmp_lg_u32 s65, 0
    s_cbranch_scc1 L_h1_r13
    s_sub_u32 s56, s56, 1
    s_cbranch_scc0 L_h1_p13
    s_mov_b32 s56, 0
    s_not_b32 s65, s88
    s_branch L_h1_r13
L_h1_p14:
    s_not_b32 s65, s88
    s_branch L_h1_r14
L_h1_p15:
    s_not_b32 s65, s88
    s_branch L_h1_r15
L_h1_again:
    s_sub_u32 s56, s56, 1
    s_cbranch_scc0 L_h1_re
    s_mov_b32 s56, 0
    s_branch L_h1_ok
L_h1_re:
    v_cmp_eq_u32 vcc, -1, v4
    s_cbranch_vccnz L_h1_all
    v_cmp_eq_u32 vcc, -1, v99
    s_cbranch_vccz L_h1_n14
    s_mov_b64 exec, vcc
    buffer_load_dwordx4 v[96:99], v2, s[16:19], s76 offen sc1
    s_mov_b64 exec, -1
L_h1_n14:
    v_cmp_eq_u32 vcc, -1, v103
    s_cbranch_vccz L_h1_n15
    s_mov_b64 exec, vcc
    buffer_load_dwordx4 v[100:103], v2, s[16:19], s77 offen sc1
    s_mov_b64 exec, -1
L_h1_n15:
    v_cmp_eq_u32 vcc, -1, v107
    s_cbranch_vccz L_h1_n16
    s_mov_b64 exec, vcc
    buffer_load_dwordx4 v[104:107], v3, s[16:19], 0 offen sc1
    s_mov_b64 exec, -1
L_h1_n16:
    s_branch L_h1_chk
L_h1_all:
    s_mov_b32 s76, 14336
    s_mov_b32 s77, 15360
    buffer_load_dwordx4 v[40:43], v2, s[16:19], 0 offen offset:0 sc1
    buffer_load_dwordx4 v[44:47], v2, s[16:19], 0 offen offset:1024 sc1
    buffer_load_dwordx4 v[48:51], v2, s[16:19], 0 offen offset:2048 sc1
    buffer_load_dwordx4 v[52:55], v2, s[16:19], 0 offen offset:3072 sc1
    buffer_load_dwordx4 v[56:59], v2, s[16:19], s92 offen offset:0 sc1
    buffer_load_dwordx4 v[60:63], v2, s[16:19], s92 offen offset:1024 sc1
L_walk_9:
    s_cbranch_execz L_walked
    buffer_load_dwordx4 v[64:67], v2, s[16:19], s92 offen offset:2048 sc1
    buffer_load_dwordx4 v[68:71], v2, s[16:19], s92 offen offset:3072 sc1
    buffer_load_dwordx4 v[72:75], v2, s[16:19], s93 offen offset:0 sc1
    buffer_load_dwordx4 v[76:79], v2, s[16:19], s93 offen offset:1024 sc1
    buffer_load_dwordx4 v[80:83], v2, s[16:19], s93 offen offset:2048 sc1
    buffer_load_dwordx4 v[84:87], v2, s[16:19], s93 offen offset:3072 sc1
    buffer_load_dwordx4 v[88:91], v2, s[16:19], s94 offen offset:0 sc1
    buffer_load_dwordx4 v[92:95], v2, s[16:19], s94 offen offset:1024 sc1
    buffer_load_dwordx4 v[96:99], v2, s[16:19], s94 offen offset:2048 sc1
    buffer_load_dwordx4 v[100:103], v2, s[16:19], s94 offen offset:3072 sc1
    buffer_load_dwordx4 v[104:107], v3, s[16:19], 0 offen sc1
    v_mov_b32 v112, 0
    v_mov_b32 v113, 0
    v_mov_b32 v114, 0
    v_mov_b32 v115, 0
    v_mov_b32 v116, 0
    v_mov_b32 v117, 0
    v_mov_b32 v118, 0
    v_mov_b32 v119, 0
    s_branch L_h1_acc
L_comp:
    s_mov_b64 exec, -1
    v_and_b32 v20, 15, v0
    v_lshrrev_b32 v21, 4, v0
    v_bfe_u32 v22, v0, 1, 3
    s_lshl_b32 s86, s49, 13
    v_lshl_add_u32 v20, v20, 7, s86
    v_or_b32 v23, 0, v21
    v_xor_b32 v23, v23, v22
    v_lshl_add_u32 v2, v23, 4, v20
    v_or_b32 v23, 4, v21
    v_xor_b32 v23, v23, v22
    v_lshl_add_u32 v3, v23, 4, v20
    v_bfe_u32 v22, v0, 2, 2
    v_lshl_add_u32 v22, v21, 3, v22
    v_lshlrev_b32 v22, 7, v22
    v_bfe_u32 v23, v0, 3, 2
    s_lshl_b32 s86, s50, 1
    v_xor_b32 v23, s86, v23
    v_lshl_add_u32 v22, v23, 5, v22
    v_and_b32 v23, 3, v0
    v_lshl_add_u32 v22, v23, 3, v22
    v_add_u32 v4, 16384, v22
    v_xor_b32 v5, 32, v4
    s_lshl_b32 s53, s2, 2
    s_add_u32 s53, s53, s3
    s_lshl_b32 s86, s53, 12
    s_add_u32 s86, s86, 1048576
    v_lshl_add_u32 v6, v0, 4, s86
    s_mul_i32 s53, s53, 160
    s_add_u32 s53, s53, 6553600
    v_lshl_add_u32 v17, v0, 4, s53
    v_mov_b32 v16, 2147483648
    v_cmp_gt_u32 vcc, 10, v0
    s_nop 1
    v_cndmask_b32 v17, v16, v17, vcc
    s_lshl2_add_u32 s86, s45, s3
    s_lshr_b32 s87, s86, 3
    s_mul_i32 s87, s87, 14336
    s_and_b32 s86, s86, 7
    s_lshl3_add_u32 s86, s44, s86
    s_mul_i32 s86, s86, 224
    s_add_u32 s86, s86, s87
    s_add_u32 s86, s86, 7864064
    v_lshl_add_u32 v16, v0, 4, s86
    s_mov_b32 vcc_lo, 0x3fff0000
    s_mov_b32 vcc_hi, 0
    v_cndmask_b32 v17, v17, v16, vcc
    s_lshl_b32 s86, s47, 1
    s_add_u32 s86, s86, s50
    s_lshl1_add_u32 s87, s86, s49
    s_lshl4_add_u32 s87, s87, s46
    s_lshl_b32 s87, s87, 6
    s_add_u32 s87, s87, 6880320
    v_lshl_add_u32 v16, v0, 4, s87
    v_cmp_le_u32 vcc, 60, v0
    s_nop 1
    v_cndmask_b32 v17, v17, v16, vcc
    s_lshl_b32 s87, s86, 1
    s_add_u32 s87, s87, s49
    s_lshl_b32 s87, s87, 4
    s_add_u32 s87, s87, s46
    s_lshl_b32 s87, s87, 10
    s_add_u32 s87, s87, 5242880
    v_lshl_add_u32 v16, v0, 4, s87
    v_mov_b32 v8, -1
    v_mov_b32 v9, -1
    v_mov_b32 v10, -1
    v_mov_b32 v11, -1
    s_waitcnt lgkmcnt(0)
    s_load_dword s61, s[84:85], 524288
    s_mov_b32 s16, s84
    s_and_b32 s17, s85, 0xffff
    s_mov_b32 s18, 268435456
    s_mov_b32 s19, 0x20000
    s_mov_b32 s8, s64
    s_and_b32 s9, s65, 0xffff
    s_mov_b32 s10, 4194304
    s_mov_b32 s11, 0x20000
    s_mov_b32 s20, s68
    s_and_b32 s21, s69, 0xffff
    s_mov_b32 s22, 2097152
    s_mov_b32 s23, 0x20000
    s_mov_b32 s24, s80
    s_and_b32 s25, s81, 0xffff
    s_mov_b32 s26, 4194304
    s_mov_b32 s27, 0x20000
    s_mov_b32 s28, s82
    s_and_b32 s29, s83, 0xffff
    s_mov_b32 s30, 256
    s_mov_b32 s31, 0x20000
    s_bitcmp1_b32 s2, 3
    s_cselect_b32 s32, s76, s74
    s_cselect_b32 s33, s77, s75
    s_and_b32 s33, s33, 0xffff
    s_mov_b32 s34, 7340032
    s_mov_b32 s35, 0x20000
    s_mov_b32 s36, s78
    s_and_b32 s37, s79, 0xffff
    s_mov_b32 s38, 7340032
    s_mov_b32 s39, 0x20000
    s_mov_b32 s40, s72
    s_and_b32 s41, s73, 0xffff
    s_mov_b32 s42, 2048
    s_mov_b32 s43, 0x20000
    s_lshl_b32 s82, s44, 5
    s_or_b32 s82, s82, s45
    s_lshl_b32 s86, s2, 9
    s_add_u32 s86, s86, 786432
    s_cmp_eq_u32 s3, 0
    s_cselect_b32 s86, s86, 2147483648
    v_lshl_add_u32 v7, v0, 2, s86
    v_mul_u32_u24 v12, 192, v21
    v_add_u32 v7, v7, v12
    s_lshl_b32 s86, s2, 8
    s_add_u32 s86, s86, 917376
    s_cmp_eq_u32 s3, 0
    s_cselect_b32 s86, s86, 2147483648
    v_lshl_add_u32 v12, v0, 2, s86
    v_cmp_gt_u32 vcc, 32, v0
    s_nop 1
    v_cndmask_b32 v7, v12, v7, vcc
    v_mov_b32 v12, 2147483648
    v_cmp_gt_u32 vcc, 48, v0
    s_nop 1
    v_cndmask_b32 v7, v12, v7, vcc
    s_lshl_b32 s86, s2, 9
    s_add_u32 s86, s86, 6291456
    v_lshl_add_u32 v13, v0, 2, s86
    v_mul_u32_u24 v12, 64, v21
    v_add_u32 v13, v13, v12
    s_cmp_eq_u32 s3, 1
    s_cselect_b64 vcc, -1, 0
    v_cndmask_b32 v7, v7, v13, vcc
    v_mov_b32 v12, 0
    buffer_store_dword v12, v7, s[16:19], 0 offen sc1
    v_mov_b32 v128, 0
    v_mov_b32 v129, 0
    v_mov_b32 v130, 0
    v_mov_b32 v131, 0
    v_mov_b32 v132, 0
    v_mov_b32 v133, 0
    v_mov_b32 v134, 0
    v_mov_b32 v135, 0
    v_mov_b32 v136, 0
    v_mov_b32 v137, 0
    v_mov_b32 v138, 0
    v_mov_b32 v139, 0
    v_mov_b32 v140, 0
    v_mov_b32 v141, 0
    v_mov_b32 v142, 0
    v_mov_b32 v143, 0
    v_mov_b32 v144, 0
    v_mov_b32 v145, 0
    v_mov_b32 v146, 0
    v_mov_b32 v147, 0
    v_mov_b32 v148, 0
    v_mov_b32 v149, 0
    v_mov_b32 v150, 0
    v_mov_b32 v151, 0
    v_mov_b32 v152, 0
    v_mov_b32 v153, 0
    v_mov_b32 v154, 0
    v_mov_b32 v155, 0
    v_mov_b32 v156, 0
    v_mov_b32 v157, 0
    v_mov_b32 v158, 0
    v_mov_b32 v159, 0
    v_mov_b32 v160, 0
    v_mov_b32 v161, 0
    v_mov_b32 v162, 0
    v_mov_b32 v163, 0
    v_mov_b32 v164, 0
    v_mov_b32 v165, 0
    v_mov_b32 v166, 0
    v_mov_b32 v167, 0
    v_mov_b32 v168, 0
    v_mov_b32 v169, 0
    v_mov_b32 v170, 0
    v_mov_b32 v171, 0
    v_mov_b32 v172, 0
    v_mov_b32 v173, 0
    v_mov_b32 v174, 0
    v_mov_b32 v175, 0
    v_mov_b32 v176, 0
    v_mov_b32 v177, 0
    v_mov_b32 v178, 0
    v_mov_b32 v179, 0
    v_mov_b32 v180, 0
    v_mov_b32 v181, 0
    v_mov_b32 v182, 0
    v_mov_b32 v183, 0
    v_mov_b32 v184, 0
    v_mov_b32 v185, 0
    v_mov_b32 v186, 0
    v_mov_b32 v187, 0
    v_mov_b32 v188, 0
    v_mov_b32 v189, 0
    v_mov_b32 v190, 0
    v_mov_b32 v191, 0
    v_mov_b32 v192, 0
    v_mov_b32 v193, 0
    v_mov_b32 v194, 0
    v_mov_b32 v195, 0
    v_mov_b32 v196, 0
    v_mov_b32 v197, 0
    v_mov_b32 v198, 0
    v_mov_b32 v199, 0
    v_mov_b32 v200, 0
    v_mov_b32 v201, 0
    v_mov_b32 v202, 0
    v_mov_b32 v203, 0
L_walkA2:
    s_cbranch_execz L_comp
    v_mov_b32 v204, 0
    v_mov_b32 v205, 0
    v_mov_b32 v206, 0
    v_mov_b32 v207, 0
    v_mov_b32 v208, 0
    v_mov_b32 v209, 0
    v_mov_b32 v210, 0
    v_mov_b32 v211, 0
    v_mov_b32 v212, 0
    v_mov_b32 v213, 0
    v_mov_b32 v214, 0
    v_mov_b32 v215, 0
    v_mov_b32 v216, 0
    v_mov_b32 v217, 0
    v_mov_b32 v218, 0
    v_mov_b32 v219, 0
    v_mov_b32 v220, 0
    v_mov_b32 v221, 0
    v_mov_b32 v222, 0
    v_mov_b32 v223, 0
    s_mov_b32 s54, 0x358637bd
    s_mov_b32 s55, 0x358637bd
    s_mul_i32 s86, s3, 3072
    s_add_u32 s86, s86, 139264
    v_lshl_add_u32 v24, v0, 4, s86
    s_xor_b32 s86, s3, 1
    s_mul_i32 s86, s86, 3072
    s_add_u32 s86, s86, 139264
    v_lshl_add_u32 v25, v0, 4, s86
    s_lshl_b32 s86, s47, 1
    s_add_u32 s86, s86, s50
    s_lshl_b32 s87, s86, 1
    s_add_u32 s87, s87, s49
    s_lshl_b32 s87, s87, 4
    s_add_u32 s87, s87, s46
    s_lshl_b32 s87, s87, 10
    s_add_u32 s87, s87, 5242880
    v_lshl_add_u32 v26, v0, 4, s87
    s_lshl1_add_u32 s87, s86, s49
    s_lshl4_add_u32 s87, s87, s46
    s_lshl_b32 s87, s87, 6
    s_add_u32 s87, s87, 6881280
    v_add_u32 v27, s87, v0
    s_mov_b32 vcc_lo, 0x00010001
    s_mov_b32 vcc_hi, vcc_lo
    v_mov_b32 v14, 2147483648
    v_cndmask_b32 v27, v14, v27, vcc
    s_lshl_b32 s87, s46, 3
    s_lshl_b32 s88, s49, 2
    s_add_u32 s87, s87, s88
    s_lshl_b32 s87, s87, 5
    s_add_u32 s87, s87, s86
    s_lshl_b32 s87, s87, 10
    s_add_u32 s87, s87, 1048576
    v_lshl_add_u32 v23, v0, 4, s87
    s_mul_i32 s87, s50, 3072
    s_add_u32 s87, s87, 151552
    v_lshl_add_u32 v20, v0, 4, s87
    s_lshl_b32 s87, s86, 1
    s_add_u32 s87, s87, s49
    s_lshl_b32 s87, s87, 5
    s_add_u32 s87, s87, s46
    s_lshl2_add_u32 s87, s87, 671744
    v_mov_b32 v19, 2147483648
    v_mov_b32 v18, 2147483648
    v_writelane_b32 v19, s87, 0
    s_lshl_b32 s87, s46, 1
    s_add_u32 s87, s87, s49
    s_lshl_b32 s87, s87, 1
    s_lshr_b32 s88, s86, 4
    s_add_u32 s87, s87, s88
    s_lshl_b32 s87, s87, 6
    s_and_b32 s88, s86, 15
    s_add_u32 s87, s87, s88
    s_lshl2_add_u32 s87, s87, 688128
    v_writelane_b32 v18, s87, 0
    s_add_u32 s87, s87, 128
    v_writelane_b32 v18, s87, 1
    v_mov_b32 v120, s95
    v_mov_b32 v121, s95
    v_mov_b32 v122, s95
    v_mov_b32 v123, s95
    s_mov_b32 s4, 0x3f317218
    s_mov_b32 s5, 0x3f317218
    s_mov_b32 s6, 0x35c1a2c6
    s_mov_b32 s62, 0
    s_mov_b32 s63, 1
    v_add_u32 v2, 40960, v2
    v_add_u32 v3, 40960, v3
    v_add_u32 v4, 40960, v4
    v_add_u32 v5, 40960, v5
    s_mov_b64 exec, 0
    s_cmp_eq_u32 s3, 0
    s_cbranch_scc1 L_walkB0
    s_cmp_eq_u32 s3, 1
    s_cbranch_scc1 L_walkB1
    s_cmp_eq_u32 s3, 2
    s_cbranch_scc1 L_walkB2
    s_branch L_walkB3
L_walked:
    s_mov_b64 exec, -1
    s_waitcnt lgkmcnt(0)
    s_add_u32 s68, s61, 0x9e3779b9
    s_barrier
    ds_read_b128 v[40:43], v2 offset:0
    ds_read_b128 v[44:47], v2 offset:2048
    ds_read_b128 v[48:51], v2 offset:4096
    ds_read_b128 v[52:55], v2 offset:6144
    ds_read_b64_tr_b16 v[56:57], v4 offset:0
    ds_read_b64_tr_b16 v[58:59], v4 offset:512
    ds_read_b64_tr_b16 v[60:61], v5 offset:0
    ds_read_b64_tr_b16 v[62:63], v5 offset:512
    ds_read_b64_tr_b16 v[64:65], v4 offset:8192
    ds_read_b64_tr_b16 v[66:67], v4 offset:8704
    ds_read_b64_tr_b16 v[68:69], v5 offset:8192
    ds_read_b64_tr_b16 v[70:71], v5 offset:8704
    ds_read_b64_tr_b16 v[72:73], v4 offset:16384
    ds_read_b64_tr_b16 v[74:75], v4 offset:16896
    ds_read_b64_tr_b16 v[76:77], v5 offset:16384
    ds_read_b64_tr_b16 v[78:79], v5 offset:16896
L_cloop:
    s_waitcnt lgkmcnt(0)
    v_mfma_f32_16x16x32_bf16 v[128:131], v[56:59], v[40:43], v[128:131]
    ds_read_b128 v[80:83], v3 offset:0
    v_mfma_f32_16x16x32_bf16 v[144:147], v[60:63], v[40:43], v[144:147]
    ds_read_b128 v[84:87], v3 offset:2048
    v_mfma_f32_16x16x32_bf16 v[148:151], v[60:63], v[44:47], v[148:151]
    ds_read_b128 v[88:91], v3 offset:4096
    v_mfma_f32_16x16x32_bf16 v[132:135], v[56:59], v[44:47], v[132:135]
    ds_read_b128 v[92:95], v3 offset:6144
    v_mfma_f32_16x16x32_bf16 v[136:139], v[56:59], v[48:51], v[136:139]
    ds_read_b64_tr_b16 v[96:97], v4 offset:4096
    v_mfma_f32_16x16x32_bf16 v[152:155], v[60:63], v[48:51], v[152:155]
    ds_read_b64_tr_b16 v[98:99], v4 offset:4608
    v_mfma_f32_16x16x32_bf16 v[156:159], v[60:63], v[52:55], v[156:159]
    ds_read_b64_tr_b16 v[100:101], v5 offset:4096
    v_mfma_f32_16x16x32_bf16 v[140:143], v[56:59], v[52:55], v[140:143]
    ds_read_b64_tr_b16 v[102:103], v5 offset:4608
    v_mfma_f32_16x16x32_bf16 v[172:175], v[52:55], v[64:67], v[172:175]
    ds_read_b64_tr_b16 v[104:105], v4 offset:12288
    v_mfma_f32_16x16x32_bf16 v[188:191], v[52:55], v[68:71], v[188:191]
    ds_read_b64_tr_b16 v[106:107], v4 offset:12800
    v_mfma_f32_16x16x32_bf16 v[184:187], v[48:51], v[68:71], v[184:187]
    ds_read_b64_tr_b16 v[108:109], v5 offset:12288
    v_mfma_f32_16x16x32_bf16 v[168:171], v[48:51], v[64:67], v[168:171]
    ds_read_b64_tr_b16 v[110:111], v5 offset:12800
    v_mfma_f32_16x16x32_bf16 v[164:167], v[44:47], v[64:67], v[164:167]
    ds_read_b64_tr_b16 v[112:113], v4 offset:20480
    v_mfma_f32_16x16x32_bf16 v[180:183], v[44:47], v[68:71], v[180:183]
    ds_read_b64_tr_b16 v[114:115], v4 offset:20992
    v_mfma_f32_16x16x32_bf16 v[176:179], v[40:43], v[68:71], v[176:179]
    ds_read_b64_tr_b16 v[116:117], v5 offset:20480
    v_mfma_f32_16x16x32_bf16 v[160:163], v[40:43], v[64:67], v[160:163]
    ds_read_b64_tr_b16 v[118:119], v5 offset:20992
    v_mfma_f32_16x16x32_bf16 v[192:195], v[40:43], v[72:75], v[192:195]
    s_add_u32 s63, s63, 1
    s_cmp_eq_u32 s63, 4
    s_cselect_b32 s53, 4294803456, 0
    s_cselect_b32 s63, 0, s63
    s_add_u32 s53, s53, 40960
    v_mfma_f32_16x16x32_bf16 v[208:211], v[40:43], v[76:79], v[208:211]
    v_add_u32 v2, s53, v2
    v_mfma_f32_16x16x32_bf16 v[212:215], v[44:47], v[76:79], v[212:215]
    v_add_u32 v4, s53, v4
    v_mfma_f32_16x16x32_bf16 v[196:199], v[44:47], v[72:75], v[196:199]
    v_add_u32 v5, s53, v5
    v_mfma_f32_16x16x32_bf16 v[200:203], v[48:51], v[72:75], v[200:203]
    v_add_u32 v3, s53, v3
    v_mfma_f32_16x16x32_bf16 v[216:219], v[48:51], v[76:79], v[216:219]
    s_cmp_ge_u32 s62, 6
    s_cbranch_scc1 L_cl_none
    buffer_store_dwordx4 v[8:11], v6, s[16:19], 0 offen sc1
    v_add_u32 v6, 1024, v6
    s_cmp_lt_u32 s62, 3
    s_cbranch_scc1 L_cl_none
    v_mov_b32 v6, v16
    v_mov_b32 v16, v17
L_cl_none:
    v_mfma_f32_16x16x32_bf16 v[220:223], v[52:55], v[76:79], v[220:223]
    v_mfma_f32_16x16x32_bf16 v[204:207], v[52:55], v[72:75], v[204:207]
    s_waitcnt lgkmcnt(0)
    v_mfma_f32_16x16x32_bf16 v[128:131], v[96:99], v[80:83], v[128:131]
L_walkB2:
    s_cbranch_execz L_walk_6
    s_barrier
    ds_read_b128 v[40:43], v2 offset:0
    v_mfma_f32_16x16x32_bf16 v[144:147], v[100:103], v[80:83], v[144:147]
    ds_read_b128 v[44:47], v2 offset:2048
    v_mfma_f32_16x16x32_bf16 v[148:151], v[100:103], v[84:87], v[148:151]
    ds_read_b128 v[48:51], v2 offset:4096
    v_mfma_f32_16x16x32_bf16 v[132:135], v[96:99], v[84:87], v[132:135]
    ds_read_b128 v[52:55], v2 offset:6144
    v_mfma_f32_16x16x32_bf16 v[136:139], v[96:99], v[88:91], v[136:139]
    ds_read_b64_tr_b16 v[56:57], v4 offset:0
    v_mfma_f32_16x16x32_bf16 v[152:155], v[100:103], v[88:91], v[152:155]
    ds_read_b64_tr_b16 v[58:59], v4 offset:512
    v_mfma_f32_16x16x32_bf16 v[156:159], v[100:103], v[92:95], v[156:159]
    ds_read_b64_tr_b16 v[60:61], v5 offset:0
    v_mfma_f32_16x16x32_bf16 v[140:143], v[96:99], v[92:95], v[140:143]
    ds_read_b64_tr_b16 v[62:63], v5 offset:512
    v_mfma_f32_16x16x32_bf16 v[172:175], v[92:95], v[104:107], v[172:175]
    ds_read_b64_tr_b16 v[64:65], v4 offset:8192
    v_mfma_f32_16x16x32_bf16 v[188:191], v[92:95], v[108:111], v[188:191]
    ds_read_b64_tr_b16 v[66:67], v4 offset:8704
    v_mfma_f32_16x16x32_bf16 v[184:187], v[88:91], v[108:111], v[184:187]
    ds_read_b64_tr_b16 v[68:69], v5 offset:8192
    v_mfma_f32_16x16x32_bf16 v[168:171], v[88:91], v[104:107], v[168:171]
    ds_read_b64_tr_b16 v[70:71], v5 offset:8704
    v_mfma_f32_16x16x32_bf16 v[164:167], v[84:87], v[104:107], v[164:167]
    ds_read_b64_tr_b16 v[72:73], v4 offset:16384
    v_mfma_f32_16x16x32_bf16 v[180:183], v[84:87], v[108:111], v[180:183]
    ds_read_b64_tr_b16 v[74:75], v4 offset:16896
    v_mfma_f32_16x16x32_bf16 v[176:179], v[80:83], v[108:111], v[176:179]
    ds_read_b64_tr_b16 v[76:77], v5 offset:16384
    v_mfma_f32_16x16x32_bf16 v[160:163], v[80:83], v[104:107], v[160:163]
    ds_read_b64_tr_b16 v[78:79], v5 offset:16896
    v_mfma_f32_16x16x32_bf16 v[192:195], v[80:83], v[112:115], v[192:195]
    v_mfma_f32_16x16x32_bf16 v[208:211], v[80:83], v[116:119], v[208:211]
    s_cmp_lg_u32 s62, 7
    s_cbranch_scc1 L_cl_nw
    s_waitcnt vmcnt(0)
L_cl_nw:
    v_mfma_f32_16x16x32_bf16 v[212:215], v[84:87], v[116:119], v[212:215]
    v_mfma_f32_16x16x32_bf16 v[196:199], v[84:87], v[112:115], v[196:199]
    v_mfma_f32_16x16x32_bf16 v[200:203], v[88:91], v[112:115], v[200:203]
    s_add_u32 s62, s62, 1
    v_mfma_f32_16x16x32_bf16 v[216:219], v[88:91], v[116:119], v[216:219]
    v_mfma_f32_16x16x32_bf16 v[220:223], v[92:95], v[116:119], v[220:223]
    v_mfma_f32_16x16x32_bf16 v[204:207], v[92:95], v[112:115], v[204:207]
    s_cmp_lt_u32 s62, 15
    s_cbranch_scc1 L_cloop
    s_waitcnt lgkmcnt(0)
    v_mfma_f32_16x16x32_bf16 v[160:163], v[40:43], v[64:67], v[160:163]
    ds_read_b128 v[80:83], v3 offset:0
    v_mfma_f32_16x16x32_bf16 v[176:179], v[40:43], v[68:71], v[176:179]
    ds_read_b128 v[84:87], v3 offset:2048
    v_mfma_f32_16x16x32_bf16 v[180:183], v[44:47], v[68:71], v[180:183]
    ds_read_b128 v[88:91], v3 offset:4096
    v_mfma_f32_16x16x32_bf16 v[164:167], v[44:47], v[64:67], v[164:167]
    ds_read_b128 v[92:95], v3 offset:6144
    v_mfma_f32_16x16x32_bf16 v[168:171], v[48:51], v[64:67], v[168:171]
    ds_read_b64_tr_b16 v[104:105], v4 offset:12288
    v_mfma_f32_16x16x32_bf16 v[184:187], v[48:51], v[68:71], v[184:187]
    ds_read_b64_tr_b16 v[106:107], v4 offset:12800
    v_mfma_f32_16x16x32_bf16 v[188:191], v[52:55], v[68:71], v[188:191]
    ds_read_b64_tr_b16 v[108:109], v5 offset:12288
    v_mfma_f32_16x16x32_bf16 v[172:175], v[52:55], v[64:67], v[172:175]
    ds_read_b64_tr_b16 v[110:111], v5 offset:12800
    v_mfma_f32_16x16x32_bf16 v[204:207], v[52:55], v[72:75], v[204:207]
    ds_read_b64_tr_b16 v[112:113], v4 offset:20480
    v_mfma_f32_16x16x32_bf16 v[220:223], v[52:55], v[76:79], v[220:223]
    ds_read_b64_tr_b16 v[114:115], v4 offset:20992
    v_lshrrev_b32 v21, 4, v0
    v_and_b32 v22, 15, v0
    v_mfma_f32_16x16x32_bf16 v[216:219], v[48:51], v[76:79], v[216:219]
    ds_read_b64_tr_b16 v[116:117], v5 offset:20480
    s_lshl_b32 s86, s49, 8
    s_add_u32 s86, s86, 131072
    v_lshl_add_u32 v6, v21, 4, s86
    v_mfma_f32_16x16x32_bf16 v[200:203], v[48:51], v[72:75], v[200:203]
    ds_read_b64_tr_b16 v[118:119], v5 offset:20992
    v_lshl_add_u32 v7, v22, 2, s86
    v_mfma_f32_16x16x32_bf16 v[196:199], v[44:47], v[72:75], v[196:199]
    ds_read_b64_tr_b16 v[96:97], v4 offset:4096
    s_lshl_b32 s86, s50, 7
    s_add_u32 s86, s86, 132608
    v_lshl_add_u32 v8, v22, 2, s86
    v_mfma_f32_16x16x32_bf16 v[212:215], v[44:47], v[76:79], v[212:215]
    ds_read_b64_tr_b16 v[98:99], v4 offset:4608
    v_lshl_add_u32 v9, v21, 4, s86
    v_mfma_f32_16x16x32_bf16 v[208:211], v[40:43], v[76:79], v[208:211]
    ds_read_b64_tr_b16 v[100:101], v5 offset:4096
    s_lshl_b32 s86, s3, 2
    s_add_u32 s86, s86, 135168
    v_mov_b32 v12, s86
    v_mfma_f32_16x16x32_bf16 v[192:195], v[40:43], v[72:75], v[192:195]
    ds_read_b64_tr_b16 v[102:103], v5 offset:4608
    v_xor_b32 v13, 4, v12
    v_mov_b32 v17, s68
    s_waitcnt lgkmcnt(8)
    v_mfma_f32_16x16x32_bf16 v[160:163], v[80:83], v[104:107], v[160:163]
    v_mfma_f32_16x16x32_bf16 v[176:179], v[80:83], v[108:111], v[176:179]
    v_mfma_f32_16x16x32_bf16 v[180:183], v[84:87], v[108:111], v[180:183]
    v_mfma_f32_16x16x32_bf16 v[164:167], v[84:87], v[104:107], v[164:167]
    v_mfma_f32_16x16x32_bf16 v[168:171], v[88:91], v[104:107], v[168:171]
    s_waitcnt lgkmcnt(0)
    s_barrier
    ds_read_b128 v[64:67], v6 offset:0
    ds_read_b128 v[68:71], v6 offset:64
    v_mfma_f32_16x16x32_bf16 v[184:187], v[88:91], v[108:111], v[184:187]
    ds_read_b128 v[72:75], v6 offset:128
    ds_read_b128 v[76:79], v6 offset:192
    v_mfma_f32_16x16x32_bf16 v[188:191], v[92:95], v[108:111], v[188:191]
    ds_read_b32 v28, v8 offset:256
    ds_read_b32 v29, v8 offset:320
    v_mfma_f32_16x16x32_bf16 v[172:175], v[92:95], v[104:107], v[172:175]
    ds_read_b32 v30, v8 offset:512
    ds_read_b32 v31, v8 offset:576
    v_mfma_f32_16x16x32_bf16 v[204:207], v[92:95], v[112:115], v[204:207]
    ds_read_b128 v[224:227], v6 offset:512
    ds_read_b128 v[228:231], v6 offset:576
    v_mfma_f32_16x16x32_bf16 v[220:223], v[92:95], v[116:119], v[220:223]
    ds_read_b128 v[232:235], v6 offset:640
    ds_read_b128 v[236:239], v6 offset:704
    v_mfma_f32_16x16x32_bf16 v[216:219], v[88:91], v[116:119], v[216:219]
    ds_read_b128 v[240:243], v6 offset:1024
    ds_read_b128 v[244:247], v6 offset:1088
    v_mfma_f32_16x16x32_bf16 v[200:203], v[88:91], v[112:115], v[200:203]
    ds_read_b128 v[248:251], v6 offset:1152
    ds_read_b128 v[252:255], v6 offset:1216
    v_mfma_f32_16x16x32_bf16 v[196:199], v[84:87], v[112:115], v[196:199]
    ds_read_b128 v[32:35], v9 offset:0
    ds_read_b128 v[36:39], v9 offset:64
    v_mfma_f32_16x16x32_bf16 v[212:215], v[84:87], v[116:119], v[212:215]
    v_mfma_f32_16x16x32_bf16 v[208:211], v[80:83], v[116:119], v[208:211]
    v_mfma_f32_16x16x32_bf16 v[192:195], v[80:83], v[112:115], v[192:195]
    ds_read_b32 v104, v7 offset:0
    ds_read_b32 v124, v7 offset:1024
    ds_read_b32 v105, v7 offset:64
    ds_read_b32 v125, v7 offset:1088
    ds_read_b32 v106, v7 offset:128
    ds_read_b32 v126, v7 offset:1152
    ds_read_b32 v107, v7 offset:192
    ds_read_b32 v127, v7 offset:1216
    s_waitcnt lgkmcnt(8)
    v_pk_fma_f32 v[160:161], v[64:65], v[28:29], v[160:161] op_sel_hi:[1,0,1]
    v_pk_fma_f32 v[162:163], v[66:67], v[28:29], v[162:163] op_sel_hi:[1,0,1]
    v_pk_mul_f32 v[160:161], v[160:161], v[240:241]
    v_pk_mul_f32 v[162:163], v[162:163], v[242:243]
L_walkB3:
    s_cbranch_execz L_walk_7
    v_exp_f32 v112, v160 clamp
    v_exp_f32 v114, v162 clamp
    v_exp_f32 v113, v161 clamp
    v_exp_f32 v115, v163 clamp
    v_max_f32 v160, s6, v160
    v_max_f32 v162, s6, v162
    v_max_f32 v161, s6, v161
    v_max_f32 v163, s6, v163
    v_pk_fma_f32 v[160:161], v[160:161], s[4:5], v[112:113]
    v_pk_fma_f32 v[162:163], v[162:163], s[4:5], v[114:115]
    v_cvt_pk_bf16_f32 v160, v160, v161
    v_cvt_pk_bf16_f32 v161, v162, v163
    v_pk_fma_f32 v[164:165], v[68:69], v[28:29], v[164:165] op_sel_hi:[1,0,1]
    v_pk_fma_f32 v[166:167], v[70:71], v[28:29], v[166:167] op_sel_hi:[1,0,1]
    v_pk_mul_f32 v[164:165], v[164:165], v[244:245]
    v_pk_mul_f32 v[166:167], v[166:167], v[246:247]
    v_exp_f32 v116, v164 clamp
    v_exp_f32 v118, v166 clamp
    v_exp_f32 v117, v165 clamp
    v_exp_f32 v119, v167 clamp
    v_max_f32 v164, s6, v164
    v_max_f32 v166, s6, v166
    v_max_f32 v165, s6, v165
    v_max_f32 v167, s6, v167
    v_pk_fma_f32 v[164:165], v[164:165], s[4:5], v[116:117]
    v_pk_fma_f32 v[166:167], v[166:167], s[4:5], v[118:119]
    v_cvt_pk_bf16_f32 v162, v164, v165
    v_cvt_pk_bf16_f32 v163, v166, v167
    v_pk_fma_f32 v[168:169], v[72:73], v[28:29], v[168:169] op_sel_hi:[1,0,1]
    v_pk_fma_f32 v[170:171], v[74:75], v[28:29], v[170:171] op_sel_hi:[1,0,1]
    v_pk_mul_f32 v[168:169], v[168:169], v[248:249]
    v_pk_mul_f32 v[170:171], v[170:171], v[250:251]
    v_exp_f32 v112, v168 clamp
    v_exp_f32 v114, v170 clamp
    v_exp_f32 v113, v169 clamp
    v_exp_f32 v115, v171 clamp
    v_max_f32 v168, s6, v168
    v_max_f32 v170, s6, v170
    v_max_f32 v169, s6, v169
    v_max_f32 v171, s6, v171
    v_pk_fma_f32 v[168:169], v[168:169], s[4:5], v[112:113]
    v_pk_fma_f32 v[170:171], v[170:171], s[4:5], v[114:115]
    v_cvt_pk_bf16_f32 v168, v168, v169
    v_cvt_pk_bf16_f32 v169, v170, v171
    v_pk_fma_f32 v[172:173], v[76:77], v[28:29], v[172:173] op_sel_hi:[1,0,1]
    v_pk_fma_f32 v[174:175], v[78:79], v[28:29], v[174:175] op_sel_hi:[1,0,1]
    v_pk_mul_f32 v[172:173], v[172:173], v[252:253]
    v_pk_mul_f32 v[174:175], v[174:175], v[254:255]
    v_exp_f32 v116, v172 clamp
    v_exp_f32 v118, v174 clamp
    v_exp_f32 v117, v173 clamp
    v_exp_f32 v119, v175 clamp
    v_max_f32 v172, s6, v172
    v_max_f32 v174, s6, v174
    v_max_f32 v173, s6, v173
    v_max_f32 v175, s6, v175
    v_pk_fma_f32 v[172:173], v[172:173], s[4:5], v[116:117]
    v_pk_fma_f32 v[174:175], v[174:175], s[4:5], v[118:119]
    v_cvt_pk_bf16_f32 v170, v172, v173
    v_cvt_pk_bf16_f32 v171, v174, v175
    v_pk_fma_f32 v[176:177], v[64:65], v[28:29], v[176:177] op_sel:[0,1,0] op_sel_hi:[1,1,1]
    v_pk_fma_f32 v[178:179], v[66:67], v[28:29], v[178:179] op_sel:[0,1,0] op_sel_hi:[1,1,1]
    v_pk_mul_f32 v[176:177], v[176:177], v[240:241]
    v_pk_mul_f32 v[178:179], v[178:179], v[242:243]
    v_exp_f32 v112, v176 clamp
    v_exp_f32 v114, v178 clamp
    v_exp_f32 v113, v177 clamp
    v_exp_f32 v115, v179 clamp
    v_max_f32 v176, s6, v176
    v_max_f32 v178, s6, v178
    v_max_f32 v177, s6, v177
    v_max_f32 v179, s6, v179
    v_pk_fma_f32 v[176:177], v[176:177], s[4:5], v[112:113]
    v_pk_fma_f32 v[178:179], v[178:179], s[4:5], v[114:115]
    v_cvt_pk_bf16_f32 v176, v176, v177
    v_cvt_pk_bf16_f32 v177, v178, v179
    v_pk_fma_f32 v[180:181], v[68:69], v[28:29], v[180:181] op_sel:[0,1,0] op_sel_hi:[1,1,1]
    v_pk_fma_f32 v[182:183], v[70:71], v[28:29], v[182:183] op_sel:[0,1,0] op_sel_hi:[1,1,1]
    v_pk_mul_f32 v[180:181], v[180:181], v[244:245]
    v_pk_mul_f32 v[182:183], v[182:183], v[246:247]
    v_exp_f32 v116, v180 clamp
    v_exp_f32 v118, v182 clamp
    v_exp_f32 v117, v181 clamp
    v_exp_f32 v119, v183 clamp
    v_max_f32 v180, s6, v180
    v_max_f32 v182, s6, v182
    v_max_f32 v181, s6, v181
    v_max_f32 v183, s6, v183
    v_pk_fma_f32 v[180:181], v[180:181], s[4:5], v[116:117]
    v_pk_fma_f32 v[182:183], v[182:183], s[4:5], v[118:119]
    v_cvt_pk_bf16_f32 v178, v180, v181
    v_cvt_pk_bf16_f32 v179, v182, v183
    v_pk_fma_f32 v[184:185], v[72:73], v[28:29], v[184:185] op_sel:[0,1,0] op_sel_hi:[1,1,1]
    v_pk_fma_f32 v[186:187], v[74:75], v[28:29], v[186:187] op_sel:[0,1,0] op_sel_hi:[1,1,1]
    v_pk_mul_f32 v[184:185], v[184:185], v[248:249]
    v_pk_mul_f32 v[186:187], v[186:187], v[250:251]
    v_exp_f32 v112, v184 clamp
    v_exp_f32 v114, v186 clamp
    v_exp_f32 v113, v185 clamp
    v_exp_f32 v115, v187 clamp
    v_max_f32 v184, s6, v184
    v_max_f32 v186, s6, v186
    v_max_f32 v185, s6, v185
    v_max_f32 v187, s6, v187
    v_pk_fma_f32 v[184:185], v[184:185], s[4:5], v[112:113]
    v_pk_fma_f32 v[186:187], v[186:187], s[4:5], v[114:115]
    v_cvt_pk_bf16_f32 v184, v184, v185
    v_cvt_pk_bf16_f32 v185, v186, v187
    v_pk_fma_f32 v[188:189], v[76:77], v[28:29], v[188:189] op_sel:[0,1,0] op_sel_hi:[1,1,1]
    v_pk_fma_f32 v[190:191], v[78:79], v[28:29], v[190:191] op_sel:[0,1,0] op_sel_hi:[1,1,1]
    v_pk_mul_f32 v[188:189], v[188:189], v[252:253]
    v_pk_mul_f32 v[190:191], v[190:191], v[254:255]
    v_exp_f32 v116, v188 clamp
    v_exp_f32 v118, v190 clamp
    v_exp_f32 v117, v189 clamp
    v_exp_f32 v119, v191 clamp
    v_max_f32 v188, s6, v188
    v_max_f32 v190, s6, v190
    v_max_f32 v189, s6, v189
    v_max_f32 v191, s6, v191
    v_pk_fma_f32 v[188:189], v[188:189], s[4:5], v[116:117]
    v_pk_fma_f32 v[190:191], v[190:191], s[4:5], v[118:119]
    v_cvt_pk_bf16_f32 v186, v188, v189
    v_cvt_pk_bf16_f32 v187, v190, v191
    v_pk_fma_f32 v[192:193], v[64:65], v[30:31], v[192:193] op_sel_hi:[1,0,1]
    v_pk_mul_f32 v[192:193], v[192:193], v[224:225]
    v_cvt_pk_bf16_f32 v192, v192, v193
    v_pk_fma_f32 v[194:195], v[66:67], v[30:31], v[194:195] op_sel_hi:[1,0,1]
    v_pk_mul_f32 v[194:195], v[194:195], v[226:227]
    v_cvt_pk_bf16_f32 v193, v194, v195
    v_pk_fma_f32 v[196:197], v[68:69], v[30:31], v[196:197] op_sel_hi:[1,0,1]
    v_pk_mul_f32 v[196:197], v[196:197], v[228:229]
    v_cvt_pk_bf16_f32 v194, v196, v197
    v_pk_fma_f32 v[198:199], v[70:71], v[30:31], v[198:199] op_sel_hi:[1,0,1]
    v_pk_mul_f32 v[198:199], v[198:199], v[230:231]
    v_cvt_pk_bf16_f32 v195, v198, v199
    v_pk_fma_f32 v[200:201], v[72:73], v[30:31], v[200:201] op_sel_hi:[1,0,1]
    v_pk_mul_f32 v[200:201], v[200:201], v[232:233]
    v_cvt_pk_bf16_f32 v200, v200, v201
    v_pk_fma_f32 v[202:203], v[74:75], v[30:31], v[202:203] op_sel_hi:[1,0,1]
    v_pk_mul_f32 v[202:203], v[202:203], v[234:235]
    v_cvt_pk_bf16_f32 v201, v202, v203
    v_pk_fma_f32 v[204:205], v[76:77], v[30:31], v[204:205] op_sel_hi:[1,0,1]
    v_pk_mul_f32 v[204:205], v[204:205], v[236:237]
    v_cvt_pk_bf16_f32 v202, v204, v205
    v_pk_fma_f32 v[206:207], v[78:79], v[30:31], v[206:207] op_sel_hi:[1,0,1]
    v_pk_mul_f32 v[206:207], v[206:207], v[238:239]
    v_cvt_pk_bf16_f32 v203, v206, v207
    v_pk_fma_f32 v[208:209], v[64:65], v[30:31], v[208:209] op_sel:[0,1,0] op_sel_hi:[1,1,1]
    v_pk_mul_f32 v[208:209], v[208:209], v[224:225]
    v_cvt_pk_bf16_f32 v208, v208, v209
    v_pk_fma_f32 v[210:211], v[66:67], v[30:31], v[210:211] op_sel:[0,1,0] op_sel_hi:[1,1,1]
L_walk_13:
    s_cbranch_execz L_walked
    v_pk_mul_f32 v[210:211], v[210:211], v[226:227]
    v_cvt_pk_bf16_f32 v209, v210, v211
    v_pk_fma_f32 v[212:213], v[68:69], v[30:31], v[212:213] op_sel:[0,1,0] op_sel_hi:[1,1,1]
    v_pk_mul_f32 v[212:213], v[212:213], v[228:229]
    v_cvt_pk_bf16_f32 v210, v212, v213
    v_pk_fma_f32 v[214:215], v[70:71], v[30:31], v[214:215] op_sel:[0,1,0] op_sel_hi:[1,1,1]
    v_pk_mul_f32 v[214:215], v[214:215], v[230:231]
    v_cvt_pk_bf16_f32 v211, v214, v215
    v_pk_fma_f32 v[216:217], v[72:73], v[30:31], v[216:217] op_sel:[0,1,0] op_sel_hi:[1,1,1]
    v_pk_mul_f32 v[216:217], v[216:217], v[232:233]
    v_cvt_pk_bf16_f32 v216, v216, v217
    v_pk_fma_f32 v[218:219], v[74:75], v[30:31], v[218:219] op_sel:[0,1,0] op_sel_hi:[1,1,1]
    v_pk_mul_f32 v[218:219], v[218:219], v[234:235]
    v_cvt_pk_bf16_f32 v217, v218, v219
    v_pk_fma_f32 v[220:221], v[76:77], v[30:31], v[220:221] op_sel:[0,1,0] op_sel_hi:[1,1,1]
    v_pk_mul_f32 v[220:221], v[220:221], v[236:237]
    v_cvt_pk_bf16_f32 v218, v220, v221
    v_pk_fma_f32 v[222:223], v[78:79], v[30:31], v[222:223] op_sel:[0,1,0] op_sel_hi:[1,1,1]
    v_pk_mul_f32 v[222:223], v[222:223], v[238:239]
    v_cvt_pk_bf16_f32 v219, v222, v223
    s_cmp_eq_u32 s49, 1
    s_cbranch_scc1 L_kv1
    v_mfma_f32_16x16x32_bf16 v[236:239], v[160:163], v[208:211], 0
    v_mfma_f32_16x16x32_bf16 v[240:243], v[176:179], v[208:211], 0
    v_mfma_f32_16x16x32_bf16 v[244:247], v[176:179], v[120:123], 0
    v_mfma_f32_16x16x32_bf16 v[224:227], v[160:163], v[192:195], 0
    v_mfma_f32_16x16x32_bf16 v[228:231], v[176:179], v[192:195], 0
    v_mfma_f32_16x16x32_bf16 v[232:235], v[160:163], v[120:123], 0
    v_mfma_f32_16x16x32_bf16 v[236:239], v[168:171], v[216:219], v[236:239]
    v_mfma_f32_16x16x32_bf16 v[240:243], v[184:187], v[216:219], v[240:243]
    v_mfma_f32_16x16x32_bf16 v[244:247], v[184:187], v[120:123], v[244:247]
    v_mfma_f32_16x16x32_bf16 v[224:227], v[168:171], v[200:203], v[224:227]
    v_mfma_f32_16x16x32_bf16 v[228:231], v[184:187], v[200:203], v[228:231]
    v_mfma_f32_16x16x32_bf16 v[232:235], v[168:171], v[120:123], v[232:235]
    s_branch L_kvd
L_kv1:
    v_mfma_f32_16x16x32_bf16 v[236:239], v[160:163], v[192:195], 0
    v_mfma_f32_16x16x32_bf16 v[240:243], v[176:179], v[192:195], 0
    v_mfma_f32_16x16x32_bf16 v[244:247], v[160:163], v[120:123], 0
    v_mfma_f32_16x16x32_bf16 v[224:227], v[160:163], v[208:211], 0
    v_mfma_f32_16x16x32_bf16 v[228:231], v[176:179], v[208:211], 0
    v_mfma_f32_16x16x32_bf16 v[232:235], v[176:179], v[120:123], 0
    v_mfma_f32_16x16x32_bf16 v[236:239], v[168:171], v[200:203], v[236:239]
    v_mfma_f32_16x16x32_bf16 v[240:243], v[184:187], v[200:203], v[240:243]
    v_mfma_f32_16x16x32_bf16 v[244:247], v[168:171], v[120:123], v[244:247]
    v_mfma_f32_16x16x32_bf16 v[224:227], v[168:171], v[216:219], v[224:227]
    v_mfma_f32_16x16x32_bf16 v[228:231], v[184:187], v[216:219], v[228:231]
    v_mfma_f32_16x16x32_bf16 v[232:235], v[184:187], v[120:123], v[232:235]
L_kvd:
    s_nop 2
    ds_write_b128 v24, v[236:239] offset:0
    ds_write_b128 v24, v[240:243] offset:1024
    ds_write_b128 v24, v[244:247] offset:2048
    ds_write_b32 v12, v12
L_xkv:
    ds_read_b32 v14, v13
    ds_read_b128 v[236:239], v25 offset:0
    ds_read_b128 v[240:243], v25 offset:1024
    ds_read_b128 v[244:247], v25 offset:2048
    s_waitcnt lgkmcnt(0)
    v_cmp_eq_u32 vcc, 0, v14
    s_cbranch_vccz L_ok_2
    s_sub_u32 s56, s56, 1
    s_cbranch_scc0 L_xkv
    s_mov_b32 s56, 0
L_ok_2:
    v_pk_add_f32 v[224:225], v[224:225], v[236:237]
    v_pk_add_f32 v[226:227], v[226:227], v[238:239]
    v_pk_add_f32 v[228:229], v[228:229], v[240:241]
    v_pk_add_f32 v[230:231], v[230:231], v[242:243]
    v_pk_add_f32 v[232:233], v[232:233], v[244:245]
    v_pk_add_f32 v[234:235], v[234:235], v[246:247]
    v_cvt_pk_bf16_f32 v248, v224, v225
    v_cvt_pk_bf16_f32 v249, v226, v227
    v_cvt_pk_bf16_f32 v250, v228, v229
    v_cvt_pk_bf16_f32 v251, v230, v231
    buffer_store_dwordx4 v[248:251], v26, s[16:19], 0 offen sc1
    buffer_store_dwordx4 v[232:235], v27, s[16:19], 0 offen sc1
    buffer_atomic_swap v17, v19, s[16:19], 0 offen sc1
    v_mfma_f32_16x16x32_bf16 v[128:131], v[56:59], v[40:43], v[128:131]
    v_mfma_f32_16x16x32_bf16 v[144:147], v[60:63], v[40:43], v[144:147]
    v_mfma_f32_16x16x32_bf16 v[148:151], v[60:63], v[44:47], v[148:151]
    v_mfma_f32_16x16x32_bf16 v[132:135], v[56:59], v[44:47], v[132:135]
    v_mfma_f32_16x16x32_bf16 v[136:139], v[56:59], v[48:51], v[136:139]
    v_mfma_f32_16x16x32_bf16 v[152:155], v[60:63], v[48:51], v[152:155]
    v_mfma_f32_16x16x32_bf16 v[156:159], v[60:63], v[52:55], v[156:159]
    v_mfma_f32_16x16x32_bf16 v[140:143], v[56:59], v[52:55], v[140:143]
    v_mfma_f32_16x16x32_bf16 v[128:131], v[96:99], v[80:83], v[128:131]
    v_mfma_f32_16x16x32_bf16 v[144:147], v[100:103], v[80:83], v[144:147]
    v_mfma_f32_16x16x32_bf16 v[148:151], v[100:103], v[84:87], v[148:151]
    v_mfma_f32_16x16x32_bf16 v[132:135], v[96:99], v[84:87], v[132:135]
    v_mfma_f32_16x16x32_bf16 v[136:139], v[96:99], v[88:91], v[136:139]
    v_mfma_f32_16x16x32_bf16 v[152:155], v[100:103], v[88:91], v[152:155]
    v_mfma_f32_16x16x32_bf16 v[156:159], v[100:103], v[92:95], v[156:159]
    v_mfma_f32_16x16x32_bf16 v[140:143], v[96:99], v[92:95], v[140:143]
    s_nop 0
    v_pk_fma_f32 v[128:129], v[32:33], v[104:105], v[128:129] op_sel_hi:[1,0,1]
    v_pk_fma_f32 v[130:131], v[34:35], v[104:105], v[130:131] op_sel_hi:[1,0,1]
    v_pk_mul_f32 v[128:129], v[128:129], v[124:125] op_sel_hi:[1,0]
    v_pk_mul_f32 v[130:131], v[130:131], v[124:125] op_sel_hi:[1,0]
    v_exp_f32 v112, v128 clamp
    v_exp_f32 v114, v130 clamp
    v_exp_f32 v113, v129 clamp
    v_exp_f32 v115, v131 clamp
    v_max_f32 v128, s6, v128
    v_max_f32 v130, s6, v130
    v_max_f32 v129, s6, v129
    v_max_f32 v131, s6, v131
    v_pk_fma_f32 v[128:129], v[128:129], s[4:5], v[112:113]
    v_pk_fma_f32 v[130:131], v[130:131], s[4:5], v[114:115]
    v_cvt_pk_bf16_f32 v192, v128, v129
    v_cvt_pk_bf16_f32 v193, v130, v131
    v_pk_fma_f32 v[144:145], v[36:37], v[104:105], v[144:145] op_sel_hi:[1,0,1]
    v_pk_fma_f32 v[146:147], v[38:39], v[104:105], v[146:147] op_sel_hi:[1,0,1]
    v_pk_mul_f32 v[144:145], v[144:145], v[124:125] op_sel_hi:[1,0]
    v_pk_mul_f32 v[146:147], v[146:147], v[124:125] op_sel_hi:[1,0]
    v_exp_f32 v116, v144 clamp
    v_exp_f32 v118, v146 clamp
    v_exp_f32 v117, v145 clamp
    v_exp_f32 v119, v147 clamp
    v_max_f32 v144, s6, v144
    v_max_f32 v146, s6, v146
    v_max_f32 v145, s6, v145
    v_max_f32 v147, s6, v147
    v_pk_fma_f32 v[144:145], v[144:145], s[4:5], v[116:117]
    v_pk_fma_f32 v[146:147], v[146:147], s[4:5], v[118:119]
    v_cvt_pk_bf16_f32 v194, v144, v145
    v_cvt_pk_bf16_f32 v195, v146, v147
    v_pk_fma_f32 v[132:133], v[32:33], v[104:105], v[132:133] op_sel:[0,1,0] op_sel_hi:[1,1,1]
    v_pk_fma_f32 v[134:135], v[34:35], v[104:105], v[134:135] op_sel:[0,1,0] op_sel_hi:[1,1,1]
    v_pk_mul_f32 v[132:133], v[132:133], v[124:125] op_sel:[0,1] op_sel_hi:[1,1]
    v_pk_mul_f32 v[134:135], v[134:135], v[124:125] op_sel:[0,1] op_sel_hi:[1,1]
    v_exp_f32 v112, v132 clamp
    v_exp_f32 v114, v134 clamp
    v_exp_f32 v113, v133 clamp
    v_exp_f32 v115, v135 clamp
    v_max_f32 v132, s6, v132
    v_max_f32 v134, s6, v134
    v_max_f32 v133, s6, v133
    v_max_f32 v135, s6, v135
    v_pk_fma_f32 v[132:133], v[132:133], s[4:5], v[112:113]
    v_pk_fma_f32 v[134:135], v[134:135], s[4:5], v[114:115]
    v_cvt_pk_bf16_f32 v196, v132, v133
    v_cvt_pk_bf16_f32 v197, v134, v135
    v_pk_fma_f32 v[148:149], v[36:37], v[104:105], v[148:149] op_sel:[0,1,0] op_sel_hi:[1,1,1]
    v_pk_fma_f32 v[150:151], v[38:39], v[104:105], v[150:151] op_sel:[0,1,0] op_sel_hi:[1,1,1]
    v_pk_mul_f32 v[148:149], v[148:149], v[124:125] op_sel:[0,1] op_sel_hi:[1,1]
    v_pk_mul_f32 v[150:151], v[150:151], v[124:125] op_sel:[0,1] op_sel_hi:[1,1]
    v_exp_f32 v116, v148 clamp
    v_exp_f32 v118, v150 clamp
    v_exp_f32 v117, v149 clamp
L_walk_14:
    s_cbranch_execz L_walked
    v_exp_f32 v119, v151 clamp
    v_max_f32 v148, s6, v148
    v_max_f32 v150, s6, v150
    v_max_f32 v149, s6, v149
    v_max_f32 v151, s6, v151
    v_pk_fma_f32 v[148:149], v[148:149], s[4:5], v[116:117]
    v_pk_fma_f32 v[150:151], v[150:151], s[4:5], v[118:119]
    v_cvt_pk_bf16_f32 v198, v148, v149
    v_cvt_pk_bf16_f32 v199, v150, v151
    v_pk_fma_f32 v[136:137], v[32:33], v[106:107], v[136:137] op_sel_hi:[1,0,1]
    v_pk_fma_f32 v[138:139], v[34:35], v[106:107], v[138:139] op_sel_hi:[1,0,1]
    v_pk_mul_f32 v[136:137], v[136:137], v[126:127] op_sel_hi:[1,0]
    v_pk_mul_f32 v[138:139], v[138:139], v[126:127] op_sel_hi:[1,0]
    v_exp_f32 v112, v136 clamp
    v_exp_f32 v114, v138 clamp
    v_exp_f32 v113, v137 clamp
    v_exp_f32 v115, v139 clamp
    v_max_f32 v136, s6, v136
    v_max_f32 v138, s6, v138
    v_max_f32 v137, s6, v137
    v_max_f32 v139, s6, v139
    v_pk_fma_f32 v[136:137], v[136:137], s[4:5], v[112:113]
    v_pk_fma_f32 v[138:139], v[138:139], s[4:5], v[114:115]
    v_cvt_pk_bf16_f32 v200, v136, v137
    v_cvt_pk_bf16_f32 v201, v138, v139
    v_pk_fma_f32 v[152:153], v[36:37], v[106:107], v[152:153] op_sel_hi:[1,0,1]
    v_pk_fma_f32 v[154:155], v[38:39], v[106:107], v[154:155] op_sel_hi:[1,0,1]
    v_pk_mul_f32 v[152:153], v[152:153], v[126:127] op_sel_hi:[1,0]
    v_pk_mul_f32 v[154:155], v[154:155], v[126:127] op_sel_hi:[1,0]
    v_exp_f32 v116, v152 clamp
    v_exp_f32 v118, v154 clamp
    v_exp_f32 v117, v153 clamp
    v_exp_f32 v119, v155 clamp
    v_max_f32 v152, s6, v152
    v_max_f32 v154, s6, v154
    v_max_f32 v153, s6, v153
    v_max_f32 v155, s6, v155
    v_pk_fma_f32 v[152:153], v[152:153], s[4:5], v[116:117]
    v_pk_fma_f32 v[154:155], v[154:155], s[4:5], v[118:119]
    v_cvt_pk_bf16_f32 v202, v152, v153
    v_cvt_pk_bf16_f32 v203, v154, v155
    v_pk_fma_f32 v[140:141], v[32:33], v[106:107], v[140:141] op_sel:[0,1,0] op_sel_hi:[1,1,1]
    v_pk_fma_f32 v[142:143], v[34:35], v[106:107], v[142:143] op_sel:[0,1,0] op_sel_hi:[1,1,1]
    v_pk_mul_f32 v[140:141], v[140:141], v[126:127] op_sel:[0,1] op_sel_hi:[1,1]
    v_pk_mul_f32 v[142:143], v[142:143], v[126:127] op_sel:[0,1] op_sel_hi:[1,1]
    v_exp_f32 v112, v140 clamp
    v_exp_f32 v114, v142 clamp
    v_exp_f32 v113, v141 clamp
    v_exp_f32 v115, v143 clamp
    v_max_f32 v140, s6, v140
    v_max_f32 v142, s6, v142
    v_max_f32 v141, s6, v141
    v_max_f32 v143, s6, v143
    v_pk_fma_f32 v[140:141], v[140:141], s[4:5], v[112:113]
    v_pk_fma_f32 v[142:143], v[142:143], s[4:5], v[114:115]
    v_cvt_pk_bf16_f32 v204, v140, v141
    v_cvt_pk_bf16_f32 v205, v142, v143
    v_pk_fma_f32 v[156:157], v[36:37], v[106:107], v[156:157] op_sel:[0,1,0] op_sel_hi:[1,1,1]
    v_pk_fma_f32 v[158:159], v[38:39], v[106:107], v[158:159] op_sel:[0,1,0] op_sel_hi:[1,1,1]
    v_pk_mul_f32 v[156:157], v[156:157], v[126:127] op_sel:[0,1] op_sel_hi:[1,1]
    v_pk_mul_f32 v[158:159], v[158:159], v[126:127] op_sel:[0,1] op_sel_hi:[1,1]
    v_exp_f32 v116, v156 clamp
    v_exp_f32 v118, v158 clamp
    v_exp_f32 v117, v157 clamp
    v_exp_f32 v119, v159 clamp
    v_max_f32 v156, s6, v156
    v_max_f32 v158, s6, v158
    v_max_f32 v157, s6, v157
    v_max_f32 v159, s6, v159
    v_pk_fma_f32 v[156:157], v[156:157], s[4:5], v[116:117]
    v_pk_fma_f32 v[158:159], v[158:159], s[4:5], v[118:119]
    v_cvt_pk_bf16_f32 v206, v156, v157
    v_cvt_pk_bf16_f32 v207, v158, v159
    s_lshr_b32 s62, s3, 2
    s_lshl_b32 s53, s51, 3
    s_lshl_b32 s86, s48, 1
    s_add_u32 s53, s53, s86
    s_add_u32 s53, s53, s62
    v_lshrrev_b32 v36, 4, v0
    v_and_b32 v37, 15, v0
    s_lshl_b32 s87, s53, 15
    s_lshl_b32 s86, s62, 14
    s_add_u32 s86, s86, s87
    s_add_u32 s86, s86, 1048576
    v_lshl_add_u32 v157, v0, 4, s86
    v_xor_b32 v158, 0x8000, v157
    s_lshl_b32 s86, s51, 1
    s_lshr_b32 s87, s48, 1
    s_add_u32 s86, s86, s87
    s_lshl_b32 s86, s86, 1
    s_add_u32 s86, s86, s62
    s_lshl_b32 s86, s86, 1
    s_and_b32 s87, s48, 1
    s_add_u32 s86, s86, s87
    s_lshl_b32 s86, s86, 7
    s_add_u32 s86, s86, 688128
    v_lshl_add_u32 v159, v0, 2, s86
    v_mov_b32 v38, 2147483648
    v_cmp_gt_u32 vcc, 16, v0
    s_nop 1
    v_cndmask_b32 v159, v38, v159, vcc
    v_bfe_u32 v38, v0, 2, 2
    v_lshl_add_u32 v38, v36, 2, v38
    v_bfe_u32 v39, v38, 1, 2
    v_lshlrev_b32 v38, 7, v38
    v_lshl_add_u32 v38, v39, 5, v38
    v_and_b32 v39, 3, v0
    v_lshl_add_u32 v38, v39, 3, v38
    s_lshl_b32 s86, s62, 16
    s_add_u32 s86, s86, 0
    v_add_u32 v144, s86, v38
    v_xor_b32 v145, 32, v144
    v_xor_b32 v146, 64, v144
    v_xor_b32 v147, 96, v144
    v_cmp_eq_u32 s[4:5], 1, v39
    v_cmp_eq_u32 s[6:7], 2, v39
    v_cmp_eq_u32 s[98:99], 3, v39
    s_lshl_b32 s86, s53, 10
    s_add_u32 s86, s86, 786432
    v_lshl_add_u32 v160, v0, 2, s86
    v_mul_u32_u24 v161, 192, v36
    v_add_u32 v160, v160, v161
    s_mov_b32 s72, 0x00f0000f
    s_mov_b32 s73, 0xf0000f00
    s_mov_b32 s74, 0x000ff000
    s_mov_b32 s75, 0x0f0000f0
    v_lshrrev_b32 v38, 2, v37
    v_lshl_add_u32 v161, v38, 4, v37
    v_lshlrev_b32 v161, 2, v161
    s_lshl_b32 s86, s3, 12
    s_add_u32 s86, s86, 131072
    v_lshl_add_u32 v162, v0, 4, s86
    v_xor_b32 v163, 0x4000, v162
    s_lshl_b32 s86, s52, 7
    v_lshl_add_u32 v36, v36, 3, s86
    s_lshl_b32 s87, s53, 15
    s_add_u32 s87, s87, s86
    s_lshl_b32 s86, s62, 6
    s_add_u32 s87, s87, s86
    v_lshl_add_u32 v39, v37, 11, s87
    v_and_b32 v38, 48, v0
    v_add_u32 v39, v39, v38
    v_xor_b32 v37, 0x8000, v39
    buffer_load_dwordx4 v[136:139], v39, s[8:11], 0 offen
    buffer_load_dwordx4 v[140:143], v37, s[8:11], 0 offen
    buffer_load_dwordx2 v[148:149], v36, s[40:43], 0 offen offset:0
    buffer_load_dwordx2 v[150:151], v36, s[40:43], 0 offen offset:32
    buffer_load_dwordx2 v[152:153], v36, s[40:43], 0 offen offset:64
    buffer_load_dwordx2 v[154:155], v36, s[40:43], 0 offen offset:96
    s_barrier
    ds_read_b128 v[40:43], v20 offset:0
    ds_read_b128 v[44:47], v20 offset:1024
    ds_read_b128 v[48:51], v20 offset:2048
    v_mov_b32 v38, 135200
    ds_read_b32 v38, v38
    s_mov_b32 s86, 0x8000
    s_mov_b32 s87, 0x10000
    s_mov_b32 s88, 0x18000
    s_waitcnt lgkmcnt(0)
    v_mfma_f32_16x16x32_bf16 v[216:219], v[48:51], v[192:195], 0
    v_mfma_f32_16x16x32_bf16 v[208:211], v[40:43], v[192:195], 0
    v_mfma_f32_16x16x32_bf16 v[212:215], v[44:47], v[192:195], 0
    v_mfma_f32_16x16x32_bf16 v[228:231], v[48:51], v[196:199], 0
    v_mfma_f32_16x16x32_bf16 v[220:223], v[40:43], v[196:199], 0
    v_mfma_f32_16x16x32_bf16 v[224:227], v[44:47], v[196:199], 0
    v_mfma_f32_16x16x32_bf16 v[240:243], v[48:51], v[200:203], 0
    v_mfma_f32_16x16x32_bf16 v[232:235], v[40:43], v[200:203], 0
L_walkB4:
    s_cbranch_execz L_walk_19
    v_mfma_f32_16x16x32_bf16 v[236:239], v[44:47], v[200:203], 0
    v_mfma_f32_16x16x32_bf16 v[252:255], v[48:51], v[204:207], 0
    v_mfma_f32_16x16x32_bf16 v[244:247], v[40:43], v[204:207], 0
    v_mfma_f32_16x16x32_bf16 v[248:251], v[44:47], v[204:207], 0
    v_add_f32 v216, s54, v216
    v_rcp_f32 v216, v216
    s_nop 0
    v_pk_mul_f32 v[208:209], v[208:209], v[216:217] op_sel_hi:[1,0]
    v_pk_mul_f32 v[210:211], v[210:211], v[216:217] op_sel_hi:[1,0]
    v_pk_mul_f32 v[212:213], v[212:213], v[216:217] op_sel_hi:[1,0]
    v_pk_mul_f32 v[214:215], v[214:215], v[216:217] op_sel_hi:[1,0]
    v_cvt_pk_bf16_f32 v60, v208, v209
    v_cvt_pk_bf16_f32 v61, v210, v211
    v_cvt_pk_bf16_f32 v62, v212, v213
    v_cvt_pk_bf16_f32 v63, v214, v215
    buffer_store_dwordx4 v[60:63], v23, s[16:19], 0 offen sc1
    v_add_f32 v228, s54, v228
    v_rcp_f32 v228, v228
    s_nop 0
    v_pk_mul_f32 v[220:221], v[220:221], v[228:229] op_sel_hi:[1,0]
    v_pk_mul_f32 v[222:223], v[222:223], v[228:229] op_sel_hi:[1,0]
    v_pk_mul_f32 v[224:225], v[224:225], v[228:229] op_sel_hi:[1,0]
    v_pk_mul_f32 v[226:227], v[226:227], v[228:229] op_sel_hi:[1,0]
    v_cvt_pk_bf16_f32 v64, v220, v221
    v_cvt_pk_bf16_f32 v65, v222, v223
    v_cvt_pk_bf16_f32 v66, v224, v225
    v_cvt_pk_bf16_f32 v67, v226, v227
    buffer_store_dwordx4 v[64:67], v23, s[16:19], s86 offen sc1
    v_add_f32 v240, s54, v240
    v_rcp_f32 v240, v240
    s_nop 0
    v_pk_mul_f32 v[232:233], v[232:233], v[240:241] op_sel_hi:[1,0]
    v_pk_mul_f32 v[234:235], v[234:235], v[240:241] op_sel_hi:[1,0]
    v_pk_mul_f32 v[236:237], v[236:237], v[240:241] op_sel_hi:[1,0]
    v_pk_mul_f32 v[238:239], v[238:239], v[240:241] op_sel_hi:[1,0]
    v_cvt_pk_bf16_f32 v68, v232, v233
    v_cvt_pk_bf16_f32 v69, v234, v235
    v_cvt_pk_bf16_f32 v70, v236, v237
    v_cvt_pk_bf16_f32 v71, v238, v239
    buffer_store_dwordx4 v[68:71], v23, s[16:19], s87 offen sc1
    v_add_f32 v252, s54, v252
    v_rcp_f32 v252, v252
    s_nop 0
    v_pk_mul_f32 v[244:245], v[244:245], v[252:253] op_sel_hi:[1,0]
    v_pk_mul_f32 v[246:247], v[246:247], v[252:253] op_sel_hi:[1,0]
    v_pk_mul_f32 v[248:249], v[248:249], v[252:253] op_sel_hi:[1,0]
    v_pk_mul_f32 v[250:251], v[250:251], v[252:253] op_sel_hi:[1,0]
    v_cvt_pk_bf16_f32 v72, v244, v245
    v_cvt_pk_bf16_f32 v73, v246, v247
    v_cvt_pk_bf16_f32 v74, v248, v249
    v_cvt_pk_bf16_f32 v75, v250, v251
    buffer_store_dwordx4 v[72:75], v23, s[16:19], s88 offen sc1
    buffer_atomic_swap v17, v18, s[16:19], 0 offen sc1
    v_mov_b32 v8, 0
    buffer_atomic_or v8, v159, s[16:19], 0 offen sc0 sc1
    v_mov_b32 v14, 2147483648
    v_mov_b32 v11, 2147483648
    s_waitcnt vmcnt(6)
    v_bfe_u32 v36, v0, 2, 1
    v_cmp_eq_u32 vcc, 1, v36
    v_mov_b32 v36, s95
    s_nop 0
    v_cndmask_b32 v148, v36, v148, vcc
    v_cndmask_b32 v149, v36, v149, vcc
    v_cndmask_b32 v150, v36, v150, vcc
    v_cndmask_b32 v151, v36, v151, vcc
    v_cndmask_b32 v152, v36, v152, vcc
    v_cndmask_b32 v153, v36, v153, vcc
    v_cndmask_b32 v154, v36, v154, vcc
    v_cndmask_b32 v155, v36, v155, vcc
    v_readfirstlane_b32 s57, v38
L_phaseB:
    v_lshrrev_b32 v1, 4, v0
    v_and_b32 v2, 15, v0
    v_mov_b32 v3, 0x3f80
    s_lshl_b32 s87, s53, 4
    v_add_u32 v6, s87, v2
    s_lshl_b32 s86, s52, 7
    v_lshl_add_u32 v5, v6, 11, s86
    v_sub_u32 v6, 2047, v6
    v_mov_b32 v7, v39
    v_lshrrev_b32 v9, 1, v1
    v_lshl_add_u32 v5, v9, 4, v5
    v_and_b32 v9, 1, v1
    v_lshl_add_u32 v5, v9, 5, v5
    s_mov_b32 s67, 0
    s_mov_b32 s66, 0xffffaaaa
    s_mov_b32 s63, 0
    s_lshl2_add_u32 s86, s3, 163776
    v_mov_b32 v12, s86
    s_cmp_eq_u32 s62, 0
    s_cselect_b64 vcc, -1, 0
    v_cndmask_b32 v12, v12, v162, vcc
    v_mov_b32 v13, 163792
L_b_init:
    v_bfe_u32 v9, v0, 3, 1
    v_bfe_u32 v10, v0, 4, 1
    v_xor_b32 v9, v9, v10
    v_bfe_u32 v10, v0, 1, 2
    v_lshl_add_u32 v9, v9, 3, v10
    v_lshrrev_b32 v10, 5, v0
    v_lshl_add_u32 v9, v10, 2, v9
    v_and_b32 v10, 1, v0
    v_lshlrev_b32 v10, 4, v10
    v_lshlrev_b32 v10, v10, v3
    v_cmp_eq_u32 vcc, 0, v9
    s_nop 1
    v_cndmask_b32 v128, 0, v10, vcc
    v_cmp_eq_u32 vcc, 1, v9
    s_nop 1
    v_cndmask_b32 v129, 0, v10, vcc
    v_cmp_eq_u32 vcc, 2, v9
    s_nop 1
    v_cndmask_b32 v130, 0, v10, vcc
    v_cmp_eq_u32 vcc, 3, v9
    s_nop 1
    v_cndmask_b32 v131, 0, v10, vcc
    v_cmp_eq_u32 vcc, 4, v9
    s_nop 1
    v_cndmask_b32 v132, 0, v10, vcc
    v_cmp_eq_u32 vcc, 5, v9
    s_nop 1
    v_cndmask_b32 v133, 0, v10, vcc
    v_cmp_eq_u32 vcc, 6, v9
    s_nop 1
    v_cndmask_b32 v134, 0, v10, vcc
    v_cmp_eq_u32 vcc, 7, v9
    s_nop 1
    v_cndmask_b32 v135, 0, v10, vcc
    v_mov_b32 v80, 0
    v_mov_b32 v81, 0
    v_mov_b32 v82, 0
    v_mov_b32 v83, 0
    v_mov_b32 v84, 0
    v_mov_b32 v85, 0
    v_mov_b32 v86, 0
    v_mov_b32 v87, 0
    v_mov_b32 v88, 0
    v_mov_b32 v89, 0
    v_mov_b32 v90, 0
    v_mov_b32 v91, 0
    v_mov_b32 v92, 0
    v_mov_b32 v93, 0
    v_mov_b32 v94, 0
    v_mov_b32 v95, 0
    v_mov_b32 v96, 0
    v_mov_b32 v97, 0
    v_mov_b32 v98, 0
    v_mov_b32 v99, 0
    v_mov_b32 v100, 0
    v_mov_b32 v101, 0
    v_mov_b32 v102, 0
    v_mov_b32 v103, 0
    v_mov_b32 v104, 0
    v_mov_b32 v105, 0
    v_mov_b32 v106, 0
    v_mov_b32 v107, 0
    v_mov_b32 v108, 0
    v_mov_b32 v109, 0
    v_mov_b32 v110, 0
    v_mov_b32 v111, 0
    v_mov_b32 v156, 0
    s_branch L_b_w0
L_b_r0:
    s_ff1_i32_b32 s91, s65
    s_bitset0_b32 s65, s91
    s_lshl_b32 s76, s91, 12
    s_lshl_b32 s91, s91, 10
    buffer_load_dwordx4 v[16:19], v157, s[16:19], s91 offen offset:0 sc1
    buffer_load_dwordx4 v[20:23], v158, s[16:19], s91 offen offset:0 sc1
    buffer_load_dwordx4 v[24:27], v157, s[16:19], s91 offen offset:1024 sc1
    buffer_load_dwordx4 v[28:31], v158, s[16:19], s91 offen offset:1024 sc1
    s_cmp_eq_u32 s65, 0
    s_cbranch_scc1 L_b_p1
L_b_r1:
    s_ff1_i32_b32 s91, s65
    s_bitset0_b32 s65, s91
    s_lshl_b32 s77, s91, 12
    s_lshl_b32 s91, s91, 10
    buffer_load_dwordx4 v[32:35], v157, s[16:19], s91 offen offset:0 sc1
    buffer_load_dwordx4 v[36:39], v158, s[16:19], s91 offen offset:0 sc1
    buffer_load_dwordx4 v[40:43], v157, s[16:19], s91 offen offset:1024 sc1
    buffer_load_dwordx4 v[44:47], v158, s[16:19], s91 offen offset:1024 sc1
    s_cmp_le_u32 s62, s63
    s_cbranch_scc1 L_b_wok
L_b_wf:
    ds_read_b128 v[112:115], v13
    s_waitcnt lgkmcnt(0)
    v_min3_u32 v112, v112, v113, v114
    v_min_u32 v112, v112, v115
    v_cmp_eq_u32 vcc, 0, v112
    s_cbranch_vccz L_ok_3
    s_sub_u32 s56, s56, 1
    s_cbranch_scc0 L_b_wf
    s_mov_b32 s56, 0
L_ok_3:
L_b_wok:
    s_xor_b32 s89, s67, s76
    s_mov_b32 s67, s76
    v_xor_b32 v144, s89, v144
    ds_read_b64_tr_b16 v[112:113], v144 offset:0
    ds_read_b64_tr_b16 v[114:115], v144 offset:2048
    v_xor_b32 v145, s89, v145
    ds_read_b64_tr_b16 v[116:117], v145 offset:0
    ds_read_b64_tr_b16 v[118:119], v145 offset:2048
L_walkB5:
    s_cbranch_execz L_walk_20
    v_xor_b32 v146, s89, v146
    ds_read_b64_tr_b16 v[120:121], v146 offset:0
    ds_read_b64_tr_b16 v[122:123], v146 offset:2048
    v_xor_b32 v147, s89, v147
    ds_read_b64_tr_b16 v[124:125], v147 offset:0
    ds_read_b64_tr_b16 v[126:127], v147 offset:2048
    s_cmp_eq_u32 s62, 0
    s_cbranch_scc0 L_b_x1
    v_mfma_f32_16x16x32_bf16 v[80:83], v[128:131], v[136:139], 0
    v_mfma_f32_16x16x32_bf16 v[96:99], v[128:131], v[140:143], 0
    v_mfma_f32_16x16x32_bf16 v[84:87], v[132:135], v[136:139], 0
    v_mfma_f32_16x16x32_bf16 v[100:103], v[132:135], v[140:143], 0
    s_branch L_b_xd
L_b_x1:
    s_setprio 1
    v_mfma_f32_16x16x32_bf16 v[88:91], v[128:131], v[136:139], 0
    v_mfma_f32_16x16x32_bf16 v[104:107], v[128:131], v[140:143], 0
    v_mfma_f32_16x16x32_bf16 v[92:95], v[132:135], v[136:139], 0
    v_mfma_f32_16x16x32_bf16 v[108:111], v[132:135], v[140:143], 0
L_b_xd:
    s_waitcnt vmcnt(6) lgkmcnt(6)
    v_max3_u32 v156, v156, v19, v23
    v_mfma_f32_16x16x32_bf16 v[80:83], v[112:115], v[16:19], v[80:83]
    ds_read_b64_tr_b16 v[128:129], v144 offset:4096
    v_mfma_f32_16x16x32_bf16 v[96:99], v[112:115], v[20:23], v[96:99]
    ds_read_b64_tr_b16 v[130:131], v144 offset:6144
    s_waitcnt lgkmcnt(6)
    v_mfma_f32_16x16x32_bf16 v[84:87], v[116:119], v[16:19], v[84:87]
    ds_read_b64_tr_b16 v[132:133], v145 offset:4096
    v_mfma_f32_16x16x32_bf16 v[100:103], v[116:119], v[20:23], v[100:103]
    ds_read_b64_tr_b16 v[134:135], v145 offset:6144
    s_waitcnt lgkmcnt(6)
    v_mfma_f32_16x16x32_bf16 v[88:91], v[120:123], v[16:19], v[88:91]
    ds_read_b64_tr_b16 v[136:137], v146 offset:4096
    v_mfma_f32_16x16x32_bf16 v[104:107], v[120:123], v[20:23], v[104:107]
    ds_read_b64_tr_b16 v[138:139], v146 offset:6144
    s_waitcnt lgkmcnt(6)
    v_mfma_f32_16x16x32_bf16 v[92:95], v[124:127], v[16:19], v[92:95]
    ds_read_b64_tr_b16 v[140:141], v147 offset:4096
    v_mfma_f32_16x16x32_bf16 v[108:111], v[124:127], v[20:23], v[108:111]
    ds_read_b64_tr_b16 v[142:143], v147 offset:6144
    s_not_b32 s91, s66
    s_cmp_eq_u32 s65, 0
    s_cselect_b32 s65, s91, s65
    s_cselect_b32 s66, -1, s66
    s_ff1_i32_b32 s91, s65
    s_bitset0_b32 s65, s91
    s_lshl_b32 s78, s91, 12
    s_lshl_b32 s91, s91, 10
    buffer_load_dwordx4 v[48:51], v157, s[16:19], s91 offen offset:0 sc1
    buffer_load_dwordx4 v[52:55], v158, s[16:19], s91 offen offset:0 sc1
    s_waitcnt vmcnt(6) lgkmcnt(6)
    v_max3_u32 v156, v156, v27, v31
    v_mfma_f32_16x16x32_bf16 v[80:83], v[128:131], v[24:27], v[80:83]
    s_xor_b32 s89, s67, s77
    s_mov_b32 s67, s77
    v_xor_b32 v144, s89, v144
    ds_read_b64_tr_b16 v[112:113], v144 offset:0
    v_mfma_f32_16x16x32_bf16 v[96:99], v[128:131], v[28:31], v[96:99]
    ds_read_b64_tr_b16 v[114:115], v144 offset:2048
    s_waitcnt lgkmcnt(6)
    v_mfma_f32_16x16x32_bf16 v[84:87], v[132:135], v[24:27], v[84:87]
    v_xor_b32 v145, s89, v145
    ds_read_b64_tr_b16 v[116:117], v145 offset:0
    v_mfma_f32_16x16x32_bf16 v[100:103], v[132:135], v[28:31], v[100:103]
    ds_read_b64_tr_b16 v[118:119], v145 offset:2048
    s_waitcnt lgkmcnt(6)
    v_mfma_f32_16x16x32_bf16 v[88:91], v[136:139], v[24:27], v[88:91]
    v_xor_b32 v146, s89, v146
    ds_read_b64_tr_b16 v[120:121], v146 offset:0
    v_mfma_f32_16x16x32_bf16 v[104:107], v[136:139], v[28:31], v[104:107]
    ds_read_b64_tr_b16 v[122:123], v146 offset:2048
    s_waitcnt lgkmcnt(6)
    v_mfma_f32_16x16x32_bf16 v[92:95], v[140:143], v[24:27], v[92:95]
    v_xor_b32 v147, s89, v147
    ds_read_b64_tr_b16 v[124:125], v147 offset:0
    v_mfma_f32_16x16x32_bf16 v[108:111], v[140:143], v[28:31], v[108:111]
    ds_read_b64_tr_b16 v[126:127], v147 offset:2048
    buffer_load_dwordx4 v[56:59], v157, s[16:19], s91 offen offset:1024 sc1
    buffer_load_dwordx4 v[60:63], v158, s[16:19], s91 offen offset:1024 sc1
    s_waitcnt vmcnt(6) lgkmcnt(6)
    v_max3_u32 v156, v156, v35, v39
    v_mfma_f32_16x16x32_bf16 v[80:83], v[112:115], v[32:35], v[80:83]
    ds_read_b64_tr_b16 v[128:129], v144 offset:4096
    v_mfma_f32_16x16x32_bf16 v[96:99], v[112:115], v[36:39], v[96:99]
    ds_read_b64_tr_b16 v[130:131], v144 offset:6144
    s_waitcnt lgkmcnt(6)
    v_mfma_f32_16x16x32_bf16 v[84:87], v[116:119], v[32:35], v[84:87]
    ds_read_b64_tr_b16 v[132:133], v145 offset:4096
    v_mfma_f32_16x16x32_bf16 v[100:103], v[116:119], v[36:39], v[100:103]
    ds_read_b64_tr_b16 v[134:135], v145 offset:6144
    s_waitcnt lgkmcnt(6)
    v_mfma_f32_16x16x32_bf16 v[88:91], v[120:123], v[32:35], v[88:91]
    ds_read_b64_tr_b16 v[136:137], v146 offset:4096
    v_mfma_f32_16x16x32_bf16 v[104:107], v[120:123], v[36:39], v[104:107]
    ds_read_b64_tr_b16 v[138:139], v146 offset:6144
    s_waitcnt lgkmcnt(6)
    v_mfma_f32_16x16x32_bf16 v[92:95], v[124:127], v[32:35], v[92:95]
    ds_read_b64_tr_b16 v[140:141], v147 offset:4096
    v_mfma_f32_16x16x32_bf16 v[108:111], v[124:127], v[36:39], v[108:111]
    ds_read_b64_tr_b16 v[142:143], v147 offset:6144
    s_not_b32 s91, s66
    s_cmp_eq_u32 s65, 0
    s_cselect_b32 s65, s91, s65
    s_cselect_b32 s66, -1, s66
    s_ff1_i32_b32 s91, s65
    s_bitset0_b32 s65, s91
    s_lshl_b32 s79, s91, 12
    s_lshl_b32 s91, s91, 10
    buffer_load_dwordx4 v[64:67], v157, s[16:19], s91 offen offset:0 sc1
    buffer_load_dwordx4 v[68:71], v158, s[16:19], s91 offen offset:0 sc1
    s_waitcnt vmcnt(6) lgkmcnt(6)
    v_max3_u32 v156, v156, v43, v47
    v_mfma_f32_16x16x32_bf16 v[80:83], v[128:131], v[40:43], v[80:83]
    s_xor_b32 s89, s67, s78
    s_mov_b32 s67, s78
    v_xor_b32 v144, s89, v144
    ds_read_b64_tr_b16 v[112:113], v144 offset:0
    v_mfma_f32_16x16x32_bf16 v[96:99], v[128:131], v[44:47], v[96:99]
    ds_read_b64_tr_b16 v[114:115], v144 offset:2048
    s_waitcnt lgkmcnt(6)
    v_mfma_f32_16x16x32_bf16 v[84:87], v[132:135], v[40:43], v[84:87]
    v_xor_b32 v145, s89, v145
    ds_read_b64_tr_b16 v[116:117], v145 offset:0
    v_mfma_f32_16x16x32_bf16 v[100:103], v[132:135], v[44:47], v[100:103]
    ds_read_b64_tr_b16 v[118:119], v145 offset:2048
    s_waitcnt lgkmcnt(6)
    v_mfma_f32_16x16x32_bf16 v[88:91], v[136:139], v[40:43], v[88:91]
    v_xor_b32 v146, s89, v146
    ds_read_b64_tr_b16 v[120:121], v146 offset:0
    v_mfma_f32_16x16x32_bf16 v[104:107], v[136:139], v[44:47], v[104:107]
    ds_read_b64_tr_b16 v[122:123], v146 offset:2048
    s_waitcnt lgkmcnt(6)
    v_mfma_f32_16x16x32_bf16 v[92:95], v[140:143], v[40:43], v[92:95]
    v_xor_b32 v147, s89, v147
    ds_read_b64_tr_b16 v[124:125], v147 offset:0
    v_mfma_f32_16x16x32_bf16 v[108:111], v[140:143], v[44:47], v[108:111]
    ds_read_b64_tr_b16 v[126:127], v147 offset:2048
    buffer_load_dwordx4 v[72:75], v157, s[16:19], s91 offen offset:1024 sc1
    buffer_load_dwordx4 v[76:79], v158, s[16:19], s91 offen offset:1024 sc1
    s_waitcnt vmcnt(6) lgkmcnt(6)
L_b_c4:
    v_max_u32 v4, v51, v55
    v_cmp_eq_u32 vcc, -1, v4
    s_cbranch_vccnz L_b_g4
L_b_d4:
    v_mfma_f32_16x16x32_bf16 v[80:83], v[112:115], v[48:51], v[80:83]
    ds_read_b64_tr_b16 v[128:129], v144 offset:4096
    v_mfma_f32_16x16x32_bf16 v[96:99], v[112:115], v[52:55], v[96:99]
    ds_read_b64_tr_b16 v[130:131], v144 offset:6144
    s_waitcnt lgkmcnt(6)
    v_mfma_f32_16x16x32_bf16 v[84:87], v[116:119], v[48:51], v[84:87]
    ds_read_b64_tr_b16 v[132:133], v145 offset:4096
    v_mfma_f32_16x16x32_bf16 v[100:103], v[116:119], v[52:55], v[100:103]
    ds_read_b64_tr_b16 v[134:135], v145 offset:6144
    s_waitcnt lgkmcnt(6)
    v_mfma_f32_16x16x32_bf16 v[88:91], v[120:123], v[48:51], v[88:91]
    ds_read_b64_tr_b16 v[136:137], v146 offset:4096
    v_mfma_f32_16x16x32_bf16 v[104:107], v[120:123], v[52:55], v[104:107]
    ds_read_b64_tr_b16 v[138:139], v146 offset:6144
    s_waitcnt lgkmcnt(6)
    v_mfma_f32_16x16x32_bf16 v[92:95], v[124:127], v[48:51], v[92:95]
    ds_read_b64_tr_b16 v[140:141], v147 offset:4096
    v_mfma_f32_16x16x32_bf16 v[108:111], v[124:127], v[52:55], v[108:111]
    ds_read_b64_tr_b16 v[142:143], v147 offset:6144
    s_not_b32 s91, s66
    s_cmp_eq_u32 s65, 0
    s_cselect_b32 s65, s91, s65
    s_cselect_b32 s66, -1, s66
    s_ff1_i32_b32 s91, s65
    s_bitset0_b32 s65, s91
    s_lshl_b32 s76, s91, 12
    s_lshl_b32 s91, s91, 10
    buffer_load_dwordx4 v[16:19], v157, s[16:19], s91 offen offset:0 sc1
    buffer_load_dwordx4 v[20:23], v158, s[16:19], s91 offen offset:0 sc1
L_walkB6:
    s_cbranch_execz L_walk_21
    s_waitcnt vmcnt(6) lgkmcnt(6)
L_b_c5:
    v_max_u32 v4, v59, v63
    v_cmp_eq_u32 vcc, -1, v4
    s_cbranch_vccnz L_b_g5
L_b_d5:
    v_mfma_f32_16x16x32_bf16 v[80:83], v[128:131], v[56:59], v[80:83]
    s_xor_b32 s89, s67, s79
    s_mov_b32 s67, s79
    v_xor_b32 v144, s89, v144
    ds_read_b64_tr_b16 v[112:113], v144 offset:0
    v_mfma_f32_16x16x32_bf16 v[96:99], v[128:131], v[60:63], v[96:99]
    ds_read_b64_tr_b16 v[114:115], v144 offset:2048
    s_waitcnt lgkmcnt(6)
    v_mfma_f32_16x16x32_bf16 v[84:87], v[132:135], v[56:59], v[84:87]
    v_xor_b32 v145, s89, v145
    ds_read_b64_tr_b16 v[116:117], v145 offset:0
    v_mfma_f32_16x16x32_bf16 v[100:103], v[132:135], v[60:63], v[100:103]
    ds_read_b64_tr_b16 v[118:119], v145 offset:2048
    s_waitcnt lgkmcnt(6)
    v_mfma_f32_16x16x32_bf16 v[88:91], v[136:139], v[56:59], v[88:91]
    v_xor_b32 v146, s89, v146
    ds_read_b64_tr_b16 v[120:121], v146 offset:0
    v_mfma_f32_16x16x32_bf16 v[104:107], v[136:139], v[60:63], v[104:107]
    ds_read_b64_tr_b16 v[122:123], v146 offset:2048
    s_waitcnt lgkmcnt(6)
    v_mfma_f32_16x16x32_bf16 v[92:95], v[140:143], v[56:59], v[92:95]
    v_xor_b32 v147, s89, v147
    ds_read_b64_tr_b16 v[124:125], v147 offset:0
    v_mfma_f32_16x16x32_bf16 v[108:111], v[140:143], v[60:63], v[108:111]
    ds_read_b64_tr_b16 v[126:127], v147 offset:2048
    buffer_load_dwordx4 v[24:27], v157, s[16:19], s91 offen offset:1024 sc1
    buffer_load_dwordx4 v[28:31], v158, s[16:19], s91 offen offset:1024 sc1
    s_setprio 0
    s_waitcnt vmcnt(6) lgkmcnt(6)
L_b_c6:
    v_max_u32 v4, v67, v71
    v_cmp_eq_u32 vcc, -1, v4
    s_cbranch_vccnz L_b_g6
L_b_d6:
    v_mfma_f32_16x16x32_bf16 v[80:83], v[112:115], v[64:67], v[80:83]
    ds_read_b64_tr_b16 v[128:129], v144 offset:4096
    v_mfma_f32_16x16x32_bf16 v[96:99], v[112:115], v[68:71], v[96:99]
    ds_read_b64_tr_b16 v[130:131], v144 offset:6144
    s_waitcnt lgkmcnt(6)
    v_mfma_f32_16x16x32_bf16 v[84:87], v[116:119], v[64:67], v[84:87]
    ds_read_b64_tr_b16 v[132:133], v145 offset:4096
    v_mfma_f32_16x16x32_bf16 v[100:103], v[116:119], v[68:71], v[100:103]
    ds_read_b64_tr_b16 v[134:135], v145 offset:6144
    s_waitcnt lgkmcnt(6)
    v_mfma_f32_16x16x32_bf16 v[88:91], v[120:123], v[64:67], v[88:91]
    ds_read_b64_tr_b16 v[136:137], v146 offset:4096
    v_mfma_f32_16x16x32_bf16 v[104:107], v[120:123], v[68:71], v[104:107]
    ds_read_b64_tr_b16 v[138:139], v146 offset:6144
    s_waitcnt lgkmcnt(6)
    v_mfma_f32_16x16x32_bf16 v[92:95], v[124:127], v[64:67], v[92:95]
    ds_read_b64_tr_b16 v[140:141], v147 offset:4096
    v_mfma_f32_16x16x32_bf16 v[108:111], v[124:127], v[68:71], v[108:111]
    ds_read_b64_tr_b16 v[142:143], v147 offset:6144
    s_not_b32 s91, s66
    s_cmp_eq_u32 s65, 0
    s_cselect_b32 s65, s91, s65
    s_cselect_b32 s66, -1, s66
    s_ff1_i32_b32 s91, s65
    s_bitset0_b32 s65, s91
    s_lshl_b32 s77, s91, 12
    s_lshl_b32 s91, s91, 10
    buffer_load_dwordx4 v[32:35], v157, s[16:19], s91 offen offset:0 sc1
    buffer_load_dwordx4 v[36:39], v158, s[16:19], s91 offen offset:0 sc1
    s_waitcnt vmcnt(6) lgkmcnt(6)
L_b_c7:
    v_max_u32 v4, v75, v79
    v_cmp_eq_u32 vcc, -1, v4
    s_cbranch_vccnz L_b_g7
L_b_d7:
    v_mfma_f32_16x16x32_bf16 v[80:83], v[128:131], v[72:75], v[80:83]
    s_xor_b32 s89, s67, s76
    s_mov_b32 s67, s76
    v_xor_b32 v144, s89, v144
    ds_read_b64_tr_b16 v[112:113], v144 offset:0
    v_mfma_f32_16x16x32_bf16 v[96:99], v[128:131], v[76:79], v[96:99]
    ds_read_b64_tr_b16 v[114:115], v144 offset:2048
    s_waitcnt lgkmcnt(6)
    v_mfma_f32_16x16x32_bf16 v[84:87], v[132:135], v[72:75], v[84:87]
    v_xor_b32 v145, s89, v145
    ds_read_b64_tr_b16 v[116:117], v145 offset:0
    v_mfma_f32_16x16x32_bf16 v[100:103], v[132:135], v[76:79], v[100:103]
    ds_read_b64_tr_b16 v[118:119], v145 offset:2048
    s_waitcnt lgkmcnt(6)
    v_mfma_f32_16x16x32_bf16 v[88:91], v[136:139], v[72:75], v[88:91]
    v_xor_b32 v146, s89, v146
    ds_read_b64_tr_b16 v[120:121], v146 offset:0
    v_mfma_f32_16x16x32_bf16 v[104:107], v[136:139], v[76:79], v[104:107]
    ds_read_b64_tr_b16 v[122:123], v146 offset:2048
    s_waitcnt lgkmcnt(6)
    v_mfma_f32_16x16x32_bf16 v[92:95], v[140:143], v[72:75], v[92:95]
    v_xor_b32 v147, s89, v147
    ds_read_b64_tr_b16 v[124:125], v147 offset:0
    v_mfma_f32_16x16x32_bf16 v[108:111], v[140:143], v[76:79], v[108:111]
    ds_read_b64_tr_b16 v[126:127], v147 offset:2048
    buffer_load_dwordx4 v[40:43], v157, s[16:19], s91 offen offset:1024 sc1
    buffer_load_dwordx4 v[44:47], v158, s[16:19], s91 offen offset:1024 sc1
    s_waitcnt vmcnt(6) lgkmcnt(6)
L_b_c8:
    v_max_u32 v4, v19, v23
    v_cmp_eq_u32 vcc, -1, v4
    s_cbranch_vccnz L_b_g8
L_b_d8:
    v_mfma_f32_16x16x32_bf16 v[80:83], v[112:115], v[16:19], v[80:83]
    ds_read_b64_tr_b16 v[128:129], v144 offset:4096
    v_mfma_f32_16x16x32_bf16 v[96:99], v[112:115], v[20:23], v[96:99]
    ds_read_b64_tr_b16 v[130:131], v144 offset:6144
    s_waitcnt lgkmcnt(6)
    v_mfma_f32_16x16x32_bf16 v[84:87], v[116:119], v[16:19], v[84:87]
    ds_read_b64_tr_b16 v[132:133], v145 offset:4096
    v_mfma_f32_16x16x32_bf16 v[100:103], v[116:119], v[20:23], v[100:103]
    ds_read_b64_tr_b16 v[134:135], v145 offset:6144
    s_waitcnt lgkmcnt(6)
    v_mfma_f32_16x16x32_bf16 v[88:91], v[120:123], v[16:19], v[88:91]
    ds_read_b64_tr_b16 v[136:137], v146 offset:4096
    v_mfma_f32_16x16x32_bf16 v[104:107], v[120:123], v[20:23], v[104:107]
    ds_read_b64_tr_b16 v[138:139], v146 offset:6144
    s_waitcnt lgkmcnt(6)
    v_mfma_f32_16x16x32_bf16 v[92:95], v[124:127], v[16:19], v[92:95]
    ds_read_b64_tr_b16 v[140:141], v147 offset:4096
    v_mfma_f32_16x16x32_bf16 v[108:111], v[124:127], v[20:23], v[108:111]
    ds_read_b64_tr_b16 v[142:143], v147 offset:6144
    s_not_b32 s91, s66
    s_cmp_eq_u32 s65, 0
    s_cselect_b32 s65, s91, s65
    s_cselect_b32 s66, -1, s66
    s_ff1_i32_b32 s91, s65
    s_bitset0_b32 s65, s91
    s_lshl_b32 s78, s91, 12
    s_lshl_b32 s91, s91, 10
    buffer_load_dwordx4 v[48:51], v157, s[16:19], s91 offen offset:0 sc1
    buffer_load_dwordx4 v[52:55], v158, s[16:19], s91 offen offset:0 sc1
    s_waitcnt vmcnt(6) lgkmcnt(6)
L_b_c9:
    v_max_u32 v4, v27, v31
    v_cmp_eq_u32 vcc, -1, v4
    s_cbranch_vccnz L_b_g9
L_b_d9:
    v_mfma_f32_16x16x32_bf16 v[80:83], v[128:131], v[24:27], v[80:83]
    s_xor_b32 s89, s67, s77
    s_mov_b32 s67, s77
    v_xor_b32 v144, s89, v144
    ds_read_b64_tr_b16 v[112:113], v144 offset:0
    v_mfma_f32_16x16x32_bf16 v[96:99], v[128:131], v[28:31], v[96:99]
    ds_read_b64_tr_b16 v[114:115], v144 offset:2048
    s_waitcnt lgkmcnt(6)
    v_mfma_f32_16x16x32_bf16 v[84:87], v[132:135], v[24:27], v[84:87]
    v_xor_b32 v145, s89, v145
    ds_read_b64_tr_b16 v[116:117], v145 offset:0
    v_mfma_f32_16x16x32_bf16 v[100:103], v[132:135], v[28:31], v[100:103]
    ds_read_b64_tr_b16 v[118:119], v145 offset:2048
    s_waitcnt lgkmcnt(6)
    v_mfma_f32_16x16x32_bf16 v[88:91], v[136:139], v[24:27], v[88:91]
    v_xor_b32 v146, s89, v146
    ds_read_b64_tr_b16 v[120:121], v146 offset:0
    v_mfma_f32_16x16x32_bf16 v[104:107], v[136:139], v[28:31], v[104:107]
    ds_read_b64_tr_b16 v[122:123], v146 offset:2048
    s_waitcnt lgkmcnt(6)
    v_mfma_f32_16x16x32_bf16 v[92:95], v[140:143], v[24:27], v[92:95]
    v_xor_b32 v147, s89, v147
    ds_read_b64_tr_b16 v[124:125], v147 offset:0
    v_mfma_f32_16x16x32_bf16 v[108:111], v[140:143], v[28:31], v[108:111]
    ds_read_b64_tr_b16 v[126:127], v147 offset:2048
    buffer_load_dwordx4 v[56:59], v157, s[16:19], s91 offen offset:1024 sc1
    buffer_load_dwordx4 v[60:63], v158, s[16:19], s91 offen offset:1024 sc1
    s_waitcnt vmcnt(6) lgkmcnt(6)
L_b_c10:
    v_max_u32 v4, v35, v39
    v_cmp_eq_u32 vcc, -1, v4
    s_cbranch_vccnz L_b_g10
L_b_d10:
    v_mfma_f32_16x16x32_bf16 v[80:83], v[112:115], v[32:35], v[80:83]
    ds_read_b64_tr_b16 v[128:129], v144 offset:4096
    v_mfma_f32_16x16x32_bf16 v[96:99], v[112:115], v[36:39], v[96:99]
    ds_read_b64_tr_b16 v[130:131], v144 offset:6144
    s_waitcnt lgkmcnt(6)
    v_mfma_f32_16x16x32_bf16 v[84:87], v[116:119], v[32:35], v[84:87]
L_walkB7:
    s_cbranch_execz L_walk_22
    ds_read_b64_tr_b16 v[132:133], v145 offset:4096
    v_mfma_f32_16x16x32_bf16 v[100:103], v[116:119], v[36:39], v[100:103]
    ds_read_b64_tr_b16 v[134:135], v145 offset:6144
    s_waitcnt lgkmcnt(6)
    v_mfma_f32_16x16x32_bf16 v[88:91], v[120:123], v[32:35], v[88:91]
    ds_read_b64_tr_b16 v[136:137], v146 offset:4096
    v_mfma_f32_16x16x32_bf16 v[104:107], v[120:123], v[36:39], v[104:107]
    ds_read_b64_tr_b16 v[138:139], v146 offset:6144
    s_waitcnt lgkmcnt(6)
    v_mfma_f32_16x16x32_bf16 v[92:95], v[124:127], v[32:35], v[92:95]
    ds_read_b64_tr_b16 v[140:141], v147 offset:4096
    v_mfma_f32_16x16x32_bf16 v[108:111], v[124:127], v[36:39], v[108:111]
    ds_read_b64_tr_b16 v[142:143], v147 offset:6144
    s_not_b32 s91, s66
    s_or_b32 s65, s65, s91
    s_ff1_i32_b32 s91, s65
    s_bitset0_b32 s65, s91
    s_lshl_b32 s79, s91, 12
    s_lshl_b32 s91, s91, 10
    buffer_load_dwordx4 v[64:67], v157, s[16:19], s91 offen offset:0 sc1
    buffer_load_dwordx4 v[68:71], v158, s[16:19], s91 offen offset:0 sc1
    s_waitcnt vmcnt(6) lgkmcnt(6)
L_b_c11:
    v_max_u32 v4, v43, v47
    v_cmp_eq_u32 vcc, -1, v4
    s_cbranch_vccnz L_b_g11
L_b_d11:
    v_mfma_f32_16x16x32_bf16 v[80:83], v[128:131], v[40:43], v[80:83]
    s_xor_b32 s89, s67, s78
    s_mov_b32 s67, s78
    v_xor_b32 v144, s89, v144
    ds_read_b64_tr_b16 v[112:113], v144 offset:0
    v_mfma_f32_16x16x32_bf16 v[96:99], v[128:131], v[44:47], v[96:99]
    ds_read_b64_tr_b16 v[114:115], v144 offset:2048
    s_waitcnt lgkmcnt(6)
    v_mfma_f32_16x16x32_bf16 v[84:87], v[132:135], v[40:43], v[84:87]
    v_xor_b32 v145, s89, v145
    ds_read_b64_tr_b16 v[116:117], v145 offset:0
    v_mfma_f32_16x16x32_bf16 v[100:103], v[132:135], v[44:47], v[100:103]
    ds_read_b64_tr_b16 v[118:119], v145 offset:2048
    s_waitcnt lgkmcnt(6)
    v_mfma_f32_16x16x32_bf16 v[88:91], v[136:139], v[40:43], v[88:91]
    v_xor_b32 v146, s89, v146
    ds_read_b64_tr_b16 v[120:121], v146 offset:0
    v_mfma_f32_16x16x32_bf16 v[104:107], v[136:139], v[44:47], v[104:107]
    ds_read_b64_tr_b16 v[122:123], v146 offset:2048
    s_waitcnt lgkmcnt(6)
    v_mfma_f32_16x16x32_bf16 v[92:95], v[140:143], v[40:43], v[92:95]
    v_xor_b32 v147, s89, v147
    ds_read_b64_tr_b16 v[124:125], v147 offset:0
    v_mfma_f32_16x16x32_bf16 v[108:111], v[140:143], v[44:47], v[108:111]
    ds_read_b64_tr_b16 v[126:127], v147 offset:2048
    buffer_load_dwordx4 v[72:75], v157, s[16:19], s91 offen offset:1024 sc1
    buffer_load_dwordx4 v[76:79], v158, s[16:19], s91 offen offset:1024 sc1
    s_waitcnt vmcnt(6) lgkmcnt(6)
L_b_c12:
    v_max_u32 v4, v51, v55
    v_cmp_eq_u32 vcc, -1, v4
    s_cbranch_vccnz L_b_g12
L_b_d12:
    v_mfma_f32_16x16x32_bf16 v[80:83], v[112:115], v[48:51], v[80:83]
    ds_read_b64_tr_b16 v[128:129], v144 offset:4096
    v_mfma_f32_16x16x32_bf16 v[96:99], v[112:115], v[52:55], v[96:99]
    ds_read_b64_tr_b16 v[130:131], v144 offset:6144
    s_waitcnt lgkmcnt(6)
    v_mfma_f32_16x16x32_bf16 v[84:87], v[116:119], v[48:51], v[84:87]
    ds_read_b64_tr_b16 v[132:133], v145 offset:4096
    v_mfma_f32_16x16x32_bf16 v[100:103], v[116:119], v[52:55], v[100:103]
    ds_read_b64_tr_b16 v[134:135], v145 offset:6144
    s_waitcnt lgkmcnt(6)
    v_mfma_f32_16x16x32_bf16 v[88:91], v[120:123], v[48:51], v[88:91]
    ds_read_b64_tr_b16 v[136:137], v146 offset:4096
    v_mfma_f32_16x16x32_bf16 v[104:107], v[120:123], v[52:55], v[104:107]
    ds_read_b64_tr_b16 v[138:139], v146 offset:6144
    s_waitcnt lgkmcnt(6)
    v_mfma_f32_16x16x32_bf16 v[92:95], v[124:127], v[48:51], v[92:95]
    ds_read_b64_tr_b16 v[140:141], v147 offset:4096
    v_mfma_f32_16x16x32_bf16 v[108:111], v[124:127], v[52:55], v[108:111]
    ds_read_b64_tr_b16 v[142:143], v147 offset:6144
    s_waitcnt vmcnt(4) lgkmcnt(6)
L_b_c13:
    v_max_u32 v4, v59, v63
    v_cmp_eq_u32 vcc, -1, v4
    s_cbranch_vccnz L_b_g13
L_b_d13:
    v_mfma_f32_16x16x32_bf16 v[80:83], v[128:131], v[56:59], v[80:83]
    s_xor_b32 s89, s67, s79
    s_mov_b32 s67, s79
    v_xor_b32 v144, s89, v144
    ds_read_b64_tr_b16 v[112:113], v144 offset:0
    v_mfma_f32_16x16x32_bf16 v[96:99], v[128:131], v[60:63], v[96:99]
    ds_read_b64_tr_b16 v[114:115], v144 offset:2048
    s_waitcnt lgkmcnt(6)
    v_mfma_f32_16x16x32_bf16 v[84:87], v[132:135], v[56:59], v[84:87]
    v_xor_b32 v145, s89, v145
    ds_read_b64_tr_b16 v[116:117], v145 offset:0
    v_mfma_f32_16x16x32_bf16 v[100:103], v[132:135], v[60:63], v[100:103]
    ds_read_b64_tr_b16 v[118:119], v145 offset:2048
    s_waitcnt lgkmcnt(6)
    v_mfma_f32_16x16x32_bf16 v[88:91], v[136:139], v[56:59], v[88:91]
    v_xor_b32 v146, s89, v146
    ds_read_b64_tr_b16 v[120:121], v146 offset:0
    v_mfma_f32_16x16x32_bf16 v[104:107], v[136:139], v[60:63], v[104:107]
    ds_read_b64_tr_b16 v[122:123], v146 offset:2048
    s_waitcnt lgkmcnt(6)
    v_mfma_f32_16x16x32_bf16 v[92:95], v[140:143], v[56:59], v[92:95]
    v_xor_b32 v147, s89, v147
    ds_read_b64_tr_b16 v[124:125], v147 offset:0
    v_mfma_f32_16x16x32_bf16 v[108:111], v[140:143], v[60:63], v[108:111]
    ds_read_b64_tr_b16 v[126:127], v147 offset:2048
    s_waitcnt vmcnt(2) lgkmcnt(6)
L_b_c14:
    v_max_u32 v4, v67, v71
    v_cmp_eq_u32 vcc, -1, v4
    s_cbranch_vccnz L_b_g14
L_b_d14:
    v_mfma_f32_16x16x32_bf16 v[80:83], v[112:115], v[64:67], v[80:83]
    ds_read_b64_tr_b16 v[128:129], v144 offset:4096
    v_mfma_f32_16x16x32_bf16 v[96:99], v[112:115], v[68:71], v[96:99]
    ds_read_b64_tr_b16 v[130:131], v144 offset:6144
    s_waitcnt lgkmcnt(6)
    v_mfma_f32_16x16x32_bf16 v[84:87], v[116:119], v[64:67], v[84:87]
    ds_read_b64_tr_b16 v[132:133], v145 offset:4096
    v_mfma_f32_16x16x32_bf16 v[100:103], v[116:119], v[68:71], v[100:103]
    ds_read_b64_tr_b16 v[134:135], v145 offset:6144
    s_waitcnt lgkmcnt(6)
    v_mfma_f32_16x16x32_bf16 v[88:91], v[120:123], v[64:67], v[88:91]
    ds_read_b64_tr_b16 v[136:137], v146 offset:4096
    v_mfma_f32_16x16x32_bf16 v[104:107], v[120:123], v[68:71], v[104:107]
    ds_read_b64_tr_b16 v[138:139], v146 offset:6144
    s_waitcnt lgkmcnt(6)
    v_mfma_f32_16x16x32_bf16 v[92:95], v[124:127], v[64:67], v[92:95]
    ds_read_b64_tr_b16 v[140:141], v147 offset:4096
    v_mfma_f32_16x16x32_bf16 v[108:111], v[124:127], v[68:71], v[108:111]
    ds_read_b64_tr_b16 v[142:143], v147 offset:6144
    s_waitcnt vmcnt(0) lgkmcnt(6)
L_b_c15:
    v_max_u32 v4, v75, v79
    v_cmp_eq_u32 vcc, -1, v4
    s_cbranch_vccnz L_b_g15
L_b_d15:
    v_cmp_eq_u32 vcc, -1, v156
    s_cbranch_vccz L_ok_4
    s_sub_u32 s56, s56, 1
    s_cbranch_scc0 L_b_restart
    s_mov_b32 s56, 0
L_ok_4:
    v_mfma_f32_16x16x32_bf16 v[80:83], v[128:131], v[72:75], v[80:83]
    s_mov_b32 s90, 71680
    buffer_load_dwordx4 v[204:207], v11, s[32:35], s90 offen
    v_mfma_f32_16x16x32_bf16 v[96:99], v[128:131], v[76:79], v[96:99]
    s_mov_b32 s90, 78848
    buffer_load_dwordx4 v[208:211], v11, s[32:35], s90 offen
    s_waitcnt lgkmcnt(4)
    v_mfma_f32_16x16x32_bf16 v[84:87], v[132:135], v[72:75], v[84:87]
    v_mfma_f32_16x16x32_bf16 v[100:103], v[132:135], v[76:79], v[100:103]
    s_mov_b32 s90, 86016
    buffer_load_dwordx4 v[212:215], v11, s[32:35], s90 offen
    s_waitcnt lgkmcnt(2)
    v_mfma_f32_16x16x32_bf16 v[88:91], v[136:139], v[72:75], v[88:91]
    s_mov_b32 s90, 93184
    buffer_load_dwordx4 v[216:219], v11, s[32:35], s90 offen
    v_mfma_f32_16x16x32_bf16 v[104:107], v[136:139], v[76:79], v[104:107]
    s_mov_b32 s90, 100352
    buffer_load_dwordx4 v[220:223], v11, s[32:35], s90 offen
    s_waitcnt lgkmcnt(0)
    v_mfma_f32_16x16x32_bf16 v[92:95], v[140:143], v[72:75], v[92:95]
    v_mfma_f32_16x16x32_bf16 v[108:111], v[140:143], v[76:79], v[108:111]
    s_mov_b32 s90, 107520
    buffer_load_dwordx4 v[224:227], v11, s[32:35], s90 offen
    ds_write_b128 v162, v[96:99] offset:0
    ds_write_b128 v162, v[100:103] offset:1024
    ds_write_b128 v162, v[104:107] offset:2048
    s_nop 2
    ds_write_b128 v162, v[108:111] offset:3072
    s_waitcnt lgkmcnt(0)
    s_barrier
    ds_read_b128 v[16:19], v163 offset:0
L_walk_19:
    s_cbranch_execz L_walk_23
    ds_read_b128 v[20:23], v163 offset:1024
    ds_read_b128 v[24:27], v163 offset:2048
    ds_read_b128 v[28:31], v163 offset:3072
    s_waitcnt lgkmcnt(3)
    v_pk_add_f32 v[80:81], v[80:81], v[16:17]
    v_pk_add_f32 v[82:83], v[82:83], v[18:19]
    v_cvt_pk_bf16_f32 v32, v80, v81
    v_cvt_pk_bf16_f32 v33, v82, v83
    s_waitcnt lgkmcnt(2)
    v_pk_add_f32 v[84:85], v[84:85], v[20:21]
    v_pk_add_f32 v[86:87], v[86:87], v[22:23]
    v_cvt_pk_bf16_f32 v34, v84, v85
    v_cvt_pk_bf16_f32 v35, v86, v87
    s_waitcnt lgkmcnt(1)
    v_pk_add_f32 v[88:89], v[88:89], v[24:25]
    v_pk_add_f32 v[90:91], v[90:91], v[26:27]
    v_cvt_pk_bf16_f32 v36, v88, v89
    v_cvt_pk_bf16_f32 v37, v90, v91
    s_waitcnt lgkmcnt(0)
    v_pk_add_f32 v[92:93], v[92:93], v[28:29]
    v_pk_add_f32 v[94:95], v[94:95], v[30:31]
    v_cvt_pk_bf16_f32 v38, v92, v93
    v_cvt_pk_bf16_f32 v39, v94, v95
    v_mfma_f32_16x16x32_bf16 v[60:63], v[32:35], v[32:35], 0
    v_mfma_f32_16x16x32_bf16 v[56:59], v[32:35], v[148:151], 0
    v_mfma_f32_16x16x32_bf16 v[60:63], v[36:39], v[36:39], v[60:63]
    v_mfma_f32_16x16x32_bf16 v[56:59], v[36:39], v[152:155], v[56:59]
    v_lshlrev_b32 v40, 16, v32
    v_and_b32 v41, 0xffff0000, v32
    v_lshlrev_b32 v42, 16, v33
    v_and_b32 v43, 0xffff0000, v33
    v_lshlrev_b32 v44, 16, v34
    v_and_b32 v45, 0xffff0000, v34
    s_nop 1
    v_cndmask_b32 v56, v56, v60, s[72:73]
    v_cndmask_b32 v57, v57, v61, s[72:73]
    v_cndmask_b32 v58, v58, v62, s[72:73]
    v_cndmask_b32 v59, v59, v63, s[72:73]
    v_cndmask_b32 v56, v56, v57, s[4:5]
    v_cndmask_b32 v58, v58, v59, s[98:99]
    s_or_b64 vcc, s[6:7], s[98:99]
    v_cndmask_b32 v56, v56, v58, vcc
    v_cndmask_b32 v56, v56, 1.0, s[74:75]
    v_mov_b32 v67, v56
    buffer_atomic_add_f32 v67, v160, s[16:19], 0 offen sc0 sc1
    s_mov_b32 s90, 0
    buffer_load_dwordx4 v[228:231], v14, s[36:39], s90 offen
    s_mov_b32 s90, 2048
    buffer_load_dwordx4 v[232:235], v14, s[36:39], s90 offen
    s_mov_b32 s90, 4096
    buffer_load_dwordx4 v[236:239], v14, s[36:39], s90 offen
    s_lshl_b32 s86, s3, 11
    s_add_u32 s86, s86, 69632
    v_lshl_add_u32 v150, v0, 4, s86
    ds_write_b128 v150, v[32:35]
    ds_write_b128 v150, v[36:39] offset:1024
    s_lshl_b32 s86, s3, 7
    s_add_u32 s86, s86, 66560
    v_lshl_add_u32 v151, v2, 3, s86
    s_cmp_eq_u32 s62, 0
    s_cbranch_scc1 L_unp
    v_and_b32 v24, 1, v0
    v_cmp_eq_u32 vcc, 1, v24
    v_mov_b32 v24, 0x0c0c0100
    v_mov_b32 v25, 0x01000c0c
    v_cndmask_b32 v16, v24, v25, vcc
    v_mov_b32 v24, 0x0c0c0302
    v_mov_b32 v25, 0x03020c0c
    v_cndmask_b32 v17, v24, v25, vcc
    v_bfe_u32 v24, v0, 1, 2
    v_mov_b32 v25, 0x0c0c0c0c
    v_cmp_eq_u32 vcc, 0, v24
    s_nop 1
    v_cndmask_b32 v72, v25, v16, vcc
    v_cndmask_b32 v76, v25, v17, vcc
    v_cmp_eq_u32 vcc, 1, v24
    s_nop 1
    v_cndmask_b32 v73, v25, v16, vcc
    v_cndmask_b32 v77, v25, v17, vcc
    v_cmp_eq_u32 vcc, 2, v24
    s_nop 1
    v_cndmask_b32 v74, v25, v16, vcc
    v_cndmask_b32 v78, v25, v17, vcc
    v_cmp_eq_u32 vcc, 3, v24
    s_nop 1
    v_cndmask_b32 v75, v25, v16, vcc
    v_cndmask_b32 v79, v25, v17, vcc
    s_lshl_b32 s86, s48, 10
    s_add_u32 s86, s86, 90112
    v_lshl_add_u32 v18, v0, 4, s86
    s_and_b32 s86, s48, 1
    s_cselect_b32 s87, s81, s80
    s_lshr_b32 s90, s48, 1
    s_and_b32 s88, s82, 1
    s_and_b32 s89, s82, 6
    s_lshl3_add_u32 s88, s88, s89
    s_add_u32 s88, s88, s90
    s_mul_i32 s88, s88, 56
    s_add_u32 s88, s88, s87
    s_lshl_b32 s88, s88, 8
    s_add_u32 s88, s88, 7864320
    s_cmp_lt_u32 s87, 56
    s_cselect_b32 s88, s88, 2147483648
    v_lshl_add_u32 v131, v0, 2, s88
    s_lshl2_add_u32 s86, s90, s86
    s_lshl_b32 s86, s86, 7
    s_add_u32 s86, s86, 90112
    v_lshrrev_b32 v16, 3, v0
    v_lshl_add_u32 v133, v16, 4, s86
    v_bfe_u32 v17, v0, 2, 1
    v_lshl_add_u32 v133, v17, 8, v133
    v_and_b32 v17, 3, v0
    v_lshl_add_u32 v133, v17, 2, v133
    s_lshr_b32 s86, s82, 3
    s_lshl2_add_u32 s86, s86, s48
    s_mul_i32 s86, s86, 112
    s_add_u32 s86, s86, 7864320
    v_mul_u32_u24 v16, 14336, v16
    v_and_b32 v17, 7, v0
    v_lshl_add_u32 v137, v17, 4, s86
    v_add_u32 v137, v137, v16
    v_mov_b32 v16, 2147483648
    v_cmp_eq_u32 vcc, 7, v17
    s_nop 1
    v_cndmask_b32 v137, v137, v16, vcc
    s_branch L_unpd
L_unp:
    v_lshlrev_b32 v46, 16, v35
    v_and_b32 v47, 0xffff0000, v35
    v_lshlrev_b32 v48, 16, v36
    v_and_b32 v49, 0xffff0000, v36
    v_lshlrev_b32 v50, 16, v37
    v_and_b32 v51, 0xffff0000, v37
    v_lshlrev_b32 v52, 16, v38
    v_and_b32 v53, 0xffff0000, v38
    v_lshlrev_b32 v54, 16, v39
    v_and_b32 v55, 0xffff0000, v39
L_unpd:
    v_mov_b32 v9, 0x3a800000
    s_lshl_b32 s86, s3, 6
    s_add_u32 s86, s86, 65536
    v_lshl_add_u32 v152, v2, 2, s86
    v_and_b32 v10, 31, v0
    v_lshlrev_b32 v10, 4, v10
    v_add_u32 v10, 65536, v10
    s_lshl_b32 s86, s52, 11
    s_lshr_b32 s87, s51, 3
    s_lshl_b32 s87, s87, 6
    s_add_u32 s86, s86, s87
    s_and_b32 s87, s51, 7
    s_lshl3_add_u32 s86, s87, s86
    s_add_u32 s86, s86, 6684672
    v_lshl_add_u32 v149, v0, 7, s86
    v_mov_b32 v8, 2147483648
    v_cmp_gt_u32 vcc, 16, v0
    s_nop 1
    v_cndmask_b32 v149, v8, v149, vcc
    s_bfe_u32 s67, s82, 0x20001
    s_lshl2_add_u32 s67, s67, s48
    s_and_b32 s87, s2, 15
    s_lshl_b32 s86, s67, 4
    s_add_u32 s86, s86, s87
    s_lshl_b32 s86, s86, 7
    s_add_u32 s86, s86, 6684672
    v_lshl_add_u32 v148, v0, 3, s86
    v_mov_b32 v8, 2147483648
    v_cmp_gt_u32 vcc, 16, v0
    s_nop 1
    v_cndmask_b32 v148, v8, v148, vcc
    s_lshl_b32 s67, s67, 7
    s_add_u32 s67, s67, 6619136
    s_waitcnt vmcnt(3)
    v_add_f32 v67, v67, v56
    v_cmp_ne_u32 vcc, 0x41800000, v67
    s_nop 0
    s_and_b64 vcc, vcc, s[74:75]
    s_cbranch_scc1 L_h3
L_h3_done:
    v_mul_f32_dpp v64, v67, v9 row_ror:8 row_mask:0x5 bank_mask:0xf
    v_mov_b32_dpp v65, v67 row_ror:12 row_mask:0x5 bank_mask:0xf
    v_mul_f32 v66, v9, v67
    v_mul_f32_dpp v64, v67, v9 row_ror:12 row_mask:0xa bank_mask:0xf
    v_mov_b32_dpp v65, v67 row_ror:8 row_mask:0xa bank_mask:0xf
    v_fma_f32 v66, -v64, v64, v66
    v_max_f32 v66, 0, v66
L_walk_20:
    s_cbranch_execz L_walk_24
    v_cvt_pk_bf16_f32 v69, v64, v66
    v_lshlrev_b32 v68, 16, v69
    v_and_b32 v69, 0xffff0000, v69
    v_add_f32 v69, 0x3727c5ac, v69
    v_cvt_pk_bf16_f32 v69, v69, v69
    v_lshlrev_b32 v69, 16, v69
    v_sqrt_f32 v69, v69
    s_nop 0
    v_cvt_pk_bf16_f32 v69, v69, v69
    v_lshlrev_b32 v69, 16, v69
    v_rcp_f32 v70, v69
    v_fma_f32 v12, -v68, s57, v65
    v_mul_f32 v12, v12, v70
    v_mul_f32 v71, -v68, v70
    v_cvt_pk_bf16_f32 v12, v12, v12
    v_ashrrev_i32 v8, 31, v12
    v_or_b32 v8, 0x80000000, v8
    v_xor_b32 v8, v8, v12
    v_and_b32 v8, 4294901760, v8
    v_or_b32 v13, v8, v6
    s_mov_b64 exec, s[72:73]
    ds_write_b32 v152, v13
    ds_write_b64 v151, v[70:71]
    s_mov_b64 exec, -1
    ds_read_b64 v[70:71], v151
    ds_read_b32 v13, v152
    s_cmp_eq_u32 s62, 0
    s_cbranch_scc1 L_nop0
    v_mov_b32 v128, 0
    v_mov_b32 v129, 0
    buffer_atomic_or_x2 v[128:129], v148, s[16:19], 0 offen sc0 sc1
L_nop0:
    s_waitcnt lgkmcnt(2)
    s_barrier
    ds_read_b128 v[60:63], v10
    s_cmp_lg_u32 s62, 0
    s_cbranch_scc1 L_t3_ld
    ds_read_b32 v144, v152 offset:256
    ds_read_b64 v[142:143], v151 offset:512
    ds_read_b128 v[112:115], v150 offset:8192
    ds_read_b128 v[116:119], v150 offset:9216
    s_waitcnt lgkmcnt(5)
    s_waitcnt lgkmcnt(4)
    v_max3_u32 v64, v60, v61, v62
    v_max_u32 v66, v64, v63
    v_med3_u32 v67, v60, v61, v62
    v_med3_u32 v67, v64, v67, v63
    v_min_u32_dpp v64, v66, v66 row_ror:8 row_mask:0xf bank_mask:0xf
    v_max_u32_dpp v66, v66, v66 row_ror:8 row_mask:0xf bank_mask:0xf
    v_max_u32_dpp v65, v67, v67 row_ror:8 row_mask:0xf bank_mask:0xf
    v_max_u32 v67, v64, v65
    v_min_u32_dpp v64, v66, v66 row_ror:4 row_mask:0xf bank_mask:0xf
    v_max_u32_dpp v66, v66, v66 row_ror:4 row_mask:0xf bank_mask:0xf
    v_max_u32_dpp v65, v67, v67 row_ror:4 row_mask:0xf bank_mask:0xf
    v_max_u32 v67, v64, v65
    v_min_u32_dpp v64, v66, v66 row_ror:2 row_mask:0xf bank_mask:0xf
    v_max_u32_dpp v66, v66, v66 row_ror:2 row_mask:0xf bank_mask:0xf
    v_max_u32_dpp v65, v67, v67 row_ror:2 row_mask:0xf bank_mask:0xf
    v_max_u32 v67, v64, v65
    v_min_u32_dpp v64, v66, v66 row_ror:1 row_mask:0xf bank_mask:0xf
    v_max_u32_dpp v60, v66, v66 row_ror:1 row_mask:0xf bank_mask:0xf
    v_max_u32_dpp v65, v67, v67 row_ror:1 row_mask:0xf bank_mask:0xf
    v_max_u32_dpp v66, v66, v66 row_ror:1 row_mask:0xf bank_mask:0xf
    v_max_u32 v67, v64, v65
    v_max_u32 v65, v64, v65
    v_permlane16_swap_b32 v66, v60
    v_min_u32 v64, v66, v60
    v_permlane16_swap_b32 v67, v65
    v_max_u32 v66, v66, v60
    v_max3_u32 v67, v64, v67, v65
    s_cmp_lg_u32 s3, 0
    s_cbranch_scc1 L_nokey
    buffer_atomic_swap_x2 v[66:67], v149, s[16:19], 0 offen sc1
L_nokey:
    v_pk_fma_f32 v[16:17], v[40:41], v[70:71], v[70:71] op_sel:[0,0,1] op_sel_hi:[1,0,1]
    v_pk_fma_f32 v[18:19], v[42:43], v[70:71], v[70:71] op_sel:[0,0,1] op_sel_hi:[1,0,1]
    v_pk_fma_f32 v[20:21], v[44:45], v[70:71], v[70:71] op_sel:[0,0,1] op_sel_hi:[1,0,1]
    v_pk_fma_f32 v[22:23], v[46:47], v[70:71], v[70:71] op_sel:[0,0,1] op_sel_hi:[1,0,1]
    v_pk_fma_f32 v[24:25], v[48:49], v[70:71], v[70:71] op_sel:[0,0,1] op_sel_hi:[1,0,1]
    v_pk_fma_f32 v[26:27], v[50:51], v[70:71], v[70:71] op_sel:[0,0,1] op_sel_hi:[1,0,1]
    v_pk_fma_f32 v[28:29], v[52:53], v[70:71], v[70:71] op_sel:[0,0,1] op_sel_hi:[1,0,1]
    v_pk_fma_f32 v[30:31], v[54:55], v[70:71], v[70:71] op_sel:[0,0,1] op_sel_hi:[1,0,1]
    v_cvt_pk_bf16_f32 v96, v16, v17
    v_cvt_pk_bf16_f32 v97, v18, v19
    v_cvt_pk_bf16_f32 v98, v20, v21
    v_cvt_pk_bf16_f32 v99, v22, v23
    v_cvt_pk_bf16_f32 v100, v24, v25
    v_cvt_pk_bf16_f32 v101, v26, v27
    v_cvt_pk_bf16_f32 v102, v28, v29
    v_cvt_pk_bf16_f32 v103, v30, v31
    v_cmp_eq_u32 s[4:5], v66, v13
    v_cmp_eq_u32 s[6:7], v67, v13
    s_nop 0
    s_or_b64 s[96:97], s[4:5], s[6:7]
    s_cbranch_scc0 L_nocand
    s_lshl_b32 s86, s51, 12
    s_lshl_b32 s87, s52, 7
    s_add_u32 s86, s86, s87
    s_add_u32 s86, s86, 6619136
    v_lshl_add_u32 v8, v1, 3, s86
    v_add_u32 v9, 2048, v8
    v_cndmask_b32 v8, v8, v9, s[6:7]
    v_mov_b32 v9, 2147483648
    v_cndmask_b32 v8, v9, v8, s[96:97]
    buffer_store_dwordx2 v[96:97], v8, s[16:19], 0 offen offset:0 sc1
    buffer_store_dwordx2 v[98:99], v8, s[16:19], 0 offen offset:32 sc1
    buffer_store_dwordx2 v[100:101], v8, s[16:19], 0 offen offset:64 sc1
    buffer_store_dwordx2 v[102:103], v8, s[16:19], 0 offen offset:96 sc1
    v_subrev_u32 v131, 65536, v8
L_nocand:
    s_waitcnt lgkmcnt(0)
    v_lshlrev_b32 v80, 16, v112
    v_and_b32 v81, 0xffff0000, v112
    v_lshlrev_b32 v82, 16, v113
    v_and_b32 v83, 0xffff0000, v113
    v_lshlrev_b32 v84, 16, v114
    v_and_b32 v85, 0xffff0000, v114
    v_lshlrev_b32 v86, 16, v115
    v_and_b32 v87, 0xffff0000, v115
    v_lshlrev_b32 v88, 16, v116
    v_and_b32 v89, 0xffff0000, v116
    v_lshlrev_b32 v90, 16, v117
    v_and_b32 v91, 0xffff0000, v117
    v_lshlrev_b32 v92, 16, v118
    v_and_b32 v93, 0xffff0000, v118
    v_lshlrev_b32 v94, 16, v119
    v_and_b32 v95, 0xffff0000, v119
    v_pk_fma_f32 v[16:17], v[80:81], v[142:143], v[142:143] op_sel:[0,0,1] op_sel_hi:[1,0,1]
    v_pk_fma_f32 v[18:19], v[82:83], v[142:143], v[142:143] op_sel:[0,0,1] op_sel_hi:[1,0,1]
    v_pk_fma_f32 v[20:21], v[84:85], v[142:143], v[142:143] op_sel:[0,0,1] op_sel_hi:[1,0,1]
    v_pk_fma_f32 v[22:23], v[86:87], v[142:143], v[142:143] op_sel:[0,0,1] op_sel_hi:[1,0,1]
    v_pk_fma_f32 v[24:25], v[88:89], v[142:143], v[142:143] op_sel:[0,0,1] op_sel_hi:[1,0,1]
    v_pk_fma_f32 v[26:27], v[90:91], v[142:143], v[142:143] op_sel:[0,0,1] op_sel_hi:[1,0,1]
    v_pk_fma_f32 v[28:29], v[92:93], v[142:143], v[142:143] op_sel:[0,0,1] op_sel_hi:[1,0,1]
    v_pk_fma_f32 v[30:31], v[94:95], v[142:143], v[142:143] op_sel:[0,0,1] op_sel_hi:[1,0,1]
    v_cvt_pk_bf16_f32 v132, v16, v17
    v_cvt_pk_bf16_f32 v133, v18, v19
    v_cvt_pk_bf16_f32 v134, v20, v21
    v_cvt_pk_bf16_f32 v135, v22, v23
    v_cvt_pk_bf16_f32 v136, v24, v25
    v_cvt_pk_bf16_f32 v137, v26, v27
    v_cvt_pk_bf16_f32 v138, v28, v29
    v_cvt_pk_bf16_f32 v139, v30, v31
    v_cmp_eq_u32 s[4:5], v66, v144
    v_cmp_eq_u32 s[6:7], v67, v144
    s_nop 0
    s_or_b64 s[70:71], s[4:5], s[6:7]
    s_cbranch_scc0 L_nocand2
    s_lshl_b32 s86, s51, 12
    s_lshl_b32 s87, s52, 7
    s_add_u32 s86, s86, s87
    s_add_u32 s86, s86, 6619136
    v_lshl_add_u32 v8, v1, 3, s86
    v_add_u32 v9, 2048, v8
    v_cndmask_b32 v8, v8, v9, s[6:7]
    v_mov_b32 v9, 2147483648
    v_cndmask_b32 v8, v9, v8, s[70:71]
    buffer_store_dwordx2 v[132:133], v8, s[16:19], 0 offen offset:0 sc1
    buffer_store_dwordx2 v[134:135], v8, s[16:19], 0 offen offset:32 sc1
    buffer_store_dwordx2 v[136:137], v8, s[16:19], 0 offen offset:64 sc1
    buffer_store_dwordx2 v[138:139], v8, s[16:19], 0 offen offset:96 sc1
    v_subrev_u32 v140, 65536, v8
L_nocand2:
    v_mov_b32 v9, 2147483648
    v_xor_b32 v6, 0x8000, v5
    v_lshlrev_b32 v16, 16, v96
    v_and_b32 v17, 0xffff0000, v96
    v_lshlrev_b32 v18, 16, v97
L_walk_21:
    s_cbranch_execz L_walk_25
    v_and_b32 v19, 0xffff0000, v97
    v_lshlrev_b32 v20, 16, v98
    v_and_b32 v21, 0xffff0000, v98
    v_lshlrev_b32 v22, 16, v99
    v_and_b32 v23, 0xffff0000, v99
    v_lshlrev_b32 v24, 16, v100
    v_and_b32 v25, 0xffff0000, v100
    v_lshlrev_b32 v26, 16, v101
    v_and_b32 v27, 0xffff0000, v101
    v_lshlrev_b32 v28, 16, v102
    v_and_b32 v29, 0xffff0000, v102
    v_lshlrev_b32 v30, 16, v103
    v_and_b32 v31, 0xffff0000, v103
    v_pk_add_f32 v[16:17], v[16:17], v[40:41]
    v_pk_add_f32 v[18:19], v[18:19], v[42:43]
    v_pk_add_f32 v[20:21], v[20:21], v[44:45]
    v_pk_add_f32 v[22:23], v[22:23], v[46:47]
    v_pk_add_f32 v[24:25], v[24:25], v[48:49]
    v_pk_add_f32 v[26:27], v[26:27], v[50:51]
    v_pk_add_f32 v[28:29], v[28:29], v[52:53]
    v_pk_add_f32 v[30:31], v[30:31], v[54:55]
    v_cvt_pk_bf16_f32 v104, v16, v17
    v_cvt_pk_bf16_f32 v105, v18, v19
    v_cvt_pk_bf16_f32 v106, v20, v21
    v_cvt_pk_bf16_f32 v107, v22, v23
    v_cvt_pk_bf16_f32 v108, v24, v25
    v_cvt_pk_bf16_f32 v109, v26, v27
    v_cvt_pk_bf16_f32 v110, v28, v29
    v_cvt_pk_bf16_f32 v111, v30, v31
    v_permlane16_swap_b32 v104, v106
    v_permlane16_swap_b32 v105, v107
    v_permlane16_swap_b32 v108, v110
    v_permlane16_swap_b32 v109, v111
    v_mov_b32 v16, v104
    v_mov_b32 v17, v105
    v_mov_b32 v18, v106
    v_mov_b32 v19, v107
    v_mov_b32_dpp v104, v108 row_ror:8 row_mask:0xf bank_mask:0xc
    v_mov_b32_dpp v105, v109 row_ror:8 row_mask:0xf bank_mask:0xc
    v_mov_b32_dpp v106, v110 row_ror:8 row_mask:0xf bank_mask:0xc
    v_mov_b32_dpp v107, v111 row_ror:8 row_mask:0xf bank_mask:0xc
    v_mov_b32_dpp v108, v16 row_ror:8 row_mask:0xf bank_mask:0x3
    v_mov_b32_dpp v109, v17 row_ror:8 row_mask:0xf bank_mask:0x3
    v_mov_b32_dpp v110, v18 row_ror:8 row_mask:0xf bank_mask:0x3
    v_mov_b32_dpp v111, v19 row_ror:8 row_mask:0xf bank_mask:0x3
    v_cndmask_b32 v8, v5, v9, s[96:97]
    v_lshlrev_b32 v16, 16, v132
    v_and_b32 v17, 0xffff0000, v132
    v_lshlrev_b32 v18, 16, v133
    v_and_b32 v19, 0xffff0000, v133
    v_lshlrev_b32 v20, 16, v134
    v_and_b32 v21, 0xffff0000, v134
    v_lshlrev_b32 v22, 16, v135
    v_and_b32 v23, 0xffff0000, v135
    v_lshlrev_b32 v24, 16, v136
    v_and_b32 v25, 0xffff0000, v136
    v_lshlrev_b32 v26, 16, v137
    v_and_b32 v27, 0xffff0000, v137
    v_lshlrev_b32 v28, 16, v138
    v_and_b32 v29, 0xffff0000, v138
    v_lshlrev_b32 v30, 16, v139
    v_and_b32 v31, 0xffff0000, v139
    v_pk_add_f32 v[16:17], v[16:17], v[80:81]
    v_pk_add_f32 v[18:19], v[18:19], v[82:83]
    v_pk_add_f32 v[20:21], v[20:21], v[84:85]
    v_pk_add_f32 v[22:23], v[22:23], v[86:87]
    v_pk_add_f32 v[24:25], v[24:25], v[88:89]
    v_pk_add_f32 v[26:27], v[26:27], v[90:91]
    v_pk_add_f32 v[28:29], v[28:29], v[92:93]
    v_pk_add_f32 v[30:31], v[30:31], v[94:95]
    v_cvt_pk_bf16_f32 v120, v16, v17
    v_cvt_pk_bf16_f32 v121, v18, v19
    v_cvt_pk_bf16_f32 v122, v20, v21
    v_cvt_pk_bf16_f32 v123, v22, v23
    v_cvt_pk_bf16_f32 v124, v24, v25
    v_cvt_pk_bf16_f32 v125, v26, v27
    v_cvt_pk_bf16_f32 v126, v28, v29
    v_cvt_pk_bf16_f32 v127, v30, v31
    v_permlane16_swap_b32 v120, v122
    v_permlane16_swap_b32 v121, v123
    v_permlane16_swap_b32 v124, v126
    v_permlane16_swap_b32 v125, v127
    v_mov_b32 v16, v120
    v_mov_b32 v17, v121
    v_mov_b32 v18, v122
    v_mov_b32 v19, v123
    v_mov_b32_dpp v120, v124 row_ror:8 row_mask:0xf bank_mask:0xc
    v_mov_b32_dpp v121, v125 row_ror:8 row_mask:0xf bank_mask:0xc
    v_mov_b32_dpp v122, v126 row_ror:8 row_mask:0xf bank_mask:0xc
    v_mov_b32_dpp v123, v127 row_ror:8 row_mask:0xf bank_mask:0xc
    v_mov_b32_dpp v124, v16 row_ror:8 row_mask:0xf bank_mask:0x3
    v_mov_b32_dpp v125, v17 row_ror:8 row_mask:0xf bank_mask:0x3
    v_mov_b32_dpp v126, v18 row_ror:8 row_mask:0xf bank_mask:0x3
    v_mov_b32_dpp v127, v19 row_ror:8 row_mask:0xf bank_mask:0x3
    s_cmp_eq_u64 s[96:97], 0
    s_cbranch_scc1 L_noha
    buffer_store_dwordx2 v[32:33], v131, s[16:19], 0 offen offset:0 sc1
    buffer_store_dwordx2 v[34:35], v131, s[16:19], 0 offen offset:32 sc1
    buffer_store_dwordx2 v[36:37], v131, s[16:19], 0 offen offset:64 sc1
    buffer_store_dwordx2 v[38:39], v131, s[16:19], 0 offen offset:96 sc1
L_noha:
    s_cmp_eq_u64 s[70:71], 0
    s_cbranch_scc1 L_nohb
    buffer_store_dwordx2 v[112:113], v140, s[16:19], 0 offen offset:0 sc1
    buffer_store_dwordx2 v[114:115], v140, s[16:19], 0 offen offset:32 sc1
    buffer_store_dwordx2 v[116:117], v140, s[16:19], 0 offen offset:64 sc1
    buffer_store_dwordx2 v[118:119], v140, s[16:19], 0 offen offset:96 sc1
L_nohb:
    v_mov_b32 v8, 66304
    s_barrier
    ds_read_b64 v[10:11], v8
    s_waitcnt lgkmcnt(0)
    v_cmp_ne_u32 s[4:5], v10, v13
    v_cmp_ne_u32 s[6:7], v11, v13
    s_nop 0
    s_and_b64 s[4:5], s[4:5], s[6:7]
    v_cndmask_b32 v8, v9, v5, s[4:5]
    v_add_u32 v17, 64, v8
    v_mov_b32 v16, v8
    s_nop 1
    v_mov_b32_dpp v16, v17 row_ror:8 row_mask:0xf bank_mask:0xc
    v_mov_b32_dpp v17, v8 row_ror:8 row_mask:0xf bank_mask:0x3
    buffer_store_dwordx4 v[104:107], v16, s[24:27], 0 offen sc1
    v_cmp_ne_u32 s[4:5], v10, v144
    v_cmp_ne_u32 s[6:7], v11, v144
    s_nop 0
    s_and_b64 s[4:5], s[4:5], s[6:7]
    v_cndmask_b32 v8, v9, v6, s[4:5]
    v_add_u32 v19, 64, v8
    v_mov_b32 v18, v8
    s_nop 1
    v_mov_b32_dpp v18, v19 row_ror:8 row_mask:0xf bank_mask:0xc
    v_mov_b32_dpp v19, v8 row_ror:8 row_mask:0xf bank_mask:0x3
    s_barrier
    s_barrier
    s_barrier
    buffer_store_dwordx4 v[108:111], v17, s[24:27], 0 offen sc1
    buffer_store_dwordx4 v[120:123], v18, s[24:27], 0 offen sc1
    buffer_store_dwordx4 v[124:127], v19, s[24:27], 0 offen sc1
    s_branch L_fin
L_t3_ld:
    s_mov_b32 s90, 6144
    buffer_load_dwordx4 v[240:243], v14, s[36:39], s90 offen
    s_mov_b32 s90, 8192
    buffer_load_dwordx4 v[244:247], v14, s[36:39], s90 offen
    s_mov_b32 s90, 10240
    buffer_load_dwordx4 v[248:251], v14, s[36:39], s90 offen
    s_mov_b32 s90, 12288
    buffer_load_dwordx4 v[252:255], v14, s[36:39], s90 offen
    v_bfe_u32 v8, v0, 3, 1
    s_waitcnt lgkmcnt(0)
    v_lshl_add_u32 v10, v1, 5, s67
    s_mov_b32 s60, 0
    s_mov_b32 s61, 0
    s_lshl_b32 s63, 1, s51
    s_mov_b32 m0, s51
    s_waitcnt lgkmcnt(0)
    v_max3_u32 v96, v60, v61, v62
    v_max_u32 v98, v96, v63
    v_med3_u32 v99, v60, v61, v62
    v_med3_u32 v99, v96, v99, v63
    v_min_u32_dpp v96, v98, v98 row_ror:8 row_mask:0xf bank_mask:0xf
    v_max_u32_dpp v98, v98, v98 row_ror:8 row_mask:0xf bank_mask:0xf
    v_max_u32_dpp v97, v99, v99 row_ror:8 row_mask:0xf bank_mask:0xf
    v_max_u32 v99, v96, v97
    v_min_u32_dpp v96, v98, v98 row_ror:4 row_mask:0xf bank_mask:0xf
    v_max_u32_dpp v98, v98, v98 row_ror:4 row_mask:0xf bank_mask:0xf
    v_max_u32_dpp v97, v99, v99 row_ror:4 row_mask:0xf bank_mask:0xf
L_walk_22:
    s_cbranch_execz L_walked2
    v_max_u32 v99, v96, v97
    v_min_u32_dpp v96, v98, v98 row_ror:2 row_mask:0xf bank_mask:0xf
    v_max_u32_dpp v98, v98, v98 row_ror:2 row_mask:0xf bank_mask:0xf
    v_max_u32_dpp v97, v99, v99 row_ror:2 row_mask:0xf bank_mask:0xf
    v_max_u32 v99, v96, v97
    v_min_u32_dpp v96, v98, v98 row_ror:1 row_mask:0xf bank_mask:0xf
    v_max_u32_dpp v60, v98, v98 row_ror:1 row_mask:0xf bank_mask:0xf
    v_max_u32_dpp v97, v99, v99 row_ror:1 row_mask:0xf bank_mask:0xf
    v_max_u32_dpp v98, v98, v98 row_ror:1 row_mask:0xf bank_mask:0xf
    v_max_u32 v99, v96, v97
    v_max_u32 v97, v96, v97
    v_permlane16_swap_b32 v98, v60
    v_min_u32 v96, v98, v60
    v_permlane16_swap_b32 v99, v97
    v_max_u32 v98, v98, v60
    v_max3_u32 v99, v96, v99, v97
    v_readfirstlane_b32 s58, v98
    v_readfirstlane_b32 s59, v99
    s_mov_b32 s76, 0x05040100
    s_mov_b32 s77, 0x07060302
    s_mov_b32 s6, 0xffff0000
    s_mov_b32 s7, 0xffff0000
    v_perm_b32 v32, v168, v164, s76
    v_perm_b32 v33, v176, v172, s76
    v_perm_b32 v34, v184, v180, s76
    v_perm_b32 v35, v192, v188, s76
    v_perm_b32 v36, v168, v164, s77
    v_perm_b32 v37, v176, v172, s77
    v_perm_b32 v38, v184, v180, s77
    v_perm_b32 v39, v192, v188, s77
    v_perm_b32 v40, v169, v165, s76
    v_perm_b32 v41, v177, v173, s76
    v_perm_b32 v42, v185, v181, s76
    v_perm_b32 v43, v193, v189, s76
    v_perm_b32 v44, v169, v165, s77
    v_perm_b32 v45, v177, v173, s77
    v_perm_b32 v46, v185, v181, s77
    v_perm_b32 v47, v193, v189, s77
    v_perm_b32 v48, v170, v166, s76
    v_perm_b32 v49, v178, v174, s76
    v_perm_b32 v50, v186, v182, s76
    v_perm_b32 v51, v194, v190, s76
    v_perm_b32 v52, v170, v166, s77
    v_perm_b32 v53, v178, v174, s77
    v_perm_b32 v54, v186, v182, s77
    v_perm_b32 v55, v194, v190, s77
    v_perm_b32 v56, v171, v167, s76
    v_perm_b32 v57, v179, v175, s76
    v_perm_b32 v58, v187, v183, s76
    v_perm_b32 v59, v195, v191, s76
    v_perm_b32 v60, v171, v167, s77
    v_perm_b32 v61, v179, v175, s77
    v_perm_b32 v62, v187, v183, s77
    v_perm_b32 v63, v195, v191, s77
    v_perm_b32 v164, v200, v196, s76
    v_perm_b32 v165, v208, v204, s76
    v_perm_b32 v166, v216, v212, s76
    v_perm_b32 v167, v224, v220, s76
    v_perm_b32 v168, v200, v196, s77
    v_perm_b32 v169, v208, v204, s77
    v_perm_b32 v170, v216, v212, s77
    v_perm_b32 v171, v224, v220, s77
    v_perm_b32 v172, v201, v197, s76
    v_perm_b32 v173, v209, v205, s76
    v_perm_b32 v174, v217, v213, s76
    v_perm_b32 v175, v225, v221, s76
    v_perm_b32 v176, v201, v197, s77
    v_perm_b32 v177, v209, v205, s77
    v_perm_b32 v178, v217, v213, s77
    v_perm_b32 v179, v225, v221, s77
    v_perm_b32 v180, v202, v198, s76
    v_perm_b32 v181, v210, v206, s76
    v_perm_b32 v182, v218, v214, s76
    v_perm_b32 v183, v226, v222, s76
    v_perm_b32 v184, v202, v198, s77
    v_perm_b32 v185, v210, v206, s77
    v_perm_b32 v186, v218, v214, s77
    v_perm_b32 v187, v226, v222, s77
    v_perm_b32 v188, v203, v199, s76
    v_perm_b32 v189, v211, v207, s76
    v_perm_b32 v190, v219, v215, s76
    v_perm_b32 v191, v227, v223, s76
    v_perm_b32 v192, v203, v199, s77
    v_perm_b32 v193, v211, v207, s77
    v_perm_b32 v194, v219, v215, s77
    v_perm_b32 v195, v227, v223, s77
    v_min_u32 v22, 16, v0
    v_and_b32 v22, 16, v22
    v_and_or_b32 v22, v0, 15, v22
    v_lshlrev_b32 v22, 3, v22
    v_add_u32 v22, 66304, v22
    s_waitcnt vmcnt(4)
    s_branch L_h4_chk0
L_h4_w0:
    s_waitcnt vmcnt(0)
L_h4_chk0:
    v_cmp_eq_u32 vcc, -1, v128
    s_nop 0
    s_andn2_b32 s86, vcc_lo, s63
    s_cbranch_scc0 L_h4_all0
    v_cndmask_b32 v96, v128, 0, vcc
    v_cndmask_b32 v97, v129, 0, vcc
    v_mov_b32 v128, 0
    v_mov_b32 v129, 0
    buffer_atomic_or_x2 v[128:129], v148, s[16:19], 0 offen sc0 sc1
    s_sub_u32 s56, s56, 1
    s_cbranch_scc1 L_h4_out
    v_min_u32_dpp v98, v96, v96 row_ror:8 row_mask:0xf bank_mask:0xf
    v_max_u32_dpp v96, v96, v96 row_ror:8 row_mask:0xf bank_mask:0xf
    v_max_u32_dpp v99, v97, v97 row_ror:8 row_mask:0xf bank_mask:0xf
    v_max_u32 v97, v98, v99
    v_min_u32_dpp v98, v96, v96 row_ror:4 row_mask:0xf bank_mask:0xf
    v_max_u32_dpp v96, v96, v96 row_ror:4 row_mask:0xf bank_mask:0xf
    v_max_u32_dpp v99, v97, v97 row_ror:4 row_mask:0xf bank_mask:0xf
    v_max_u32 v97, v98, v99
    v_min_u32_dpp v98, v96, v96 row_ror:2 row_mask:0xf bank_mask:0xf
    v_max_u32_dpp v96, v96, v96 row_ror:2 row_mask:0xf bank_mask:0xf
    v_max_u32_dpp v99, v97, v97 row_ror:2 row_mask:0xf bank_mask:0xf
    v_max_u32 v97, v98, v99
    v_min_u32_dpp v98, v96, v96 row_ror:1 row_mask:0xf bank_mask:0xf
    v_max_u32_dpp v96, v96, v96 row_ror:1 row_mask:0xf bank_mask:0xf
    v_max_u32_dpp v99, v97, v97 row_ror:1 row_mask:0xf bank_mask:0xf
    v_max_u32 v97, v98, v99
    v_readlane_b32 s70, v96, 0
    v_readlane_b32 s71, v97, 0
    s_nop 0
    s_cmp_eq_u64 s[70:71], s[60:61]
    s_cbranch_scc1 L_h4_w0
    s_mov_b64 s[60:61], s[70:71]
    s_bfe_u32 s86, s60, 0x40007
    s_bfe_u32 s87, s61, 0x40007
    s_sub_u32 s87, s86, s87
    s_lshl_b32 s87, s87, 12
    s_cselect_b32 s69, s87, 2048
    v_mad_i32_i24 v130, v8, s69, v10
    s_xor_b32 s86, s86, 15
    s_lshl_b32 s66, s86, 12
    buffer_load_dwordx4 v[64:67], v130, s[16:19], s66 offen sc1
    buffer_load_dwordx4 v[68:71], v130, s[16:19], s66 offen offset:16 sc1
    s_waitcnt vmcnt(2)
    s_branch L_h4_chk0
L_h4_own:
    s_waitcnt vmcnt(0)
    v_mov_b32 v128, 0
    v_mov_b32 v129, 0
    buffer_atomic_or_x2 v[128:129], v148, s[16:19], 0 offen sc0 sc1
    s_sub_u32 s56, s56, 1
    s_cbranch_scc0 L_h4_w0
L_h4_out:
    s_mov_b32 s56, 0
    s_waitcnt vmcnt(0)
    s_mov_b64 vcc, 0
L_h4_all0:
    v_writelane_b32 v128, s58, m0
    v_writelane_b32 v129, s59, m0
    s_nop 0
    v_min_u32_dpp v98, v128, v128 row_ror:8 row_mask:0xf bank_mask:0xf
    v_max_u32_dpp v96, v128, v128 row_ror:8 row_mask:0xf bank_mask:0xf
    v_max_u32_dpp v99, v129, v129 row_ror:8 row_mask:0xf bank_mask:0xf
    v_max_u32 v97, v98, v99
L_h4_all:
    v_min_u32_dpp v98, v96, v96 row_ror:4 row_mask:0xf bank_mask:0xf
    v_max_u32_dpp v96, v96, v96 row_ror:4 row_mask:0xf bank_mask:0xf
    v_max_u32_dpp v99, v97, v97 row_ror:4 row_mask:0xf bank_mask:0xf
    v_max_u32 v97, v98, v99
    v_min_u32_dpp v98, v96, v96 row_ror:2 row_mask:0xf bank_mask:0xf
L_walk_23:
    s_cbranch_execz L_walked2
    v_max_u32_dpp v96, v96, v96 row_ror:2 row_mask:0xf bank_mask:0xf
    v_max_u32_dpp v99, v97, v97 row_ror:2 row_mask:0xf bank_mask:0xf
    v_max_u32 v97, v98, v99
    v_min_u32_dpp v98, v96, v96 row_ror:1 row_mask:0xf bank_mask:0xf
    v_max_u32_dpp v96, v96, v96 row_ror:1 row_mask:0xf bank_mask:0xf
    v_max_u32_dpp v99, v97, v97 row_ror:1 row_mask:0xf bank_mask:0xf
    v_max_u32 v97, v98, v99
    ds_write_b64 v22, v[96:97]
    v_readlane_b32 s70, v96, 0
    v_readlane_b32 s71, v97, 0
    s_nop 0
    s_cmp_ge_u32 s58, s71
    s_cselect_b32 s86, vcc_lo, 0
    s_cmp_lg_u32 s86, 0
    s_cbranch_scc1 L_h4_own
    s_cmp_eq_u64 s[70:71], s[60:61]
    s_cbranch_scc1 L_h4_go
    s_mov_b64 s[60:61], s[70:71]
    s_bfe_u32 s86, s60, 0x40007
    s_bfe_u32 s87, s61, 0x40007
    s_sub_u32 s87, s86, s87
    s_lshl_b32 s87, s87, 12
    s_cselect_b32 s69, s87, 2048
    v_mad_i32_i24 v130, v8, s69, v10
    s_xor_b32 s86, s86, 15
    s_lshl_b32 s66, s86, 12
    buffer_load_dwordx4 v[64:67], v130, s[16:19], s66 offen sc1
    buffer_load_dwordx4 v[68:71], v130, s[16:19], s66 offen offset:16 sc1
L_h4_go:
    s_waitcnt lgkmcnt(0)
    s_barrier
    s_waitcnt vmcnt(0)
    v_max3_u32 v16, v65, v67, v69
    v_max_u32 v16, v16, v71
    v_cmp_eq_u32 vcc, -1, v16
    s_cbranch_vccnz L_seg
L_seg_done:
    v_mfma_f32_16x16x32_bf16 v[196:199], v[64:67], v[32:35], 0
    v_mfma_f32_16x16x32_bf16 v[212:215], v[64:67], v[48:51], 0
    v_mfma_f32_16x16x32_bf16 v[196:199], v[68:71], v[164:167], v[196:199]
    v_mfma_f32_16x16x32_bf16 v[212:215], v[68:71], v[180:183], v[212:215]
    v_mfma_f32_16x16x32_bf16 v[200:203], v[64:67], v[36:39], 0
    v_mfma_f32_16x16x32_bf16 v[216:219], v[64:67], v[52:55], 0
    v_mfma_f32_16x16x32_bf16 v[200:203], v[68:71], v[168:171], v[200:203]
    v_mfma_f32_16x16x32_bf16 v[216:219], v[68:71], v[184:187], v[216:219]
    s_nop 3
    v_cndmask_b32 v88, v196, v212, s[6:7]
    v_mfma_f32_16x16x32_bf16 v[204:207], v[64:67], v[40:43], 0
    v_mfma_f32_16x16x32_bf16 v[220:223], v[64:67], v[56:59], 0
    v_mfma_f32_16x16x32_bf16 v[204:207], v[68:71], v[172:175], v[204:207]
    v_mfma_f32_16x16x32_bf16 v[220:223], v[68:71], v[188:191], v[220:223]
    v_cndmask_b32 v89, v200, v216, s[6:7]
    v_mfma_f32_16x16x32_bf16 v[208:211], v[64:67], v[44:47], 0
    v_mfma_f32_16x16x32_bf16 v[224:227], v[64:67], v[60:63], 0
    v_mfma_f32_16x16x32_bf16 v[208:211], v[68:71], v[176:179], v[208:211]
    v_mfma_f32_16x16x32_bf16 v[224:227], v[68:71], v[192:195], v[224:227]
    s_nop 2
    v_cndmask_b32 v90, v204, v220, s[6:7]
    s_nop 3
    v_cndmask_b32 v91, v208, v224, s[6:7]
    ds_write_b128 v18, v[88:91]
    s_waitcnt lgkmcnt(0)
    s_barrier
    ds_read2st64_b32 v[24:25], v133 offset0:0 offset1:4
    ds_read2st64_b32 v[26:27], v133 offset0:8 offset1:12
    s_mov_b32 s79, 114688
    s_cmp_eq_u32 s83, 0
    s_waitcnt lgkmcnt(0)
    v_pk_add_f32 v[24:25], v[24:25], v[26:27]
    v_add_f32 v24, v24, v25
    s_cbranch_scc1 L_h5_far
    buffer_store_dword v24, v131, s[16:19], 0 offen
L_h5_out:
    s_lshr_b32 s88, s48, 1
    s_cselect_b32 s86, s69, 0
    s_cselect_b32 s63, s61, s60
    s_and_b32 s87, s48, 1
    s_and_b32 s89, s82, 7
    s_lshl1_add_u32 s87, s89, s87
    s_lshl_b32 s87, s87, 7
    s_add_u32 s86, s86, s66
    s_add_u32 s86, s86, s87
    s_add_u32 s86, s86, 6553600
    v_lshl_add_u32 v142, v0, 1, s86
    v_mov_b32 v140, 0
    v_mov_b32 v141, 0
    s_mov_b32 s65, 65536
    buffer_load_short_d16_hi v140, v142, s[16:19], 0 offen sc1
    buffer_load_short_d16_hi v141, v142, s[16:19], s65 offen sc1
    s_and_b32 s86, s63, 0x7ff
    s_sub_u32 s86, 2047, s86
    s_lshl_b32 s86, s86, 11
    s_add_u32 s86, s86, s87
    v_lshl_add_u32 v143, v0, 1, s86
    s_ashr_i32 s86, s63, 31
    s_orn2_b32 s86, 0x80000000, s86
    s_xor_b32 s63, s63, s86
    s_and_b32 s63, s63, 0xffff0000
    s_lshr_b32 s86, s48, 1
    s_and_b32 s87, s48, 1
    s_lshl_b32 s88, s86, 9
    s_lshl_b32 s89, s87, 7
    s_add_u32 s88, s88, s89
    s_add_u32 s88, s88, 94208
    v_lshrrev_b32 v17, 3, v0
    v_lshl_add_u32 v20, v17, 4, s88
    v_bfe_u32 v9, v0, 2, 1
    v_lshl_add_u32 v20, v9, 8, v20
    v_and_b32 v9, 3, v0
    v_lshl_add_u32 v20, v9, 2, v20
    s_and_b32 s89, s82, 7
    s_lshl3_add_u32 s86, s86, s89
    s_lshl1_add_u32 s86, s86, s87
    s_lshl_b32 s86, s86, 11
    s_add_u32 s86, s86, 917504
    v_lshl_add_u32 v9, v17, 8, s86
    v_and_b32 v17, 7, v0
    v_lshl_add_u32 v9, v17, 3, v9
    s_mov_b32 s76, 0
    s_mov_b32 s77, 0x41900000
    s_lshl_b32 s86, s48, 7
    s_add_u32 s86, s86, 100352
    v_lshl_add_u32 v11, v8, 6, s86
    v_lshl_add_u32 v11, v1, 4, v11
    v_and_b32 v16, 7, v0
    v_cmp_eq_u32 vcc, 7, v16
    v_lshl_add_u32 v16, v16, 2, v1
    v_mul_u32_u24 v17, 37, v16
    v_lshrrev_b32 v17, 8, v17
    v_add_u32 v16, v16, v17
    v_lshl_or_b32 v17, v1, 3, 7
    v_cndmask_b32 v16, v16, v17, vcc
    v_lshl_add_u32 v16, v8, 5, v16
    v_lshl_add_u32 v10, v16, 1, s86
    v_mov_b32 v144, s63
    v_mul_f32 v144, 0xbfb8aa3b, v144
    v_exp_f32 v144, v144
    s_nop 0
    v_add_f32 v144, 1.0, v144
    v_rcp_f32 v144, v144
    s_nop 0
    v_cvt_pk_bf16_f32 v144, v144, v144
    v_lshlrev_b32 v144, 16, v144
    s_mov_b32 s6, 0x80808080
    s_mov_b32 s7, 0x80808080
    v_mov_b32 v19, v9
    buffer_load_dwordx4 v[112:115], v137, s[16:19], 0 offen sc1
    buffer_load_dwordx4 v[116:119], v137, s[16:19], s79 offen sc1
    s_waitcnt vmcnt(0)
    v_max_u32 v16, v115, v119
    v_cmp_eq_u32 vcc, -1, v16
    s_cbranch_vccnz L_h5
L_h5_done:
    v_permlane32_swap_b32 v112, v114
    v_permlane32_swap_b32 v113, v115
    v_permlane32_swap_b32 v116, v118
    v_permlane32_swap_b32 v117, v119
    v_add_f32 v112, v112, v114
    v_add_f32 v113, v113, v115
    v_add_f32 v116, v116, v118
    v_add_f32 v117, v117, v119
    v_permlane16_swap_b32 v112, v113
    s_nop 0
    v_permlane16_swap_b32 v116, v117
    v_add_f32 v112, v112, v113
    v_add_f32 v116, v116, v117
    v_cvt_pk_bf16_f32 v25, v112, v116
    v_lshlrev_b32 v24, 16, v25
    v_and_b32 v28, 0xffff0000, v25
    v_mul_f32 v25, 0xbfb8aa3b, v24
    v_exp_f32 v25, v25
    s_nop 0
    v_add_f32 v25, 1.0, v25
    v_rcp_f32 v25, v25
    s_nop 0
    v_mul_f32 v24, v24, v25
    v_cvt_pk_bf16_f32 v24, v24, v24
    v_lshlrev_b32 v24, 16, v24
    v_mul_f32 v24, v24, v28
    v_cvt_pk_bf16_f32 v24, v24, v24
    ds_write_b16 v10, v24
    ds_read_b128 v[64:67], v11
    s_waitcnt lgkmcnt(0)
    v_perm_b32 v80, v64, v64, v72
    v_perm_b32 v81, v64, v64, v73
    v_perm_b32 v82, v64, v64, v74
    v_perm_b32 v83, v64, v64, v75
    v_perm_b32 v84, v64, v64, v76
    v_perm_b32 v85, v64, v64, v77
L_walk_24:
    s_cbranch_execz L_walked2
    v_perm_b32 v86, v64, v64, v78
    v_perm_b32 v87, v64, v64, v79
    v_mfma_f32_16x16x32_bf16 v[88:91], v[80:83], v[228:231], 0
    v_perm_b32 v92, v65, v65, v72
    v_perm_b32 v93, v65, v65, v73
    v_perm_b32 v94, v65, v65, v74
    v_perm_b32 v95, v65, v65, v75
    v_mfma_f32_16x16x32_bf16 v[88:91], v[84:87], v[232:235], v[88:91]
    v_perm_b32 v80, v65, v65, v76
    v_perm_b32 v81, v65, v65, v77
    v_perm_b32 v82, v65, v65, v78
    v_perm_b32 v83, v65, v65, v79
    v_mfma_f32_16x16x32_bf16 v[88:91], v[92:95], v[236:239], v[88:91]
    v_perm_b32 v84, v66, v66, v72
    v_perm_b32 v85, v66, v66, v73
    v_perm_b32 v86, v66, v66, v74
    v_perm_b32 v87, v66, v66, v75
    v_mfma_f32_16x16x32_bf16 v[88:91], v[80:83], v[240:243], v[88:91]
    v_perm_b32 v92, v66, v66, v76
    v_perm_b32 v93, v66, v66, v77
    v_perm_b32 v94, v66, v66, v78
    v_perm_b32 v95, v66, v66, v79
    v_mfma_f32_16x16x32_bf16 v[88:91], v[84:87], v[244:247], v[88:91]
    v_perm_b32 v80, v67, v67, v72
    v_perm_b32 v81, v67, v67, v73
    v_perm_b32 v82, v67, v67, v74
    v_perm_b32 v83, v67, v67, v75
    v_mfma_f32_16x16x32_bf16 v[88:91], v[92:95], v[248:251], v[88:91]
    s_nop 0
    v_mfma_f32_16x16x32_bf16 v[88:91], v[80:83], v[252:255], v[88:91]
    s_nop 7
    ds_write_b128 v18, v[88:91] offset:4096
    s_waitcnt lgkmcnt(0)
    s_barrier
    ds_read2st64_b32 v[24:25], v20 offset0:0 offset1:4
    ds_read2st64_b32 v[26:27], v20 offset0:8 offset1:12
    s_waitcnt lgkmcnt(0)
    v_pk_add_f32 v[24:25], v[24:25], v[26:27]
    v_add_f32 v24, v24, v25
    v_cvt_f64_f32 v[26:27], v24
    v_add_f64 v[24:25], v[26:27], s[76:77]
    buffer_atomic_add_f64 v[24:25], v19, s[16:19], 0 offen sc0 sc1
    s_barrier
    s_mov_b32 s77, 0xc1df0000
    v_add_f64 v[26:27], v[26:27], s[76:77]
    s_waitcnt vmcnt(1)
    v_max_u32 v16, v140, v141
    v_cmp_eq_u32 vcc, 0xffff0000, v16
    s_cbranch_vccnz L_fin_ld
L_fin_go:
    s_mov_b32 s88, 0x4c000000
    v_mov_b32 v17, 2147483648
    s_waitcnt vmcnt(0)
    v_add_f64 v[24:25], v[24:25], v[26:27]
    v_cvt_f32_f64 v24, v[24:25]
    v_cmp_lt_f32 vcc, |v24|, s88
    v_cvt_pk_bf16_f32 v24, v24, v24
    v_lshlrev_b32 v24, 16, v24
    v_mul_f32 v24, v24, v144
    v_cndmask_b32 v17, v17, v143, vcc
    v_cvt_pk_bf16_f32 v24, v24, v24
    v_lshlrev_b32 v24, 16, v24
    v_add_f32 v24, v24, v141
    v_cvt_pk_bf16_f32 v24, v24, v24
    v_lshlrev_b32 v24, 16, v24
    v_add_f32 v24, v24, v140
    v_cvt_pk_bf16_f32 v24, v24, v24
    buffer_store_short v24, v17, s[24:27], 0 offen
L_fin:
L_end:
    s_endpgm
L_b_restart:
    s_waitcnt vmcnt(0)
    v_xor_b32 v9, 0x8000, v7
    buffer_load_dwordx4 v[136:139], v7, s[8:11], 0 offen
    buffer_load_dwordx4 v[140:143], v9, s[8:11], 0 offen
    v_mov_b32 v8, s68
    s_mov_b32 s66, 0xffffaaaa
    s_mov_b32 s63, 1
    s_branch L_b_init
L_b_g4:
    s_lshr_b32 s86, s78, 2
    buffer_load_dwordx4 v[48:51], v157, s[16:19], s86 offen offset:0 sc1
    buffer_load_dwordx4 v[52:55], v158, s[16:19], s86 offen offset:0 sc1
    s_waitcnt vmcnt(0)
    s_sub_u32 s56, s56, 1
    s_cbranch_scc0 L_b_c4
    s_mov_b32 s56, 0
    s_branch L_b_d4
L_b_g5:
    s_lshr_b32 s86, s78, 2
    buffer_load_dwordx4 v[56:59], v157, s[16:19], s86 offen offset:1024 sc1
    buffer_load_dwordx4 v[60:63], v158, s[16:19], s86 offen offset:1024 sc1
    s_waitcnt vmcnt(0)
    s_sub_u32 s56, s56, 1
    s_cbranch_scc0 L_b_c5
    s_mov_b32 s56, 0
    s_branch L_b_d5
L_b_g6:
    s_lshr_b32 s86, s79, 2
    buffer_load_dwordx4 v[64:67], v157, s[16:19], s86 offen offset:0 sc1
    buffer_load_dwordx4 v[68:71], v158, s[16:19], s86 offen offset:0 sc1
    s_waitcnt vmcnt(0)
    s_sub_u32 s56, s56, 1
    s_cbranch_scc0 L_b_c6
    s_mov_b32 s56, 0
    s_branch L_b_d6
L_b_g7:
    s_lshr_b32 s86, s79, 2
    buffer_load_dwordx4 v[72:75], v157, s[16:19], s86 offen offset:1024 sc1
    buffer_load_dwordx4 v[76:79], v158, s[16:19], s86 offen offset:1024 sc1
    s_waitcnt vmcnt(0)
    s_sub_u32 s56, s56, 1
    s_cbranch_scc0 L_b_c7
    s_mov_b32 s56, 0
    s_branch L_b_d7
L_b_g8:
    s_lshr_b32 s86, s76, 2
    buffer_load_dwordx4 v[16:19], v157, s[16:19], s86 offen offset:0 sc1
    buffer_load_dwordx4 v[20:23], v158, s[16:19], s86 offen offset:0 sc1
    s_waitcnt vmcnt(0)
    s_sub_u32 s56, s56, 1
    s_cbranch_scc0 L_b_c8
    s_mov_b32 s56, 0
    s_branch L_b_d8
L_b_g9:
    s_lshr_b32 s86, s76, 2
    buffer_load_dwordx4 v[24:27], v157, s[16:19], s86 offen offset:1024 sc1
    buffer_load_dwordx4 v[28:31], v158, s[16:19], s86 offen offset:1024 sc1
    s_waitcnt vmcnt(0)
    s_sub_u32 s56, s56, 1
    s_cbranch_scc0 L_b_c9
    s_mov_b32 s56, 0
    s_branch L_b_d9
L_b_g10:
    s_lshr_b32 s86, s77, 2
    buffer_load_dwordx4 v[32:35], v157, s[16:19], s86 offen offset:0 sc1
    buffer_load_dwordx4 v[36:39], v158, s[16:19], s86 offen offset:0 sc1
    s_waitcnt vmcnt(0)
    s_sub_u32 s56, s56, 1
    s_cbranch_scc0 L_b_c10
    s_mov_b32 s56, 0
    s_branch L_b_d10
L_b_g11:
    s_lshr_b32 s86, s77, 2
    buffer_load_dwordx4 v[40:43], v157, s[16:19], s86 offen offset:1024 sc1
    buffer_load_dwordx4 v[44:47], v158, s[16:19], s86 offen offset:1024 sc1
    s_waitcnt vmcnt(0)
    s_sub_u32 s56, s56, 1
    s_cbranch_scc0 L_b_c11
    s_mov_b32 s56, 0
    s_branch L_b_d11
L_b_g12:
    s_lshr_b32 s86, s78, 2
    buffer_load_dwordx4 v[48:51], v157, s[16:19], s86 offen offset:0 sc1
    buffer_load_dwordx4 v[52:55], v158, s[16:19], s86 offen offset:0 sc1
    s_waitcnt vmcnt(0)
    s_sub_u32 s56, s56, 1
    s_cbranch_scc0 L_b_c12
    s_mov_b32 s56, 0
    s_branch L_b_d12
L_b_g13:
    s_lshr_b32 s86, s78, 2
    buffer_load_dwordx4 v[56:59], v157, s[16:19], s86 offen offset:1024 sc1
    buffer_load_dwordx4 v[60:63], v158, s[16:19], s86 offen offset:1024 sc1
    s_waitcnt vmcnt(0)
    s_sub_u32 s56, s56, 1
    s_cbranch_scc0 L_b_c13
    s_mov_b32 s56, 0
    s_branch L_b_d13
L_b_g14:
    s_lshr_b32 s86, s79, 2
    buffer_load_dwordx4 v[64:67], v157, s[16:19], s86 offen offset:0 sc1
    buffer_load_dwordx4 v[68:71], v158, s[16:19], s86 offen offset:0 sc1
    s_waitcnt vmcnt(0)
    s_sub_u32 s56, s56, 1
    s_cbranch_scc0 L_b_c14
    s_mov_b32 s56, 0
    s_branch L_b_d14
L_b_g15:
    s_lshr_b32 s86, s79, 2
    buffer_load_dwordx4 v[72:75], v157, s[16:19], s86 offen offset:1024 sc1
    buffer_load_dwordx4 v[76:79], v158, s[16:19], s86 offen offset:1024 sc1
    s_waitcnt vmcnt(0)
    s_sub_u32 s56, s56, 1
    s_cbranch_scc0 L_b_c15
    s_mov_b32 s56, 0
    s_branch L_b_d15
L_b_p0:
    v_mov_b32 v8, 0
    buffer_atomic_or v8, v159, s[16:19], 0 offen sc0 sc1
L_b_w0:
    s_waitcnt vmcnt(0)
    ds_write_b32 v12, v12
    v_mov_b32 v12, v162
    v_cmp_eq_u32 vcc, s68, v8
    s_nop 0
    s_lshr_b32 s65, vcc_lo, 1
    s_and_b32 s65, s65, vcc_lo
    s_andn2_b32 s65, s65, s66
    s_cbranch_scc0 L_b_q0
    s_or_b32 s66, s66, s65
    s_branch L_b_r0
L_b_q0:
    s_sub_u32 s56, s56, 1
    s_cbranch_scc0 L_b_p0
    s_mov_b32 s56, 0
    s_not_b32 s65, s66
    s_branch L_b_r0
L_b_p1:
    v_mov_b32 v8, 0
    buffer_atomic_or v8, v159, s[16:19], 0 offen sc0 sc1
    s_waitcnt vmcnt(0)
    v_cmp_eq_u32 vcc, s68, v8
    s_nop 0
    s_lshr_b32 s65, vcc_lo, 1
    s_and_b32 s65, s65, vcc_lo
    s_andn2_b32 s65, s65, s66
    s_cbranch_scc0 L_b_q1
    s_or_b32 s66, s66, s65
    s_branch L_b_r1
L_walk_25:
    s_cbranch_execz L_walked2
L_b_q1:
    s_sub_u32 s56, s56, 1
    s_cbranch_scc0 L_b_p1
    s_mov_b32 s56, 0
    s_not_b32 s65, s66
    s_branch L_b_r1
L_h3:
    s_sub_u32 s56, s56, 1
    s_cbranch_scc1 L_h3_to
    v_mov_b32 v67, 0
    buffer_atomic_or v67, v160, s[16:19], 0 offen sc0 sc1
    s_waitcnt vmcnt(0)
    v_cmp_ne_u32 vcc, 0x41800000, v67
    s_nop 0
    s_and_b64 vcc, vcc, s[74:75]
    s_cbranch_scc0 L_h3_done
    s_branch L_h3
L_h3_to:
    s_mov_b32 s56, 0
    s_branch L_h3_done
L_seg:
    s_sub_u32 s56, s56, 1
    s_cbranch_scc1 L_seg_to
    buffer_load_dwordx4 v[64:67], v130, s[16:19], s66 offen sc1
    buffer_load_dwordx4 v[68:71], v130, s[16:19], s66 offen offset:16 sc1
    s_waitcnt vmcnt(0)
    v_max3_u32 v16, v65, v67, v69
    v_max_u32 v16, v16, v71
    v_cmp_eq_u32 vcc, -1, v16
    s_cbranch_vccz L_seg_done
    s_branch L_seg
L_seg_to:
    s_mov_b32 s56, 0
    s_branch L_seg_done
L_h5_far:
    buffer_store_dword v24, v131, s[16:19], 0 offen sc1
    s_branch L_h5_out
L_h5:
    s_sub_u32 s56, s56, 1
    s_cbranch_scc1 L_h5_to
    v_cmp_eq_u32 vcc, -1, v115
    s_cbranch_vccz L_h5_s0
    s_mov_b64 exec, vcc
    buffer_load_dwordx4 v[112:115], v137, s[16:19], 0 offen sc1
    s_mov_b64 exec, -1
L_h5_s0:
    v_cmp_eq_u32 vcc, -1, v119
    s_cbranch_vccz L_h5_s1
    s_mov_b64 exec, vcc
    buffer_load_dwordx4 v[116:119], v137, s[16:19], s79 offen sc1
    s_mov_b64 exec, -1
L_h5_s1:
    s_waitcnt vmcnt(0)
    v_max_u32 v16, v115, v119
    v_cmp_eq_u32 vcc, -1, v16
    s_cbranch_vccz L_h5_done
    s_branch L_h5
L_h5_to:
    s_mov_b32 s56, 0
    s_branch L_h5_done
L_fin_ld:
    buffer_load_short_d16_hi v140, v142, s[16:19], 0 offen sc1
    buffer_load_short_d16_hi v141, v142, s[16:19], s65 offen sc1
    s_waitcnt vmcnt(0)
    v_max_u32 v16, v140, v141
    v_cmp_eq_u32 vcc, 0xffff0000, v16
    s_cbranch_vccz L_fin_go
    s_sub_u32 s56, s56, 1
    s_cbranch_scc0 L_fin_ld
    s_branch L_fin_go
L_last:
    s_endpgm
.section .rodata,"a"
.p2align 6
.amdhsa_kernel sequential_preLN__linear_attn_block__moe_arch_mod__prompt_kernel
  .amdhsa_next_free_vgpr 256
  .amdhsa_next_free_sgpr 102
  .amdhsa_accum_offset 256
  .amdhsa_group_segment_fixed_size 0
  .amdhsa_kernarg_size 88
  .amdhsa_user_sgpr_count 2
  .amdhsa_user_sgpr_kernarg_segment_ptr 1
  .amdhsa_system_sgpr_workgroup_id_x 1
.end_amdhsa_kernel
```

```asm
; @launch grid=(256,1,1) block=(512,1,1) lds=163840
.amdgcn_target "amdgcn-amd-amdhsa--gfx950"
.text
.globl sequential_preLN__linear_attn_block__moe_arch_mod__prompt_kernel
.p2align 8
.type sequential_preLN__linear_attn_block__moe_arch_mod__prompt_kernel,@function
sequential_preLN__linear_attn_block__moe_arch_mod__prompt_kernel:
    s_cmp_ge_u32 s2, 256
    s_cbranch_scc1 L_end
    s_load_dwordx16 s[64:79], s[0:1], 0
    s_load_dwordx4 s[80:83], s[0:1], 64
    s_load_dwordx2 s[84:85], s[0:1], 80
    v_lshrrev_b32 v1, 6, v0
    v_and_b32 v0, 63, v0
    v_readfirstlane_b32 s3, v1
    s_and_b32 s44, s2, 7
    s_lshr_b32 s45, s2, 3
    s_and_b32 s46, s44, 1
    s_lshl_b32 s46, s46, 3
    s_and_b32 s86, s45, 7
    s_add_u32 s46, s46, s86
    s_lshr_b32 s47, s44, 1
    s_lshl_b32 s47, s47, 2
    s_lshr_b32 s86, s45, 3
    s_add_u32 s47, s47, s86
    s_mov_b32 s51, s47
    s_mov_b32 s52, s46
    s_and_b32 s48, s3, 3
    s_and_b32 s49, s3, 1
    s_bfe_u32 s50, s3, 0x10001
    s_mov_b32 s56, 65536
    s_mov_b32 s95, 0x3f803f80
    s_movk_i32 s92, 0x1000
    s_movk_i32 s93, 0x2000
    s_movk_i32 s94, 0x3000
    s_cmp_lt_u32 s3, 4
    s_cbranch_scc1 L_comp0
    v_lshrrev_b32 v20, 3, v0
    v_and_b32 v21, 7, v0
    v_lshrrev_b32 v22, 4, v0
    v_xor_b32 v23, v21, v22
    v_xor_b32 v24, 4, v23
    s_lshl_b32 s86, s48, 5
    v_add_u32 v25, s86, v20
    v_lshlrev_b32 v25, 11, v25
    v_lshl_add_u32 v2, v23, 4, v25
    v_lshl_add_u32 v3, v24, 4, v25
    v_add_u32 v3, 15360, v3
    v_lshl_add_u32 v4, v23, 4, v25
    v_add_u32 v4, 30720, v4
    v_lshl_add_u32 v5, v24, 4, v25
    v_add_u32 v5, 46080, v5
    s_lshl_b32 s86, s48, 4
    v_add_u32 v25, s86, v20
    v_mul_u32_u24 v25, 6144, v25
    s_lshl_b32 s86, s47, 7
    v_add_u32 v25, s86, v25
    v_bfe_u32 v26, v0, 4, 1
    v_lshlrev_b32 v26, 1, v26
    v_xor_b32 v26, v26, v21
    v_xor_b32 v27, 4, v26
    v_lshl_add_u32 v6, v26, 4, v25
    v_lshl_add_u32 v7, v27, 4, v25
    v_add_u32 v7, 48128, v7
    v_lshl_add_u32 v8, v26, 4, v25
    v_add_u32 v8, 2048, v8
    v_lshl_add_u32 v9, v27, 4, v25
    v_add_u32 v9, 50176, v9
    v_lshl_add_u32 v10, v26, 4, v25
    v_add_u32 v10, 4096, v10
    v_lshl_add_u32 v11, v27, 4, v25
    v_add_u32 v11, 52224, v11
    s_lshl_b32 s63, s46, 18
    s_lshl_b32 s53, s48, 12
    s_lshl_b32 s62, s48, 11
    s_add_u32 s62, s62, 16384
    s_setprio 1
    s_lshl_b32 s86, s45, 2
    s_add_u32 s86, s86, s48
    s_mul_i32 s87, s86, 12288
    s_and_b32 s88, s47, 12
    s_lshl_b32 s88, s88, 7
    s_add_u32 s87, s87, s88
    s_add_u32 s87, s87, 384
    s_bitcmp1_b32 s47, 2
    s_cselect_b32 s87, 2147483648, s87
    v_lshl_add_u32 v37, v0, 11, s87
    v_mov_b32 v24, 2147483648
    v_cmp_gt_u32 vcc, 6, v0
    s_nop 1
    v_cndmask_b32 v37, v24, v37, vcc
    s_lshl_b32 s86, s86, 14
    s_and_b32 s88, s52, 8
    s_lshl_b32 s88, s88, 7
    s_add_u32 s86, s86, s88
    s_add_u32 s86, s86, 384
    v_lshl_add_u32 v38, v0, 11, s86
    v_cmp_gt_u32 vcc, 8, v0
    s_nop 1
    v_cndmask_b32 v38, v24, v38, vcc
    s_waitcnt lgkmcnt(0)
    s_mov_b32 s8, s64
    s_and_b32 s9, s65, 0xffff
    s_mov_b32 s10, 4194304
    s_mov_b32 s11, 0x20000
    s_mov_b32 s12, s66
    s_and_b32 s13, s67, 0xffff
    s_mov_b32 s14, 6291456
    s_mov_b32 s15, 0x20000
    s_and_b32 s86, s47, 12
    s_and_b32 s87, s46, 8
    s_add_u32 s64, s86, s87
    s_and_b32 s64, s64, 15
    s_mov_b32 s67, s64
    s_load_dword s61, s[84:85], 524288
    s_lshr_b32 s90, s67, 2
    s_mul_i32 s90, s90, 1572864
    buffer_load_dword v39, v37, s[12:15], s90 offen
    s_add_u32 m0, s53, 40960
    s_lshl_b32 s70, s64, 7
    s_add_u32 s70, s70, s63
    buffer_load_dwordx4 v2, s[8:11], s70 offen offset:0 lds
    buffer_load_dwordx4 v3, s[8:11], s70 offen offset:1024 lds
    buffer_load_dwordx4 v4, s[8:11], s70 offen offset:2048 lds
    buffer_load_dwordx4 v5, s[8:11], s70 offen offset:3072 lds
    s_mul_i32 s91, s64, 393216
    s_add_u32 s64, s64, 1
    s_and_b32 s64, s64, 15
    s_add_u32 m0, s62, 40960
    s_nop 0
    buffer_load_dwordx4 v6, s[12:15], s91 offen offset:0 lds
    buffer_load_dwordx4 v7, s[12:15], s91 offen offset:1024 lds
    s_add_u32 m0, s62, 49152
    s_nop 0
    buffer_load_dwordx4 v8, s[12:15], s91 offen offset:0 lds
    buffer_load_dwordx4 v9, s[12:15], s91 offen offset:1024 lds
    s_add_u32 m0, s62, 57344
    s_nop 0
    buffer_load_dwordx4 v10, s[12:15], s91 offen offset:0 lds
    buffer_load_dwordx4 v11, s[12:15], s91 offen offset:1024 lds
    s_branch L_ld1
L_comp0:
    s_lshl2_add_u32 s86, s45, s3
    s_cmp_ge_u32 s86, 4
    s_cbranch_scc1 L_noipf
    s_getpc_b64 s[4:5]
L_ipf:
    s_sub_u32 s4, s4, L_ipf-sequential_preLN__linear_attn_block__moe_arch_mod__prompt_kernel
    s_subb_u32 s5, s5, 0
    s_lshl_b32 s86, s86, 13
    v_lshl_add_u32 v31, v0, 7, s86
    v_min_u32 v31, L_last-sequential_preLN__linear_attn_block__moe_arch_mod__prompt_kernel, v31
    global_load_dword v30, v31, s[4:5]
L_noipf:
    s_cmp_eq_u32 s3, 3
    s_cbranch_scc1 L_comp
    s_mov_b64 exec, 0
    s_cmp_eq_u32 s3, 2
    s_cbranch_scc1 L_walkA2
    s_cmp_eq_u32 s3, 1
    s_cbranch_scc1 L_walkA1
    s_branch L_walkA0
L_ld1:
    s_mov_b32 s16, s84
    s_and_b32 s17, s85, 0xffff
    s_mov_b32 s18, 268435456
    s_mov_b32 s19, 0x20000
    s_mov_b32 s20, s68
    s_and_b32 s21, s69, 0xffff
    s_mov_b32 s22, 2097152
    s_mov_b32 s23, 0x20000
    s_mov_b32 s24, s80
    s_and_b32 s25, s81, 0xffff
    s_mov_b32 s26, 4194304
    s_mov_b32 s27, 0x20000
    s_mov_b32 s28, s82
    s_and_b32 s29, s83, 0xffff
    s_mov_b32 s30, 256
    s_mov_b32 s31, 0x20000
    s_bitcmp1_b32 s2, 3
    s_cselect_b32 s32, s76, s74
    s_cselect_b32 s33, s77, s75
    s_and_b32 s33, s33, 0xffff
    s_mov_b32 s34, 7340032
    s_mov_b32 s35, 0x20000
    s_mov_b32 s36, s78
    s_and_b32 s37, s79, 0xffff
    s_mov_b32 s38, 7340032
    s_mov_b32 s39, 0x20000
    s_mov_b32 s40, s72
    s_and_b32 s41, s73, 0xffff
    s_mov_b32 s42, 2048
    s_mov_b32 s43, 0x20000
    s_lshl_b32 s82, s44, 5
    s_or_b32 s82, s82, s45
    v_lshrrev_b32 v22, 4, v0
    v_and_b32 v23, 15, v0
    s_lshl_b32 s86, s45, 2
    s_add_u32 s86, s86, s48
L_walkA0:
    s_cbranch_execz L_comp
    s_mul_i32 s87, s86, 6
    v_mul_u32_u24 v24, 43, v0
    v_lshrrev_b32 v24, 8, v24
    v_mul_u32_u24 v25, 6, v24
    v_sub_u32 v25, v0, v25
    v_add_u32 v25, s87, v25
    s_add_u32 s87, s67, 2
    v_add_u32 v24, s87, v24
    v_and_b32 v24, 15, v24
    v_mul_u32_u24 v124, 393216, v24
    v_lshrrev_b32 v24, 2, v25
    v_lshl_add_u32 v124, v24, 11, v124
    v_and_b32 v25, 3, v25
    s_and_b32 s88, s47, 12
    v_add_u32 v25, s88, v25
    v_lshl_add_u32 v124, v25, 7, v124
    v_mov_b32 v24, 2147483648
    v_cmp_gt_u32 vcc, 36, v0
    s_nop 1
    v_cndmask_b32 v124, v24, v124, vcc
    v_add_u32 v24, s87, v20
    v_and_b32 v24, 15, v24
    s_and_b32 s88, s46, 8
    s_lshl4_add_u32 s86, s88, s86
    s_lshl_b32 s86, s86, 14
    v_lshl_add_u32 v123, v21, 11, s86
    v_mov_b32 v125, v123
    v_lshl_add_u32 v123, v24, 7, v123
    v_mov_b32 v24, 2147483648
    v_cmp_gt_u32 vcc, 16, v0
    s_nop 1
    v_cndmask_b32 v123, v24, v123, vcc
    s_add_u32 m0, s53, 81920
    s_lshl_b32 s70, s64, 7
    s_add_u32 s70, s70, s63
    buffer_load_dwordx4 v2, s[8:11], s70 offen offset:0 lds
    buffer_load_dwordx4 v3, s[8:11], s70 offen offset:1024 lds
    buffer_load_dwordx4 v4, s[8:11], s70 offen offset:2048 lds
    buffer_load_dwordx4 v5, s[8:11], s70 offen offset:3072 lds
    s_mul_i32 s91, s64, 393216
    s_add_u32 s64, s64, 1
    s_and_b32 s64, s64, 15
    s_add_u32 m0, s62, 81920
    s_nop 0
    buffer_load_dwordx4 v6, s[12:15], s91 offen offset:0 lds
    buffer_load_dwordx4 v7, s[12:15], s91 offen offset:1024 lds
    s_add_u32 m0, s62, 90112
    s_nop 0
    buffer_load_dwordx4 v8, s[12:15], s91 offen offset:0 lds
    buffer_load_dwordx4 v9, s[12:15], s91 offen offset:1024 lds
    s_add_u32 m0, s62, 98304
    s_nop 0
    buffer_load_dwordx4 v10, s[12:15], s91 offen offset:0 lds
    buffer_load_dwordx4 v11, s[12:15], s91 offen offset:1024 lds
    buffer_load_dword v122, v123, s[8:11], 0 offen
    buffer_load_dword v122, v124, s[12:15], 0 offen
    s_and_b32 s65, s45, 7
    s_lshr_b32 s66, s45, 3
    s_add_u32 s86, s65, 1
    s_and_b32 s86, s86, 3
    s_mul_i32 s86, s86, 40960
    s_lshl_b32 s87, s48, 13
    s_cmp_eq_u32 s48, 3
    s_cselect_b32 s87, 0, s87
    s_add_u32 s86, s86, s87
    s_add_u32 s86, s86, 16384
    v_lshl_add_u32 v25, v20, 7, s86
    v_lshl_add_u32 v28, v26, 4, v25
    v_lshl_add_u32 v29, v27, 4, v25
    s_add_u32 s86, s66, 1
    s_and_b32 s86, s86, 3
    s_mul_i32 s86, s86, 40960
    s_add_u32 s86, s86, s53
    v_lshl_add_u32 v16, v0, 6, s86
    v_bfe_u32 v25, v0, 2, 2
    v_lshl_add_u32 v16, v25, 4, v16
    v_xor_b32 v17, 16, v16
    v_xor_b32 v18, 32, v16
    v_xor_b32 v19, 48, v16
    s_lshl_b32 s86, s46, 14
    s_lshl_b32 s87, s48, 8
    s_add_u32 s86, s86, s87
    s_add_u32 s86, s86, 262144
    v_lshl_add_u32 v33, v23, 4, s86
    v_lshl_add_u32 v33, v22, 10, v33
    s_lshl_b32 s87, s47, 10
    s_add_u32 s86, s86, s87
    v_lshl_add_u32 v13, v0, 2, s86
    v_and_b32 v25, 3, v0
    v_cmp_eq_u32 vcc, 0, v25
    v_mov_b32 v24, 2147483648
    s_nop 0
    v_cndmask_b32 v13, v24, v13, vcc
    s_mul_i32 s86, s47, 12288
    s_add_u32 s86, s86, 65536
    s_lshl_b32 s87, s48, 8
    s_cmp_eq_u32 s48, 3
    s_cselect_b32 s87, 2147483648, s87
    s_mov_b32 s88, 0
    s_add_u32 s86, s86, s87
    v_lshl_add_u32 v32, v23, 4, s86
    v_mul_u32_u24 v25, 768, v22
    v_add_u32 v32, v32, v25
    s_mul_i32 s87, s46, 768
    s_add_u32 s86, s86, s87
    s_add_u32 s86, s86, s88
    v_lshl_add_u32 v34, v23, 5, s86
    v_lshl_add_u32 v34, v22, 4, v34
    v_and_b32 v25, 0x28, v0
    v_cmp_eq_u32 vcc, 0, v25
    s_nop 1
    v_cndmask_b32 v34, v24, v34, vcc
    s_bfe_u32 s86, s82, 0x20001
    s_lshl_b32 s86, s86, 2
    s_add_u32 s86, s86, s48
    s_lshl_b32 s86, s86, 6
    v_lshl_add_u32 v30, v22, 4, s86
    v_mul_u32_u24 v30, 7168, v30
    s_add_u32 s86, s44, 3
    s_and_b32 s86, s86, 7
    s_min_u32 s86, s86, 6
    s_mul_i32 s87, s44, 7
    s_lshr_b32 s88, s45, 3
    s_lshl_b32 s88, s88, 1
    s_sub_u32 s80, s88, 2
    s_cmp_ge_u32 s80, s86
    s_addc_u32 s80, s80, s87
    s_sub_u32 s81, s88, 1
    s_cmp_ge_u32 s81, s86
    s_addc_u32 s81, s81, s87
    s_add_u32 s86, s86, s87
    s_cmp_lt_u32 s45, 8
    s_cselect_b32 s80, s86, s80
    s_cselect_b32 s81, 56, s81
    v_mov_b32 v24, s80
    v_mov_b32 v25, s81
    s_mov_b32 vcc_lo, 4278255360
    s_mov_b32 vcc_hi, vcc_lo
    v_cndmask_b32 v24, v24, v25, vcc
    v_cmp_gt_u32 vcc, 56, v24
    v_and_b32 v25, 7, v0
    v_lshlrev_b32 v24, 7, v24
    v_lshl_add_u32 v24, v25, 4, v24
    v_add_u32 v30, v30, v24
    v_mov_b32 v24, 2147483648
    v_cndmask_b32 v30, v24, v30, vcc
    s_lshr_b32 s86, s82, 3
    s_mul_i32 s86, s86, 112
    s_mul_i32 s87, s48, 28
    s_add_u32 s86, s86, s87
    v_mul_u32_u24 v31, 7, v22
    v_add_u32 v31, s86, v31
    v_lshlrev_b32 v31, 11, v31
    s_and_b32 s86, s82, 7
    s_lshl_b32 s86, s86, 8
    v_lshl_add_u32 v24, v23, 4, s86
    v_add_u32 v31, v31, v24
    v_lshlrev_b32 v24, 1, v22
    v_xor_b32 v24, v24, v21
    s_lshl_b32 s86, s48, 3
    v_add_u32 v12, s86, v20
    v_lshlrev_b32 v12, 11, v12
    s_lshl_b32 s86, s52, 7
    v_lshl_add_u32 v24, v24, 4, s86
    v_add_u32 v12, v12, v24
    s_lshl_b32 s89, s48, 10
    v_and_b32 v24, 1, v0
    v_lshlrev_b32 v24, 4, v24
    v_mov_b32 v25, 0x3f80
    v_lshlrev_b32 v24, v24, v25
    v_bfe_u32 v25, v0, 1, 2
    v_cmp_eq_u32 vcc, 0, v25
    s_nop 1
    v_cndmask_b32 v104, 0, v24, vcc
    v_cmp_eq_u32 vcc, 1, v25
    s_nop 1
    v_cndmask_b32 v105, 0, v24, vcc
    v_cmp_eq_u32 vcc, 2, v25
    s_nop 1
    v_cndmask_b32 v106, 0, v24, vcc
    v_cmp_eq_u32 vcc, 3, v25
    s_nop 1
    v_cndmask_b32 v107, 0, v24, vcc
    s_waitcnt lgkmcnt(0)
    s_add_u32 s68, s61, 0x9e3779b9
    v_mov_b32 v35, s68
    s_lshl_b32 s86, s46, 2
    s_add_u32 s86, s86, s48
    s_lshl_b32 s86, s86, 7
    s_add_u32 s86, s86, 655360
    s_lshl_b32 s87, s47, 2
    s_add_u32 s87, s87, s48
    s_lshl_b32 s87, s87, 7
    s_add_u32 s87, s87, 663552
    s_cmp_eq_u32 s48, 3
    s_cselect_b32 s87, 2147483648, s87
    s_cselect_b32 s76, 0xffff, -1
    s_mov_b32 s77, 0
    v_mov_b32 v24, s86
    v_mov_b32 v25, s87
    v_cmp_gt_u32 vcc, 16, v0
    s_nop 1
    v_cndmask_b32 v117, v25, v24, vcc
    v_lshl_add_u32 v117, v23, 2, v117
    v_mov_b32 v116, 2147483648
    v_cmp_gt_u32 vcc, 32, v0
    s_nop 1
L_walkA1:
    s_cbranch_execz L_comp
    v_cndmask_b32 v117, v116, v117, vcc
    s_lshl2_add_u32 s86, s47, s86
    s_lshl2_add_u32 s87, s46, s87
    v_writelane_b32 v116, s86, 0
    v_writelane_b32 v116, s87, 1
    s_getreg_b32 s83, hwreg(HW_REG_XCC_ID, 0, 4)
    s_add_u32 s83, s83, s68
    v_mov_b32 v121, s83
    s_lshl_b32 s86, s44, 7
    s_add_u32 s86, s86, 753664
    v_lshl_add_u32 v119, v0, 2, s86
    v_mov_b32 v120, 2147483648
    v_cmp_gt_u32 vcc, 32, v0
    s_nop 1
    v_cndmask_b32 v119, v120, v119, vcc
    s_lshl_b32 s86, s48, 6
    s_add_u32 s86, s86, s45
    v_cmp_eq_u32 vcc, s86, v0
    s_nop 1
    v_cndmask_b32 v120, v120, v119, vcc
    s_mov_b64 exec, 0
    s_cmp_eq_u32 s48, 0
    s_cbranch_scc1 L_walkB4
    s_cmp_eq_u32 s48, 1
    s_cbranch_scc1 L_walkB5
    s_cmp_eq_u32 s48, 2
    s_cbranch_scc1 L_walkB6
    s_branch L_walkB7
L_walked2:
    s_mov_b64 exec, -1
    s_waitcnt vmcnt(12)
    s_barrier
    buffer_store_dword v121, v120, s[16:19], 0 offen sc1
    s_add_u32 m0, s53, 122880
    s_lshl_b32 s70, s64, 7
    s_add_u32 s70, s70, s63
    buffer_load_dwordx4 v2, s[8:11], s70 offen offset:0 lds
    buffer_load_dwordx4 v3, s[8:11], s70 offen offset:1024 lds
    buffer_load_dwordx4 v4, s[8:11], s70 offen offset:2048 lds
    buffer_load_dwordx4 v5, s[8:11], s70 offen offset:3072 lds
    s_mul_i32 s91, s64, 393216
    s_add_u32 s64, s64, 1
    s_and_b32 s64, s64, 15
    s_add_u32 m0, s62, 122880
    s_nop 0
    buffer_load_dwordx4 v6, s[12:15], s91 offen offset:0 lds
    buffer_load_dwordx4 v7, s[12:15], s91 offen offset:1024 lds
    s_add_u32 m0, s62, 131072
    s_nop 0
    buffer_load_dwordx4 v8, s[12:15], s91 offen offset:0 lds
    buffer_load_dwordx4 v9, s[12:15], s91 offen offset:1024 lds
    s_add_u32 m0, s62, 139264
    s_nop 0
    buffer_load_dwordx4 v10, s[12:15], s91 offen offset:0 lds
    buffer_load_dwordx4 v11, s[12:15], s91 offen offset:1024 lds
    s_add_u32 s87, s67, 4
    v_add_u32 v24, s87, v20
    v_and_b32 v24, 15, v24
    v_lshl_add_u32 v123, v24, 7, v125
    v_mov_b32 v24, 2147483648
    v_cmp_gt_u32 vcc, 32, v0
    s_nop 1
    v_cndmask_b32 v123, v24, v123, vcc
    buffer_load_dword v122, v123, s[8:11], 0 offen
    s_cmp_lg_u32 s65, 0
    s_cbranch_scc1 L_h0c0
    ds_read_b128 v[40:43], v28 offset:0
    ds_read_b128 v[44:47], v29 offset:1024
    ds_read_b128 v[48:51], v28 offset:2048
    ds_read_b128 v[52:55], v29 offset:3072
    ds_read_b128 v[56:59], v28 offset:4096
    ds_read_b128 v[60:63], v29 offset:5120
    ds_read_b128 v[64:67], v28 offset:6144
    ds_read_b128 v[68:71], v29 offset:7168
L_h0c0:
    s_cmp_lg_u32 s66, 0
    s_cbranch_scc1 L_h0r0
    ds_read_b128 v[72:75], v16
    ds_read_b128 v[76:79], v17
    ds_read_b128 v[80:83], v18
    ds_read_b128 v[84:87], v19
L_h0r0:
    s_waitcnt lgkmcnt(0)
    s_waitcnt vmcnt(14)
    s_barrier
    s_add_u32 m0, s53, 0
    s_lshl_b32 s70, s64, 7
    s_add_u32 s70, s70, s63
    buffer_load_dwordx4 v2, s[8:11], s70 offen offset:0 lds
    buffer_load_dwordx4 v3, s[8:11], s70 offen offset:1024 lds
    buffer_load_dwordx4 v4, s[8:11], s70 offen offset:2048 lds
    buffer_load_dwordx4 v5, s[8:11], s70 offen offset:3072 lds
    s_mul_i32 s91, s64, 393216
    s_add_u32 s64, s64, 1
    s_and_b32 s64, s64, 15
    s_add_u32 m0, s62, 0
    s_nop 0
    buffer_load_dwordx4 v6, s[12:15], s91 offen offset:0 lds
    buffer_load_dwordx4 v7, s[12:15], s91 offen offset:1024 lds
    s_add_u32 m0, s62, 8192
    s_nop 0
    buffer_load_dwordx4 v8, s[12:15], s91 offen offset:0 lds
    buffer_load_dwordx4 v9, s[12:15], s91 offen offset:1024 lds
    s_add_u32 m0, s62, 16384
    s_nop 0
    buffer_load_dwordx4 v10, s[12:15], s91 offen offset:0 lds
    buffer_load_dwordx4 v11, s[12:15], s91 offen offset:1024 lds
    s_cmp_lg_u32 s65, 1
    s_cbranch_scc1 L_h0c1
    ds_read_b128 v[40:43], v28 offset:0
    ds_read_b128 v[44:47], v29 offset:1024
    ds_read_b128 v[48:51], v28 offset:2048
    ds_read_b128 v[52:55], v29 offset:3072
    ds_read_b128 v[56:59], v28 offset:4096
    ds_read_b128 v[60:63], v29 offset:5120
    ds_read_b128 v[64:67], v28 offset:6144
    ds_read_b128 v[68:71], v29 offset:7168
L_h0c1:
    s_cmp_lg_u32 s66, 1
    s_cbranch_scc1 L_h0r1
    ds_read_b128 v[72:75], v16
    ds_read_b128 v[76:79], v17
    ds_read_b128 v[80:83], v18
    ds_read_b128 v[84:87], v19
L_h0r1:
    s_waitcnt lgkmcnt(0)
    s_waitcnt vmcnt(11)
    s_barrier
    s_add_u32 m0, s53, 40960
    s_lshl_b32 s70, s64, 7
    s_add_u32 s70, s70, s63
    buffer_load_dwordx4 v2, s[8:11], s70 offen offset:0 lds
    buffer_load_dwordx4 v3, s[8:11], s70 offen offset:1024 lds
    buffer_load_dwordx4 v4, s[8:11], s70 offen offset:2048 lds
    buffer_load_dwordx4 v5, s[8:11], s70 offen offset:3072 lds
    s_mul_i32 s91, s64, 393216
    s_add_u32 s64, s64, 1
    s_and_b32 s64, s64, 15
    s_add_u32 m0, s62, 40960
    s_nop 0
    buffer_load_dwordx4 v6, s[12:15], s91 offen offset:0 lds
    buffer_load_dwordx4 v7, s[12:15], s91 offen offset:1024 lds
    s_add_u32 m0, s62, 49152
    s_nop 0
    buffer_load_dwordx4 v8, s[12:15], s91 offen offset:0 lds
    buffer_load_dwordx4 v9, s[12:15], s91 offen offset:1024 lds
    s_add_u32 m0, s62, 57344
    s_nop 0
    buffer_load_dwordx4 v10, s[12:15], s91 offen offset:0 lds
    buffer_load_dwordx4 v11, s[12:15], s91 offen offset:1024 lds
    s_cmp_lg_u32 s65, 2
    s_cbranch_scc1 L_h0c2
    ds_read_b128 v[40:43], v28 offset:0
    ds_read_b128 v[44:47], v29 offset:1024
    ds_read_b128 v[48:51], v28 offset:2048
    ds_read_b128 v[52:55], v29 offset:3072
    ds_read_b128 v[56:59], v28 offset:4096
    ds_read_b128 v[60:63], v29 offset:5120
    ds_read_b128 v[64:67], v28 offset:6144
    ds_read_b128 v[68:71], v29 offset:7168
L_h0c2:
    s_cmp_lg_u32 s66, 2
    s_cbranch_scc1 L_h0r2
    ds_read_b128 v[72:75], v16
    ds_read_b128 v[76:79], v17
    ds_read_b128 v[80:83], v18
    ds_read_b128 v[84:87], v19
L_h0r2:
    s_waitcnt lgkmcnt(0)
    s_waitcnt vmcnt(10)
    s_barrier
    s_add_u32 m0, s53, 81920
    s_lshl_b32 s70, s64, 7
    s_add_u32 s70, s70, s63
    buffer_load_dwordx4 v2, s[8:11], s70 offen offset:0 lds
    buffer_load_dwordx4 v3, s[8:11], s70 offen offset:1024 lds
    buffer_load_dwordx4 v4, s[8:11], s70 offen offset:2048 lds
    buffer_load_dwordx4 v5, s[8:11], s70 offen offset:3072 lds
    s_mul_i32 s91, s64, 393216
    s_add_u32 s64, s64, 1
    s_and_b32 s64, s64, 15
    s_add_u32 m0, s62, 81920
    s_nop 0
L_walkB0:
    s_cbranch_execz L_walk_4
    buffer_load_dwordx4 v6, s[12:15], s91 offen offset:0 lds
    buffer_load_dwordx4 v7, s[12:15], s91 offen offset:1024 lds
    s_add_u32 m0, s62, 90112
    s_nop 0
    buffer_load_dwordx4 v8, s[12:15], s91 offen offset:0 lds
    buffer_load_dwordx4 v9, s[12:15], s91 offen offset:1024 lds
    s_add_u32 m0, s62, 98304
    s_nop 0
    buffer_load_dwordx4 v10, s[12:15], s91 offen offset:0 lds
    buffer_load_dwordx4 v11, s[12:15], s91 offen offset:1024 lds
    s_lshr_b32 s90, s67, 2
    s_add_u32 s90, s90, 2
    s_and_b32 s90, s90, 3
    s_mul_i32 s90, s90, 1572864
    buffer_load_dword v39, v37, s[12:15], s90 offen
    s_cmp_lg_u32 s65, 3
    s_cbranch_scc1 L_h0c3
    ds_read_b128 v[40:43], v28 offset:0
    ds_read_b128 v[44:47], v29 offset:1024
    ds_read_b128 v[48:51], v28 offset:2048
    ds_read_b128 v[52:55], v29 offset:3072
    ds_read_b128 v[56:59], v28 offset:4096
    ds_read_b128 v[60:63], v29 offset:5120
    ds_read_b128 v[64:67], v28 offset:6144
    ds_read_b128 v[68:71], v29 offset:7168
L_h0c3:
    s_cmp_lg_u32 s66, 3
    s_cbranch_scc1 L_h0r3
    ds_read_b128 v[72:75], v16
    ds_read_b128 v[76:79], v17
    ds_read_b128 v[80:83], v18
    ds_read_b128 v[84:87], v19
L_h0r3:
    s_waitcnt lgkmcnt(0)
    s_waitcnt vmcnt(11)
    s_barrier
    s_add_u32 m0, s53, 122880
    s_lshl_b32 s70, s64, 7
    s_add_u32 s70, s70, s63
    buffer_load_dwordx4 v2, s[8:11], s70 offen offset:0 lds
    buffer_load_dwordx4 v3, s[8:11], s70 offen offset:1024 lds
    buffer_load_dwordx4 v4, s[8:11], s70 offen offset:2048 lds
    buffer_load_dwordx4 v5, s[8:11], s70 offen offset:3072 lds
    s_mul_i32 s91, s64, 393216
    s_add_u32 s64, s64, 1
    s_and_b32 s64, s64, 15
    s_add_u32 m0, s62, 122880
    s_nop 0
    buffer_load_dwordx4 v6, s[12:15], s91 offen offset:0 lds
    buffer_load_dwordx4 v7, s[12:15], s91 offen offset:1024 lds
    s_add_u32 m0, s62, 131072
    s_nop 0
    buffer_load_dwordx4 v8, s[12:15], s91 offen offset:0 lds
    buffer_load_dwordx4 v9, s[12:15], s91 offen offset:1024 lds
    s_add_u32 m0, s62, 139264
    s_nop 0
    buffer_load_dwordx4 v10, s[12:15], s91 offen offset:0 lds
    buffer_load_dwordx4 v11, s[12:15], s91 offen offset:1024 lds
    s_cmp_lg_u32 s65, 4
    s_cbranch_scc1 L_h0c4
    ds_read_b128 v[40:43], v28 offset:0
    ds_read_b128 v[44:47], v29 offset:1024
    ds_read_b128 v[48:51], v28 offset:2048
    ds_read_b128 v[52:55], v29 offset:3072
    ds_read_b128 v[56:59], v28 offset:4096
    ds_read_b128 v[60:63], v29 offset:5120
    ds_read_b128 v[64:67], v28 offset:6144
    ds_read_b128 v[68:71], v29 offset:7168
L_h0c4:
    s_waitcnt lgkmcnt(0)
    v_mov_b32 v88, 0
    v_mov_b32 v89, 0
    v_mov_b32 v90, 0
    v_mov_b32 v91, 0
    v_mov_b32 v92, 0
    v_mov_b32 v93, 0
    v_mov_b32 v94, 0
    v_mov_b32 v95, 0
    v_dot2c_f32_bf16 v88, s95, v72
    v_dot2c_f32_bf16 v89, s95, v73
    v_dot2c_f32_bf16 v90, s95, v74
    v_dot2c_f32_bf16 v91, s95, v75
    v_dot2c_f32_bf16 v92, v72, v72
    v_dot2c_f32_bf16 v93, v73, v73
    v_dot2c_f32_bf16 v94, v74, v74
    v_dot2c_f32_bf16 v95, v75, v75
    v_dot2c_f32_bf16 v88, s95, v76
    v_dot2c_f32_bf16 v89, s95, v77
    v_dot2c_f32_bf16 v90, s95, v78
    v_dot2c_f32_bf16 v91, s95, v79
    v_dot2c_f32_bf16 v92, v76, v76
    v_dot2c_f32_bf16 v93, v77, v77
    v_dot2c_f32_bf16 v94, v78, v78
    v_dot2c_f32_bf16 v95, v79, v79
    v_dot2c_f32_bf16 v88, s95, v80
    v_dot2c_f32_bf16 v89, s95, v81
    v_dot2c_f32_bf16 v90, s95, v82
    v_dot2c_f32_bf16 v91, s95, v83
    v_dot2c_f32_bf16 v92, v80, v80
    v_dot2c_f32_bf16 v93, v81, v81
    v_dot2c_f32_bf16 v94, v82, v82
    v_dot2c_f32_bf16 v95, v83, v83
    v_dot2c_f32_bf16 v88, s95, v84
    v_dot2c_f32_bf16 v89, s95, v85
    v_dot2c_f32_bf16 v90, s95, v86
    v_dot2c_f32_bf16 v91, s95, v87
    v_dot2c_f32_bf16 v92, v84, v84
    v_dot2c_f32_bf16 v93, v85, v85
    v_dot2c_f32_bf16 v94, v86, v86
    v_dot2c_f32_bf16 v95, v87, v87
    s_waitcnt vmcnt(11)
    s_barrier
    s_add_u32 m0, s53, 0
    s_lshl_b32 s70, s64, 7
    s_add_u32 s70, s70, s63
    buffer_load_dwordx4 v2, s[8:11], s70 offen offset:0 lds
    buffer_load_dwordx4 v3, s[8:11], s70 offen offset:1024 lds
    buffer_load_dwordx4 v4, s[8:11], s70 offen offset:2048 lds
    buffer_load_dwordx4 v5, s[8:11], s70 offen offset:3072 lds
    s_mul_i32 s91, s64, 393216
    s_add_u32 s64, s64, 1
    s_and_b32 s64, s64, 15
    s_add_u32 m0, s62, 0
    s_nop 0
    buffer_load_dwordx4 v6, s[12:15], s91 offen offset:0 lds
    buffer_load_dwordx4 v7, s[12:15], s91 offen offset:1024 lds
    s_add_u32 m0, s62, 8192
    s_nop 0
    buffer_load_dwordx4 v8, s[12:15], s91 offen offset:0 lds
    buffer_load_dwordx4 v9, s[12:15], s91 offen offset:1024 lds
    s_add_u32 m0, s62, 16384
    s_nop 0
    buffer_load_dwordx4 v10, s[12:15], s91 offen offset:0 lds
    buffer_load_dwordx4 v11, s[12:15], s91 offen offset:1024 lds
    buffer_load_dword v39, v38, s[20:23], 0 offen
    s_cmp_lg_u32 s65, 5
    s_cbranch_scc1 L_h0c5
    ds_read_b128 v[40:43], v28 offset:0
    ds_read_b128 v[44:47], v29 offset:1024
    ds_read_b128 v[48:51], v28 offset:2048
    ds_read_b128 v[52:55], v29 offset:3072
    ds_read_b128 v[56:59], v28 offset:4096
    ds_read_b128 v[60:63], v29 offset:5120
    ds_read_b128 v[64:67], v28 offset:6144
    ds_read_b128 v[68:71], v29 offset:7168
L_h0c5:
    s_waitcnt lgkmcnt(0)
    v_pk_add_f32 v[88:89], v[88:89], v[90:91]
    v_pk_add_f32 v[92:93], v[92:93], v[94:95]
    v_add_f32 v88, v88, v89
    v_add_f32 v89, v92, v93
    s_nop 0
    v_add_f32_dpp v88, v88, v88 quad_perm:[1,0,3,2] row_mask:0xf bank_mask:0xf
    v_add_f32_dpp v89, v89, v89 quad_perm:[1,0,3,2] row_mask:0xf bank_mask:0xf
    s_nop 0
    v_mov_b32_dpp v90, v88 quad_perm:[2,2,2,2] row_mask:0xf bank_mask:0xf
    v_mov_b32_dpp v91, v89 quad_perm:[2,2,2,2] row_mask:0xf bank_mask:0xf
    buffer_store_dwordx4 v[88:91], v13, s[16:19], 0 offen sc1
    s_lshl_b32 s86, s48, 7
    s_add_u32 s86, s86, 131072
    v_lshl_add_u32 v16, v23, 3, s86
    v_lshrrev_b32 v17, 5, v0
    v_lshl_add_u32 v16, v17, 2, v16
    s_lshl_b32 s86, s48, 8
    s_add_u32 s86, s86, 132608
    v_lshl_add_u32 v17, v23, 4, s86
    v_lshl_add_u32 v17, v22, 2, v17
    s_waitcnt vmcnt(12)
    s_barrier
    s_add_u32 m0, s53, 40960
    s_lshl_b32 s70, s64, 7
    s_add_u32 s70, s70, s63
    buffer_load_dwordx4 v2, s[8:11], s70 offen offset:0 lds
    buffer_load_dwordx4 v3, s[8:11], s70 offen offset:1024 lds
    buffer_load_dwordx4 v4, s[8:11], s70 offen offset:2048 lds
    buffer_load_dwordx4 v5, s[8:11], s70 offen offset:3072 lds
    s_mul_i32 s91, s64, 393216
    s_add_u32 s64, s64, 1
    s_and_b32 s64, s64, 15
    s_add_u32 m0, s62, 40960
    s_nop 0
    buffer_load_dwordx4 v6, s[12:15], s91 offen offset:0 lds
    buffer_load_dwordx4 v7, s[12:15], s91 offen offset:1024 lds
    s_add_u32 m0, s62, 49152
    s_nop 0
L_walkB1:
    s_cbranch_execz L_walk_5
    buffer_load_dwordx4 v8, s[12:15], s91 offen offset:0 lds
    buffer_load_dwordx4 v9, s[12:15], s91 offen offset:1024 lds
    s_add_u32 m0, s62, 57344
    s_nop 0
    buffer_load_dwordx4 v10, s[12:15], s91 offen offset:0 lds
    buffer_load_dwordx4 v11, s[12:15], s91 offen offset:1024 lds
    s_lshr_b32 s90, s67, 2
    s_add_u32 s90, s90, 3
    s_and_b32 s90, s90, 3
    s_mul_i32 s90, s90, 1572864
    buffer_load_dword v39, v37, s[12:15], s90 offen
    s_cmp_lg_u32 s65, 6
    s_cbranch_scc1 L_h0c6
    ds_read_b128 v[40:43], v28 offset:0
    ds_read_b128 v[44:47], v29 offset:1024
    ds_read_b128 v[48:51], v28 offset:2048
    ds_read_b128 v[52:55], v29 offset:3072
    ds_read_b128 v[56:59], v28 offset:4096
    ds_read_b128 v[60:63], v29 offset:5120
    ds_read_b128 v[64:67], v28 offset:6144
    ds_read_b128 v[68:71], v29 offset:7168
L_h0c6:
    s_waitcnt lgkmcnt(0)
    s_waitcnt vmcnt(13)
    s_barrier
    s_add_u32 m0, s53, 81920
    s_lshl_b32 s70, s64, 7
    s_add_u32 s70, s70, s63
    buffer_load_dwordx4 v2, s[8:11], s70 offen offset:0 lds
    buffer_load_dwordx4 v3, s[8:11], s70 offen offset:1024 lds
    buffer_load_dwordx4 v4, s[8:11], s70 offen offset:2048 lds
    buffer_load_dwordx4 v5, s[8:11], s70 offen offset:3072 lds
    s_mul_i32 s91, s64, 393216
    s_add_u32 s64, s64, 1
    s_and_b32 s64, s64, 15
    s_add_u32 m0, s62, 81920
    s_nop 0
    buffer_load_dwordx4 v6, s[12:15], s91 offen offset:0 lds
    buffer_load_dwordx4 v7, s[12:15], s91 offen offset:1024 lds
    s_add_u32 m0, s62, 90112
    s_nop 0
    buffer_load_dwordx4 v8, s[12:15], s91 offen offset:0 lds
    buffer_load_dwordx4 v9, s[12:15], s91 offen offset:1024 lds
    s_add_u32 m0, s62, 98304
    s_nop 0
    buffer_load_dwordx4 v10, s[12:15], s91 offen offset:0 lds
    buffer_load_dwordx4 v11, s[12:15], s91 offen offset:1024 lds
    s_add_u32 m0, s53, 122880
    s_lshl_b32 s70, s64, 7
    s_add_u32 s70, s70, s63
    buffer_load_dwordx4 v2, s[8:11], s70 offen offset:0 lds
    buffer_load_dwordx4 v3, s[8:11], s70 offen offset:1024 lds
    s_cmp_lg_u32 s65, 7
    s_cbranch_scc1 L_h0c7
    ds_read_b128 v[40:43], v28 offset:0
    ds_read_b128 v[44:47], v29 offset:1024
    ds_read_b128 v[48:51], v28 offset:2048
    ds_read_b128 v[52:55], v29 offset:3072
    ds_read_b128 v[56:59], v28 offset:4096
    ds_read_b128 v[60:63], v29 offset:5120
    ds_read_b128 v[64:67], v28 offset:6144
    ds_read_b128 v[68:71], v29 offset:7168
L_h0c7:
    s_waitcnt lgkmcnt(0)
    v_mfma_f32_16x16x32_bf16 v[108:111], v[104:107], v[40:43], 0
    v_mfma_f32_16x16x32_bf16 v[108:111], v[104:107], v[44:47], v[108:111]
    v_mfma_f32_16x16x32_bf16 v[108:111], v[104:107], v[48:51], v[108:111]
    v_mfma_f32_16x16x32_bf16 v[108:111], v[104:107], v[52:55], v[108:111]
    v_mfma_f32_16x16x32_bf16 v[108:111], v[104:107], v[56:59], v[108:111]
    v_mfma_f32_16x16x32_bf16 v[108:111], v[104:107], v[60:63], v[108:111]
    v_mfma_f32_16x16x32_bf16 v[108:111], v[104:107], v[64:67], v[108:111]
    v_mfma_f32_16x16x32_bf16 v[108:111], v[104:107], v[68:71], v[108:111]
    s_nop 7
    v_add_f32_dpp v108, v108, v108 row_ror:8 row_mask:0xf bank_mask:0xf
    v_add_f32_dpp v109, v109, v109 row_ror:8 row_mask:0xf bank_mask:0xf
    v_add_f32_dpp v110, v110, v110 row_ror:8 row_mask:0xf bank_mask:0xf
    v_add_f32_dpp v111, v111, v111 row_ror:8 row_mask:0xf bank_mask:0xf
    buffer_store_dwordx4 v[108:111], v34, s[16:19], 0 offen sc1
    s_waitcnt vmcnt(14)
    s_barrier
    s_add_u32 m0, s53, 122880
    s_nop 0
    buffer_load_dwordx4 v4, s[8:11], s70 offen offset:2048 lds
    buffer_load_dwordx4 v5, s[8:11], s70 offen offset:3072 lds
    s_mul_i32 s91, s64, 393216
    s_add_u32 s64, s64, 1
    s_and_b32 s64, s64, 15
    s_add_u32 m0, s62, 122880
    s_nop 0
    buffer_load_dwordx4 v6, s[12:15], s91 offen offset:0 lds
    buffer_load_dwordx4 v7, s[12:15], s91 offen offset:1024 lds
    s_add_u32 m0, s62, 131072
    s_nop 0
    buffer_load_dwordx4 v8, s[12:15], s91 offen offset:0 lds
    buffer_load_dwordx4 v9, s[12:15], s91 offen offset:1024 lds
    s_add_u32 m0, s62, 139264
    s_nop 0
    buffer_load_dwordx4 v10, s[12:15], s91 offen offset:0 lds
    buffer_load_dwordx4 v11, s[12:15], s91 offen offset:1024 lds
    s_add_u32 m0, s53, 0
    s_lshl_b32 s70, s64, 7
    s_add_u32 s70, s70, s63
    buffer_load_dwordx4 v2, s[8:11], s70 offen offset:0 lds
    buffer_load_dwordx4 v3, s[8:11], s70 offen offset:1024 lds
    s_waitcnt vmcnt(10)
    s_barrier
    buffer_atomic_swap v35, v116, s[16:19], 0 offen sc1
    s_add_u32 m0, s53, 0
    s_nop 0
    buffer_load_dwordx4 v4, s[8:11], s70 offen offset:2048 lds
    buffer_load_dwordx4 v5, s[8:11], s70 offen offset:3072 lds
    s_mul_i32 s91, s64, 393216
    s_add_u32 s64, s64, 1
    s_and_b32 s64, s64, 15
    s_add_u32 m0, s62, 0
    s_nop 0
    buffer_load_dwordx4 v6, s[12:15], s91 offen offset:0 lds
    buffer_load_dwordx4 v7, s[12:15], s91 offen offset:1024 lds
    s_add_u32 m0, s62, 8192
    s_nop 0
    buffer_load_dwordx4 v8, s[12:15], s91 offen offset:0 lds
    buffer_load_dwordx4 v9, s[12:15], s91 offen offset:1024 lds
    s_add_u32 m0, s62, 16384
    s_nop 0
    buffer_load_dwordx4 v10, s[12:15], s91 offen offset:0 lds
    buffer_load_dwordx4 v11, s[12:15], s91 offen offset:1024 lds
    s_add_u32 m0, s53, 40960
    s_lshl_b32 s70, s64, 7
    s_add_u32 s70, s70, s63
    buffer_load_dwordx4 v2, s[8:11], s70 offen offset:0 lds
    buffer_load_dwordx4 v3, s[8:11], s70 offen offset:1024 lds
    buffer_load_dwordx4 v4, s[8:11], s70 offen offset:2048 lds
    buffer_load_dwordx4 v5, s[8:11], s70 offen offset:3072 lds
    s_mul_i32 s91, s64, 393216
    s_add_u32 s64, s64, 1
    s_and_b32 s64, s64, 15
    s_waitcnt vmcnt(15)
    s_barrier
    s_add_u32 m0, s62, 40960
    s_nop 0
    buffer_load_dwordx4 v6, s[12:15], s91 offen offset:0 lds
    buffer_load_dwordx4 v7, s[12:15], s91 offen offset:1024 lds
    s_add_u32 m0, s62, 49152
    s_nop 0
    buffer_load_dwordx4 v8, s[12:15], s91 offen offset:0 lds
    buffer_load_dwordx4 v9, s[12:15], s91 offen offset:1024 lds
    s_add_u32 m0, s62, 57344
    s_nop 0
    buffer_load_dwordx4 v10, s[12:15], s91 offen offset:0 lds
    buffer_load_dwordx4 v11, s[12:15], s91 offen offset:1024 lds
    s_add_u32 m0, s53, 81920
    s_lshl_b32 s70, s64, 7
    s_add_u32 s70, s70, s63
    buffer_load_dwordx4 v2, s[8:11], s70 offen offset:0 lds
    buffer_load_dwordx4 v3, s[8:11], s70 offen offset:1024 lds
    buffer_load_dwordx4 v4, s[8:11], s70 offen offset:2048 lds
    buffer_load_dwordx4 v5, s[8:11], s70 offen offset:3072 lds
    s_mul_i32 s91, s64, 393216
    s_add_u32 s64, s64, 1
    s_and_b32 s64, s64, 15
    s_add_u32 m0, s62, 81920
    s_nop 0
    buffer_load_dwordx4 v6, s[12:15], s91 offen offset:0 lds
    buffer_load_dwordx4 v7, s[12:15], s91 offen offset:1024 lds
    s_waitcnt vmcnt(16)
    s_barrier
    buffer_load_dword v121, v119, s[16:19], 0 offen sc1
L_walk_4:
    s_cbranch_execz L_walk_8
    s_add_u32 m0, s62, 90112
    s_nop 0
    buffer_load_dwordx4 v8, s[12:15], s91 offen offset:0 lds
    buffer_load_dwordx4 v9, s[12:15], s91 offen offset:1024 lds
    s_add_u32 m0, s62, 98304
    s_nop 0
    buffer_load_dwordx4 v10, s[12:15], s91 offen offset:0 lds
    buffer_load_dwordx4 v11, s[12:15], s91 offen offset:1024 lds
    s_add_u32 m0, s53, 122880
    s_lshl_b32 s70, s64, 7
    s_add_u32 s70, s70, s63
    buffer_load_dwordx4 v2, s[8:11], s70 offen offset:0 lds
    buffer_load_dwordx4 v3, s[8:11], s70 offen offset:1024 lds
    buffer_load_dwordx4 v4, s[8:11], s70 offen offset:2048 lds
    buffer_load_dwordx4 v5, s[8:11], s70 offen offset:3072 lds
    s_mul_i32 s91, s64, 393216
    s_add_u32 s64, s64, 1
    s_and_b32 s64, s64, 15
    s_add_u32 m0, s62, 122880
    s_nop 0
    buffer_load_dwordx4 v6, s[12:15], s91 offen offset:0 lds
    buffer_load_dwordx4 v7, s[12:15], s91 offen offset:1024 lds
    s_add_u32 m0, s62, 131072
    s_nop 0
    buffer_load_dwordx4 v8, s[12:15], s91 offen offset:0 lds
    buffer_load_dwordx4 v9, s[12:15], s91 offen offset:1024 lds
    s_lshr_b32 s60, s3, 2
    s_lshl_b32 s69, s51, 3
    s_lshl_b32 s86, s48, 1
    s_add_u32 s69, s69, s86
    s_add_u32 s69, s69, s60
    v_lshrrev_b32 v36, 4, v0
    v_and_b32 v37, 15, v0
    s_lshl_b32 s87, s69, 15
    s_lshl_b32 s86, s60, 14
    s_add_u32 s86, s86, s87
    s_add_u32 s86, s86, 1048576
    v_lshl_add_u32 v157, v0, 4, s86
    v_xor_b32 v158, 0x8000, v157
    s_lshl_b32 s86, s51, 1
    s_lshr_b32 s87, s48, 1
    s_add_u32 s86, s86, s87
    s_lshl_b32 s86, s86, 1
    s_add_u32 s86, s86, s60
    s_lshl_b32 s86, s86, 1
    s_and_b32 s87, s48, 1
    s_add_u32 s86, s86, s87
    s_lshl_b32 s86, s86, 7
    s_add_u32 s86, s86, 688128
    v_lshl_add_u32 v159, v0, 2, s86
    v_mov_b32 v38, 2147483648
    v_cmp_gt_u32 vcc, 16, v0
    s_nop 1
    v_cndmask_b32 v159, v38, v159, vcc
    v_bfe_u32 v38, v0, 2, 2
    v_lshl_add_u32 v38, v36, 2, v38
    v_bfe_u32 v39, v38, 1, 2
    v_lshlrev_b32 v38, 7, v38
    v_lshl_add_u32 v38, v39, 5, v38
    v_and_b32 v39, 3, v0
    v_lshl_add_u32 v38, v39, 3, v38
    s_lshl_b32 s86, s60, 16
    s_add_u32 s86, s86, 0
    v_add_u32 v144, s86, v38
    v_xor_b32 v145, 32, v144
    v_xor_b32 v146, 64, v144
    v_xor_b32 v147, 96, v144
    v_cmp_eq_u32 s[4:5], 1, v39
    v_cmp_eq_u32 s[6:7], 2, v39
    v_cmp_eq_u32 s[98:99], 3, v39
    s_lshl_b32 s86, s69, 10
    s_add_u32 s86, s86, 786432
    v_lshl_add_u32 v160, v0, 2, s86
    v_mul_u32_u24 v161, 192, v36
    v_add_u32 v160, v160, v161
    s_mov_b32 s72, 0x00f0000f
    s_mov_b32 s73, 0xf0000f00
    s_mov_b32 s74, 0x000ff000
    s_mov_b32 s75, 0x0f0000f0
    v_lshrrev_b32 v38, 2, v37
    v_lshl_add_u32 v161, v38, 4, v37
    v_lshlrev_b32 v161, 2, v161
    s_lshl_b32 s86, s3, 12
    s_add_u32 s86, s86, 131072
    v_lshl_add_u32 v162, v0, 4, s86
    v_xor_b32 v163, 0x4000, v162
    s_lshl_b32 s86, s52, 7
    v_lshl_add_u32 v36, v36, 3, s86
    s_lshl_b32 s87, s69, 15
    s_add_u32 s87, s87, s86
    s_lshl_b32 s86, s60, 6
    s_add_u32 s87, s87, s86
    v_lshl_add_u32 v39, v37, 11, s87
    v_and_b32 v38, 48, v0
    v_add_u32 v39, v39, v38
    v_xor_b32 v37, 0x8000, v39
    v_lshlrev_b32 v38, 4, v0
    s_waitcnt vmcnt(19)
    s_barrier
    v_mov_b32 v118, 0
    buffer_atomic_or v118, v117, s[16:19], 0 offen sc0 sc1
    s_add_u32 m0, s62, 139264
    s_nop 0
    buffer_load_dwordx4 v10, s[12:15], s91 offen offset:0 lds
    buffer_load_dwordx4 v11, s[12:15], s91 offen offset:1024 lds
    s_add_u32 m0, s53, 0
    s_lshl_b32 s70, s64, 7
    s_add_u32 s70, s70, s63
    buffer_load_dwordx4 v2, s[8:11], s70 offen offset:0 lds
    buffer_load_dwordx4 v3, s[8:11], s70 offen offset:1024 lds
    buffer_load_dwordx4 v4, s[8:11], s70 offen offset:2048 lds
    buffer_load_dwordx4 v5, s[8:11], s70 offen offset:3072 lds
    s_mul_i32 s91, s64, 393216
    s_add_u32 s64, s64, 1
    s_and_b32 s64, s64, 15
    s_add_u32 m0, s62, 0
    s_nop 0
    buffer_load_dwordx4 v6, s[12:15], s91 offen offset:0 lds
    buffer_load_dwordx4 v7, s[12:15], s91 offen offset:1024 lds
    s_add_u32 m0, s62, 8192
    s_nop 0
    buffer_load_dwordx4 v8, s[12:15], s91 offen offset:0 lds
    buffer_load_dwordx4 v9, s[12:15], s91 offen offset:1024 lds
    s_add_u32 m0, s62, 16384
    s_nop 0
    buffer_load_dwordx4 v10, s[12:15], s91 offen offset:0 lds
    buffer_load_dwordx4 v11, s[12:15], s91 offen offset:1024 lds
    s_waitcnt vmcnt(21)
    s_barrier
    s_waitcnt vmcnt(12)
    s_branch L_h0_chk0
L_h0_spin:
    v_mov_b32 v118, 0
    buffer_atomic_or v118, v117, s[16:19], 0 offen sc0 sc1
    s_waitcnt vmcnt(0)
L_h0_chk0:
    v_cmp_ne_u32 vcc, s68, v118
    s_nop 0
    s_and_b64 vcc, vcc, s[76:77]
    s_cbranch_vccz L_ok_1
    s_sub_u32 s56, s56, 1
    s_cbranch_scc0 L_h0_spin
    s_mov_b32 s56, 0
L_ok_1:
    buffer_load_dwordx4 v[56:59], v33, s[16:19], 0 offen sc1
    buffer_load_dwordx4 v[60:63], v33, s[16:19], s92 offen sc1
    buffer_load_dwordx4 v[64:67], v33, s[16:19], s93 offen sc1
    buffer_load_dwordx4 v[68:71], v33, s[16:19], s94 offen sc1
    buffer_load_dwordx4 v[40:43], v32, s[16:19], 0 offen offset:0 sc1
    buffer_load_dwordx4 v[44:47], v32, s[16:19], 0 offen offset:3072 sc1
    buffer_load_dwordx4 v[48:51], v32, s[16:19], s92 offen offset:2048 sc1
    buffer_load_dwordx4 v[52:55], v32, s[16:19], s93 offen offset:1024 sc1
    v_cmp_eq_u32 vcc, s83, v121
    s_nop 0
    s_cmp_eq_u32 vcc_lo, -1
    s_cselect_b32 s83, 1, 0
    s_mov_b32 s90, 0
    buffer_load_dwordx4 v[164:167], v30, s[32:35], s90 offen
    s_mov_b32 s90, 7168
    buffer_load_dwordx4 v[168:171], v30, s[32:35], s90 offen
    s_mov_b32 s90, 14336
    buffer_load_dwordx4 v[172:175], v30, s[32:35], s90 offen
    s_mov_b32 s90, 21504
    buffer_load_dwordx4 v[176:179], v30, s[32:35], s90 offen
    s_waitcnt vmcnt(22)
    s_barrier
    s_add_u32 m0, s89, 40960
    s_mov_b32 s90, 655360
    buffer_load_dwordx4 v12, s[20:23], s90 offen lds
    s_add_u32 m0, s89, 45056
    s_mov_b32 s90, 720896
    buffer_load_dwordx4 v12, s[20:23], s90 offen lds
    s_add_u32 m0, s89, 49152
    s_mov_b32 s90, 786432
    buffer_load_dwordx4 v12, s[20:23], s90 offen lds
    s_add_u32 m0, s89, 53248
    s_mov_b32 s90, 851968
    buffer_load_dwordx4 v12, s[20:23], s90 offen lds
    s_mov_b32 s90, 28672
    buffer_load_dwordx4 v[180:183], v30, s[32:35], s90 offen
    s_mov_b32 s90, 35840
    buffer_load_dwordx4 v[184:187], v30, s[32:35], s90 offen
    s_mov_b32 s90, 43008
    buffer_load_dwordx4 v[188:191], v30, s[32:35], s90 offen
L_walk_5:
    s_cbranch_execz L_walk_9
    s_waitcnt vmcnt(11)
    v_add_f32 v40, v40, v44
    v_add_f32 v41, v41, v45
    v_add_f32 v42, v42, v46
    v_add_f32 v43, v43, v47
    v_add_f32 v40, v40, v48
    v_add_f32 v41, v41, v49
    v_add_f32 v42, v42, v50
    v_add_f32 v43, v43, v51
    v_add_f32 v40, v40, v52
    v_add_f32 v41, v41, v53
    v_add_f32 v42, v42, v54
    v_add_f32 v43, v43, v55
    v_add_f32 v56, v56, v60
    v_add_f32 v57, v57, v61
    v_add_f32 v58, v58, v62
    v_add_f32 v59, v59, v63
    v_add_f32 v56, v56, v64
    v_add_f32 v57, v57, v65
    v_add_f32 v58, v58, v66
    v_add_f32 v59, v59, v67
    v_add_f32 v56, v56, v68
    v_add_f32 v57, v57, v69
    v_add_f32 v58, v58, v70
    v_add_f32 v59, v59, v71
    s_nop 0
    v_permlane32_swap_b32 v56, v58
    v_permlane32_swap_b32 v57, v59
    v_permlane32_swap_b32 v40, v42
    v_permlane32_swap_b32 v41, v43
    v_add_f32 v56, v56, v58
    v_add_f32 v57, v57, v59
    v_add_f32 v40, v40, v42
    v_add_f32 v41, v41, v43
    v_mov_b32 v58, v56
    v_mov_b32 v59, v57
    v_permlane16_swap_b32 v40, v41
    v_permlane16_swap_b32 v56, v58
    v_permlane16_swap_b32 v57, v59
    v_add_f32 v40, v40, v41
    v_add_f32 v56, v56, v58
    v_add_f32 v57, v57, v59
    v_mul_f32 v56, 0x3a800000, v56
    v_mul_f32 v57, 0x3a800000, v57
    v_fma_f32 v57, -v56, v56, v57
    v_max_f32 v57, 0, v57
    v_cvt_pk_bf16_f32 v48, v56, v57
    v_lshlrev_b32 v44, 16, v48
    v_and_b32 v48, 0xffff0000, v48
    v_add_f32 v48, 0x3727c5ac, v48
    v_cvt_pk_bf16_f32 v48, v48, v48
    v_lshlrev_b32 v48, 16, v48
    v_sqrt_f32 v48, v48
    s_nop 0
    v_cvt_pk_bf16_f32 v48, v48, v48
    v_lshlrev_b32 v48, 16, v48
    v_rcp_f32 v46, v48
    v_sub_f32 v44, 0, v44
    v_mul_f32 v48, 0x3fb8aa3b, v46
    s_waitcnt vmcnt(19)
    s_barrier
    v_mov_b32 v24, 135168
    v_lshl_add_u32 v24, v21, 2, v24
    v_mov_b32 v25, 0
    ds_write_b32 v24, v25
    ds_write_b32 v24, v25 offset:28608
    ds_write_b32 v17, v40
    ds_write_b32 v16, v44
    ds_write_b32 v16, v46 offset:512
    ds_write_b32 v16, v48 offset:1024
    s_waitcnt lgkmcnt(0)
    s_add_u32 m0, s89, 57344
    s_mov_b32 s90, 917504
    buffer_load_dwordx4 v12, s[20:23], s90 offen lds
    s_add_u32 m0, s89, 61440
    s_mov_b32 s90, 983040
    buffer_load_dwordx4 v12, s[20:23], s90 offen lds
    s_add_u32 m0, s89, 65536
    s_mov_b32 s90, 1048576
    buffer_load_dwordx4 v12, s[20:23], s90 offen lds
    s_add_u32 m0, s89, 69632
    s_mov_b32 s90, 1114112
    buffer_load_dwordx4 v12, s[20:23], s90 offen lds
    s_add_u32 m0, s89, 73728
    s_mov_b32 s90, 1179648
    buffer_load_dwordx4 v12, s[20:23], s90 offen lds
    s_add_u32 m0, s89, 77824
    s_mov_b32 s90, 1245184
    buffer_load_dwordx4 v12, s[20:23], s90 offen lds
    s_barrier
    s_setprio 0
    s_add_u32 m0, s89, 81920
    s_mov_b32 s90, 1310720
    buffer_load_dwordx4 v12, s[20:23], s90 offen lds
    s_add_u32 m0, s89, 86016
    s_mov_b32 s90, 1376256
    buffer_load_dwordx4 v12, s[20:23], s90 offen lds
    s_add_u32 m0, s89, 90112
    s_mov_b32 s90, 1441792
    buffer_load_dwordx4 v12, s[20:23], s90 offen lds
    s_add_u32 m0, s89, 94208
    s_mov_b32 s90, 1507328
    buffer_load_dwordx4 v12, s[20:23], s90 offen lds
    s_add_u32 m0, s89, 98304
    s_mov_b32 s90, 1572864
    buffer_load_dwordx4 v12, s[20:23], s90 offen lds
    s_add_u32 m0, s89, 102400
    s_mov_b32 s90, 1638400
    buffer_load_dwordx4 v12, s[20:23], s90 offen lds
    s_add_u32 m0, s89, 0
    s_mov_b32 s90, 0
    buffer_load_dwordx4 v12, s[20:23], s90 offen lds
    s_add_u32 m0, s89, 4096
    s_mov_b32 s90, 65536
    buffer_load_dwordx4 v12, s[20:23], s90 offen lds
    s_add_u32 m0, s89, 8192
    s_mov_b32 s90, 131072
    buffer_load_dwordx4 v12, s[20:23], s90 offen lds
    s_add_u32 m0, s89, 12288
    s_mov_b32 s90, 196608
    buffer_load_dwordx4 v12, s[20:23], s90 offen lds
    s_add_u32 m0, s89, 16384
    s_mov_b32 s90, 262144
    buffer_load_dwordx4 v12, s[20:23], s90 offen lds
    s_add_u32 m0, s89, 20480
    s_mov_b32 s90, 327680
    buffer_load_dwordx4 v12, s[20:23], s90 offen lds
    s_add_u32 m0, s89, 24576
    s_mov_b32 s90, 393216
    buffer_load_dwordx4 v12, s[20:23], s90 offen lds
    s_add_u32 m0, s89, 28672
    s_mov_b32 s90, 458752
    buffer_load_dwordx4 v12, s[20:23], s90 offen lds
    s_add_u32 m0, s89, 32768
    s_mov_b32 s90, 524288
    buffer_load_dwordx4 v12, s[20:23], s90 offen lds
    s_add_u32 m0, s89, 36864
    s_mov_b32 s90, 589824
    buffer_load_dwordx4 v12, s[20:23], s90 offen lds
    s_lshl_b32 s86, s47, 2
    s_add_u32 s86, s86, s48
    s_lshl_b32 s87, s86, 7
    s_add_u32 s87, s87, 671744
    v_lshl_add_u32 v6, v0, 2, s87
    v_mov_b32 v4, 2147483648
    v_cmp_gt_u32 vcc, 16, v0
    s_nop 1
    v_cndmask_b32 v6, v4, v6, vcc
    s_lshl_b32 s86, s86, 14
    s_add_u32 s86, s86, 5242880
    v_lshl_add_u32 v2, v0, 4, s86
    s_lshl_b32 s86, s47, 1
    s_add_u32 s86, s86, s50
    s_lshl_b32 s86, s86, 11
    s_lshl_b32 s87, s49, 10
    s_add_u32 s86, s86, s87
    s_add_u32 s86, s86, 6881280
    v_lshl_add_u32 v3, v23, 6, s86
    v_lshl_add_u32 v3, v22, 4, v3
    v_mov_b32 v112, 0
    v_mov_b32 v113, 0
    v_mov_b32 v114, 0
    v_mov_b32 v115, 0
    v_mov_b32 v116, 0
    v_mov_b32 v117, 0
    v_mov_b32 v118, 0
    v_mov_b32 v119, 0
    s_mov_b32 s53, s69
    s_mov_b32 s62, s60
    buffer_load_dwordx2 v[148:149], v36, s[40:43], 0 offen offset:0
    buffer_load_dwordx2 v[150:151], v36, s[40:43], 0 offen offset:32
    buffer_load_dwordx2 v[152:153], v36, s[40:43], 0 offen offset:64
L_walk_6:
    s_cbranch_execz L_walk_13
    buffer_load_dwordx2 v[154:155], v36, s[40:43], 0 offen offset:96
    buffer_load_dwordx4 v[128:131], v38, s[40:43], 0 offen
    buffer_load_dwordx4 v[132:135], v38, s[40:43], 0 offen offset:1024
    buffer_load_dwordx4 v[136:139], v39, s[8:11], 0 offen
    buffer_load_dwordx4 v[140:143], v37, s[8:11], 0 offen
    s_mov_b32 s90, 50176
    buffer_load_dwordx4 v[192:195], v30, s[32:35], s90 offen
    s_mov_b32 s90, 57344
    buffer_load_dwordx4 v[196:199], v30, s[32:35], s90 offen
    s_mov_b32 s90, 64512
    buffer_load_dwordx4 v[200:203], v30, s[32:35], s90 offen
    s_waitcnt vmcnt(5)
    v_mov_b32 v4, 0
    buffer_atomic_or v4, v6, s[16:19], 0 offen sc0 sc1
    v_bfe_u32 v36, v0, 2, 1
    v_cmp_eq_u32 vcc, 1, v36
    v_mov_b32 v36, s95
    v_mov_b32 v38, 0
    v_dot2c_f32_bf16 v38, s95, v128
    v_dot2c_f32_bf16 v38, s95, v129
    v_dot2c_f32_bf16 v38, s95, v130
    v_dot2c_f32_bf16 v38, s95, v131
    v_dot2c_f32_bf16 v38, s95, v132
    v_dot2c_f32_bf16 v38, s95, v133
    v_dot2c_f32_bf16 v38, s95, v134
    v_dot2c_f32_bf16 v38, s95, v135
    v_cndmask_b32 v148, v36, v148, vcc
    v_cndmask_b32 v149, v36, v149, vcc
    v_cndmask_b32 v150, v36, v150, vcc
    v_cndmask_b32 v151, v36, v151, vcc
    v_cndmask_b32 v152, v36, v152, vcc
    v_cndmask_b32 v153, v36, v153, vcc
    v_cndmask_b32 v154, v36, v154, vcc
    v_cndmask_b32 v155, v36, v155, vcc
    v_add_f32_dpp v38, v38, v38 row_ror:8 row_mask:0xf bank_mask:0xf
    s_nop 1
    v_add_f32_dpp v38, v38, v38 row_ror:4 row_mask:0xf bank_mask:0xf
    s_nop 1
    v_add_f32_dpp v38, v38, v38 row_ror:2 row_mask:0xf bank_mask:0xf
    s_nop 1
    v_add_f32_dpp v38, v38, v38 row_ror:1 row_mask:0xf bank_mask:0xf
    v_mov_b32 v36, v38
    s_nop 1
    v_permlane32_swap_b32 v38, v36
    v_add_f32 v38, v38, v36
    v_mov_b32 v36, v38
    s_nop 1
    v_permlane16_swap_b32 v38, v36
    v_add_f32 v38, v38, v36
    v_mov_b32 v36, 135200
    v_readfirstlane_b32 s57, v38
    ds_write_b32 v36, v38
    s_mul_i32 s86, s50, 3072
    s_add_u32 s86, s86, 151552
    v_lshl_add_u32 v7, v0, 4, s86
    s_lshl_b32 s86, s49, 10
    v_add_u32 v5, s86, v7
    s_lshl_b32 s86, s49, 3
    v_add_u32 v7, s86, v7
    s_mov_b32 s88, 0xffff0000
    s_mov_b32 s86, 0x00003f80
    s_mov_b32 s87, 0x3f800000
    s_branch L_h1_w0
L_h1_r0:
    s_ff1_i32_b32 s66, s65
    s_bitset0_b32 s65, s66
    s_lshl_b32 s66, s66, 10
    buffer_load_dwordx4 v[40:43], v2, s[16:19], s66 offen sc1
    s_cmp_eq_u32 s65, 0
    s_cbranch_scc1 L_h1_p1
L_h1_r1:
    s_ff1_i32_b32 s66, s65
    s_bitset0_b32 s65, s66
    s_lshl_b32 s66, s66, 10
    buffer_load_dwordx4 v[44:47], v2, s[16:19], s66 offen sc1
    s_cmp_eq_u32 s65, 0
    s_cbranch_scc1 L_h1_p2
L_h1_r2:
    s_ff1_i32_b32 s66, s65
    s_bitset0_b32 s65, s66
    s_lshl_b32 s66, s66, 10
    buffer_load_dwordx4 v[48:51], v2, s[16:19], s66 offen sc1
    s_cmp_eq_u32 s65, 0
    s_cbranch_scc1 L_h1_p3
L_h1_r3:
    s_ff1_i32_b32 s66, s65
    s_bitset0_b32 s65, s66
    s_lshl_b32 s66, s66, 10
    buffer_load_dwordx4 v[52:55], v2, s[16:19], s66 offen sc1
    s_cmp_eq_u32 s65, 0
    s_cbranch_scc1 L_h1_p4
L_h1_r4:
    s_ff1_i32_b32 s66, s65
    s_bitset0_b32 s65, s66
    s_lshl_b32 s66, s66, 10
    buffer_load_dwordx4 v[56:59], v2, s[16:19], s66 offen sc1
    s_cmp_eq_u32 s65, 0
    s_cbranch_scc1 L_h1_p5
L_h1_r5:
    s_ff1_i32_b32 s66, s65
    s_bitset0_b32 s65, s66
    s_lshl_b32 s66, s66, 10
    buffer_load_dwordx4 v[60:63], v2, s[16:19], s66 offen sc1
    s_cmp_eq_u32 s65, 0
    s_cbranch_scc1 L_h1_p6
L_h1_r6:
    s_ff1_i32_b32 s66, s65
    s_bitset0_b32 s65, s66
    s_lshl_b32 s66, s66, 10
    buffer_load_dwordx4 v[64:67], v2, s[16:19], s66 offen sc1
    s_cmp_eq_u32 s65, 0
    s_cbranch_scc1 L_h1_p7
L_h1_r7:
    s_ff1_i32_b32 s66, s65
    s_bitset0_b32 s65, s66
    s_lshl_b32 s66, s66, 10
    buffer_load_dwordx4 v[68:71], v2, s[16:19], s66 offen sc1
    s_cmp_eq_u32 s65, 0
    s_cbranch_scc1 L_h1_p8
L_h1_r8:
    s_ff1_i32_b32 s66, s65
    s_bitset0_b32 s65, s66
    s_lshl_b32 s66, s66, 10
    buffer_load_dwordx4 v[72:75], v2, s[16:19], s66 offen sc1
    s_cmp_eq_u32 s65, 0
    s_cbranch_scc1 L_h1_p9
L_h1_r9:
    s_ff1_i32_b32 s66, s65
    s_bitset0_b32 s65, s66
    s_lshl_b32 s66, s66, 10
    buffer_load_dwordx4 v[76:79], v2, s[16:19], s66 offen sc1
    s_cmp_eq_u32 s65, 0
    s_cbranch_scc1 L_h1_p10
L_h1_r10:
    s_ff1_i32_b32 s66, s65
    s_bitset0_b32 s65, s66
    s_lshl_b32 s66, s66, 10
    buffer_load_dwordx4 v[80:83], v2, s[16:19], s66 offen sc1
    s_cmp_eq_u32 s65, 0
    s_cbranch_scc1 L_h1_p11
L_h1_r11:
    s_ff1_i32_b32 s66, s65
    s_bitset0_b32 s65, s66
    s_lshl_b32 s66, s66, 10
    buffer_load_dwordx4 v[84:87], v2, s[16:19], s66 offen sc1
    s_cmp_eq_u32 s65, 0
    s_cbranch_scc1 L_h1_p12
L_h1_r12:
    s_ff1_i32_b32 s66, s65
    s_bitset0_b32 s65, s66
    s_lshl_b32 s66, s66, 10
    buffer_load_dwordx4 v[88:91], v2, s[16:19], s66 offen sc1
    s_cmp_eq_u32 s65, 0
    s_cbranch_scc1 L_h1_p13
L_h1_r13:
    s_ff1_i32_b32 s66, s65
    s_bitset0_b32 s65, s66
    s_lshl_b32 s66, s66, 10
    buffer_load_dwordx4 v[92:95], v2, s[16:19], s66 offen sc1
    s_cmp_eq_u32 s65, 0
    s_cbranch_scc1 L_h1_p14
L_h1_r14:
    s_ff1_i32_b32 s76, s65
    s_bitset0_b32 s65, s76
    s_lshl_b32 s76, s76, 10
    buffer_load_dwordx4 v[96:99], v2, s[16:19], s76 offen sc1
    s_cmp_eq_u32 s65, 0
    s_cbranch_scc1 L_h1_p15
L_h1_r15:
    s_ff1_i32_b32 s77, s65
    s_bitset0_b32 s65, s77
    s_lshl_b32 s77, s77, 10
    buffer_load_dwordx4 v[100:103], v2, s[16:19], s77 offen sc1
    buffer_load_dwordx4 v[104:107], v3, s[16:19], 0 offen sc1
L_h1_acc:
    s_waitcnt vmcnt(16)
    v_dot2c_f32_bf16 v112, s86, v40
    v_dot2c_f32_bf16 v113, s87, v40
    v_dot2c_f32_bf16 v114, s86, v41
    v_dot2c_f32_bf16 v115, s87, v41
    v_dot2c_f32_bf16 v116, s86, v42
    v_dot2c_f32_bf16 v117, s87, v42
    v_dot2c_f32_bf16 v118, s86, v43
    v_dot2c_f32_bf16 v119, s87, v43
    s_waitcnt vmcnt(15)
    v_dot2c_f32_bf16 v112, s86, v44
    v_dot2c_f32_bf16 v113, s87, v44
    v_dot2c_f32_bf16 v114, s86, v45
    v_dot2c_f32_bf16 v115, s87, v45
    v_dot2c_f32_bf16 v116, s86, v46
    v_dot2c_f32_bf16 v117, s87, v46
    v_dot2c_f32_bf16 v118, s86, v47
    v_dot2c_f32_bf16 v119, s87, v47
    s_waitcnt vmcnt(14)
    v_dot2c_f32_bf16 v112, s86, v48
    v_dot2c_f32_bf16 v113, s87, v48
    v_dot2c_f32_bf16 v114, s86, v49
    v_dot2c_f32_bf16 v115, s87, v49
    v_dot2c_f32_bf16 v116, s86, v50
    v_dot2c_f32_bf16 v117, s87, v50
    v_dot2c_f32_bf16 v118, s86, v51
    v_dot2c_f32_bf16 v119, s87, v51
    v_max3_u32 v4, v43, v47, v51
    s_waitcnt vmcnt(13)
    v_dot2c_f32_bf16 v112, s86, v52
    v_dot2c_f32_bf16 v113, s87, v52
    v_dot2c_f32_bf16 v114, s86, v53
    v_dot2c_f32_bf16 v115, s87, v53
    v_dot2c_f32_bf16 v116, s86, v54
    v_dot2c_f32_bf16 v117, s87, v54
    v_dot2c_f32_bf16 v118, s86, v55
    v_dot2c_f32_bf16 v119, s87, v55
    s_waitcnt vmcnt(12)
    v_dot2c_f32_bf16 v112, s86, v56
    v_dot2c_f32_bf16 v113, s87, v56
    v_dot2c_f32_bf16 v114, s86, v57
    v_dot2c_f32_bf16 v115, s87, v57
    v_dot2c_f32_bf16 v116, s86, v58
    v_dot2c_f32_bf16 v117, s87, v58
    v_dot2c_f32_bf16 v118, s86, v59
    v_dot2c_f32_bf16 v119, s87, v59
    v_max3_u32 v4, v4, v55, v59
    s_waitcnt vmcnt(11)
    v_dot2c_f32_bf16 v112, s86, v60
    v_dot2c_f32_bf16 v113, s87, v60
    v_dot2c_f32_bf16 v114, s86, v61
    v_dot2c_f32_bf16 v115, s87, v61
    v_dot2c_f32_bf16 v116, s86, v62
    v_dot2c_f32_bf16 v117, s87, v62
    v_dot2c_f32_bf16 v118, s86, v63
    v_dot2c_f32_bf16 v119, s87, v63
    s_waitcnt vmcnt(10)
    v_dot2c_f32_bf16 v112, s86, v64
    v_dot2c_f32_bf16 v113, s87, v64
    v_dot2c_f32_bf16 v114, s86, v65
    v_dot2c_f32_bf16 v115, s87, v65
    v_dot2c_f32_bf16 v116, s86, v66
    v_dot2c_f32_bf16 v117, s87, v66
    v_dot2c_f32_bf16 v118, s86, v67
    v_dot2c_f32_bf16 v119, s87, v67
    v_max3_u32 v4, v4, v63, v67
    s_waitcnt vmcnt(9)
    v_dot2c_f32_bf16 v112, s86, v68
    v_dot2c_f32_bf16 v113, s87, v68
    v_dot2c_f32_bf16 v114, s86, v69
    v_dot2c_f32_bf16 v115, s87, v69
    v_dot2c_f32_bf16 v116, s86, v70
    v_dot2c_f32_bf16 v117, s87, v70
    v_dot2c_f32_bf16 v118, s86, v71
    v_dot2c_f32_bf16 v119, s87, v71
L_walk_7:
    s_cbranch_execz L_walk_14
    s_waitcnt vmcnt(8)
    v_dot2c_f32_bf16 v112, s86, v72
    v_dot2c_f32_bf16 v113, s87, v72
    v_dot2c_f32_bf16 v114, s86, v73
    v_dot2c_f32_bf16 v115, s87, v73
    v_dot2c_f32_bf16 v116, s86, v74
    v_dot2c_f32_bf16 v117, s87, v74
    v_dot2c_f32_bf16 v118, s86, v75
    v_dot2c_f32_bf16 v119, s87, v75
    v_max3_u32 v4, v4, v71, v75
    s_waitcnt vmcnt(7)
    v_dot2c_f32_bf16 v112, s86, v76
    v_dot2c_f32_bf16 v113, s87, v76
    v_dot2c_f32_bf16 v114, s86, v77
    v_dot2c_f32_bf16 v115, s87, v77
    v_dot2c_f32_bf16 v116, s86, v78
    v_dot2c_f32_bf16 v117, s87, v78
    v_dot2c_f32_bf16 v118, s86, v79
    v_dot2c_f32_bf16 v119, s87, v79
    s_waitcnt vmcnt(6)
    v_dot2c_f32_bf16 v112, s86, v80
    v_dot2c_f32_bf16 v113, s87, v80
    v_dot2c_f32_bf16 v114, s86, v81
    v_dot2c_f32_bf16 v115, s87, v81
    v_dot2c_f32_bf16 v116, s86, v82
    v_dot2c_f32_bf16 v117, s87, v82
    v_dot2c_f32_bf16 v118, s86, v83
    v_dot2c_f32_bf16 v119, s87, v83
    v_max3_u32 v4, v4, v79, v83
    s_waitcnt vmcnt(5)
    v_dot2c_f32_bf16 v112, s86, v84
    v_dot2c_f32_bf16 v113, s87, v84
    v_dot2c_f32_bf16 v114, s86, v85
    v_dot2c_f32_bf16 v115, s87, v85
    v_dot2c_f32_bf16 v116, s86, v86
    v_dot2c_f32_bf16 v117, s87, v86
    v_dot2c_f32_bf16 v118, s86, v87
    v_dot2c_f32_bf16 v119, s87, v87
    s_waitcnt vmcnt(4)
    v_dot2c_f32_bf16 v112, s86, v88
    v_dot2c_f32_bf16 v113, s87, v88
    v_dot2c_f32_bf16 v114, s86, v89
    v_dot2c_f32_bf16 v115, s87, v89
    v_dot2c_f32_bf16 v116, s86, v90
    v_dot2c_f32_bf16 v117, s87, v90
    v_dot2c_f32_bf16 v118, s86, v91
    v_dot2c_f32_bf16 v119, s87, v91
    v_max3_u32 v4, v4, v87, v91
    s_waitcnt vmcnt(3)
    v_dot2c_f32_bf16 v112, s86, v92
    v_dot2c_f32_bf16 v113, s87, v92
    v_dot2c_f32_bf16 v114, s86, v93
    v_dot2c_f32_bf16 v115, s87, v93
    v_dot2c_f32_bf16 v116, s86, v94
    v_dot2c_f32_bf16 v117, s87, v94
    v_dot2c_f32_bf16 v118, s86, v95
    v_dot2c_f32_bf16 v119, s87, v95
    v_max_u32 v4, v4, v95
L_h1_chk:
    s_waitcnt vmcnt(0)
    v_max3_u32 v8, v4, v99, v103
    v_max3_u32 v8, v8, v107, v107
    v_cmp_eq_u32 vcc, -1, v8
    s_cbranch_vccnz L_h1_again
L_h1_ok:
    s_add_u32 m0, s89, 106496
    s_mov_b32 s90, 1703936
    buffer_load_dwordx4 v12, s[20:23], s90 offen lds
    s_add_u32 m0, s89, 110592
    s_mov_b32 s90, 1769472
    buffer_load_dwordx4 v12, s[20:23], s90 offen lds
    s_add_u32 m0, s89, 114688
    s_mov_b32 s90, 1835008
    buffer_load_dwordx4 v12, s[20:23], s90 offen lds
    s_add_u32 m0, s89, 118784
    s_mov_b32 s90, 1900544
    buffer_load_dwordx4 v12, s[20:23], s90 offen lds
    s_add_u32 m0, s89, 122880
    s_mov_b32 s90, 1966080
    buffer_load_dwordx4 v12, s[20:23], s90 offen lds
    s_add_u32 m0, s89, 126976
    s_mov_b32 s90, 2031616
    buffer_load_dwordx4 v12, s[20:23], s90 offen lds
    v_dot2c_f32_bf16 v112, s86, v96
    v_dot2c_f32_bf16 v113, s87, v96
    v_dot2c_f32_bf16 v114, s86, v97
    v_dot2c_f32_bf16 v115, s87, v97
    v_dot2c_f32_bf16 v116, s86, v98
    v_dot2c_f32_bf16 v117, s87, v98
    v_dot2c_f32_bf16 v118, s86, v99
    v_dot2c_f32_bf16 v119, s87, v99
    v_dot2c_f32_bf16 v112, s86, v100
    v_dot2c_f32_bf16 v113, s87, v100
    v_dot2c_f32_bf16 v114, s86, v101
    v_dot2c_f32_bf16 v115, s87, v101
    v_dot2c_f32_bf16 v116, s86, v102
    v_dot2c_f32_bf16 v117, s87, v102
    v_dot2c_f32_bf16 v118, s86, v103
    v_dot2c_f32_bf16 v119, s87, v103
    v_add_f32_dpp v104, v104, v104 row_ror:8 row_mask:0xf bank_mask:0xf
    v_add_f32_dpp v105, v105, v105 row_ror:8 row_mask:0xf bank_mask:0xf
    v_add_f32_dpp v106, v106, v106 row_ror:8 row_mask:0xf bank_mask:0xf
    v_add_f32_dpp v107, v107, v107 row_ror:8 row_mask:0xf bank_mask:0xf
    v_cvt_pk_bf16_f32 v120, v112, v113
    v_cvt_pk_bf16_f32 v121, v114, v115
    v_cvt_pk_bf16_f32 v122, v116, v117
    v_cvt_pk_bf16_f32 v123, v118, v119
    ds_write_b128 v5, v[120:123]
    v_add_f32_dpp v104, v104, v104 row_ror:4 row_mask:0xf bank_mask:0xf
    v_add_f32_dpp v105, v105, v105 row_ror:4 row_mask:0xf bank_mask:0xf
    v_add_f32_dpp v106, v106, v106 row_ror:4 row_mask:0xf bank_mask:0xf
    v_add_f32_dpp v107, v107, v107 row_ror:4 row_mask:0xf bank_mask:0xf
    v_add_f32_dpp v104, v104, v104 row_ror:2 row_mask:0xf bank_mask:0xf
    v_add_f32_dpp v105, v105, v105 row_ror:2 row_mask:0xf bank_mask:0xf
    v_add_f32_dpp v106, v106, v106 row_ror:2 row_mask:0xf bank_mask:0xf
    v_add_f32_dpp v107, v107, v107 row_ror:2 row_mask:0xf bank_mask:0xf
    v_add_f32_dpp v104, v104, v104 row_ror:1 row_mask:0xf bank_mask:0xf
    v_add_f32_dpp v105, v105, v105 row_ror:1 row_mask:0xf bank_mask:0xf
    v_add_f32_dpp v106, v106, v106 row_ror:1 row_mask:0xf bank_mask:0xf
    v_add_f32_dpp v107, v107, v107 row_ror:1 row_mask:0xf bank_mask:0xf
    v_cvt_pk_bf16_f32 v124, v104, v105
    v_cvt_pk_bf16_f32 v125, v106, v107
    ds_write_b64 v7, v[124:125] offset:2048
L_h1_done:
    s_waitcnt lgkmcnt(0)
    s_barrier
    s_or_b32 s86, s2, s48
    s_cmp_eq_u32 s86, 0
    s_cselect_b32 s86, 0, 2147483648
    s_add_u32 s86, s86, 524288
    v_mov_b32 v6, s86
    buffer_store_dword v35, v6, s[16:19], 0 offen sc1
    v_mov_b32 v11, v30
    v_mov_b32 v14, v31
    v_mov_b32 v8, 0
    buffer_atomic_or v8, v159, s[16:19], 0 offen sc0 sc1
    s_branch L_phaseB
L_h1_p0:
L_h1_w0:
    s_waitcnt vmcnt(0)
    v_cmp_eq_u32 vcc, s68, v4
    s_nop 0
    s_andn2_b32 s65, vcc_lo, s88
    s_or_b32 s88, s88, s65
    s_bcnt0_i32_b32 s90, s88
    s_cmp_le_u32 s90, 2
    s_cbranch_scc1 L_h1_r0
    v_mov_b32 v4, 0
    buffer_atomic_or v4, v6, s[16:19], 0 offen sc0 sc1
    s_mov_b32 s67, 0
    s_cmp_lg_u32 s65, 0
    s_cbranch_scc1 L_h1_r0
    s_sub_u32 s56, s56, 1
    s_cbranch_scc0 L_h1_p0
    s_mov_b32 s56, 0
    s_not_b32 s65, s88
    s_branch L_h1_r0
L_h1_p1:
    s_waitcnt vmcnt(1)
    s_cmp_eq_u32 s67, 0
    s_cbranch_scc1 L_h1_s1
    s_waitcnt vmcnt(0)
L_h1_s1:
    v_cmp_eq_u32 vcc, s68, v4
    s_nop 0
    s_andn2_b32 s65, vcc_lo, s88
    s_or_b32 s88, s88, s65
    s_bcnt0_i32_b32 s90, s88
    s_cmp_le_u32 s90, 2
    s_cbranch_scc1 L_h1_r1
    v_mov_b32 v4, 0
    buffer_atomic_or v4, v6, s[16:19], 0 offen sc0 sc1
    s_mov_b32 s67, 1
    s_cmp_lg_u32 s65, 0
    s_cbranch_scc1 L_h1_r1
    s_sub_u32 s56, s56, 1
    s_cbranch_scc0 L_h1_p1
    s_mov_b32 s56, 0
    s_not_b32 s65, s88
    s_branch L_h1_r1
L_h1_p2:
    s_waitcnt vmcnt(2)
    s_cmp_eq_u32 s67, 0
    s_cbranch_scc1 L_h1_s2
    s_waitcnt vmcnt(0)
L_h1_s2:
    v_cmp_eq_u32 vcc, s68, v4
    s_nop 0
    s_andn2_b32 s65, vcc_lo, s88
    s_or_b32 s88, s88, s65
    s_bcnt0_i32_b32 s90, s88
    s_cmp_le_u32 s90, 2
    s_cbranch_scc1 L_h1_r2
    v_mov_b32 v4, 0
    buffer_atomic_or v4, v6, s[16:19], 0 offen sc0 sc1
    s_mov_b32 s67, 2
    s_cmp_lg_u32 s65, 0
    s_cbranch_scc1 L_h1_r2
    s_sub_u32 s56, s56, 1
    s_cbranch_scc0 L_h1_p2
    s_mov_b32 s56, 0
    s_not_b32 s65, s88
    s_branch L_h1_r2
L_h1_p3:
    s_waitcnt vmcnt(3)
    s_cmp_eq_u32 s67, 0
    s_cbranch_scc1 L_h1_s3
    s_waitcnt vmcnt(0)
L_h1_s3:
    v_cmp_eq_u32 vcc, s68, v4
    s_nop 0
    s_andn2_b32 s65, vcc_lo, s88
    s_or_b32 s88, s88, s65
    s_bcnt0_i32_b32 s90, s88
    s_cmp_le_u32 s90, 2
    s_cbranch_scc1 L_h1_r3
    v_mov_b32 v4, 0
    buffer_atomic_or v4, v6, s[16:19], 0 offen sc0 sc1
    s_mov_b32 s67, 3
    s_cmp_lg_u32 s65, 0
    s_cbranch_scc1 L_h1_r3
    s_sub_u32 s56, s56, 1
    s_cbranch_scc0 L_h1_p3
    s_mov_b32 s56, 0
    s_not_b32 s65, s88
    s_branch L_h1_r3
L_walk_8:
    s_cbranch_execz L_walked
L_h1_p4:
    s_waitcnt vmcnt(4)
    s_cmp_eq_u32 s67, 0
    s_cbranch_scc1 L_h1_s4
    s_waitcnt vmcnt(0)
L_h1_s4:
    v_cmp_eq_u32 vcc, s68, v4
    s_nop 0
    s_andn2_b32 s65, vcc_lo, s88
    s_or_b32 s88, s88, s65
    s_bcnt0_i32_b32 s90, s88
    s_cmp_le_u32 s90, 2
    s_cbranch_scc1 L_h1_r4
    v_mov_b32 v4, 0
    buffer_atomic_or v4, v6, s[16:19], 0 offen sc0 sc1
    s_mov_b32 s67, 4
    s_cmp_lg_u32 s65, 0
    s_cbranch_scc1 L_h1_r4
    s_sub_u32 s56, s56, 1
    s_cbranch_scc0 L_h1_p4
    s_mov_b32 s56, 0
    s_not_b32 s65, s88
    s_branch L_h1_r4
L_h1_p5:
    s_waitcnt vmcnt(5)
    s_cmp_eq_u32 s67, 0
    s_cbranch_scc1 L_h1_s5
    s_waitcnt vmcnt(0)
L_h1_s5:
    v_cmp_eq_u32 vcc, s68, v4
    s_nop 0
    s_andn2_b32 s65, vcc_lo, s88
    s_or_b32 s88, s88, s65
    s_bcnt0_i32_b32 s90, s88
    s_cmp_le_u32 s90, 2
    s_cbranch_scc1 L_h1_r5
    v_mov_b32 v4, 0
    buffer_atomic_or v4, v6, s[16:19], 0 offen sc0 sc1
    s_mov_b32 s67, 5
    s_cmp_lg_u32 s65, 0
    s_cbranch_scc1 L_h1_r5
    s_sub_u32 s56, s56, 1
    s_cbranch_scc0 L_h1_p5
    s_mov_b32 s56, 0
    s_not_b32 s65, s88
    s_branch L_h1_r5
L_h1_p6:
    s_waitcnt vmcnt(6)
    s_cmp_eq_u32 s67, 0
    s_cbranch_scc1 L_h1_s6
    s_waitcnt vmcnt(0)
L_h1_s6:
    v_cmp_eq_u32 vcc, s68, v4
    s_nop 0
    s_andn2_b32 s65, vcc_lo, s88
    s_or_b32 s88, s88, s65
    s_bcnt0_i32_b32 s90, s88
    s_cmp_le_u32 s90, 2
    s_cbranch_scc1 L_h1_r6
    v_mov_b32 v4, 0
    buffer_atomic_or v4, v6, s[16:19], 0 offen sc0 sc1
    s_mov_b32 s67, 6
    s_cmp_lg_u32 s65, 0
    s_cbranch_scc1 L_h1_r6
    s_sub_u32 s56, s56, 1
    s_cbranch_scc0 L_h1_p6
    s_mov_b32 s56, 0
    s_not_b32 s65, s88
    s_branch L_h1_r6
L_h1_p7:
    s_waitcnt vmcnt(7)
    s_cmp_eq_u32 s67, 0
    s_cbranch_scc1 L_h1_s7
    s_waitcnt vmcnt(0)
L_h1_s7:
    v_cmp_eq_u32 vcc, s68, v4
    s_nop 0
    s_andn2_b32 s65, vcc_lo, s88
    s_or_b32 s88, s88, s65
    s_bcnt0_i32_b32 s90, s88
    s_cmp_le_u32 s90, 2
    s_cbranch_scc1 L_h1_r7
    v_mov_b32 v4, 0
    buffer_atomic_or v4, v6, s[16:19], 0 offen sc0 sc1
    s_mov_b32 s67, 7
    s_cmp_lg_u32 s65, 0
    s_cbranch_scc1 L_h1_r7
    s_sub_u32 s56, s56, 1
    s_cbranch_scc0 L_h1_p7
    s_mov_b32 s56, 0
    s_not_b32 s65, s88
    s_branch L_h1_r7
L_h1_p8:
    s_waitcnt vmcnt(8)
    s_cmp_eq_u32 s67, 0
    s_cbranch_scc1 L_h1_s8
    s_waitcnt vmcnt(0)
L_h1_s8:
    v_cmp_eq_u32 vcc, s68, v4
    s_nop 0
    s_andn2_b32 s65, vcc_lo, s88
    s_or_b32 s88, s88, s65
    s_bcnt0_i32_b32 s90, s88
    s_cmp_le_u32 s90, 2
    s_cbranch_scc1 L_h1_r8
    v_mov_b32 v4, 0
    buffer_atomic_or v4, v6, s[16:19], 0 offen sc0 sc1
    s_mov_b32 s67, 8
    s_cmp_lg_u32 s65, 0
    s_cbranch_scc1 L_h1_r8
    s_sub_u32 s56, s56, 1
    s_cbranch_scc0 L_h1_p8
    s_mov_b32 s56, 0
    s_not_b32 s65, s88
    s_branch L_h1_r8
L_h1_p9:
    s_waitcnt vmcnt(9)
    s_cmp_eq_u32 s67, 0
    s_cbranch_scc1 L_h1_s9
    s_waitcnt vmcnt(0)
L_h1_s9:
    v_cmp_eq_u32 vcc, s68, v4
    s_nop 0
    s_andn2_b32 s65, vcc_lo, s88
    s_or_b32 s88, s88, s65
    s_bcnt0_i32_b32 s90, s88
    s_cmp_le_u32 s90, 2
    s_cbranch_scc1 L_h1_r9
    v_mov_b32 v4, 0
    buffer_atomic_or v4, v6, s[16:19], 0 offen sc0 sc1
    s_mov_b32 s67, 9
    s_cmp_lg_u32 s65, 0
    s_cbranch_scc1 L_h1_r9
    s_sub_u32 s56, s56, 1
    s_cbranch_scc0 L_h1_p9
    s_mov_b32 s56, 0
    s_not_b32 s65, s88
    s_branch L_h1_r9
L_h1_p10:
    s_waitcnt vmcnt(10)
    s_cmp_eq_u32 s67, 0
    s_cbranch_scc1 L_h1_s10
    s_waitcnt vmcnt(0)
L_h1_s10:
    v_cmp_eq_u32 vcc, s68, v4
    s_nop 0
    s_andn2_b32 s65, vcc_lo, s88
    s_or_b32 s88, s88, s65
    s_bcnt0_i32_b32 s90, s88
    s_cmp_le_u32 s90, 2
    s_cbranch_scc1 L_h1_r10
    v_mov_b32 v4, 0
    buffer_atomic_or v4, v6, s[16:19], 0 offen sc0 sc1
    s_mov_b32 s67, 10
    s_cmp_lg_u32 s65, 0
    s_cbranch_scc1 L_h1_r10
    s_sub_u32 s56, s56, 1
    s_cbranch_scc0 L_h1_p10
    s_mov_b32 s56, 0
    s_not_b32 s65, s88
    s_branch L_h1_r10
L_h1_p11:
    s_waitcnt vmcnt(11)
    s_cmp_eq_u32 s67, 0
    s_cbranch_scc1 L_h1_s11
    s_waitcnt vmcnt(0)
L_h1_s11:
    v_cmp_eq_u32 vcc, s68, v4
    s_nop 0
    s_andn2_b32 s65, vcc_lo, s88
    s_or_b32 s88, s88, s65
    s_bcnt0_i32_b32 s90, s88
    s_cmp_le_u32 s90, 2
    s_cbranch_scc1 L_h1_r11
    v_mov_b32 v4, 0
    buffer_atomic_or v4, v6, s[16:19], 0 offen sc0 sc1
    s_mov_b32 s67, 11
    s_cmp_lg_u32 s65, 0
    s_cbranch_scc1 L_h1_r11
    s_sub_u32 s56, s56, 1
    s_cbranch_scc0 L_h1_p11
    s_mov_b32 s56, 0
    s_not_b32 s65, s88
    s_branch L_h1_r11
L_h1_p12:
    s_waitcnt vmcnt(12)
    s_cmp_eq_u32 s67, 0
    s_cbranch_scc1 L_h1_s12
    s_waitcnt vmcnt(0)
L_h1_s12:
    v_cmp_eq_u32 vcc, s68, v4
    s_nop 0
    s_andn2_b32 s65, vcc_lo, s88
    s_or_b32 s88, s88, s65
    s_bcnt0_i32_b32 s90, s88
    s_cmp_le_u32 s90, 2
    s_cbranch_scc1 L_h1_r12
    v_mov_b32 v4, 0
    buffer_atomic_or v4, v6, s[16:19], 0 offen sc0 sc1
    s_mov_b32 s67, 12
    s_cmp_lg_u32 s65, 0
    s_cbranch_scc1 L_h1_r12
    s_sub_u32 s56, s56, 1
    s_cbranch_scc0 L_h1_p12
    s_mov_b32 s56, 0
    s_not_b32 s65, s88
    s_branch L_h1_r12
L_h1_p13:
    s_waitcnt vmcnt(13)
    s_cmp_eq_u32 s67, 0
    s_cbranch_scc1 L_h1_s13
    s_waitcnt vmcnt(0)
L_h1_s13:
    v_cmp_eq_u32 vcc, s68, v4
    s_nop 0
    s_andn2_b32 s65, vcc_lo, s88
    s_or_b32 s88, s88, s65
    s_bcnt0_i32_b32 s90, s88
    s_cmp_le_u32 s90, 2
    s_cbranch_scc1 L_h1_r13
    v_mov_b32 v4, 0
    buffer_atomic_or v4, v6, s[16:19], 0 offen sc0 sc1
    s_mov_b32 s67, 13
    s_cmp_lg_u32 s65, 0
    s_cbranch_scc1 L_h1_r13
    s_sub_u32 s56, s56, 1
    s_cbranch_scc0 L_h1_p13
    s_mov_b32 s56, 0
    s_not_b32 s65, s88
    s_branch L_h1_r13
L_h1_p14:
    s_not_b32 s65, s88
    s_branch L_h1_r14
L_h1_p15:
    s_not_b32 s65, s88
    s_branch L_h1_r15
L_h1_again:
    s_sub_u32 s56, s56, 1
    s_cbranch_scc0 L_h1_re
    s_mov_b32 s56, 0
    s_branch L_h1_ok
L_h1_re:
    v_cmp_eq_u32 vcc, -1, v4
    s_cbranch_vccnz L_h1_all
    v_cmp_eq_u32 vcc, -1, v99
    s_cbranch_vccz L_h1_n14
    s_mov_b64 exec, vcc
    buffer_load_dwordx4 v[96:99], v2, s[16:19], s76 offen sc1
    s_mov_b64 exec, -1
L_h1_n14:
    v_cmp_eq_u32 vcc, -1, v103
    s_cbranch_vccz L_h1_n15
    s_mov_b64 exec, vcc
    buffer_load_dwordx4 v[100:103], v2, s[16:19], s77 offen sc1
    s_mov_b64 exec, -1
L_h1_n15:
    v_cmp_eq_u32 vcc, -1, v107
    s_cbranch_vccz L_h1_n16
    s_mov_b64 exec, vcc
    buffer_load_dwordx4 v[104:107], v3, s[16:19], 0 offen sc1
    s_mov_b64 exec, -1
L_h1_n16:
    s_branch L_h1_chk
L_h1_all:
    s_mov_b32 s76, 14336
    s_mov_b32 s77, 15360
    buffer_load_dwordx4 v[40:43], v2, s[16:19], 0 offen offset:0 sc1
    buffer_load_dwordx4 v[44:47], v2, s[16:19], 0 offen offset:1024 sc1
    buffer_load_dwordx4 v[48:51], v2, s[16:19], 0 offen offset:2048 sc1
    buffer_load_dwordx4 v[52:55], v2, s[16:19], 0 offen offset:3072 sc1
    buffer_load_dwordx4 v[56:59], v2, s[16:19], s92 offen offset:0 sc1
    buffer_load_dwordx4 v[60:63], v2, s[16:19], s92 offen offset:1024 sc1
L_walk_9:
    s_cbranch_execz L_walked
    buffer_load_dwordx4 v[64:67], v2, s[16:19], s92 offen offset:2048 sc1
    buffer_load_dwordx4 v[68:71], v2, s[16:19], s92 offen offset:3072 sc1
    buffer_load_dwordx4 v[72:75], v2, s[16:19], s93 offen offset:0 sc1
    buffer_load_dwordx4 v[76:79], v2, s[16:19], s93 offen offset:1024 sc1
    buffer_load_dwordx4 v[80:83], v2, s[16:19], s93 offen offset:2048 sc1
    buffer_load_dwordx4 v[84:87], v2, s[16:19], s93 offen offset:3072 sc1
    buffer_load_dwordx4 v[88:91], v2, s[16:19], s94 offen offset:0 sc1
    buffer_load_dwordx4 v[92:95], v2, s[16:19], s94 offen offset:1024 sc1
    buffer_load_dwordx4 v[96:99], v2, s[16:19], s94 offen offset:2048 sc1
    buffer_load_dwordx4 v[100:103], v2, s[16:19], s94 offen offset:3072 sc1
    buffer_load_dwordx4 v[104:107], v3, s[16:19], 0 offen sc1
    v_mov_b32 v112, 0
    v_mov_b32 v113, 0
    v_mov_b32 v114, 0
    v_mov_b32 v115, 0
    v_mov_b32 v116, 0
    v_mov_b32 v117, 0
    v_mov_b32 v118, 0
    v_mov_b32 v119, 0
    s_branch L_h1_acc
L_comp:
    s_mov_b64 exec, -1
    v_and_b32 v20, 15, v0
    v_lshrrev_b32 v21, 4, v0
    v_bfe_u32 v22, v0, 1, 3
    s_lshl_b32 s86, s49, 13
    v_lshl_add_u32 v20, v20, 7, s86
    v_or_b32 v23, 0, v21
    v_xor_b32 v23, v23, v22
    v_lshl_add_u32 v2, v23, 4, v20
    v_or_b32 v23, 4, v21
    v_xor_b32 v23, v23, v22
    v_lshl_add_u32 v3, v23, 4, v20
    v_bfe_u32 v22, v0, 2, 2
    v_lshl_add_u32 v22, v21, 3, v22
    v_lshlrev_b32 v22, 7, v22
    v_bfe_u32 v23, v0, 3, 2
    s_lshl_b32 s86, s50, 1
    v_xor_b32 v23, s86, v23
    v_lshl_add_u32 v22, v23, 5, v22
    v_and_b32 v23, 3, v0
    v_lshl_add_u32 v22, v23, 3, v22
    v_add_u32 v4, 16384, v22
    v_xor_b32 v5, 32, v4
    s_lshl_b32 s53, s2, 2
    s_add_u32 s53, s53, s3
    s_lshl_b32 s86, s53, 12
    s_add_u32 s86, s86, 1048576
    v_lshl_add_u32 v6, v0, 4, s86
    s_mul_i32 s53, s53, 160
    s_add_u32 s53, s53, 6553600
    v_lshl_add_u32 v17, v0, 4, s53
    v_mov_b32 v16, 2147483648
    v_cmp_gt_u32 vcc, 10, v0
    s_nop 1
    v_cndmask_b32 v17, v16, v17, vcc
    s_lshl2_add_u32 s86, s45, s3
    s_lshr_b32 s87, s86, 3
    s_mul_i32 s87, s87, 14336
    s_and_b32 s86, s86, 7
    s_lshl3_add_u32 s86, s44, s86
    s_mul_i32 s86, s86, 224
    s_add_u32 s86, s86, s87
    s_add_u32 s86, s86, 7864064
    v_lshl_add_u32 v16, v0, 4, s86
    s_mov_b32 vcc_lo, 0x3fff0000
    s_mov_b32 vcc_hi, 0
    v_cndmask_b32 v17, v17, v16, vcc
    s_lshl_b32 s86, s47, 1
    s_add_u32 s86, s86, s50
    s_lshl1_add_u32 s87, s86, s49
    s_lshl4_add_u32 s87, s87, s46
    s_lshl_b32 s87, s87, 6
    s_add_u32 s87, s87, 6880320
    v_lshl_add_u32 v16, v0, 4, s87
    v_cmp_le_u32 vcc, 60, v0
    s_nop 1
    v_cndmask_b32 v17, v17, v16, vcc
    s_lshl_b32 s87, s86, 1
    s_add_u32 s87, s87, s49
    s_lshl_b32 s87, s87, 4
    s_add_u32 s87, s87, s46
    s_lshl_b32 s87, s87, 10
    s_add_u32 s87, s87, 5242880
    v_lshl_add_u32 v16, v0, 4, s87
    v_mov_b32 v8, -1
    v_mov_b32 v9, -1
    v_mov_b32 v10, -1
    v_mov_b32 v11, -1
    s_waitcnt lgkmcnt(0)
    s_load_dword s61, s[84:85], 524288
    s_mov_b32 s16, s84
    s_and_b32 s17, s85, 0xffff
    s_mov_b32 s18, 268435456
    s_mov_b32 s19, 0x20000
    s_mov_b32 s8, s64
    s_and_b32 s9, s65, 0xffff
    s_mov_b32 s10, 4194304
    s_mov_b32 s11, 0x20000
    s_mov_b32 s20, s68
    s_and_b32 s21, s69, 0xffff
    s_mov_b32 s22, 2097152
    s_mov_b32 s23, 0x20000
    s_mov_b32 s24, s80
    s_and_b32 s25, s81, 0xffff
    s_mov_b32 s26, 4194304
    s_mov_b32 s27, 0x20000
    s_mov_b32 s28, s82
    s_and_b32 s29, s83, 0xffff
    s_mov_b32 s30, 256
    s_mov_b32 s31, 0x20000
    s_bitcmp1_b32 s2, 3
    s_cselect_b32 s32, s76, s74
    s_cselect_b32 s33, s77, s75
    s_and_b32 s33, s33, 0xffff
    s_mov_b32 s34, 7340032
    s_mov_b32 s35, 0x20000
    s_mov_b32 s36, s78
    s_and_b32 s37, s79, 0xffff
    s_mov_b32 s38, 7340032
    s_mov_b32 s39, 0x20000
    s_mov_b32 s40, s72
    s_and_b32 s41, s73, 0xffff
    s_mov_b32 s42, 2048
    s_mov_b32 s43, 0x20000
    s_lshl_b32 s82, s44, 5
    s_or_b32 s82, s82, s45
    s_lshl_b32 s86, s2, 9
    s_add_u32 s86, s86, 786432
    s_cmp_eq_u32 s3, 0
    s_cselect_b32 s86, s86, 2147483648
    v_lshl_add_u32 v7, v0, 2, s86
    v_mul_u32_u24 v12, 192, v21
    v_add_u32 v7, v7, v12
    s_lshl_b32 s86, s2, 8
    s_add_u32 s86, s86, 917376
    s_cmp_eq_u32 s3, 0
    s_cselect_b32 s86, s86, 2147483648
    v_lshl_add_u32 v12, v0, 2, s86
    v_cmp_gt_u32 vcc, 32, v0
    s_nop 1
    v_cndmask_b32 v7, v12, v7, vcc
    v_mov_b32 v12, 2147483648
    v_cmp_gt_u32 vcc, 48, v0
    s_nop 1
    v_cndmask_b32 v7, v12, v7, vcc
    s_lshl_b32 s86, s2, 9
    s_add_u32 s86, s86, 6291456
    v_lshl_add_u32 v13, v0, 2, s86
    v_mul_u32_u24 v12, 64, v21
    v_add_u32 v13, v13, v12
    s_cmp_eq_u32 s3, 1
    s_cselect_b64 vcc, -1, 0
    v_cndmask_b32 v7, v7, v13, vcc
    v_mov_b32 v12, 0
    buffer_store_dword v12, v7, s[16:19], 0 offen sc1
    v_mov_b32 v128, 0
    v_mov_b32 v129, 0
    v_mov_b32 v130, 0
    v_mov_b32 v131, 0
    v_mov_b32 v132, 0
    v_mov_b32 v133, 0
    v_mov_b32 v134, 0
    v_mov_b32 v135, 0
    v_mov_b32 v136, 0
    v_mov_b32 v137, 0
    v_mov_b32 v138, 0
    v_mov_b32 v139, 0
    v_mov_b32 v140, 0
    v_mov_b32 v141, 0
    v_mov_b32 v142, 0
    v_mov_b32 v143, 0
    v_mov_b32 v144, 0
    v_mov_b32 v145, 0
    v_mov_b32 v146, 0
    v_mov_b32 v147, 0
    v_mov_b32 v148, 0
    v_mov_b32 v149, 0
    v_mov_b32 v150, 0
    v_mov_b32 v151, 0
    v_mov_b32 v152, 0
    v_mov_b32 v153, 0
    v_mov_b32 v154, 0
    v_mov_b32 v155, 0
    v_mov_b32 v156, 0
    v_mov_b32 v157, 0
    v_mov_b32 v158, 0
    v_mov_b32 v159, 0
    v_mov_b32 v160, 0
    v_mov_b32 v161, 0
    v_mov_b32 v162, 0
    v_mov_b32 v163, 0
    v_mov_b32 v164, 0
    v_mov_b32 v165, 0
    v_mov_b32 v166, 0
    v_mov_b32 v167, 0
    v_mov_b32 v168, 0
    v_mov_b32 v169, 0
    v_mov_b32 v170, 0
    v_mov_b32 v171, 0
    v_mov_b32 v172, 0
    v_mov_b32 v173, 0
    v_mov_b32 v174, 0
    v_mov_b32 v175, 0
    v_mov_b32 v176, 0
    v_mov_b32 v177, 0
    v_mov_b32 v178, 0
    v_mov_b32 v179, 0
    v_mov_b32 v180, 0
    v_mov_b32 v181, 0
    v_mov_b32 v182, 0
    v_mov_b32 v183, 0
    v_mov_b32 v184, 0
    v_mov_b32 v185, 0
    v_mov_b32 v186, 0
    v_mov_b32 v187, 0
    v_mov_b32 v188, 0
    v_mov_b32 v189, 0
    v_mov_b32 v190, 0
    v_mov_b32 v191, 0
    v_mov_b32 v192, 0
    v_mov_b32 v193, 0
    v_mov_b32 v194, 0
    v_mov_b32 v195, 0
    v_mov_b32 v196, 0
    v_mov_b32 v197, 0
    v_mov_b32 v198, 0
    v_mov_b32 v199, 0
    v_mov_b32 v200, 0
    v_mov_b32 v201, 0
    v_mov_b32 v202, 0
    v_mov_b32 v203, 0
L_walkA2:
    s_cbranch_execz L_comp
    v_mov_b32 v204, 0
    v_mov_b32 v205, 0
    v_mov_b32 v206, 0
    v_mov_b32 v207, 0
    v_mov_b32 v208, 0
    v_mov_b32 v209, 0
    v_mov_b32 v210, 0
    v_mov_b32 v211, 0
    v_mov_b32 v212, 0
    v_mov_b32 v213, 0
    v_mov_b32 v214, 0
    v_mov_b32 v215, 0
    v_mov_b32 v216, 0
    v_mov_b32 v217, 0
    v_mov_b32 v218, 0
    v_mov_b32 v219, 0
    v_mov_b32 v220, 0
    v_mov_b32 v221, 0
    v_mov_b32 v222, 0
    v_mov_b32 v223, 0
    s_mov_b32 s54, 0x358637bd
    s_mov_b32 s55, 0x358637bd
    s_mul_i32 s86, s3, 3072
    s_add_u32 s86, s86, 139264
    v_lshl_add_u32 v24, v0, 4, s86
    s_xor_b32 s86, s3, 1
    s_mul_i32 s86, s86, 3072
    s_add_u32 s86, s86, 139264
    v_lshl_add_u32 v25, v0, 4, s86
    s_lshl_b32 s86, s47, 1
    s_add_u32 s86, s86, s50
    s_lshl_b32 s87, s86, 1
    s_add_u32 s87, s87, s49
    s_lshl_b32 s87, s87, 4
    s_add_u32 s87, s87, s46
    s_lshl_b32 s87, s87, 10
    s_add_u32 s87, s87, 5242880
    v_lshl_add_u32 v26, v0, 4, s87
    s_lshl1_add_u32 s87, s86, s49
    s_lshl4_add_u32 s87, s87, s46
    s_lshl_b32 s87, s87, 6
    s_add_u32 s87, s87, 6881280
    v_add_u32 v27, s87, v0
    s_mov_b32 vcc_lo, 0x00010001
    s_mov_b32 vcc_hi, vcc_lo
    v_mov_b32 v14, 2147483648
    v_cndmask_b32 v27, v14, v27, vcc
    s_lshl_b32 s87, s46, 3
    s_lshl_b32 s88, s49, 2
    s_add_u32 s87, s87, s88
    s_lshl_b32 s87, s87, 5
    s_add_u32 s87, s87, s86
    s_lshl_b32 s87, s87, 10
    s_add_u32 s87, s87, 1048576
    v_lshl_add_u32 v23, v0, 4, s87
    s_mul_i32 s87, s50, 3072
    s_add_u32 s87, s87, 151552
    v_lshl_add_u32 v20, v0, 4, s87
    s_lshl_b32 s87, s86, 1
    s_add_u32 s87, s87, s49
    s_lshl_b32 s87, s87, 5
    s_add_u32 s87, s87, s46
    s_lshl2_add_u32 s87, s87, 671744
    v_mov_b32 v19, 2147483648
    v_mov_b32 v18, 2147483648
    v_writelane_b32 v19, s87, 0
    s_lshl_b32 s87, s46, 1
    s_add_u32 s87, s87, s49
    s_lshl_b32 s87, s87, 1
    s_lshr_b32 s88, s86, 4
    s_add_u32 s87, s87, s88
    s_lshl_b32 s87, s87, 6
    s_and_b32 s88, s86, 15
    s_add_u32 s87, s87, s88
    s_lshl2_add_u32 s87, s87, 688128
    v_writelane_b32 v18, s87, 0
    s_add_u32 s87, s87, 128
    v_writelane_b32 v18, s87, 1
    v_mov_b32 v120, s95
    v_mov_b32 v121, s95
    v_mov_b32 v122, s95
    v_mov_b32 v123, s95
    s_mov_b32 s4, 0x3f317218
    s_mov_b32 s5, 0x3f317218
    s_mov_b32 s6, 0x35c1a2c6
    s_mov_b32 s62, 0
    s_mov_b32 s63, 1
    v_add_u32 v2, 40960, v2
    v_add_u32 v3, 40960, v3
    v_add_u32 v4, 40960, v4
    v_add_u32 v5, 40960, v5
    s_mov_b64 exec, 0
    s_cmp_eq_u32 s3, 0
    s_cbranch_scc1 L_walkB0
    s_cmp_eq_u32 s3, 1
    s_cbranch_scc1 L_walkB1
    s_cmp_eq_u32 s3, 2
    s_cbranch_scc1 L_walkB2
    s_branch L_walkB3
L_walked:
    s_mov_b64 exec, -1
    s_waitcnt lgkmcnt(0)
    s_add_u32 s68, s61, 0x9e3779b9
    s_barrier
    ds_read_b128 v[40:43], v2 offset:0
    ds_read_b128 v[44:47], v2 offset:2048
    ds_read_b128 v[48:51], v2 offset:4096
    ds_read_b128 v[52:55], v2 offset:6144
    ds_read_b64_tr_b16 v[56:57], v4 offset:0
    ds_read_b64_tr_b16 v[58:59], v4 offset:512
    ds_read_b64_tr_b16 v[60:61], v5 offset:0
    ds_read_b64_tr_b16 v[62:63], v5 offset:512
    ds_read_b64_tr_b16 v[64:65], v4 offset:8192
    ds_read_b64_tr_b16 v[66:67], v4 offset:8704
    ds_read_b64_tr_b16 v[68:69], v5 offset:8192
    ds_read_b64_tr_b16 v[70:71], v5 offset:8704
    ds_read_b64_tr_b16 v[72:73], v4 offset:16384
    ds_read_b64_tr_b16 v[74:75], v4 offset:16896
    ds_read_b64_tr_b16 v[76:77], v5 offset:16384
    ds_read_b64_tr_b16 v[78:79], v5 offset:16896
L_cloop:
    s_waitcnt lgkmcnt(0)
    v_mfma_f32_16x16x32_bf16 v[128:131], v[56:59], v[40:43], v[128:131]
    ds_read_b128 v[80:83], v3 offset:0
    v_mfma_f32_16x16x32_bf16 v[144:147], v[60:63], v[40:43], v[144:147]
    ds_read_b128 v[84:87], v3 offset:2048
    v_mfma_f32_16x16x32_bf16 v[148:151], v[60:63], v[44:47], v[148:151]
    ds_read_b128 v[88:91], v3 offset:4096
    v_mfma_f32_16x16x32_bf16 v[132:135], v[56:59], v[44:47], v[132:135]
    ds_read_b128 v[92:95], v3 offset:6144
    v_mfma_f32_16x16x32_bf16 v[136:139], v[56:59], v[48:51], v[136:139]
    ds_read_b64_tr_b16 v[96:97], v4 offset:4096
    v_mfma_f32_16x16x32_bf16 v[152:155], v[60:63], v[48:51], v[152:155]
    ds_read_b64_tr_b16 v[98:99], v4 offset:4608
    v_mfma_f32_16x16x32_bf16 v[156:159], v[60:63], v[52:55], v[156:159]
    ds_read_b64_tr_b16 v[100:101], v5 offset:4096
    v_mfma_f32_16x16x32_bf16 v[140:143], v[56:59], v[52:55], v[140:143]
    ds_read_b64_tr_b16 v[102:103], v5 offset:4608
    v_mfma_f32_16x16x32_bf16 v[172:175], v[52:55], v[64:67], v[172:175]
    ds_read_b64_tr_b16 v[104:105], v4 offset:12288
    v_mfma_f32_16x16x32_bf16 v[188:191], v[52:55], v[68:71], v[188:191]
    ds_read_b64_tr_b16 v[106:107], v4 offset:12800
    v_mfma_f32_16x16x32_bf16 v[184:187], v[48:51], v[68:71], v[184:187]
    ds_read_b64_tr_b16 v[108:109], v5 offset:12288
    v_mfma_f32_16x16x32_bf16 v[168:171], v[48:51], v[64:67], v[168:171]
    ds_read_b64_tr_b16 v[110:111], v5 offset:12800
    v_mfma_f32_16x16x32_bf16 v[164:167], v[44:47], v[64:67], v[164:167]
    ds_read_b64_tr_b16 v[112:113], v4 offset:20480
    v_mfma_f32_16x16x32_bf16 v[180:183], v[44:47], v[68:71], v[180:183]
    ds_read_b64_tr_b16 v[114:115], v4 offset:20992
    v_mfma_f32_16x16x32_bf16 v[176:179], v[40:43], v[68:71], v[176:179]
    ds_read_b64_tr_b16 v[116:117], v5 offset:20480
    v_mfma_f32_16x16x32_bf16 v[160:163], v[40:43], v[64:67], v[160:163]
    ds_read_b64_tr_b16 v[118:119], v5 offset:20992
    v_mfma_f32_16x16x32_bf16 v[192:195], v[40:43], v[72:75], v[192:195]
    s_add_u32 s63, s63, 1
    s_cmp_eq_u32 s63, 4
    s_cselect_b32 s53, 4294803456, 0
    s_cselect_b32 s63, 0, s63
    s_add_u32 s53, s53, 40960
    v_mfma_f32_16x16x32_bf16 v[208:211], v[40:43], v[76:79], v[208:211]
    v_add_u32 v2, s53, v2
    v_mfma_f32_16x16x32_bf16 v[212:215], v[44:47], v[76:79], v[212:215]
    v_add_u32 v4, s53, v4
    v_mfma_f32_16x16x32_bf16 v[196:199], v[44:47], v[72:75], v[196:199]
    v_add_u32 v5, s53, v5
    v_mfma_f32_16x16x32_bf16 v[200:203], v[48:51], v[72:75], v[200:203]
    v_add_u32 v3, s53, v3
    v_mfma_f32_16x16x32_bf16 v[216:219], v[48:51], v[76:79], v[216:219]
    s_cmp_ge_u32 s62, 6
    s_cbranch_scc1 L_cl_none
    buffer_store_dwordx4 v[8:11], v6, s[16:19], 0 offen sc1
    v_add_u32 v6, 1024, v6
    s_cmp_lt_u32 s62, 3
    s_cbranch_scc1 L_cl_none
    v_mov_b32 v6, v16
    v_mov_b32 v16, v17
L_cl_none:
    v_mfma_f32_16x16x32_bf16 v[220:223], v[52:55], v[76:79], v[220:223]
    v_mfma_f32_16x16x32_bf16 v[204:207], v[52:55], v[72:75], v[204:207]
    s_waitcnt lgkmcnt(0)
    v_mfma_f32_16x16x32_bf16 v[128:131], v[96:99], v[80:83], v[128:131]
L_walkB2:
    s_cbranch_execz L_walk_6
    s_barrier
    ds_read_b128 v[40:43], v2 offset:0
    v_mfma_f32_16x16x32_bf16 v[144:147], v[100:103], v[80:83], v[144:147]
    ds_read_b128 v[44:47], v2 offset:2048
    v_mfma_f32_16x16x32_bf16 v[148:151], v[100:103], v[84:87], v[148:151]
    ds_read_b128 v[48:51], v2 offset:4096
    v_mfma_f32_16x16x32_bf16 v[132:135], v[96:99], v[84:87], v[132:135]
    ds_read_b128 v[52:55], v2 offset:6144
    v_mfma_f32_16x16x32_bf16 v[136:139], v[96:99], v[88:91], v[136:139]
    ds_read_b64_tr_b16 v[56:57], v4 offset:0
    v_mfma_f32_16x16x32_bf16 v[152:155], v[100:103], v[88:91], v[152:155]
    ds_read_b64_tr_b16 v[58:59], v4 offset:512
    v_mfma_f32_16x16x32_bf16 v[156:159], v[100:103], v[92:95], v[156:159]
    ds_read_b64_tr_b16 v[60:61], v5 offset:0
    v_mfma_f32_16x16x32_bf16 v[140:143], v[96:99], v[92:95], v[140:143]
    ds_read_b64_tr_b16 v[62:63], v5 offset:512
    v_mfma_f32_16x16x32_bf16 v[172:175], v[92:95], v[104:107], v[172:175]
    ds_read_b64_tr_b16 v[64:65], v4 offset:8192
    v_mfma_f32_16x16x32_bf16 v[188:191], v[92:95], v[108:111], v[188:191]
    ds_read_b64_tr_b16 v[66:67], v4 offset:8704
    v_mfma_f32_16x16x32_bf16 v[184:187], v[88:91], v[108:111], v[184:187]
    ds_read_b64_tr_b16 v[68:69], v5 offset:8192
    v_mfma_f32_16x16x32_bf16 v[168:171], v[88:91], v[104:107], v[168:171]
    ds_read_b64_tr_b16 v[70:71], v5 offset:8704
    v_mfma_f32_16x16x32_bf16 v[164:167], v[84:87], v[104:107], v[164:167]
    ds_read_b64_tr_b16 v[72:73], v4 offset:16384
    v_mfma_f32_16x16x32_bf16 v[180:183], v[84:87], v[108:111], v[180:183]
    ds_read_b64_tr_b16 v[74:75], v4 offset:16896
    v_mfma_f32_16x16x32_bf16 v[176:179], v[80:83], v[108:111], v[176:179]
    ds_read_b64_tr_b16 v[76:77], v5 offset:16384
    v_mfma_f32_16x16x32_bf16 v[160:163], v[80:83], v[104:107], v[160:163]
    ds_read_b64_tr_b16 v[78:79], v5 offset:16896
    v_mfma_f32_16x16x32_bf16 v[192:195], v[80:83], v[112:115], v[192:195]
    v_mfma_f32_16x16x32_bf16 v[208:211], v[80:83], v[116:119], v[208:211]
    s_cmp_lg_u32 s62, 7
    s_cbranch_scc1 L_cl_nw
    s_waitcnt vmcnt(0)
L_cl_nw:
    v_mfma_f32_16x16x32_bf16 v[212:215], v[84:87], v[116:119], v[212:215]
    v_mfma_f32_16x16x32_bf16 v[196:199], v[84:87], v[112:115], v[196:199]
    v_mfma_f32_16x16x32_bf16 v[200:203], v[88:91], v[112:115], v[200:203]
    s_add_u32 s62, s62, 1
    v_mfma_f32_16x16x32_bf16 v[216:219], v[88:91], v[116:119], v[216:219]
    v_mfma_f32_16x16x32_bf16 v[220:223], v[92:95], v[116:119], v[220:223]
    v_mfma_f32_16x16x32_bf16 v[204:207], v[92:95], v[112:115], v[204:207]
    s_cmp_lt_u32 s62, 15
    s_cbranch_scc1 L_cloop
    s_waitcnt lgkmcnt(0)
    v_mfma_f32_16x16x32_bf16 v[160:163], v[40:43], v[64:67], v[160:163]
    ds_read_b128 v[80:83], v3 offset:0
    v_mfma_f32_16x16x32_bf16 v[176:179], v[40:43], v[68:71], v[176:179]
    ds_read_b128 v[84:87], v3 offset:2048
    v_mfma_f32_16x16x32_bf16 v[180:183], v[44:47], v[68:71], v[180:183]
    ds_read_b128 v[88:91], v3 offset:4096
    v_mfma_f32_16x16x32_bf16 v[164:167], v[44:47], v[64:67], v[164:167]
    ds_read_b128 v[92:95], v3 offset:6144
    v_mfma_f32_16x16x32_bf16 v[168:171], v[48:51], v[64:67], v[168:171]
    ds_read_b64_tr_b16 v[104:105], v4 offset:12288
    v_mfma_f32_16x16x32_bf16 v[184:187], v[48:51], v[68:71], v[184:187]
    ds_read_b64_tr_b16 v[106:107], v4 offset:12800
    v_mfma_f32_16x16x32_bf16 v[188:191], v[52:55], v[68:71], v[188:191]
    ds_read_b64_tr_b16 v[108:109], v5 offset:12288
    v_mfma_f32_16x16x32_bf16 v[172:175], v[52:55], v[64:67], v[172:175]
    ds_read_b64_tr_b16 v[110:111], v5 offset:12800
    v_mfma_f32_16x16x32_bf16 v[204:207], v[52:55], v[72:75], v[204:207]
    ds_read_b64_tr_b16 v[112:113], v4 offset:20480
    v_mfma_f32_16x16x32_bf16 v[220:223], v[52:55], v[76:79], v[220:223]
    ds_read_b64_tr_b16 v[114:115], v4 offset:20992
    v_lshrrev_b32 v21, 4, v0
    v_and_b32 v22, 15, v0
    v_mfma_f32_16x16x32_bf16 v[216:219], v[48:51], v[76:79], v[216:219]
    ds_read_b64_tr_b16 v[116:117], v5 offset:20480
    s_lshl_b32 s86, s49, 8
    s_add_u32 s86, s86, 131072
    v_lshl_add_u32 v6, v21, 4, s86
    v_mfma_f32_16x16x32_bf16 v[200:203], v[48:51], v[72:75], v[200:203]
    ds_read_b64_tr_b16 v[118:119], v5 offset:20992
    v_lshl_add_u32 v7, v22, 2, s86
    v_mfma_f32_16x16x32_bf16 v[196:199], v[44:47], v[72:75], v[196:199]
    ds_read_b64_tr_b16 v[96:97], v4 offset:4096
    s_lshl_b32 s86, s50, 7
    s_add_u32 s86, s86, 132608
    v_lshl_add_u32 v8, v22, 2, s86
    v_mfma_f32_16x16x32_bf16 v[212:215], v[44:47], v[76:79], v[212:215]
    ds_read_b64_tr_b16 v[98:99], v4 offset:4608
    v_lshl_add_u32 v9, v21, 4, s86
    v_mfma_f32_16x16x32_bf16 v[208:211], v[40:43], v[76:79], v[208:211]
    ds_read_b64_tr_b16 v[100:101], v5 offset:4096
    s_lshl_b32 s86, s3, 2
    s_add_u32 s86, s86, 135168
    v_mov_b32 v12, s86
    v_mfma_f32_16x16x32_bf16 v[192:195], v[40:43], v[72:75], v[192:195]
    ds_read_b64_tr_b16 v[102:103], v5 offset:4608
    v_xor_b32 v13, 4, v12
    v_mov_b32 v17, s68
    s_waitcnt lgkmcnt(8)
    v_mfma_f32_16x16x32_bf16 v[160:163], v[80:83], v[104:107], v[160:163]
    v_mfma_f32_16x16x32_bf16 v[176:179], v[80:83], v[108:111], v[176:179]
    v_mfma_f32_16x16x32_bf16 v[180:183], v[84:87], v[108:111], v[180:183]
    v_mfma_f32_16x16x32_bf16 v[164:167], v[84:87], v[104:107], v[164:167]
    v_mfma_f32_16x16x32_bf16 v[168:171], v[88:91], v[104:107], v[168:171]
    s_waitcnt lgkmcnt(0)
    s_barrier
    ds_read_b128 v[64:67], v6 offset:0
    ds_read_b128 v[68:71], v6 offset:64
    v_mfma_f32_16x16x32_bf16 v[184:187], v[88:91], v[108:111], v[184:187]
    ds_read_b128 v[72:75], v6 offset:128
    ds_read_b128 v[76:79], v6 offset:192
    v_mfma_f32_16x16x32_bf16 v[188:191], v[92:95], v[108:111], v[188:191]
    ds_read_b32 v28, v8 offset:256
    ds_read_b32 v29, v8 offset:320
    v_mfma_f32_16x16x32_bf16 v[172:175], v[92:95], v[104:107], v[172:175]
    ds_read_b32 v30, v8 offset:512
    ds_read_b32 v31, v8 offset:576
    v_mfma_f32_16x16x32_bf16 v[204:207], v[92:95], v[112:115], v[204:207]
    ds_read_b128 v[224:227], v6 offset:512
    ds_read_b128 v[228:231], v6 offset:576
    v_mfma_f32_16x16x32_bf16 v[220:223], v[92:95], v[116:119], v[220:223]
    ds_read_b128 v[232:235], v6 offset:640
    ds_read_b128 v[236:239], v6 offset:704
    v_mfma_f32_16x16x32_bf16 v[216:219], v[88:91], v[116:119], v[216:219]
    ds_read_b128 v[240:243], v6 offset:1024
    ds_read_b128 v[244:247], v6 offset:1088
    v_mfma_f32_16x16x32_bf16 v[200:203], v[88:91], v[112:115], v[200:203]
    ds_read_b128 v[248:251], v6 offset:1152
    ds_read_b128 v[252:255], v6 offset:1216
    v_mfma_f32_16x16x32_bf16 v[196:199], v[84:87], v[112:115], v[196:199]
    ds_read_b128 v[32:35], v9 offset:0
    ds_read_b128 v[36:39], v9 offset:64
    v_mfma_f32_16x16x32_bf16 v[212:215], v[84:87], v[116:119], v[212:215]
    v_mfma_f32_16x16x32_bf16 v[208:211], v[80:83], v[116:119], v[208:211]
    v_mfma_f32_16x16x32_bf16 v[192:195], v[80:83], v[112:115], v[192:195]
    ds_read_b32 v104, v7 offset:0
    ds_read_b32 v124, v7 offset:1024
    ds_read_b32 v105, v7 offset:64
    ds_read_b32 v125, v7 offset:1088
    ds_read_b32 v106, v7 offset:128
    ds_read_b32 v126, v7 offset:1152
    ds_read_b32 v107, v7 offset:192
    ds_read_b32 v127, v7 offset:1216
    s_waitcnt lgkmcnt(8)
    v_pk_fma_f32 v[160:161], v[64:65], v[28:29], v[160:161] op_sel_hi:[1,0,1]
    v_pk_fma_f32 v[162:163], v[66:67], v[28:29], v[162:163] op_sel_hi:[1,0,1]
    v_pk_mul_f32 v[160:161], v[160:161], v[240:241]
    v_pk_mul_f32 v[162:163], v[162:163], v[242:243]
L_walkB3:
    s_cbranch_execz L_walk_7
    v_exp_f32 v112, v160 clamp
    v_exp_f32 v114, v162 clamp
    v_exp_f32 v113, v161 clamp
    v_exp_f32 v115, v163 clamp
    v_max_f32 v160, s6, v160
    v_max_f32 v162, s6, v162
    v_max_f32 v161, s6, v161
    v_max_f32 v163, s6, v163
    v_pk_fma_f32 v[160:161], v[160:161], s[4:5], v[112:113]
    v_pk_fma_f32 v[162:163], v[162:163], s[4:5], v[114:115]
    v_cvt_pk_bf16_f32 v160, v160, v161
    v_cvt_pk_bf16_f32 v161, v162, v163
    v_pk_fma_f32 v[164:165], v[68:69], v[28:29], v[164:165] op_sel_hi:[1,0,1]
    v_pk_fma_f32 v[166:167], v[70:71], v[28:29], v[166:167] op_sel_hi:[1,0,1]
    v_pk_mul_f32 v[164:165], v[164:165], v[244:245]
    v_pk_mul_f32 v[166:167], v[166:167], v[246:247]
    v_exp_f32 v116, v164 clamp
    v_exp_f32 v118, v166 clamp
    v_exp_f32 v117, v165 clamp
    v_exp_f32 v119, v167 clamp
    v_max_f32 v164, s6, v164
    v_max_f32 v166, s6, v166
    v_max_f32 v165, s6, v165
    v_max_f32 v167, s6, v167
    v_pk_fma_f32 v[164:165], v[164:165], s[4:5], v[116:117]
    v_pk_fma_f32 v[166:167], v[166:167], s[4:5], v[118:119]
    v_cvt_pk_bf16_f32 v162, v164, v165
    v_cvt_pk_bf16_f32 v163, v166, v167
    v_pk_fma_f32 v[168:169], v[72:73], v[28:29], v[168:169] op_sel_hi:[1,0,1]
    v_pk_fma_f32 v[170:171], v[74:75], v[28:29], v[170:171] op_sel_hi:[1,0,1]
    v_pk_mul_f32 v[168:169], v[168:169], v[248:249]
    v_pk_mul_f32 v[170:171], v[170:171], v[250:251]
    v_exp_f32 v112, v168 clamp
    v_exp_f32 v114, v170 clamp
    v_exp_f32 v113, v169 clamp
    v_exp_f32 v115, v171 clamp
    v_max_f32 v168, s6, v168
    v_max_f32 v170, s6, v170
    v_max_f32 v169, s6, v169
    v_max_f32 v171, s6, v171
    v_pk_fma_f32 v[168:169], v[168:169], s[4:5], v[112:113]
    v_pk_fma_f32 v[170:171], v[170:171], s[4:5], v[114:115]
    v_cvt_pk_bf16_f32 v168, v168, v169
    v_cvt_pk_bf16_f32 v169, v170, v171
    v_pk_fma_f32 v[172:173], v[76:77], v[28:29], v[172:173] op_sel_hi:[1,0,1]
    v_pk_fma_f32 v[174:175], v[78:79], v[28:29], v[174:175] op_sel_hi:[1,0,1]
    v_pk_mul_f32 v[172:173], v[172:173], v[252:253]
    v_pk_mul_f32 v[174:175], v[174:175], v[254:255]
    v_exp_f32 v116, v172 clamp
    v_exp_f32 v118, v174 clamp
    v_exp_f32 v117, v173 clamp
    v_exp_f32 v119, v175 clamp
    v_max_f32 v172, s6, v172
    v_max_f32 v174, s6, v174
    v_max_f32 v173, s6, v173
    v_max_f32 v175, s6, v175
    v_pk_fma_f32 v[172:173], v[172:173], s[4:5], v[116:117]
    v_pk_fma_f32 v[174:175], v[174:175], s[4:5], v[118:119]
    v_cvt_pk_bf16_f32 v170, v172, v173
    v_cvt_pk_bf16_f32 v171, v174, v175
    v_pk_fma_f32 v[176:177], v[64:65], v[28:29], v[176:177] op_sel:[0,1,0] op_sel_hi:[1,1,1]
    v_pk_fma_f32 v[178:179], v[66:67], v[28:29], v[178:179] op_sel:[0,1,0] op_sel_hi:[1,1,1]
    v_pk_mul_f32 v[176:177], v[176:177], v[240:241]
    v_pk_mul_f32 v[178:179], v[178:179], v[242:243]
    v_exp_f32 v112, v176 clamp
    v_exp_f32 v114, v178 clamp
    v_exp_f32 v113, v177 clamp
    v_exp_f32 v115, v179 clamp
    v_max_f32 v176, s6, v176
    v_max_f32 v178, s6, v178
    v_max_f32 v177, s6, v177
    v_max_f32 v179, s6, v179
    v_pk_fma_f32 v[176:177], v[176:177], s[4:5], v[112:113]
    v_pk_fma_f32 v[178:179], v[178:179], s[4:5], v[114:115]
    v_cvt_pk_bf16_f32 v176, v176, v177
    v_cvt_pk_bf16_f32 v177, v178, v179
    v_pk_fma_f32 v[180:181], v[68:69], v[28:29], v[180:181] op_sel:[0,1,0] op_sel_hi:[1,1,1]
    v_pk_fma_f32 v[182:183], v[70:71], v[28:29], v[182:183] op_sel:[0,1,0] op_sel_hi:[1,1,1]
    v_pk_mul_f32 v[180:181], v[180:181], v[244:245]
    v_pk_mul_f32 v[182:183], v[182:183], v[246:247]
    v_exp_f32 v116, v180 clamp
    v_exp_f32 v118, v182 clamp
    v_exp_f32 v117, v181 clamp
    v_exp_f32 v119, v183 clamp
    v_max_f32 v180, s6, v180
    v_max_f32 v182, s6, v182
    v_max_f32 v181, s6, v181
    v_max_f32 v183, s6, v183
    v_pk_fma_f32 v[180:181], v[180:181], s[4:5], v[116:117]
    v_pk_fma_f32 v[182:183], v[182:183], s[4:5], v[118:119]
    v_cvt_pk_bf16_f32 v178, v180, v181
    v_cvt_pk_bf16_f32 v179, v182, v183
    v_pk_fma_f32 v[184:185], v[72:73], v[28:29], v[184:185] op_sel:[0,1,0] op_sel_hi:[1,1,1]
    v_pk_fma_f32 v[186:187], v[74:75], v[28:29], v[186:187] op_sel:[0,1,0] op_sel_hi:[1,1,1]
    v_pk_mul_f32 v[184:185], v[184:185], v[248:249]
    v_pk_mul_f32 v[186:187], v[186:187], v[250:251]
    v_exp_f32 v112, v184 clamp
    v_exp_f32 v114, v186 clamp
    v_exp_f32 v113, v185 clamp
    v_exp_f32 v115, v187 clamp
    v_max_f32 v184, s6, v184
    v_max_f32 v186, s6, v186
    v_max_f32 v185, s6, v185
    v_max_f32 v187, s6, v187
    v_pk_fma_f32 v[184:185], v[184:185], s[4:5], v[112:113]
    v_pk_fma_f32 v[186:187], v[186:187], s[4:5], v[114:115]
    v_cvt_pk_bf16_f32 v184, v184, v185
    v_cvt_pk_bf16_f32 v185, v186, v187
    v_pk_fma_f32 v[188:189], v[76:77], v[28:29], v[188:189] op_sel:[0,1,0] op_sel_hi:[1,1,1]
    v_pk_fma_f32 v[190:191], v[78:79], v[28:29], v[190:191] op_sel:[0,1,0] op_sel_hi:[1,1,1]
    v_pk_mul_f32 v[188:189], v[188:189], v[252:253]
    v_pk_mul_f32 v[190:191], v[190:191], v[254:255]
    v_exp_f32 v116, v188 clamp
    v_exp_f32 v118, v190 clamp
    v_exp_f32 v117, v189 clamp
    v_exp_f32 v119, v191 clamp
    v_max_f32 v188, s6, v188
    v_max_f32 v190, s6, v190
    v_max_f32 v189, s6, v189
    v_max_f32 v191, s6, v191
    v_pk_fma_f32 v[188:189], v[188:189], s[4:5], v[116:117]
    v_pk_fma_f32 v[190:191], v[190:191], s[4:5], v[118:119]
    v_cvt_pk_bf16_f32 v186, v188, v189
    v_cvt_pk_bf16_f32 v187, v190, v191
    v_pk_fma_f32 v[192:193], v[64:65], v[30:31], v[192:193] op_sel_hi:[1,0,1]
    v_pk_mul_f32 v[192:193], v[192:193], v[224:225]
    v_cvt_pk_bf16_f32 v192, v192, v193
    v_pk_fma_f32 v[194:195], v[66:67], v[30:31], v[194:195] op_sel_hi:[1,0,1]
    v_pk_mul_f32 v[194:195], v[194:195], v[226:227]
    v_cvt_pk_bf16_f32 v193, v194, v195
    v_pk_fma_f32 v[196:197], v[68:69], v[30:31], v[196:197] op_sel_hi:[1,0,1]
    v_pk_mul_f32 v[196:197], v[196:197], v[228:229]
    v_cvt_pk_bf16_f32 v194, v196, v197
    v_pk_fma_f32 v[198:199], v[70:71], v[30:31], v[198:199] op_sel_hi:[1,0,1]
    v_pk_mul_f32 v[198:199], v[198:199], v[230:231]
    v_cvt_pk_bf16_f32 v195, v198, v199
    v_pk_fma_f32 v[200:201], v[72:73], v[30:31], v[200:201] op_sel_hi:[1,0,1]
    v_pk_mul_f32 v[200:201], v[200:201], v[232:233]
    v_cvt_pk_bf16_f32 v200, v200, v201
    v_pk_fma_f32 v[202:203], v[74:75], v[30:31], v[202:203] op_sel_hi:[1,0,1]
    v_pk_mul_f32 v[202:203], v[202:203], v[234:235]
    v_cvt_pk_bf16_f32 v201, v202, v203
    v_pk_fma_f32 v[204:205], v[76:77], v[30:31], v[204:205] op_sel_hi:[1,0,1]
    v_pk_mul_f32 v[204:205], v[204:205], v[236:237]
    v_cvt_pk_bf16_f32 v202, v204, v205
    v_pk_fma_f32 v[206:207], v[78:79], v[30:31], v[206:207] op_sel_hi:[1,0,1]
    v_pk_mul_f32 v[206:207], v[206:207], v[238:239]
    v_cvt_pk_bf16_f32 v203, v206, v207
    v_pk_fma_f32 v[208:209], v[64:65], v[30:31], v[208:209] op_sel:[0,1,0] op_sel_hi:[1,1,1]
    v_pk_mul_f32 v[208:209], v[208:209], v[224:225]
    v_cvt_pk_bf16_f32 v208, v208, v209
    v_pk_fma_f32 v[210:211], v[66:67], v[30:31], v[210:211] op_sel:[0,1,0] op_sel_hi:[1,1,1]
L_walk_13:
    s_cbranch_execz L_walked
    v_pk_mul_f32 v[210:211], v[210:211], v[226:227]
    v_cvt_pk_bf16_f32 v209, v210, v211
    v_pk_fma_f32 v[212:213], v[68:69], v[30:31], v[212:213] op_sel:[0,1,0] op_sel_hi:[1,1,1]
    v_pk_mul_f32 v[212:213], v[212:213], v[228:229]
    v_cvt_pk_bf16_f32 v210, v212, v213
    v_pk_fma_f32 v[214:215], v[70:71], v[30:31], v[214:215] op_sel:[0,1,0] op_sel_hi:[1,1,1]
    v_pk_mul_f32 v[214:215], v[214:215], v[230:231]
    v_cvt_pk_bf16_f32 v211, v214, v215
    v_pk_fma_f32 v[216:217], v[72:73], v[30:31], v[216:217] op_sel:[0,1,0] op_sel_hi:[1,1,1]
    v_pk_mul_f32 v[216:217], v[216:217], v[232:233]
    v_cvt_pk_bf16_f32 v216, v216, v217
    v_pk_fma_f32 v[218:219], v[74:75], v[30:31], v[218:219] op_sel:[0,1,0] op_sel_hi:[1,1,1]
    v_pk_mul_f32 v[218:219], v[218:219], v[234:235]
    v_cvt_pk_bf16_f32 v217, v218, v219
    v_pk_fma_f32 v[220:221], v[76:77], v[30:31], v[220:221] op_sel:[0,1,0] op_sel_hi:[1,1,1]
    v_pk_mul_f32 v[220:221], v[220:221], v[236:237]
    v_cvt_pk_bf16_f32 v218, v220, v221
    v_pk_fma_f32 v[222:223], v[78:79], v[30:31], v[222:223] op_sel:[0,1,0] op_sel_hi:[1,1,1]
    v_pk_mul_f32 v[222:223], v[222:223], v[238:239]
    v_cvt_pk_bf16_f32 v219, v222, v223
    s_cmp_eq_u32 s49, 1
    s_cbranch_scc1 L_kv1
    v_mfma_f32_16x16x32_bf16 v[236:239], v[160:163], v[208:211], 0
    v_mfma_f32_16x16x32_bf16 v[240:243], v[176:179], v[208:211], 0
    v_mfma_f32_16x16x32_bf16 v[244:247], v[176:179], v[120:123], 0
    v_mfma_f32_16x16x32_bf16 v[224:227], v[160:163], v[192:195], 0
    v_mfma_f32_16x16x32_bf16 v[228:231], v[176:179], v[192:195], 0
    v_mfma_f32_16x16x32_bf16 v[232:235], v[160:163], v[120:123], 0
    v_mfma_f32_16x16x32_bf16 v[236:239], v[168:171], v[216:219], v[236:239]
    v_mfma_f32_16x16x32_bf16 v[240:243], v[184:187], v[216:219], v[240:243]
    v_mfma_f32_16x16x32_bf16 v[244:247], v[184:187], v[120:123], v[244:247]
    v_mfma_f32_16x16x32_bf16 v[224:227], v[168:171], v[200:203], v[224:227]
    v_mfma_f32_16x16x32_bf16 v[228:231], v[184:187], v[200:203], v[228:231]
    v_mfma_f32_16x16x32_bf16 v[232:235], v[168:171], v[120:123], v[232:235]
    s_branch L_kvd
L_kv1:
    v_mfma_f32_16x16x32_bf16 v[236:239], v[160:163], v[192:195], 0
    v_mfma_f32_16x16x32_bf16 v[240:243], v[176:179], v[192:195], 0
    v_mfma_f32_16x16x32_bf16 v[244:247], v[160:163], v[120:123], 0
    v_mfma_f32_16x16x32_bf16 v[224:227], v[160:163], v[208:211], 0
    v_mfma_f32_16x16x32_bf16 v[228:231], v[176:179], v[208:211], 0
    v_mfma_f32_16x16x32_bf16 v[232:235], v[176:179], v[120:123], 0
    v_mfma_f32_16x16x32_bf16 v[236:239], v[168:171], v[200:203], v[236:239]
    v_mfma_f32_16x16x32_bf16 v[240:243], v[184:187], v[200:203], v[240:243]
    v_mfma_f32_16x16x32_bf16 v[244:247], v[168:171], v[120:123], v[244:247]
    v_mfma_f32_16x16x32_bf16 v[224:227], v[168:171], v[216:219], v[224:227]
    v_mfma_f32_16x16x32_bf16 v[228:231], v[184:187], v[216:219], v[228:231]
    v_mfma_f32_16x16x32_bf16 v[232:235], v[184:187], v[120:123], v[232:235]
L_kvd:
    s_nop 2
    ds_write_b128 v24, v[236:239] offset:0
    ds_write_b128 v24, v[240:243] offset:1024
    ds_write_b128 v24, v[244:247] offset:2048
    ds_write_b32 v12, v12
L_xkv:
    ds_read_b32 v14, v13
    ds_read_b128 v[236:239], v25 offset:0
    ds_read_b128 v[240:243], v25 offset:1024
    ds_read_b128 v[244:247], v25 offset:2048
    s_waitcnt lgkmcnt(0)
    v_cmp_eq_u32 vcc, 0, v14
    s_cbranch_vccz L_ok_2
    s_sub_u32 s56, s56, 1
    s_cbranch_scc0 L_xkv
    s_mov_b32 s56, 0
L_ok_2:
    v_pk_add_f32 v[224:225], v[224:225], v[236:237]
    v_pk_add_f32 v[226:227], v[226:227], v[238:239]
    v_pk_add_f32 v[228:229], v[228:229], v[240:241]
    v_pk_add_f32 v[230:231], v[230:231], v[242:243]
    v_pk_add_f32 v[232:233], v[232:233], v[244:245]
    v_pk_add_f32 v[234:235], v[234:235], v[246:247]
    v_cvt_pk_bf16_f32 v248, v224, v225
    v_cvt_pk_bf16_f32 v249, v226, v227
    v_cvt_pk_bf16_f32 v250, v228, v229
    v_cvt_pk_bf16_f32 v251, v230, v231
    buffer_store_dwordx4 v[248:251], v26, s[16:19], 0 offen sc1
    buffer_store_dwordx4 v[232:235], v27, s[16:19], 0 offen sc1
    buffer_atomic_swap v17, v19, s[16:19], 0 offen sc1
    v_mfma_f32_16x16x32_bf16 v[128:131], v[56:59], v[40:43], v[128:131]
    v_mfma_f32_16x16x32_bf16 v[144:147], v[60:63], v[40:43], v[144:147]
    v_mfma_f32_16x16x32_bf16 v[148:151], v[60:63], v[44:47], v[148:151]
    v_mfma_f32_16x16x32_bf16 v[132:135], v[56:59], v[44:47], v[132:135]
    v_mfma_f32_16x16x32_bf16 v[136:139], v[56:59], v[48:51], v[136:139]
    v_mfma_f32_16x16x32_bf16 v[152:155], v[60:63], v[48:51], v[152:155]
    v_mfma_f32_16x16x32_bf16 v[156:159], v[60:63], v[52:55], v[156:159]
    v_mfma_f32_16x16x32_bf16 v[140:143], v[56:59], v[52:55], v[140:143]
    v_mfma_f32_16x16x32_bf16 v[128:131], v[96:99], v[80:83], v[128:131]
    v_mfma_f32_16x16x32_bf16 v[144:147], v[100:103], v[80:83], v[144:147]
    v_mfma_f32_16x16x32_bf16 v[148:151], v[100:103], v[84:87], v[148:151]
    v_mfma_f32_16x16x32_bf16 v[132:135], v[96:99], v[84:87], v[132:135]
    v_mfma_f32_16x16x32_bf16 v[136:139], v[96:99], v[88:91], v[136:139]
    v_mfma_f32_16x16x32_bf16 v[152:155], v[100:103], v[88:91], v[152:155]
    v_mfma_f32_16x16x32_bf16 v[156:159], v[100:103], v[92:95], v[156:159]
    v_mfma_f32_16x16x32_bf16 v[140:143], v[96:99], v[92:95], v[140:143]
    s_nop 0
    v_pk_fma_f32 v[128:129], v[32:33], v[104:105], v[128:129] op_sel_hi:[1,0,1]
    v_pk_fma_f32 v[130:131], v[34:35], v[104:105], v[130:131] op_sel_hi:[1,0,1]
    v_pk_mul_f32 v[128:129], v[128:129], v[124:125] op_sel_hi:[1,0]
    v_pk_mul_f32 v[130:131], v[130:131], v[124:125] op_sel_hi:[1,0]
    v_exp_f32 v112, v128 clamp
    v_exp_f32 v114, v130 clamp
    v_exp_f32 v113, v129 clamp
    v_exp_f32 v115, v131 clamp
    v_max_f32 v128, s6, v128
    v_max_f32 v130, s6, v130
    v_max_f32 v129, s6, v129
    v_max_f32 v131, s6, v131
    v_pk_fma_f32 v[128:129], v[128:129], s[4:5], v[112:113]
    v_pk_fma_f32 v[130:131], v[130:131], s[4:5], v[114:115]
    v_cvt_pk_bf16_f32 v192, v128, v129
    v_cvt_pk_bf16_f32 v193, v130, v131
    v_pk_fma_f32 v[144:145], v[36:37], v[104:105], v[144:145] op_sel_hi:[1,0,1]
    v_pk_fma_f32 v[146:147], v[38:39], v[104:105], v[146:147] op_sel_hi:[1,0,1]
    v_pk_mul_f32 v[144:145], v[144:145], v[124:125] op_sel_hi:[1,0]
    v_pk_mul_f32 v[146:147], v[146:147], v[124:125] op_sel_hi:[1,0]
    v_exp_f32 v116, v144 clamp
    v_exp_f32 v118, v146 clamp
    v_exp_f32 v117, v145 clamp
    v_exp_f32 v119, v147 clamp
    v_max_f32 v144, s6, v144
    v_max_f32 v146, s6, v146
    v_max_f32 v145, s6, v145
    v_max_f32 v147, s6, v147
    v_pk_fma_f32 v[144:145], v[144:145], s[4:5], v[116:117]
    v_pk_fma_f32 v[146:147], v[146:147], s[4:5], v[118:119]
    v_cvt_pk_bf16_f32 v194, v144, v145
    v_cvt_pk_bf16_f32 v195, v146, v147
    v_pk_fma_f32 v[132:133], v[32:33], v[104:105], v[132:133] op_sel:[0,1,0] op_sel_hi:[1,1,1]
    v_pk_fma_f32 v[134:135], v[34:35], v[104:105], v[134:135] op_sel:[0,1,0] op_sel_hi:[1,1,1]
    v_pk_mul_f32 v[132:133], v[132:133], v[124:125] op_sel:[0,1] op_sel_hi:[1,1]
    v_pk_mul_f32 v[134:135], v[134:135], v[124:125] op_sel:[0,1] op_sel_hi:[1,1]
    v_exp_f32 v112, v132 clamp
    v_exp_f32 v114, v134 clamp
    v_exp_f32 v113, v133 clamp
    v_exp_f32 v115, v135 clamp
    v_max_f32 v132, s6, v132
    v_max_f32 v134, s6, v134
    v_max_f32 v133, s6, v133
    v_max_f32 v135, s6, v135
    v_pk_fma_f32 v[132:133], v[132:133], s[4:5], v[112:113]
    v_pk_fma_f32 v[134:135], v[134:135], s[4:5], v[114:115]
    v_cvt_pk_bf16_f32 v196, v132, v133
    v_cvt_pk_bf16_f32 v197, v134, v135
    v_pk_fma_f32 v[148:149], v[36:37], v[104:105], v[148:149] op_sel:[0,1,0] op_sel_hi:[1,1,1]
    v_pk_fma_f32 v[150:151], v[38:39], v[104:105], v[150:151] op_sel:[0,1,0] op_sel_hi:[1,1,1]
    v_pk_mul_f32 v[148:149], v[148:149], v[124:125] op_sel:[0,1] op_sel_hi:[1,1]
    v_pk_mul_f32 v[150:151], v[150:151], v[124:125] op_sel:[0,1] op_sel_hi:[1,1]
    v_exp_f32 v116, v148 clamp
    v_exp_f32 v118, v150 clamp
    v_exp_f32 v117, v149 clamp
L_walk_14:
    s_cbranch_execz L_walked
    v_exp_f32 v119, v151 clamp
    v_max_f32 v148, s6, v148
    v_max_f32 v150, s6, v150
    v_max_f32 v149, s6, v149
    v_max_f32 v151, s6, v151
    v_pk_fma_f32 v[148:149], v[148:149], s[4:5], v[116:117]
    v_pk_fma_f32 v[150:151], v[150:151], s[4:5], v[118:119]
    v_cvt_pk_bf16_f32 v198, v148, v149
    v_cvt_pk_bf16_f32 v199, v150, v151
    v_pk_fma_f32 v[136:137], v[32:33], v[106:107], v[136:137] op_sel_hi:[1,0,1]
    v_pk_fma_f32 v[138:139], v[34:35], v[106:107], v[138:139] op_sel_hi:[1,0,1]
    v_pk_mul_f32 v[136:137], v[136:137], v[126:127] op_sel_hi:[1,0]
    v_pk_mul_f32 v[138:139], v[138:139], v[126:127] op_sel_hi:[1,0]
    v_exp_f32 v112, v136 clamp
    v_exp_f32 v114, v138 clamp
    v_exp_f32 v113, v137 clamp
    v_exp_f32 v115, v139 clamp
    v_max_f32 v136, s6, v136
    v_max_f32 v138, s6, v138
    v_max_f32 v137, s6, v137
    v_max_f32 v139, s6, v139
    v_pk_fma_f32 v[136:137], v[136:137], s[4:5], v[112:113]
    v_pk_fma_f32 v[138:139], v[138:139], s[4:5], v[114:115]
    v_cvt_pk_bf16_f32 v200, v136, v137
    v_cvt_pk_bf16_f32 v201, v138, v139
    v_pk_fma_f32 v[152:153], v[36:37], v[106:107], v[152:153] op_sel_hi:[1,0,1]
    v_pk_fma_f32 v[154:155], v[38:39], v[106:107], v[154:155] op_sel_hi:[1,0,1]
    v_pk_mul_f32 v[152:153], v[152:153], v[126:127] op_sel_hi:[1,0]
    v_pk_mul_f32 v[154:155], v[154:155], v[126:127] op_sel_hi:[1,0]
    v_exp_f32 v116, v152 clamp
    v_exp_f32 v118, v154 clamp
    v_exp_f32 v117, v153 clamp
    v_exp_f32 v119, v155 clamp
    v_max_f32 v152, s6, v152
    v_max_f32 v154, s6, v154
    v_max_f32 v153, s6, v153
    v_max_f32 v155, s6, v155
    v_pk_fma_f32 v[152:153], v[152:153], s[4:5], v[116:117]
    v_pk_fma_f32 v[154:155], v[154:155], s[4:5], v[118:119]
    v_cvt_pk_bf16_f32 v202, v152, v153
    v_cvt_pk_bf16_f32 v203, v154, v155
    v_pk_fma_f32 v[140:141], v[32:33], v[106:107], v[140:141] op_sel:[0,1,0] op_sel_hi:[1,1,1]
    v_pk_fma_f32 v[142:143], v[34:35], v[106:107], v[142:143] op_sel:[0,1,0] op_sel_hi:[1,1,1]
    v_pk_mul_f32 v[140:141], v[140:141], v[126:127] op_sel:[0,1] op_sel_hi:[1,1]
    v_pk_mul_f32 v[142:143], v[142:143], v[126:127] op_sel:[0,1] op_sel_hi:[1,1]
    v_exp_f32 v112, v140 clamp
    v_exp_f32 v114, v142 clamp
    v_exp_f32 v113, v141 clamp
    v_exp_f32 v115, v143 clamp
    v_max_f32 v140, s6, v140
    v_max_f32 v142, s6, v142
    v_max_f32 v141, s6, v141
    v_max_f32 v143, s6, v143
    v_pk_fma_f32 v[140:141], v[140:141], s[4:5], v[112:113]
    v_pk_fma_f32 v[142:143], v[142:143], s[4:5], v[114:115]
    v_cvt_pk_bf16_f32 v204, v140, v141
    v_cvt_pk_bf16_f32 v205, v142, v143
    v_pk_fma_f32 v[156:157], v[36:37], v[106:107], v[156:157] op_sel:[0,1,0] op_sel_hi:[1,1,1]
    v_pk_fma_f32 v[158:159], v[38:39], v[106:107], v[158:159] op_sel:[0,1,0] op_sel_hi:[1,1,1]
    v_pk_mul_f32 v[156:157], v[156:157], v[126:127] op_sel:[0,1] op_sel_hi:[1,1]
    v_pk_mul_f32 v[158:159], v[158:159], v[126:127] op_sel:[0,1] op_sel_hi:[1,1]
    v_exp_f32 v116, v156 clamp
    v_exp_f32 v118, v158 clamp
    v_exp_f32 v117, v157 clamp
    v_exp_f32 v119, v159 clamp
    v_max_f32 v156, s6, v156
    v_max_f32 v158, s6, v158
    v_max_f32 v157, s6, v157
    v_max_f32 v159, s6, v159
    v_pk_fma_f32 v[156:157], v[156:157], s[4:5], v[116:117]
    v_pk_fma_f32 v[158:159], v[158:159], s[4:5], v[118:119]
    v_cvt_pk_bf16_f32 v206, v156, v157
    v_cvt_pk_bf16_f32 v207, v158, v159
    s_lshr_b32 s62, s3, 2
    s_lshl_b32 s53, s51, 3
    s_lshl_b32 s86, s48, 1
    s_add_u32 s53, s53, s86
    s_add_u32 s53, s53, s62
    v_lshrrev_b32 v36, 4, v0
    v_and_b32 v37, 15, v0
    s_lshl_b32 s87, s53, 15
    s_lshl_b32 s86, s62, 14
    s_add_u32 s86, s86, s87
    s_add_u32 s86, s86, 1048576
    v_lshl_add_u32 v157, v0, 4, s86
    v_xor_b32 v158, 0x8000, v157
    s_lshl_b32 s86, s51, 1
    s_lshr_b32 s87, s48, 1
    s_add_u32 s86, s86, s87
    s_lshl_b32 s86, s86, 1
    s_add_u32 s86, s86, s62
    s_lshl_b32 s86, s86, 1
    s_and_b32 s87, s48, 1
    s_add_u32 s86, s86, s87
    s_lshl_b32 s86, s86, 7
    s_add_u32 s86, s86, 688128
    v_lshl_add_u32 v159, v0, 2, s86
    v_mov_b32 v38, 2147483648
    v_cmp_gt_u32 vcc, 16, v0
    s_nop 1
    v_cndmask_b32 v159, v38, v159, vcc
    v_bfe_u32 v38, v0, 2, 2
    v_lshl_add_u32 v38, v36, 2, v38
    v_bfe_u32 v39, v38, 1, 2
    v_lshlrev_b32 v38, 7, v38
    v_lshl_add_u32 v38, v39, 5, v38
    v_and_b32 v39, 3, v0
    v_lshl_add_u32 v38, v39, 3, v38
    s_lshl_b32 s86, s62, 16
    s_add_u32 s86, s86, 0
    v_add_u32 v144, s86, v38
    v_xor_b32 v145, 32, v144
    v_xor_b32 v146, 64, v144
    v_xor_b32 v147, 96, v144
    v_cmp_eq_u32 s[4:5], 1, v39
    v_cmp_eq_u32 s[6:7], 2, v39
    v_cmp_eq_u32 s[98:99], 3, v39
    s_lshl_b32 s86, s53, 10
    s_add_u32 s86, s86, 786432
    v_lshl_add_u32 v160, v0, 2, s86
    v_mul_u32_u24 v161, 192, v36
    v_add_u32 v160, v160, v161
    s_mov_b32 s72, 0x00f0000f
    s_mov_b32 s73, 0xf0000f00
    s_mov_b32 s74, 0x000ff000
    s_mov_b32 s75, 0x0f0000f0
    v_lshrrev_b32 v38, 2, v37
    v_lshl_add_u32 v161, v38, 4, v37
    v_lshlrev_b32 v161, 2, v161
    s_lshl_b32 s86, s3, 12
    s_add_u32 s86, s86, 131072
    v_lshl_add_u32 v162, v0, 4, s86
    v_xor_b32 v163, 0x4000, v162
    s_lshl_b32 s86, s52, 7
    v_lshl_add_u32 v36, v36, 3, s86
    s_lshl_b32 s87, s53, 15
    s_add_u32 s87, s87, s86
    s_lshl_b32 s86, s62, 6
    s_add_u32 s87, s87, s86
    v_lshl_add_u32 v39, v37, 11, s87
    v_and_b32 v38, 48, v0
    v_add_u32 v39, v39, v38
    v_xor_b32 v37, 0x8000, v39
    buffer_load_dwordx4 v[136:139], v39, s[8:11], 0 offen
    buffer_load_dwordx4 v[140:143], v37, s[8:11], 0 offen
    buffer_load_dwordx2 v[148:149], v36, s[40:43], 0 offen offset:0
    buffer_load_dwordx2 v[150:151], v36, s[40:43], 0 offen offset:32
    buffer_load_dwordx2 v[152:153], v36, s[40:43], 0 offen offset:64
    buffer_load_dwordx2 v[154:155], v36, s[40:43], 0 offen offset:96
    s_barrier
    ds_read_b128 v[40:43], v20 offset:0
    ds_read_b128 v[44:47], v20 offset:1024
    ds_read_b128 v[48:51], v20 offset:2048
    v_mov_b32 v38, 135200
    ds_read_b32 v38, v38
    s_mov_b32 s86, 0x8000
    s_mov_b32 s87, 0x10000
    s_mov_b32 s88, 0x18000
    s_waitcnt lgkmcnt(0)
    v_mfma_f32_16x16x32_bf16 v[216:219], v[48:51], v[192:195], 0
    v_mfma_f32_16x16x32_bf16 v[208:211], v[40:43], v[192:195], 0
    v_mfma_f32_16x16x32_bf16 v[212:215], v[44:47], v[192:195], 0
    v_mfma_f32_16x16x32_bf16 v[228:231], v[48:51], v[196:199], 0
    v_mfma_f32_16x16x32_bf16 v[220:223], v[40:43], v[196:199], 0
    v_mfma_f32_16x16x32_bf16 v[224:227], v[44:47], v[196:199], 0
    v_mfma_f32_16x16x32_bf16 v[240:243], v[48:51], v[200:203], 0
    v_mfma_f32_16x16x32_bf16 v[232:235], v[40:43], v[200:203], 0
L_walkB4:
    s_cbranch_execz L_walk_19
    v_mfma_f32_16x16x32_bf16 v[236:239], v[44:47], v[200:203], 0
    v_mfma_f32_16x16x32_bf16 v[252:255], v[48:51], v[204:207], 0
    v_mfma_f32_16x16x32_bf16 v[244:247], v[40:43], v[204:207], 0
    v_mfma_f32_16x16x32_bf16 v[248:251], v[44:47], v[204:207], 0
    v_add_f32 v216, s54, v216
    v_rcp_f32 v216, v216
    s_nop 0
    v_pk_mul_f32 v[208:209], v[208:209], v[216:217] op_sel_hi:[1,0]
    v_pk_mul_f32 v[210:211], v[210:211], v[216:217] op_sel_hi:[1,0]
    v_pk_mul_f32 v[212:213], v[212:213], v[216:217] op_sel_hi:[1,0]
    v_pk_mul_f32 v[214:215], v[214:215], v[216:217] op_sel_hi:[1,0]
    v_cvt_pk_bf16_f32 v60, v208, v209
    v_cvt_pk_bf16_f32 v61, v210, v211
    v_cvt_pk_bf16_f32 v62, v212, v213
    v_cvt_pk_bf16_f32 v63, v214, v215
    buffer_store_dwordx4 v[60:63], v23, s[16:19], 0 offen sc1
    v_add_f32 v228, s54, v228
    v_rcp_f32 v228, v228
    s_nop 0
    v_pk_mul_f32 v[220:221], v[220:221], v[228:229] op_sel_hi:[1,0]
    v_pk_mul_f32 v[222:223], v[222:223], v[228:229] op_sel_hi:[1,0]
    v_pk_mul_f32 v[224:225], v[224:225], v[228:229] op_sel_hi:[1,0]
    v_pk_mul_f32 v[226:227], v[226:227], v[228:229] op_sel_hi:[1,0]
    v_cvt_pk_bf16_f32 v64, v220, v221
    v_cvt_pk_bf16_f32 v65, v222, v223
    v_cvt_pk_bf16_f32 v66, v224, v225
    v_cvt_pk_bf16_f32 v67, v226, v227
    buffer_store_dwordx4 v[64:67], v23, s[16:19], s86 offen sc1
    v_add_f32 v240, s54, v240
    v_rcp_f32 v240, v240
    s_nop 0
    v_pk_mul_f32 v[232:233], v[232:233], v[240:241] op_sel_hi:[1,0]
    v_pk_mul_f32 v[234:235], v[234:235], v[240:241] op_sel_hi:[1,0]
    v_pk_mul_f32 v[236:237], v[236:237], v[240:241] op_sel_hi:[1,0]
    v_pk_mul_f32 v[238:239], v[238:239], v[240:241] op_sel_hi:[1,0]
    v_cvt_pk_bf16_f32 v68, v232, v233
    v_cvt_pk_bf16_f32 v69, v234, v235
    v_cvt_pk_bf16_f32 v70, v236, v237
    v_cvt_pk_bf16_f32 v71, v238, v239
    buffer_store_dwordx4 v[68:71], v23, s[16:19], s87 offen sc1
    v_add_f32 v252, s54, v252
    v_rcp_f32 v252, v252
    s_nop 0
    v_pk_mul_f32 v[244:245], v[244:245], v[252:253] op_sel_hi:[1,0]
    v_pk_mul_f32 v[246:247], v[246:247], v[252:253] op_sel_hi:[1,0]
    v_pk_mul_f32 v[248:249], v[248:249], v[252:253] op_sel_hi:[1,0]
    v_pk_mul_f32 v[250:251], v[250:251], v[252:253] op_sel_hi:[1,0]
    v_cvt_pk_bf16_f32 v72, v244, v245
    v_cvt_pk_bf16_f32 v73, v246, v247
    v_cvt_pk_bf16_f32 v74, v248, v249
    v_cvt_pk_bf16_f32 v75, v250, v251
    buffer_store_dwordx4 v[72:75], v23, s[16:19], s88 offen sc1
    buffer_atomic_swap v17, v18, s[16:19], 0 offen sc1
    v_mov_b32 v8, 0
    buffer_atomic_or v8, v159, s[16:19], 0 offen sc0 sc1
    v_mov_b32 v14, 2147483648
    v_mov_b32 v11, 2147483648
    s_waitcnt vmcnt(6)
    v_bfe_u32 v36, v0, 2, 1
    v_cmp_eq_u32 vcc, 1, v36
    v_mov_b32 v36, s95
    s_nop 0
    v_cndmask_b32 v148, v36, v148, vcc
    v_cndmask_b32 v149, v36, v149, vcc
    v_cndmask_b32 v150, v36, v150, vcc
    v_cndmask_b32 v151, v36, v151, vcc
    v_cndmask_b32 v152, v36, v152, vcc
    v_cndmask_b32 v153, v36, v153, vcc
    v_cndmask_b32 v154, v36, v154, vcc
    v_cndmask_b32 v155, v36, v155, vcc
    v_readfirstlane_b32 s57, v38
L_phaseB:
    v_lshrrev_b32 v1, 4, v0
    v_and_b32 v2, 15, v0
    v_mov_b32 v3, 0x3f80
    s_lshl_b32 s87, s53, 4
    v_add_u32 v6, s87, v2
    s_lshl_b32 s86, s52, 7
    v_lshl_add_u32 v5, v6, 11, s86
    v_sub_u32 v6, 2047, v6
    v_mov_b32 v7, v39
    v_lshrrev_b32 v9, 1, v1
    v_lshl_add_u32 v5, v9, 4, v5
    v_and_b32 v9, 1, v1
    v_lshl_add_u32 v5, v9, 5, v5
    s_mov_b32 s67, 0
    s_mov_b32 s66, 0xffffaaaa
    s_mov_b32 s63, 0
    s_lshl2_add_u32 s86, s3, 163776
    v_mov_b32 v12, s86
    s_cmp_eq_u32 s62, 0
    s_cselect_b64 vcc, -1, 0
    v_cndmask_b32 v12, v12, v162, vcc
    v_mov_b32 v13, 163792
L_b_init:
    v_bfe_u32 v9, v0, 3, 1
    v_bfe_u32 v10, v0, 4, 1
    v_xor_b32 v9, v9, v10
    v_bfe_u32 v10, v0, 1, 2
    v_lshl_add_u32 v9, v9, 3, v10
    v_lshrrev_b32 v10, 5, v0
    v_lshl_add_u32 v9, v10, 2, v9
    v_and_b32 v10, 1, v0
    v_lshlrev_b32 v10, 4, v10
    v_lshlrev_b32 v10, v10, v3
    v_cmp_eq_u32 vcc, 0, v9
    s_nop 1
    v_cndmask_b32 v128, 0, v10, vcc
    v_cmp_eq_u32 vcc, 1, v9
    s_nop 1
    v_cndmask_b32 v129, 0, v10, vcc
    v_cmp_eq_u32 vcc, 2, v9
    s_nop 1
    v_cndmask_b32 v130, 0, v10, vcc
    v_cmp_eq_u32 vcc, 3, v9
    s_nop 1
    v_cndmask_b32 v131, 0, v10, vcc
    v_cmp_eq_u32 vcc, 4, v9
    s_nop 1
    v_cndmask_b32 v132, 0, v10, vcc
    v_cmp_eq_u32 vcc, 5, v9
    s_nop 1
    v_cndmask_b32 v133, 0, v10, vcc
    v_cmp_eq_u32 vcc, 6, v9
    s_nop 1
    v_cndmask_b32 v134, 0, v10, vcc
    v_cmp_eq_u32 vcc, 7, v9
    s_nop 1
    v_cndmask_b32 v135, 0, v10, vcc
    v_mov_b32 v80, 0
    v_mov_b32 v81, 0
    v_mov_b32 v82, 0
    v_mov_b32 v83, 0
    v_mov_b32 v84, 0
    v_mov_b32 v85, 0
    v_mov_b32 v86, 0
    v_mov_b32 v87, 0
    v_mov_b32 v88, 0
    v_mov_b32 v89, 0
    v_mov_b32 v90, 0
    v_mov_b32 v91, 0
    v_mov_b32 v92, 0
    v_mov_b32 v93, 0
    v_mov_b32 v94, 0
    v_mov_b32 v95, 0
    v_mov_b32 v96, 0
    v_mov_b32 v97, 0
    v_mov_b32 v98, 0
    v_mov_b32 v99, 0
    v_mov_b32 v100, 0
    v_mov_b32 v101, 0
    v_mov_b32 v102, 0
    v_mov_b32 v103, 0
    v_mov_b32 v104, 0
    v_mov_b32 v105, 0
    v_mov_b32 v106, 0
    v_mov_b32 v107, 0
    v_mov_b32 v108, 0
    v_mov_b32 v109, 0
    v_mov_b32 v110, 0
    v_mov_b32 v111, 0
    v_mov_b32 v156, 0
    s_branch L_b_w0
L_b_r0:
    s_ff1_i32_b32 s91, s65
    s_bitset0_b32 s65, s91
    s_lshl_b32 s76, s91, 12
    s_lshl_b32 s91, s91, 10
    buffer_load_dwordx4 v[16:19], v157, s[16:19], s91 offen offset:0 sc1
    buffer_load_dwordx4 v[20:23], v158, s[16:19], s91 offen offset:0 sc1
    buffer_load_dwordx4 v[24:27], v157, s[16:19], s91 offen offset:1024 sc1
    buffer_load_dwordx4 v[28:31], v158, s[16:19], s91 offen offset:1024 sc1
    s_cmp_eq_u32 s65, 0
    s_cbranch_scc1 L_b_p1
L_b_r1:
    s_ff1_i32_b32 s91, s65
    s_bitset0_b32 s65, s91
    s_lshl_b32 s77, s91, 12
    s_lshl_b32 s91, s91, 10
    buffer_load_dwordx4 v[32:35], v157, s[16:19], s91 offen offset:0 sc1
    buffer_load_dwordx4 v[36:39], v158, s[16:19], s91 offen offset:0 sc1
    buffer_load_dwordx4 v[40:43], v157, s[16:19], s91 offen offset:1024 sc1
    buffer_load_dwordx4 v[44:47], v158, s[16:19], s91 offen offset:1024 sc1
    s_cmp_le_u32 s62, s63
    s_cbranch_scc1 L_b_wok
L_b_wf:
    ds_read_b128 v[112:115], v13
    s_waitcnt lgkmcnt(0)
    v_min3_u32 v112, v112, v113, v114
    v_min_u32 v112, v112, v115
    v_cmp_eq_u32 vcc, 0, v112
    s_cbranch_vccz L_ok_3
    s_sub_u32 s56, s56, 1
    s_cbranch_scc0 L_b_wf
    s_mov_b32 s56, 0
L_ok_3:
L_b_wok:
    s_xor_b32 s89, s67, s76
    s_mov_b32 s67, s76
    v_xor_b32 v144, s89, v144
    ds_read_b64_tr_b16 v[112:113], v144 offset:0
    ds_read_b64_tr_b16 v[114:115], v144 offset:2048
    v_xor_b32 v145, s89, v145
    ds_read_b64_tr_b16 v[116:117], v145 offset:0
    ds_read_b64_tr_b16 v[118:119], v145 offset:2048
L_walkB5:
    s_cbranch_execz L_walk_20
    v_xor_b32 v146, s89, v146
    ds_read_b64_tr_b16 v[120:121], v146 offset:0
    ds_read_b64_tr_b16 v[122:123], v146 offset:2048
    v_xor_b32 v147, s89, v147
    ds_read_b64_tr_b16 v[124:125], v147 offset:0
    ds_read_b64_tr_b16 v[126:127], v147 offset:2048
    s_cmp_eq_u32 s62, 0
    s_cbranch_scc0 L_b_x1
    v_mfma_f32_16x16x32_bf16 v[80:83], v[128:131], v[136:139], 0
    v_mfma_f32_16x16x32_bf16 v[96:99], v[128:131], v[140:143], 0
    v_mfma_f32_16x16x32_bf16 v[84:87], v[132:135], v[136:139], 0
    v_mfma_f32_16x16x32_bf16 v[100:103], v[132:135], v[140:143], 0
    s_branch L_b_xd
L_b_x1:
    s_setprio 1
    v_mfma_f32_16x16x32_bf16 v[88:91], v[128:131], v[136:139], 0
    v_mfma_f32_16x16x32_bf16 v[104:107], v[128:131], v[140:143], 0
    v_mfma_f32_16x16x32_bf16 v[92:95], v[132:135], v[136:139], 0
    v_mfma_f32_16x16x32_bf16 v[108:111], v[132:135], v[140:143], 0
L_b_xd:
    s_waitcnt vmcnt(6) lgkmcnt(6)
    v_max3_u32 v156, v156, v19, v23
    v_mfma_f32_16x16x32_bf16 v[80:83], v[112:115], v[16:19], v[80:83]
    ds_read_b64_tr_b16 v[128:129], v144 offset:4096
    v_mfma_f32_16x16x32_bf16 v[96:99], v[112:115], v[20:23], v[96:99]
    ds_read_b64_tr_b16 v[130:131], v144 offset:6144
    s_waitcnt lgkmcnt(6)
    v_mfma_f32_16x16x32_bf16 v[84:87], v[116:119], v[16:19], v[84:87]
    ds_read_b64_tr_b16 v[132:133], v145 offset:4096
    v_mfma_f32_16x16x32_bf16 v[100:103], v[116:119], v[20:23], v[100:103]
    ds_read_b64_tr_b16 v[134:135], v145 offset:6144
    s_waitcnt lgkmcnt(6)
    v_mfma_f32_16x16x32_bf16 v[88:91], v[120:123], v[16:19], v[88:91]
    ds_read_b64_tr_b16 v[136:137], v146 offset:4096
    v_mfma_f32_16x16x32_bf16 v[104:107], v[120:123], v[20:23], v[104:107]
    ds_read_b64_tr_b16 v[138:139], v146 offset:6144
    s_waitcnt lgkmcnt(6)
    v_mfma_f32_16x16x32_bf16 v[92:95], v[124:127], v[16:19], v[92:95]
    ds_read_b64_tr_b16 v[140:141], v147 offset:4096
    v_mfma_f32_16x16x32_bf16 v[108:111], v[124:127], v[20:23], v[108:111]
    ds_read_b64_tr_b16 v[142:143], v147 offset:6144
    s_not_b32 s91, s66
    s_cmp_eq_u32 s65, 0
    s_cselect_b32 s65, s91, s65
    s_cselect_b32 s66, -1, s66
    s_ff1_i32_b32 s91, s65
    s_bitset0_b32 s65, s91
    s_lshl_b32 s78, s91, 12
    s_lshl_b32 s91, s91, 10
    buffer_load_dwordx4 v[48:51], v157, s[16:19], s91 offen offset:0 sc1
    buffer_load_dwordx4 v[52:55], v158, s[16:19], s91 offen offset:0 sc1
    s_waitcnt vmcnt(6) lgkmcnt(6)
    v_max3_u32 v156, v156, v27, v31
    v_mfma_f32_16x16x32_bf16 v[80:83], v[128:131], v[24:27], v[80:83]
    s_xor_b32 s89, s67, s77
    s_mov_b32 s67, s77
    v_xor_b32 v144, s89, v144
    ds_read_b64_tr_b16 v[112:113], v144 offset:0
    v_mfma_f32_16x16x32_bf16 v[96:99], v[128:131], v[28:31], v[96:99]
    ds_read_b64_tr_b16 v[114:115], v144 offset:2048
    s_waitcnt lgkmcnt(6)
    v_mfma_f32_16x16x32_bf16 v[84:87], v[132:135], v[24:27], v[84:87]
    v_xor_b32 v145, s89, v145
    ds_read_b64_tr_b16 v[116:117], v145 offset:0
    v_mfma_f32_16x16x32_bf16 v[100:103], v[132:135], v[28:31], v[100:103]
    ds_read_b64_tr_b16 v[118:119], v145 offset:2048
    s_waitcnt lgkmcnt(6)
    v_mfma_f32_16x16x32_bf16 v[88:91], v[136:139], v[24:27], v[88:91]
    v_xor_b32 v146, s89, v146
    ds_read_b64_tr_b16 v[120:121], v146 offset:0
    v_mfma_f32_16x16x32_bf16 v[104:107], v[136:139], v[28:31], v[104:107]
    ds_read_b64_tr_b16 v[122:123], v146 offset:2048
    s_waitcnt lgkmcnt(6)
    v_mfma_f32_16x16x32_bf16 v[92:95], v[140:143], v[24:27], v[92:95]
    v_xor_b32 v147, s89, v147
    ds_read_b64_tr_b16 v[124:125], v147 offset:0
    v_mfma_f32_16x16x32_bf16 v[108:111], v[140:143], v[28:31], v[108:111]
    ds_read_b64_tr_b16 v[126:127], v147 offset:2048
    buffer_load_dwordx4 v[56:59], v157, s[16:19], s91 offen offset:1024 sc1
    buffer_load_dwordx4 v[60:63], v158, s[16:19], s91 offen offset:1024 sc1
    s_waitcnt vmcnt(6) lgkmcnt(6)
    v_max3_u32 v156, v156, v35, v39
    v_mfma_f32_16x16x32_bf16 v[80:83], v[112:115], v[32:35], v[80:83]
    ds_read_b64_tr_b16 v[128:129], v144 offset:4096
    v_mfma_f32_16x16x32_bf16 v[96:99], v[112:115], v[36:39], v[96:99]
    ds_read_b64_tr_b16 v[130:131], v144 offset:6144
    s_waitcnt lgkmcnt(6)
    v_mfma_f32_16x16x32_bf16 v[84:87], v[116:119], v[32:35], v[84:87]
    ds_read_b64_tr_b16 v[132:133], v145 offset:4096
    v_mfma_f32_16x16x32_bf16 v[100:103], v[116:119], v[36:39], v[100:103]
    ds_read_b64_tr_b16 v[134:135], v145 offset:6144
    s_waitcnt lgkmcnt(6)
    v_mfma_f32_16x16x32_bf16 v[88:91], v[120:123], v[32:35], v[88:91]
    ds_read_b64_tr_b16 v[136:137], v146 offset:4096
    v_mfma_f32_16x16x32_bf16 v[104:107], v[120:123], v[36:39], v[104:107]
    ds_read_b64_tr_b16 v[138:139], v146 offset:6144
    s_waitcnt lgkmcnt(6)
    v_mfma_f32_16x16x32_bf16 v[92:95], v[124:127], v[32:35], v[92:95]
    ds_read_b64_tr_b16 v[140:141], v147 offset:4096
    v_mfma_f32_16x16x32_bf16 v[108:111], v[124:127], v[36:39], v[108:111]
    ds_read_b64_tr_b16 v[142:143], v147 offset:6144
    s_not_b32 s91, s66
    s_cmp_eq_u32 s65, 0
    s_cselect_b32 s65, s91, s65
    s_cselect_b32 s66, -1, s66
    s_ff1_i32_b32 s91, s65
    s_bitset0_b32 s65, s91
    s_lshl_b32 s79, s91, 12
    s_lshl_b32 s91, s91, 10
    buffer_load_dwordx4 v[64:67], v157, s[16:19], s91 offen offset:0 sc1
    buffer_load_dwordx4 v[68:71], v158, s[16:19], s91 offen offset:0 sc1
    s_waitcnt vmcnt(6) lgkmcnt(6)
    v_max3_u32 v156, v156, v43, v47
    v_mfma_f32_16x16x32_bf16 v[80:83], v[128:131], v[40:43], v[80:83]
    s_xor_b32 s89, s67, s78
    s_mov_b32 s67, s78
    v_xor_b32 v144, s89, v144
    ds_read_b64_tr_b16 v[112:113], v144 offset:0
    v_mfma_f32_16x16x32_bf16 v[96:99], v[128:131], v[44:47], v[96:99]
    ds_read_b64_tr_b16 v[114:115], v144 offset:2048
    s_waitcnt lgkmcnt(6)
    v_mfma_f32_16x16x32_bf16 v[84:87], v[132:135], v[40:43], v[84:87]
    v_xor_b32 v145, s89, v145
    ds_read_b64_tr_b16 v[116:117], v145 offset:0
    v_mfma_f32_16x16x32_bf16 v[100:103], v[132:135], v[44:47], v[100:103]
    ds_read_b64_tr_b16 v[118:119], v145 offset:2048
    s_waitcnt lgkmcnt(6)
    v_mfma_f32_16x16x32_bf16 v[88:91], v[136:139], v[40:43], v[88:91]
    v_xor_b32 v146, s89, v146
    ds_read_b64_tr_b16 v[120:121], v146 offset:0
    v_mfma_f32_16x16x32_bf16 v[104:107], v[136:139], v[44:47], v[104:107]
    ds_read_b64_tr_b16 v[122:123], v146 offset:2048
    s_waitcnt lgkmcnt(6)
    v_mfma_f32_16x16x32_bf16 v[92:95], v[140:143], v[40:43], v[92:95]
    v_xor_b32 v147, s89, v147
    ds_read_b64_tr_b16 v[124:125], v147 offset:0
    v_mfma_f32_16x16x32_bf16 v[108:111], v[140:143], v[44:47], v[108:111]
    ds_read_b64_tr_b16 v[126:127], v147 offset:2048
    buffer_load_dwordx4 v[72:75], v157, s[16:19], s91 offen offset:1024 sc1
    buffer_load_dwordx4 v[76:79], v158, s[16:19], s91 offen offset:1024 sc1
    s_waitcnt vmcnt(6) lgkmcnt(6)
L_b_c4:
    v_max_u32 v4, v51, v55
    v_cmp_eq_u32 vcc, -1, v4
    s_cbranch_vccnz L_b_g4
L_b_d4:
    v_mfma_f32_16x16x32_bf16 v[80:83], v[112:115], v[48:51], v[80:83]
    ds_read_b64_tr_b16 v[128:129], v144 offset:4096
    v_mfma_f32_16x16x32_bf16 v[96:99], v[112:115], v[52:55], v[96:99]
    ds_read_b64_tr_b16 v[130:131], v144 offset:6144
    s_waitcnt lgkmcnt(6)
    v_mfma_f32_16x16x32_bf16 v[84:87], v[116:119], v[48:51], v[84:87]
    ds_read_b64_tr_b16 v[132:133], v145 offset:4096
    v_mfma_f32_16x16x32_bf16 v[100:103], v[116:119], v[52:55], v[100:103]
    ds_read_b64_tr_b16 v[134:135], v145 offset:6144
    s_waitcnt lgkmcnt(6)
    v_mfma_f32_16x16x32_bf16 v[88:91], v[120:123], v[48:51], v[88:91]
    ds_read_b64_tr_b16 v[136:137], v146 offset:4096
    v_mfma_f32_16x16x32_bf16 v[104:107], v[120:123], v[52:55], v[104:107]
    ds_read_b64_tr_b16 v[138:139], v146 offset:6144
    s_waitcnt lgkmcnt(6)
    v_mfma_f32_16x16x32_bf16 v[92:95], v[124:127], v[48:51], v[92:95]
    ds_read_b64_tr_b16 v[140:141], v147 offset:4096
    v_mfma_f32_16x16x32_bf16 v[108:111], v[124:127], v[52:55], v[108:111]
    ds_read_b64_tr_b16 v[142:143], v147 offset:6144
    s_not_b32 s91, s66
    s_cmp_eq_u32 s65, 0
    s_cselect_b32 s65, s91, s65
    s_cselect_b32 s66, -1, s66
    s_ff1_i32_b32 s91, s65
    s_bitset0_b32 s65, s91
    s_lshl_b32 s76, s91, 12
    s_lshl_b32 s91, s91, 10
    buffer_load_dwordx4 v[16:19], v157, s[16:19], s91 offen offset:0 sc1
    buffer_load_dwordx4 v[20:23], v158, s[16:19], s91 offen offset:0 sc1
L_walkB6:
    s_cbranch_execz L_walk_21
    s_waitcnt vmcnt(6) lgkmcnt(6)
L_b_c5:
    v_max_u32 v4, v59, v63
    v_cmp_eq_u32 vcc, -1, v4
    s_cbranch_vccnz L_b_g5
L_b_d5:
    v_mfma_f32_16x16x32_bf16 v[80:83], v[128:131], v[56:59], v[80:83]
    s_xor_b32 s89, s67, s79
    s_mov_b32 s67, s79
    v_xor_b32 v144, s89, v144
    ds_read_b64_tr_b16 v[112:113], v144 offset:0
    v_mfma_f32_16x16x32_bf16 v[96:99], v[128:131], v[60:63], v[96:99]
    ds_read_b64_tr_b16 v[114:115], v144 offset:2048
    s_waitcnt lgkmcnt(6)
    v_mfma_f32_16x16x32_bf16 v[84:87], v[132:135], v[56:59], v[84:87]
    v_xor_b32 v145, s89, v145
    ds_read_b64_tr_b16 v[116:117], v145 offset:0
    v_mfma_f32_16x16x32_bf16 v[100:103], v[132:135], v[60:63], v[100:103]
    ds_read_b64_tr_b16 v[118:119], v145 offset:2048
    s_waitcnt lgkmcnt(6)
    v_mfma_f32_16x16x32_bf16 v[88:91], v[136:139], v[56:59], v[88:91]
    v_xor_b32 v146, s89, v146
    ds_read_b64_tr_b16 v[120:121], v146 offset:0
    v_mfma_f32_16x16x32_bf16 v[104:107], v[136:139], v[60:63], v[104:107]
    ds_read_b64_tr_b16 v[122:123], v146 offset:2048
    s_waitcnt lgkmcnt(6)
    v_mfma_f32_16x16x32_bf16 v[92:95], v[140:143], v[56:59], v[92:95]
    v_xor_b32 v147, s89, v147
    ds_read_b64_tr_b16 v[124:125], v147 offset:0
    v_mfma_f32_16x16x32_bf16 v[108:111], v[140:143], v[60:63], v[108:111]
    ds_read_b64_tr_b16 v[126:127], v147 offset:2048
    buffer_load_dwordx4 v[24:27], v157, s[16:19], s91 offen offset:1024 sc1
    buffer_load_dwordx4 v[28:31], v158, s[16:19], s91 offen offset:1024 sc1
    s_waitcnt vmcnt(6) lgkmcnt(6)
L_b_c6:
    v_max_u32 v4, v67, v71
    v_cmp_eq_u32 vcc, -1, v4
    s_cbranch_vccnz L_b_g6
L_b_d6:
    v_mfma_f32_16x16x32_bf16 v[80:83], v[112:115], v[64:67], v[80:83]
    ds_read_b64_tr_b16 v[128:129], v144 offset:4096
    v_mfma_f32_16x16x32_bf16 v[96:99], v[112:115], v[68:71], v[96:99]
    ds_read_b64_tr_b16 v[130:131], v144 offset:6144
    s_waitcnt lgkmcnt(6)
    v_mfma_f32_16x16x32_bf16 v[84:87], v[116:119], v[64:67], v[84:87]
    ds_read_b64_tr_b16 v[132:133], v145 offset:4096
    v_mfma_f32_16x16x32_bf16 v[100:103], v[116:119], v[68:71], v[100:103]
    ds_read_b64_tr_b16 v[134:135], v145 offset:6144
    s_waitcnt lgkmcnt(6)
    v_mfma_f32_16x16x32_bf16 v[88:91], v[120:123], v[64:67], v[88:91]
    ds_read_b64_tr_b16 v[136:137], v146 offset:4096
    v_mfma_f32_16x16x32_bf16 v[104:107], v[120:123], v[68:71], v[104:107]
    ds_read_b64_tr_b16 v[138:139], v146 offset:6144
    s_waitcnt lgkmcnt(6)
    v_mfma_f32_16x16x32_bf16 v[92:95], v[124:127], v[64:67], v[92:95]
    ds_read_b64_tr_b16 v[140:141], v147 offset:4096
    v_mfma_f32_16x16x32_bf16 v[108:111], v[124:127], v[68:71], v[108:111]
    ds_read_b64_tr_b16 v[142:143], v147 offset:6144
    s_not_b32 s91, s66
    s_cmp_eq_u32 s65, 0
    s_cselect_b32 s65, s91, s65
    s_cselect_b32 s66, -1, s66
    s_ff1_i32_b32 s91, s65
    s_bitset0_b32 s65, s91
    s_lshl_b32 s77, s91, 12
    s_lshl_b32 s91, s91, 10
    buffer_load_dwordx4 v[32:35], v157, s[16:19], s91 offen offset:0 sc1
    buffer_load_dwordx4 v[36:39], v158, s[16:19], s91 offen offset:0 sc1
    s_setprio 0
    s_waitcnt vmcnt(6) lgkmcnt(6)
L_b_c7:
    v_max_u32 v4, v75, v79
    v_cmp_eq_u32 vcc, -1, v4
    s_cbranch_vccnz L_b_g7
L_b_d7:
    v_mfma_f32_16x16x32_bf16 v[80:83], v[128:131], v[72:75], v[80:83]
    s_xor_b32 s89, s67, s76
    s_mov_b32 s67, s76
    v_xor_b32 v144, s89, v144
    ds_read_b64_tr_b16 v[112:113], v144 offset:0
    v_mfma_f32_16x16x32_bf16 v[96:99], v[128:131], v[76:79], v[96:99]
    ds_read_b64_tr_b16 v[114:115], v144 offset:2048
    s_waitcnt lgkmcnt(6)
    v_mfma_f32_16x16x32_bf16 v[84:87], v[132:135], v[72:75], v[84:87]
    v_xor_b32 v145, s89, v145
    ds_read_b64_tr_b16 v[116:117], v145 offset:0
    v_mfma_f32_16x16x32_bf16 v[100:103], v[132:135], v[76:79], v[100:103]
    ds_read_b64_tr_b16 v[118:119], v145 offset:2048
    s_waitcnt lgkmcnt(6)
    v_mfma_f32_16x16x32_bf16 v[88:91], v[136:139], v[72:75], v[88:91]
    v_xor_b32 v146, s89, v146
    ds_read_b64_tr_b16 v[120:121], v146 offset:0
    v_mfma_f32_16x16x32_bf16 v[104:107], v[136:139], v[76:79], v[104:107]
    ds_read_b64_tr_b16 v[122:123], v146 offset:2048
    s_waitcnt lgkmcnt(6)
    v_mfma_f32_16x16x32_bf16 v[92:95], v[140:143], v[72:75], v[92:95]
    v_xor_b32 v147, s89, v147
    ds_read_b64_tr_b16 v[124:125], v147 offset:0
    v_mfma_f32_16x16x32_bf16 v[108:111], v[140:143], v[76:79], v[108:111]
    ds_read_b64_tr_b16 v[126:127], v147 offset:2048
    buffer_load_dwordx4 v[40:43], v157, s[16:19], s91 offen offset:1024 sc1
    buffer_load_dwordx4 v[44:47], v158, s[16:19], s91 offen offset:1024 sc1
    s_waitcnt vmcnt(6) lgkmcnt(6)
L_b_c8:
    v_max_u32 v4, v19, v23
    v_cmp_eq_u32 vcc, -1, v4
    s_cbranch_vccnz L_b_g8
L_b_d8:
    v_mfma_f32_16x16x32_bf16 v[80:83], v[112:115], v[16:19], v[80:83]
    ds_read_b64_tr_b16 v[128:129], v144 offset:4096
    v_mfma_f32_16x16x32_bf16 v[96:99], v[112:115], v[20:23], v[96:99]
    ds_read_b64_tr_b16 v[130:131], v144 offset:6144
    s_waitcnt lgkmcnt(6)
    v_mfma_f32_16x16x32_bf16 v[84:87], v[116:119], v[16:19], v[84:87]
    ds_read_b64_tr_b16 v[132:133], v145 offset:4096
    v_mfma_f32_16x16x32_bf16 v[100:103], v[116:119], v[20:23], v[100:103]
    ds_read_b64_tr_b16 v[134:135], v145 offset:6144
    s_waitcnt lgkmcnt(6)
    v_mfma_f32_16x16x32_bf16 v[88:91], v[120:123], v[16:19], v[88:91]
    ds_read_b64_tr_b16 v[136:137], v146 offset:4096
    v_mfma_f32_16x16x32_bf16 v[104:107], v[120:123], v[20:23], v[104:107]
    ds_read_b64_tr_b16 v[138:139], v146 offset:6144
    s_waitcnt lgkmcnt(6)
    v_mfma_f32_16x16x32_bf16 v[92:95], v[124:127], v[16:19], v[92:95]
    ds_read_b64_tr_b16 v[140:141], v147 offset:4096
    v_mfma_f32_16x16x32_bf16 v[108:111], v[124:127], v[20:23], v[108:111]
    ds_read_b64_tr_b16 v[142:143], v147 offset:6144
    s_not_b32 s91, s66
    s_cmp_eq_u32 s65, 0
    s_cselect_b32 s65, s91, s65
    s_cselect_b32 s66, -1, s66
    s_ff1_i32_b32 s91, s65
    s_bitset0_b32 s65, s91
    s_lshl_b32 s78, s91, 12
    s_lshl_b32 s91, s91, 10
    buffer_load_dwordx4 v[48:51], v157, s[16:19], s91 offen offset:0 sc1
    buffer_load_dwordx4 v[52:55], v158, s[16:19], s91 offen offset:0 sc1
    s_waitcnt vmcnt(6) lgkmcnt(6)
L_b_c9:
    v_max_u32 v4, v27, v31
    v_cmp_eq_u32 vcc, -1, v4
    s_cbranch_vccnz L_b_g9
L_b_d9:
    v_mfma_f32_16x16x32_bf16 v[80:83], v[128:131], v[24:27], v[80:83]
    s_xor_b32 s89, s67, s77
    s_mov_b32 s67, s77
    v_xor_b32 v144, s89, v144
    ds_read_b64_tr_b16 v[112:113], v144 offset:0
    v_mfma_f32_16x16x32_bf16 v[96:99], v[128:131], v[28:31], v[96:99]
    ds_read_b64_tr_b16 v[114:115], v144 offset:2048
    s_waitcnt lgkmcnt(6)
    v_mfma_f32_16x16x32_bf16 v[84:87], v[132:135], v[24:27], v[84:87]
    v_xor_b32 v145, s89, v145
    ds_read_b64_tr_b16 v[116:117], v145 offset:0
    v_mfma_f32_16x16x32_bf16 v[100:103], v[132:135], v[28:31], v[100:103]
    ds_read_b64_tr_b16 v[118:119], v145 offset:2048
    s_waitcnt lgkmcnt(6)
    v_mfma_f32_16x16x32_bf16 v[88:91], v[136:139], v[24:27], v[88:91]
    v_xor_b32 v146, s89, v146
    ds_read_b64_tr_b16 v[120:121], v146 offset:0
    v_mfma_f32_16x16x32_bf16 v[104:107], v[136:139], v[28:31], v[104:107]
    ds_read_b64_tr_b16 v[122:123], v146 offset:2048
    s_waitcnt lgkmcnt(6)
    v_mfma_f32_16x16x32_bf16 v[92:95], v[140:143], v[24:27], v[92:95]
    v_xor_b32 v147, s89, v147
    ds_read_b64_tr_b16 v[124:125], v147 offset:0
    v_mfma_f32_16x16x32_bf16 v[108:111], v[140:143], v[28:31], v[108:111]
    ds_read_b64_tr_b16 v[126:127], v147 offset:2048
    buffer_load_dwordx4 v[56:59], v157, s[16:19], s91 offen offset:1024 sc1
    buffer_load_dwordx4 v[60:63], v158, s[16:19], s91 offen offset:1024 sc1
    s_waitcnt vmcnt(6) lgkmcnt(6)
L_b_c10:
    v_max_u32 v4, v35, v39
    v_cmp_eq_u32 vcc, -1, v4
    s_cbranch_vccnz L_b_g10
L_b_d10:
    v_mfma_f32_16x16x32_bf16 v[80:83], v[112:115], v[32:35], v[80:83]
    ds_read_b64_tr_b16 v[128:129], v144 offset:4096
    v_mfma_f32_16x16x32_bf16 v[96:99], v[112:115], v[36:39], v[96:99]
    ds_read_b64_tr_b16 v[130:131], v144 offset:6144
    s_waitcnt lgkmcnt(6)
    v_mfma_f32_16x16x32_bf16 v[84:87], v[116:119], v[32:35], v[84:87]
L_walkB7:
    s_cbranch_execz L_walk_22
    ds_read_b64_tr_b16 v[132:133], v145 offset:4096
    v_mfma_f32_16x16x32_bf16 v[100:103], v[116:119], v[36:39], v[100:103]
    ds_read_b64_tr_b16 v[134:135], v145 offset:6144
    s_waitcnt lgkmcnt(6)
    v_mfma_f32_16x16x32_bf16 v[88:91], v[120:123], v[32:35], v[88:91]
    ds_read_b64_tr_b16 v[136:137], v146 offset:4096
    v_mfma_f32_16x16x32_bf16 v[104:107], v[120:123], v[36:39], v[104:107]
    ds_read_b64_tr_b16 v[138:139], v146 offset:6144
    s_waitcnt lgkmcnt(6)
    v_mfma_f32_16x16x32_bf16 v[92:95], v[124:127], v[32:35], v[92:95]
    ds_read_b64_tr_b16 v[140:141], v147 offset:4096
    v_mfma_f32_16x16x32_bf16 v[108:111], v[124:127], v[36:39], v[108:111]
    ds_read_b64_tr_b16 v[142:143], v147 offset:6144
    s_not_b32 s91, s66
    s_or_b32 s65, s65, s91
    s_ff1_i32_b32 s91, s65
    s_bitset0_b32 s65, s91
    s_lshl_b32 s79, s91, 12
    s_lshl_b32 s91, s91, 10
    buffer_load_dwordx4 v[64:67], v157, s[16:19], s91 offen offset:0 sc1
    buffer_load_dwordx4 v[68:71], v158, s[16:19], s91 offen offset:0 sc1
    s_waitcnt vmcnt(6) lgkmcnt(6)
L_b_c11:
    v_max_u32 v4, v43, v47
    v_cmp_eq_u32 vcc, -1, v4
    s_cbranch_vccnz L_b_g11
L_b_d11:
    v_mfma_f32_16x16x32_bf16 v[80:83], v[128:131], v[40:43], v[80:83]
    s_xor_b32 s89, s67, s78
    s_mov_b32 s67, s78
    v_xor_b32 v144, s89, v144
    ds_read_b64_tr_b16 v[112:113], v144 offset:0
    v_mfma_f32_16x16x32_bf16 v[96:99], v[128:131], v[44:47], v[96:99]
    ds_read_b64_tr_b16 v[114:115], v144 offset:2048
    s_waitcnt lgkmcnt(6)
    v_mfma_f32_16x16x32_bf16 v[84:87], v[132:135], v[40:43], v[84:87]
    v_xor_b32 v145, s89, v145
    ds_read_b64_tr_b16 v[116:117], v145 offset:0
    v_mfma_f32_16x16x32_bf16 v[100:103], v[132:135], v[44:47], v[100:103]
    ds_read_b64_tr_b16 v[118:119], v145 offset:2048
    s_waitcnt lgkmcnt(6)
    v_mfma_f32_16x16x32_bf16 v[88:91], v[136:139], v[40:43], v[88:91]
    v_xor_b32 v146, s89, v146
    ds_read_b64_tr_b16 v[120:121], v146 offset:0
    v_mfma_f32_16x16x32_bf16 v[104:107], v[136:139], v[44:47], v[104:107]
    ds_read_b64_tr_b16 v[122:123], v146 offset:2048
    s_waitcnt lgkmcnt(6)
    v_mfma_f32_16x16x32_bf16 v[92:95], v[140:143], v[40:43], v[92:95]
    v_xor_b32 v147, s89, v147
    ds_read_b64_tr_b16 v[124:125], v147 offset:0
    v_mfma_f32_16x16x32_bf16 v[108:111], v[140:143], v[44:47], v[108:111]
    ds_read_b64_tr_b16 v[126:127], v147 offset:2048
    buffer_load_dwordx4 v[72:75], v157, s[16:19], s91 offen offset:1024 sc1
    buffer_load_dwordx4 v[76:79], v158, s[16:19], s91 offen offset:1024 sc1
    s_waitcnt vmcnt(6) lgkmcnt(6)
L_b_c12:
    v_max_u32 v4, v51, v55
    v_cmp_eq_u32 vcc, -1, v4
    s_cbranch_vccnz L_b_g12
L_b_d12:
    v_mfma_f32_16x16x32_bf16 v[80:83], v[112:115], v[48:51], v[80:83]
    ds_read_b64_tr_b16 v[128:129], v144 offset:4096
    v_mfma_f32_16x16x32_bf16 v[96:99], v[112:115], v[52:55], v[96:99]
    ds_read_b64_tr_b16 v[130:131], v144 offset:6144
    s_waitcnt lgkmcnt(6)
    v_mfma_f32_16x16x32_bf16 v[84:87], v[116:119], v[48:51], v[84:87]
    ds_read_b64_tr_b16 v[132:133], v145 offset:4096
    v_mfma_f32_16x16x32_bf16 v[100:103], v[116:119], v[52:55], v[100:103]
    ds_read_b64_tr_b16 v[134:135], v145 offset:6144
    s_waitcnt lgkmcnt(6)
    v_mfma_f32_16x16x32_bf16 v[88:91], v[120:123], v[48:51], v[88:91]
    ds_read_b64_tr_b16 v[136:137], v146 offset:4096
    v_mfma_f32_16x16x32_bf16 v[104:107], v[120:123], v[52:55], v[104:107]
    ds_read_b64_tr_b16 v[138:139], v146 offset:6144
    s_waitcnt lgkmcnt(6)
    v_mfma_f32_16x16x32_bf16 v[92:95], v[124:127], v[48:51], v[92:95]
    ds_read_b64_tr_b16 v[140:141], v147 offset:4096
    v_mfma_f32_16x16x32_bf16 v[108:111], v[124:127], v[52:55], v[108:111]
    ds_read_b64_tr_b16 v[142:143], v147 offset:6144
    s_waitcnt vmcnt(4) lgkmcnt(6)
L_b_c13:
    v_max_u32 v4, v59, v63
    v_cmp_eq_u32 vcc, -1, v4
    s_cbranch_vccnz L_b_g13
L_b_d13:
    v_mfma_f32_16x16x32_bf16 v[80:83], v[128:131], v[56:59], v[80:83]
    s_xor_b32 s89, s67, s79
    s_mov_b32 s67, s79
    v_xor_b32 v144, s89, v144
    ds_read_b64_tr_b16 v[112:113], v144 offset:0
    v_mfma_f32_16x16x32_bf16 v[96:99], v[128:131], v[60:63], v[96:99]
    ds_read_b64_tr_b16 v[114:115], v144 offset:2048
    s_waitcnt lgkmcnt(6)
    v_mfma_f32_16x16x32_bf16 v[84:87], v[132:135], v[56:59], v[84:87]
    v_xor_b32 v145, s89, v145
    ds_read_b64_tr_b16 v[116:117], v145 offset:0
    v_mfma_f32_16x16x32_bf16 v[100:103], v[132:135], v[60:63], v[100:103]
    ds_read_b64_tr_b16 v[118:119], v145 offset:2048
    s_waitcnt lgkmcnt(6)
    v_mfma_f32_16x16x32_bf16 v[88:91], v[136:139], v[56:59], v[88:91]
    v_xor_b32 v146, s89, v146
    ds_read_b64_tr_b16 v[120:121], v146 offset:0
    v_mfma_f32_16x16x32_bf16 v[104:107], v[136:139], v[60:63], v[104:107]
    ds_read_b64_tr_b16 v[122:123], v146 offset:2048
    s_waitcnt lgkmcnt(6)
    v_mfma_f32_16x16x32_bf16 v[92:95], v[140:143], v[56:59], v[92:95]
    v_xor_b32 v147, s89, v147
    ds_read_b64_tr_b16 v[124:125], v147 offset:0
    v_mfma_f32_16x16x32_bf16 v[108:111], v[140:143], v[60:63], v[108:111]
    ds_read_b64_tr_b16 v[126:127], v147 offset:2048
    s_waitcnt vmcnt(2) lgkmcnt(6)
L_b_c14:
    v_max_u32 v4, v67, v71
    v_cmp_eq_u32 vcc, -1, v4
    s_cbranch_vccnz L_b_g14
L_b_d14:
    v_mfma_f32_16x16x32_bf16 v[80:83], v[112:115], v[64:67], v[80:83]
    ds_read_b64_tr_b16 v[128:129], v144 offset:4096
    v_mfma_f32_16x16x32_bf16 v[96:99], v[112:115], v[68:71], v[96:99]
    ds_read_b64_tr_b16 v[130:131], v144 offset:6144
    s_waitcnt lgkmcnt(6)
    v_mfma_f32_16x16x32_bf16 v[84:87], v[116:119], v[64:67], v[84:87]
    ds_read_b64_tr_b16 v[132:133], v145 offset:4096
    v_mfma_f32_16x16x32_bf16 v[100:103], v[116:119], v[68:71], v[100:103]
    ds_read_b64_tr_b16 v[134:135], v145 offset:6144
    s_waitcnt lgkmcnt(6)
    v_mfma_f32_16x16x32_bf16 v[88:91], v[120:123], v[64:67], v[88:91]
    ds_read_b64_tr_b16 v[136:137], v146 offset:4096
    v_mfma_f32_16x16x32_bf16 v[104:107], v[120:123], v[68:71], v[104:107]
    ds_read_b64_tr_b16 v[138:139], v146 offset:6144
    s_waitcnt lgkmcnt(6)
    v_mfma_f32_16x16x32_bf16 v[92:95], v[124:127], v[64:67], v[92:95]
    ds_read_b64_tr_b16 v[140:141], v147 offset:4096
    v_mfma_f32_16x16x32_bf16 v[108:111], v[124:127], v[68:71], v[108:111]
    ds_read_b64_tr_b16 v[142:143], v147 offset:6144
    s_waitcnt vmcnt(0) lgkmcnt(6)
L_b_c15:
    v_max_u32 v4, v75, v79
    v_cmp_eq_u32 vcc, -1, v4
    s_cbranch_vccnz L_b_g15
L_b_d15:
    v_cmp_eq_u32 vcc, -1, v156
    s_cbranch_vccz L_ok_4
    s_sub_u32 s56, s56, 1
    s_cbranch_scc0 L_b_restart
    s_mov_b32 s56, 0
L_ok_4:
    v_mfma_f32_16x16x32_bf16 v[80:83], v[128:131], v[72:75], v[80:83]
    s_mov_b32 s90, 71680
    buffer_load_dwordx4 v[204:207], v11, s[32:35], s90 offen
    v_mfma_f32_16x16x32_bf16 v[96:99], v[128:131], v[76:79], v[96:99]
    s_mov_b32 s90, 78848
    buffer_load_dwordx4 v[208:211], v11, s[32:35], s90 offen
    s_waitcnt lgkmcnt(4)
    v_mfma_f32_16x16x32_bf16 v[84:87], v[132:135], v[72:75], v[84:87]
    v_mfma_f32_16x16x32_bf16 v[100:103], v[132:135], v[76:79], v[100:103]
    s_mov_b32 s90, 86016
    buffer_load_dwordx4 v[212:215], v11, s[32:35], s90 offen
    s_waitcnt lgkmcnt(2)
    v_mfma_f32_16x16x32_bf16 v[88:91], v[136:139], v[72:75], v[88:91]
    s_mov_b32 s90, 93184
    buffer_load_dwordx4 v[216:219], v11, s[32:35], s90 offen
    v_mfma_f32_16x16x32_bf16 v[104:107], v[136:139], v[76:79], v[104:107]
    s_mov_b32 s90, 100352
    buffer_load_dwordx4 v[220:223], v11, s[32:35], s90 offen
    s_waitcnt lgkmcnt(0)
    v_mfma_f32_16x16x32_bf16 v[92:95], v[140:143], v[72:75], v[92:95]
    v_mfma_f32_16x16x32_bf16 v[108:111], v[140:143], v[76:79], v[108:111]
    s_mov_b32 s90, 107520
    buffer_load_dwordx4 v[224:227], v11, s[32:35], s90 offen
    ds_write_b128 v162, v[96:99] offset:0
    ds_write_b128 v162, v[100:103] offset:1024
    ds_write_b128 v162, v[104:107] offset:2048
    s_nop 2
    ds_write_b128 v162, v[108:111] offset:3072
    s_waitcnt lgkmcnt(0)
    s_barrier
    ds_read_b128 v[16:19], v163 offset:0
L_walk_19:
    s_cbranch_execz L_walk_23
    ds_read_b128 v[20:23], v163 offset:1024
    ds_read_b128 v[24:27], v163 offset:2048
    ds_read_b128 v[28:31], v163 offset:3072
    s_waitcnt lgkmcnt(3)
    v_pk_add_f32 v[80:81], v[80:81], v[16:17]
    v_pk_add_f32 v[82:83], v[82:83], v[18:19]
    v_cvt_pk_bf16_f32 v32, v80, v81
    v_cvt_pk_bf16_f32 v33, v82, v83
    s_waitcnt lgkmcnt(2)
    v_pk_add_f32 v[84:85], v[84:85], v[20:21]
    v_pk_add_f32 v[86:87], v[86:87], v[22:23]
    v_cvt_pk_bf16_f32 v34, v84, v85
    v_cvt_pk_bf16_f32 v35, v86, v87
    s_waitcnt lgkmcnt(1)
    v_pk_add_f32 v[88:89], v[88:89], v[24:25]
    v_pk_add_f32 v[90:91], v[90:91], v[26:27]
    v_cvt_pk_bf16_f32 v36, v88, v89
    v_cvt_pk_bf16_f32 v37, v90, v91
    s_waitcnt lgkmcnt(0)
    v_pk_add_f32 v[92:93], v[92:93], v[28:29]
    v_pk_add_f32 v[94:95], v[94:95], v[30:31]
    v_cvt_pk_bf16_f32 v38, v92, v93
    v_cvt_pk_bf16_f32 v39, v94, v95
    v_mfma_f32_16x16x32_bf16 v[60:63], v[32:35], v[32:35], 0
    v_mfma_f32_16x16x32_bf16 v[56:59], v[32:35], v[148:151], 0
    v_mfma_f32_16x16x32_bf16 v[60:63], v[36:39], v[36:39], v[60:63]
    v_mfma_f32_16x16x32_bf16 v[56:59], v[36:39], v[152:155], v[56:59]
    v_lshlrev_b32 v40, 16, v32
    v_and_b32 v41, 0xffff0000, v32
    v_lshlrev_b32 v42, 16, v33
    v_and_b32 v43, 0xffff0000, v33
    v_lshlrev_b32 v44, 16, v34
    v_and_b32 v45, 0xffff0000, v34
    s_nop 1
    v_cndmask_b32 v56, v56, v60, s[72:73]
    v_cndmask_b32 v57, v57, v61, s[72:73]
    v_cndmask_b32 v58, v58, v62, s[72:73]
    v_cndmask_b32 v59, v59, v63, s[72:73]
    v_cndmask_b32 v56, v56, v57, s[4:5]
    v_cndmask_b32 v58, v58, v59, s[98:99]
    s_or_b64 vcc, s[6:7], s[98:99]
    v_cndmask_b32 v56, v56, v58, vcc
    v_cndmask_b32 v56, v56, 1.0, s[74:75]
    v_mov_b32 v67, v56
    buffer_atomic_add_f32 v67, v160, s[16:19], 0 offen sc0 sc1
    s_mov_b32 s90, 0
    buffer_load_dwordx4 v[228:231], v14, s[36:39], s90 offen
    s_mov_b32 s90, 2048
    buffer_load_dwordx4 v[232:235], v14, s[36:39], s90 offen
    s_mov_b32 s90, 4096
    buffer_load_dwordx4 v[236:239], v14, s[36:39], s90 offen
    s_lshl_b32 s86, s3, 11
    s_add_u32 s86, s86, 69632
    v_lshl_add_u32 v150, v0, 4, s86
    ds_write_b128 v150, v[32:35]
    ds_write_b128 v150, v[36:39] offset:1024
    s_lshl_b32 s86, s3, 7
    s_add_u32 s86, s86, 66560
    v_lshl_add_u32 v151, v2, 3, s86
    s_cmp_eq_u32 s62, 0
    s_cbranch_scc1 L_unp
    v_and_b32 v24, 1, v0
    v_cmp_eq_u32 vcc, 1, v24
    v_mov_b32 v24, 0x0c0c0100
    v_mov_b32 v25, 0x01000c0c
    v_cndmask_b32 v16, v24, v25, vcc
    v_mov_b32 v24, 0x0c0c0302
    v_mov_b32 v25, 0x03020c0c
    v_cndmask_b32 v17, v24, v25, vcc
    v_bfe_u32 v24, v0, 1, 2
    v_mov_b32 v25, 0x0c0c0c0c
    v_cmp_eq_u32 vcc, 0, v24
    s_nop 1
    v_cndmask_b32 v72, v25, v16, vcc
    v_cndmask_b32 v76, v25, v17, vcc
    v_cmp_eq_u32 vcc, 1, v24
    s_nop 1
    v_cndmask_b32 v73, v25, v16, vcc
    v_cndmask_b32 v77, v25, v17, vcc
    v_cmp_eq_u32 vcc, 2, v24
    s_nop 1
    v_cndmask_b32 v74, v25, v16, vcc
    v_cndmask_b32 v78, v25, v17, vcc
    v_cmp_eq_u32 vcc, 3, v24
    s_nop 1
    v_cndmask_b32 v75, v25, v16, vcc
    v_cndmask_b32 v79, v25, v17, vcc
    s_lshl_b32 s86, s48, 10
    s_add_u32 s86, s86, 90112
    v_lshl_add_u32 v18, v0, 4, s86
    s_and_b32 s86, s48, 1
    s_cselect_b32 s87, s81, s80
    s_lshr_b32 s90, s48, 1
    s_and_b32 s88, s82, 1
    s_and_b32 s89, s82, 6
    s_lshl3_add_u32 s88, s88, s89
    s_add_u32 s88, s88, s90
    s_mul_i32 s88, s88, 56
    s_add_u32 s88, s88, s87
    s_lshl_b32 s88, s88, 8
    s_add_u32 s88, s88, 7864320
    s_cmp_lt_u32 s87, 56
    s_cselect_b32 s88, s88, 2147483648
    v_lshl_add_u32 v131, v0, 2, s88
    s_lshl2_add_u32 s86, s90, s86
    s_lshl_b32 s86, s86, 7
    s_add_u32 s86, s86, 90112
    v_lshrrev_b32 v16, 3, v0
    v_lshl_add_u32 v133, v16, 4, s86
    v_bfe_u32 v17, v0, 2, 1
    v_lshl_add_u32 v133, v17, 8, v133
    v_and_b32 v17, 3, v0
    v_lshl_add_u32 v133, v17, 2, v133
    s_lshr_b32 s86, s82, 3
    s_lshl2_add_u32 s86, s86, s48
    s_mul_i32 s86, s86, 112
    s_add_u32 s86, s86, 7864320
    v_mul_u32_u24 v16, 14336, v16
    v_and_b32 v17, 7, v0
    v_lshl_add_u32 v137, v17, 4, s86
    v_add_u32 v137, v137, v16
    v_mov_b32 v16, 2147483648
    v_cmp_eq_u32 vcc, 7, v17
    s_nop 1
    v_cndmask_b32 v137, v137, v16, vcc
    s_branch L_unpd
L_unp:
    v_lshlrev_b32 v46, 16, v35
    v_and_b32 v47, 0xffff0000, v35
    v_lshlrev_b32 v48, 16, v36
    v_and_b32 v49, 0xffff0000, v36
    v_lshlrev_b32 v50, 16, v37
    v_and_b32 v51, 0xffff0000, v37
    v_lshlrev_b32 v52, 16, v38
    v_and_b32 v53, 0xffff0000, v38
    v_lshlrev_b32 v54, 16, v39
    v_and_b32 v55, 0xffff0000, v39
L_unpd:
    v_mov_b32 v9, 0x3a800000
    s_lshl_b32 s86, s3, 6
    s_add_u32 s86, s86, 65536
    v_lshl_add_u32 v152, v2, 2, s86
    v_and_b32 v10, 31, v0
    v_lshlrev_b32 v10, 4, v10
    v_add_u32 v10, 65536, v10
    s_lshl_b32 s86, s52, 11
    s_lshr_b32 s87, s51, 3
    s_lshl_b32 s87, s87, 6
    s_add_u32 s86, s86, s87
    s_and_b32 s87, s51, 7
    s_lshl3_add_u32 s86, s87, s86
    s_add_u32 s86, s86, 6684672
    v_lshl_add_u32 v149, v0, 7, s86
    v_mov_b32 v8, 2147483648
    v_cmp_gt_u32 vcc, 16, v0
    s_nop 1
    v_cndmask_b32 v149, v8, v149, vcc
    s_bfe_u32 s67, s82, 0x20001
    s_lshl2_add_u32 s67, s67, s48
    s_and_b32 s87, s2, 15
    s_lshl_b32 s86, s67, 4
    s_add_u32 s86, s86, s87
    s_lshl_b32 s86, s86, 7
    s_add_u32 s86, s86, 6684672
    v_lshl_add_u32 v148, v0, 3, s86
    v_mov_b32 v8, 2147483648
    v_cmp_gt_u32 vcc, 16, v0
    s_nop 1
    v_cndmask_b32 v148, v8, v148, vcc
    s_lshl_b32 s67, s67, 7
    s_add_u32 s67, s67, 6619136
    s_waitcnt vmcnt(3)
    v_add_f32 v67, v67, v56
    v_cmp_ne_u32 vcc, 0x41800000, v67
    s_nop 0
    s_and_b64 vcc, vcc, s[74:75]
    s_cbranch_scc1 L_h3
L_h3_done:
    v_mul_f32_dpp v64, v67, v9 row_ror:8 row_mask:0x5 bank_mask:0xf
    v_mov_b32_dpp v65, v67 row_ror:12 row_mask:0x5 bank_mask:0xf
    v_mul_f32 v66, v9, v67
    v_mul_f32_dpp v64, v67, v9 row_ror:12 row_mask:0xa bank_mask:0xf
    v_mov_b32_dpp v65, v67 row_ror:8 row_mask:0xa bank_mask:0xf
    v_fma_f32 v66, -v64, v64, v66
    v_max_f32 v66, 0, v66
L_walk_20:
    s_cbranch_execz L_walk_24
    v_cvt_pk_bf16_f32 v69, v64, v66
    v_lshlrev_b32 v68, 16, v69
    v_and_b32 v69, 0xffff0000, v69
    v_add_f32 v69, 0x3727c5ac, v69
    v_cvt_pk_bf16_f32 v69, v69, v69
    v_lshlrev_b32 v69, 16, v69
    v_sqrt_f32 v69, v69
    s_nop 0
    v_cvt_pk_bf16_f32 v69, v69, v69
    v_lshlrev_b32 v69, 16, v69
    v_rcp_f32 v70, v69
    v_fma_f32 v12, -v68, s57, v65
    v_mul_f32 v12, v12, v70
    v_mul_f32 v71, -v68, v70
    v_cvt_pk_bf16_f32 v12, v12, v12
    v_ashrrev_i32 v8, 31, v12
    v_or_b32 v8, 0x80000000, v8
    v_xor_b32 v8, v8, v12
    v_and_b32 v8, 4294901760, v8
    v_or_b32 v13, v8, v6
    s_mov_b64 exec, s[72:73]
    ds_write_b32 v152, v13
    ds_write_b64 v151, v[70:71]
    s_mov_b64 exec, -1
    ds_read_b64 v[70:71], v151
    ds_read_b32 v13, v152
    s_cmp_eq_u32 s62, 0
    s_cbranch_scc1 L_nop0
    v_mov_b32 v128, 0
    v_mov_b32 v129, 0
    buffer_atomic_or_x2 v[128:129], v148, s[16:19], 0 offen sc0 sc1
L_nop0:
    s_waitcnt lgkmcnt(2)
    s_barrier
    ds_read_b128 v[60:63], v10
    s_cmp_lg_u32 s62, 0
    s_cbranch_scc1 L_t3_ld
    ds_read_b32 v144, v152 offset:256
    ds_read_b64 v[142:143], v151 offset:512
    ds_read_b128 v[112:115], v150 offset:8192
    ds_read_b128 v[116:119], v150 offset:9216
    s_waitcnt lgkmcnt(5)
    s_waitcnt lgkmcnt(4)
    v_max3_u32 v64, v60, v61, v62
    v_max_u32 v66, v64, v63
    v_med3_u32 v67, v60, v61, v62
    v_med3_u32 v67, v64, v67, v63
    v_min_u32_dpp v64, v66, v66 row_ror:8 row_mask:0xf bank_mask:0xf
    v_max_u32_dpp v66, v66, v66 row_ror:8 row_mask:0xf bank_mask:0xf
    v_max_u32_dpp v65, v67, v67 row_ror:8 row_mask:0xf bank_mask:0xf
    v_max_u32 v67, v64, v65
    v_min_u32_dpp v64, v66, v66 row_ror:4 row_mask:0xf bank_mask:0xf
    v_max_u32_dpp v66, v66, v66 row_ror:4 row_mask:0xf bank_mask:0xf
    v_max_u32_dpp v65, v67, v67 row_ror:4 row_mask:0xf bank_mask:0xf
    v_max_u32 v67, v64, v65
    v_min_u32_dpp v64, v66, v66 row_ror:2 row_mask:0xf bank_mask:0xf
    v_max_u32_dpp v66, v66, v66 row_ror:2 row_mask:0xf bank_mask:0xf
    v_max_u32_dpp v65, v67, v67 row_ror:2 row_mask:0xf bank_mask:0xf
    v_max_u32 v67, v64, v65
    v_min_u32_dpp v64, v66, v66 row_ror:1 row_mask:0xf bank_mask:0xf
    v_max_u32_dpp v60, v66, v66 row_ror:1 row_mask:0xf bank_mask:0xf
    v_max_u32_dpp v65, v67, v67 row_ror:1 row_mask:0xf bank_mask:0xf
    v_max_u32_dpp v66, v66, v66 row_ror:1 row_mask:0xf bank_mask:0xf
    v_max_u32 v67, v64, v65
    v_max_u32 v65, v64, v65
    v_permlane16_swap_b32 v66, v60
    v_min_u32 v64, v66, v60
    v_permlane16_swap_b32 v67, v65
    v_max_u32 v66, v66, v60
    v_max3_u32 v67, v64, v67, v65
    s_cmp_lg_u32 s3, 0
    s_cbranch_scc1 L_nokey
    buffer_atomic_swap_x2 v[66:67], v149, s[16:19], 0 offen sc1
L_nokey:
    v_pk_fma_f32 v[16:17], v[40:41], v[70:71], v[70:71] op_sel:[0,0,1] op_sel_hi:[1,0,1]
    v_pk_fma_f32 v[18:19], v[42:43], v[70:71], v[70:71] op_sel:[0,0,1] op_sel_hi:[1,0,1]
    v_pk_fma_f32 v[20:21], v[44:45], v[70:71], v[70:71] op_sel:[0,0,1] op_sel_hi:[1,0,1]
    v_pk_fma_f32 v[22:23], v[46:47], v[70:71], v[70:71] op_sel:[0,0,1] op_sel_hi:[1,0,1]
    v_pk_fma_f32 v[24:25], v[48:49], v[70:71], v[70:71] op_sel:[0,0,1] op_sel_hi:[1,0,1]
    v_pk_fma_f32 v[26:27], v[50:51], v[70:71], v[70:71] op_sel:[0,0,1] op_sel_hi:[1,0,1]
    v_pk_fma_f32 v[28:29], v[52:53], v[70:71], v[70:71] op_sel:[0,0,1] op_sel_hi:[1,0,1]
    v_pk_fma_f32 v[30:31], v[54:55], v[70:71], v[70:71] op_sel:[0,0,1] op_sel_hi:[1,0,1]
    v_cvt_pk_bf16_f32 v96, v16, v17
    v_cvt_pk_bf16_f32 v97, v18, v19
    v_cvt_pk_bf16_f32 v98, v20, v21
    v_cvt_pk_bf16_f32 v99, v22, v23
    v_cvt_pk_bf16_f32 v100, v24, v25
    v_cvt_pk_bf16_f32 v101, v26, v27
    v_cvt_pk_bf16_f32 v102, v28, v29
    v_cvt_pk_bf16_f32 v103, v30, v31
    v_cmp_eq_u32 s[4:5], v66, v13
    v_cmp_eq_u32 s[6:7], v67, v13
    s_nop 0
    s_or_b64 s[96:97], s[4:5], s[6:7]
    s_cbranch_scc0 L_nocand
    s_lshl_b32 s86, s51, 12
    s_lshl_b32 s87, s52, 7
    s_add_u32 s86, s86, s87
    s_add_u32 s86, s86, 6619136
    v_lshl_add_u32 v8, v1, 3, s86
    v_add_u32 v9, 2048, v8
    v_cndmask_b32 v8, v8, v9, s[6:7]
    v_mov_b32 v9, 2147483648
    v_cndmask_b32 v8, v9, v8, s[96:97]
    buffer_store_dwordx2 v[96:97], v8, s[16:19], 0 offen offset:0 sc1
    buffer_store_dwordx2 v[98:99], v8, s[16:19], 0 offen offset:32 sc1
    buffer_store_dwordx2 v[100:101], v8, s[16:19], 0 offen offset:64 sc1
    buffer_store_dwordx2 v[102:103], v8, s[16:19], 0 offen offset:96 sc1
    v_subrev_u32 v131, 65536, v8
L_nocand:
    s_waitcnt lgkmcnt(0)
    v_lshlrev_b32 v80, 16, v112
    v_and_b32 v81, 0xffff0000, v112
    v_lshlrev_b32 v82, 16, v113
    v_and_b32 v83, 0xffff0000, v113
    v_lshlrev_b32 v84, 16, v114
    v_and_b32 v85, 0xffff0000, v114
    v_lshlrev_b32 v86, 16, v115
    v_and_b32 v87, 0xffff0000, v115
    v_lshlrev_b32 v88, 16, v116
    v_and_b32 v89, 0xffff0000, v116
    v_lshlrev_b32 v90, 16, v117
    v_and_b32 v91, 0xffff0000, v117
    v_lshlrev_b32 v92, 16, v118
    v_and_b32 v93, 0xffff0000, v118
    v_lshlrev_b32 v94, 16, v119
    v_and_b32 v95, 0xffff0000, v119
    v_pk_fma_f32 v[16:17], v[80:81], v[142:143], v[142:143] op_sel:[0,0,1] op_sel_hi:[1,0,1]
    v_pk_fma_f32 v[18:19], v[82:83], v[142:143], v[142:143] op_sel:[0,0,1] op_sel_hi:[1,0,1]
    v_pk_fma_f32 v[20:21], v[84:85], v[142:143], v[142:143] op_sel:[0,0,1] op_sel_hi:[1,0,1]
    v_pk_fma_f32 v[22:23], v[86:87], v[142:143], v[142:143] op_sel:[0,0,1] op_sel_hi:[1,0,1]
    v_pk_fma_f32 v[24:25], v[88:89], v[142:143], v[142:143] op_sel:[0,0,1] op_sel_hi:[1,0,1]
    v_pk_fma_f32 v[26:27], v[90:91], v[142:143], v[142:143] op_sel:[0,0,1] op_sel_hi:[1,0,1]
    v_pk_fma_f32 v[28:29], v[92:93], v[142:143], v[142:143] op_sel:[0,0,1] op_sel_hi:[1,0,1]
    v_pk_fma_f32 v[30:31], v[94:95], v[142:143], v[142:143] op_sel:[0,0,1] op_sel_hi:[1,0,1]
    v_cvt_pk_bf16_f32 v132, v16, v17
    v_cvt_pk_bf16_f32 v133, v18, v19
    v_cvt_pk_bf16_f32 v134, v20, v21
    v_cvt_pk_bf16_f32 v135, v22, v23
    v_cvt_pk_bf16_f32 v136, v24, v25
    v_cvt_pk_bf16_f32 v137, v26, v27
    v_cvt_pk_bf16_f32 v138, v28, v29
    v_cvt_pk_bf16_f32 v139, v30, v31
    v_cmp_eq_u32 s[4:5], v66, v144
    v_cmp_eq_u32 s[6:7], v67, v144
    s_nop 0
    s_or_b64 s[70:71], s[4:5], s[6:7]
    s_cbranch_scc0 L_nocand2
    s_lshl_b32 s86, s51, 12
    s_lshl_b32 s87, s52, 7
    s_add_u32 s86, s86, s87
    s_add_u32 s86, s86, 6619136
    v_lshl_add_u32 v8, v1, 3, s86
    v_add_u32 v9, 2048, v8
    v_cndmask_b32 v8, v8, v9, s[6:7]
    v_mov_b32 v9, 2147483648
    v_cndmask_b32 v8, v9, v8, s[70:71]
    buffer_store_dwordx2 v[132:133], v8, s[16:19], 0 offen offset:0 sc1
    buffer_store_dwordx2 v[134:135], v8, s[16:19], 0 offen offset:32 sc1
    buffer_store_dwordx2 v[136:137], v8, s[16:19], 0 offen offset:64 sc1
    buffer_store_dwordx2 v[138:139], v8, s[16:19], 0 offen offset:96 sc1
    v_subrev_u32 v140, 65536, v8
L_nocand2:
    v_mov_b32 v9, 2147483648
    v_xor_b32 v6, 0x8000, v5
    v_lshlrev_b32 v16, 16, v96
    v_and_b32 v17, 0xffff0000, v96
    v_lshlrev_b32 v18, 16, v97
L_walk_21:
    s_cbranch_execz L_walk_25
    v_and_b32 v19, 0xffff0000, v97
    v_lshlrev_b32 v20, 16, v98
    v_and_b32 v21, 0xffff0000, v98
    v_lshlrev_b32 v22, 16, v99
    v_and_b32 v23, 0xffff0000, v99
    v_lshlrev_b32 v24, 16, v100
    v_and_b32 v25, 0xffff0000, v100
    v_lshlrev_b32 v26, 16, v101
    v_and_b32 v27, 0xffff0000, v101
    v_lshlrev_b32 v28, 16, v102
    v_and_b32 v29, 0xffff0000, v102
    v_lshlrev_b32 v30, 16, v103
    v_and_b32 v31, 0xffff0000, v103
    v_pk_add_f32 v[16:17], v[16:17], v[40:41]
    v_pk_add_f32 v[18:19], v[18:19], v[42:43]
    v_pk_add_f32 v[20:21], v[20:21], v[44:45]
    v_pk_add_f32 v[22:23], v[22:23], v[46:47]
    v_pk_add_f32 v[24:25], v[24:25], v[48:49]
    v_pk_add_f32 v[26:27], v[26:27], v[50:51]
    v_pk_add_f32 v[28:29], v[28:29], v[52:53]
    v_pk_add_f32 v[30:31], v[30:31], v[54:55]
    v_cvt_pk_bf16_f32 v104, v16, v17
    v_cvt_pk_bf16_f32 v105, v18, v19
    v_cvt_pk_bf16_f32 v106, v20, v21
    v_cvt_pk_bf16_f32 v107, v22, v23
    v_cvt_pk_bf16_f32 v108, v24, v25
    v_cvt_pk_bf16_f32 v109, v26, v27
    v_cvt_pk_bf16_f32 v110, v28, v29
    v_cvt_pk_bf16_f32 v111, v30, v31
    v_permlane16_swap_b32 v104, v106
    v_permlane16_swap_b32 v105, v107
    v_permlane16_swap_b32 v108, v110
    v_permlane16_swap_b32 v109, v111
    v_mov_b32 v16, v104
    v_mov_b32 v17, v105
    v_mov_b32 v18, v106
    v_mov_b32 v19, v107
    v_mov_b32_dpp v104, v108 row_ror:8 row_mask:0xf bank_mask:0xc
    v_mov_b32_dpp v105, v109 row_ror:8 row_mask:0xf bank_mask:0xc
    v_mov_b32_dpp v106, v110 row_ror:8 row_mask:0xf bank_mask:0xc
    v_mov_b32_dpp v107, v111 row_ror:8 row_mask:0xf bank_mask:0xc
    v_mov_b32_dpp v108, v16 row_ror:8 row_mask:0xf bank_mask:0x3
    v_mov_b32_dpp v109, v17 row_ror:8 row_mask:0xf bank_mask:0x3
    v_mov_b32_dpp v110, v18 row_ror:8 row_mask:0xf bank_mask:0x3
    v_mov_b32_dpp v111, v19 row_ror:8 row_mask:0xf bank_mask:0x3
    v_cndmask_b32 v8, v5, v9, s[96:97]
    v_lshlrev_b32 v16, 16, v132
    v_and_b32 v17, 0xffff0000, v132
    v_lshlrev_b32 v18, 16, v133
    v_and_b32 v19, 0xffff0000, v133
    v_lshlrev_b32 v20, 16, v134
    v_and_b32 v21, 0xffff0000, v134
    v_lshlrev_b32 v22, 16, v135
    v_and_b32 v23, 0xffff0000, v135
    v_lshlrev_b32 v24, 16, v136
    v_and_b32 v25, 0xffff0000, v136
    v_lshlrev_b32 v26, 16, v137
    v_and_b32 v27, 0xffff0000, v137
    v_lshlrev_b32 v28, 16, v138
    v_and_b32 v29, 0xffff0000, v138
    v_lshlrev_b32 v30, 16, v139
    v_and_b32 v31, 0xffff0000, v139
    v_pk_add_f32 v[16:17], v[16:17], v[80:81]
    v_pk_add_f32 v[18:19], v[18:19], v[82:83]
    v_pk_add_f32 v[20:21], v[20:21], v[84:85]
    v_pk_add_f32 v[22:23], v[22:23], v[86:87]
    v_pk_add_f32 v[24:25], v[24:25], v[88:89]
    v_pk_add_f32 v[26:27], v[26:27], v[90:91]
    v_pk_add_f32 v[28:29], v[28:29], v[92:93]
    v_pk_add_f32 v[30:31], v[30:31], v[94:95]
    v_cvt_pk_bf16_f32 v120, v16, v17
    v_cvt_pk_bf16_f32 v121, v18, v19
    v_cvt_pk_bf16_f32 v122, v20, v21
    v_cvt_pk_bf16_f32 v123, v22, v23
    v_cvt_pk_bf16_f32 v124, v24, v25
    v_cvt_pk_bf16_f32 v125, v26, v27
    v_cvt_pk_bf16_f32 v126, v28, v29
    v_cvt_pk_bf16_f32 v127, v30, v31
    v_permlane16_swap_b32 v120, v122
    v_permlane16_swap_b32 v121, v123
    v_permlane16_swap_b32 v124, v126
    v_permlane16_swap_b32 v125, v127
    v_mov_b32 v16, v120
    v_mov_b32 v17, v121
    v_mov_b32 v18, v122
    v_mov_b32 v19, v123
    v_mov_b32_dpp v120, v124 row_ror:8 row_mask:0xf bank_mask:0xc
    v_mov_b32_dpp v121, v125 row_ror:8 row_mask:0xf bank_mask:0xc
    v_mov_b32_dpp v122, v126 row_ror:8 row_mask:0xf bank_mask:0xc
    v_mov_b32_dpp v123, v127 row_ror:8 row_mask:0xf bank_mask:0xc
    v_mov_b32_dpp v124, v16 row_ror:8 row_mask:0xf bank_mask:0x3
    v_mov_b32_dpp v125, v17 row_ror:8 row_mask:0xf bank_mask:0x3
    v_mov_b32_dpp v126, v18 row_ror:8 row_mask:0xf bank_mask:0x3
    v_mov_b32_dpp v127, v19 row_ror:8 row_mask:0xf bank_mask:0x3
    s_cmp_eq_u64 s[96:97], 0
    s_cbranch_scc1 L_noha
    buffer_store_dwordx2 v[32:33], v131, s[16:19], 0 offen offset:0 sc1
    buffer_store_dwordx2 v[34:35], v131, s[16:19], 0 offen offset:32 sc1
    buffer_store_dwordx2 v[36:37], v131, s[16:19], 0 offen offset:64 sc1
    buffer_store_dwordx2 v[38:39], v131, s[16:19], 0 offen offset:96 sc1
L_noha:
    s_cmp_eq_u64 s[70:71], 0
    s_cbranch_scc1 L_nohb
    buffer_store_dwordx2 v[112:113], v140, s[16:19], 0 offen offset:0 sc1
    buffer_store_dwordx2 v[114:115], v140, s[16:19], 0 offen offset:32 sc1
    buffer_store_dwordx2 v[116:117], v140, s[16:19], 0 offen offset:64 sc1
    buffer_store_dwordx2 v[118:119], v140, s[16:19], 0 offen offset:96 sc1
L_nohb:
    v_mov_b32 v8, 66304
    s_barrier
    ds_read_b64 v[10:11], v8
    s_waitcnt lgkmcnt(0)
    v_cmp_ne_u32 s[4:5], v10, v13
    v_cmp_ne_u32 s[6:7], v11, v13
    s_nop 0
    s_and_b64 s[4:5], s[4:5], s[6:7]
    v_cndmask_b32 v8, v9, v5, s[4:5]
    v_add_u32 v17, 64, v8
    v_mov_b32 v16, v8
    s_nop 1
    v_mov_b32_dpp v16, v17 row_ror:8 row_mask:0xf bank_mask:0xc
    v_mov_b32_dpp v17, v8 row_ror:8 row_mask:0xf bank_mask:0x3
    buffer_store_dwordx4 v[104:107], v16, s[24:27], 0 offen sc1
    v_cmp_ne_u32 s[4:5], v10, v144
    v_cmp_ne_u32 s[6:7], v11, v144
    s_nop 0
    s_and_b64 s[4:5], s[4:5], s[6:7]
    v_cndmask_b32 v8, v9, v6, s[4:5]
    v_add_u32 v19, 64, v8
    v_mov_b32 v18, v8
    s_nop 1
    v_mov_b32_dpp v18, v19 row_ror:8 row_mask:0xf bank_mask:0xc
    v_mov_b32_dpp v19, v8 row_ror:8 row_mask:0xf bank_mask:0x3
    s_barrier
    s_barrier
    s_barrier
    buffer_store_dwordx4 v[108:111], v17, s[24:27], 0 offen sc1
    buffer_store_dwordx4 v[120:123], v18, s[24:27], 0 offen sc1
    buffer_store_dwordx4 v[124:127], v19, s[24:27], 0 offen sc1
    s_branch L_fin
L_t3_ld:
    s_mov_b32 s90, 6144
    buffer_load_dwordx4 v[240:243], v14, s[36:39], s90 offen
    s_mov_b32 s90, 8192
    buffer_load_dwordx4 v[244:247], v14, s[36:39], s90 offen
    s_mov_b32 s90, 10240
    buffer_load_dwordx4 v[248:251], v14, s[36:39], s90 offen
    s_mov_b32 s90, 12288
    buffer_load_dwordx4 v[252:255], v14, s[36:39], s90 offen
    v_bfe_u32 v8, v0, 3, 1
    s_waitcnt lgkmcnt(0)
    v_lshl_add_u32 v10, v1, 5, s67
    s_mov_b32 s60, 0
    s_mov_b32 s61, 0
    s_lshl_b32 s63, 1, s51
    s_mov_b32 m0, s51
    s_waitcnt lgkmcnt(0)
    v_max3_u32 v96, v60, v61, v62
    v_max_u32 v98, v96, v63
    v_med3_u32 v99, v60, v61, v62
    v_med3_u32 v99, v96, v99, v63
    v_min_u32_dpp v96, v98, v98 row_ror:8 row_mask:0xf bank_mask:0xf
    v_max_u32_dpp v98, v98, v98 row_ror:8 row_mask:0xf bank_mask:0xf
    v_max_u32_dpp v97, v99, v99 row_ror:8 row_mask:0xf bank_mask:0xf
    v_max_u32 v99, v96, v97
    v_min_u32_dpp v96, v98, v98 row_ror:4 row_mask:0xf bank_mask:0xf
    v_max_u32_dpp v98, v98, v98 row_ror:4 row_mask:0xf bank_mask:0xf
    v_max_u32_dpp v97, v99, v99 row_ror:4 row_mask:0xf bank_mask:0xf
L_walk_22:
    s_cbranch_execz L_walked2
    v_max_u32 v99, v96, v97
    v_min_u32_dpp v96, v98, v98 row_ror:2 row_mask:0xf bank_mask:0xf
    v_max_u32_dpp v98, v98, v98 row_ror:2 row_mask:0xf bank_mask:0xf
    v_max_u32_dpp v97, v99, v99 row_ror:2 row_mask:0xf bank_mask:0xf
    v_max_u32 v99, v96, v97
    v_min_u32_dpp v96, v98, v98 row_ror:1 row_mask:0xf bank_mask:0xf
    v_max_u32_dpp v60, v98, v98 row_ror:1 row_mask:0xf bank_mask:0xf
    v_max_u32_dpp v97, v99, v99 row_ror:1 row_mask:0xf bank_mask:0xf
    v_max_u32_dpp v98, v98, v98 row_ror:1 row_mask:0xf bank_mask:0xf
    v_max_u32 v99, v96, v97
    v_max_u32 v97, v96, v97
    v_permlane16_swap_b32 v98, v60
    v_min_u32 v96, v98, v60
    v_permlane16_swap_b32 v99, v97
    v_max_u32 v98, v98, v60
    v_max3_u32 v99, v96, v99, v97
    v_readfirstlane_b32 s58, v98
    v_readfirstlane_b32 s59, v99
    s_mov_b32 s76, 0x05040100
    s_mov_b32 s77, 0x07060302
    s_mov_b32 s6, 0xffff0000
    s_mov_b32 s7, 0xffff0000
    v_perm_b32 v32, v168, v164, s76
    v_perm_b32 v33, v176, v172, s76
    v_perm_b32 v34, v184, v180, s76
    v_perm_b32 v35, v192, v188, s76
    v_perm_b32 v36, v168, v164, s77
    v_perm_b32 v37, v176, v172, s77
    v_perm_b32 v38, v184, v180, s77
    v_perm_b32 v39, v192, v188, s77
    v_perm_b32 v40, v169, v165, s76
    v_perm_b32 v41, v177, v173, s76
    v_perm_b32 v42, v185, v181, s76
    v_perm_b32 v43, v193, v189, s76
    v_perm_b32 v44, v169, v165, s77
    v_perm_b32 v45, v177, v173, s77
    v_perm_b32 v46, v185, v181, s77
    v_perm_b32 v47, v193, v189, s77
    v_perm_b32 v48, v170, v166, s76
    v_perm_b32 v49, v178, v174, s76
    v_perm_b32 v50, v186, v182, s76
    v_perm_b32 v51, v194, v190, s76
    v_perm_b32 v52, v170, v166, s77
    v_perm_b32 v53, v178, v174, s77
    v_perm_b32 v54, v186, v182, s77
    v_perm_b32 v55, v194, v190, s77
    v_perm_b32 v56, v171, v167, s76
    v_perm_b32 v57, v179, v175, s76
    v_perm_b32 v58, v187, v183, s76
    v_perm_b32 v59, v195, v191, s76
    v_perm_b32 v60, v171, v167, s77
    v_perm_b32 v61, v179, v175, s77
    v_perm_b32 v62, v187, v183, s77
    v_perm_b32 v63, v195, v191, s77
    v_perm_b32 v164, v200, v196, s76
    v_perm_b32 v165, v208, v204, s76
    v_perm_b32 v166, v216, v212, s76
    v_perm_b32 v167, v224, v220, s76
    v_perm_b32 v168, v200, v196, s77
    v_perm_b32 v169, v208, v204, s77
    v_perm_b32 v170, v216, v212, s77
    v_perm_b32 v171, v224, v220, s77
    v_perm_b32 v172, v201, v197, s76
    v_perm_b32 v173, v209, v205, s76
    v_perm_b32 v174, v217, v213, s76
    v_perm_b32 v175, v225, v221, s76
    v_perm_b32 v176, v201, v197, s77
    v_perm_b32 v177, v209, v205, s77
    v_perm_b32 v178, v217, v213, s77
    v_perm_b32 v179, v225, v221, s77
    v_perm_b32 v180, v202, v198, s76
    v_perm_b32 v181, v210, v206, s76
    v_perm_b32 v182, v218, v214, s76
    v_perm_b32 v183, v226, v222, s76
    v_perm_b32 v184, v202, v198, s77
    v_perm_b32 v185, v210, v206, s77
    v_perm_b32 v186, v218, v214, s77
    v_perm_b32 v187, v226, v222, s77
    v_perm_b32 v188, v203, v199, s76
    v_perm_b32 v189, v211, v207, s76
    v_perm_b32 v190, v219, v215, s76
    v_perm_b32 v191, v227, v223, s76
    v_perm_b32 v192, v203, v199, s77
    v_perm_b32 v193, v211, v207, s77
    v_perm_b32 v194, v219, v215, s77
    v_perm_b32 v195, v227, v223, s77
    v_min_u32 v22, 16, v0
    v_and_b32 v22, 16, v22
    v_and_or_b32 v22, v0, 15, v22
    v_lshlrev_b32 v22, 3, v22
    v_add_u32 v22, 66304, v22
    s_waitcnt vmcnt(4)
    s_branch L_h4_chk0
L_h4_w0:
    s_waitcnt vmcnt(0)
L_h4_chk0:
    v_cmp_eq_u32 vcc, -1, v128
    s_nop 0
    s_andn2_b32 s86, vcc_lo, s63
    s_cbranch_scc0 L_h4_all0
    v_cndmask_b32 v96, v128, 0, vcc
    v_cndmask_b32 v97, v129, 0, vcc
    v_mov_b32 v128, 0
    v_mov_b32 v129, 0
    buffer_atomic_or_x2 v[128:129], v148, s[16:19], 0 offen sc0 sc1
    s_sub_u32 s56, s56, 1
    s_cbranch_scc1 L_h4_out
    v_min_u32_dpp v98, v96, v96 row_ror:8 row_mask:0xf bank_mask:0xf
    v_max_u32_dpp v96, v96, v96 row_ror:8 row_mask:0xf bank_mask:0xf
    v_max_u32_dpp v99, v97, v97 row_ror:8 row_mask:0xf bank_mask:0xf
    v_max_u32 v97, v98, v99
    v_min_u32_dpp v98, v96, v96 row_ror:4 row_mask:0xf bank_mask:0xf
    v_max_u32_dpp v96, v96, v96 row_ror:4 row_mask:0xf bank_mask:0xf
    v_max_u32_dpp v99, v97, v97 row_ror:4 row_mask:0xf bank_mask:0xf
    v_max_u32 v97, v98, v99
    v_min_u32_dpp v98, v96, v96 row_ror:2 row_mask:0xf bank_mask:0xf
    v_max_u32_dpp v96, v96, v96 row_ror:2 row_mask:0xf bank_mask:0xf
    v_max_u32_dpp v99, v97, v97 row_ror:2 row_mask:0xf bank_mask:0xf
    v_max_u32 v97, v98, v99
    v_min_u32_dpp v98, v96, v96 row_ror:1 row_mask:0xf bank_mask:0xf
    v_max_u32_dpp v96, v96, v96 row_ror:1 row_mask:0xf bank_mask:0xf
    v_max_u32_dpp v99, v97, v97 row_ror:1 row_mask:0xf bank_mask:0xf
    v_max_u32 v97, v98, v99
    v_readlane_b32 s70, v96, 0
    v_readlane_b32 s71, v97, 0
    s_nop 0
    s_cmp_eq_u64 s[70:71], s[60:61]
    s_cbranch_scc1 L_h4_w0
    s_mov_b64 s[60:61], s[70:71]
    s_bfe_u32 s86, s60, 0x40007
    s_bfe_u32 s87, s61, 0x40007
    s_sub_u32 s87, s86, s87
    s_lshl_b32 s87, s87, 12
    s_cselect_b32 s69, s87, 2048
    v_mad_i32_i24 v130, v8, s69, v10
    s_xor_b32 s86, s86, 15
    s_lshl_b32 s66, s86, 12
    buffer_load_dwordx4 v[64:67], v130, s[16:19], s66 offen sc1
    buffer_load_dwordx4 v[68:71], v130, s[16:19], s66 offen offset:16 sc1
    ds_write_b64 v22, v[96:97]
    s_waitcnt vmcnt(2)
    s_branch L_h4_chk0
L_h4_own:
    s_waitcnt vmcnt(0)
    v_mov_b32 v128, 0
    v_mov_b32 v129, 0
    buffer_atomic_or_x2 v[128:129], v148, s[16:19], 0 offen sc0 sc1
    s_sub_u32 s56, s56, 1
    s_cbranch_scc0 L_h4_w0
L_h4_out:
    s_mov_b32 s56, 0
    s_waitcnt vmcnt(0)
    s_mov_b64 vcc, 0
L_h4_all0:
    v_cmp_lt_u32 s[4:5], s61, v128
    v_cmp_ne_u32 s[72:73], s60, v128
    v_cmp_lt_u32 s[74:75], s61, v129
    s_cmp_ge_u32 s58, s61
    s_cselect_b32 s86, vcc_lo, 0
    s_and_b32 s4, s4, s72
    s_or_b32 s4, s4, s74
    s_andn2_b32 s4, s4, vcc_lo
    s_or_b32 s4, s4, s86
    s_cbranch_scc0 L_h4_go
    v_writelane_b32 v128, s58, m0
    v_writelane_b32 v129, s59, m0
    s_nop 0
L_walk_23:
    s_cbranch_execz L_walked2
    v_min_u32_dpp v98, v128, v128 row_ror:8 row_mask:0xf bank_mask:0xf
    v_max_u32_dpp v96, v128, v128 row_ror:8 row_mask:0xf bank_mask:0xf
    v_max_u32_dpp v99, v129, v129 row_ror:8 row_mask:0xf bank_mask:0xf
    v_max_u32 v97, v98, v99
L_h4_all:
    v_min_u32_dpp v98, v96, v96 row_ror:4 row_mask:0xf bank_mask:0xf
    v_max_u32_dpp v96, v96, v96 row_ror:4 row_mask:0xf bank_mask:0xf
    v_max_u32_dpp v99, v97, v97 row_ror:4 row_mask:0xf bank_mask:0xf
    v_max_u32 v97, v98, v99
    v_min_u32_dpp v98, v96, v96 row_ror:2 row_mask:0xf bank_mask:0xf
    v_max_u32_dpp v96, v96, v96 row_ror:2 row_mask:0xf bank_mask:0xf
    v_max_u32_dpp v99, v97, v97 row_ror:2 row_mask:0xf bank_mask:0xf
    v_max_u32 v97, v98, v99
    v_min_u32_dpp v98, v96, v96 row_ror:1 row_mask:0xf bank_mask:0xf
    v_max_u32_dpp v96, v96, v96 row_ror:1 row_mask:0xf bank_mask:0xf
    v_max_u32_dpp v99, v97, v97 row_ror:1 row_mask:0xf bank_mask:0xf
    v_max_u32 v97, v98, v99
    ds_write_b64 v22, v[96:97]
    v_readlane_b32 s70, v96, 0
    v_readlane_b32 s71, v97, 0
    s_nop 0
    s_cmp_ge_u32 s58, s71
    s_cselect_b32 s86, vcc_lo, 0
    s_cmp_lg_u32 s86, 0
    s_cbranch_scc1 L_h4_own
    s_cmp_eq_u64 s[70:71], s[60:61]
    s_cbranch_scc1 L_h4_go
    s_mov_b64 s[60:61], s[70:71]
    s_bfe_u32 s86, s60, 0x40007
    s_bfe_u32 s87, s61, 0x40007
    s_sub_u32 s87, s86, s87
    s_lshl_b32 s87, s87, 12
    s_cselect_b32 s69, s87, 2048
    v_mad_i32_i24 v130, v8, s69, v10
    s_xor_b32 s86, s86, 15
    s_lshl_b32 s66, s86, 12
    buffer_load_dwordx4 v[64:67], v130, s[16:19], s66 offen sc1
    buffer_load_dwordx4 v[68:71], v130, s[16:19], s66 offen offset:16 sc1
L_h4_go:
    s_waitcnt lgkmcnt(0)
    s_barrier
    s_waitcnt vmcnt(0)
    v_max3_u32 v16, v65, v67, v69
    v_max_u32 v16, v16, v71
    v_cmp_eq_u32 vcc, -1, v16
    s_cbranch_vccnz L_seg
L_seg_done:
    v_mfma_f32_16x16x32_bf16 v[196:199], v[64:67], v[32:35], 0
    v_mfma_f32_16x16x32_bf16 v[212:215], v[64:67], v[48:51], 0
    v_mfma_f32_16x16x32_bf16 v[196:199], v[68:71], v[164:167], v[196:199]
    v_mfma_f32_16x16x32_bf16 v[212:215], v[68:71], v[180:183], v[212:215]
    v_mfma_f32_16x16x32_bf16 v[200:203], v[64:67], v[36:39], 0
    v_mfma_f32_16x16x32_bf16 v[216:219], v[64:67], v[52:55], 0
    v_mfma_f32_16x16x32_bf16 v[200:203], v[68:71], v[168:171], v[200:203]
    v_mfma_f32_16x16x32_bf16 v[216:219], v[68:71], v[184:187], v[216:219]
    s_nop 3
    v_cndmask_b32 v88, v196, v212, s[6:7]
    v_mfma_f32_16x16x32_bf16 v[204:207], v[64:67], v[40:43], 0
    v_mfma_f32_16x16x32_bf16 v[220:223], v[64:67], v[56:59], 0
    v_mfma_f32_16x16x32_bf16 v[204:207], v[68:71], v[172:175], v[204:207]
    v_mfma_f32_16x16x32_bf16 v[220:223], v[68:71], v[188:191], v[220:223]
    v_cndmask_b32 v89, v200, v216, s[6:7]
    v_mfma_f32_16x16x32_bf16 v[208:211], v[64:67], v[44:47], 0
    v_mfma_f32_16x16x32_bf16 v[224:227], v[64:67], v[60:63], 0
    v_mfma_f32_16x16x32_bf16 v[208:211], v[68:71], v[176:179], v[208:211]
    v_mfma_f32_16x16x32_bf16 v[224:227], v[68:71], v[192:195], v[224:227]
    s_nop 2
    v_cndmask_b32 v90, v204, v220, s[6:7]
    s_nop 3
    v_cndmask_b32 v91, v208, v224, s[6:7]
    ds_write_b128 v18, v[88:91]
    s_waitcnt lgkmcnt(0)
    s_barrier
    ds_read2st64_b32 v[24:25], v133 offset0:0 offset1:4
    ds_read2st64_b32 v[26:27], v133 offset0:8 offset1:12
    s_mov_b32 s79, 114688
    s_cmp_eq_u32 s83, 0
    s_waitcnt lgkmcnt(0)
    v_pk_add_f32 v[24:25], v[24:25], v[26:27]
    v_add_f32 v24, v24, v25
    s_cbranch_scc1 L_h5_far
    buffer_store_dword v24, v131, s[16:19], 0 offen
L_h5_out:
    s_lshr_b32 s88, s48, 1
    s_cselect_b32 s86, s69, 0
    s_cselect_b32 s63, s61, s60
    s_and_b32 s87, s48, 1
    s_and_b32 s89, s82, 7
    s_lshl1_add_u32 s87, s89, s87
    s_lshl_b32 s87, s87, 7
    s_add_u32 s86, s86, s66
    s_add_u32 s86, s86, s87
    s_add_u32 s86, s86, 6553600
    v_lshl_add_u32 v142, v0, 1, s86
    v_mov_b32 v140, 0
    v_mov_b32 v141, 0
    s_mov_b32 s65, 65536
    buffer_load_short_d16_hi v140, v142, s[16:19], 0 offen sc1
    buffer_load_short_d16_hi v141, v142, s[16:19], s65 offen sc1
    s_and_b32 s86, s63, 0x7ff
    s_sub_u32 s86, 2047, s86
    s_lshl_b32 s86, s86, 11
    s_add_u32 s86, s86, s87
    v_lshl_add_u32 v143, v0, 1, s86
    s_ashr_i32 s86, s63, 31
    s_orn2_b32 s86, 0x80000000, s86
    s_xor_b32 s63, s63, s86
    s_and_b32 s63, s63, 0xffff0000
    s_lshr_b32 s86, s48, 1
    s_and_b32 s87, s48, 1
    s_lshl_b32 s88, s86, 9
    s_lshl_b32 s89, s87, 7
    s_add_u32 s88, s88, s89
    s_add_u32 s88, s88, 94208
    v_lshrrev_b32 v17, 3, v0
    v_lshl_add_u32 v20, v17, 4, s88
    v_bfe_u32 v9, v0, 2, 1
    v_lshl_add_u32 v20, v9, 8, v20
    v_and_b32 v9, 3, v0
    v_lshl_add_u32 v20, v9, 2, v20
    s_and_b32 s89, s82, 7
    s_lshl3_add_u32 s86, s86, s89
    s_lshl1_add_u32 s86, s86, s87
    s_lshl_b32 s86, s86, 11
    s_add_u32 s86, s86, 917504
    v_lshl_add_u32 v9, v17, 8, s86
    v_and_b32 v17, 7, v0
    v_lshl_add_u32 v9, v17, 3, v9
    s_mov_b32 s76, 0
    s_mov_b32 s77, 0x41900000
    s_lshl_b32 s86, s48, 7
    s_add_u32 s86, s86, 100352
    v_lshl_add_u32 v11, v8, 6, s86
    v_lshl_add_u32 v11, v1, 4, v11
    v_and_b32 v16, 7, v0
    v_cmp_eq_u32 vcc, 7, v16
    v_lshl_add_u32 v16, v16, 2, v1
    v_mul_u32_u24 v17, 37, v16
    v_lshrrev_b32 v17, 8, v17
    v_add_u32 v16, v16, v17
    v_lshl_or_b32 v17, v1, 3, 7
    v_cndmask_b32 v16, v16, v17, vcc
    v_lshl_add_u32 v16, v8, 5, v16
    v_lshl_add_u32 v10, v16, 1, s86
    v_mov_b32 v144, s63
    v_mul_f32 v144, 0xbfb8aa3b, v144
    v_exp_f32 v144, v144
    s_nop 0
    v_add_f32 v144, 1.0, v144
    v_rcp_f32 v144, v144
    s_nop 0
    v_cvt_pk_bf16_f32 v144, v144, v144
    v_lshlrev_b32 v144, 16, v144
    s_mov_b32 s6, 0x80808080
    s_mov_b32 s7, 0x80808080
    v_mov_b32 v19, v9
    buffer_load_dwordx4 v[112:115], v137, s[16:19], 0 offen sc1
    buffer_load_dwordx4 v[116:119], v137, s[16:19], s79 offen sc1
    s_waitcnt vmcnt(0)
    v_max_u32 v16, v115, v119
    v_cmp_eq_u32 vcc, -1, v16
    s_cbranch_vccnz L_h5
L_h5_done:
    v_permlane32_swap_b32 v112, v114
    v_permlane32_swap_b32 v113, v115
    v_permlane32_swap_b32 v116, v118
    v_permlane32_swap_b32 v117, v119
    v_add_f32 v112, v112, v114
    v_add_f32 v113, v113, v115
    v_add_f32 v116, v116, v118
    v_add_f32 v117, v117, v119
    v_permlane16_swap_b32 v112, v113
    s_nop 0
    v_permlane16_swap_b32 v116, v117
    v_add_f32 v112, v112, v113
    v_add_f32 v116, v116, v117
    v_cvt_pk_bf16_f32 v25, v112, v116
    v_lshlrev_b32 v24, 16, v25
    v_and_b32 v28, 0xffff0000, v25
    v_mul_f32 v25, 0xbfb8aa3b, v24
    v_exp_f32 v25, v25
    s_nop 0
    v_add_f32 v25, 1.0, v25
    v_rcp_f32 v25, v25
    s_nop 0
    v_mul_f32 v24, v24, v25
    v_cvt_pk_bf16_f32 v24, v24, v24
    v_lshlrev_b32 v24, 16, v24
    v_mul_f32 v24, v24, v28
    v_cvt_pk_bf16_f32 v24, v24, v24
    ds_write_b16 v10, v24
L_walk_24:
    s_cbranch_execz L_walked2
    ds_read_b128 v[64:67], v11
    s_waitcnt lgkmcnt(0)
    v_perm_b32 v80, v64, v64, v72
    v_perm_b32 v81, v64, v64, v73
    v_perm_b32 v82, v64, v64, v74
    v_perm_b32 v83, v64, v64, v75
    v_perm_b32 v84, v64, v64, v76
    v_perm_b32 v85, v64, v64, v77
    v_perm_b32 v86, v64, v64, v78
    v_perm_b32 v87, v64, v64, v79
    v_mfma_f32_16x16x32_bf16 v[88:91], v[80:83], v[228:231], 0
    v_perm_b32 v92, v65, v65, v72
    v_perm_b32 v93, v65, v65, v73
    v_perm_b32 v94, v65, v65, v74
    v_perm_b32 v95, v65, v65, v75
    v_mfma_f32_16x16x32_bf16 v[88:91], v[84:87], v[232:235], v[88:91]
    v_perm_b32 v80, v65, v65, v76
    v_perm_b32 v81, v65, v65, v77
    v_perm_b32 v82, v65, v65, v78
    v_perm_b32 v83, v65, v65, v79
    v_mfma_f32_16x16x32_bf16 v[88:91], v[92:95], v[236:239], v[88:91]
    v_perm_b32 v84, v66, v66, v72
    v_perm_b32 v85, v66, v66, v73
    v_perm_b32 v86, v66, v66, v74
    v_perm_b32 v87, v66, v66, v75
    v_mfma_f32_16x16x32_bf16 v[88:91], v[80:83], v[240:243], v[88:91]
    v_perm_b32 v92, v66, v66, v76
    v_perm_b32 v93, v66, v66, v77
    v_perm_b32 v94, v66, v66, v78
    v_perm_b32 v95, v66, v66, v79
    v_mfma_f32_16x16x32_bf16 v[88:91], v[84:87], v[244:247], v[88:91]
    v_perm_b32 v80, v67, v67, v72
    v_perm_b32 v81, v67, v67, v73
    v_perm_b32 v82, v67, v67, v74
    v_perm_b32 v83, v67, v67, v75
    v_mfma_f32_16x16x32_bf16 v[88:91], v[92:95], v[248:251], v[88:91]
    s_nop 0
    v_mfma_f32_16x16x32_bf16 v[88:91], v[80:83], v[252:255], v[88:91]
    s_nop 7
    ds_write_b128 v18, v[88:91] offset:4096
    s_waitcnt lgkmcnt(0)
    s_barrier
    ds_read2st64_b32 v[24:25], v20 offset0:0 offset1:4
    ds_read2st64_b32 v[26:27], v20 offset0:8 offset1:12
    s_waitcnt lgkmcnt(0)
    v_pk_add_f32 v[24:25], v[24:25], v[26:27]
    v_add_f32 v24, v24, v25
    v_cvt_f64_f32 v[26:27], v24
    v_add_f64 v[24:25], v[26:27], s[76:77]
    buffer_atomic_add_f64 v[24:25], v19, s[16:19], 0 offen sc0 sc1
    s_barrier
    s_mov_b32 s77, 0xc1df0000
    v_add_f64 v[26:27], v[26:27], s[76:77]
    s_waitcnt vmcnt(1)
    v_max_u32 v16, v140, v141
    v_cmp_eq_u32 vcc, 0xffff0000, v16
    s_cbranch_vccnz L_fin_ld
L_fin_go:
    s_mov_b32 s88, 0x4c000000
    v_mov_b32 v17, 2147483648
    s_waitcnt vmcnt(0)
    v_add_f64 v[24:25], v[24:25], v[26:27]
    v_cvt_f32_f64 v24, v[24:25]
    v_cmp_lt_f32 vcc, |v24|, s88
    v_cvt_pk_bf16_f32 v24, v24, v24
    v_lshlrev_b32 v24, 16, v24
    v_mul_f32 v24, v24, v144
    v_cndmask_b32 v17, v17, v143, vcc
    v_cvt_pk_bf16_f32 v24, v24, v24
    v_lshlrev_b32 v24, 16, v24
    v_add_f32 v24, v24, v141
    v_cvt_pk_bf16_f32 v24, v24, v24
    v_lshlrev_b32 v24, 16, v24
    v_add_f32 v24, v24, v140
    v_cvt_pk_bf16_f32 v24, v24, v24
    buffer_store_short v24, v17, s[24:27], 0 offen
L_fin:
L_end:
    s_endpgm
L_b_restart:
    s_waitcnt vmcnt(0)
    v_xor_b32 v9, 0x8000, v7
    buffer_load_dwordx4 v[136:139], v7, s[8:11], 0 offen
    buffer_load_dwordx4 v[140:143], v9, s[8:11], 0 offen
    v_mov_b32 v8, s68
    s_mov_b32 s66, 0xffffaaaa
    s_mov_b32 s63, 1
    s_branch L_b_init
L_b_g4:
    s_lshr_b32 s86, s78, 2
    buffer_load_dwordx4 v[48:51], v157, s[16:19], s86 offen offset:0 sc1
    buffer_load_dwordx4 v[52:55], v158, s[16:19], s86 offen offset:0 sc1
    s_waitcnt vmcnt(0)
    s_sub_u32 s56, s56, 1
    s_cbranch_scc0 L_b_c4
    s_mov_b32 s56, 0
    s_branch L_b_d4
L_b_g5:
    s_lshr_b32 s86, s78, 2
    buffer_load_dwordx4 v[56:59], v157, s[16:19], s86 offen offset:1024 sc1
    buffer_load_dwordx4 v[60:63], v158, s[16:19], s86 offen offset:1024 sc1
    s_waitcnt vmcnt(0)
    s_sub_u32 s56, s56, 1
    s_cbranch_scc0 L_b_c5
    s_mov_b32 s56, 0
    s_branch L_b_d5
L_b_g6:
    s_lshr_b32 s86, s79, 2
    buffer_load_dwordx4 v[64:67], v157, s[16:19], s86 offen offset:0 sc1
    buffer_load_dwordx4 v[68:71], v158, s[16:19], s86 offen offset:0 sc1
    s_waitcnt vmcnt(0)
    s_sub_u32 s56, s56, 1
    s_cbranch_scc0 L_b_c6
    s_mov_b32 s56, 0
    s_branch L_b_d6
L_b_g7:
    s_lshr_b32 s86, s79, 2
    buffer_load_dwordx4 v[72:75], v157, s[16:19], s86 offen offset:1024 sc1
    buffer_load_dwordx4 v[76:79], v158, s[16:19], s86 offen offset:1024 sc1
    s_waitcnt vmcnt(0)
    s_sub_u32 s56, s56, 1
    s_cbranch_scc0 L_b_c7
    s_mov_b32 s56, 0
    s_branch L_b_d7
L_b_g8:
    s_lshr_b32 s86, s76, 2
    buffer_load_dwordx4 v[16:19], v157, s[16:19], s86 offen offset:0 sc1
    buffer_load_dwordx4 v[20:23], v158, s[16:19], s86 offen offset:0 sc1
    s_waitcnt vmcnt(0)
    s_sub_u32 s56, s56, 1
    s_cbranch_scc0 L_b_c8
    s_mov_b32 s56, 0
    s_branch L_b_d8
L_b_g9:
    s_lshr_b32 s86, s76, 2
    buffer_load_dwordx4 v[24:27], v157, s[16:19], s86 offen offset:1024 sc1
    buffer_load_dwordx4 v[28:31], v158, s[16:19], s86 offen offset:1024 sc1
    s_waitcnt vmcnt(0)
    s_sub_u32 s56, s56, 1
    s_cbranch_scc0 L_b_c9
    s_mov_b32 s56, 0
    s_branch L_b_d9
L_b_g10:
    s_lshr_b32 s86, s77, 2
    buffer_load_dwordx4 v[32:35], v157, s[16:19], s86 offen offset:0 sc1
    buffer_load_dwordx4 v[36:39], v158, s[16:19], s86 offen offset:0 sc1
    s_waitcnt vmcnt(0)
    s_sub_u32 s56, s56, 1
    s_cbranch_scc0 L_b_c10
    s_mov_b32 s56, 0
    s_branch L_b_d10
L_b_g11:
    s_lshr_b32 s86, s77, 2
    buffer_load_dwordx4 v[40:43], v157, s[16:19], s86 offen offset:1024 sc1
    buffer_load_dwordx4 v[44:47], v158, s[16:19], s86 offen offset:1024 sc1
    s_waitcnt vmcnt(0)
    s_sub_u32 s56, s56, 1
    s_cbranch_scc0 L_b_c11
    s_mov_b32 s56, 0
    s_branch L_b_d11
L_b_g12:
    s_lshr_b32 s86, s78, 2
    buffer_load_dwordx4 v[48:51], v157, s[16:19], s86 offen offset:0 sc1
    buffer_load_dwordx4 v[52:55], v158, s[16:19], s86 offen offset:0 sc1
    s_waitcnt vmcnt(0)
    s_sub_u32 s56, s56, 1
    s_cbranch_scc0 L_b_c12
    s_mov_b32 s56, 0
    s_branch L_b_d12
L_b_g13:
    s_lshr_b32 s86, s78, 2
    buffer_load_dwordx4 v[56:59], v157, s[16:19], s86 offen offset:1024 sc1
    buffer_load_dwordx4 v[60:63], v158, s[16:19], s86 offen offset:1024 sc1
    s_waitcnt vmcnt(0)
    s_sub_u32 s56, s56, 1
    s_cbranch_scc0 L_b_c13
    s_mov_b32 s56, 0
    s_branch L_b_d13
L_b_g14:
    s_lshr_b32 s86, s79, 2
    buffer_load_dwordx4 v[64:67], v157, s[16:19], s86 offen offset:0 sc1
    buffer_load_dwordx4 v[68:71], v158, s[16:19], s86 offen offset:0 sc1
    s_waitcnt vmcnt(0)
    s_sub_u32 s56, s56, 1
    s_cbranch_scc0 L_b_c14
    s_mov_b32 s56, 0
    s_branch L_b_d14
L_b_g15:
    s_lshr_b32 s86, s79, 2
    buffer_load_dwordx4 v[72:75], v157, s[16:19], s86 offen offset:1024 sc1
    buffer_load_dwordx4 v[76:79], v158, s[16:19], s86 offen offset:1024 sc1
    s_waitcnt vmcnt(0)
    s_sub_u32 s56, s56, 1
    s_cbranch_scc0 L_b_c15
    s_mov_b32 s56, 0
    s_branch L_b_d15
L_b_p0:
    v_mov_b32 v8, 0
    buffer_atomic_or v8, v159, s[16:19], 0 offen sc0 sc1
L_b_w0:
    s_waitcnt vmcnt(0)
    ds_write_b32 v12, v12
    v_mov_b32 v12, v162
    v_cmp_eq_u32 vcc, s68, v8
    s_nop 0
    s_lshr_b32 s65, vcc_lo, 1
    s_and_b32 s65, s65, vcc_lo
    s_andn2_b32 s65, s65, s66
    s_cbranch_scc0 L_b_q0
    s_or_b32 s66, s66, s65
    s_branch L_b_r0
L_walk_25:
    s_cbranch_execz L_walked2
L_b_q0:
    s_sub_u32 s56, s56, 1
    s_cbranch_scc0 L_b_p0
    s_mov_b32 s56, 0
    s_not_b32 s65, s66
    s_branch L_b_r0
L_b_p1:
    v_mov_b32 v8, 0
    buffer_atomic_or v8, v159, s[16:19], 0 offen sc0 sc1
    s_waitcnt vmcnt(0)
    v_cmp_eq_u32 vcc, s68, v8
    s_nop 0
    s_lshr_b32 s65, vcc_lo, 1
    s_and_b32 s65, s65, vcc_lo
    s_andn2_b32 s65, s65, s66
    s_cbranch_scc0 L_b_q1
    s_or_b32 s66, s66, s65
    s_branch L_b_r1
L_b_q1:
    s_sub_u32 s56, s56, 1
    s_cbranch_scc0 L_b_p1
    s_mov_b32 s56, 0
    s_not_b32 s65, s66
    s_branch L_b_r1
L_h3:
    s_sub_u32 s56, s56, 1
    s_cbranch_scc1 L_h3_to
    v_mov_b32 v67, 0
    buffer_atomic_or v67, v160, s[16:19], 0 offen sc0 sc1
    s_waitcnt vmcnt(0)
    v_cmp_ne_u32 vcc, 0x41800000, v67
    s_nop 0
    s_and_b64 vcc, vcc, s[74:75]
    s_cbranch_scc0 L_h3_done
    s_branch L_h3
L_h3_to:
    s_mov_b32 s56, 0
    s_branch L_h3_done
L_seg:
    s_sub_u32 s56, s56, 1
    s_cbranch_scc1 L_seg_to
    buffer_load_dwordx4 v[64:67], v130, s[16:19], s66 offen sc1
    buffer_load_dwordx4 v[68:71], v130, s[16:19], s66 offen offset:16 sc1
    s_waitcnt vmcnt(0)
    v_max3_u32 v16, v65, v67, v69
    v_max_u32 v16, v16, v71
    v_cmp_eq_u32 vcc, -1, v16
    s_cbranch_vccz L_seg_done
    s_branch L_seg
L_seg_to:
    s_mov_b32 s56, 0
    s_branch L_seg_done
L_h5_far:
    buffer_store_dword v24, v131, s[16:19], 0 offen sc1
    s_branch L_h5_out
L_h5:
    s_sub_u32 s56, s56, 1
    s_cbranch_scc1 L_h5_to
    v_cmp_eq_u32 vcc, -1, v115
    s_cbranch_vccz L_h5_s0
    s_mov_b64 exec, vcc
    buffer_load_dwordx4 v[112:115], v137, s[16:19], 0 offen sc1
    s_mov_b64 exec, -1
L_h5_s0:
    v_cmp_eq_u32 vcc, -1, v119
    s_cbranch_vccz L_h5_s1
    s_mov_b64 exec, vcc
    buffer_load_dwordx4 v[116:119], v137, s[16:19], s79 offen sc1
    s_mov_b64 exec, -1
L_h5_s1:
    s_waitcnt vmcnt(0)
    v_max_u32 v16, v115, v119
    v_cmp_eq_u32 vcc, -1, v16
    s_cbranch_vccz L_h5_done
    s_branch L_h5
L_h5_to:
    s_mov_b32 s56, 0
    s_branch L_h5_done
L_fin_ld:
    buffer_load_short_d16_hi v140, v142, s[16:19], 0 offen sc1
    buffer_load_short_d16_hi v141, v142, s[16:19], s65 offen sc1
    s_waitcnt vmcnt(0)
    v_max_u32 v16, v140, v141
    v_cmp_eq_u32 vcc, 0xffff0000, v16
    s_cbranch_vccz L_fin_go
    s_sub_u32 s56, s56, 1
    s_cbranch_scc0 L_fin_ld
    s_branch L_fin_go
L_last:
    s_endpgm
.section .rodata,"a"
.p2align 6
.amdhsa_kernel sequential_preLN__linear_attn_block__moe_arch_mod__prompt_kernel
  .amdhsa_next_free_vgpr 256
  .amdhsa_next_free_sgpr 102
  .amdhsa_accum_offset 256
  .amdhsa_group_segment_fixed_size 0
  .amdhsa_kernarg_size 88
  .amdhsa_user_sgpr_count 2
  .amdhsa_user_sgpr_kernarg_segment_ptr 1
  .amdhsa_system_sgpr_workgroup_id_x 1
.end_amdhsa_kernel
```
